```python
import torch

def _softmax(x, axis=-1):
    return torch.softmax(x, dim=axis)
def _gelu(x):
    return torch.nn.functional.gelu(x, approximate="tanh")
def _silu(x):
    return torch.nn.functional.silu(x)
def _sigmoid(x):
    return torch.sigmoid(x)
def _layernorm(x, axis=-1, eps=1e-5):
    m = x.mean(dim=axis, keepdim=True)
    v = x.var(dim=axis, keepdim=True, unbiased=False)
    return (x - m) / torch.sqrt(v + eps)
def _scatter_add(tgt, idx, src, axis=0):
    return tgt.clone().index_add_(axis, idx, src)
def _segment_sum(src, seg, n):
    out = torch.zeros((n,) + src.shape[1:], dtype=src.dtype)
    return out.index_add_(0, seg, src)
def _pad(x, pw):
    flat = tuple(v for pair in reversed(pw) for v in pair)
    return torch.nn.functional.pad(x, flat)

kernel_name = 'parallel_sum__sliding_local_dilated__mixer_token_mlp__prompt'

def setup_inputs():

    _w = (lambda a: (lambda t: t.to(torch.bfloat16) if t.is_floating_point() else t)(torch.as_tensor(a)))
    def _A_setup():
        B, S, D = 1, 2048, 448
        return {
            "x": _w((lambda *s: torch.randn(*s, dtype=torch.bfloat16) * 0.05)(B, S, D)),
            "wqkv": _w((lambda *s: torch.randn(*s, dtype=torch.bfloat16) * 0.05)(D, 3 * D)),
            "wo": _w((lambda *s: torch.randn(*s, dtype=torch.bfloat16) * 0.05)(D, D)),
        }
    _A_in = _A_setup()

    def _B_setup():
        B, S, D, F = 1, 2048, 448, 1792
        return {
            "x": _w((lambda *s: torch.randn(*s, dtype=torch.bfloat16) * 0.05)(B, S, D)),
            "w1": _w((lambda *s: torch.randn(*s, dtype=torch.bfloat16) * 1.6)(S, F) * (S ** -0.5)),
            "b1": _w((lambda *s: torch.randn(*s, dtype=torch.bfloat16) * 12.8)(F) * 0.02),
            "w2": _w((lambda *s: torch.randn(*s, dtype=torch.bfloat16) * 0.4)(F, S) * (F ** -0.5)),
            "b2": _w((lambda *s: torch.randn(*s, dtype=torch.bfloat16) * 6.4)(S) * 0.02),
        }
    _B_in = _B_setup()

    return {
        "A_x": _A_in["x"],
        "A_wqkv": _A_in["wqkv"],
        "A_wo": _A_in["wo"],
        "B_x": _B_in["x"],
        "B_w1": _B_in["w1"],
        "B_b1": _B_in["b1"],
        "B_w2": _B_in["w2"],
        "B_b2": _B_in["b2"],
    }

def reference(A_x, A_wqkv, A_wo, B_x, B_w1, B_b1, B_w2, B_b2):
    def _A_ref(x, wqkv, wo):
        B, S, D = x.shape
        H = 16; Dh = D // H
        W, dil = 8, 2
        qkv = (lambda x, *d: x.permute(*d))((x @ wqkv).reshape(B, S, 3, H, Dh), 2, 0, 3, 1, 4)
        q, k, v = qkv[0], qkv[1], qkv[2]
        scale = Dh ** -0.5
        pos = torch.arange(S)
        off = torch.arange(W) * dil
        idx = pos[:, None] - off[None, :]
        mask = idx >= 0
        idx_c = torch.where(mask, idx, 0).reshape(-1)
        kg = k[:, :, idx_c, :].reshape(B, H, S, W, Dh)
        vg = v[:, :, idx_c, :].reshape(B, H, S, W, Dh)
        logits = torch.einsum("bhsd,bhswd->bhsw", q, kg) * scale
        logits = torch.where(mask[None, None, :, :], logits, -1e9)
        attn = _softmax(logits, axis=-1)
        o = torch.einsum("bhsw,bhswd->bhsd", attn, vg)
        return (lambda x, *d: x.permute(*d))(o, 0, 2, 1, 3).reshape(B, S, D) @ wo

    def _B_ref(x, w1, b1, w2, b2):
        B, S, D = x.shape
        h = _layernorm(x, axis=-1)
        u = torch.einsum("bsd,sf->bdf", h, w1) + b1
        u = _gelu(u)
        y = torch.einsum("bdf,fs->bds", u, w2) + b2
        return (lambda x, *d: x.permute(*d))(y, 0, 2, 1)

    x = A_x
    xn = _layernorm(x, axis=-1)
    return x + _A_ref(xn, A_wqkv, A_wo) + _B_ref(xn, B_w1, B_b1, B_w2, B_b2)
```

```asm
; @launch grid=(256,1,1) block=(256,1,1) lds=163840
.amdgcn_target "amdgcn-amd-amdhsa--gfx950"
.text
.globl parallel_sum__sliding_local_dilated__mixer_token_mlp__prompt_kernel
.p2align 8
.type parallel_sum__sliding_local_dilated__mixer_token_mlp__prompt_kernel,@function
parallel_sum__sliding_local_dilated__mixer_token_mlp__prompt_kernel:
    s_cmp_ge_u32 s2, 256
    s_cbranch_scc1 L_end
    s_load_dwordx2 s[4:5], s[0:1], 0
    s_load_dwordx2 s[8:9], s[0:1], 8
    s_load_dwordx2 s[24:25], s[0:1], 80
    s_load_dwordx2 s[40:41], s[0:1], 72
    s_load_dwordx2 s[16:17], s[0:1], 32
    s_load_dwordx2 s[20:21], s[0:1], 48
    s_load_dwordx2 s[12:13], s[0:1], 16
    s_load_dwordx2 s[28:29], s[0:1], 64
    s_load_dwordx2 s[32:33], s[0:1], 40
    s_load_dwordx2 s[36:37], s[0:1], 56
    v_lshrrev_b32 v17, 6, v0
    v_and_b32 v1, 63, v0
    s_and_b32 s45, s2, 7
    s_lshr_b32 s46, s2, 3
    v_readfirstlane_b32 s44, v17
    s_mov_b32 s6, 1835008
    s_mov_b32 s7, 0x20000
    s_mov_b32 s10, 1204224
    s_mov_b32 s11, 0x20000
    s_mov_b32 s26, 16777216
    s_mov_b32 s27, 0x20000
    s_mov_b32 s42, 256
    s_mov_b32 s43, 0x20000
    s_mov_b32 s18, 7340032
    s_mov_b32 s19, 0x20000
    s_mov_b32 s22, 7340032
    s_mov_b32 s23, 0x20000
    s_mov_b32 s14, 401408
    s_mov_b32 s15, 0x20000
    s_mov_b32 s30, 1835008
    s_mov_b32 s31, 0x20000
    s_mov_b32 s34, 3584
    s_mov_b32 s35, 0x20000
    s_mov_b32 s38, 4096
    s_mov_b32 s39, 0x20000
    s_mul_i32 s53, s46, 37
    s_lshr_b32 s53, s53, 8
    s_mul_i32 s54, s53, 7
    s_sub_u32 s49, s46, s54
    s_lshl_b32 s48, s45, 2
    s_add_u32 s48, s48, s53
    s_lshl_b32 s52, s44, 11
    v_lshlrev_b32 v14, 4, v1
    s_waitcnt lgkmcnt(0)
    s_or_b32 s53, s2, s44
    s_cmp_lg_u32 s53, 0
    s_cbranch_scc1 L_nononce
    s_memrealtime s[98:99]
    s_waitcnt lgkmcnt(0)
    s_or_b32 s98, s98, 1
    v_mov_b32 v17, 0
    v_mov_b32 v18, s98
    s_mov_b64 exec, 1
    buffer_store_dword v18, v17, s[40:43], 0 offen sc1
    s_mov_b64 exec, -1
L_nononce:
    s_cmp_ge_u32 s46, 28
    s_cbranch_scc1 L_helper
    v_lshrrev_b32 v29, 2, v0
    v_mul_u32_u24 v17, 896, v29
    v_and_b32 v30, 3, v0
    v_lshl_add_u32 v17, v30, 4, v17
    s_mul_i32 s53, s48, 57344
    s_mov_b32 s54, s49
    s_lshl_b32 s60, s54, 7
    s_add_u32 s60, s60, s53
    s_mul_i32 s67, s54, 172032
    s_add_u32 s54, s54, 1
    s_cmp_eq_u32 s54, 7
    s_cselect_b32 s54, 0, s54
    s_lshl_b32 s61, s54, 7
    s_add_u32 s61, s61, s53
    s_mul_i32 s68, s54, 172032
    s_add_u32 s54, s54, 1
    s_cmp_eq_u32 s54, 7
    s_cselect_b32 s54, 0, s54
    s_lshl_b32 s62, s54, 7
    s_add_u32 s62, s62, s53
    s_mul_i32 s69, s54, 172032
    s_add_u32 s54, s54, 1
    s_cmp_eq_u32 s54, 7
    s_cselect_b32 s54, 0, s54
    s_lshl_b32 s63, s54, 7
    s_add_u32 s63, s63, s53
    s_mul_i32 s70, s54, 172032
    s_add_u32 s54, s54, 1
    s_cmp_eq_u32 s54, 7
    s_cselect_b32 s54, 0, s54
    s_lshl_b32 s64, s54, 7
    s_add_u32 s64, s64, s53
    s_mul_i32 s71, s54, 172032
    s_add_u32 s54, s54, 1
    s_cmp_eq_u32 s54, 7
    s_cselect_b32 s54, 0, s54
    s_lshl_b32 s65, s54, 7
    s_add_u32 s65, s65, s53
    s_mul_i32 s72, s54, 172032
    s_add_u32 s54, s54, 1
    s_cmp_eq_u32 s54, 7
    s_cselect_b32 s54, 0, s54
    s_lshl_b32 s66, s54, 7
    s_add_u32 s66, s66, s53
    s_mul_i32 s73, s54, 172032
    buffer_load_dwordx4 v[32:35], v17, s[4:7], s60 offen offset:0
    buffer_load_dwordx4 v[36:39], v17, s[4:7], s60 offen offset:64
    buffer_load_dwordx4 v[40:43], v17, s[4:7], s61 offen offset:0
    buffer_load_dwordx4 v[44:47], v17, s[4:7], s61 offen offset:64
    buffer_load_dwordx4 v[48:51], v17, s[4:7], s62 offen offset:0
    buffer_load_dwordx4 v[52:55], v17, s[4:7], s62 offen offset:64
    buffer_load_dwordx4 v[56:59], v17, s[4:7], s63 offen offset:0
    buffer_load_dwordx4 v[60:63], v17, s[4:7], s63 offen offset:64
    buffer_load_dwordx4 v[64:67], v17, s[4:7], s64 offen offset:0
    buffer_load_dwordx4 v[68:71], v17, s[4:7], s64 offen offset:64
    buffer_load_dwordx4 v[72:75], v17, s[4:7], s65 offen offset:0
    buffer_load_dwordx4 v[76:79], v17, s[4:7], s65 offen offset:64
    buffer_load_dwordx4 v[80:83], v17, s[4:7], s66 offen offset:0
    buffer_load_dwordx4 v[84:87], v17, s[4:7], s66 offen offset:64
    v_lshrrev_b32 v210, 5, v1
    v_bfe_u32 v211, v1, 2, 2
    v_lshl_add_u32 v208, v210, 2, v211
    v_bfe_u32 v212, v1, 4, 1
    v_lshlrev_b32 v209, 4, v30
    v_lshl_add_u32 v209, v212, 6, v209
    s_mul_i32 s53, s44, 43008
    s_mul_i32 s54, s49, 384
    s_add_u32 s53, s53, s54
    v_mul_u32_u24 v18, 2688, v208
    v_add3_u32 v18, v18, v209, s53
    v_add_u32 v19, 128, v18
    v_add_u32 v20, 256, v18
    v_add_u32 v21, 21504, v18
    v_add_u32 v22, 21632, v18
    v_add_u32 v23, 21760, v18
    s_mul_i32 s55, s44, 6144
    s_add_u32 m0, s55, 65536
    s_nop 0
    buffer_load_dwordx4 v18, s[8:11], s67 offen lds
    s_add_u32 m0, s55, 66560
    s_nop 0
    buffer_load_dwordx4 v19, s[8:11], s67 offen lds
    s_add_u32 m0, s55, 67584
    s_nop 0
    buffer_load_dwordx4 v20, s[8:11], s67 offen lds
    s_add_u32 m0, s55, 68608
    s_nop 0
    buffer_load_dwordx4 v21, s[8:11], s67 offen lds
    s_add_u32 m0, s55, 69632
    s_nop 0
    buffer_load_dwordx4 v22, s[8:11], s67 offen lds
    s_add_u32 m0, s55, 70656
    s_nop 0
    buffer_load_dwordx4 v23, s[8:11], s67 offen lds
    s_add_u32 m0, s55, 90112
    s_nop 0
    buffer_load_dwordx4 v18, s[8:11], s68 offen lds
    s_add_u32 m0, s55, 91136
    s_nop 0
    buffer_load_dwordx4 v19, s[8:11], s68 offen lds
    s_add_u32 m0, s55, 92160
    s_nop 0
    buffer_load_dwordx4 v20, s[8:11], s68 offen lds
    s_add_u32 m0, s55, 93184
    s_nop 0
    buffer_load_dwordx4 v21, s[8:11], s68 offen lds
    s_add_u32 m0, s55, 94208
    s_nop 0
    buffer_load_dwordx4 v22, s[8:11], s68 offen lds
    s_add_u32 m0, s55, 95232
    s_nop 0
    buffer_load_dwordx4 v23, s[8:11], s68 offen lds
    s_add_u32 m0, s55, 114688
    s_nop 0
    buffer_load_dwordx4 v18, s[8:11], s69 offen lds
    s_add_u32 m0, s55, 115712
    s_nop 0
    buffer_load_dwordx4 v19, s[8:11], s69 offen lds
    s_add_u32 m0, s55, 116736
    s_nop 0
    buffer_load_dwordx4 v20, s[8:11], s69 offen lds
    s_add_u32 m0, s55, 117760
    s_nop 0
    buffer_load_dwordx4 v21, s[8:11], s69 offen lds
    s_add_u32 m0, s55, 118784
    s_nop 0
    buffer_load_dwordx4 v22, s[8:11], s69 offen lds
    s_add_u32 m0, s55, 119808
    s_nop 0
    buffer_load_dwordx4 v23, s[8:11], s69 offen lds
    s_add_u32 m0, s55, 139264
    s_nop 0
    buffer_load_dwordx4 v18, s[8:11], s70 offen lds
    s_add_u32 m0, s55, 140288
    s_nop 0
    buffer_load_dwordx4 v19, s[8:11], s70 offen lds
    s_add_u32 m0, s55, 141312
    s_nop 0
    buffer_load_dwordx4 v20, s[8:11], s70 offen lds
    s_add_u32 m0, s55, 142336
    s_nop 0
    buffer_load_dwordx4 v21, s[8:11], s70 offen lds
    s_add_u32 m0, s55, 143360
    s_nop 0
    buffer_load_dwordx4 v22, s[8:11], s70 offen lds
    s_add_u32 m0, s55, 144384
    s_nop 0
    buffer_load_dwordx4 v23, s[8:11], s70 offen lds
    v_mul_u32_u24 v24, 1056, v30
    v_lshl_add_u32 v24, v29, 4, v24
    v_lshlrev_b32 v213, 6, v211
    v_lshl_add_u32 v213, v212, 5, v213
    v_lshl_add_u32 v213, v30, 3, v213
    s_and_b32 s53, s44, 1
    s_lshl_b32 s53, s53, 9
    v_and_b32 v214, 31, v1
    v_mul_u32_u24 v25, 1056, v210
    v_lshl_add_u32 v25, v214, 4, v25
    v_add_u32 v25, s53, v25
    s_lshr_b32 s53, s44, 1
    s_lshl_b32 s53, s53, 8
    s_add_u32 s53, s53, 65536
    v_mul_u32_u24 v26, 3072, v210
    v_add3_u32 v26, v26, v213, s53
    v_add_u32 v27, 49152, v26
    v_bfe_u32 v215, v1, 1, 1
    v_lshl_add_u32 v215, v212, 1, v215
    v_mul_u32_u24 v28, 1056, v215
    v_lshl_add_u32 v215, v210, 3, v211
    v_lshl_add_u32 v28, v215, 4, v28
    v_and_b32 v215, 1, v1
    v_lshl_add_u32 v28, v215, 3, v28
    s_lshl_b32 s53, s44, 8
    v_add_u32 v28, s53, v28
    v_lshl_add_u32 v2, v210, 10, v213
    v_add_u32 v2, s52, v2
    v_add_u32 v3, 65536, v2
    v_add_u32 v4, 131072, v2
    v_lshl_add_u32 v5, v210, 9, v213
    v_add_u32 v5, s52, v5
    v_add_u32 v6, 65536, v5
    v_add_u32 v7, 131072, v5
    s_lshr_b32 s53, s45, 1
    s_mul_i32 s53, s53, 49
    s_and_b32 s54, s45, 1
    s_mul_i32 s56, s54, 25
    s_add_u32 s53, s53, s56
    s_add_u32 s53, s53, s46
    s_add_u32 s54, s54, s46
    s_cmp_lt_u32 s54, 25
    s_cselect_b32 s75, 1, 0
    s_min_u32 s53, s53, 195
    s_mul_i32 s50, s53, 9363
    s_lshr_b32 s50, s50, 16
    s_mul_i32 s54, s50, 7
    s_sub_u32 s51, s53, s54
    s_mul_i32 s53, s44, 1835008
    s_lshl_b32 s54, s50, 7
    s_add_u32 s53, s53, s54
    s_lshr_b32 s54, s44, 1
    s_lshl_b32 s54, s54, 6
    v_xor_b32 v215, s54, v209
    v_mul_u32_u24 v8, 3584, v208
    v_add3_u32 v8, v8, v215, s53
    v_add_u32 v9, 27648, v8
    s_mul_i32 s53, s44, 1835008
    s_lshl_b32 s54, s48, 7
    s_add_u32 s53, s53, s54
    v_lshlrev_b32 v10, 12, v208
    v_add3_u32 v10, v10, v209, s53
    v_add_u32 v11, 31744, v10
    s_mul_i32 s53, s44, 100352
    s_lshl_b32 s54, s49, 7
    s_add_u32 s53, s53, s54
    v_mul_u32_u24 v12, 896, v208
    v_add3_u32 v12, v12, v209, s53
    v_add_u32 v13, 6144, v12
    s_and_b32 s53, s44, 1
    s_lshl_b32 s53, s53, 10
    v_add_u32 v15, s53, v14
    v_xor_b32 v16, 1024, v15
    s_mov_b32 s74, 0x3f803f80
    v_mov_b32 v216, 0
    v_mov_b32 v217, 0
    s_waitcnt vmcnt(37)
    v_dot2c_f32_bf16 v216, s74, v32
    v_dot2c_f32_bf16 v217, v32, v32
    v_lshlrev_b32 v96, 16, v32
    v_and_b32 v97, 0xffff0000, v32
    v_dot2c_f32_bf16 v216, s74, v33
    v_dot2c_f32_bf16 v217, v33, v33
    v_lshlrev_b32 v98, 16, v33
    v_and_b32 v99, 0xffff0000, v33
    v_dot2c_f32_bf16 v216, s74, v34
    v_dot2c_f32_bf16 v217, v34, v34
    v_lshlrev_b32 v100, 16, v34
    v_and_b32 v101, 0xffff0000, v34
    v_dot2c_f32_bf16 v216, s74, v35
    v_dot2c_f32_bf16 v217, v35, v35
    v_lshlrev_b32 v102, 16, v35
    v_and_b32 v103, 0xffff0000, v35
    s_waitcnt vmcnt(36)
    v_dot2c_f32_bf16 v216, s74, v36
    v_dot2c_f32_bf16 v217, v36, v36
    v_lshlrev_b32 v104, 16, v36
    v_and_b32 v105, 0xffff0000, v36
    v_dot2c_f32_bf16 v216, s74, v37
    v_dot2c_f32_bf16 v217, v37, v37
    v_lshlrev_b32 v106, 16, v37
    v_and_b32 v107, 0xffff0000, v37
    v_dot2c_f32_bf16 v216, s74, v38
    v_dot2c_f32_bf16 v217, v38, v38
    v_lshlrev_b32 v108, 16, v38
    v_and_b32 v109, 0xffff0000, v38
    v_dot2c_f32_bf16 v216, s74, v39
    v_dot2c_f32_bf16 v217, v39, v39
    v_lshlrev_b32 v110, 16, v39
    v_and_b32 v111, 0xffff0000, v39
    s_waitcnt vmcnt(35)
    v_dot2c_f32_bf16 v216, s74, v40
    v_dot2c_f32_bf16 v217, v40, v40
    v_lshlrev_b32 v112, 16, v40
    v_and_b32 v113, 0xffff0000, v40
    v_dot2c_f32_bf16 v216, s74, v41
    v_dot2c_f32_bf16 v217, v41, v41
    v_lshlrev_b32 v114, 16, v41
    v_and_b32 v115, 0xffff0000, v41
    v_dot2c_f32_bf16 v216, s74, v42
    v_dot2c_f32_bf16 v217, v42, v42
    v_lshlrev_b32 v116, 16, v42
    v_and_b32 v117, 0xffff0000, v42
    v_dot2c_f32_bf16 v216, s74, v43
    v_dot2c_f32_bf16 v217, v43, v43
    v_lshlrev_b32 v118, 16, v43
    v_and_b32 v119, 0xffff0000, v43
    s_waitcnt vmcnt(34)
    v_dot2c_f32_bf16 v216, s74, v44
    v_dot2c_f32_bf16 v217, v44, v44
    v_lshlrev_b32 v120, 16, v44
    v_and_b32 v121, 0xffff0000, v44
    v_dot2c_f32_bf16 v216, s74, v45
    v_dot2c_f32_bf16 v217, v45, v45
    v_lshlrev_b32 v122, 16, v45
    v_and_b32 v123, 0xffff0000, v45
    v_dot2c_f32_bf16 v216, s74, v46
    v_dot2c_f32_bf16 v217, v46, v46
    v_lshlrev_b32 v124, 16, v46
    v_and_b32 v125, 0xffff0000, v46
    v_dot2c_f32_bf16 v216, s74, v47
    v_dot2c_f32_bf16 v217, v47, v47
    v_lshlrev_b32 v126, 16, v47
    v_and_b32 v127, 0xffff0000, v47
    s_waitcnt vmcnt(33)
    v_dot2c_f32_bf16 v216, s74, v48
    v_dot2c_f32_bf16 v217, v48, v48
    v_lshlrev_b32 v128, 16, v48
    v_and_b32 v129, 0xffff0000, v48
    v_dot2c_f32_bf16 v216, s74, v49
    v_dot2c_f32_bf16 v217, v49, v49
    v_lshlrev_b32 v130, 16, v49
    v_and_b32 v131, 0xffff0000, v49
    v_dot2c_f32_bf16 v216, s74, v50
    v_dot2c_f32_bf16 v217, v50, v50
    v_lshlrev_b32 v132, 16, v50
    v_and_b32 v133, 0xffff0000, v50
    v_dot2c_f32_bf16 v216, s74, v51
    v_dot2c_f32_bf16 v217, v51, v51
    v_lshlrev_b32 v134, 16, v51
    v_and_b32 v135, 0xffff0000, v51
    s_waitcnt vmcnt(32)
    v_dot2c_f32_bf16 v216, s74, v52
    v_dot2c_f32_bf16 v217, v52, v52
    v_lshlrev_b32 v136, 16, v52
    v_and_b32 v137, 0xffff0000, v52
    v_dot2c_f32_bf16 v216, s74, v53
    v_dot2c_f32_bf16 v217, v53, v53
    v_lshlrev_b32 v138, 16, v53
    v_and_b32 v139, 0xffff0000, v53
    v_dot2c_f32_bf16 v216, s74, v54
    v_dot2c_f32_bf16 v217, v54, v54
    v_lshlrev_b32 v140, 16, v54
    v_and_b32 v141, 0xffff0000, v54
    v_dot2c_f32_bf16 v216, s74, v55
    v_dot2c_f32_bf16 v217, v55, v55
    v_lshlrev_b32 v142, 16, v55
    v_and_b32 v143, 0xffff0000, v55
    s_waitcnt vmcnt(31)
    v_dot2c_f32_bf16 v216, s74, v56
    v_dot2c_f32_bf16 v217, v56, v56
    v_lshlrev_b32 v144, 16, v56
    v_and_b32 v145, 0xffff0000, v56
    v_dot2c_f32_bf16 v216, s74, v57
    v_dot2c_f32_bf16 v217, v57, v57
    v_lshlrev_b32 v146, 16, v57
    v_and_b32 v147, 0xffff0000, v57
    v_dot2c_f32_bf16 v216, s74, v58
    v_dot2c_f32_bf16 v217, v58, v58
    v_lshlrev_b32 v148, 16, v58
    v_and_b32 v149, 0xffff0000, v58
    v_dot2c_f32_bf16 v216, s74, v59
    v_dot2c_f32_bf16 v217, v59, v59
    v_lshlrev_b32 v150, 16, v59
    v_and_b32 v151, 0xffff0000, v59
    s_waitcnt vmcnt(30)
    v_dot2c_f32_bf16 v216, s74, v60
    v_dot2c_f32_bf16 v217, v60, v60
    v_lshlrev_b32 v152, 16, v60
    v_and_b32 v153, 0xffff0000, v60
    v_dot2c_f32_bf16 v216, s74, v61
    v_dot2c_f32_bf16 v217, v61, v61
    v_lshlrev_b32 v154, 16, v61
    v_and_b32 v155, 0xffff0000, v61
    v_dot2c_f32_bf16 v216, s74, v62
    v_dot2c_f32_bf16 v217, v62, v62
    v_lshlrev_b32 v156, 16, v62
    v_and_b32 v157, 0xffff0000, v62
    v_dot2c_f32_bf16 v216, s74, v63
    v_dot2c_f32_bf16 v217, v63, v63
    v_lshlrev_b32 v158, 16, v63
    v_and_b32 v159, 0xffff0000, v63
    s_waitcnt vmcnt(29)
    v_dot2c_f32_bf16 v216, s74, v64
    v_dot2c_f32_bf16 v217, v64, v64
    v_lshlrev_b32 v160, 16, v64
    v_and_b32 v161, 0xffff0000, v64
    v_dot2c_f32_bf16 v216, s74, v65
    v_dot2c_f32_bf16 v217, v65, v65
    v_lshlrev_b32 v162, 16, v65
    v_and_b32 v163, 0xffff0000, v65
    v_dot2c_f32_bf16 v216, s74, v66
    v_dot2c_f32_bf16 v217, v66, v66
    v_lshlrev_b32 v164, 16, v66
    v_and_b32 v165, 0xffff0000, v66
    v_dot2c_f32_bf16 v216, s74, v67
    v_dot2c_f32_bf16 v217, v67, v67
    v_lshlrev_b32 v166, 16, v67
    v_and_b32 v167, 0xffff0000, v67
    s_waitcnt vmcnt(28)
    v_dot2c_f32_bf16 v216, s74, v68
    v_dot2c_f32_bf16 v217, v68, v68
    v_lshlrev_b32 v168, 16, v68
    v_and_b32 v169, 0xffff0000, v68
    v_dot2c_f32_bf16 v216, s74, v69
    v_dot2c_f32_bf16 v217, v69, v69
    v_lshlrev_b32 v170, 16, v69
    v_and_b32 v171, 0xffff0000, v69
    v_dot2c_f32_bf16 v216, s74, v70
    v_dot2c_f32_bf16 v217, v70, v70
    v_lshlrev_b32 v172, 16, v70
    v_and_b32 v173, 0xffff0000, v70
    v_dot2c_f32_bf16 v216, s74, v71
    v_dot2c_f32_bf16 v217, v71, v71
    v_lshlrev_b32 v174, 16, v71
    v_and_b32 v175, 0xffff0000, v71
    s_waitcnt vmcnt(27)
    v_dot2c_f32_bf16 v216, s74, v72
    v_dot2c_f32_bf16 v217, v72, v72
    v_lshlrev_b32 v176, 16, v72
    v_and_b32 v177, 0xffff0000, v72
    v_dot2c_f32_bf16 v216, s74, v73
    v_dot2c_f32_bf16 v217, v73, v73
    v_lshlrev_b32 v178, 16, v73
    v_and_b32 v179, 0xffff0000, v73
    v_dot2c_f32_bf16 v216, s74, v74
    v_dot2c_f32_bf16 v217, v74, v74
    v_lshlrev_b32 v180, 16, v74
    v_and_b32 v181, 0xffff0000, v74
    v_dot2c_f32_bf16 v216, s74, v75
    v_dot2c_f32_bf16 v217, v75, v75
    v_lshlrev_b32 v182, 16, v75
    v_and_b32 v183, 0xffff0000, v75
    s_waitcnt vmcnt(26)
    v_dot2c_f32_bf16 v216, s74, v76
    v_dot2c_f32_bf16 v217, v76, v76
    v_lshlrev_b32 v184, 16, v76
    v_and_b32 v185, 0xffff0000, v76
    v_dot2c_f32_bf16 v216, s74, v77
    v_dot2c_f32_bf16 v217, v77, v77
    v_lshlrev_b32 v186, 16, v77
    v_and_b32 v187, 0xffff0000, v77
    v_dot2c_f32_bf16 v216, s74, v78
    v_dot2c_f32_bf16 v217, v78, v78
    v_lshlrev_b32 v188, 16, v78
    v_and_b32 v189, 0xffff0000, v78
    v_dot2c_f32_bf16 v216, s74, v79
    v_dot2c_f32_bf16 v217, v79, v79
    v_lshlrev_b32 v190, 16, v79
    v_and_b32 v191, 0xffff0000, v79
    s_waitcnt vmcnt(25)
    v_dot2c_f32_bf16 v216, s74, v80
    v_dot2c_f32_bf16 v217, v80, v80
    v_lshlrev_b32 v192, 16, v80
    v_and_b32 v193, 0xffff0000, v80
    v_dot2c_f32_bf16 v216, s74, v81
    v_dot2c_f32_bf16 v217, v81, v81
    v_lshlrev_b32 v194, 16, v81
    v_and_b32 v195, 0xffff0000, v81
    v_dot2c_f32_bf16 v216, s74, v82
    v_dot2c_f32_bf16 v217, v82, v82
    v_lshlrev_b32 v196, 16, v82
    v_and_b32 v197, 0xffff0000, v82
    v_dot2c_f32_bf16 v216, s74, v83
    v_dot2c_f32_bf16 v217, v83, v83
    v_lshlrev_b32 v198, 16, v83
    v_and_b32 v199, 0xffff0000, v83
    s_waitcnt vmcnt(24)
    v_dot2c_f32_bf16 v216, s74, v84
    v_dot2c_f32_bf16 v217, v84, v84
    v_lshlrev_b32 v200, 16, v84
    v_and_b32 v201, 0xffff0000, v84
    v_dot2c_f32_bf16 v216, s74, v85
    v_dot2c_f32_bf16 v217, v85, v85
    v_lshlrev_b32 v202, 16, v85
    v_and_b32 v203, 0xffff0000, v85
    v_dot2c_f32_bf16 v216, s74, v86
    v_dot2c_f32_bf16 v217, v86, v86
    v_lshlrev_b32 v204, 16, v86
    v_and_b32 v205, 0xffff0000, v86
    v_dot2c_f32_bf16 v216, s74, v87
    v_dot2c_f32_bf16 v217, v87, v87
    v_lshlrev_b32 v206, 16, v87
    v_and_b32 v207, 0xffff0000, v87
    v_mov_b32 v29, 0
    buffer_load_dword v29, v29, s[40:43], 0 offen sc1
    v_add_f32_dpp v216, v216, v216 quad_perm:[1,0,3,2] row_mask:0xf bank_mask:0xf
    v_add_f32_dpp v217, v217, v217 quad_perm:[1,0,3,2] row_mask:0xf bank_mask:0xf
    s_nop 0
    v_add_f32_dpp v216, v216, v216 quad_perm:[2,3,0,1] row_mask:0xf bank_mask:0xf
    v_add_f32_dpp v217, v217, v217 quad_perm:[2,3,0,1] row_mask:0xf bank_mask:0xf
    v_mul_f32 v218, 0x3b124925, v216
    v_mul_f32 v219, 0x3b124925, v217
    v_fma_f32 v219, -v218, v218, v219
    v_max_f32 v219, 0, v219
    v_cvt_pk_bf16_f32 v220, v219, v219
    v_and_b32 v220, 0xffff0000, v220
    v_add_f32 v220, 0x3727c5ac, v220
    v_cvt_pk_bf16_f32 v220, v220, v220
    v_and_b32 v220, 0xffff0000, v220
    v_sqrt_f32 v220, v220
    s_nop 0
    v_cvt_pk_bf16_f32 v220, v220, v220
    v_and_b32 v220, 0xffff0000, v220
    v_rcp_f32 v220, v220
    s_nop 0
    v_mul_f32 v219, v219, v220
    v_mul_f32 v219, v219, v220
    v_cvt_pk_bf16_f32 v224, v219, v219
    v_and_b32 v224, 0xffff0000, v224
    v_add_f32 v224, 0x3727c5ac, v224
    v_cvt_pk_bf16_f32 v224, v224, v224
    v_and_b32 v224, 0xffff0000, v224
    v_sqrt_f32 v224, v224
    s_nop 0
    v_cvt_pk_bf16_f32 v224, v224, v224
    v_and_b32 v224, 0xffff0000, v224
    v_rcp_f32 v224, v224
    s_nop 0
    v_mul_f32 v224, v224, v220
    v_mul_f32 v222, v218, v220
    v_mul_f32 v226, v218, v224
    v_pk_fma_f32 v[228:229], v[96:97], v[224:225], v[226:227] op_sel_hi:[1,0,0] neg_lo:[0,0,1] neg_hi:[0,0,1]
    v_pk_fma_f32 v[230:231], v[98:99], v[224:225], v[226:227] op_sel_hi:[1,0,0] neg_lo:[0,0,1] neg_hi:[0,0,1]
    v_pk_fma_f32 v[232:233], v[100:101], v[224:225], v[226:227] op_sel_hi:[1,0,0] neg_lo:[0,0,1] neg_hi:[0,0,1]
    v_pk_fma_f32 v[234:235], v[102:103], v[224:225], v[226:227] op_sel_hi:[1,0,0] neg_lo:[0,0,1] neg_hi:[0,0,1]
    v_pk_fma_f32 v[236:237], v[104:105], v[224:225], v[226:227] op_sel_hi:[1,0,0] neg_lo:[0,0,1] neg_hi:[0,0,1]
    v_pk_fma_f32 v[238:239], v[106:107], v[224:225], v[226:227] op_sel_hi:[1,0,0] neg_lo:[0,0,1] neg_hi:[0,0,1]
    v_pk_fma_f32 v[240:241], v[108:109], v[224:225], v[226:227] op_sel_hi:[1,0,0] neg_lo:[0,0,1] neg_hi:[0,0,1]
    v_pk_fma_f32 v[242:243], v[110:111], v[224:225], v[226:227] op_sel_hi:[1,0,0] neg_lo:[0,0,1] neg_hi:[0,0,1]
    v_cvt_pk_bf16_f32 v244, v228, v229
    v_cvt_pk_bf16_f32 v245, v230, v231
    v_cvt_pk_bf16_f32 v246, v232, v233
    v_cvt_pk_bf16_f32 v247, v234, v235
    v_cvt_pk_bf16_f32 v248, v236, v237
    v_cvt_pk_bf16_f32 v249, v238, v239
    v_cvt_pk_bf16_f32 v250, v240, v241
    v_cvt_pk_bf16_f32 v251, v242, v243
    ds_write_b128 v24, v[244:247]
    ds_write_b128 v24, v[248:251] offset:4224
    ds_read_b64_tr_b16 v[228:229], v28 offset:0
    ds_read_b64_tr_b16 v[230:231], v28 offset:64
    ds_read_b64_tr_b16 v[232:233], v28 offset:4224
    ds_read_b64_tr_b16 v[234:235], v28 offset:4288
    s_lshl_b32 s53, s49, 18
    s_lshl_b32 s54, s48, 13
    s_add_u32 s53, s53, s54
    s_add_u32 s53, s53, s52
    v_pk_fma_f32 v[96:97], v[96:97], v[220:221], v[222:223] op_sel_hi:[1,0,0] neg_lo:[0,0,1] neg_hi:[0,0,1]
    v_pk_fma_f32 v[98:99], v[98:99], v[220:221], v[222:223] op_sel_hi:[1,0,0] neg_lo:[0,0,1] neg_hi:[0,0,1]
    v_pk_fma_f32 v[100:101], v[100:101], v[220:221], v[222:223] op_sel_hi:[1,0,0] neg_lo:[0,0,1] neg_hi:[0,0,1]
    v_pk_fma_f32 v[102:103], v[102:103], v[220:221], v[222:223] op_sel_hi:[1,0,0] neg_lo:[0,0,1] neg_hi:[0,0,1]
    v_cvt_pk_bf16_f32 v32, v96, v97
    v_cvt_pk_bf16_f32 v33, v98, v99
    v_cvt_pk_bf16_f32 v34, v100, v101
    v_cvt_pk_bf16_f32 v35, v102, v103
    ds_write_b128 v24, v[32:35] offset:0
    s_waitcnt lgkmcnt(1)
    buffer_store_dwordx4 v[228:231], v14, s[24:27], s53 offen offset:0 sc1
    buffer_store_dwordx4 v[232:235], v14, s[24:27], s53 offen offset:1024 sc1
    v_pk_fma_f32 v[104:105], v[104:105], v[220:221], v[222:223] op_sel_hi:[1,0,0] neg_lo:[0,0,1] neg_hi:[0,0,1]
    v_pk_fma_f32 v[106:107], v[106:107], v[220:221], v[222:223] op_sel_hi:[1,0,0] neg_lo:[0,0,1] neg_hi:[0,0,1]
    v_pk_fma_f32 v[108:109], v[108:109], v[220:221], v[222:223] op_sel_hi:[1,0,0] neg_lo:[0,0,1] neg_hi:[0,0,1]
    v_pk_fma_f32 v[110:111], v[110:111], v[220:221], v[222:223] op_sel_hi:[1,0,0] neg_lo:[0,0,1] neg_hi:[0,0,1]
    v_cvt_pk_bf16_f32 v36, v104, v105
    v_cvt_pk_bf16_f32 v37, v106, v107
    v_cvt_pk_bf16_f32 v38, v108, v109
    v_cvt_pk_bf16_f32 v39, v110, v111
    ds_write_b128 v24, v[36:39] offset:4224
    v_pk_fma_f32 v[112:113], v[112:113], v[220:221], v[222:223] op_sel_hi:[1,0,0] neg_lo:[0,0,1] neg_hi:[0,0,1]
    v_pk_fma_f32 v[114:115], v[114:115], v[220:221], v[222:223] op_sel_hi:[1,0,0] neg_lo:[0,0,1] neg_hi:[0,0,1]
    v_pk_fma_f32 v[116:117], v[116:117], v[220:221], v[222:223] op_sel_hi:[1,0,0] neg_lo:[0,0,1] neg_hi:[0,0,1]
    v_pk_fma_f32 v[118:119], v[118:119], v[220:221], v[222:223] op_sel_hi:[1,0,0] neg_lo:[0,0,1] neg_hi:[0,0,1]
    v_cvt_pk_bf16_f32 v40, v112, v113
    v_cvt_pk_bf16_f32 v41, v114, v115
    v_cvt_pk_bf16_f32 v42, v116, v117
    v_cvt_pk_bf16_f32 v43, v118, v119
    ds_write_b128 v24, v[40:43] offset:8448
    v_pk_fma_f32 v[120:121], v[120:121], v[220:221], v[222:223] op_sel_hi:[1,0,0] neg_lo:[0,0,1] neg_hi:[0,0,1]
    v_pk_fma_f32 v[122:123], v[122:123], v[220:221], v[222:223] op_sel_hi:[1,0,0] neg_lo:[0,0,1] neg_hi:[0,0,1]
    v_pk_fma_f32 v[124:125], v[124:125], v[220:221], v[222:223] op_sel_hi:[1,0,0] neg_lo:[0,0,1] neg_hi:[0,0,1]
    v_pk_fma_f32 v[126:127], v[126:127], v[220:221], v[222:223] op_sel_hi:[1,0,0] neg_lo:[0,0,1] neg_hi:[0,0,1]
    v_cvt_pk_bf16_f32 v44, v120, v121
    v_cvt_pk_bf16_f32 v45, v122, v123
    v_cvt_pk_bf16_f32 v46, v124, v125
    v_cvt_pk_bf16_f32 v47, v126, v127
    ds_write_b128 v24, v[44:47] offset:12672
    v_pk_fma_f32 v[128:129], v[128:129], v[220:221], v[222:223] op_sel_hi:[1,0,0] neg_lo:[0,0,1] neg_hi:[0,0,1]
    v_pk_fma_f32 v[130:131], v[130:131], v[220:221], v[222:223] op_sel_hi:[1,0,0] neg_lo:[0,0,1] neg_hi:[0,0,1]
    v_pk_fma_f32 v[132:133], v[132:133], v[220:221], v[222:223] op_sel_hi:[1,0,0] neg_lo:[0,0,1] neg_hi:[0,0,1]
    v_pk_fma_f32 v[134:135], v[134:135], v[220:221], v[222:223] op_sel_hi:[1,0,0] neg_lo:[0,0,1] neg_hi:[0,0,1]
    v_cvt_pk_bf16_f32 v48, v128, v129
    v_cvt_pk_bf16_f32 v49, v130, v131
    v_cvt_pk_bf16_f32 v50, v132, v133
    v_cvt_pk_bf16_f32 v51, v134, v135
    ds_write_b128 v24, v[48:51] offset:16896
    v_pk_fma_f32 v[136:137], v[136:137], v[220:221], v[222:223] op_sel_hi:[1,0,0] neg_lo:[0,0,1] neg_hi:[0,0,1]
    v_pk_fma_f32 v[138:139], v[138:139], v[220:221], v[222:223] op_sel_hi:[1,0,0] neg_lo:[0,0,1] neg_hi:[0,0,1]
    v_pk_fma_f32 v[140:141], v[140:141], v[220:221], v[222:223] op_sel_hi:[1,0,0] neg_lo:[0,0,1] neg_hi:[0,0,1]
    v_pk_fma_f32 v[142:143], v[142:143], v[220:221], v[222:223] op_sel_hi:[1,0,0] neg_lo:[0,0,1] neg_hi:[0,0,1]
    v_cvt_pk_bf16_f32 v52, v136, v137
    v_cvt_pk_bf16_f32 v53, v138, v139
    v_cvt_pk_bf16_f32 v54, v140, v141
    v_cvt_pk_bf16_f32 v55, v142, v143
    ds_write_b128 v24, v[52:55] offset:21120
    v_pk_fma_f32 v[144:145], v[144:145], v[220:221], v[222:223] op_sel_hi:[1,0,0] neg_lo:[0,0,1] neg_hi:[0,0,1]
    v_pk_fma_f32 v[146:147], v[146:147], v[220:221], v[222:223] op_sel_hi:[1,0,0] neg_lo:[0,0,1] neg_hi:[0,0,1]
    v_pk_fma_f32 v[148:149], v[148:149], v[220:221], v[222:223] op_sel_hi:[1,0,0] neg_lo:[0,0,1] neg_hi:[0,0,1]
    v_pk_fma_f32 v[150:151], v[150:151], v[220:221], v[222:223] op_sel_hi:[1,0,0] neg_lo:[0,0,1] neg_hi:[0,0,1]
    v_cvt_pk_bf16_f32 v56, v144, v145
    v_cvt_pk_bf16_f32 v57, v146, v147
    v_cvt_pk_bf16_f32 v58, v148, v149
    v_cvt_pk_bf16_f32 v59, v150, v151
    ds_write_b128 v24, v[56:59] offset:25344
    v_pk_fma_f32 v[152:153], v[152:153], v[220:221], v[222:223] op_sel_hi:[1,0,0] neg_lo:[0,0,1] neg_hi:[0,0,1]
    v_pk_fma_f32 v[154:155], v[154:155], v[220:221], v[222:223] op_sel_hi:[1,0,0] neg_lo:[0,0,1] neg_hi:[0,0,1]
    v_pk_fma_f32 v[156:157], v[156:157], v[220:221], v[222:223] op_sel_hi:[1,0,0] neg_lo:[0,0,1] neg_hi:[0,0,1]
    v_pk_fma_f32 v[158:159], v[158:159], v[220:221], v[222:223] op_sel_hi:[1,0,0] neg_lo:[0,0,1] neg_hi:[0,0,1]
    v_cvt_pk_bf16_f32 v60, v152, v153
    v_cvt_pk_bf16_f32 v61, v154, v155
    v_cvt_pk_bf16_f32 v62, v156, v157
    v_cvt_pk_bf16_f32 v63, v158, v159
    ds_write_b128 v24, v[60:63] offset:29568
    v_pk_fma_f32 v[160:161], v[160:161], v[220:221], v[222:223] op_sel_hi:[1,0,0] neg_lo:[0,0,1] neg_hi:[0,0,1]
    v_pk_fma_f32 v[162:163], v[162:163], v[220:221], v[222:223] op_sel_hi:[1,0,0] neg_lo:[0,0,1] neg_hi:[0,0,1]
    v_pk_fma_f32 v[164:165], v[164:165], v[220:221], v[222:223] op_sel_hi:[1,0,0] neg_lo:[0,0,1] neg_hi:[0,0,1]
    v_pk_fma_f32 v[166:167], v[166:167], v[220:221], v[222:223] op_sel_hi:[1,0,0] neg_lo:[0,0,1] neg_hi:[0,0,1]
    v_cvt_pk_bf16_f32 v64, v160, v161
    v_cvt_pk_bf16_f32 v65, v162, v163
    v_cvt_pk_bf16_f32 v66, v164, v165
    v_cvt_pk_bf16_f32 v67, v166, v167
    ds_write_b128 v24, v[64:67] offset:33792
    v_pk_fma_f32 v[168:169], v[168:169], v[220:221], v[222:223] op_sel_hi:[1,0,0] neg_lo:[0,0,1] neg_hi:[0,0,1]
    v_pk_fma_f32 v[170:171], v[170:171], v[220:221], v[222:223] op_sel_hi:[1,0,0] neg_lo:[0,0,1] neg_hi:[0,0,1]
    v_pk_fma_f32 v[172:173], v[172:173], v[220:221], v[222:223] op_sel_hi:[1,0,0] neg_lo:[0,0,1] neg_hi:[0,0,1]
    v_pk_fma_f32 v[174:175], v[174:175], v[220:221], v[222:223] op_sel_hi:[1,0,0] neg_lo:[0,0,1] neg_hi:[0,0,1]
    v_cvt_pk_bf16_f32 v68, v168, v169
    v_cvt_pk_bf16_f32 v69, v170, v171
    v_cvt_pk_bf16_f32 v70, v172, v173
    v_cvt_pk_bf16_f32 v71, v174, v175
    ds_write_b128 v24, v[68:71] offset:38016
    v_pk_fma_f32 v[176:177], v[176:177], v[220:221], v[222:223] op_sel_hi:[1,0,0] neg_lo:[0,0,1] neg_hi:[0,0,1]
    v_pk_fma_f32 v[178:179], v[178:179], v[220:221], v[222:223] op_sel_hi:[1,0,0] neg_lo:[0,0,1] neg_hi:[0,0,1]
    v_pk_fma_f32 v[180:181], v[180:181], v[220:221], v[222:223] op_sel_hi:[1,0,0] neg_lo:[0,0,1] neg_hi:[0,0,1]
    v_pk_fma_f32 v[182:183], v[182:183], v[220:221], v[222:223] op_sel_hi:[1,0,0] neg_lo:[0,0,1] neg_hi:[0,0,1]
    v_cvt_pk_bf16_f32 v72, v176, v177
    v_cvt_pk_bf16_f32 v73, v178, v179
    v_cvt_pk_bf16_f32 v74, v180, v181
    v_cvt_pk_bf16_f32 v75, v182, v183
    ds_write_b128 v24, v[72:75] offset:42240
    v_pk_fma_f32 v[184:185], v[184:185], v[220:221], v[222:223] op_sel_hi:[1,0,0] neg_lo:[0,0,1] neg_hi:[0,0,1]
    v_pk_fma_f32 v[186:187], v[186:187], v[220:221], v[222:223] op_sel_hi:[1,0,0] neg_lo:[0,0,1] neg_hi:[0,0,1]
    v_pk_fma_f32 v[188:189], v[188:189], v[220:221], v[222:223] op_sel_hi:[1,0,0] neg_lo:[0,0,1] neg_hi:[0,0,1]
    v_pk_fma_f32 v[190:191], v[190:191], v[220:221], v[222:223] op_sel_hi:[1,0,0] neg_lo:[0,0,1] neg_hi:[0,0,1]
    v_cvt_pk_bf16_f32 v76, v184, v185
    v_cvt_pk_bf16_f32 v77, v186, v187
    v_cvt_pk_bf16_f32 v78, v188, v189
    v_cvt_pk_bf16_f32 v79, v190, v191
    ds_write_b128 v24, v[76:79] offset:46464
    v_pk_fma_f32 v[192:193], v[192:193], v[220:221], v[222:223] op_sel_hi:[1,0,0] neg_lo:[0,0,1] neg_hi:[0,0,1]
    v_pk_fma_f32 v[194:195], v[194:195], v[220:221], v[222:223] op_sel_hi:[1,0,0] neg_lo:[0,0,1] neg_hi:[0,0,1]
    v_pk_fma_f32 v[196:197], v[196:197], v[220:221], v[222:223] op_sel_hi:[1,0,0] neg_lo:[0,0,1] neg_hi:[0,0,1]
    v_pk_fma_f32 v[198:199], v[198:199], v[220:221], v[222:223] op_sel_hi:[1,0,0] neg_lo:[0,0,1] neg_hi:[0,0,1]
    v_cvt_pk_bf16_f32 v80, v192, v193
    v_cvt_pk_bf16_f32 v81, v194, v195
    v_cvt_pk_bf16_f32 v82, v196, v197
    v_cvt_pk_bf16_f32 v83, v198, v199
    ds_write_b128 v24, v[80:83] offset:50688
    v_pk_fma_f32 v[200:201], v[200:201], v[220:221], v[222:223] op_sel_hi:[1,0,0] neg_lo:[0,0,1] neg_hi:[0,0,1]
    v_pk_fma_f32 v[202:203], v[202:203], v[220:221], v[222:223] op_sel_hi:[1,0,0] neg_lo:[0,0,1] neg_hi:[0,0,1]
    v_pk_fma_f32 v[204:205], v[204:205], v[220:221], v[222:223] op_sel_hi:[1,0,0] neg_lo:[0,0,1] neg_hi:[0,0,1]
    v_pk_fma_f32 v[206:207], v[206:207], v[220:221], v[222:223] op_sel_hi:[1,0,0] neg_lo:[0,0,1] neg_hi:[0,0,1]
    v_cvt_pk_bf16_f32 v84, v200, v201
    v_cvt_pk_bf16_f32 v85, v202, v203
    v_cvt_pk_bf16_f32 v86, v204, v205
    v_cvt_pk_bf16_f32 v87, v206, v207
    ds_write_b128 v24, v[84:87] offset:54912
    s_waitcnt vmcnt(21) lgkmcnt(0)
    s_barrier
    ds_read_b128 v[96:99], v25 offset:0
    ds_read_b64_tr_b16 v[104:105], v26 offset:0
    ds_read_b64_tr_b16 v[106:107], v26 offset:512
    ds_read_b64_tr_b16 v[108:109], v26 offset:1024
    ds_read_b64_tr_b16 v[110:111], v26 offset:1536
    ds_read_b64_tr_b16 v[112:113], v26 offset:2048
    ds_read_b64_tr_b16 v[114:115], v26 offset:2560
    ds_read_b128 v[100:103], v25 offset:2112
    ds_read_b64_tr_b16 v[116:117], v26 offset:6144
    ds_read_b64_tr_b16 v[118:119], v26 offset:6656
    s_waitcnt lgkmcnt(7)
    v_mfma_f32_32x32x16_bf16 v[32:47], v[104:107], v[96:99], 0
    ds_read_b64_tr_b16 v[120:121], v26 offset:7168
    ds_read_b64_tr_b16 v[122:123], v26 offset:7680
    s_waitcnt lgkmcnt(7)
    v_mfma_f32_32x32x16_bf16 v[48:63], v[108:111], v[96:99], 0
    ds_read_b64_tr_b16 v[124:125], v26 offset:8192
    ds_read_b64_tr_b16 v[126:127], v26 offset:8704
    s_waitcnt lgkmcnt(7)
    v_mfma_f32_32x32x16_bf16 v[64:79], v[112:115], v[96:99], 0
    ds_read_b128 v[96:99], v25 offset:4224
    ds_read_b64_tr_b16 v[104:105], v26 offset:12288
    ds_read_b64_tr_b16 v[106:107], v26 offset:12800
    s_waitcnt lgkmcnt(7)
    v_mfma_f32_32x32x16_bf16 v[32:47], v[116:119], v[100:103], v[32:47]
    ds_read_b64_tr_b16 v[108:109], v26 offset:13312
    ds_read_b64_tr_b16 v[110:111], v26 offset:13824
    s_waitcnt lgkmcnt(7)
    v_mfma_f32_32x32x16_bf16 v[48:63], v[120:123], v[100:103], v[48:63]
    ds_read_b64_tr_b16 v[112:113], v26 offset:14336
    ds_read_b64_tr_b16 v[114:115], v26 offset:14848
    s_waitcnt lgkmcnt(7)
    v_mfma_f32_32x32x16_bf16 v[64:79], v[124:127], v[100:103], v[64:79]
    ds_read_b128 v[100:103], v25 offset:6336
    ds_read_b64_tr_b16 v[116:117], v26 offset:18432
    ds_read_b64_tr_b16 v[118:119], v26 offset:18944
    s_waitcnt lgkmcnt(7)
    v_mfma_f32_32x32x16_bf16 v[32:47], v[104:107], v[96:99], v[32:47]
    ds_read_b64_tr_b16 v[120:121], v26 offset:19456
    ds_read_b64_tr_b16 v[122:123], v26 offset:19968
    s_waitcnt lgkmcnt(7)
    v_mfma_f32_32x32x16_bf16 v[48:63], v[108:111], v[96:99], v[48:63]
    ds_read_b64_tr_b16 v[124:125], v26 offset:20480
    ds_read_b64_tr_b16 v[126:127], v26 offset:20992
    s_waitcnt lgkmcnt(7)
    v_mfma_f32_32x32x16_bf16 v[64:79], v[112:115], v[96:99], v[64:79]
    s_waitcnt lgkmcnt(4)
    v_mfma_f32_32x32x16_bf16 v[32:47], v[116:119], v[100:103], v[32:47]
    s_waitcnt lgkmcnt(2)
    v_mfma_f32_32x32x16_bf16 v[48:63], v[120:123], v[100:103], v[48:63]
    s_waitcnt lgkmcnt(0)
    v_mfma_f32_32x32x16_bf16 v[64:79], v[124:127], v[100:103], v[64:79]
    s_waitcnt vmcnt(15)
    s_barrier
    ds_read_b128 v[96:99], v25 offset:8448
    ds_read_b64_tr_b16 v[104:105], v26 offset:24576
    ds_read_b64_tr_b16 v[106:107], v26 offset:25088
    ds_read_b64_tr_b16 v[108:109], v26 offset:25600
    ds_read_b64_tr_b16 v[110:111], v26 offset:26112
    ds_read_b64_tr_b16 v[112:113], v26 offset:26624
    ds_read_b64_tr_b16 v[114:115], v26 offset:27136
    ds_read_b128 v[100:103], v25 offset:10560
    ds_read_b64_tr_b16 v[116:117], v26 offset:30720
    ds_read_b64_tr_b16 v[118:119], v26 offset:31232
    s_waitcnt lgkmcnt(7)
    v_mfma_f32_32x32x16_bf16 v[32:47], v[104:107], v[96:99], v[32:47]
    s_add_u32 m0, s55, 65536
    s_nop 0
    buffer_load_dwordx4 v18, s[8:11], s71 offen lds
    ds_read_b64_tr_b16 v[120:121], v26 offset:31744
    ds_read_b64_tr_b16 v[122:123], v26 offset:32256
    s_waitcnt lgkmcnt(7)
    v_mfma_f32_32x32x16_bf16 v[48:63], v[108:111], v[96:99], v[48:63]
    ds_read_b64_tr_b16 v[124:125], v26 offset:32768
    ds_read_b64_tr_b16 v[126:127], v26 offset:33280
    s_waitcnt lgkmcnt(7)
    v_mfma_f32_32x32x16_bf16 v[64:79], v[112:115], v[96:99], v[64:79]
    s_add_u32 m0, s55, 66560
    s_nop 0
    buffer_load_dwordx4 v19, s[8:11], s71 offen lds
    ds_read_b128 v[96:99], v25 offset:12672
    ds_read_b64_tr_b16 v[104:105], v26 offset:36864
    ds_read_b64_tr_b16 v[106:107], v26 offset:37376
    s_waitcnt lgkmcnt(7)
    v_mfma_f32_32x32x16_bf16 v[32:47], v[116:119], v[100:103], v[32:47]
    s_add_u32 m0, s55, 67584
    s_nop 0
    buffer_load_dwordx4 v20, s[8:11], s71 offen lds
    ds_read_b64_tr_b16 v[108:109], v26 offset:37888
    ds_read_b64_tr_b16 v[110:111], v26 offset:38400
    s_waitcnt lgkmcnt(7)
    v_mfma_f32_32x32x16_bf16 v[48:63], v[120:123], v[100:103], v[48:63]
    ds_read_b64_tr_b16 v[112:113], v26 offset:38912
    ds_read_b64_tr_b16 v[114:115], v26 offset:39424
    s_waitcnt lgkmcnt(7)
    v_mfma_f32_32x32x16_bf16 v[64:79], v[124:127], v[100:103], v[64:79]
    s_add_u32 m0, s55, 68608
    s_nop 0
    buffer_load_dwordx4 v21, s[8:11], s71 offen lds
    ds_read_b128 v[100:103], v25 offset:14784
    ds_read_b64_tr_b16 v[116:117], v26 offset:43008
    ds_read_b64_tr_b16 v[118:119], v26 offset:43520
    s_waitcnt lgkmcnt(7)
    v_mfma_f32_32x32x16_bf16 v[32:47], v[104:107], v[96:99], v[32:47]
    s_add_u32 m0, s55, 69632
    s_nop 0
    buffer_load_dwordx4 v22, s[8:11], s71 offen lds
    ds_read_b64_tr_b16 v[120:121], v26 offset:44032
    ds_read_b64_tr_b16 v[122:123], v26 offset:44544
    s_waitcnt lgkmcnt(7)
    v_mfma_f32_32x32x16_bf16 v[48:63], v[108:111], v[96:99], v[48:63]
    ds_read_b64_tr_b16 v[124:125], v26 offset:45056
    ds_read_b64_tr_b16 v[126:127], v26 offset:45568
    s_waitcnt lgkmcnt(7)
    v_mfma_f32_32x32x16_bf16 v[64:79], v[112:115], v[96:99], v[64:79]
    s_add_u32 m0, s55, 70656
    s_nop 0
    buffer_load_dwordx4 v23, s[8:11], s71 offen lds
    s_waitcnt lgkmcnt(4)
    v_mfma_f32_32x32x16_bf16 v[32:47], v[116:119], v[100:103], v[32:47]
    s_waitcnt lgkmcnt(2)
    v_mfma_f32_32x32x16_bf16 v[48:63], v[120:123], v[100:103], v[48:63]
    s_waitcnt lgkmcnt(0)
    v_mfma_f32_32x32x16_bf16 v[64:79], v[124:127], v[100:103], v[64:79]
    s_waitcnt vmcnt(15)
    s_barrier
    ds_read_b128 v[96:99], v25 offset:16896
    ds_read_b64_tr_b16 v[104:105], v27 offset:0
    ds_read_b64_tr_b16 v[106:107], v27 offset:512
    ds_read_b64_tr_b16 v[108:109], v27 offset:1024
    ds_read_b64_tr_b16 v[110:111], v27 offset:1536
    ds_read_b64_tr_b16 v[112:113], v27 offset:2048
    ds_read_b64_tr_b16 v[114:115], v27 offset:2560
    ds_read_b128 v[100:103], v25 offset:19008
    ds_read_b64_tr_b16 v[116:117], v27 offset:6144
    ds_read_b64_tr_b16 v[118:119], v27 offset:6656
    s_waitcnt lgkmcnt(7)
    v_mfma_f32_32x32x16_bf16 v[32:47], v[104:107], v[96:99], v[32:47]
    s_add_u32 m0, s55, 90112
    s_nop 0
    buffer_load_dwordx4 v18, s[8:11], s72 offen lds
    ds_read_b64_tr_b16 v[120:121], v27 offset:7168
    ds_read_b64_tr_b16 v[122:123], v27 offset:7680
    s_waitcnt lgkmcnt(7)
    v_mfma_f32_32x32x16_bf16 v[48:63], v[108:111], v[96:99], v[48:63]
    ds_read_b64_tr_b16 v[124:125], v27 offset:8192
    ds_read_b64_tr_b16 v[126:127], v27 offset:8704
    s_waitcnt lgkmcnt(7)
    v_mfma_f32_32x32x16_bf16 v[64:79], v[112:115], v[96:99], v[64:79]
    s_add_u32 m0, s55, 91136
    s_nop 0
    buffer_load_dwordx4 v19, s[8:11], s72 offen lds
    ds_read_b128 v[96:99], v25 offset:21120
    ds_read_b64_tr_b16 v[104:105], v27 offset:12288
    ds_read_b64_tr_b16 v[106:107], v27 offset:12800
    s_waitcnt lgkmcnt(7)
    v_mfma_f32_32x32x16_bf16 v[32:47], v[116:119], v[100:103], v[32:47]
    s_add_u32 m0, s55, 92160
    s_nop 0
    buffer_load_dwordx4 v20, s[8:11], s72 offen lds
    ds_read_b64_tr_b16 v[108:109], v27 offset:13312
    ds_read_b64_tr_b16 v[110:111], v27 offset:13824
    s_waitcnt lgkmcnt(7)
    v_mfma_f32_32x32x16_bf16 v[48:63], v[120:123], v[100:103], v[48:63]
    ds_read_b64_tr_b16 v[112:113], v27 offset:14336
    ds_read_b64_tr_b16 v[114:115], v27 offset:14848
    s_waitcnt lgkmcnt(7)
    v_mfma_f32_32x32x16_bf16 v[64:79], v[124:127], v[100:103], v[64:79]
    s_add_u32 m0, s55, 93184
    s_nop 0
    buffer_load_dwordx4 v21, s[8:11], s72 offen lds
    ds_read_b128 v[100:103], v25 offset:23232
    ds_read_b64_tr_b16 v[116:117], v27 offset:18432
    ds_read_b64_tr_b16 v[118:119], v27 offset:18944
    s_waitcnt lgkmcnt(7)
    v_mfma_f32_32x32x16_bf16 v[32:47], v[104:107], v[96:99], v[32:47]
    s_add_u32 m0, s55, 94208
    s_nop 0
    buffer_load_dwordx4 v22, s[8:11], s72 offen lds
    ds_read_b64_tr_b16 v[120:121], v27 offset:19456
    ds_read_b64_tr_b16 v[122:123], v27 offset:19968
    s_waitcnt lgkmcnt(7)
    v_mfma_f32_32x32x16_bf16 v[48:63], v[108:111], v[96:99], v[48:63]
    ds_read_b64_tr_b16 v[124:125], v27 offset:20480
    ds_read_b64_tr_b16 v[126:127], v27 offset:20992
    s_waitcnt lgkmcnt(7)
    v_mfma_f32_32x32x16_bf16 v[64:79], v[112:115], v[96:99], v[64:79]
    s_add_u32 m0, s55, 95232
    s_nop 0
    buffer_load_dwordx4 v23, s[8:11], s72 offen lds
    s_waitcnt lgkmcnt(4)
    v_mfma_f32_32x32x16_bf16 v[32:47], v[116:119], v[100:103], v[32:47]
    s_waitcnt lgkmcnt(2)
    v_mfma_f32_32x32x16_bf16 v[48:63], v[120:123], v[100:103], v[48:63]
    s_waitcnt lgkmcnt(0)
    v_mfma_f32_32x32x16_bf16 v[64:79], v[124:127], v[100:103], v[64:79]
    s_waitcnt vmcnt(14)
    v_mov_b32 v30, 0
    v_cmp_eq_u32 vcc, 0, v29
    s_nop 0
    s_cbranch_vccz L_ok2
    s_mov_b32 s59, 200000
L_spin1:
    buffer_load_dword v29, v30, s[40:43], 0 offen sc1
    s_waitcnt vmcnt(0)
    v_cmp_eq_u32 vcc, 0, v29
    s_nop 0
    s_cbranch_vccz L_ok2
    s_sub_u32 s59, s59, 1
    s_cbranch_scc0 L_spin1
L_ok2:
    v_readfirstlane_b32 s47, v29
    s_waitcnt vmcnt(12)
    s_barrier
    s_lshl_b32 s53, s49, 5
    s_add_u32 s53, s53, s48
    s_lshl_b32 s53, s53, 7
    s_add_u32 s53, s53, 12582912
    s_cmp_lg_u32 s44, 0
    s_cbranch_scc1 L_nopub3
    v_mov_b32 v29, 0
    v_mov_b32 v30, s47
    s_mov_b64 exec, 1
    buffer_store_dword v30, v29, s[24:27], s53 offen sc1
    s_mov_b64 exec, -1
L_nopub3:
    ds_read_b128 v[96:99], v25 offset:25344
    ds_read_b64_tr_b16 v[104:105], v27 offset:24576
    ds_read_b64_tr_b16 v[106:107], v27 offset:25088
    ds_read_b64_tr_b16 v[108:109], v27 offset:25600
    ds_read_b64_tr_b16 v[110:111], v27 offset:26112
    ds_read_b64_tr_b16 v[112:113], v27 offset:26624
    ds_read_b64_tr_b16 v[114:115], v27 offset:27136
    ds_read_b128 v[100:103], v25 offset:27456
    ds_read_b64_tr_b16 v[116:117], v27 offset:30720
    ds_read_b64_tr_b16 v[118:119], v27 offset:31232
    s_waitcnt lgkmcnt(7)
    v_mfma_f32_32x32x16_bf16 v[32:47], v[104:107], v[96:99], v[32:47]
    s_add_u32 m0, s55, 114688
    s_nop 0
    buffer_load_dwordx4 v18, s[8:11], s73 offen lds
    ds_read_b64_tr_b16 v[120:121], v27 offset:31744
    ds_read_b64_tr_b16 v[122:123], v27 offset:32256
    s_waitcnt lgkmcnt(7)
    v_mfma_f32_32x32x16_bf16 v[48:63], v[108:111], v[96:99], v[48:63]
    ds_read_b64_tr_b16 v[124:125], v27 offset:32768
    ds_read_b64_tr_b16 v[126:127], v27 offset:33280
    s_waitcnt lgkmcnt(7)
    v_mfma_f32_32x32x16_bf16 v[64:79], v[112:115], v[96:99], v[64:79]
    s_add_u32 m0, s55, 115712
    s_nop 0
    buffer_load_dwordx4 v19, s[8:11], s73 offen lds
    ds_read_b128 v[96:99], v25 offset:29568
    ds_read_b64_tr_b16 v[104:105], v27 offset:36864
    ds_read_b64_tr_b16 v[106:107], v27 offset:37376
    s_waitcnt lgkmcnt(7)
    v_mfma_f32_32x32x16_bf16 v[32:47], v[116:119], v[100:103], v[32:47]
    s_add_u32 m0, s55, 116736
    s_nop 0
    buffer_load_dwordx4 v20, s[8:11], s73 offen lds
    ds_read_b64_tr_b16 v[108:109], v27 offset:37888
    ds_read_b64_tr_b16 v[110:111], v27 offset:38400
    s_waitcnt lgkmcnt(7)
    v_mfma_f32_32x32x16_bf16 v[48:63], v[120:123], v[100:103], v[48:63]
    ds_read_b64_tr_b16 v[112:113], v27 offset:38912
    ds_read_b64_tr_b16 v[114:115], v27 offset:39424
    s_waitcnt lgkmcnt(7)
    v_mfma_f32_32x32x16_bf16 v[64:79], v[124:127], v[100:103], v[64:79]
    s_add_u32 m0, s55, 117760
    s_nop 0
    buffer_load_dwordx4 v21, s[8:11], s73 offen lds
    ds_read_b128 v[100:103], v25 offset:31680
    ds_read_b64_tr_b16 v[116:117], v27 offset:43008
    ds_read_b64_tr_b16 v[118:119], v27 offset:43520
    s_waitcnt lgkmcnt(7)
    v_mfma_f32_32x32x16_bf16 v[32:47], v[104:107], v[96:99], v[32:47]
    s_add_u32 m0, s55, 118784
    s_nop 0
    buffer_load_dwordx4 v22, s[8:11], s73 offen lds
    ds_read_b64_tr_b16 v[120:121], v27 offset:44032
    ds_read_b64_tr_b16 v[122:123], v27 offset:44544
    s_waitcnt lgkmcnt(7)
    v_mfma_f32_32x32x16_bf16 v[48:63], v[108:111], v[96:99], v[48:63]
    ds_read_b64_tr_b16 v[124:125], v27 offset:45056
    ds_read_b64_tr_b16 v[126:127], v27 offset:45568
    s_waitcnt lgkmcnt(7)
    v_mfma_f32_32x32x16_bf16 v[64:79], v[112:115], v[96:99], v[64:79]
    s_add_u32 m0, s55, 119808
    s_nop 0
    buffer_load_dwordx4 v23, s[8:11], s73 offen lds
    s_waitcnt lgkmcnt(4)
    v_mfma_f32_32x32x16_bf16 v[32:47], v[116:119], v[100:103], v[32:47]
    s_waitcnt lgkmcnt(2)
    v_mfma_f32_32x32x16_bf16 v[48:63], v[120:123], v[100:103], v[48:63]
    s_waitcnt lgkmcnt(0)
    v_mfma_f32_32x32x16_bf16 v[64:79], v[124:127], v[100:103], v[64:79]
    s_waitcnt vmcnt(12)
    s_barrier
    ds_read_b128 v[96:99], v25 offset:33792
    ds_read_b64_tr_b16 v[104:105], v26 offset:0
    ds_read_b64_tr_b16 v[106:107], v26 offset:512
    ds_read_b64_tr_b16 v[108:109], v26 offset:1024
    ds_read_b64_tr_b16 v[110:111], v26 offset:1536
    ds_read_b64_tr_b16 v[112:113], v26 offset:2048
    ds_read_b64_tr_b16 v[114:115], v26 offset:2560
    ds_read_b128 v[100:103], v25 offset:35904
    ds_read_b64_tr_b16 v[116:117], v26 offset:6144
    ds_read_b64_tr_b16 v[118:119], v26 offset:6656
    s_waitcnt lgkmcnt(7)
    v_mfma_f32_32x32x16_bf16 v[32:47], v[104:107], v[96:99], v[32:47]
    ds_read_b64_tr_b16 v[120:121], v26 offset:7168
    ds_read_b64_tr_b16 v[122:123], v26 offset:7680
    s_waitcnt lgkmcnt(7)
    v_mfma_f32_32x32x16_bf16 v[48:63], v[108:111], v[96:99], v[48:63]
    ds_read_b64_tr_b16 v[124:125], v26 offset:8192
    ds_read_b64_tr_b16 v[126:127], v26 offset:8704
    s_waitcnt lgkmcnt(7)
    v_mfma_f32_32x32x16_bf16 v[64:79], v[112:115], v[96:99], v[64:79]
    ds_read_b128 v[96:99], v25 offset:38016
    ds_read_b64_tr_b16 v[104:105], v26 offset:12288
    ds_read_b64_tr_b16 v[106:107], v26 offset:12800
    s_waitcnt lgkmcnt(7)
    v_mfma_f32_32x32x16_bf16 v[32:47], v[116:119], v[100:103], v[32:47]
    ds_read_b64_tr_b16 v[108:109], v26 offset:13312
    ds_read_b64_tr_b16 v[110:111], v26 offset:13824
    s_waitcnt lgkmcnt(7)
    v_mfma_f32_32x32x16_bf16 v[48:63], v[120:123], v[100:103], v[48:63]
    ds_read_b64_tr_b16 v[112:113], v26 offset:14336
    ds_read_b64_tr_b16 v[114:115], v26 offset:14848
    s_waitcnt lgkmcnt(7)
    v_mfma_f32_32x32x16_bf16 v[64:79], v[124:127], v[100:103], v[64:79]
    ds_read_b128 v[100:103], v25 offset:40128
    ds_read_b64_tr_b16 v[116:117], v26 offset:18432
    ds_read_b64_tr_b16 v[118:119], v26 offset:18944
    s_waitcnt lgkmcnt(7)
    v_mfma_f32_32x32x16_bf16 v[32:47], v[104:107], v[96:99], v[32:47]
    ds_read_b64_tr_b16 v[120:121], v26 offset:19456
    ds_read_b64_tr_b16 v[122:123], v26 offset:19968
    s_waitcnt lgkmcnt(7)
    v_mfma_f32_32x32x16_bf16 v[48:63], v[108:111], v[96:99], v[48:63]
    ds_read_b64_tr_b16 v[124:125], v26 offset:20480
    ds_read_b64_tr_b16 v[126:127], v26 offset:20992
    s_waitcnt lgkmcnt(7)
    v_mfma_f32_32x32x16_bf16 v[64:79], v[112:115], v[96:99], v[64:79]
    s_waitcnt lgkmcnt(4)
    v_mfma_f32_32x32x16_bf16 v[32:47], v[116:119], v[100:103], v[32:47]
    s_waitcnt lgkmcnt(2)
    v_mfma_f32_32x32x16_bf16 v[48:63], v[120:123], v[100:103], v[48:63]
    s_waitcnt lgkmcnt(0)
    v_mfma_f32_32x32x16_bf16 v[64:79], v[124:127], v[100:103], v[64:79]
    s_waitcnt vmcnt(6)
    s_barrier
    ds_read_b128 v[96:99], v25 offset:42240
    ds_read_b64_tr_b16 v[104:105], v26 offset:24576
    ds_read_b64_tr_b16 v[106:107], v26 offset:25088
    ds_read_b64_tr_b16 v[108:109], v26 offset:25600
    ds_read_b64_tr_b16 v[110:111], v26 offset:26112
    ds_read_b64_tr_b16 v[112:113], v26 offset:26624
    ds_read_b64_tr_b16 v[114:115], v26 offset:27136
    ds_read_b128 v[100:103], v25 offset:44352
    ds_read_b64_tr_b16 v[116:117], v26 offset:30720
    ds_read_b64_tr_b16 v[118:119], v26 offset:31232
    s_waitcnt lgkmcnt(7)
    v_mfma_f32_32x32x16_bf16 v[32:47], v[104:107], v[96:99], v[32:47]
    ds_read_b64_tr_b16 v[120:121], v26 offset:31744
    ds_read_b64_tr_b16 v[122:123], v26 offset:32256
    s_waitcnt lgkmcnt(7)
    v_mfma_f32_32x32x16_bf16 v[48:63], v[108:111], v[96:99], v[48:63]
    ds_read_b64_tr_b16 v[124:125], v26 offset:32768
    ds_read_b64_tr_b16 v[126:127], v26 offset:33280
    s_waitcnt lgkmcnt(7)
    v_mfma_f32_32x32x16_bf16 v[64:79], v[112:115], v[96:99], v[64:79]
    ds_read_b128 v[96:99], v25 offset:46464
    ds_read_b64_tr_b16 v[104:105], v26 offset:36864
    ds_read_b64_tr_b16 v[106:107], v26 offset:37376
    s_waitcnt lgkmcnt(7)
    v_mfma_f32_32x32x16_bf16 v[32:47], v[116:119], v[100:103], v[32:47]
    ds_read_b64_tr_b16 v[108:109], v26 offset:37888
    ds_read_b64_tr_b16 v[110:111], v26 offset:38400
    s_waitcnt lgkmcnt(7)
    v_mfma_f32_32x32x16_bf16 v[48:63], v[120:123], v[100:103], v[48:63]
    ds_read_b64_tr_b16 v[112:113], v26 offset:38912
    ds_read_b64_tr_b16 v[114:115], v26 offset:39424
    s_waitcnt lgkmcnt(7)
    v_mfma_f32_32x32x16_bf16 v[64:79], v[124:127], v[100:103], v[64:79]
    ds_read_b128 v[100:103], v25 offset:48576
    ds_read_b64_tr_b16 v[116:117], v26 offset:43008
    ds_read_b64_tr_b16 v[118:119], v26 offset:43520
    s_waitcnt lgkmcnt(7)
    v_mfma_f32_32x32x16_bf16 v[32:47], v[104:107], v[96:99], v[32:47]
    ds_read_b64_tr_b16 v[120:121], v26 offset:44032
    ds_read_b64_tr_b16 v[122:123], v26 offset:44544
    s_waitcnt lgkmcnt(7)
    v_mfma_f32_32x32x16_bf16 v[48:63], v[108:111], v[96:99], v[48:63]
    ds_read_b64_tr_b16 v[124:125], v26 offset:45056
    ds_read_b64_tr_b16 v[126:127], v26 offset:45568
    s_waitcnt lgkmcnt(7)
    v_mfma_f32_32x32x16_bf16 v[64:79], v[112:115], v[96:99], v[64:79]
    s_waitcnt lgkmcnt(4)
    v_mfma_f32_32x32x16_bf16 v[32:47], v[116:119], v[100:103], v[32:47]
    s_waitcnt lgkmcnt(2)
    v_mfma_f32_32x32x16_bf16 v[48:63], v[120:123], v[100:103], v[48:63]
    s_waitcnt lgkmcnt(0)
    v_mfma_f32_32x32x16_bf16 v[64:79], v[124:127], v[100:103], v[64:79]
    s_waitcnt vmcnt(0)
    s_barrier
    ds_read_b128 v[96:99], v25 offset:50688
    ds_read_b64_tr_b16 v[104:105], v27 offset:0
    ds_read_b64_tr_b16 v[106:107], v27 offset:512
    ds_read_b64_tr_b16 v[108:109], v27 offset:1024
    ds_read_b64_tr_b16 v[110:111], v27 offset:1536
    ds_read_b64_tr_b16 v[112:113], v27 offset:2048
    ds_read_b64_tr_b16 v[114:115], v27 offset:2560
    ds_read_b128 v[100:103], v25 offset:52800
    ds_read_b64_tr_b16 v[116:117], v27 offset:6144
    ds_read_b64_tr_b16 v[118:119], v27 offset:6656
    s_waitcnt lgkmcnt(7)
    v_mfma_f32_32x32x16_bf16 v[32:47], v[104:107], v[96:99], v[32:47]
    ds_read_b64_tr_b16 v[120:121], v27 offset:7168
    ds_read_b64_tr_b16 v[122:123], v27 offset:7680
    s_waitcnt lgkmcnt(7)
    v_mfma_f32_32x32x16_bf16 v[48:63], v[108:111], v[96:99], v[48:63]
    ds_read_b64_tr_b16 v[124:125], v27 offset:8192
    ds_read_b64_tr_b16 v[126:127], v27 offset:8704
    s_waitcnt lgkmcnt(7)
    v_mfma_f32_32x32x16_bf16 v[64:79], v[112:115], v[96:99], v[64:79]
    ds_read_b128 v[96:99], v25 offset:54912
    ds_read_b64_tr_b16 v[104:105], v27 offset:12288
    ds_read_b64_tr_b16 v[106:107], v27 offset:12800
    s_waitcnt lgkmcnt(7)
    v_mfma_f32_32x32x16_bf16 v[32:47], v[116:119], v[100:103], v[32:47]
    ds_read_b64_tr_b16 v[108:109], v27 offset:13312
    ds_read_b64_tr_b16 v[110:111], v27 offset:13824
    s_waitcnt lgkmcnt(7)
    v_mfma_f32_32x32x16_bf16 v[48:63], v[120:123], v[100:103], v[48:63]
    ds_read_b64_tr_b16 v[112:113], v27 offset:14336
    ds_read_b64_tr_b16 v[114:115], v27 offset:14848
    s_waitcnt lgkmcnt(7)
    v_mfma_f32_32x32x16_bf16 v[64:79], v[124:127], v[100:103], v[64:79]
    ds_read_b128 v[100:103], v25 offset:57024
    ds_read_b64_tr_b16 v[116:117], v27 offset:18432
    ds_read_b64_tr_b16 v[118:119], v27 offset:18944
    s_waitcnt lgkmcnt(7)
    v_mfma_f32_32x32x16_bf16 v[32:47], v[104:107], v[96:99], v[32:47]
    ds_read_b64_tr_b16 v[120:121], v27 offset:19456
    ds_read_b64_tr_b16 v[122:123], v27 offset:19968
    s_waitcnt lgkmcnt(7)
    v_mfma_f32_32x32x16_bf16 v[48:63], v[108:111], v[96:99], v[48:63]
    ds_read_b64_tr_b16 v[124:125], v27 offset:20480
    ds_read_b64_tr_b16 v[126:127], v27 offset:20992
    s_waitcnt lgkmcnt(7)
    v_mfma_f32_32x32x16_bf16 v[64:79], v[112:115], v[96:99], v[64:79]
    s_waitcnt lgkmcnt(4)
    v_mfma_f32_32x32x16_bf16 v[32:47], v[116:119], v[100:103], v[32:47]
    s_waitcnt lgkmcnt(2)
    v_mfma_f32_32x32x16_bf16 v[48:63], v[120:123], v[100:103], v[48:63]
    s_waitcnt lgkmcnt(0)
    v_mfma_f32_32x32x16_bf16 v[64:79], v[124:127], v[100:103], v[64:79]
    v_lshrrev_b32 v29, 5, v1
    v_and_b32 v30, 31, v1
    v_lshlrev_b32 v29, 15, v29
    v_lshl_add_u32 v29, v30, 4, v29
    s_mul_i32 s53, s49, 24
    s_lshr_b32 s54, s44, 1
    s_lshl_b32 s54, s54, 2
    s_add_u32 s53, s53, s54
    s_lshl_b32 s53, s53, 15
    s_lshl_b32 s54, s48, 10
    s_add_u32 s53, s53, s54
    s_and_b32 s54, s44, 1
    s_lshl_b32 s54, s54, 9
    s_add_u32 s53, s53, s54
    v_cvt_pk_bf16_f32 v128, v32, v33
    v_cvt_pk_bf16_f32 v129, v34, v35
    v_cvt_pk_bf16_f32 v130, v36, v37
    v_cvt_pk_bf16_f32 v131, v38, v39
    v_cvt_pk_bf16_f32 v132, v40, v41
    v_cvt_pk_bf16_f32 v133, v42, v43
    v_cvt_pk_bf16_f32 v134, v44, v45
    v_cvt_pk_bf16_f32 v135, v46, v47
    v_permlane32_swap_b32 v128, v130
    v_permlane32_swap_b32 v129, v131
    s_add_u32 s54, s53, 6291456
    buffer_store_dwordx4 v[128:131], v29, s[24:27], s54 offen sc1
    v_permlane32_swap_b32 v132, v134
    v_permlane32_swap_b32 v133, v135
    s_add_u32 s54, s53, 6356992
    buffer_store_dwordx4 v[132:135], v29, s[24:27], s54 offen sc1
    v_cvt_pk_bf16_f32 v136, v48, v49
    v_cvt_pk_bf16_f32 v137, v50, v51
    v_cvt_pk_bf16_f32 v138, v52, v53
    v_cvt_pk_bf16_f32 v139, v54, v55
    v_cvt_pk_bf16_f32 v140, v56, v57
    v_cvt_pk_bf16_f32 v141, v58, v59
    v_cvt_pk_bf16_f32 v142, v60, v61
    v_cvt_pk_bf16_f32 v143, v62, v63
    v_permlane32_swap_b32 v136, v138
    v_permlane32_swap_b32 v137, v139
    s_add_u32 s54, s53, 6553600
    buffer_store_dwordx4 v[136:139], v29, s[24:27], s54 offen sc1
    v_permlane32_swap_b32 v140, v142
    v_permlane32_swap_b32 v141, v143
    s_add_u32 s54, s53, 6619136
    buffer_store_dwordx4 v[140:143], v29, s[24:27], s54 offen sc1
    v_cvt_pk_bf16_f32 v144, v64, v65
    v_cvt_pk_bf16_f32 v145, v66, v67
    v_cvt_pk_bf16_f32 v146, v68, v69
    v_cvt_pk_bf16_f32 v147, v70, v71
    v_cvt_pk_bf16_f32 v148, v72, v73
    v_cvt_pk_bf16_f32 v149, v74, v75
    v_cvt_pk_bf16_f32 v150, v76, v77
    v_cvt_pk_bf16_f32 v151, v78, v79
    v_permlane32_swap_b32 v144, v146
    v_permlane32_swap_b32 v145, v147
    s_add_u32 s54, s53, 6815744
    buffer_store_dwordx4 v[144:147], v29, s[24:27], s54 offen sc1
    v_permlane32_swap_b32 v148, v150
    v_permlane32_swap_b32 v149, v151
    s_add_u32 s54, s53, 6881280
    buffer_store_dwordx4 v[148:151], v29, s[24:27], s54 offen sc1
    s_waitcnt vmcnt(0)
    s_barrier
    s_lshl_b32 s53, s48, 3
    s_add_u32 s53, s53, s49
    s_lshl_b32 s53, s53, 7
    s_add_u32 s53, s53, 12648448
    s_cmp_lg_u32 s44, 0
    s_cbranch_scc1 L_nopub4
    v_mov_b32 v29, 0
    v_mov_b32 v30, s47
    s_mov_b64 exec, 1
    buffer_store_dword v30, v29, s[24:27], s53 offen sc1
    s_mov_b64 exec, -1
L_nopub4:
    s_cmp_eq_u32 s75, 0
    s_cbranch_scc1 L_nop2
    s_lshl_b32 s53, s51, 5
    s_lshl_b32 s54, s44, 3
    s_add_u32 s53, s53, s54
    s_lshl_b32 s53, s53, 7
    s_add_u32 s53, s53, 12582912
    v_and_b32 v18, 7, v1
    v_lshlrev_b32 v18, 7, v18
    v_add_u32 v18, s53, v18
    s_lshl_b32 s53, s50, 7
    s_lshr_b32 s54, s44, 1
    s_lshl_b32 s54, s54, 6
    s_add_u32 s53, s53, s54
    v_lshrrev_b32 v19, 5, v1
    v_lshlrev_b32 v19, 3, v19
    s_lshl_b32 s58, s51, 18
    s_lshl_b32 s54, s44, 16
    s_add_u32 s58, s58, s54
    buffer_load_dword v17, v18, s[24:27], 0 offen sc1
    buffer_load_dwordx2 v[20:21], v19, s[32:35], s53 offen offset:0
    buffer_load_dwordx2 v[22:23], v19, s[32:35], s53 offen offset:16
    buffer_load_dwordx2 v[24:25], v19, s[32:35], s53 offen offset:32
    buffer_load_dwordx2 v[26:27], v19, s[32:35], s53 offen offset:48
    s_add_u32 m0, s52, 0
    s_mov_b32 s57, 0
    buffer_load_dwordx4 v8, s[16:19], s57 offen lds
    buffer_load_dwordx4 v9, s[16:19], s57 offen offset:1024 lds
    s_add_u32 m0, s52, 8192
    s_mov_b32 s57, 57344
    buffer_load_dwordx4 v8, s[16:19], s57 offen lds
    buffer_load_dwordx4 v9, s[16:19], s57 offen offset:1024 lds
    s_waitcnt vmcnt(8)
    v_cmp_ne_u32 vcc, s47, v17
    s_nop 0
    s_cbranch_vccz L_ok6
    s_mov_b32 s59, 200000
L_spin5:
    buffer_load_dword v17, v18, s[24:27], 0 offen sc1
    s_waitcnt vmcnt(0)
    v_cmp_ne_u32 vcc, s47, v17
    s_nop 0
    s_cbranch_vccz L_ok6
    s_sub_u32 s59, s59, 1
    s_cbranch_scc0 L_spin5
L_ok6:
    s_add_u32 m0, s52, 16384
    s_mov_b32 s57, 114688
    buffer_load_dwordx4 v8, s[16:19], s57 offen lds
    buffer_load_dwordx4 v9, s[16:19], s57 offen offset:1024 lds
    s_add_u32 m0, s52, 24576
    s_mov_b32 s57, 172032
    buffer_load_dwordx4 v8, s[16:19], s57 offen lds
    buffer_load_dwordx4 v9, s[16:19], s57 offen offset:1024 lds
    s_waitcnt vmcnt(8)
    v_lshlrev_b32 v32, 16, v20
    v_and_b32 v33, 0xffff0000, v20
    v_lshlrev_b32 v34, 16, v21
    v_and_b32 v35, 0xffff0000, v21
    v_lshlrev_b32 v36, 16, v22
    v_and_b32 v37, 0xffff0000, v22
    v_lshlrev_b32 v38, 16, v23
    v_and_b32 v39, 0xffff0000, v23
    v_lshlrev_b32 v40, 16, v24
    v_and_b32 v41, 0xffff0000, v24
    v_lshlrev_b32 v42, 16, v25
    v_and_b32 v43, 0xffff0000, v25
    v_lshlrev_b32 v44, 16, v26
    v_and_b32 v45, 0xffff0000, v26
    v_lshlrev_b32 v46, 16, v27
    v_and_b32 v47, 0xffff0000, v27
    buffer_load_dwordx4 v[96:99], v15, s[24:27], s58 offen offset:0 sc1
    buffer_load_dwordx4 v[100:103], v16, s[24:27], s58 offen offset:0 sc1
    s_add_u32 m0, s52, 32768
    s_mov_b32 s57, 229376
    buffer_load_dwordx4 v8, s[16:19], s57 offen lds
    buffer_load_dwordx4 v9, s[16:19], s57 offen offset:1024 lds
    buffer_load_dwordx4 v[104:107], v15, s[24:27], s58 offen offset:2048 sc1
    buffer_load_dwordx4 v[108:111], v16, s[24:27], s58 offen offset:2048 sc1
    s_add_u32 m0, s52, 40960
    s_mov_b32 s57, 286720
    buffer_load_dwordx4 v8, s[16:19], s57 offen lds
    buffer_load_dwordx4 v9, s[16:19], s57 offen offset:1024 lds
    s_add_u32 s58, s58, 4096
    buffer_load_dwordx4 v[112:115], v15, s[24:27], s58 offen offset:0 sc1
    buffer_load_dwordx4 v[116:119], v16, s[24:27], s58 offen offset:0 sc1
    s_add_u32 m0, s52, 49152
    s_mov_b32 s57, 344064
    buffer_load_dwordx4 v8, s[16:19], s57 offen lds
    buffer_load_dwordx4 v9, s[16:19], s57 offen offset:1024 lds
    buffer_load_dwordx4 v[120:123], v15, s[24:27], s58 offen offset:2048 sc1
    buffer_load_dwordx4 v[124:127], v16, s[24:27], s58 offen offset:2048 sc1
    s_add_u32 m0, s52, 57344
    s_mov_b32 s57, 401408
    buffer_load_dwordx4 v8, s[16:19], s57 offen lds
    buffer_load_dwordx4 v9, s[16:19], s57 offen offset:1024 lds
    s_add_u32 s58, s58, 4096
    buffer_load_dwordx4 v[128:131], v15, s[24:27], s58 offen offset:0 sc1
    buffer_load_dwordx4 v[132:135], v16, s[24:27], s58 offen offset:0 sc1
    s_waitcnt vmcnt(24)
    ds_read_b64_tr_b16 a[0:1], v2 offset:0
    ds_read_b64_tr_b16 a[2:3], v2 offset:512
    ds_read_b64_tr_b16 a[4:5], v2 offset:256
    ds_read_b64_tr_b16 a[6:7], v2 offset:768
    s_add_u32 m0, s52, 65536
    s_mov_b32 s57, 458752
    buffer_load_dwordx4 v8, s[16:19], s57 offen lds
    buffer_load_dwordx4 v9, s[16:19], s57 offen offset:1024 lds
    s_waitcnt vmcnt(24)
    ds_read_b64_tr_b16 a[8:9], v2 offset:8192
    ds_read_b64_tr_b16 a[10:11], v2 offset:8704
    ds_read_b64_tr_b16 a[12:13], v2 offset:8448
    ds_read_b64_tr_b16 a[14:15], v2 offset:8960
    buffer_load_dwordx4 v[136:139], v15, s[24:27], s58 offen offset:2048 sc1
    buffer_load_dwordx4 v[140:143], v16, s[24:27], s58 offen offset:2048 sc1
    s_waitcnt vmcnt(24)
    ds_read_b64_tr_b16 a[16:17], v2 offset:16384
    ds_read_b64_tr_b16 a[18:19], v2 offset:16896
    ds_read_b64_tr_b16 a[20:21], v2 offset:16640
    ds_read_b64_tr_b16 a[22:23], v2 offset:17152
    s_add_u32 m0, s52, 73728
    s_mov_b32 s57, 516096
    buffer_load_dwordx4 v8, s[16:19], s57 offen lds
    buffer_load_dwordx4 v9, s[16:19], s57 offen offset:1024 lds
    s_waitcnt vmcnt(24)
    ds_read_b64_tr_b16 a[24:25], v2 offset:24576
    ds_read_b64_tr_b16 a[26:27], v2 offset:25088
    ds_read_b64_tr_b16 a[28:29], v2 offset:24832
    ds_read_b64_tr_b16 a[30:31], v2 offset:25344
    s_add_u32 s58, s58, 4096
    buffer_load_dwordx4 v[144:147], v15, s[24:27], s58 offen offset:0 sc1
    s_waitcnt vmcnt(24)
    s_waitcnt lgkmcnt(12)
    v_mfma_f32_32x32x16_bf16 v[32:47], a[0:3], v[96:99], v[32:47]
    buffer_load_dwordx4 v[148:151], v16, s[24:27], s58 offen offset:0 sc1
    v_mfma_f32_32x32x16_bf16 v[64:79], a[4:7], v[96:99], 0
    s_add_u32 m0, s52, 81920
    s_mov_b32 s57, 573440
    buffer_load_dwordx4 v8, s[16:19], s57 offen lds
    s_waitcnt vmcnt(25)
    v_mfma_f32_32x32x16_bf16 v[48:63], a[0:3], v[100:103], 0
    buffer_load_dwordx4 v9, s[16:19], s57 offen offset:1024 lds
    v_mfma_f32_32x32x16_bf16 v[80:95], a[4:7], v[100:103], 0
    s_waitcnt vmcnt(24)
    ds_read_b64_tr_b16 a[32:33], v2 offset:32768
    ds_read_b64_tr_b16 a[34:35], v2 offset:33280
    ds_read_b64_tr_b16 a[36:37], v2 offset:33024
    ds_read_b64_tr_b16 a[38:39], v2 offset:33536
    buffer_load_dwordx4 v[152:155], v15, s[24:27], s58 offen offset:2048 sc1
    s_waitcnt vmcnt(24)
    s_waitcnt lgkmcnt(12)
    v_mfma_f32_32x32x16_bf16 v[32:47], a[8:11], v[104:107], v[32:47]
    buffer_load_dwordx4 v[156:159], v16, s[24:27], s58 offen offset:2048 sc1
    v_mfma_f32_32x32x16_bf16 v[64:79], a[12:15], v[104:107], v[64:79]
    s_add_u32 m0, s52, 90112
    s_mov_b32 s57, 630784
    buffer_load_dwordx4 v8, s[16:19], s57 offen lds
    s_waitcnt vmcnt(25)
    v_mfma_f32_32x32x16_bf16 v[48:63], a[8:11], v[108:111], v[48:63]
    buffer_load_dwordx4 v9, s[16:19], s57 offen offset:1024 lds
    v_mfma_f32_32x32x16_bf16 v[80:95], a[12:15], v[108:111], v[80:95]
    s_waitcnt vmcnt(24)
    ds_read_b64_tr_b16 a[40:41], v2 offset:40960
    ds_read_b64_tr_b16 a[42:43], v2 offset:41472
    ds_read_b64_tr_b16 a[44:45], v2 offset:41216
    ds_read_b64_tr_b16 a[46:47], v2 offset:41728
    s_add_u32 s58, s58, 4096
    buffer_load_dwordx4 v[160:163], v15, s[24:27], s58 offen offset:0 sc1
    s_waitcnt vmcnt(24)
    s_waitcnt lgkmcnt(12)
    v_mfma_f32_32x32x16_bf16 v[32:47], a[16:19], v[112:115], v[32:47]
    buffer_load_dwordx4 v[164:167], v16, s[24:27], s58 offen offset:0 sc1
    v_mfma_f32_32x32x16_bf16 v[64:79], a[20:23], v[112:115], v[64:79]
    s_add_u32 m0, s52, 98304
    s_mov_b32 s57, 688128
    buffer_load_dwordx4 v8, s[16:19], s57 offen lds
    s_waitcnt vmcnt(25)
    v_mfma_f32_32x32x16_bf16 v[48:63], a[16:19], v[116:119], v[48:63]
    buffer_load_dwordx4 v9, s[16:19], s57 offen offset:1024 lds
    v_mfma_f32_32x32x16_bf16 v[80:95], a[20:23], v[116:119], v[80:95]
    s_waitcnt vmcnt(24)
    ds_read_b64_tr_b16 a[48:49], v2 offset:49152
    ds_read_b64_tr_b16 a[50:51], v2 offset:49664
    ds_read_b64_tr_b16 a[52:53], v2 offset:49408
    ds_read_b64_tr_b16 a[54:55], v2 offset:49920
    buffer_load_dwordx4 v[168:171], v15, s[24:27], s58 offen offset:2048 sc1
    s_waitcnt vmcnt(24)
    s_waitcnt lgkmcnt(12)
    v_mfma_f32_32x32x16_bf16 v[32:47], a[24:27], v[120:123], v[32:47]
    buffer_load_dwordx4 v[172:175], v16, s[24:27], s58 offen offset:2048 sc1
    v_mfma_f32_32x32x16_bf16 v[64:79], a[28:31], v[120:123], v[64:79]
    s_add_u32 m0, s52, 106496
    s_mov_b32 s57, 745472
    buffer_load_dwordx4 v8, s[16:19], s57 offen lds
    s_waitcnt vmcnt(25)
    v_mfma_f32_32x32x16_bf16 v[48:63], a[24:27], v[124:127], v[48:63]
    buffer_load_dwordx4 v9, s[16:19], s57 offen offset:1024 lds
    v_mfma_f32_32x32x16_bf16 v[80:95], a[28:31], v[124:127], v[80:95]
    s_waitcnt vmcnt(24)
    ds_read_b64_tr_b16 a[56:57], v2 offset:57344
    ds_read_b64_tr_b16 a[58:59], v2 offset:57856
    ds_read_b64_tr_b16 a[60:61], v2 offset:57600
    ds_read_b64_tr_b16 a[62:63], v2 offset:58112
    s_add_u32 s58, s58, 4096
    buffer_load_dwordx4 v[176:179], v15, s[24:27], s58 offen offset:0 sc1
    s_waitcnt vmcnt(24)
    s_waitcnt lgkmcnt(12)
    v_mfma_f32_32x32x16_bf16 v[32:47], a[32:35], v[128:131], v[32:47]
    buffer_load_dwordx4 v[180:183], v16, s[24:27], s58 offen offset:0 sc1
    v_mfma_f32_32x32x16_bf16 v[64:79], a[36:39], v[128:131], v[64:79]
    s_add_u32 m0, s52, 114688
    s_mov_b32 s57, 802816
    buffer_load_dwordx4 v8, s[16:19], s57 offen lds
    s_waitcnt vmcnt(25)
    v_mfma_f32_32x32x16_bf16 v[48:63], a[32:35], v[132:135], v[48:63]
    buffer_load_dwordx4 v9, s[16:19], s57 offen offset:1024 lds
    v_mfma_f32_32x32x16_bf16 v[80:95], a[36:39], v[132:135], v[80:95]
    s_waitcnt vmcnt(24)
    ds_read_b64_tr_b16 a[64:65], v3 offset:0
    ds_read_b64_tr_b16 a[66:67], v3 offset:512
    ds_read_b64_tr_b16 a[68:69], v3 offset:256
    ds_read_b64_tr_b16 a[70:71], v3 offset:768
    buffer_load_dwordx4 v[184:187], v15, s[24:27], s58 offen offset:2048 sc1
    s_waitcnt vmcnt(24)
    s_waitcnt lgkmcnt(12)
    v_mfma_f32_32x32x16_bf16 v[32:47], a[40:43], v[136:139], v[32:47]
    buffer_load_dwordx4 v[188:191], v16, s[24:27], s58 offen offset:2048 sc1
    v_mfma_f32_32x32x16_bf16 v[64:79], a[44:47], v[136:139], v[64:79]
    s_add_u32 m0, s52, 122880
    s_mov_b32 s57, 860160
    buffer_load_dwordx4 v8, s[16:19], s57 offen lds
    s_waitcnt vmcnt(25)
    v_mfma_f32_32x32x16_bf16 v[48:63], a[40:43], v[140:143], v[48:63]
    buffer_load_dwordx4 v9, s[16:19], s57 offen offset:1024 lds
    v_mfma_f32_32x32x16_bf16 v[80:95], a[44:47], v[140:143], v[80:95]
    s_waitcnt vmcnt(24)
    ds_read_b64_tr_b16 a[72:73], v3 offset:8192
    ds_read_b64_tr_b16 a[74:75], v3 offset:8704
    ds_read_b64_tr_b16 a[76:77], v3 offset:8448
    ds_read_b64_tr_b16 a[78:79], v3 offset:8960
    s_add_u32 s58, s58, 4096
    buffer_load_dwordx4 v[192:195], v15, s[24:27], s58 offen offset:0 sc1
    s_waitcnt vmcnt(24)
    s_waitcnt lgkmcnt(12)
    v_mfma_f32_32x32x16_bf16 v[32:47], a[48:51], v[144:147], v[32:47]
    buffer_load_dwordx4 v[196:199], v16, s[24:27], s58 offen offset:0 sc1
    v_mfma_f32_32x32x16_bf16 v[64:79], a[52:55], v[144:147], v[64:79]
    s_add_u32 m0, s52, 131072
    s_mov_b32 s57, 917504
    buffer_load_dwordx4 v8, s[16:19], s57 offen lds
    s_waitcnt vmcnt(25)
    v_mfma_f32_32x32x16_bf16 v[48:63], a[48:51], v[148:151], v[48:63]
    buffer_load_dwordx4 v9, s[16:19], s57 offen offset:1024 lds
    v_mfma_f32_32x32x16_bf16 v[80:95], a[52:55], v[148:151], v[80:95]
    s_waitcnt vmcnt(24)
    ds_read_b64_tr_b16 a[80:81], v3 offset:16384
    ds_read_b64_tr_b16 a[82:83], v3 offset:16896
    ds_read_b64_tr_b16 a[84:85], v3 offset:16640
    ds_read_b64_tr_b16 a[86:87], v3 offset:17152
    buffer_load_dwordx4 v[200:203], v15, s[24:27], s58 offen offset:2048 sc1
    s_waitcnt vmcnt(24)
    s_waitcnt lgkmcnt(12)
    v_mfma_f32_32x32x16_bf16 v[32:47], a[56:59], v[152:155], v[32:47]
    buffer_load_dwordx4 v[204:207], v16, s[24:27], s58 offen offset:2048 sc1
    v_mfma_f32_32x32x16_bf16 v[64:79], a[60:63], v[152:155], v[64:79]
    s_add_u32 m0, s52, 139264
    s_mov_b32 s57, 974848
    buffer_load_dwordx4 v8, s[16:19], s57 offen lds
    s_waitcnt vmcnt(25)
    v_mfma_f32_32x32x16_bf16 v[48:63], a[56:59], v[156:159], v[48:63]
    buffer_load_dwordx4 v9, s[16:19], s57 offen offset:1024 lds
    v_mfma_f32_32x32x16_bf16 v[80:95], a[60:63], v[156:159], v[80:95]
    s_waitcnt vmcnt(24)
    ds_read_b64_tr_b16 a[88:89], v3 offset:24576
    ds_read_b64_tr_b16 a[90:91], v3 offset:25088
    ds_read_b64_tr_b16 a[92:93], v3 offset:24832
    ds_read_b64_tr_b16 a[94:95], v3 offset:25344
    s_add_u32 s58, s58, 4096
    buffer_load_dwordx4 v[208:211], v15, s[24:27], s58 offen offset:0 sc1
    s_waitcnt vmcnt(24)
    s_waitcnt lgkmcnt(12)
    v_mfma_f32_32x32x16_bf16 v[32:47], a[64:67], v[160:163], v[32:47]
    buffer_load_dwordx4 v[212:215], v16, s[24:27], s58 offen offset:0 sc1
    v_mfma_f32_32x32x16_bf16 v[64:79], a[68:71], v[160:163], v[64:79]
    s_add_u32 m0, s52, 147456
    s_mov_b32 s57, 1032192
    buffer_load_dwordx4 v8, s[16:19], s57 offen lds
    s_waitcnt vmcnt(25)
    v_mfma_f32_32x32x16_bf16 v[48:63], a[64:67], v[164:167], v[48:63]
    buffer_load_dwordx4 v9, s[16:19], s57 offen offset:1024 lds
    v_mfma_f32_32x32x16_bf16 v[80:95], a[68:71], v[164:167], v[80:95]
    s_waitcnt vmcnt(24)
    ds_read_b64_tr_b16 a[96:97], v3 offset:32768
    ds_read_b64_tr_b16 a[98:99], v3 offset:33280
    ds_read_b64_tr_b16 a[100:101], v3 offset:33024
    ds_read_b64_tr_b16 a[102:103], v3 offset:33536
    buffer_load_dwordx4 v[216:219], v15, s[24:27], s58 offen offset:2048 sc1
    s_waitcnt vmcnt(24)
    s_waitcnt lgkmcnt(12)
    v_mfma_f32_32x32x16_bf16 v[32:47], a[72:75], v[168:171], v[32:47]
    buffer_load_dwordx4 v[220:223], v16, s[24:27], s58 offen offset:2048 sc1
    v_mfma_f32_32x32x16_bf16 v[64:79], a[76:79], v[168:171], v[64:79]
    s_add_u32 m0, s52, 155648
    s_mov_b32 s57, 1089536
    buffer_load_dwordx4 v8, s[16:19], s57 offen lds
    s_waitcnt vmcnt(25)
    v_mfma_f32_32x32x16_bf16 v[48:63], a[72:75], v[172:175], v[48:63]
    buffer_load_dwordx4 v9, s[16:19], s57 offen offset:1024 lds
    v_mfma_f32_32x32x16_bf16 v[80:95], a[76:79], v[172:175], v[80:95]
    s_waitcnt vmcnt(24)
    ds_read_b64_tr_b16 a[104:105], v3 offset:40960
    ds_read_b64_tr_b16 a[106:107], v3 offset:41472
    ds_read_b64_tr_b16 a[108:109], v3 offset:41216
    ds_read_b64_tr_b16 a[110:111], v3 offset:41728
    s_add_u32 s58, s58, 4096
    buffer_load_dwordx4 v[224:227], v15, s[24:27], s58 offen offset:0 sc1
    s_waitcnt vmcnt(24)
    s_waitcnt lgkmcnt(12)
    v_mfma_f32_32x32x16_bf16 v[32:47], a[80:83], v[176:179], v[32:47]
    buffer_load_dwordx4 v[228:231], v16, s[24:27], s58 offen offset:0 sc1
    v_mfma_f32_32x32x16_bf16 v[64:79], a[84:87], v[176:179], v[64:79]
    s_add_u32 m0, s52, 0
    s_mov_b32 s57, 1146880
    buffer_load_dwordx4 v8, s[16:19], s57 offen lds
    s_waitcnt vmcnt(25)
    v_mfma_f32_32x32x16_bf16 v[48:63], a[80:83], v[180:183], v[48:63]
    buffer_load_dwordx4 v9, s[16:19], s57 offen offset:1024 lds
    v_mfma_f32_32x32x16_bf16 v[80:95], a[84:87], v[180:183], v[80:95]
    s_waitcnt vmcnt(24)
    ds_read_b64_tr_b16 a[112:113], v3 offset:49152
    ds_read_b64_tr_b16 a[114:115], v3 offset:49664
    ds_read_b64_tr_b16 a[116:117], v3 offset:49408
    ds_read_b64_tr_b16 a[118:119], v3 offset:49920
    buffer_load_dwordx4 v[232:235], v15, s[24:27], s58 offen offset:2048 sc1
    s_waitcnt vmcnt(24)
    s_waitcnt lgkmcnt(12)
    v_mfma_f32_32x32x16_bf16 v[32:47], a[88:91], v[184:187], v[32:47]
    buffer_load_dwordx4 v[236:239], v16, s[24:27], s58 offen offset:2048 sc1
    v_mfma_f32_32x32x16_bf16 v[64:79], a[92:95], v[184:187], v[64:79]
    s_add_u32 m0, s52, 8192
    s_mov_b32 s57, 1204224
    buffer_load_dwordx4 v8, s[16:19], s57 offen lds
    s_waitcnt vmcnt(25)
    v_mfma_f32_32x32x16_bf16 v[48:63], a[88:91], v[188:191], v[48:63]
    buffer_load_dwordx4 v9, s[16:19], s57 offen offset:1024 lds
    v_mfma_f32_32x32x16_bf16 v[80:95], a[92:95], v[188:191], v[80:95]
    s_waitcnt vmcnt(24)
    ds_read_b64_tr_b16 a[120:121], v3 offset:57344
    ds_read_b64_tr_b16 a[122:123], v3 offset:57856
    ds_read_b64_tr_b16 a[124:125], v3 offset:57600
    ds_read_b64_tr_b16 a[126:127], v3 offset:58112
    s_add_u32 s58, s58, 4096
    buffer_load_dwordx4 v[240:243], v15, s[24:27], s58 offen offset:0 sc1
    s_waitcnt vmcnt(24)
    s_waitcnt lgkmcnt(12)
    v_mfma_f32_32x32x16_bf16 v[32:47], a[96:99], v[192:195], v[32:47]
    buffer_load_dwordx4 v[244:247], v16, s[24:27], s58 offen offset:0 sc1
    v_mfma_f32_32x32x16_bf16 v[64:79], a[100:103], v[192:195], v[64:79]
    s_add_u32 m0, s52, 16384
    s_mov_b32 s57, 1261568
    buffer_load_dwordx4 v8, s[16:19], s57 offen lds
    s_waitcnt vmcnt(25)
    v_mfma_f32_32x32x16_bf16 v[48:63], a[96:99], v[196:199], v[48:63]
    buffer_load_dwordx4 v9, s[16:19], s57 offen offset:1024 lds
    v_mfma_f32_32x32x16_bf16 v[80:95], a[100:103], v[196:199], v[80:95]
    s_waitcnt vmcnt(24)
    ds_read_b64_tr_b16 a[128:129], v4 offset:0
    ds_read_b64_tr_b16 a[130:131], v4 offset:512
    ds_read_b64_tr_b16 a[132:133], v4 offset:256
    ds_read_b64_tr_b16 a[134:135], v4 offset:768
    buffer_load_dwordx4 v[248:251], v15, s[24:27], s58 offen offset:2048 sc1
    s_waitcnt vmcnt(24)
    s_waitcnt lgkmcnt(12)
    v_mfma_f32_32x32x16_bf16 v[32:47], a[104:107], v[200:203], v[32:47]
    buffer_load_dwordx4 v[252:255], v16, s[24:27], s58 offen offset:2048 sc1
    v_mfma_f32_32x32x16_bf16 v[64:79], a[108:111], v[200:203], v[64:79]
    s_add_u32 m0, s52, 24576
    s_mov_b32 s57, 1318912
    buffer_load_dwordx4 v8, s[16:19], s57 offen lds
    s_waitcnt vmcnt(25)
    v_mfma_f32_32x32x16_bf16 v[48:63], a[104:107], v[204:207], v[48:63]
    buffer_load_dwordx4 v9, s[16:19], s57 offen offset:1024 lds
    v_mfma_f32_32x32x16_bf16 v[80:95], a[108:111], v[204:207], v[80:95]
    s_waitcnt vmcnt(24)
    ds_read_b64_tr_b16 a[136:137], v4 offset:8192
    ds_read_b64_tr_b16 a[138:139], v4 offset:8704
    ds_read_b64_tr_b16 a[140:141], v4 offset:8448
    ds_read_b64_tr_b16 a[142:143], v4 offset:8960
    s_add_u32 s58, s58, 4096
    buffer_load_dwordx4 v[96:99], v15, s[24:27], s58 offen offset:0 sc1
    s_waitcnt vmcnt(24)
    s_waitcnt lgkmcnt(12)
    v_mfma_f32_32x32x16_bf16 v[32:47], a[112:115], v[208:211], v[32:47]
    buffer_load_dwordx4 v[100:103], v16, s[24:27], s58 offen offset:0 sc1
    v_mfma_f32_32x32x16_bf16 v[64:79], a[116:119], v[208:211], v[64:79]
    s_add_u32 m0, s52, 32768
    s_mov_b32 s57, 1376256
    buffer_load_dwordx4 v8, s[16:19], s57 offen lds
    s_waitcnt vmcnt(25)
    v_mfma_f32_32x32x16_bf16 v[48:63], a[112:115], v[212:215], v[48:63]
    buffer_load_dwordx4 v9, s[16:19], s57 offen offset:1024 lds
    v_mfma_f32_32x32x16_bf16 v[80:95], a[116:119], v[212:215], v[80:95]
    s_waitcnt vmcnt(24)
    ds_read_b64_tr_b16 a[144:145], v4 offset:16384
    ds_read_b64_tr_b16 a[146:147], v4 offset:16896
    ds_read_b64_tr_b16 a[148:149], v4 offset:16640
    ds_read_b64_tr_b16 a[150:151], v4 offset:17152
    buffer_load_dwordx4 v[104:107], v15, s[24:27], s58 offen offset:2048 sc1
    s_waitcnt vmcnt(24)
    s_waitcnt lgkmcnt(12)
    v_mfma_f32_32x32x16_bf16 v[32:47], a[120:123], v[216:219], v[32:47]
    buffer_load_dwordx4 v[108:111], v16, s[24:27], s58 offen offset:2048 sc1
    v_mfma_f32_32x32x16_bf16 v[64:79], a[124:127], v[216:219], v[64:79]
    s_add_u32 m0, s52, 40960
    s_mov_b32 s57, 1433600
    buffer_load_dwordx4 v8, s[16:19], s57 offen lds
    s_waitcnt vmcnt(25)
    v_mfma_f32_32x32x16_bf16 v[48:63], a[120:123], v[220:223], v[48:63]
    buffer_load_dwordx4 v9, s[16:19], s57 offen offset:1024 lds
    v_mfma_f32_32x32x16_bf16 v[80:95], a[124:127], v[220:223], v[80:95]
    s_waitcnt vmcnt(24)
    ds_read_b64_tr_b16 a[152:153], v4 offset:24576
    ds_read_b64_tr_b16 a[154:155], v4 offset:25088
    ds_read_b64_tr_b16 a[156:157], v4 offset:24832
    ds_read_b64_tr_b16 a[158:159], v4 offset:25344
    s_add_u32 s58, s58, 4096
    buffer_load_dwordx4 v[112:115], v15, s[24:27], s58 offen offset:0 sc1
    s_waitcnt vmcnt(24)
    s_waitcnt lgkmcnt(12)
    v_mfma_f32_32x32x16_bf16 v[32:47], a[128:131], v[224:227], v[32:47]
    buffer_load_dwordx4 v[116:119], v16, s[24:27], s58 offen offset:0 sc1
    v_mfma_f32_32x32x16_bf16 v[64:79], a[132:135], v[224:227], v[64:79]
    s_add_u32 m0, s52, 49152
    s_mov_b32 s57, 1490944
    buffer_load_dwordx4 v8, s[16:19], s57 offen lds
    s_waitcnt vmcnt(25)
    v_mfma_f32_32x32x16_bf16 v[48:63], a[128:131], v[228:231], v[48:63]
    buffer_load_dwordx4 v9, s[16:19], s57 offen offset:1024 lds
    v_mfma_f32_32x32x16_bf16 v[80:95], a[132:135], v[228:231], v[80:95]
    s_waitcnt vmcnt(24)
    ds_read_b64_tr_b16 a[160:161], v2 offset:0
    ds_read_b64_tr_b16 a[162:163], v2 offset:512
    ds_read_b64_tr_b16 a[164:165], v2 offset:256
    ds_read_b64_tr_b16 a[166:167], v2 offset:768
    buffer_load_dwordx4 v[120:123], v15, s[24:27], s58 offen offset:2048 sc1
    s_waitcnt vmcnt(24)
    s_waitcnt lgkmcnt(12)
    v_mfma_f32_32x32x16_bf16 v[32:47], a[136:139], v[232:235], v[32:47]
    buffer_load_dwordx4 v[124:127], v16, s[24:27], s58 offen offset:2048 sc1
    v_mfma_f32_32x32x16_bf16 v[64:79], a[140:143], v[232:235], v[64:79]
    s_add_u32 m0, s52, 57344
    s_mov_b32 s57, 1548288
    buffer_load_dwordx4 v8, s[16:19], s57 offen lds
    s_waitcnt vmcnt(25)
    v_mfma_f32_32x32x16_bf16 v[48:63], a[136:139], v[236:239], v[48:63]
    buffer_load_dwordx4 v9, s[16:19], s57 offen offset:1024 lds
    v_mfma_f32_32x32x16_bf16 v[80:95], a[140:143], v[236:239], v[80:95]
    s_waitcnt vmcnt(24)
    ds_read_b64_tr_b16 a[168:169], v2 offset:8192
    ds_read_b64_tr_b16 a[170:171], v2 offset:8704
    ds_read_b64_tr_b16 a[172:173], v2 offset:8448
    ds_read_b64_tr_b16 a[174:175], v2 offset:8960
    s_add_u32 s58, s58, 4096
    buffer_load_dwordx4 v[128:131], v15, s[24:27], s58 offen offset:0 sc1
    s_waitcnt vmcnt(24)
    s_waitcnt lgkmcnt(12)
    v_mfma_f32_32x32x16_bf16 v[32:47], a[144:147], v[240:243], v[32:47]
    buffer_load_dwordx4 v[132:135], v16, s[24:27], s58 offen offset:0 sc1
    v_mfma_f32_32x32x16_bf16 v[64:79], a[148:151], v[240:243], v[64:79]
    s_add_u32 m0, s52, 65536
    s_mov_b32 s57, 1605632
    buffer_load_dwordx4 v8, s[16:19], s57 offen lds
    s_waitcnt vmcnt(25)
    v_mfma_f32_32x32x16_bf16 v[48:63], a[144:147], v[244:247], v[48:63]
    buffer_load_dwordx4 v9, s[16:19], s57 offen offset:1024 lds
    v_mfma_f32_32x32x16_bf16 v[80:95], a[148:151], v[244:247], v[80:95]
    s_waitcnt vmcnt(24)
    ds_read_b64_tr_b16 a[176:177], v2 offset:16384
    ds_read_b64_tr_b16 a[178:179], v2 offset:16896
    ds_read_b64_tr_b16 a[180:181], v2 offset:16640
    ds_read_b64_tr_b16 a[182:183], v2 offset:17152
    buffer_load_dwordx4 v[136:139], v15, s[24:27], s58 offen offset:2048 sc1
    s_waitcnt vmcnt(24)
    s_waitcnt lgkmcnt(12)
    v_mfma_f32_32x32x16_bf16 v[32:47], a[152:155], v[248:251], v[32:47]
    buffer_load_dwordx4 v[140:143], v16, s[24:27], s58 offen offset:2048 sc1
    v_mfma_f32_32x32x16_bf16 v[64:79], a[156:159], v[248:251], v[64:79]
    s_add_u32 m0, s52, 73728
    s_mov_b32 s57, 1662976
    buffer_load_dwordx4 v8, s[16:19], s57 offen lds
    s_waitcnt vmcnt(25)
    v_mfma_f32_32x32x16_bf16 v[48:63], a[152:155], v[252:255], v[48:63]
    buffer_load_dwordx4 v9, s[16:19], s57 offen offset:1024 lds
    v_mfma_f32_32x32x16_bf16 v[80:95], a[156:159], v[252:255], v[80:95]
    s_waitcnt vmcnt(24)
    ds_read_b64_tr_b16 a[184:185], v2 offset:24576
    ds_read_b64_tr_b16 a[186:187], v2 offset:25088
    ds_read_b64_tr_b16 a[188:189], v2 offset:24832
    ds_read_b64_tr_b16 a[190:191], v2 offset:25344
    s_add_u32 s58, s58, 4096
    buffer_load_dwordx4 v[144:147], v15, s[24:27], s58 offen offset:0 sc1
    s_waitcnt vmcnt(24)
    s_waitcnt lgkmcnt(12)
    v_mfma_f32_32x32x16_bf16 v[32:47], a[160:163], v[96:99], v[32:47]
    buffer_load_dwordx4 v[148:151], v16, s[24:27], s58 offen offset:0 sc1
    v_mfma_f32_32x32x16_bf16 v[64:79], a[164:167], v[96:99], v[64:79]
    s_add_u32 m0, s52, 81920
    s_mov_b32 s57, 1720320
    buffer_load_dwordx4 v8, s[16:19], s57 offen lds
    s_waitcnt vmcnt(25)
    v_mfma_f32_32x32x16_bf16 v[48:63], a[160:163], v[100:103], v[48:63]
    buffer_load_dwordx4 v9, s[16:19], s57 offen offset:1024 lds
    v_mfma_f32_32x32x16_bf16 v[80:95], a[164:167], v[100:103], v[80:95]
    s_waitcnt vmcnt(24)
    ds_read_b64_tr_b16 a[192:193], v2 offset:32768
    ds_read_b64_tr_b16 a[194:195], v2 offset:33280
    ds_read_b64_tr_b16 a[196:197], v2 offset:33024
    ds_read_b64_tr_b16 a[198:199], v2 offset:33536
    buffer_load_dwordx4 v[152:155], v15, s[24:27], s58 offen offset:2048 sc1
    s_waitcnt vmcnt(24)
    s_waitcnt lgkmcnt(12)
    v_mfma_f32_32x32x16_bf16 v[32:47], a[168:171], v[104:107], v[32:47]
    buffer_load_dwordx4 v[156:159], v16, s[24:27], s58 offen offset:2048 sc1
    v_mfma_f32_32x32x16_bf16 v[64:79], a[172:175], v[104:107], v[64:79]
    s_add_u32 m0, s52, 90112
    s_mov_b32 s57, 1777664
    buffer_load_dwordx4 v8, s[16:19], s57 offen lds
    s_waitcnt vmcnt(25)
    v_mfma_f32_32x32x16_bf16 v[48:63], a[168:171], v[108:111], v[48:63]
    buffer_load_dwordx4 v9, s[16:19], s57 offen offset:1024 lds
    v_mfma_f32_32x32x16_bf16 v[80:95], a[172:175], v[108:111], v[80:95]
    s_waitcnt vmcnt(24)
    ds_read_b64_tr_b16 a[200:201], v2 offset:40960
    ds_read_b64_tr_b16 a[202:203], v2 offset:41472
    ds_read_b64_tr_b16 a[204:205], v2 offset:41216
    ds_read_b64_tr_b16 a[206:207], v2 offset:41728
    s_add_u32 s58, s58, 4096
    buffer_load_dwordx4 v[160:163], v15, s[24:27], s58 offen offset:0 sc1
    s_waitcnt vmcnt(24)
    s_waitcnt lgkmcnt(12)
    v_mfma_f32_32x32x16_bf16 v[32:47], a[176:179], v[112:115], v[32:47]
    buffer_load_dwordx4 v[164:167], v16, s[24:27], s58 offen offset:0 sc1
    v_mfma_f32_32x32x16_bf16 v[64:79], a[180:183], v[112:115], v[64:79]
    buffer_load_dwordx4 v[168:171], v15, s[24:27], s58 offen offset:2048 sc1
    s_waitcnt vmcnt(25)
    v_mfma_f32_32x32x16_bf16 v[48:63], a[176:179], v[116:119], v[48:63]
    buffer_load_dwordx4 v[172:175], v16, s[24:27], s58 offen offset:2048 sc1
    v_mfma_f32_32x32x16_bf16 v[80:95], a[180:183], v[116:119], v[80:95]
    s_waitcnt vmcnt(24)
    ds_read_b64_tr_b16 a[208:209], v2 offset:49152
    ds_read_b64_tr_b16 a[210:211], v2 offset:49664
    ds_read_b64_tr_b16 a[212:213], v2 offset:49408
    ds_read_b64_tr_b16 a[214:215], v2 offset:49920
    s_add_u32 s58, s58, 4096
    buffer_load_dwordx4 v[176:179], v15, s[24:27], s58 offen offset:0 sc1
    s_waitcnt vmcnt(24)
    s_waitcnt lgkmcnt(12)
    v_mfma_f32_32x32x16_bf16 v[32:47], a[184:187], v[120:123], v[32:47]
    buffer_load_dwordx4 v[180:183], v16, s[24:27], s58 offen offset:0 sc1
    v_mfma_f32_32x32x16_bf16 v[64:79], a[188:191], v[120:123], v[64:79]
    buffer_load_dwordx4 v[184:187], v15, s[24:27], s58 offen offset:2048 sc1
    s_waitcnt vmcnt(25)
    v_mfma_f32_32x32x16_bf16 v[48:63], a[184:187], v[124:127], v[48:63]
    buffer_load_dwordx4 v[188:191], v16, s[24:27], s58 offen offset:2048 sc1
    v_mfma_f32_32x32x16_bf16 v[80:95], a[188:191], v[124:127], v[80:95]
    s_waitcnt vmcnt(24)
    ds_read_b64_tr_b16 a[216:217], v2 offset:57344
    ds_read_b64_tr_b16 a[218:219], v2 offset:57856
    ds_read_b64_tr_b16 a[220:221], v2 offset:57600
    ds_read_b64_tr_b16 a[222:223], v2 offset:58112
    s_waitcnt vmcnt(23)
    s_waitcnt lgkmcnt(12)
    v_mfma_f32_32x32x16_bf16 v[32:47], a[192:195], v[128:131], v[32:47]
    v_mfma_f32_32x32x16_bf16 v[64:79], a[196:199], v[128:131], v[64:79]
    s_waitcnt vmcnt(22)
    v_mfma_f32_32x32x16_bf16 v[48:63], a[192:195], v[132:135], v[48:63]
    v_mfma_f32_32x32x16_bf16 v[80:95], a[196:199], v[132:135], v[80:95]
    s_waitcnt vmcnt(20)
    ds_read_b64_tr_b16 a[224:225], v3 offset:0
    ds_read_b64_tr_b16 a[226:227], v3 offset:512
    ds_read_b64_tr_b16 a[228:229], v3 offset:256
    ds_read_b64_tr_b16 a[230:231], v3 offset:768
    s_waitcnt vmcnt(19)
    s_waitcnt lgkmcnt(12)
    v_mfma_f32_32x32x16_bf16 v[32:47], a[200:203], v[136:139], v[32:47]
    v_mfma_f32_32x32x16_bf16 v[64:79], a[204:207], v[136:139], v[64:79]
    s_waitcnt vmcnt(18)
    v_mfma_f32_32x32x16_bf16 v[48:63], a[200:203], v[140:143], v[48:63]
    v_mfma_f32_32x32x16_bf16 v[80:95], a[204:207], v[140:143], v[80:95]
    s_waitcnt vmcnt(16)
    ds_read_b64_tr_b16 a[232:233], v3 offset:8192
    ds_read_b64_tr_b16 a[234:235], v3 offset:8704
    ds_read_b64_tr_b16 a[236:237], v3 offset:8448
    ds_read_b64_tr_b16 a[238:239], v3 offset:8960
    s_waitcnt vmcnt(15)
    s_waitcnt lgkmcnt(12)
    v_mfma_f32_32x32x16_bf16 v[32:47], a[208:211], v[144:147], v[32:47]
    v_mfma_f32_32x32x16_bf16 v[64:79], a[212:215], v[144:147], v[64:79]
    s_waitcnt vmcnt(14)
    v_mfma_f32_32x32x16_bf16 v[48:63], a[208:211], v[148:151], v[48:63]
    v_mfma_f32_32x32x16_bf16 v[80:95], a[212:215], v[148:151], v[80:95]
    s_waitcnt vmcnt(12)
    ds_read_b64_tr_b16 a[240:241], v3 offset:16384
    ds_read_b64_tr_b16 a[242:243], v3 offset:16896
    ds_read_b64_tr_b16 a[244:245], v3 offset:16640
    ds_read_b64_tr_b16 a[246:247], v3 offset:17152
    s_waitcnt vmcnt(11)
    s_waitcnt lgkmcnt(12)
    v_mfma_f32_32x32x16_bf16 v[32:47], a[216:219], v[152:155], v[32:47]
    v_mfma_f32_32x32x16_bf16 v[64:79], a[220:223], v[152:155], v[64:79]
    s_waitcnt vmcnt(10)
    v_mfma_f32_32x32x16_bf16 v[48:63], a[216:219], v[156:159], v[48:63]
    v_mfma_f32_32x32x16_bf16 v[80:95], a[220:223], v[156:159], v[80:95]
    s_waitcnt vmcnt(8)
    ds_read_b64_tr_b16 a[248:249], v3 offset:24576
    ds_read_b64_tr_b16 a[250:251], v3 offset:25088
    ds_read_b64_tr_b16 a[252:253], v3 offset:24832
    ds_read_b64_tr_b16 a[254:255], v3 offset:25344
    s_waitcnt vmcnt(7)
    s_waitcnt lgkmcnt(12)
    v_mfma_f32_32x32x16_bf16 v[32:47], a[224:227], v[160:163], v[32:47]
    v_mfma_f32_32x32x16_bf16 v[64:79], a[228:231], v[160:163], v[64:79]
    s_waitcnt vmcnt(6)
    v_mfma_f32_32x32x16_bf16 v[48:63], a[224:227], v[164:167], v[48:63]
    v_mfma_f32_32x32x16_bf16 v[80:95], a[228:231], v[164:167], v[80:95]
    s_waitcnt vmcnt(5)
    s_waitcnt lgkmcnt(8)
    v_mfma_f32_32x32x16_bf16 v[32:47], a[232:235], v[168:171], v[32:47]
    v_mfma_f32_32x32x16_bf16 v[64:79], a[236:239], v[168:171], v[64:79]
    s_waitcnt vmcnt(4)
    v_mfma_f32_32x32x16_bf16 v[48:63], a[232:235], v[172:175], v[48:63]
    v_mfma_f32_32x32x16_bf16 v[80:95], a[236:239], v[172:175], v[80:95]
    s_waitcnt vmcnt(3)
    s_waitcnt lgkmcnt(4)
    v_mfma_f32_32x32x16_bf16 v[32:47], a[240:243], v[176:179], v[32:47]
    v_mfma_f32_32x32x16_bf16 v[64:79], a[244:247], v[176:179], v[64:79]
    s_waitcnt vmcnt(2)
    v_mfma_f32_32x32x16_bf16 v[48:63], a[240:243], v[180:183], v[48:63]
    v_mfma_f32_32x32x16_bf16 v[80:95], a[244:247], v[180:183], v[80:95]
    s_waitcnt vmcnt(1)
    s_waitcnt lgkmcnt(0)
    v_mfma_f32_32x32x16_bf16 v[32:47], a[248:251], v[184:187], v[32:47]
    v_mfma_f32_32x32x16_bf16 v[64:79], a[252:255], v[184:187], v[64:79]
    s_waitcnt vmcnt(0)
    v_mfma_f32_32x32x16_bf16 v[48:63], a[248:251], v[188:191], v[48:63]
    v_mfma_f32_32x32x16_bf16 v[80:95], a[252:255], v[188:191], v[80:95]
    v_add_u32 v19, s52, v14
    v_xor_b32 v20, 2048, v19
    v_xor_b32 v21, 4096, v19
    v_xor_b32 v22, 6144, v19
    s_nop 6
    ds_write_b128 v19, v[48:51] offset:0
    ds_write_b128 v19, v[52:55] offset:1024
    ds_write_b128 v19, v[56:59] offset:8192
    ds_write_b128 v19, v[60:63] offset:9216
    ds_write_b128 v19, v[64:67] offset:16384
    ds_write_b128 v19, v[68:71] offset:17408
    ds_write_b128 v19, v[72:75] offset:24576
    ds_write_b128 v19, v[76:79] offset:25600
    ds_write_b128 v19, v[80:83] offset:32768
    ds_write_b128 v19, v[84:87] offset:33792
    ds_write_b128 v19, v[88:91] offset:40960
    ds_write_b128 v19, v[92:95] offset:41984
    s_waitcnt lgkmcnt(0)
    s_barrier
    ds_read_b128 v[96:99], v20 offset:0
    ds_read_b128 v[112:115], v21 offset:16384
    ds_read_b128 v[128:131], v22 offset:32768
    ds_read_b128 v[100:103], v20 offset:1024
    ds_read_b128 v[116:119], v21 offset:17408
    ds_read_b128 v[132:135], v22 offset:33792
    ds_read_b128 v[104:107], v20 offset:8192
    ds_read_b128 v[120:123], v21 offset:24576
    ds_read_b128 v[136:139], v22 offset:40960
    ds_read_b128 v[108:111], v20 offset:9216
    ds_read_b128 v[124:127], v21 offset:25600
    ds_read_b128 v[140:143], v22 offset:41984
    s_mov_b32 s76, 0xbdd2d3e8
    v_mov_b32 v24, 0xc0135761
    s_mul_i32 s53, s51, 229376
    s_lshl_b32 s54, s50, 13
    s_add_u32 s53, s53, s54
    s_lshr_b32 s54, s44, 1
    s_lshl_b32 s54, s54, 12
    s_add_u32 s53, s53, s54
    s_add_u32 s53, s53, 2097152
    s_waitcnt lgkmcnt(9)
    v_pk_add_f32 v[96:97], v[96:97], v[112:113]
    v_pk_add_f32 v[32:33], v[32:33], v[128:129]
    v_pk_add_f32 v[98:99], v[98:99], v[114:115]
    v_pk_add_f32 v[34:35], v[34:35], v[130:131]
    v_pk_add_f32 v[32:33], v[32:33], v[96:97]
    v_pk_add_f32 v[34:35], v[34:35], v[98:99]
    v_mul_f32 v160, v32, v32
    v_mul_f32 v161, v33, v33
    v_mul_f32 v162, v34, v34
    v_mul_f32 v163, v35, v35
    v_fma_f32 v160, v160, s76, v24
    v_fma_f32 v161, v161, s76, v24
    v_fma_f32 v162, v162, s76, v24
    v_fma_f32 v163, v163, s76, v24
    v_mul_f32 v160, v160, v32
    v_mul_f32 v161, v161, v33
    v_mul_f32 v162, v162, v34
    v_mul_f32 v163, v163, v35
    v_exp_f32 v160, v160
    v_exp_f32 v161, v161
    v_exp_f32 v162, v162
    v_exp_f32 v163, v163
    v_add_f32 v160, 1.0, v160
    v_add_f32 v161, 1.0, v161
    v_add_f32 v162, 1.0, v162
    v_add_f32 v163, 1.0, v163
    v_rcp_f32 v160, v160
    v_rcp_f32 v161, v161
    v_rcp_f32 v162, v162
    v_rcp_f32 v163, v163
    v_mul_f32 v160, v160, v32
    v_mul_f32 v161, v161, v33
    v_mul_f32 v162, v162, v34
    v_mul_f32 v163, v163, v35
    v_cvt_pk_bf16_f32 v168, v160, v161
    v_cvt_pk_bf16_f32 v169, v162, v163
    s_waitcnt lgkmcnt(6)
    v_pk_add_f32 v[100:101], v[100:101], v[116:117]
    v_pk_add_f32 v[36:37], v[36:37], v[132:133]
    v_pk_add_f32 v[102:103], v[102:103], v[118:119]
    v_pk_add_f32 v[38:39], v[38:39], v[134:135]
    v_pk_add_f32 v[36:37], v[36:37], v[100:101]
    v_pk_add_f32 v[38:39], v[38:39], v[102:103]
    v_mul_f32 v160, v36, v36
    v_mul_f32 v161, v37, v37
    v_mul_f32 v162, v38, v38
    v_mul_f32 v163, v39, v39
    v_fma_f32 v160, v160, s76, v24
    v_fma_f32 v161, v161, s76, v24
    v_fma_f32 v162, v162, s76, v24
    v_fma_f32 v163, v163, s76, v24
    v_mul_f32 v160, v160, v36
    v_mul_f32 v161, v161, v37
    v_mul_f32 v162, v162, v38
    v_mul_f32 v163, v163, v39
    v_exp_f32 v160, v160
    v_exp_f32 v161, v161
    v_exp_f32 v162, v162
    v_exp_f32 v163, v163
    v_add_f32 v160, 1.0, v160
    v_add_f32 v161, 1.0, v161
    v_add_f32 v162, 1.0, v162
    v_add_f32 v163, 1.0, v163
    v_rcp_f32 v160, v160
    v_rcp_f32 v161, v161
    v_rcp_f32 v162, v162
    v_rcp_f32 v163, v163
    v_mul_f32 v160, v160, v36
    v_mul_f32 v161, v161, v37
    v_mul_f32 v162, v162, v38
    v_mul_f32 v163, v163, v39
    v_cvt_pk_bf16_f32 v170, v160, v161
    v_cvt_pk_bf16_f32 v171, v162, v163
    buffer_store_dwordx4 v[168:171], v15, s[24:27], s53 offen offset:0 sc1
    s_waitcnt lgkmcnt(3)
    v_pk_add_f32 v[104:105], v[104:105], v[120:121]
    v_pk_add_f32 v[40:41], v[40:41], v[136:137]
    v_pk_add_f32 v[106:107], v[106:107], v[122:123]
    v_pk_add_f32 v[42:43], v[42:43], v[138:139]
    v_pk_add_f32 v[40:41], v[40:41], v[104:105]
    v_pk_add_f32 v[42:43], v[42:43], v[106:107]
    v_mul_f32 v160, v40, v40
    v_mul_f32 v161, v41, v41
    v_mul_f32 v162, v42, v42
    v_mul_f32 v163, v43, v43
    v_fma_f32 v160, v160, s76, v24
    v_fma_f32 v161, v161, s76, v24
    v_fma_f32 v162, v162, s76, v24
    v_fma_f32 v163, v163, s76, v24
    v_mul_f32 v160, v160, v40
    v_mul_f32 v161, v161, v41
    v_mul_f32 v162, v162, v42
    v_mul_f32 v163, v163, v43
    v_exp_f32 v160, v160
    v_exp_f32 v161, v161
    v_exp_f32 v162, v162
    v_exp_f32 v163, v163
    v_add_f32 v160, 1.0, v160
    v_add_f32 v161, 1.0, v161
    v_add_f32 v162, 1.0, v162
    v_add_f32 v163, 1.0, v163
    v_rcp_f32 v160, v160
    v_rcp_f32 v161, v161
    v_rcp_f32 v162, v162
    v_rcp_f32 v163, v163
    v_mul_f32 v160, v160, v40
    v_mul_f32 v161, v161, v41
    v_mul_f32 v162, v162, v42
    v_mul_f32 v163, v163, v43
    v_cvt_pk_bf16_f32 v172, v160, v161
    v_cvt_pk_bf16_f32 v173, v162, v163
    s_waitcnt lgkmcnt(0)
    v_pk_add_f32 v[108:109], v[108:109], v[124:125]
    v_pk_add_f32 v[44:45], v[44:45], v[140:141]
    v_pk_add_f32 v[110:111], v[110:111], v[126:127]
    v_pk_add_f32 v[46:47], v[46:47], v[142:143]
    v_pk_add_f32 v[44:45], v[44:45], v[108:109]
    v_pk_add_f32 v[46:47], v[46:47], v[110:111]
    v_mul_f32 v160, v44, v44
    v_mul_f32 v161, v45, v45
    v_mul_f32 v162, v46, v46
    v_mul_f32 v163, v47, v47
    v_fma_f32 v160, v160, s76, v24
    v_fma_f32 v161, v161, s76, v24
    v_fma_f32 v162, v162, s76, v24
    v_fma_f32 v163, v163, s76, v24
    v_mul_f32 v160, v160, v44
    v_mul_f32 v161, v161, v45
    v_mul_f32 v162, v162, v46
    v_mul_f32 v163, v163, v47
    v_exp_f32 v160, v160
    v_exp_f32 v161, v161
    v_exp_f32 v162, v162
    v_exp_f32 v163, v163
    v_add_f32 v160, 1.0, v160
    v_add_f32 v161, 1.0, v161
    v_add_f32 v162, 1.0, v162
    v_add_f32 v163, 1.0, v163
    v_rcp_f32 v160, v160
    v_rcp_f32 v161, v161
    v_rcp_f32 v162, v162
    v_rcp_f32 v163, v163
    v_mul_f32 v160, v160, v44
    v_mul_f32 v161, v161, v45
    v_mul_f32 v162, v162, v46
    v_mul_f32 v163, v163, v47
    v_cvt_pk_bf16_f32 v174, v160, v161
    v_cvt_pk_bf16_f32 v175, v162, v163
    buffer_store_dwordx4 v[172:175], v15, s[24:27], s53 offen offset:2048 sc1
    s_waitcnt vmcnt(0)
    s_barrier
    s_lshl_b32 s53, s51, 5
    s_add_u32 s53, s53, s50
    s_lshl_b32 s53, s53, 7
    s_add_u32 s53, s53, 12713984
    s_cmp_lg_u32 s44, 0
    s_cbranch_scc1 L_nopub7
    v_mov_b32 v29, 0
    v_mov_b32 v30, s47
    s_mov_b64 exec, 1
    buffer_store_dword v30, v29, s[24:27], s53 offen sc1
    s_mov_b64 exec, -1
L_nopub7:
L_p3:
    v_and_b32 v21, 7, v1
    v_min_u32 v21, 6, v21
    v_lshlrev_b32 v21, 7, v21
    s_lshl_b32 s53, s45, 10
    s_add_u32 s53, s53, 12779520
    v_add_u32 v18, s53, v21
    s_lshl_b32 s53, s49, 5
    s_mul_i32 s54, s44, 7
    s_add_u32 s53, s53, s54
    s_lshl_b32 s53, s53, 7
    s_add_u32 s53, s53, 12713984
    v_add_u32 v20, s53, v21
    s_lshl_b32 s76, s48, 16
    s_lshl_b32 s54, s44, 14
    s_add_u32 s76, s76, s54
    s_add_u32 s76, s76, 4194304
    s_mul_i32 s77, s49, 229376
    s_mul_i32 s54, s44, 57344
    s_add_u32 s77, s77, s54
    s_add_u32 s77, s77, 2097152
    v_lshrrev_b32 v24, 3, v0
    v_and_b32 v25, 7, v0
    v_mul_u32_u24 v22, 896, v24
    v_lshl_add_u32 v22, v25, 4, v22
    v_lshlrev_b32 v23, 1, v24
    s_mul_i32 s78, s48, 57344
    s_lshl_b32 s54, s49, 7
    s_add_u32 s78, s78, s54
    s_add_u32 s79, s78, 28672
    s_lshl_b32 s80, s48, 7
    buffer_load_dwordx4 v[240:243], v22, s[4:7], s78 offen
    buffer_load_dwordx4 v[244:247], v22, s[4:7], s79 offen
    buffer_load_ushort v248, v23, s[36:39], s80 offen
    buffer_load_ushort v249, v23, s[36:39], s80 offen offset:64
    s_add_u32 m0, s52, 0
    s_mov_b32 s57, 0
    buffer_load_dwordx4 v12, s[12:15], s57 offen lds
    buffer_load_dwordx4 v13, s[12:15], s57 offen offset:1024 lds
    s_add_u32 m0, s52, 8192
    s_mov_b32 s57, 14336
    buffer_load_dwordx4 v12, s[12:15], s57 offen lds
    buffer_load_dwordx4 v13, s[12:15], s57 offen offset:1024 lds
    s_add_u32 m0, s52, 16384
    s_mov_b32 s57, 21504
    buffer_load_dwordx4 v12, s[12:15], s57 offen lds
    buffer_load_dwordx4 v13, s[12:15], s57 offen offset:1024 lds
    s_add_u32 m0, s52, 24576
    s_mov_b32 s57, 35840
    buffer_load_dwordx4 v12, s[12:15], s57 offen lds
    buffer_load_dwordx4 v13, s[12:15], s57 offen offset:1024 lds
    s_add_u32 m0, s52, 32768
    s_mov_b32 s57, 50176
    buffer_load_dwordx4 v12, s[12:15], s57 offen lds
    buffer_load_dwordx4 v13, s[12:15], s57 offen offset:1024 lds
    s_add_u32 m0, s52, 40960
    s_mov_b32 s57, 64512
    buffer_load_dwordx4 v12, s[12:15], s57 offen lds
    buffer_load_dwordx4 v13, s[12:15], s57 offen offset:1024 lds
    s_add_u32 m0, s52, 49152
    s_mov_b32 s57, 71680
    buffer_load_dwordx4 v12, s[12:15], s57 offen lds
    buffer_load_dwordx4 v13, s[12:15], s57 offen offset:1024 lds
    s_add_u32 m0, s52, 57344
    s_mov_b32 s57, 86016
    buffer_load_dwordx4 v12, s[12:15], s57 offen lds
    buffer_load_dwordx4 v13, s[12:15], s57 offen offset:1024 lds
    s_add_u32 m0, s52, 65536
    s_mov_b32 s57, 0
    buffer_load_dwordx4 v10, s[20:23], s57 offen lds
    buffer_load_dwordx4 v11, s[20:23], s57 offen offset:1024 lds
    s_add_u32 m0, s52, 73728
    s_mov_b32 s57, 65536
    buffer_load_dwordx4 v10, s[20:23], s57 offen lds
    buffer_load_dwordx4 v11, s[20:23], s57 offen offset:1024 lds
    s_add_u32 m0, s52, 81920
    s_mov_b32 s57, 131072
    buffer_load_dwordx4 v10, s[20:23], s57 offen lds
    buffer_load_dwordx4 v11, s[20:23], s57 offen offset:1024 lds
    s_add_u32 m0, s52, 90112
    s_mov_b32 s57, 196608
    buffer_load_dwordx4 v10, s[20:23], s57 offen lds
    buffer_load_dwordx4 v11, s[20:23], s57 offen offset:1024 lds
    s_add_u32 m0, s52, 98304
    s_mov_b32 s57, 262144
    buffer_load_dwordx4 v10, s[20:23], s57 offen lds
    buffer_load_dwordx4 v11, s[20:23], s57 offen offset:1024 lds
    s_waitcnt vmcnt(24)
    ds_read_b64_tr_b16 a[0:1], v2 offset:0
    ds_read_b64_tr_b16 a[2:3], v2 offset:512
    ds_read_b64_tr_b16 a[4:5], v2 offset:256
    ds_read_b64_tr_b16 a[6:7], v2 offset:768
    s_add_u32 m0, s52, 106496
    s_mov_b32 s57, 327680
    buffer_load_dwordx4 v10, s[20:23], s57 offen lds
    buffer_load_dwordx4 v11, s[20:23], s57 offen offset:1024 lds
    s_waitcnt vmcnt(24)
    ds_read_b64_tr_b16 a[8:9], v2 offset:8192
    ds_read_b64_tr_b16 a[10:11], v2 offset:8704
    ds_read_b64_tr_b16 a[12:13], v2 offset:8448
    ds_read_b64_tr_b16 a[14:15], v2 offset:8960
    s_add_u32 m0, s52, 114688
    s_mov_b32 s57, 393216
    buffer_load_dwordx4 v10, s[20:23], s57 offen lds
    buffer_load_dwordx4 v11, s[20:23], s57 offen offset:1024 lds
    s_waitcnt vmcnt(24)
    ds_read_b64_tr_b16 a[16:17], v2 offset:16384
    ds_read_b64_tr_b16 a[18:19], v2 offset:16896
    ds_read_b64_tr_b16 a[20:21], v2 offset:16640
    ds_read_b64_tr_b16 a[22:23], v2 offset:17152
    s_add_u32 m0, s52, 122880
    s_mov_b32 s57, 458752
    buffer_load_dwordx4 v10, s[20:23], s57 offen lds
    buffer_load_dwordx4 v11, s[20:23], s57 offen offset:1024 lds
    s_waitcnt vmcnt(24)
    ds_read_b64_tr_b16 a[24:25], v2 offset:24576
    ds_read_b64_tr_b16 a[26:27], v2 offset:25088
    ds_read_b64_tr_b16 a[28:29], v2 offset:24832
    ds_read_b64_tr_b16 a[30:31], v2 offset:25344
    s_add_u32 m0, s52, 131072
    s_mov_b32 s57, 524288
    buffer_load_dwordx4 v10, s[20:23], s57 offen lds
    buffer_load_dwordx4 v11, s[20:23], s57 offen offset:1024 lds
    s_waitcnt vmcnt(24)
    ds_read_b64_tr_b16 a[32:33], v2 offset:32768
    ds_read_b64_tr_b16 a[34:35], v2 offset:33280
    ds_read_b64_tr_b16 a[36:37], v2 offset:33024
    ds_read_b64_tr_b16 a[38:39], v2 offset:33536
    s_add_u32 m0, s52, 139264
    s_mov_b32 s57, 589824
    buffer_load_dwordx4 v10, s[20:23], s57 offen lds
    buffer_load_dwordx4 v11, s[20:23], s57 offen offset:1024 lds
    s_waitcnt vmcnt(24)
    ds_read_b64_tr_b16 a[40:41], v2 offset:40960
    ds_read_b64_tr_b16 a[42:43], v2 offset:41472
    ds_read_b64_tr_b16 a[44:45], v2 offset:41216
    ds_read_b64_tr_b16 a[46:47], v2 offset:41728
    s_add_u32 m0, s52, 147456
    s_mov_b32 s57, 655360
    buffer_load_dwordx4 v10, s[20:23], s57 offen lds
    buffer_load_dwordx4 v11, s[20:23], s57 offen offset:1024 lds
    s_waitcnt vmcnt(24)
    ds_read_b64_tr_b16 a[48:49], v2 offset:49152
    ds_read_b64_tr_b16 a[50:51], v2 offset:49664
    ds_read_b64_tr_b16 a[52:53], v2 offset:49408
    ds_read_b64_tr_b16 a[54:55], v2 offset:49920
    s_add_u32 m0, s52, 155648
    s_mov_b32 s57, 720896
    buffer_load_dwordx4 v10, s[20:23], s57 offen lds
    buffer_load_dwordx4 v11, s[20:23], s57 offen offset:1024 lds
    s_waitcnt vmcnt(24)
    ds_read_b64_tr_b16 a[56:57], v2 offset:57344
    ds_read_b64_tr_b16 a[58:59], v2 offset:57856
    ds_read_b64_tr_b16 a[60:61], v2 offset:57600
    ds_read_b64_tr_b16 a[62:63], v2 offset:58112
    s_waitcnt lgkmcnt(15)
    s_add_u32 m0, s52, 0
    s_mov_b32 s57, 786432
    buffer_load_dwordx4 v10, s[20:23], s57 offen lds
    buffer_load_dwordx4 v11, s[20:23], s57 offen offset:1024 lds
    s_waitcnt vmcnt(24)
    ds_read_b64_tr_b16 a[64:65], v6 offset:0
    ds_read_b64_tr_b16 a[66:67], v6 offset:1024
    ds_read_b64_tr_b16 a[68:69], v6 offset:256
    ds_read_b64_tr_b16 a[70:71], v6 offset:1280
    s_add_u32 m0, s52, 8192
    s_mov_b32 s57, 851968
    buffer_load_dwordx4 v10, s[20:23], s57 offen lds
    buffer_load_dwordx4 v11, s[20:23], s57 offen offset:1024 lds
    s_waitcnt vmcnt(24)
    ds_read_b64_tr_b16 a[72:73], v6 offset:8192
    ds_read_b64_tr_b16 a[74:75], v6 offset:9216
    ds_read_b64_tr_b16 a[76:77], v6 offset:8448
    ds_read_b64_tr_b16 a[78:79], v6 offset:9472
    s_add_u32 m0, s52, 16384
    s_mov_b32 s57, 917504
    buffer_load_dwordx4 v10, s[20:23], s57 offen lds
    buffer_load_dwordx4 v11, s[20:23], s57 offen offset:1024 lds
    s_waitcnt vmcnt(24)
    ds_read_b64_tr_b16 a[80:81], v6 offset:16384
    ds_read_b64_tr_b16 a[82:83], v6 offset:17408
    ds_read_b64_tr_b16 a[84:85], v6 offset:16640
    ds_read_b64_tr_b16 a[86:87], v6 offset:17664
    s_add_u32 m0, s52, 24576
    s_mov_b32 s57, 983040
    buffer_load_dwordx4 v10, s[20:23], s57 offen lds
    buffer_load_dwordx4 v11, s[20:23], s57 offen offset:1024 lds
    s_waitcnt vmcnt(24)
    ds_read_b64_tr_b16 a[88:89], v6 offset:24576
    ds_read_b64_tr_b16 a[90:91], v6 offset:25600
    ds_read_b64_tr_b16 a[92:93], v6 offset:24832
    ds_read_b64_tr_b16 a[94:95], v6 offset:25856
    s_waitcnt lgkmcnt(15)
    s_add_u32 m0, s52, 32768
    s_mov_b32 s57, 1048576
    buffer_load_dwordx4 v10, s[20:23], s57 offen lds
    buffer_load_dwordx4 v11, s[20:23], s57 offen offset:1024 lds
    s_waitcnt vmcnt(24)
    ds_read_b64_tr_b16 a[96:97], v6 offset:32768
    ds_read_b64_tr_b16 a[98:99], v6 offset:33792
    ds_read_b64_tr_b16 a[100:101], v6 offset:33024
    ds_read_b64_tr_b16 a[102:103], v6 offset:34048
    s_add_u32 m0, s52, 40960
    s_mov_b32 s57, 1114112
    buffer_load_dwordx4 v10, s[20:23], s57 offen lds
    buffer_load_dwordx4 v11, s[20:23], s57 offen offset:1024 lds
    s_waitcnt vmcnt(24)
    ds_read_b64_tr_b16 a[104:105], v6 offset:40960
    ds_read_b64_tr_b16 a[106:107], v6 offset:41984
    ds_read_b64_tr_b16 a[108:109], v6 offset:41216
    ds_read_b64_tr_b16 a[110:111], v6 offset:42240
    s_add_u32 m0, s52, 49152
    s_mov_b32 s57, 1179648
    buffer_load_dwordx4 v10, s[20:23], s57 offen lds
    buffer_load_dwordx4 v11, s[20:23], s57 offen offset:1024 lds
    s_waitcnt vmcnt(24)
    ds_read_b64_tr_b16 a[112:113], v6 offset:49152
    ds_read_b64_tr_b16 a[114:115], v6 offset:50176
    ds_read_b64_tr_b16 a[116:117], v6 offset:49408
    ds_read_b64_tr_b16 a[118:119], v6 offset:50432
    s_add_u32 m0, s52, 57344
    s_mov_b32 s57, 1245184
    buffer_load_dwordx4 v10, s[20:23], s57 offen lds
    buffer_load_dwordx4 v11, s[20:23], s57 offen offset:1024 lds
    s_waitcnt vmcnt(24)
    ds_read_b64_tr_b16 a[120:121], v6 offset:57344
    ds_read_b64_tr_b16 a[122:123], v6 offset:58368
    ds_read_b64_tr_b16 a[124:125], v6 offset:57600
    ds_read_b64_tr_b16 a[126:127], v6 offset:58624
    buffer_load_dword v17, v18, s[24:27], 0 offen sc1
    s_waitcnt lgkmcnt(15)
    s_add_u32 m0, s52, 65536
    s_mov_b32 s57, 1310720
    buffer_load_dwordx4 v10, s[20:23], s57 offen lds
    s_waitcnt vmcnt(24)
    ds_read_b64_tr_b16 a[128:129], v7 offset:0
    ds_read_b64_tr_b16 a[130:131], v7 offset:1024
    ds_read_b64_tr_b16 a[132:133], v7 offset:256
    ds_read_b64_tr_b16 a[134:135], v7 offset:1280
    buffer_load_dwordx4 v11, s[20:23], s57 offen offset:1024 lds
    s_add_u32 m0, s52, 73728
    s_mov_b32 s57, 1376256
    buffer_load_dwordx4 v10, s[20:23], s57 offen lds
    s_waitcnt vmcnt(24)
    ds_read_b64_tr_b16 a[136:137], v7 offset:8192
    ds_read_b64_tr_b16 a[138:139], v7 offset:9216
    ds_read_b64_tr_b16 a[140:141], v7 offset:8448
    ds_read_b64_tr_b16 a[142:143], v7 offset:9472
    buffer_load_dwordx4 v11, s[20:23], s57 offen offset:1024 lds
    s_add_u32 m0, s52, 81920
    s_mov_b32 s57, 1441792
    buffer_load_dwordx4 v10, s[20:23], s57 offen lds
    s_waitcnt vmcnt(24)
    ds_read_b64_tr_b16 a[144:145], v7 offset:16384
    ds_read_b64_tr_b16 a[146:147], v7 offset:17408
    ds_read_b64_tr_b16 a[148:149], v7 offset:16640
    ds_read_b64_tr_b16 a[150:151], v7 offset:17664
    buffer_load_dwordx4 v11, s[20:23], s57 offen offset:1024 lds
    s_add_u32 m0, s52, 90112
    s_mov_b32 s57, 1507328
    buffer_load_dwordx4 v10, s[20:23], s57 offen lds
    s_waitcnt vmcnt(24)
    ds_read_b64_tr_b16 a[152:153], v7 offset:24576
    ds_read_b64_tr_b16 a[154:155], v7 offset:25600
    ds_read_b64_tr_b16 a[156:157], v7 offset:24832
    ds_read_b64_tr_b16 a[158:159], v7 offset:25856
    buffer_load_dwordx4 v11, s[20:23], s57 offen offset:1024 lds
    s_waitcnt vmcnt(23)
    ds_read_b64_tr_b16 a[160:161], v5 offset:0
    ds_read_b64_tr_b16 a[162:163], v5 offset:1024
    ds_read_b64_tr_b16 a[164:165], v5 offset:256
    ds_read_b64_tr_b16 a[166:167], v5 offset:1280
    s_waitcnt vmcnt(21)
    ds_read_b64_tr_b16 a[168:169], v5 offset:8192
    ds_read_b64_tr_b16 a[170:171], v5 offset:9216
    ds_read_b64_tr_b16 a[172:173], v5 offset:8448
    ds_read_b64_tr_b16 a[174:175], v5 offset:9472
    s_waitcnt vmcnt(19)
    ds_read_b64_tr_b16 a[176:177], v5 offset:16384
    ds_read_b64_tr_b16 a[178:179], v5 offset:17408
    ds_read_b64_tr_b16 a[180:181], v5 offset:16640
    ds_read_b64_tr_b16 a[182:183], v5 offset:17664
    s_waitcnt vmcnt(17)
    ds_read_b64_tr_b16 a[184:185], v5 offset:24576
    ds_read_b64_tr_b16 a[186:187], v5 offset:25600
    ds_read_b64_tr_b16 a[188:189], v5 offset:24832
    ds_read_b64_tr_b16 a[190:191], v5 offset:25856
    s_waitcnt vmcnt(15)
    ds_read_b64_tr_b16 a[192:193], v5 offset:32768
    ds_read_b64_tr_b16 a[194:195], v5 offset:33792
    ds_read_b64_tr_b16 a[196:197], v5 offset:33024
    ds_read_b64_tr_b16 a[198:199], v5 offset:34048
    s_waitcnt vmcnt(13)
    ds_read_b64_tr_b16 a[200:201], v5 offset:40960
    ds_read_b64_tr_b16 a[202:203], v5 offset:41984
    ds_read_b64_tr_b16 a[204:205], v5 offset:41216
    ds_read_b64_tr_b16 a[206:207], v5 offset:42240
    s_waitcnt vmcnt(11)
    ds_read_b64_tr_b16 a[208:209], v5 offset:49152
    ds_read_b64_tr_b16 a[210:211], v5 offset:50176
    ds_read_b64_tr_b16 a[212:213], v5 offset:49408
    ds_read_b64_tr_b16 a[214:215], v5 offset:50432
    s_waitcnt vmcnt(9)
    ds_read_b64_tr_b16 a[216:217], v5 offset:57344
    ds_read_b64_tr_b16 a[218:219], v5 offset:58368
    ds_read_b64_tr_b16 a[220:221], v5 offset:57600
    ds_read_b64_tr_b16 a[222:223], v5 offset:58624
    s_waitcnt vmcnt(8)
    v_cmp_ne_u32 vcc, s47, v17
    s_nop 0
    s_cbranch_vccz L_ok9
    s_mov_b32 s59, 200000
L_spin8:
    buffer_load_dword v17, v18, s[24:27], 0 offen sc1
    s_waitcnt vmcnt(0)
    v_cmp_ne_u32 vcc, s47, v17
    s_nop 0
    s_cbranch_vccz L_ok9
    s_sub_u32 s59, s59, 1
    s_cbranch_scc0 L_spin8
L_ok9:
    buffer_load_dwordx4 v[96:99], v14, s[24:27], s76 offen offset:0 sc1
    buffer_load_dwordx4 v[100:103], v14, s[24:27], s76 offen offset:1024 sc1
    buffer_load_dwordx4 v[104:107], v14, s[24:27], s76 offen offset:2048 sc1
    buffer_load_dwordx4 v[108:111], v14, s[24:27], s76 offen offset:3072 sc1
    s_add_u32 s76, s76, 4096
    buffer_load_dwordx4 v[112:115], v14, s[24:27], s76 offen offset:0 sc1
    buffer_load_dwordx4 v[116:119], v14, s[24:27], s76 offen offset:1024 sc1
    buffer_load_dwordx4 v[120:123], v14, s[24:27], s76 offen offset:2048 sc1
    buffer_load_dwordx4 v[124:127], v14, s[24:27], s76 offen offset:3072 sc1
    s_add_u32 s76, s76, 4096
    buffer_load_dwordx4 v[128:131], v14, s[24:27], s76 offen offset:0 sc1
    buffer_load_dwordx4 v[132:135], v14, s[24:27], s76 offen offset:1024 sc1
    buffer_load_dwordx4 v[136:139], v14, s[24:27], s76 offen offset:2048 sc1
    buffer_load_dwordx4 v[140:143], v14, s[24:27], s76 offen offset:3072 sc1
    s_add_u32 s76, s76, 4096
    buffer_load_dwordx4 v[144:147], v14, s[24:27], s76 offen offset:0 sc1
    buffer_load_dwordx4 v[148:151], v14, s[24:27], s76 offen offset:1024 sc1
    buffer_load_dwordx4 v[152:155], v14, s[24:27], s76 offen offset:2048 sc1
    buffer_load_dwordx4 v[156:159], v14, s[24:27], s76 offen offset:3072 sc1
    buffer_load_dword v19, v20, s[24:27], 0 offen sc1
    s_waitcnt lgkmcnt(15)
    s_add_u32 m0, s52, 98304
    s_mov_b32 s57, 1572864
    buffer_load_dwordx4 v10, s[20:23], s57 offen lds
    s_waitcnt vmcnt(24)
    ds_read_b64_tr_b16 a[224:225], v6 offset:0
    ds_read_b64_tr_b16 a[226:227], v6 offset:1024
    ds_read_b64_tr_b16 a[228:229], v6 offset:256
    ds_read_b64_tr_b16 a[230:231], v6 offset:1280
    buffer_load_dwordx4 v11, s[20:23], s57 offen offset:1024 lds
    s_add_u32 m0, s52, 106496
    s_mov_b32 s57, 1638400
    buffer_load_dwordx4 v10, s[20:23], s57 offen lds
    s_waitcnt vmcnt(24)
    ds_read_b64_tr_b16 a[232:233], v6 offset:8192
    ds_read_b64_tr_b16 a[234:235], v6 offset:9216
    ds_read_b64_tr_b16 a[236:237], v6 offset:8448
    ds_read_b64_tr_b16 a[238:239], v6 offset:9472
    buffer_load_dwordx4 v11, s[20:23], s57 offen offset:1024 lds
    s_add_u32 m0, s52, 114688
    s_mov_b32 s57, 1703936
    buffer_load_dwordx4 v10, s[20:23], s57 offen lds
    s_waitcnt vmcnt(24)
    ds_read_b64_tr_b16 a[240:241], v6 offset:16384
    ds_read_b64_tr_b16 a[242:243], v6 offset:17408
    ds_read_b64_tr_b16 a[244:245], v6 offset:16640
    ds_read_b64_tr_b16 a[246:247], v6 offset:17664
    buffer_load_dwordx4 v11, s[20:23], s57 offen offset:1024 lds
    s_add_u32 m0, s52, 122880
    s_mov_b32 s57, 1769472
    buffer_load_dwordx4 v10, s[20:23], s57 offen lds
    s_waitcnt vmcnt(24)
    ds_read_b64_tr_b16 a[248:249], v6 offset:24576
    ds_read_b64_tr_b16 a[250:251], v6 offset:25600
    ds_read_b64_tr_b16 a[252:253], v6 offset:24832
    ds_read_b64_tr_b16 a[254:255], v6 offset:25856
    buffer_load_dwordx4 v11, s[20:23], s57 offen offset:1024 lds
    s_waitcnt vmcnt(24)
    v_mfma_f32_32x32x16_bf16 v[32:47], a[0:3], v[96:99], 0
    v_mfma_f32_32x32x16_bf16 v[64:79], a[4:7], v[96:99], 0
    s_waitcnt vmcnt(23)
    v_mfma_f32_32x32x16_bf16 v[48:63], a[0:3], v[100:103], 0
    v_mfma_f32_32x32x16_bf16 v[80:95], a[4:7], v[100:103], 0
    s_waitcnt vmcnt(22)
    v_mfma_f32_32x32x16_bf16 v[32:47], a[8:11], v[104:107], v[32:47]
    v_mfma_f32_32x32x16_bf16 v[64:79], a[12:15], v[104:107], v[64:79]
    s_waitcnt vmcnt(21)
    v_mfma_f32_32x32x16_bf16 v[48:63], a[8:11], v[108:111], v[48:63]
    v_mfma_f32_32x32x16_bf16 v[80:95], a[12:15], v[108:111], v[80:95]
    s_waitcnt vmcnt(20)
    v_mfma_f32_32x32x16_bf16 v[32:47], a[16:19], v[112:115], v[32:47]
    v_mfma_f32_32x32x16_bf16 v[64:79], a[20:23], v[112:115], v[64:79]
    s_waitcnt vmcnt(19)
    v_mfma_f32_32x32x16_bf16 v[48:63], a[16:19], v[116:119], v[48:63]
    v_mfma_f32_32x32x16_bf16 v[80:95], a[20:23], v[116:119], v[80:95]
    s_waitcnt vmcnt(18)
    v_mfma_f32_32x32x16_bf16 v[32:47], a[24:27], v[120:123], v[32:47]
    v_mfma_f32_32x32x16_bf16 v[64:79], a[28:31], v[120:123], v[64:79]
    s_waitcnt vmcnt(17)
    v_mfma_f32_32x32x16_bf16 v[48:63], a[24:27], v[124:127], v[48:63]
    v_mfma_f32_32x32x16_bf16 v[80:95], a[28:31], v[124:127], v[80:95]
    s_waitcnt vmcnt(8)
    v_cmp_ne_u32 vcc, s47, v19
    s_nop 0
    s_cbranch_vccz L_ok11
    s_mov_b32 s59, 200000
L_spin10:
    buffer_load_dword v19, v20, s[24:27], 0 offen sc1
    s_waitcnt vmcnt(0)
    v_cmp_ne_u32 vcc, s47, v19
    s_nop 0
    s_cbranch_vccz L_ok11
    s_sub_u32 s59, s59, 1
    s_cbranch_scc0 L_spin10
L_ok11:
    buffer_load_dwordx4 v[160:163], v14, s[24:27], s77 offen offset:0 sc1
    buffer_load_dwordx4 v[164:167], v14, s[24:27], s77 offen offset:1024 sc1
    buffer_load_dwordx4 v[168:171], v14, s[24:27], s77 offen offset:2048 sc1
    buffer_load_dwordx4 v[172:175], v14, s[24:27], s77 offen offset:3072 sc1
    s_add_u32 s77, s77, 4096
    buffer_load_dwordx4 v[176:179], v14, s[24:27], s77 offen offset:0 sc1
    buffer_load_dwordx4 v[180:183], v14, s[24:27], s77 offen offset:1024 sc1
    buffer_load_dwordx4 v[184:187], v14, s[24:27], s77 offen offset:2048 sc1
    buffer_load_dwordx4 v[188:191], v14, s[24:27], s77 offen offset:3072 sc1
    v_mfma_f32_32x32x16_bf16 v[32:47], a[32:35], v[128:131], v[32:47]
    s_add_u32 s77, s77, 4096
    buffer_load_dwordx4 v[192:195], v14, s[24:27], s77 offen offset:0 sc1
    v_mfma_f32_32x32x16_bf16 v[64:79], a[36:39], v[128:131], v[64:79]
    buffer_load_dwordx4 v[196:199], v14, s[24:27], s77 offen offset:1024 sc1
    v_mfma_f32_32x32x16_bf16 v[48:63], a[32:35], v[132:135], v[48:63]
    buffer_load_dwordx4 v[200:203], v14, s[24:27], s77 offen offset:2048 sc1
    v_mfma_f32_32x32x16_bf16 v[80:95], a[36:39], v[132:135], v[80:95]
    v_mfma_f32_32x32x16_bf16 v[32:47], a[40:43], v[136:139], v[32:47]
    v_mfma_f32_32x32x16_bf16 v[64:79], a[44:47], v[136:139], v[64:79]
    buffer_load_dwordx4 v[204:207], v14, s[24:27], s77 offen offset:3072 sc1
    v_mfma_f32_32x32x16_bf16 v[48:63], a[40:43], v[140:143], v[48:63]
    s_add_u32 s77, s77, 4096
    buffer_load_dwordx4 v[208:211], v14, s[24:27], s77 offen offset:0 sc1
    v_mfma_f32_32x32x16_bf16 v[80:95], a[44:47], v[140:143], v[80:95]
    v_mfma_f32_32x32x16_bf16 v[32:47], a[48:51], v[144:147], v[32:47]
    v_mfma_f32_32x32x16_bf16 v[64:79], a[52:55], v[144:147], v[64:79]
    buffer_load_dwordx4 v[212:215], v14, s[24:27], s77 offen offset:1024 sc1
    v_mfma_f32_32x32x16_bf16 v[48:63], a[48:51], v[148:151], v[48:63]
    buffer_load_dwordx4 v[216:219], v14, s[24:27], s77 offen offset:2048 sc1
    v_mfma_f32_32x32x16_bf16 v[80:95], a[52:55], v[148:151], v[80:95]
    v_mfma_f32_32x32x16_bf16 v[32:47], a[56:59], v[152:155], v[32:47]
    v_mfma_f32_32x32x16_bf16 v[64:79], a[60:63], v[152:155], v[64:79]
    buffer_load_dwordx4 v[220:223], v14, s[24:27], s77 offen offset:3072 sc1
    v_mfma_f32_32x32x16_bf16 v[48:63], a[56:59], v[156:159], v[48:63]
    s_add_u32 s77, s77, 4096
    buffer_load_dwordx4 v[224:227], v14, s[24:27], s77 offen offset:0 sc1
    v_mfma_f32_32x32x16_bf16 v[80:95], a[60:63], v[156:159], v[80:95]
    buffer_load_dwordx4 v[228:231], v14, s[24:27], s77 offen offset:1024 sc1
    s_waitcnt vmcnt(24)
    ds_read_b64_tr_b16 a[0:1], v6 offset:32768
    ds_read_b64_tr_b16 a[2:3], v6 offset:33792
    ds_read_b64_tr_b16 a[4:5], v6 offset:33024
    ds_read_b64_tr_b16 a[6:7], v6 offset:34048
    buffer_load_dwordx4 v[232:235], v14, s[24:27], s77 offen offset:2048 sc1
    buffer_load_dwordx4 v[236:239], v14, s[24:27], s77 offen offset:3072 sc1
    s_waitcnt vmcnt(24)
    ds_read_b64_tr_b16 a[8:9], v6 offset:40960
    ds_read_b64_tr_b16 a[10:11], v6 offset:41984
    ds_read_b64_tr_b16 a[12:13], v6 offset:41216
    ds_read_b64_tr_b16 a[14:15], v6 offset:42240
    s_add_u32 s77, s77, 4096
    buffer_load_dwordx4 v[96:99], v14, s[24:27], s77 offen offset:0 sc1
    buffer_load_dwordx4 v[100:103], v14, s[24:27], s77 offen offset:1024 sc1
    s_waitcnt vmcnt(24)
    ds_read_b64_tr_b16 a[16:17], v6 offset:49152
    ds_read_b64_tr_b16 a[18:19], v6 offset:50176
    ds_read_b64_tr_b16 a[20:21], v6 offset:49408
    ds_read_b64_tr_b16 a[22:23], v6 offset:50432
    buffer_load_dwordx4 v[104:107], v14, s[24:27], s77 offen offset:2048 sc1
    buffer_load_dwordx4 v[108:111], v14, s[24:27], s77 offen offset:3072 sc1
    s_waitcnt vmcnt(24)
    ds_read_b64_tr_b16 a[24:25], v6 offset:57344
    ds_read_b64_tr_b16 a[26:27], v6 offset:58368
    ds_read_b64_tr_b16 a[28:29], v6 offset:57600
    ds_read_b64_tr_b16 a[30:31], v6 offset:58624
    s_add_u32 s77, s77, 4096
    buffer_load_dwordx4 v[112:115], v14, s[24:27], s77 offen offset:0 sc1
    s_waitcnt vmcnt(24)
    v_mfma_f32_32x32x16_bf16 v[32:47], v[160:163], a[64:67], v[32:47]
    buffer_load_dwordx4 v[116:119], v14, s[24:27], s77 offen offset:1024 sc1
    v_mfma_f32_32x32x16_bf16 v[48:63], v[160:163], a[68:71], v[48:63]
    buffer_load_dwordx4 v[120:123], v14, s[24:27], s77 offen offset:2048 sc1
    s_waitcnt vmcnt(25)
    v_mfma_f32_32x32x16_bf16 v[64:79], v[164:167], a[64:67], v[64:79]
    buffer_load_dwordx4 v[124:127], v14, s[24:27], s77 offen offset:3072 sc1
    v_mfma_f32_32x32x16_bf16 v[80:95], v[164:167], a[68:71], v[80:95]
    s_waitcnt vmcnt(25)
    v_mfma_f32_32x32x16_bf16 v[32:47], v[168:171], a[72:75], v[32:47]
    v_mfma_f32_32x32x16_bf16 v[48:63], v[168:171], a[76:79], v[48:63]
    s_add_u32 s77, s77, 4096
    buffer_load_dwordx4 v[128:131], v14, s[24:27], s77 offen offset:0 sc1
    s_waitcnt vmcnt(25)
    v_mfma_f32_32x32x16_bf16 v[64:79], v[172:175], a[72:75], v[64:79]
    buffer_load_dwordx4 v[132:135], v14, s[24:27], s77 offen offset:1024 sc1
    v_mfma_f32_32x32x16_bf16 v[80:95], v[172:175], a[76:79], v[80:95]
    s_waitcnt vmcnt(25)
    v_mfma_f32_32x32x16_bf16 v[32:47], v[176:179], a[80:83], v[32:47]
    v_mfma_f32_32x32x16_bf16 v[48:63], v[176:179], a[84:87], v[48:63]
    buffer_load_dwordx4 v[136:139], v14, s[24:27], s77 offen offset:2048 sc1
    s_waitcnt vmcnt(25)
    v_mfma_f32_32x32x16_bf16 v[64:79], v[180:183], a[80:83], v[64:79]
    buffer_load_dwordx4 v[140:143], v14, s[24:27], s77 offen offset:3072 sc1
    v_mfma_f32_32x32x16_bf16 v[80:95], v[180:183], a[84:87], v[80:95]
    s_waitcnt vmcnt(25)
    v_mfma_f32_32x32x16_bf16 v[32:47], v[184:187], a[88:91], v[32:47]
    v_mfma_f32_32x32x16_bf16 v[48:63], v[184:187], a[92:95], v[48:63]
    s_add_u32 s77, s77, 4096
    buffer_load_dwordx4 v[144:147], v14, s[24:27], s77 offen offset:0 sc1
    s_waitcnt vmcnt(25)
    v_mfma_f32_32x32x16_bf16 v[64:79], v[188:191], a[88:91], v[64:79]
    buffer_load_dwordx4 v[148:151], v14, s[24:27], s77 offen offset:1024 sc1
    v_mfma_f32_32x32x16_bf16 v[80:95], v[188:191], a[92:95], v[80:95]
    s_waitcnt vmcnt(25)
    v_mfma_f32_32x32x16_bf16 v[32:47], v[192:195], a[96:99], v[32:47]
    v_mfma_f32_32x32x16_bf16 v[48:63], v[192:195], a[100:103], v[48:63]
    buffer_load_dwordx4 v[152:155], v14, s[24:27], s77 offen offset:2048 sc1
    s_waitcnt vmcnt(25)
    v_mfma_f32_32x32x16_bf16 v[64:79], v[196:199], a[96:99], v[64:79]
    buffer_load_dwordx4 v[156:159], v14, s[24:27], s77 offen offset:3072 sc1
    v_mfma_f32_32x32x16_bf16 v[80:95], v[196:199], a[100:103], v[80:95]
    s_waitcnt vmcnt(25)
    v_mfma_f32_32x32x16_bf16 v[32:47], v[200:203], a[104:107], v[32:47]
    v_mfma_f32_32x32x16_bf16 v[48:63], v[200:203], a[108:111], v[48:63]
    s_add_u32 s77, s77, 4096
    buffer_load_dwordx4 v[160:163], v14, s[24:27], s77 offen offset:0 sc1
    s_waitcnt vmcnt(25)
    v_mfma_f32_32x32x16_bf16 v[64:79], v[204:207], a[104:107], v[64:79]
    buffer_load_dwordx4 v[164:167], v14, s[24:27], s77 offen offset:1024 sc1
    v_mfma_f32_32x32x16_bf16 v[80:95], v[204:207], a[108:111], v[80:95]
    s_waitcnt vmcnt(25)
    v_mfma_f32_32x32x16_bf16 v[32:47], v[208:211], a[112:115], v[32:47]
    v_mfma_f32_32x32x16_bf16 v[48:63], v[208:211], a[116:119], v[48:63]
    buffer_load_dwordx4 v[168:171], v14, s[24:27], s77 offen offset:2048 sc1
    s_waitcnt vmcnt(25)
    v_mfma_f32_32x32x16_bf16 v[64:79], v[212:215], a[112:115], v[64:79]
    buffer_load_dwordx4 v[172:175], v14, s[24:27], s77 offen offset:3072 sc1
    v_mfma_f32_32x32x16_bf16 v[80:95], v[212:215], a[116:119], v[80:95]
    s_waitcnt vmcnt(25)
    v_mfma_f32_32x32x16_bf16 v[32:47], v[216:219], a[120:123], v[32:47]
    v_mfma_f32_32x32x16_bf16 v[48:63], v[216:219], a[124:127], v[48:63]
    s_add_u32 s77, s77, 4096
    buffer_load_dwordx4 v[176:179], v14, s[24:27], s77 offen offset:0 sc1
    s_waitcnt vmcnt(25)
    v_mfma_f32_32x32x16_bf16 v[64:79], v[220:223], a[120:123], v[64:79]
    buffer_load_dwordx4 v[180:183], v14, s[24:27], s77 offen offset:1024 sc1
    v_mfma_f32_32x32x16_bf16 v[80:95], v[220:223], a[124:127], v[80:95]
    s_waitcnt vmcnt(25)
    v_mfma_f32_32x32x16_bf16 v[32:47], v[224:227], a[128:131], v[32:47]
    v_mfma_f32_32x32x16_bf16 v[48:63], v[224:227], a[132:135], v[48:63]
    buffer_load_dwordx4 v[184:187], v14, s[24:27], s77 offen offset:2048 sc1
    s_waitcnt vmcnt(25)
    v_mfma_f32_32x32x16_bf16 v[64:79], v[228:231], a[128:131], v[64:79]
    buffer_load_dwordx4 v[188:191], v14, s[24:27], s77 offen offset:3072 sc1
    v_mfma_f32_32x32x16_bf16 v[80:95], v[228:231], a[132:135], v[80:95]
    s_waitcnt vmcnt(25)
    v_mfma_f32_32x32x16_bf16 v[32:47], v[232:235], a[136:139], v[32:47]
    v_mfma_f32_32x32x16_bf16 v[48:63], v[232:235], a[140:143], v[48:63]
    s_add_u32 s77, s77, 4096
    buffer_load_dwordx4 v[192:195], v14, s[24:27], s77 offen offset:0 sc1
    s_waitcnt vmcnt(25)
    v_mfma_f32_32x32x16_bf16 v[64:79], v[236:239], a[136:139], v[64:79]
    buffer_load_dwordx4 v[196:199], v14, s[24:27], s77 offen offset:1024 sc1
    v_mfma_f32_32x32x16_bf16 v[80:95], v[236:239], a[140:143], v[80:95]
    s_waitcnt vmcnt(25)
    v_mfma_f32_32x32x16_bf16 v[32:47], v[96:99], a[144:147], v[32:47]
    v_mfma_f32_32x32x16_bf16 v[48:63], v[96:99], a[148:151], v[48:63]
    buffer_load_dwordx4 v[200:203], v14, s[24:27], s77 offen offset:2048 sc1
    s_waitcnt vmcnt(25)
    v_mfma_f32_32x32x16_bf16 v[64:79], v[100:103], a[144:147], v[64:79]
    buffer_load_dwordx4 v[204:207], v14, s[24:27], s77 offen offset:3072 sc1
    v_mfma_f32_32x32x16_bf16 v[80:95], v[100:103], a[148:151], v[80:95]
    s_waitcnt vmcnt(25)
    v_mfma_f32_32x32x16_bf16 v[32:47], v[104:107], a[152:155], v[32:47]
    v_mfma_f32_32x32x16_bf16 v[48:63], v[104:107], a[156:159], v[48:63]
    s_add_u32 s77, s77, 4096
    buffer_load_dwordx4 v[208:211], v14, s[24:27], s77 offen offset:0 sc1
    s_waitcnt vmcnt(25)
    v_mfma_f32_32x32x16_bf16 v[64:79], v[108:111], a[152:155], v[64:79]
    buffer_load_dwordx4 v[212:215], v14, s[24:27], s77 offen offset:1024 sc1
    v_mfma_f32_32x32x16_bf16 v[80:95], v[108:111], a[156:159], v[80:95]
    s_waitcnt vmcnt(25)
    v_mfma_f32_32x32x16_bf16 v[32:47], v[112:115], a[160:163], v[32:47]
    v_mfma_f32_32x32x16_bf16 v[48:63], v[112:115], a[164:167], v[48:63]
    buffer_load_dwordx4 v[216:219], v14, s[24:27], s77 offen offset:2048 sc1
    s_waitcnt vmcnt(25)
    v_mfma_f32_32x32x16_bf16 v[64:79], v[116:119], a[160:163], v[64:79]
    buffer_load_dwordx4 v[220:223], v14, s[24:27], s77 offen offset:3072 sc1
    v_mfma_f32_32x32x16_bf16 v[80:95], v[116:119], a[164:167], v[80:95]
    s_waitcnt vmcnt(25)
    v_mfma_f32_32x32x16_bf16 v[32:47], v[120:123], a[168:171], v[32:47]
    v_mfma_f32_32x32x16_bf16 v[48:63], v[120:123], a[172:175], v[48:63]
    s_add_u32 s77, s77, 4096
    buffer_load_dwordx4 v[224:227], v14, s[24:27], s77 offen offset:0 sc1
    s_waitcnt vmcnt(25)
    v_mfma_f32_32x32x16_bf16 v[64:79], v[124:127], a[168:171], v[64:79]
    buffer_load_dwordx4 v[228:231], v14, s[24:27], s77 offen offset:1024 sc1
    v_mfma_f32_32x32x16_bf16 v[80:95], v[124:127], a[172:175], v[80:95]
    s_waitcnt vmcnt(25)
    v_mfma_f32_32x32x16_bf16 v[32:47], v[128:131], a[176:179], v[32:47]
    v_mfma_f32_32x32x16_bf16 v[48:63], v[128:131], a[180:183], v[48:63]
    buffer_load_dwordx4 v[232:235], v14, s[24:27], s77 offen offset:2048 sc1
    s_waitcnt vmcnt(25)
    v_mfma_f32_32x32x16_bf16 v[64:79], v[132:135], a[176:179], v[64:79]
    buffer_load_dwordx4 v[236:239], v14, s[24:27], s77 offen offset:3072 sc1
    v_mfma_f32_32x32x16_bf16 v[80:95], v[132:135], a[180:183], v[80:95]
    s_waitcnt vmcnt(25)
    v_mfma_f32_32x32x16_bf16 v[32:47], v[136:139], a[184:187], v[32:47]
    v_mfma_f32_32x32x16_bf16 v[48:63], v[136:139], a[188:191], v[48:63]
    s_waitcnt vmcnt(24)
    v_mfma_f32_32x32x16_bf16 v[64:79], v[140:143], a[184:187], v[64:79]
    v_mfma_f32_32x32x16_bf16 v[80:95], v[140:143], a[188:191], v[80:95]
    s_waitcnt vmcnt(23)
    s_waitcnt lgkmcnt(15)
    v_mfma_f32_32x32x16_bf16 v[32:47], v[144:147], a[192:195], v[32:47]
    v_mfma_f32_32x32x16_bf16 v[48:63], v[144:147], a[196:199], v[48:63]
    s_waitcnt vmcnt(22)
    v_mfma_f32_32x32x16_bf16 v[64:79], v[148:151], a[192:195], v[64:79]
    v_mfma_f32_32x32x16_bf16 v[80:95], v[148:151], a[196:199], v[80:95]
    s_waitcnt vmcnt(21)
    v_mfma_f32_32x32x16_bf16 v[32:47], v[152:155], a[200:203], v[32:47]
    v_mfma_f32_32x32x16_bf16 v[48:63], v[152:155], a[204:207], v[48:63]
    s_waitcnt vmcnt(20)
    v_mfma_f32_32x32x16_bf16 v[64:79], v[156:159], a[200:203], v[64:79]
    v_mfma_f32_32x32x16_bf16 v[80:95], v[156:159], a[204:207], v[80:95]
    s_waitcnt vmcnt(19)
    v_mfma_f32_32x32x16_bf16 v[32:47], v[160:163], a[208:211], v[32:47]
    v_mfma_f32_32x32x16_bf16 v[48:63], v[160:163], a[212:215], v[48:63]
    s_waitcnt vmcnt(18)
    v_mfma_f32_32x32x16_bf16 v[64:79], v[164:167], a[208:211], v[64:79]
    v_mfma_f32_32x32x16_bf16 v[80:95], v[164:167], a[212:215], v[80:95]
    s_waitcnt vmcnt(17)
    v_mfma_f32_32x32x16_bf16 v[32:47], v[168:171], a[216:219], v[32:47]
    v_mfma_f32_32x32x16_bf16 v[48:63], v[168:171], a[220:223], v[48:63]
    s_waitcnt vmcnt(16)
    v_mfma_f32_32x32x16_bf16 v[64:79], v[172:175], a[216:219], v[64:79]
    v_mfma_f32_32x32x16_bf16 v[80:95], v[172:175], a[220:223], v[80:95]
    s_waitcnt vmcnt(15)
    v_mfma_f32_32x32x16_bf16 v[32:47], v[176:179], a[224:227], v[32:47]
    v_mfma_f32_32x32x16_bf16 v[48:63], v[176:179], a[228:231], v[48:63]
    s_waitcnt vmcnt(14)
    v_mfma_f32_32x32x16_bf16 v[64:79], v[180:183], a[224:227], v[64:79]
    v_mfma_f32_32x32x16_bf16 v[80:95], v[180:183], a[228:231], v[80:95]
    s_waitcnt vmcnt(13)
    v_mfma_f32_32x32x16_bf16 v[32:47], v[184:187], a[232:235], v[32:47]
    v_mfma_f32_32x32x16_bf16 v[48:63], v[184:187], a[236:239], v[48:63]
    s_waitcnt vmcnt(12)
    v_mfma_f32_32x32x16_bf16 v[64:79], v[188:191], a[232:235], v[64:79]
    v_mfma_f32_32x32x16_bf16 v[80:95], v[188:191], a[236:239], v[80:95]
    s_waitcnt vmcnt(11)
    v_mfma_f32_32x32x16_bf16 v[32:47], v[192:195], a[240:243], v[32:47]
    v_mfma_f32_32x32x16_bf16 v[48:63], v[192:195], a[244:247], v[48:63]
    s_waitcnt vmcnt(10)
    v_mfma_f32_32x32x16_bf16 v[64:79], v[196:199], a[240:243], v[64:79]
    v_mfma_f32_32x32x16_bf16 v[80:95], v[196:199], a[244:247], v[80:95]
    s_waitcnt vmcnt(9)
    v_mfma_f32_32x32x16_bf16 v[32:47], v[200:203], a[248:251], v[32:47]
    v_mfma_f32_32x32x16_bf16 v[48:63], v[200:203], a[252:255], v[48:63]
    s_waitcnt vmcnt(8)
    v_mfma_f32_32x32x16_bf16 v[64:79], v[204:207], a[248:251], v[64:79]
    v_mfma_f32_32x32x16_bf16 v[80:95], v[204:207], a[252:255], v[80:95]
    s_waitcnt vmcnt(7)
    s_waitcnt lgkmcnt(12)
    v_mfma_f32_32x32x16_bf16 v[32:47], v[208:211], a[0:3], v[32:47]
    v_mfma_f32_32x32x16_bf16 v[48:63], v[208:211], a[4:7], v[48:63]
    s_waitcnt vmcnt(6)
    v_mfma_f32_32x32x16_bf16 v[64:79], v[212:215], a[0:3], v[64:79]
    v_mfma_f32_32x32x16_bf16 v[80:95], v[212:215], a[4:7], v[80:95]
    s_waitcnt vmcnt(5)
    s_waitcnt lgkmcnt(8)
    v_mfma_f32_32x32x16_bf16 v[32:47], v[216:219], a[8:11], v[32:47]
    v_mfma_f32_32x32x16_bf16 v[48:63], v[216:219], a[12:15], v[48:63]
    s_waitcnt vmcnt(4)
    v_mfma_f32_32x32x16_bf16 v[64:79], v[220:223], a[8:11], v[64:79]
    v_mfma_f32_32x32x16_bf16 v[80:95], v[220:223], a[12:15], v[80:95]
    s_waitcnt vmcnt(3)
    s_waitcnt lgkmcnt(4)
    v_mfma_f32_32x32x16_bf16 v[32:47], v[224:227], a[16:19], v[32:47]
    v_mfma_f32_32x32x16_bf16 v[48:63], v[224:227], a[20:23], v[48:63]
    s_waitcnt vmcnt(2)
    v_mfma_f32_32x32x16_bf16 v[64:79], v[228:231], a[16:19], v[64:79]
    v_mfma_f32_32x32x16_bf16 v[80:95], v[228:231], a[20:23], v[80:95]
    s_waitcnt vmcnt(1)
    s_waitcnt lgkmcnt(0)
    v_mfma_f32_32x32x16_bf16 v[32:47], v[232:235], a[24:27], v[32:47]
    v_mfma_f32_32x32x16_bf16 v[48:63], v[232:235], a[28:31], v[48:63]
    s_waitcnt vmcnt(0)
    v_mfma_f32_32x32x16_bf16 v[64:79], v[236:239], a[24:27], v[64:79]
    v_mfma_f32_32x32x16_bf16 v[80:95], v[236:239], a[28:31], v[80:95]
    v_and_b32 v24, 31, v1
    v_lshrrev_b32 v25, 3, v24
    v_and_b32 v26, 7, v24
    v_lshlrev_b32 v96, 13, v25
    v_lshl_add_u32 v96, v26, 8, v96
    v_lshl_add_u32 v96, v26, 4, v96
    v_add_u32 v96, s52, v96
    v_lshrrev_b32 v25, 5, v1
    v_bfe_u32 v27, v1, 1, 1
    v_xor_b32 v25, v25, v27
    v_lshl_add_u32 v96, v25, 7, v96
    v_xor_b32 v97, 16, v96
    v_xor_b32 v98, 32, v96
    v_xor_b32 v99, 48, v96
    v_xor_b32 v100, 64, v96
    v_xor_b32 v101, 80, v96
    v_xor_b32 v102, 96, v96
    v_xor_b32 v103, 112, v96
    v_lshrrev_b32 v24, 3, v0
    v_and_b32 v25, 7, v0
    v_and_b32 v26, 7, v24
    v_xor_b32 v25, v25, v26
    v_lshrrev_b32 v27, 3, v24
    v_lshlrev_b32 v104, 13, v27
    v_lshl_add_u32 v104, v26, 8, v104
    v_lshl_add_u32 v104, v25, 4, v104
    v_bfe_u32 v27, v24, 1, 1
    v_lshl_add_u32 v104, v27, 7, v104
    v_xor_b32 v105, 128, v104
    ds_write_b128 v96, v[32:35] offset:0
    ds_write_b128 v97, v[36:39] offset:0
    ds_write_b128 v98, v[40:43] offset:0
    ds_write_b128 v99, v[44:47] offset:0
    ds_write_b128 v96, v[48:51] offset:32768
    ds_write_b128 v97, v[52:55] offset:32768
    ds_write_b128 v98, v[56:59] offset:32768
    ds_write_b128 v99, v[60:63] offset:32768
    ds_write_b128 v100, v[64:67] offset:0
    ds_write_b128 v101, v[68:71] offset:0
    ds_write_b128 v102, v[72:75] offset:0
    ds_write_b128 v103, v[76:79] offset:0
    ds_write_b128 v100, v[80:83] offset:32768
    ds_write_b128 v101, v[84:87] offset:32768
    ds_write_b128 v102, v[88:91] offset:32768
    ds_write_b128 v103, v[92:95] offset:32768
    s_waitcnt lgkmcnt(0)
    s_barrier
    ds_read_b128 v[112:115], v104 offset:0
    ds_read_b128 v[116:119], v104 offset:2048
    ds_read_b128 v[120:123], v104 offset:4096
    ds_read_b128 v[124:127], v104 offset:6144
    ds_read_b128 v[128:131], v105 offset:0
    ds_read_b128 v[132:135], v105 offset:2048
    ds_read_b128 v[136:139], v105 offset:4096
    ds_read_b128 v[140:143], v105 offset:6144
    ds_read_b128 v[144:147], v104 offset:32768
    ds_read_b128 v[148:151], v104 offset:34816
    ds_read_b128 v[152:155], v104 offset:36864
    ds_read_b128 v[156:159], v104 offset:38912
    ds_read_b128 v[160:163], v105 offset:32768
    ds_read_b128 v[164:167], v105 offset:34816
    ds_read_b128 v[168:171], v105 offset:36864
    ds_read_b128 v[172:175], v105 offset:38912
    v_lshlrev_b32 v248, 16, v248
    v_lshlrev_b32 v32, 16, v240
    v_and_b32 v33, 0xffff0000, v240
    v_lshlrev_b32 v34, 16, v241
    v_and_b32 v35, 0xffff0000, v241
    v_lshlrev_b32 v36, 16, v242
    v_and_b32 v37, 0xffff0000, v242
    v_lshlrev_b32 v38, 16, v243
    v_and_b32 v39, 0xffff0000, v243
    v_add_f32 v32, v32, v248
    v_add_f32 v33, v33, v248
    v_add_f32 v34, v34, v248
    v_add_f32 v35, v35, v248
    v_add_f32 v36, v36, v248
    v_add_f32 v37, v37, v248
    v_add_f32 v38, v38, v248
    v_add_f32 v39, v39, v248
    v_lshlrev_b32 v249, 16, v249
    v_lshlrev_b32 v40, 16, v244
    v_and_b32 v41, 0xffff0000, v244
    v_lshlrev_b32 v42, 16, v245
    v_and_b32 v43, 0xffff0000, v245
    v_lshlrev_b32 v44, 16, v246
    v_and_b32 v45, 0xffff0000, v246
    v_lshlrev_b32 v46, 16, v247
    v_and_b32 v47, 0xffff0000, v247
    v_add_f32 v40, v40, v249
    v_add_f32 v41, v41, v249
    v_add_f32 v42, v42, v249
    v_add_f32 v43, v43, v249
    v_add_f32 v44, v44, v249
    v_add_f32 v45, v45, v249
    v_add_f32 v46, v46, v249
    v_add_f32 v47, v47, v249
    s_waitcnt lgkmcnt(12)
    v_pk_add_f32 v[112:113], v[112:113], v[116:117]
    v_pk_add_f32 v[120:121], v[120:121], v[124:125]
    v_pk_add_f32 v[114:115], v[114:115], v[118:119]
    v_pk_add_f32 v[122:123], v[122:123], v[126:127]
    v_pk_add_f32 v[32:33], v[32:33], v[112:113]
    v_pk_add_f32 v[34:35], v[34:35], v[114:115]
    v_pk_add_f32 v[32:33], v[32:33], v[120:121]
    v_pk_add_f32 v[34:35], v[34:35], v[122:123]
    v_cvt_pk_bf16_f32 v48, v32, v33
    v_cvt_pk_bf16_f32 v49, v34, v35
    s_waitcnt lgkmcnt(8)
    v_pk_add_f32 v[128:129], v[128:129], v[132:133]
    v_pk_add_f32 v[136:137], v[136:137], v[140:141]
    v_pk_add_f32 v[130:131], v[130:131], v[134:135]
    v_pk_add_f32 v[138:139], v[138:139], v[142:143]
    v_pk_add_f32 v[36:37], v[36:37], v[128:129]
    v_pk_add_f32 v[38:39], v[38:39], v[130:131]
    v_pk_add_f32 v[36:37], v[36:37], v[136:137]
    v_pk_add_f32 v[38:39], v[38:39], v[138:139]
    v_cvt_pk_bf16_f32 v50, v36, v37
    v_cvt_pk_bf16_f32 v51, v38, v39
    buffer_store_dwordx4 v[48:51], v22, s[28:31], s78 offen
    s_waitcnt lgkmcnt(4)
    v_pk_add_f32 v[144:145], v[144:145], v[148:149]
    v_pk_add_f32 v[152:153], v[152:153], v[156:157]
    v_pk_add_f32 v[146:147], v[146:147], v[150:151]
    v_pk_add_f32 v[154:155], v[154:155], v[158:159]
    v_pk_add_f32 v[40:41], v[40:41], v[144:145]
    v_pk_add_f32 v[42:43], v[42:43], v[146:147]
    v_pk_add_f32 v[40:41], v[40:41], v[152:153]
    v_pk_add_f32 v[42:43], v[42:43], v[154:155]
    v_cvt_pk_bf16_f32 v52, v40, v41
    v_cvt_pk_bf16_f32 v53, v42, v43
    s_waitcnt lgkmcnt(0)
    v_pk_add_f32 v[160:161], v[160:161], v[164:165]
    v_pk_add_f32 v[168:169], v[168:169], v[172:173]
    v_pk_add_f32 v[162:163], v[162:163], v[166:167]
    v_pk_add_f32 v[170:171], v[170:171], v[174:175]
    v_pk_add_f32 v[44:45], v[44:45], v[160:161]
    v_pk_add_f32 v[46:47], v[46:47], v[162:163]
    v_pk_add_f32 v[44:45], v[44:45], v[168:169]
    v_pk_add_f32 v[46:47], v[46:47], v[170:171]
    v_cvt_pk_bf16_f32 v54, v44, v45
    v_cvt_pk_bf16_f32 v55, v46, v47
    buffer_store_dwordx4 v[52:55], v22, s[28:31], s79 offen
    s_endpgm
L_helper:
    s_waitcnt vmcnt(0) lgkmcnt(0)
    v_mov_b32 v10, 0
    v_mov_b32 v11, 0
    v_mov_b32 v12, 0
    v_mov_b32 v13, 0
    v_mov_b32 v29, 0
    buffer_load_dword v29, v29, s[40:43], 0 offen sc1
    s_waitcnt vmcnt(0)
    v_mov_b32 v30, 0
    v_cmp_eq_u32 vcc, 0, v29
    s_nop 0
    s_cbranch_vccz L_ok13
    s_mov_b32 s59, 200000
L_spin12:
    buffer_load_dword v29, v30, s[40:43], 0 offen sc1
    s_waitcnt vmcnt(0)
    v_cmp_eq_u32 vcc, 0, v29
    s_nop 0
    s_cbranch_vccz L_ok13
    s_sub_u32 s59, s59, 1
    s_cbranch_scc0 L_spin12
L_ok13:
    v_readfirstlane_b32 s47, v29
    s_branch L_attn
L_nop2:
    s_cmp_lt_u32 s46, 25
    s_cbranch_scc1 L_p3
L_attn:
    s_waitcnt vmcnt(0) lgkmcnt(0)
    v_and_b32 v17, 15, v1
    v_lshrrev_b32 v18, 4, v1
    v_lshrrev_b32 v28, 3, v1
    v_min_u32 v28, 4, v28
    s_lshl_b32 s53, s45, 2
    s_sub_u32 s53, s53, 1
    v_add_u32 v28, s53, v28
    v_max_i32 v28, 0, v28
    v_and_b32 v29, 7, v1
    v_min_u32 v29, 6, v29
    v_lshl_add_u32 v28, v28, 3, v29
    v_lshlrev_b32 v28, 7, v28
    v_add_u32 v28, 12648448, v28
    buffer_load_dword v29, v28, s[24:27], 0 offen sc1
    v_lshlrev_b32 v19, 15, v18
    v_lshl_add_u32 v19, v17, 4, v19
    v_lshrrev_b32 v23, 1, v18
    v_lshlrev_b32 v20, 11, v23
    v_and_b32 v23, 1, v18
    v_lshl_add_u32 v20, v23, 9, v20
    v_lshl_add_u32 v20, v17, 4, v20
    s_lshl_b32 s53, s44, 12
    v_add_u32 v21, s53, v14
    v_and_b32 v23, 3, v1
    v_lshlrev_b32 v22, 8, v23
    v_lshrrev_b32 v23, 2, v1
    v_lshl_add_u32 v22, v23, 4, v22
    v_add_u32 v22, s53, v22
    v_and_b32 v23, 1, v17
    v_cmp_eq_u32 s[76:77], 1, v23
    v_lshl_add_u32 v23, v18, 2, v23
    v_cmp_le_u32 s[78:79], v23, v17
    v_add_u32 v23, 2, v23
    v_cmp_le_u32 s[80:81], v23, v17
    v_mov_b32 v23, 0xffff
    v_mov_b32 v30, 0xffff0000
    v_cndmask_b32 v23, v23, v30, s[76:77]
    v_cndmask_b32 v24, v23, 0, s[78:79]
    v_cndmask_b32 v25, v23, 0, s[80:81]
    v_cndmask_b32 v26, 0, v23, s[78:79]
    v_cndmask_b32 v27, 0, v23, s[80:81]
    s_sub_u32 s90, s46, 25
    s_lshl_b32 s90, s90, 2
    s_add_u32 s90, s90, s44
    s_waitcnt vmcnt(0)
    v_cmp_ne_u32 vcc, s47, v29
    s_nop 0
    s_cbranch_vccz L_ok15
    s_mov_b32 s59, 200000
L_spin14:
    buffer_load_dword v29, v28, s[24:27], 0 offen sc1
    s_waitcnt vmcnt(0)
    v_cmp_ne_u32 vcc, s47, v29
    s_nop 0
    s_cbranch_vccz L_ok15
    s_sub_u32 s59, s59, 1
    s_cbranch_scc0 L_spin14
L_ok15:
    s_and_b32 s53, s90, 15
    s_mul_i32 s53, s53, 7
    s_lshr_b32 s53, s53, 1
    s_lshl_b32 s53, s53, 15
    s_lshr_b32 s54, s90, 4
    s_lshl_b32 s56, s45, 3
    s_add_u32 s54, s54, s56
    s_lshl_b32 s54, s54, 9
    s_add_u32 s91, s53, s54
    s_add_u32 s91, s91, 6291456
    s_cmp_eq_u32 s54, 0
    s_cselect_b32 s56, 0, 256
    s_add_u32 s92, s91, 1835008
    s_sub_u32 s93, s92, s56
    buffer_load_dwordx4 v[96:99], v19, s[24:27], s91 offen offset:0 sc1
    buffer_load_dwordx4 v[100:103], v19, s[24:27], s91 offen offset:256 sc1
    buffer_load_dwordx4 v[104:107], v19, s[24:27], s93 offen sc1
    buffer_load_dwordx4 v[108:111], v19, s[24:27], s92 offen offset:0 sc1
    buffer_load_dwordx4 v[112:115], v19, s[24:27], s92 offen offset:256 sc1
    s_add_u32 s92, s92, 1835008
    s_add_u32 s93, s93, 1835008
    buffer_load_dwordx4 v[116:119], v19, s[24:27], s93 offen sc1
    buffer_load_dwordx4 v[120:123], v19, s[24:27], s92 offen offset:0 sc1
    buffer_load_dwordx4 v[124:127], v19, s[24:27], s92 offen offset:256 sc1
L_attn_loop:
    s_bitcmp1_b32 s90, 0
    s_cselect_b32 s82, 0xffff, 0
    s_mov_b32 s83, 0
    s_mov_b32 s84, 0
    s_cselect_b32 s85, 0, 0xffff0000
    s_lshr_b32 s54, s90, 4
    s_lshl_b32 s56, s45, 3
    s_add_u32 s54, s54, s56
    s_lshr_b32 s94, s54, 1
    s_lshl_b32 s94, s94, 16
    s_and_b32 s56, s54, 1
    s_lshl_b32 s56, s56, 10
    s_add_u32 s94, s94, s56
    s_and_b32 s56, s90, 15
    s_lshl_b32 s56, s56, 12
    s_add_u32 s94, s94, s56
    s_add_u32 s94, s94, 4194304
    s_cmp_eq_u32 s54, 0
    s_cselect_b64 s[86:87], -1, 0
    s_andn2_b64 s[88:89], s[86:87], s[80:81]
    s_andn2_b64 s[86:87], s[86:87], s[78:79]
    s_waitcnt vmcnt(0) lgkmcnt(0)
    ds_write_b128 v21, v[116:119] offset:0
    ds_write_b128 v21, v[120:123] offset:1024
    ds_write_b128 v21, v[124:127] offset:2048
    v_cndmask_b32 v96, v96, 0, s[82:83]
    v_cndmask_b32 v97, v97, 0, s[82:83]
    v_cndmask_b32 v98, v98, 0, s[84:85]
    v_cndmask_b32 v99, v99, 0, s[84:85]
    v_cndmask_b32 v100, v100, 0, s[82:83]
    v_cndmask_b32 v101, v101, 0, s[82:83]
    v_cndmask_b32 v102, v102, 0, s[84:85]
    v_cndmask_b32 v103, v103, 0, s[84:85]
    ds_read_b64_tr_b16 v[144:145], v22 offset:0
    ds_read_b64_tr_b16 v[146:147], v22 offset:1024
    ds_read_b64_tr_b16 v[148:149], v22 offset:2048
    ds_read_b64_tr_b16 v[150:151], v22 offset:8
    ds_read_b64_tr_b16 v[152:153], v22 offset:1032
    ds_read_b64_tr_b16 v[154:155], v22 offset:2056
    v_mfma_f32_16x16x32_bf16 v[128:131], v[104:107], v[96:99], 0
    v_mfma_f32_16x16x32_bf16 v[132:135], v[108:111], v[96:99], 0
    v_mfma_f32_16x16x32_bf16 v[136:139], v[108:111], v[100:103], 0
    v_mfma_f32_16x16x32_bf16 v[140:143], v[112:115], v[100:103], 0
    s_waitcnt lgkmcnt(0)
    s_add_u32 s95, s90, 28
    s_min_u32 s90, s95, 127
    s_and_b32 s53, s90, 15
    s_mul_i32 s53, s53, 7
    s_lshr_b32 s53, s53, 1
    s_lshl_b32 s53, s53, 15
    s_lshr_b32 s54, s90, 4
    s_lshl_b32 s56, s45, 3
    s_add_u32 s54, s54, s56
    s_lshl_b32 s54, s54, 9
    s_add_u32 s91, s53, s54
    s_add_u32 s91, s91, 6291456
    s_cmp_eq_u32 s54, 0
    s_cselect_b32 s56, 0, 256
    s_add_u32 s92, s91, 1835008
    s_sub_u32 s93, s92, s56
    buffer_load_dwordx4 v[96:99], v19, s[24:27], s91 offen offset:0 sc1
    buffer_load_dwordx4 v[100:103], v19, s[24:27], s91 offen offset:256 sc1
    buffer_load_dwordx4 v[104:107], v19, s[24:27], s93 offen sc1
    buffer_load_dwordx4 v[108:111], v19, s[24:27], s92 offen offset:0 sc1
    buffer_load_dwordx4 v[112:115], v19, s[24:27], s92 offen offset:256 sc1
    s_add_u32 s92, s92, 1835008
    s_add_u32 s93, s93, 1835008
    buffer_load_dwordx4 v[116:119], v19, s[24:27], s93 offen sc1
    buffer_load_dwordx4 v[120:123], v19, s[24:27], s92 offen offset:0 sc1
    buffer_load_dwordx4 v[124:127], v19, s[24:27], s92 offen offset:256 sc1
    s_mov_b32 s53, 0x3e8b97f6
    v_mov_b32 v23, 0xf149f2ca
    v_cndmask_b32 v188, v128, v129, s[76:77]
    v_cndmask_b32 v189, v130, v131, s[76:77]
    v_cndmask_b32 v190, v132, v133, s[76:77]
    v_cndmask_b32 v191, v134, v135, s[76:77]
    v_cndmask_b32 v188, v188, v190, s[78:79]
    v_cndmask_b32 v189, v189, v191, s[80:81]
    v_cndmask_b32 v196, v136, v137, s[76:77]
    v_cndmask_b32 v197, v138, v139, s[76:77]
    v_cndmask_b32 v198, v140, v141, s[76:77]
    v_cndmask_b32 v199, v142, v143, s[76:77]
    v_cndmask_b32 v196, v196, v198, s[78:79]
    v_cndmask_b32 v197, v197, v199, s[80:81]
    v_cndmask_b32 v188, v188, v23, s[86:87]
    v_cndmask_b32 v189, v189, v23, s[88:89]
    v_max_f32 v190, v188, v189
    v_max_f32 v198, v196, v197
    v_mov_b32 v191, v190
    v_mov_b32 v199, v198
    s_nop 0
    v_permlane16_swap_b32 v190, v191
    v_permlane16_swap_b32 v198, v199
    v_max_f32 v190, v190, v191
    v_max_f32 v198, v198, v199
    v_mov_b32 v191, v190
    v_mov_b32 v199, v198
    s_nop 0
    v_permlane32_swap_b32 v190, v191
    v_permlane32_swap_b32 v198, v199
    v_max_f32 v190, v190, v191
    v_max_f32 v198, v198, v199
    v_sub_f32 v188, v188, v190
    v_sub_f32 v189, v189, v190
    v_sub_f32 v196, v196, v198
    v_sub_f32 v197, v197, v198
    v_mul_f32 v188, s53, v188
    v_mul_f32 v189, s53, v189
    v_mul_f32 v196, s53, v196
    v_mul_f32 v197, s53, v197
    v_exp_f32 v188, v188
    v_exp_f32 v189, v189
    v_exp_f32 v196, v196
    v_exp_f32 v197, v197
    v_add_f32 v190, v188, v189
    v_add_f32 v198, v196, v197
    v_mov_b32 v191, v190
    v_mov_b32 v199, v198
    s_nop 0
    v_permlane16_swap_b32 v190, v191
    v_permlane16_swap_b32 v198, v199
    v_add_f32 v190, v190, v191
    v_add_f32 v198, v198, v199
    v_mov_b32 v191, v190
    v_mov_b32 v199, v198
    s_nop 0
    v_permlane32_swap_b32 v190, v191
    v_permlane32_swap_b32 v198, v199
    v_add_f32 v190, v190, v191
    v_add_f32 v198, v198, v199
    v_rcp_f32 v190, v190
    v_rcp_f32 v198, v198
    v_mul_f32 v188, v188, v190
    v_mul_f32 v189, v189, v190
    v_mul_f32 v196, v196, v198
    v_mul_f32 v197, v197, v198
    v_cvt_pk_bf16_f32 v188, v188, v188
    v_cvt_pk_bf16_f32 v189, v189, v189
    v_cvt_pk_bf16_f32 v196, v196, v196
    v_cvt_pk_bf16_f32 v197, v197, v197
    v_and_b32 v156, v188, v24
    v_and_b32 v157, v189, v25
    v_and_b32 v158, v188, v26
    v_and_b32 v159, v189, v27
    v_and_b32 v160, v196, v24
    v_and_b32 v161, v197, v25
    v_and_b32 v162, v196, v26
    v_and_b32 v163, v197, v27
    v_mfma_f32_16x16x32_bf16 v[164:167], v[144:147], v[156:159], 0
    v_mfma_f32_16x16x32_bf16 v[168:171], v[150:153], v[156:159], 0
    v_mfma_f32_16x16x32_bf16 v[172:175], v[146:149], v[160:163], 0
    v_mfma_f32_16x16x32_bf16 v[176:179], v[152:155], v[160:163], 0
    s_nop 4
    v_cvt_pk_bf16_f32 v180, v164, v165
    v_cvt_pk_bf16_f32 v181, v166, v167
    v_cvt_pk_bf16_f32 v182, v168, v169
    v_cvt_pk_bf16_f32 v183, v170, v171
    v_cndmask_b32 v180, v180, 0, s[82:83]
    v_cndmask_b32 v181, v181, 0, s[82:83]
    v_cndmask_b32 v182, v182, 0, s[84:85]
    v_cndmask_b32 v183, v183, 0, s[84:85]
    buffer_store_dwordx4 v[180:183], v20, s[24:27], s94 offen offset:0 sc1
    v_cvt_pk_bf16_f32 v184, v172, v173
    v_cvt_pk_bf16_f32 v185, v174, v175
    v_cvt_pk_bf16_f32 v186, v176, v177
    v_cvt_pk_bf16_f32 v187, v178, v179
    v_cndmask_b32 v184, v184, 0, s[82:83]
    v_cndmask_b32 v185, v185, 0, s[82:83]
    v_cndmask_b32 v186, v186, 0, s[84:85]
    v_cndmask_b32 v187, v187, 0, s[84:85]
    buffer_store_dwordx4 v[184:187], v20, s[24:27], s94 offen offset:256 sc1
    s_cmp_lt_u32 s95, 128
    s_cbranch_scc1 L_attn_loop
    s_waitcnt vmcnt(0) lgkmcnt(0)
    s_barrier
    s_lshl_b32 s53, s45, 3
    s_add_u32 s53, s53, s46
    s_sub_u32 s53, s53, 25
    s_lshl_b32 s53, s53, 7
    s_add_u32 s53, s53, 12779520
    s_cmp_lg_u32 s44, 0
    s_cbranch_scc1 L_nopub16
    v_mov_b32 v29, 0
    v_mov_b32 v30, s47
    s_mov_b64 exec, 1
    buffer_store_dword v30, v29, s[24:27], s53 offen sc1
    s_mov_b64 exec, -1
L_nopub16:
    s_cmp_lt_u32 s46, 28
    s_cbranch_scc1 L_p3
L_end:
    s_endpgm
.section .rodata,"a"
.p2align 6
.amdhsa_kernel parallel_sum__sliding_local_dilated__mixer_token_mlp__prompt_kernel
  .amdhsa_next_free_vgpr 512
  .amdhsa_next_free_sgpr 102
  .amdhsa_accum_offset 256
  .amdhsa_group_segment_fixed_size 0
  .amdhsa_kernarg_size 88
  .amdhsa_user_sgpr_count 2
  .amdhsa_user_sgpr_kernarg_segment_ptr 1
  .amdhsa_system_sgpr_workgroup_id_x 1
  .amdhsa_float_denorm_mode_32 3
.end_amdhsa_kernel
```

```asm
; @launch grid=(256,1,1) block=(256,1,1) lds=163840
.amdgcn_target "amdgcn-amd-amdhsa--gfx950"
.text
.globl parallel_sum__sliding_local_dilated__mixer_token_mlp__prompt_kernel
.p2align 8
.type parallel_sum__sliding_local_dilated__mixer_token_mlp__prompt_kernel,@function
parallel_sum__sliding_local_dilated__mixer_token_mlp__prompt_kernel:
    s_cmp_ge_u32 s2, 256
    s_cbranch_scc1 L_end
    s_load_dwordx2 s[4:5], s[0:1], 0
    s_load_dwordx2 s[8:9], s[0:1], 8
    s_load_dwordx2 s[24:25], s[0:1], 80
    s_load_dwordx2 s[40:41], s[0:1], 72
    s_load_dwordx2 s[16:17], s[0:1], 32
    s_load_dwordx2 s[20:21], s[0:1], 48
    s_load_dwordx2 s[12:13], s[0:1], 16
    s_load_dwordx2 s[28:29], s[0:1], 64
    s_load_dwordx2 s[32:33], s[0:1], 40
    s_load_dwordx2 s[36:37], s[0:1], 56
    v_lshrrev_b32 v17, 6, v0
    v_and_b32 v1, 63, v0
    s_and_b32 s45, s2, 7
    s_lshr_b32 s46, s2, 3
    v_readfirstlane_b32 s44, v17
    s_mov_b32 s6, 1835008
    s_mov_b32 s7, 0x20000
    s_mov_b32 s10, 1204224
    s_mov_b32 s11, 0x20000
    s_mov_b32 s26, 16777216
    s_mov_b32 s27, 0x20000
    s_mov_b32 s42, 256
    s_mov_b32 s43, 0x20000
    s_mov_b32 s18, 7340032
    s_mov_b32 s19, 0x20000
    s_mov_b32 s22, 7340032
    s_mov_b32 s23, 0x20000
    s_mov_b32 s14, 401408
    s_mov_b32 s15, 0x20000
    s_mov_b32 s30, 1835008
    s_mov_b32 s31, 0x20000
    s_mov_b32 s34, 3584
    s_mov_b32 s35, 0x20000
    s_mov_b32 s38, 4096
    s_mov_b32 s39, 0x20000
    s_mul_i32 s53, s46, 37
    s_lshr_b32 s53, s53, 8
    s_mul_i32 s54, s53, 7
    s_sub_u32 s49, s46, s54
    s_lshl_b32 s48, s45, 2
    s_add_u32 s48, s48, s53
    s_lshl_b32 s52, s44, 11
    v_lshlrev_b32 v14, 4, v1
    s_waitcnt lgkmcnt(0)
    s_or_b32 s53, s2, s44
    s_cmp_lg_u32 s53, 0
    s_cbranch_scc1 L_nononce
    s_memrealtime s[98:99]
    s_waitcnt lgkmcnt(0)
    s_or_b32 s98, s98, 1
    v_mov_b32 v17, 0
    v_mov_b32 v18, s98
    s_mov_b64 exec, 1
    buffer_store_dword v18, v17, s[40:43], 0 offen sc1
    s_mov_b64 exec, -1
L_nononce:
    s_cmp_ge_u32 s46, 28
    s_cbranch_scc1 L_helper
    v_lshrrev_b32 v29, 2, v0
    v_mul_u32_u24 v17, 896, v29
    v_and_b32 v30, 3, v0
    v_lshl_add_u32 v17, v30, 4, v17
    s_mul_i32 s53, s48, 57344
    s_lshl_b32 s54, s48, 1
    s_add_u32 s54, s54, s49
    s_mul_i32 s56, s54, 37
    s_lshr_b32 s56, s56, 8
    s_mul_i32 s56, s56, 7
    s_sub_u32 s54, s54, s56
    s_mov_b32 s3, s54
    s_lshl_b32 s60, s54, 7
    s_add_u32 s60, s60, s53
    s_mul_i32 s67, s54, 172032
    s_add_u32 s54, s54, 1
    s_cmp_eq_u32 s54, 7
    s_cselect_b32 s54, 0, s54
    s_lshl_b32 s61, s54, 7
    s_add_u32 s61, s61, s53
    s_mul_i32 s68, s54, 172032
    s_add_u32 s54, s54, 1
    s_cmp_eq_u32 s54, 7
    s_cselect_b32 s54, 0, s54
    s_lshl_b32 s62, s54, 7
    s_add_u32 s62, s62, s53
    s_mul_i32 s69, s54, 172032
    s_add_u32 s54, s54, 1
    s_cmp_eq_u32 s54, 7
    s_cselect_b32 s54, 0, s54
    s_lshl_b32 s63, s54, 7
    s_add_u32 s63, s63, s53
    s_mul_i32 s70, s54, 172032
    s_add_u32 s54, s54, 1
    s_cmp_eq_u32 s54, 7
    s_cselect_b32 s54, 0, s54
    s_lshl_b32 s64, s54, 7
    s_add_u32 s64, s64, s53
    s_mul_i32 s71, s54, 172032
    s_add_u32 s54, s54, 1
    s_cmp_eq_u32 s54, 7
    s_cselect_b32 s54, 0, s54
    s_lshl_b32 s65, s54, 7
    s_add_u32 s65, s65, s53
    s_mul_i32 s72, s54, 172032
    s_add_u32 s54, s54, 1
    s_cmp_eq_u32 s54, 7
    s_cselect_b32 s54, 0, s54
    s_lshl_b32 s66, s54, 7
    s_add_u32 s66, s66, s53
    s_mul_i32 s73, s54, 172032
    buffer_load_dwordx4 v[32:35], v17, s[4:7], s60 offen offset:0 nt
    buffer_load_dwordx4 v[36:39], v17, s[4:7], s60 offen offset:64 nt
    buffer_load_dwordx4 v[40:43], v17, s[4:7], s61 offen offset:0 nt
    buffer_load_dwordx4 v[44:47], v17, s[4:7], s61 offen offset:64 nt
    buffer_load_dwordx4 v[48:51], v17, s[4:7], s62 offen offset:0 nt
    buffer_load_dwordx4 v[52:55], v17, s[4:7], s62 offen offset:64 nt
    buffer_load_dwordx4 v[56:59], v17, s[4:7], s63 offen offset:0 nt
    buffer_load_dwordx4 v[60:63], v17, s[4:7], s63 offen offset:64 nt
    buffer_load_dwordx4 v[64:67], v17, s[4:7], s64 offen offset:0 nt
    buffer_load_dwordx4 v[68:71], v17, s[4:7], s64 offen offset:64 nt
    buffer_load_dwordx4 v[72:75], v17, s[4:7], s65 offen offset:0 nt
    buffer_load_dwordx4 v[76:79], v17, s[4:7], s65 offen offset:64 nt
    buffer_load_dwordx4 v[80:83], v17, s[4:7], s66 offen offset:0 nt
    buffer_load_dwordx4 v[84:87], v17, s[4:7], s66 offen offset:64 nt
    v_lshrrev_b32 v210, 5, v1
    v_bfe_u32 v211, v1, 2, 2
    v_lshl_add_u32 v208, v210, 2, v211
    v_bfe_u32 v212, v1, 4, 1
    v_lshlrev_b32 v209, 4, v30
    v_lshl_add_u32 v209, v212, 6, v209
    s_mul_i32 s53, s44, 43008
    s_mul_i32 s54, s49, 384
    s_add_u32 s53, s53, s54
    v_mul_u32_u24 v18, 2688, v208
    v_add3_u32 v18, v18, v209, s53
    v_add_u32 v19, 128, v18
    v_add_u32 v20, 256, v18
    v_add_u32 v21, 21504, v18
    v_add_u32 v22, 21632, v18
    v_add_u32 v23, 21760, v18
    s_mul_i32 s55, s44, 6144
    s_add_u32 m0, s55, 65536
    s_nop 0
    buffer_load_dwordx4 v18, s[8:11], s67 offen lds
    s_add_u32 m0, s55, 66560
    s_nop 0
    buffer_load_dwordx4 v19, s[8:11], s67 offen lds
    s_add_u32 m0, s55, 67584
    s_nop 0
    buffer_load_dwordx4 v20, s[8:11], s67 offen lds
    s_add_u32 m0, s55, 68608
    s_nop 0
    buffer_load_dwordx4 v21, s[8:11], s67 offen lds
    s_add_u32 m0, s55, 69632
    s_nop 0
    buffer_load_dwordx4 v22, s[8:11], s67 offen lds
    s_add_u32 m0, s55, 70656
    s_nop 0
    buffer_load_dwordx4 v23, s[8:11], s67 offen lds
    s_add_u32 m0, s55, 90112
    s_nop 0
    buffer_load_dwordx4 v18, s[8:11], s68 offen lds
    s_add_u32 m0, s55, 91136
    s_nop 0
    buffer_load_dwordx4 v19, s[8:11], s68 offen lds
    s_add_u32 m0, s55, 92160
    s_nop 0
    buffer_load_dwordx4 v20, s[8:11], s68 offen lds
    s_add_u32 m0, s55, 93184
    s_nop 0
    buffer_load_dwordx4 v21, s[8:11], s68 offen lds
    s_add_u32 m0, s55, 94208
    s_nop 0
    buffer_load_dwordx4 v22, s[8:11], s68 offen lds
    s_add_u32 m0, s55, 95232
    s_nop 0
    buffer_load_dwordx4 v23, s[8:11], s68 offen lds
    s_add_u32 m0, s55, 114688
    s_nop 0
    buffer_load_dwordx4 v18, s[8:11], s69 offen lds
    s_add_u32 m0, s55, 115712
    s_nop 0
    buffer_load_dwordx4 v19, s[8:11], s69 offen lds
    s_add_u32 m0, s55, 116736
    s_nop 0
    buffer_load_dwordx4 v20, s[8:11], s69 offen lds
    s_add_u32 m0, s55, 117760
    s_nop 0
    buffer_load_dwordx4 v21, s[8:11], s69 offen lds
    s_add_u32 m0, s55, 118784
    s_nop 0
    buffer_load_dwordx4 v22, s[8:11], s69 offen lds
    s_add_u32 m0, s55, 119808
    s_nop 0
    buffer_load_dwordx4 v23, s[8:11], s69 offen lds
    s_add_u32 m0, s55, 139264
    s_nop 0
    buffer_load_dwordx4 v18, s[8:11], s70 offen lds
    s_add_u32 m0, s55, 140288
    s_nop 0
    buffer_load_dwordx4 v19, s[8:11], s70 offen lds
    s_add_u32 m0, s55, 141312
    s_nop 0
    buffer_load_dwordx4 v20, s[8:11], s70 offen lds
    s_add_u32 m0, s55, 142336
    s_nop 0
    buffer_load_dwordx4 v21, s[8:11], s70 offen lds
    s_add_u32 m0, s55, 143360
    s_nop 0
    buffer_load_dwordx4 v22, s[8:11], s70 offen lds
    s_add_u32 m0, s55, 144384
    s_nop 0
    buffer_load_dwordx4 v23, s[8:11], s70 offen lds
    v_mul_u32_u24 v24, 1056, v30
    v_lshl_add_u32 v24, v29, 4, v24
    v_lshlrev_b32 v213, 6, v211
    v_lshl_add_u32 v213, v212, 5, v213
    v_lshl_add_u32 v213, v30, 3, v213
    s_and_b32 s53, s44, 1
    s_lshl_b32 s53, s53, 9
    v_and_b32 v214, 31, v1
    v_mul_u32_u24 v25, 1056, v210
    v_lshl_add_u32 v25, v214, 4, v25
    v_add_u32 v25, s53, v25
    s_lshr_b32 s53, s44, 1
    s_lshl_b32 s53, s53, 8
    s_add_u32 s53, s53, 65536
    v_mul_u32_u24 v26, 3072, v210
    v_add3_u32 v26, v26, v213, s53
    v_add_u32 v27, 49152, v26
    v_bfe_u32 v215, v1, 1, 1
    v_lshl_add_u32 v215, v212, 1, v215
    v_mul_u32_u24 v28, 1056, v215
    v_lshl_add_u32 v215, v210, 3, v211
    v_lshl_add_u32 v28, v215, 4, v28
    v_and_b32 v215, 1, v1
    v_lshl_add_u32 v28, v215, 3, v28
    s_lshl_b32 s53, s44, 8
    v_add_u32 v28, s53, v28
    v_lshl_add_u32 v2, v210, 10, v213
    v_add_u32 v2, s52, v2
    v_add_u32 v3, 65536, v2
    v_add_u32 v4, 131072, v2
    v_lshl_add_u32 v5, v210, 9, v213
    v_add_u32 v5, s52, v5
    v_add_u32 v6, 65536, v5
    v_add_u32 v7, 131072, v5
    s_lshr_b32 s53, s45, 1
    s_mul_i32 s53, s53, 49
    s_and_b32 s54, s45, 1
    s_mul_i32 s56, s54, 25
    s_add_u32 s53, s53, s56
    s_add_u32 s53, s53, s46
    s_add_u32 s54, s54, s46
    s_cmp_lt_u32 s54, 25
    s_cselect_b32 s75, 1, 0
    s_min_u32 s53, s53, 195
    s_mul_i32 s50, s53, 9363
    s_lshr_b32 s50, s50, 16
    s_mul_i32 s54, s50, 7
    s_sub_u32 s51, s53, s54
    s_mul_i32 s53, s44, 1835008
    s_lshl_b32 s54, s50, 7
    s_add_u32 s53, s53, s54
    s_lshr_b32 s54, s44, 1
    s_lshl_b32 s54, s54, 6
    v_xor_b32 v215, s54, v209
    v_mul_u32_u24 v8, 3584, v208
    v_add3_u32 v8, v8, v215, s53
    v_add_u32 v9, 27648, v8
    s_mul_i32 s53, s44, 1835008
    s_lshl_b32 s54, s48, 7
    s_add_u32 s53, s53, s54
    v_lshlrev_b32 v10, 12, v208
    v_add3_u32 v10, v10, v209, s53
    v_add_u32 v11, 31744, v10
    s_mul_i32 s53, s44, 100352
    s_lshl_b32 s54, s49, 7
    s_add_u32 s53, s53, s54
    v_mul_u32_u24 v12, 896, v208
    v_add3_u32 v12, v12, v209, s53
    v_add_u32 v13, 6144, v12
    s_and_b32 s53, s44, 1
    s_lshl_b32 s53, s53, 10
    v_add_u32 v15, s53, v14
    v_xor_b32 v16, 1024, v15
    s_mov_b32 s74, 0x3f803f80
    v_mov_b32 v216, 0
    v_mov_b32 v217, 0
    s_waitcnt vmcnt(37)
    v_dot2c_f32_bf16 v216, s74, v32
    v_dot2c_f32_bf16 v217, v32, v32
    v_lshlrev_b32 v96, 16, v32
    v_and_b32 v97, 0xffff0000, v32
    v_dot2c_f32_bf16 v216, s74, v33
    v_dot2c_f32_bf16 v217, v33, v33
    v_lshlrev_b32 v98, 16, v33
    v_and_b32 v99, 0xffff0000, v33
    v_dot2c_f32_bf16 v216, s74, v34
    v_dot2c_f32_bf16 v217, v34, v34
    v_lshlrev_b32 v100, 16, v34
    v_and_b32 v101, 0xffff0000, v34
    v_dot2c_f32_bf16 v216, s74, v35
    v_dot2c_f32_bf16 v217, v35, v35
    v_lshlrev_b32 v102, 16, v35
    v_and_b32 v103, 0xffff0000, v35
    s_waitcnt vmcnt(36)
    v_dot2c_f32_bf16 v216, s74, v36
    v_dot2c_f32_bf16 v217, v36, v36
    v_lshlrev_b32 v104, 16, v36
    v_and_b32 v105, 0xffff0000, v36
    v_dot2c_f32_bf16 v216, s74, v37
    v_dot2c_f32_bf16 v217, v37, v37
    v_lshlrev_b32 v106, 16, v37
    v_and_b32 v107, 0xffff0000, v37
    v_dot2c_f32_bf16 v216, s74, v38
    v_dot2c_f32_bf16 v217, v38, v38
    v_lshlrev_b32 v108, 16, v38
    v_and_b32 v109, 0xffff0000, v38
    v_dot2c_f32_bf16 v216, s74, v39
    v_dot2c_f32_bf16 v217, v39, v39
    v_lshlrev_b32 v110, 16, v39
    v_and_b32 v111, 0xffff0000, v39
    s_waitcnt vmcnt(35)
    v_dot2c_f32_bf16 v216, s74, v40
    v_dot2c_f32_bf16 v217, v40, v40
    v_lshlrev_b32 v112, 16, v40
    v_and_b32 v113, 0xffff0000, v40
    v_dot2c_f32_bf16 v216, s74, v41
    v_dot2c_f32_bf16 v217, v41, v41
    v_lshlrev_b32 v114, 16, v41
    v_and_b32 v115, 0xffff0000, v41
    v_dot2c_f32_bf16 v216, s74, v42
    v_dot2c_f32_bf16 v217, v42, v42
    v_lshlrev_b32 v116, 16, v42
    v_and_b32 v117, 0xffff0000, v42
    v_dot2c_f32_bf16 v216, s74, v43
    v_dot2c_f32_bf16 v217, v43, v43
    v_lshlrev_b32 v118, 16, v43
    v_and_b32 v119, 0xffff0000, v43
    s_waitcnt vmcnt(34)
    v_dot2c_f32_bf16 v216, s74, v44
    v_dot2c_f32_bf16 v217, v44, v44
    v_lshlrev_b32 v120, 16, v44
    v_and_b32 v121, 0xffff0000, v44
    v_dot2c_f32_bf16 v216, s74, v45
    v_dot2c_f32_bf16 v217, v45, v45
    v_lshlrev_b32 v122, 16, v45
    v_and_b32 v123, 0xffff0000, v45
    v_dot2c_f32_bf16 v216, s74, v46
    v_dot2c_f32_bf16 v217, v46, v46
    v_lshlrev_b32 v124, 16, v46
    v_and_b32 v125, 0xffff0000, v46
    v_dot2c_f32_bf16 v216, s74, v47
    v_dot2c_f32_bf16 v217, v47, v47
    v_lshlrev_b32 v126, 16, v47
    v_and_b32 v127, 0xffff0000, v47
    s_waitcnt vmcnt(33)
    v_dot2c_f32_bf16 v216, s74, v48
    v_dot2c_f32_bf16 v217, v48, v48
    v_lshlrev_b32 v128, 16, v48
    v_and_b32 v129, 0xffff0000, v48
    v_dot2c_f32_bf16 v216, s74, v49
    v_dot2c_f32_bf16 v217, v49, v49
    v_lshlrev_b32 v130, 16, v49
    v_and_b32 v131, 0xffff0000, v49
    v_dot2c_f32_bf16 v216, s74, v50
    v_dot2c_f32_bf16 v217, v50, v50
    v_lshlrev_b32 v132, 16, v50
    v_and_b32 v133, 0xffff0000, v50
    v_dot2c_f32_bf16 v216, s74, v51
    v_dot2c_f32_bf16 v217, v51, v51
    v_lshlrev_b32 v134, 16, v51
    v_and_b32 v135, 0xffff0000, v51
    s_waitcnt vmcnt(32)
    v_dot2c_f32_bf16 v216, s74, v52
    v_dot2c_f32_bf16 v217, v52, v52
    v_lshlrev_b32 v136, 16, v52
    v_and_b32 v137, 0xffff0000, v52
    v_dot2c_f32_bf16 v216, s74, v53
    v_dot2c_f32_bf16 v217, v53, v53
    v_lshlrev_b32 v138, 16, v53
    v_and_b32 v139, 0xffff0000, v53
    v_dot2c_f32_bf16 v216, s74, v54
    v_dot2c_f32_bf16 v217, v54, v54
    v_lshlrev_b32 v140, 16, v54
    v_and_b32 v141, 0xffff0000, v54
    v_dot2c_f32_bf16 v216, s74, v55
    v_dot2c_f32_bf16 v217, v55, v55
    v_lshlrev_b32 v142, 16, v55
    v_and_b32 v143, 0xffff0000, v55
    s_waitcnt vmcnt(31)
    v_dot2c_f32_bf16 v216, s74, v56
    v_dot2c_f32_bf16 v217, v56, v56
    v_lshlrev_b32 v144, 16, v56
    v_and_b32 v145, 0xffff0000, v56
    v_dot2c_f32_bf16 v216, s74, v57
    v_dot2c_f32_bf16 v217, v57, v57
    v_lshlrev_b32 v146, 16, v57
    v_and_b32 v147, 0xffff0000, v57
    v_dot2c_f32_bf16 v216, s74, v58
    v_dot2c_f32_bf16 v217, v58, v58
    v_lshlrev_b32 v148, 16, v58
    v_and_b32 v149, 0xffff0000, v58
    v_dot2c_f32_bf16 v216, s74, v59
    v_dot2c_f32_bf16 v217, v59, v59
    v_lshlrev_b32 v150, 16, v59
    v_and_b32 v151, 0xffff0000, v59
    s_waitcnt vmcnt(30)
    v_dot2c_f32_bf16 v216, s74, v60
    v_dot2c_f32_bf16 v217, v60, v60
    v_lshlrev_b32 v152, 16, v60
    v_and_b32 v153, 0xffff0000, v60
    v_dot2c_f32_bf16 v216, s74, v61
    v_dot2c_f32_bf16 v217, v61, v61
    v_lshlrev_b32 v154, 16, v61
    v_and_b32 v155, 0xffff0000, v61
    v_dot2c_f32_bf16 v216, s74, v62
    v_dot2c_f32_bf16 v217, v62, v62
    v_lshlrev_b32 v156, 16, v62
    v_and_b32 v157, 0xffff0000, v62
    v_dot2c_f32_bf16 v216, s74, v63
    v_dot2c_f32_bf16 v217, v63, v63
    v_lshlrev_b32 v158, 16, v63
    v_and_b32 v159, 0xffff0000, v63
    s_waitcnt vmcnt(29)
    v_dot2c_f32_bf16 v216, s74, v64
    v_dot2c_f32_bf16 v217, v64, v64
    v_lshlrev_b32 v160, 16, v64
    v_and_b32 v161, 0xffff0000, v64
    v_dot2c_f32_bf16 v216, s74, v65
    v_dot2c_f32_bf16 v217, v65, v65
    v_lshlrev_b32 v162, 16, v65
    v_and_b32 v163, 0xffff0000, v65
    v_dot2c_f32_bf16 v216, s74, v66
    v_dot2c_f32_bf16 v217, v66, v66
    v_lshlrev_b32 v164, 16, v66
    v_and_b32 v165, 0xffff0000, v66
    v_dot2c_f32_bf16 v216, s74, v67
    v_dot2c_f32_bf16 v217, v67, v67
    v_lshlrev_b32 v166, 16, v67
    v_and_b32 v167, 0xffff0000, v67
    s_waitcnt vmcnt(28)
    v_dot2c_f32_bf16 v216, s74, v68
    v_dot2c_f32_bf16 v217, v68, v68
    v_lshlrev_b32 v168, 16, v68
    v_and_b32 v169, 0xffff0000, v68
    v_dot2c_f32_bf16 v216, s74, v69
    v_dot2c_f32_bf16 v217, v69, v69
    v_lshlrev_b32 v170, 16, v69
    v_and_b32 v171, 0xffff0000, v69
    v_dot2c_f32_bf16 v216, s74, v70
    v_dot2c_f32_bf16 v217, v70, v70
    v_lshlrev_b32 v172, 16, v70
    v_and_b32 v173, 0xffff0000, v70
    v_dot2c_f32_bf16 v216, s74, v71
    v_dot2c_f32_bf16 v217, v71, v71
    v_lshlrev_b32 v174, 16, v71
    v_and_b32 v175, 0xffff0000, v71
    s_waitcnt vmcnt(27)
    v_dot2c_f32_bf16 v216, s74, v72
    v_dot2c_f32_bf16 v217, v72, v72
    v_lshlrev_b32 v176, 16, v72
    v_and_b32 v177, 0xffff0000, v72
    v_dot2c_f32_bf16 v216, s74, v73
    v_dot2c_f32_bf16 v217, v73, v73
    v_lshlrev_b32 v178, 16, v73
    v_and_b32 v179, 0xffff0000, v73
    v_dot2c_f32_bf16 v216, s74, v74
    v_dot2c_f32_bf16 v217, v74, v74
    v_lshlrev_b32 v180, 16, v74
    v_and_b32 v181, 0xffff0000, v74
    v_dot2c_f32_bf16 v216, s74, v75
    v_dot2c_f32_bf16 v217, v75, v75
    v_lshlrev_b32 v182, 16, v75
    v_and_b32 v183, 0xffff0000, v75
    s_waitcnt vmcnt(26)
    v_dot2c_f32_bf16 v216, s74, v76
    v_dot2c_f32_bf16 v217, v76, v76
    v_lshlrev_b32 v184, 16, v76
    v_and_b32 v185, 0xffff0000, v76
    v_dot2c_f32_bf16 v216, s74, v77
    v_dot2c_f32_bf16 v217, v77, v77
    v_lshlrev_b32 v186, 16, v77
    v_and_b32 v187, 0xffff0000, v77
    v_dot2c_f32_bf16 v216, s74, v78
    v_dot2c_f32_bf16 v217, v78, v78
    v_lshlrev_b32 v188, 16, v78
    v_and_b32 v189, 0xffff0000, v78
    v_dot2c_f32_bf16 v216, s74, v79
    v_dot2c_f32_bf16 v217, v79, v79
    v_lshlrev_b32 v190, 16, v79
    v_and_b32 v191, 0xffff0000, v79
    s_waitcnt vmcnt(25)
    v_dot2c_f32_bf16 v216, s74, v80
    v_dot2c_f32_bf16 v217, v80, v80
    v_lshlrev_b32 v192, 16, v80
    v_and_b32 v193, 0xffff0000, v80
    v_dot2c_f32_bf16 v216, s74, v81
    v_dot2c_f32_bf16 v217, v81, v81
    v_lshlrev_b32 v194, 16, v81
    v_and_b32 v195, 0xffff0000, v81
    v_dot2c_f32_bf16 v216, s74, v82
    v_dot2c_f32_bf16 v217, v82, v82
    v_lshlrev_b32 v196, 16, v82
    v_and_b32 v197, 0xffff0000, v82
    v_dot2c_f32_bf16 v216, s74, v83
    v_dot2c_f32_bf16 v217, v83, v83
    v_lshlrev_b32 v198, 16, v83
    v_and_b32 v199, 0xffff0000, v83
    s_waitcnt vmcnt(24)
    v_dot2c_f32_bf16 v216, s74, v84
    v_dot2c_f32_bf16 v217, v84, v84
    v_lshlrev_b32 v200, 16, v84
    v_and_b32 v201, 0xffff0000, v84
    v_dot2c_f32_bf16 v216, s74, v85
    v_dot2c_f32_bf16 v217, v85, v85
    v_lshlrev_b32 v202, 16, v85
    v_and_b32 v203, 0xffff0000, v85
    v_dot2c_f32_bf16 v216, s74, v86
    v_dot2c_f32_bf16 v217, v86, v86
    v_lshlrev_b32 v204, 16, v86
    v_and_b32 v205, 0xffff0000, v86
    v_dot2c_f32_bf16 v216, s74, v87
    v_dot2c_f32_bf16 v217, v87, v87
    v_lshlrev_b32 v206, 16, v87
    v_and_b32 v207, 0xffff0000, v87
    v_mov_b32 v29, 0
    buffer_load_dword v29, v29, s[40:43], 0 offen sc1
    v_add_f32_dpp v216, v216, v216 quad_perm:[1,0,3,2] row_mask:0xf bank_mask:0xf
    v_add_f32_dpp v217, v217, v217 quad_perm:[1,0,3,2] row_mask:0xf bank_mask:0xf
    s_nop 0
    v_add_f32_dpp v216, v216, v216 quad_perm:[2,3,0,1] row_mask:0xf bank_mask:0xf
    v_add_f32_dpp v217, v217, v217 quad_perm:[2,3,0,1] row_mask:0xf bank_mask:0xf
    v_mul_f32 v218, 0x3b124925, v216
    v_mul_f32 v219, 0x3b124925, v217
    v_fma_f32 v219, -v218, v218, v219
    v_max_f32 v219, 0, v219
    v_cvt_pk_bf16_f32 v220, v219, v219
    v_and_b32 v220, 0xffff0000, v220
    v_add_f32 v220, 0x3727c5ac, v220
    v_cvt_pk_bf16_f32 v220, v220, v220
    v_and_b32 v220, 0xffff0000, v220
    v_sqrt_f32 v220, v220
    s_nop 0
    v_cvt_pk_bf16_f32 v220, v220, v220
    v_and_b32 v220, 0xffff0000, v220
    v_rcp_f32 v220, v220
    s_nop 0
    v_mul_f32 v219, v219, v220
    v_mul_f32 v219, v219, v220
    v_cvt_pk_bf16_f32 v224, v219, v219
    v_and_b32 v224, 0xffff0000, v224
    v_add_f32 v224, 0x3727c5ac, v224
    v_cvt_pk_bf16_f32 v224, v224, v224
    v_and_b32 v224, 0xffff0000, v224
    v_sqrt_f32 v224, v224
    s_nop 0
    v_cvt_pk_bf16_f32 v224, v224, v224
    v_and_b32 v224, 0xffff0000, v224
    v_rcp_f32 v224, v224
    s_nop 0
    v_mul_f32 v224, v224, v220
    v_mul_f32 v222, v218, v220
    v_mul_f32 v226, v218, v224
    v_pk_fma_f32 v[228:229], v[96:97], v[224:225], v[226:227] op_sel_hi:[1,0,0] neg_lo:[0,0,1] neg_hi:[0,0,1]
    v_pk_fma_f32 v[230:231], v[98:99], v[224:225], v[226:227] op_sel_hi:[1,0,0] neg_lo:[0,0,1] neg_hi:[0,0,1]
    v_pk_fma_f32 v[232:233], v[100:101], v[224:225], v[226:227] op_sel_hi:[1,0,0] neg_lo:[0,0,1] neg_hi:[0,0,1]
    v_pk_fma_f32 v[234:235], v[102:103], v[224:225], v[226:227] op_sel_hi:[1,0,0] neg_lo:[0,0,1] neg_hi:[0,0,1]
    v_pk_fma_f32 v[236:237], v[104:105], v[224:225], v[226:227] op_sel_hi:[1,0,0] neg_lo:[0,0,1] neg_hi:[0,0,1]
    v_pk_fma_f32 v[238:239], v[106:107], v[224:225], v[226:227] op_sel_hi:[1,0,0] neg_lo:[0,0,1] neg_hi:[0,0,1]
    v_pk_fma_f32 v[240:241], v[108:109], v[224:225], v[226:227] op_sel_hi:[1,0,0] neg_lo:[0,0,1] neg_hi:[0,0,1]
    v_pk_fma_f32 v[242:243], v[110:111], v[224:225], v[226:227] op_sel_hi:[1,0,0] neg_lo:[0,0,1] neg_hi:[0,0,1]
    v_cvt_pk_bf16_f32 v244, v228, v229
    v_cvt_pk_bf16_f32 v245, v230, v231
    v_cvt_pk_bf16_f32 v246, v232, v233
    v_cvt_pk_bf16_f32 v247, v234, v235
    v_cvt_pk_bf16_f32 v248, v236, v237
    v_cvt_pk_bf16_f32 v249, v238, v239
    v_cvt_pk_bf16_f32 v250, v240, v241
    v_cvt_pk_bf16_f32 v251, v242, v243
    ds_write_b128 v24, v[244:247]
    ds_write_b128 v24, v[248:251] offset:4224
    ds_read_b64_tr_b16 v[228:229], v28 offset:0
    ds_read_b64_tr_b16 v[230:231], v28 offset:64
    ds_read_b64_tr_b16 v[232:233], v28 offset:4224
    ds_read_b64_tr_b16 v[234:235], v28 offset:4288
    s_lshl_b32 s53, s3, 18
    s_lshl_b32 s54, s48, 13
    s_add_u32 s53, s53, s54
    s_add_u32 s53, s53, s52
    v_pk_fma_f32 v[96:97], v[96:97], v[220:221], v[222:223] op_sel_hi:[1,0,0] neg_lo:[0,0,1] neg_hi:[0,0,1]
    v_pk_fma_f32 v[98:99], v[98:99], v[220:221], v[222:223] op_sel_hi:[1,0,0] neg_lo:[0,0,1] neg_hi:[0,0,1]
    v_pk_fma_f32 v[100:101], v[100:101], v[220:221], v[222:223] op_sel_hi:[1,0,0] neg_lo:[0,0,1] neg_hi:[0,0,1]
    v_pk_fma_f32 v[102:103], v[102:103], v[220:221], v[222:223] op_sel_hi:[1,0,0] neg_lo:[0,0,1] neg_hi:[0,0,1]
    v_cvt_pk_bf16_f32 v32, v96, v97
    v_cvt_pk_bf16_f32 v33, v98, v99
    v_cvt_pk_bf16_f32 v34, v100, v101
    v_cvt_pk_bf16_f32 v35, v102, v103
    ds_write_b128 v24, v[32:35] offset:0
    s_waitcnt lgkmcnt(1)
    buffer_store_dwordx4 v[228:231], v14, s[24:27], s53 offen offset:0 sc1
    buffer_store_dwordx4 v[232:235], v14, s[24:27], s53 offen offset:1024 sc1
    v_pk_fma_f32 v[104:105], v[104:105], v[220:221], v[222:223] op_sel_hi:[1,0,0] neg_lo:[0,0,1] neg_hi:[0,0,1]
    v_pk_fma_f32 v[106:107], v[106:107], v[220:221], v[222:223] op_sel_hi:[1,0,0] neg_lo:[0,0,1] neg_hi:[0,0,1]
    v_pk_fma_f32 v[108:109], v[108:109], v[220:221], v[222:223] op_sel_hi:[1,0,0] neg_lo:[0,0,1] neg_hi:[0,0,1]
    v_pk_fma_f32 v[110:111], v[110:111], v[220:221], v[222:223] op_sel_hi:[1,0,0] neg_lo:[0,0,1] neg_hi:[0,0,1]
    v_cvt_pk_bf16_f32 v36, v104, v105
    v_cvt_pk_bf16_f32 v37, v106, v107
    v_cvt_pk_bf16_f32 v38, v108, v109
    v_cvt_pk_bf16_f32 v39, v110, v111
    ds_write_b128 v24, v[36:39] offset:4224
    v_pk_fma_f32 v[112:113], v[112:113], v[220:221], v[222:223] op_sel_hi:[1,0,0] neg_lo:[0,0,1] neg_hi:[0,0,1]
    v_pk_fma_f32 v[114:115], v[114:115], v[220:221], v[222:223] op_sel_hi:[1,0,0] neg_lo:[0,0,1] neg_hi:[0,0,1]
    v_pk_fma_f32 v[116:117], v[116:117], v[220:221], v[222:223] op_sel_hi:[1,0,0] neg_lo:[0,0,1] neg_hi:[0,0,1]
    v_pk_fma_f32 v[118:119], v[118:119], v[220:221], v[222:223] op_sel_hi:[1,0,0] neg_lo:[0,0,1] neg_hi:[0,0,1]
    v_cvt_pk_bf16_f32 v40, v112, v113
    v_cvt_pk_bf16_f32 v41, v114, v115
    v_cvt_pk_bf16_f32 v42, v116, v117
    v_cvt_pk_bf16_f32 v43, v118, v119
    ds_write_b128 v24, v[40:43] offset:8448
    v_pk_fma_f32 v[120:121], v[120:121], v[220:221], v[222:223] op_sel_hi:[1,0,0] neg_lo:[0,0,1] neg_hi:[0,0,1]
    v_pk_fma_f32 v[122:123], v[122:123], v[220:221], v[222:223] op_sel_hi:[1,0,0] neg_lo:[0,0,1] neg_hi:[0,0,1]
    v_pk_fma_f32 v[124:125], v[124:125], v[220:221], v[222:223] op_sel_hi:[1,0,0] neg_lo:[0,0,1] neg_hi:[0,0,1]
    v_pk_fma_f32 v[126:127], v[126:127], v[220:221], v[222:223] op_sel_hi:[1,0,0] neg_lo:[0,0,1] neg_hi:[0,0,1]
    v_cvt_pk_bf16_f32 v44, v120, v121
    v_cvt_pk_bf16_f32 v45, v122, v123
    v_cvt_pk_bf16_f32 v46, v124, v125
    v_cvt_pk_bf16_f32 v47, v126, v127
    ds_write_b128 v24, v[44:47] offset:12672
    v_pk_fma_f32 v[128:129], v[128:129], v[220:221], v[222:223] op_sel_hi:[1,0,0] neg_lo:[0,0,1] neg_hi:[0,0,1]
    v_pk_fma_f32 v[130:131], v[130:131], v[220:221], v[222:223] op_sel_hi:[1,0,0] neg_lo:[0,0,1] neg_hi:[0,0,1]
    v_pk_fma_f32 v[132:133], v[132:133], v[220:221], v[222:223] op_sel_hi:[1,0,0] neg_lo:[0,0,1] neg_hi:[0,0,1]
    v_pk_fma_f32 v[134:135], v[134:135], v[220:221], v[222:223] op_sel_hi:[1,0,0] neg_lo:[0,0,1] neg_hi:[0,0,1]
    v_cvt_pk_bf16_f32 v48, v128, v129
    v_cvt_pk_bf16_f32 v49, v130, v131
    v_cvt_pk_bf16_f32 v50, v132, v133
    v_cvt_pk_bf16_f32 v51, v134, v135
    ds_write_b128 v24, v[48:51] offset:16896
    v_pk_fma_f32 v[136:137], v[136:137], v[220:221], v[222:223] op_sel_hi:[1,0,0] neg_lo:[0,0,1] neg_hi:[0,0,1]
    v_pk_fma_f32 v[138:139], v[138:139], v[220:221], v[222:223] op_sel_hi:[1,0,0] neg_lo:[0,0,1] neg_hi:[0,0,1]
    v_pk_fma_f32 v[140:141], v[140:141], v[220:221], v[222:223] op_sel_hi:[1,0,0] neg_lo:[0,0,1] neg_hi:[0,0,1]
    v_pk_fma_f32 v[142:143], v[142:143], v[220:221], v[222:223] op_sel_hi:[1,0,0] neg_lo:[0,0,1] neg_hi:[0,0,1]
    v_cvt_pk_bf16_f32 v52, v136, v137
    v_cvt_pk_bf16_f32 v53, v138, v139
    v_cvt_pk_bf16_f32 v54, v140, v141
    v_cvt_pk_bf16_f32 v55, v142, v143
    ds_write_b128 v24, v[52:55] offset:21120
    v_pk_fma_f32 v[144:145], v[144:145], v[220:221], v[222:223] op_sel_hi:[1,0,0] neg_lo:[0,0,1] neg_hi:[0,0,1]
    v_pk_fma_f32 v[146:147], v[146:147], v[220:221], v[222:223] op_sel_hi:[1,0,0] neg_lo:[0,0,1] neg_hi:[0,0,1]
    v_pk_fma_f32 v[148:149], v[148:149], v[220:221], v[222:223] op_sel_hi:[1,0,0] neg_lo:[0,0,1] neg_hi:[0,0,1]
    v_pk_fma_f32 v[150:151], v[150:151], v[220:221], v[222:223] op_sel_hi:[1,0,0] neg_lo:[0,0,1] neg_hi:[0,0,1]
    v_cvt_pk_bf16_f32 v56, v144, v145
    v_cvt_pk_bf16_f32 v57, v146, v147
    v_cvt_pk_bf16_f32 v58, v148, v149
    v_cvt_pk_bf16_f32 v59, v150, v151
    ds_write_b128 v24, v[56:59] offset:25344
    v_pk_fma_f32 v[152:153], v[152:153], v[220:221], v[222:223] op_sel_hi:[1,0,0] neg_lo:[0,0,1] neg_hi:[0,0,1]
    v_pk_fma_f32 v[154:155], v[154:155], v[220:221], v[222:223] op_sel_hi:[1,0,0] neg_lo:[0,0,1] neg_hi:[0,0,1]
    v_pk_fma_f32 v[156:157], v[156:157], v[220:221], v[222:223] op_sel_hi:[1,0,0] neg_lo:[0,0,1] neg_hi:[0,0,1]
    v_pk_fma_f32 v[158:159], v[158:159], v[220:221], v[222:223] op_sel_hi:[1,0,0] neg_lo:[0,0,1] neg_hi:[0,0,1]
    v_cvt_pk_bf16_f32 v60, v152, v153
    v_cvt_pk_bf16_f32 v61, v154, v155
    v_cvt_pk_bf16_f32 v62, v156, v157
    v_cvt_pk_bf16_f32 v63, v158, v159
    ds_write_b128 v24, v[60:63] offset:29568
    v_pk_fma_f32 v[160:161], v[160:161], v[220:221], v[222:223] op_sel_hi:[1,0,0] neg_lo:[0,0,1] neg_hi:[0,0,1]
    v_pk_fma_f32 v[162:163], v[162:163], v[220:221], v[222:223] op_sel_hi:[1,0,0] neg_lo:[0,0,1] neg_hi:[0,0,1]
    v_pk_fma_f32 v[164:165], v[164:165], v[220:221], v[222:223] op_sel_hi:[1,0,0] neg_lo:[0,0,1] neg_hi:[0,0,1]
    v_pk_fma_f32 v[166:167], v[166:167], v[220:221], v[222:223] op_sel_hi:[1,0,0] neg_lo:[0,0,1] neg_hi:[0,0,1]
    v_cvt_pk_bf16_f32 v64, v160, v161
    v_cvt_pk_bf16_f32 v65, v162, v163
    v_cvt_pk_bf16_f32 v66, v164, v165
    v_cvt_pk_bf16_f32 v67, v166, v167
    ds_write_b128 v24, v[64:67] offset:33792
    v_pk_fma_f32 v[168:169], v[168:169], v[220:221], v[222:223] op_sel_hi:[1,0,0] neg_lo:[0,0,1] neg_hi:[0,0,1]
    v_pk_fma_f32 v[170:171], v[170:171], v[220:221], v[222:223] op_sel_hi:[1,0,0] neg_lo:[0,0,1] neg_hi:[0,0,1]
    v_pk_fma_f32 v[172:173], v[172:173], v[220:221], v[222:223] op_sel_hi:[1,0,0] neg_lo:[0,0,1] neg_hi:[0,0,1]
    v_pk_fma_f32 v[174:175], v[174:175], v[220:221], v[222:223] op_sel_hi:[1,0,0] neg_lo:[0,0,1] neg_hi:[0,0,1]
    v_cvt_pk_bf16_f32 v68, v168, v169
    v_cvt_pk_bf16_f32 v69, v170, v171
    v_cvt_pk_bf16_f32 v70, v172, v173
    v_cvt_pk_bf16_f32 v71, v174, v175
    ds_write_b128 v24, v[68:71] offset:38016
    v_pk_fma_f32 v[176:177], v[176:177], v[220:221], v[222:223] op_sel_hi:[1,0,0] neg_lo:[0,0,1] neg_hi:[0,0,1]
    v_pk_fma_f32 v[178:179], v[178:179], v[220:221], v[222:223] op_sel_hi:[1,0,0] neg_lo:[0,0,1] neg_hi:[0,0,1]
    v_pk_fma_f32 v[180:181], v[180:181], v[220:221], v[222:223] op_sel_hi:[1,0,0] neg_lo:[0,0,1] neg_hi:[0,0,1]
    v_pk_fma_f32 v[182:183], v[182:183], v[220:221], v[222:223] op_sel_hi:[1,0,0] neg_lo:[0,0,1] neg_hi:[0,0,1]
    v_cvt_pk_bf16_f32 v72, v176, v177
    v_cvt_pk_bf16_f32 v73, v178, v179
    v_cvt_pk_bf16_f32 v74, v180, v181
    v_cvt_pk_bf16_f32 v75, v182, v183
    ds_write_b128 v24, v[72:75] offset:42240
    v_pk_fma_f32 v[184:185], v[184:185], v[220:221], v[222:223] op_sel_hi:[1,0,0] neg_lo:[0,0,1] neg_hi:[0,0,1]
    v_pk_fma_f32 v[186:187], v[186:187], v[220:221], v[222:223] op_sel_hi:[1,0,0] neg_lo:[0,0,1] neg_hi:[0,0,1]
    v_pk_fma_f32 v[188:189], v[188:189], v[220:221], v[222:223] op_sel_hi:[1,0,0] neg_lo:[0,0,1] neg_hi:[0,0,1]
    v_pk_fma_f32 v[190:191], v[190:191], v[220:221], v[222:223] op_sel_hi:[1,0,0] neg_lo:[0,0,1] neg_hi:[0,0,1]
    v_cvt_pk_bf16_f32 v76, v184, v185
    v_cvt_pk_bf16_f32 v77, v186, v187
    v_cvt_pk_bf16_f32 v78, v188, v189
    v_cvt_pk_bf16_f32 v79, v190, v191
    ds_write_b128 v24, v[76:79] offset:46464
    v_pk_fma_f32 v[192:193], v[192:193], v[220:221], v[222:223] op_sel_hi:[1,0,0] neg_lo:[0,0,1] neg_hi:[0,0,1]
    v_pk_fma_f32 v[194:195], v[194:195], v[220:221], v[222:223] op_sel_hi:[1,0,0] neg_lo:[0,0,1] neg_hi:[0,0,1]
    v_pk_fma_f32 v[196:197], v[196:197], v[220:221], v[222:223] op_sel_hi:[1,0,0] neg_lo:[0,0,1] neg_hi:[0,0,1]
    v_pk_fma_f32 v[198:199], v[198:199], v[220:221], v[222:223] op_sel_hi:[1,0,0] neg_lo:[0,0,1] neg_hi:[0,0,1]
    v_cvt_pk_bf16_f32 v80, v192, v193
    v_cvt_pk_bf16_f32 v81, v194, v195
    v_cvt_pk_bf16_f32 v82, v196, v197
    v_cvt_pk_bf16_f32 v83, v198, v199
    ds_write_b128 v24, v[80:83] offset:50688
    v_pk_fma_f32 v[200:201], v[200:201], v[220:221], v[222:223] op_sel_hi:[1,0,0] neg_lo:[0,0,1] neg_hi:[0,0,1]
    v_pk_fma_f32 v[202:203], v[202:203], v[220:221], v[222:223] op_sel_hi:[1,0,0] neg_lo:[0,0,1] neg_hi:[0,0,1]
    v_pk_fma_f32 v[204:205], v[204:205], v[220:221], v[222:223] op_sel_hi:[1,0,0] neg_lo:[0,0,1] neg_hi:[0,0,1]
    v_pk_fma_f32 v[206:207], v[206:207], v[220:221], v[222:223] op_sel_hi:[1,0,0] neg_lo:[0,0,1] neg_hi:[0,0,1]
    v_cvt_pk_bf16_f32 v84, v200, v201
    v_cvt_pk_bf16_f32 v85, v202, v203
    v_cvt_pk_bf16_f32 v86, v204, v205
    v_cvt_pk_bf16_f32 v87, v206, v207
    ds_write_b128 v24, v[84:87] offset:54912
    s_waitcnt vmcnt(21) lgkmcnt(0)
    s_barrier
    ds_read_b128 v[96:99], v25 offset:0
    ds_read_b64_tr_b16 v[104:105], v26 offset:0
    ds_read_b64_tr_b16 v[106:107], v26 offset:512
    ds_read_b64_tr_b16 v[108:109], v26 offset:1024
    ds_read_b64_tr_b16 v[110:111], v26 offset:1536
    ds_read_b64_tr_b16 v[112:113], v26 offset:2048
    ds_read_b64_tr_b16 v[114:115], v26 offset:2560
    ds_read_b128 v[100:103], v25 offset:2112
    ds_read_b64_tr_b16 v[116:117], v26 offset:6144
    ds_read_b64_tr_b16 v[118:119], v26 offset:6656
    s_waitcnt lgkmcnt(7)
    v_mfma_f32_32x32x16_bf16 v[32:47], v[104:107], v[96:99], 0
    ds_read_b64_tr_b16 v[120:121], v26 offset:7168
    ds_read_b64_tr_b16 v[122:123], v26 offset:7680
    s_waitcnt lgkmcnt(7)
    v_mfma_f32_32x32x16_bf16 v[48:63], v[108:111], v[96:99], 0
    ds_read_b64_tr_b16 v[124:125], v26 offset:8192
    ds_read_b64_tr_b16 v[126:127], v26 offset:8704
    s_waitcnt lgkmcnt(7)
    v_mfma_f32_32x32x16_bf16 v[64:79], v[112:115], v[96:99], 0
    ds_read_b128 v[96:99], v25 offset:4224
    ds_read_b64_tr_b16 v[104:105], v26 offset:12288
    ds_read_b64_tr_b16 v[106:107], v26 offset:12800
    s_waitcnt lgkmcnt(7)
    v_mfma_f32_32x32x16_bf16 v[32:47], v[116:119], v[100:103], v[32:47]
    ds_read_b64_tr_b16 v[108:109], v26 offset:13312
    ds_read_b64_tr_b16 v[110:111], v26 offset:13824
    s_waitcnt lgkmcnt(7)
    v_mfma_f32_32x32x16_bf16 v[48:63], v[120:123], v[100:103], v[48:63]
    ds_read_b64_tr_b16 v[112:113], v26 offset:14336
    ds_read_b64_tr_b16 v[114:115], v26 offset:14848
    s_waitcnt lgkmcnt(7)
    v_mfma_f32_32x32x16_bf16 v[64:79], v[124:127], v[100:103], v[64:79]
    ds_read_b128 v[100:103], v25 offset:6336
    ds_read_b64_tr_b16 v[116:117], v26 offset:18432
    ds_read_b64_tr_b16 v[118:119], v26 offset:18944
    s_waitcnt lgkmcnt(7)
    v_mfma_f32_32x32x16_bf16 v[32:47], v[104:107], v[96:99], v[32:47]
    ds_read_b64_tr_b16 v[120:121], v26 offset:19456
    ds_read_b64_tr_b16 v[122:123], v26 offset:19968
    s_waitcnt lgkmcnt(7)
    v_mfma_f32_32x32x16_bf16 v[48:63], v[108:111], v[96:99], v[48:63]
    ds_read_b64_tr_b16 v[124:125], v26 offset:20480
    ds_read_b64_tr_b16 v[126:127], v26 offset:20992
    s_waitcnt lgkmcnt(7)
    v_mfma_f32_32x32x16_bf16 v[64:79], v[112:115], v[96:99], v[64:79]
    s_waitcnt lgkmcnt(4)
    v_mfma_f32_32x32x16_bf16 v[32:47], v[116:119], v[100:103], v[32:47]
    s_waitcnt lgkmcnt(2)
    v_mfma_f32_32x32x16_bf16 v[48:63], v[120:123], v[100:103], v[48:63]
    s_waitcnt lgkmcnt(0)
    v_mfma_f32_32x32x16_bf16 v[64:79], v[124:127], v[100:103], v[64:79]
    s_waitcnt vmcnt(15)
    s_barrier
    ds_read_b128 v[96:99], v25 offset:8448
    ds_read_b64_tr_b16 v[104:105], v26 offset:24576
    ds_read_b64_tr_b16 v[106:107], v26 offset:25088
    ds_read_b64_tr_b16 v[108:109], v26 offset:25600
    ds_read_b64_tr_b16 v[110:111], v26 offset:26112
    ds_read_b64_tr_b16 v[112:113], v26 offset:26624
    ds_read_b64_tr_b16 v[114:115], v26 offset:27136
    ds_read_b128 v[100:103], v25 offset:10560
    ds_read_b64_tr_b16 v[116:117], v26 offset:30720
    ds_read_b64_tr_b16 v[118:119], v26 offset:31232
    s_waitcnt lgkmcnt(7)
    v_mfma_f32_32x32x16_bf16 v[32:47], v[104:107], v[96:99], v[32:47]
    s_add_u32 m0, s55, 65536
    s_nop 0
    buffer_load_dwordx4 v18, s[8:11], s71 offen lds
    ds_read_b64_tr_b16 v[120:121], v26 offset:31744
    ds_read_b64_tr_b16 v[122:123], v26 offset:32256
    s_waitcnt lgkmcnt(7)
    v_mfma_f32_32x32x16_bf16 v[48:63], v[108:111], v[96:99], v[48:63]
    ds_read_b64_tr_b16 v[124:125], v26 offset:32768
    ds_read_b64_tr_b16 v[126:127], v26 offset:33280
    s_waitcnt lgkmcnt(7)
    v_mfma_f32_32x32x16_bf16 v[64:79], v[112:115], v[96:99], v[64:79]
    s_add_u32 m0, s55, 66560
    s_nop 0
    buffer_load_dwordx4 v19, s[8:11], s71 offen lds
    ds_read_b128 v[96:99], v25 offset:12672
    ds_read_b64_tr_b16 v[104:105], v26 offset:36864
    ds_read_b64_tr_b16 v[106:107], v26 offset:37376
    s_waitcnt lgkmcnt(7)
    v_mfma_f32_32x32x16_bf16 v[32:47], v[116:119], v[100:103], v[32:47]
    s_add_u32 m0, s55, 67584
    s_nop 0
    buffer_load_dwordx4 v20, s[8:11], s71 offen lds
    ds_read_b64_tr_b16 v[108:109], v26 offset:37888
    ds_read_b64_tr_b16 v[110:111], v26 offset:38400
    s_waitcnt lgkmcnt(7)
    v_mfma_f32_32x32x16_bf16 v[48:63], v[120:123], v[100:103], v[48:63]
    ds_read_b64_tr_b16 v[112:113], v26 offset:38912
    ds_read_b64_tr_b16 v[114:115], v26 offset:39424
    s_waitcnt lgkmcnt(7)
    v_mfma_f32_32x32x16_bf16 v[64:79], v[124:127], v[100:103], v[64:79]
    s_add_u32 m0, s55, 68608
    s_nop 0
    buffer_load_dwordx4 v21, s[8:11], s71 offen lds
    ds_read_b128 v[100:103], v25 offset:14784
    ds_read_b64_tr_b16 v[116:117], v26 offset:43008
    ds_read_b64_tr_b16 v[118:119], v26 offset:43520
    s_waitcnt lgkmcnt(7)
    v_mfma_f32_32x32x16_bf16 v[32:47], v[104:107], v[96:99], v[32:47]
    s_add_u32 m0, s55, 69632
    s_nop 0
    buffer_load_dwordx4 v22, s[8:11], s71 offen lds
    ds_read_b64_tr_b16 v[120:121], v26 offset:44032
    ds_read_b64_tr_b16 v[122:123], v26 offset:44544
    s_waitcnt lgkmcnt(7)
    v_mfma_f32_32x32x16_bf16 v[48:63], v[108:111], v[96:99], v[48:63]
    ds_read_b64_tr_b16 v[124:125], v26 offset:45056
    ds_read_b64_tr_b16 v[126:127], v26 offset:45568
    s_waitcnt lgkmcnt(7)
    v_mfma_f32_32x32x16_bf16 v[64:79], v[112:115], v[96:99], v[64:79]
    s_add_u32 m0, s55, 70656
    s_nop 0
    buffer_load_dwordx4 v23, s[8:11], s71 offen lds
    s_waitcnt lgkmcnt(4)
    v_mfma_f32_32x32x16_bf16 v[32:47], v[116:119], v[100:103], v[32:47]
    s_waitcnt lgkmcnt(2)
    v_mfma_f32_32x32x16_bf16 v[48:63], v[120:123], v[100:103], v[48:63]
    s_waitcnt lgkmcnt(0)
    v_mfma_f32_32x32x16_bf16 v[64:79], v[124:127], v[100:103], v[64:79]
    s_waitcnt vmcnt(15)
    s_barrier
    ds_read_b128 v[96:99], v25 offset:16896
    ds_read_b64_tr_b16 v[104:105], v27 offset:0
    ds_read_b64_tr_b16 v[106:107], v27 offset:512
    ds_read_b64_tr_b16 v[108:109], v27 offset:1024
    ds_read_b64_tr_b16 v[110:111], v27 offset:1536
    ds_read_b64_tr_b16 v[112:113], v27 offset:2048
    ds_read_b64_tr_b16 v[114:115], v27 offset:2560
    ds_read_b128 v[100:103], v25 offset:19008
    ds_read_b64_tr_b16 v[116:117], v27 offset:6144
    ds_read_b64_tr_b16 v[118:119], v27 offset:6656
    s_waitcnt lgkmcnt(7)
    v_mfma_f32_32x32x16_bf16 v[32:47], v[104:107], v[96:99], v[32:47]
    s_add_u32 m0, s55, 90112
    s_nop 0
    buffer_load_dwordx4 v18, s[8:11], s72 offen lds
    ds_read_b64_tr_b16 v[120:121], v27 offset:7168
    ds_read_b64_tr_b16 v[122:123], v27 offset:7680
    s_waitcnt lgkmcnt(7)
    v_mfma_f32_32x32x16_bf16 v[48:63], v[108:111], v[96:99], v[48:63]
    ds_read_b64_tr_b16 v[124:125], v27 offset:8192
    ds_read_b64_tr_b16 v[126:127], v27 offset:8704
    s_waitcnt lgkmcnt(7)
    v_mfma_f32_32x32x16_bf16 v[64:79], v[112:115], v[96:99], v[64:79]
    s_add_u32 m0, s55, 91136
    s_nop 0
    buffer_load_dwordx4 v19, s[8:11], s72 offen lds
    ds_read_b128 v[96:99], v25 offset:21120
    ds_read_b64_tr_b16 v[104:105], v27 offset:12288
    ds_read_b64_tr_b16 v[106:107], v27 offset:12800
    s_waitcnt lgkmcnt(7)
    v_mfma_f32_32x32x16_bf16 v[32:47], v[116:119], v[100:103], v[32:47]
    s_add_u32 m0, s55, 92160
    s_nop 0
    buffer_load_dwordx4 v20, s[8:11], s72 offen lds
    ds_read_b64_tr_b16 v[108:109], v27 offset:13312
    ds_read_b64_tr_b16 v[110:111], v27 offset:13824
    s_waitcnt lgkmcnt(7)
    v_mfma_f32_32x32x16_bf16 v[48:63], v[120:123], v[100:103], v[48:63]
    ds_read_b64_tr_b16 v[112:113], v27 offset:14336
    ds_read_b64_tr_b16 v[114:115], v27 offset:14848
    s_waitcnt lgkmcnt(7)
    v_mfma_f32_32x32x16_bf16 v[64:79], v[124:127], v[100:103], v[64:79]
    s_add_u32 m0, s55, 93184
    s_nop 0
    buffer_load_dwordx4 v21, s[8:11], s72 offen lds
    ds_read_b128 v[100:103], v25 offset:23232
    ds_read_b64_tr_b16 v[116:117], v27 offset:18432
    ds_read_b64_tr_b16 v[118:119], v27 offset:18944
    s_waitcnt lgkmcnt(7)
    v_mfma_f32_32x32x16_bf16 v[32:47], v[104:107], v[96:99], v[32:47]
    s_add_u32 m0, s55, 94208
    s_nop 0
    buffer_load_dwordx4 v22, s[8:11], s72 offen lds
    ds_read_b64_tr_b16 v[120:121], v27 offset:19456
    ds_read_b64_tr_b16 v[122:123], v27 offset:19968
    s_waitcnt lgkmcnt(7)
    v_mfma_f32_32x32x16_bf16 v[48:63], v[108:111], v[96:99], v[48:63]
    ds_read_b64_tr_b16 v[124:125], v27 offset:20480
    ds_read_b64_tr_b16 v[126:127], v27 offset:20992
    s_waitcnt lgkmcnt(7)
    v_mfma_f32_32x32x16_bf16 v[64:79], v[112:115], v[96:99], v[64:79]
    s_add_u32 m0, s55, 95232
    s_nop 0
    buffer_load_dwordx4 v23, s[8:11], s72 offen lds
    s_waitcnt lgkmcnt(4)
    v_mfma_f32_32x32x16_bf16 v[32:47], v[116:119], v[100:103], v[32:47]
    s_waitcnt lgkmcnt(2)
    v_mfma_f32_32x32x16_bf16 v[48:63], v[120:123], v[100:103], v[48:63]
    s_waitcnt lgkmcnt(0)
    v_mfma_f32_32x32x16_bf16 v[64:79], v[124:127], v[100:103], v[64:79]
    s_waitcnt vmcnt(14)
    v_mov_b32 v30, 0
    v_cmp_eq_u32 vcc, 0, v29
    s_nop 0
    s_cbranch_vccz L_ok2
    s_mov_b32 s59, 200000
L_spin1:
    buffer_load_dword v29, v30, s[40:43], 0 offen sc1
    s_waitcnt vmcnt(0)
    v_cmp_eq_u32 vcc, 0, v29
    s_nop 0
    s_cbranch_vccz L_ok2
    s_sub_u32 s59, s59, 1
    s_cbranch_scc0 L_spin1
L_ok2:
    v_readfirstlane_b32 s47, v29
    s_waitcnt vmcnt(12)
    s_barrier
    s_lshl_b32 s53, s3, 5
    s_add_u32 s53, s53, s48
    s_lshl_b32 s53, s53, 7
    s_add_u32 s53, s53, 12582912
    s_cmp_lg_u32 s44, 0
    s_cbranch_scc1 L_nopub3
    v_mov_b32 v29, 0
    v_mov_b32 v30, s47
    s_mov_b64 exec, 1
    buffer_store_dword v30, v29, s[24:27], s53 offen sc1
    s_mov_b64 exec, -1
L_nopub3:
    ds_read_b128 v[96:99], v25 offset:25344
    ds_read_b64_tr_b16 v[104:105], v27 offset:24576
    ds_read_b64_tr_b16 v[106:107], v27 offset:25088
    ds_read_b64_tr_b16 v[108:109], v27 offset:25600
    ds_read_b64_tr_b16 v[110:111], v27 offset:26112
    ds_read_b64_tr_b16 v[112:113], v27 offset:26624
    ds_read_b64_tr_b16 v[114:115], v27 offset:27136
    ds_read_b128 v[100:103], v25 offset:27456
    ds_read_b64_tr_b16 v[116:117], v27 offset:30720
    ds_read_b64_tr_b16 v[118:119], v27 offset:31232
    s_waitcnt lgkmcnt(7)
    v_mfma_f32_32x32x16_bf16 v[32:47], v[104:107], v[96:99], v[32:47]
    s_add_u32 m0, s55, 114688
    s_nop 0
    buffer_load_dwordx4 v18, s[8:11], s73 offen lds
    ds_read_b64_tr_b16 v[120:121], v27 offset:31744
    ds_read_b64_tr_b16 v[122:123], v27 offset:32256
    s_waitcnt lgkmcnt(7)
    v_mfma_f32_32x32x16_bf16 v[48:63], v[108:111], v[96:99], v[48:63]
    ds_read_b64_tr_b16 v[124:125], v27 offset:32768
    ds_read_b64_tr_b16 v[126:127], v27 offset:33280
    s_waitcnt lgkmcnt(7)
    v_mfma_f32_32x32x16_bf16 v[64:79], v[112:115], v[96:99], v[64:79]
    s_add_u32 m0, s55, 115712
    s_nop 0
    buffer_load_dwordx4 v19, s[8:11], s73 offen lds
    ds_read_b128 v[96:99], v25 offset:29568
    ds_read_b64_tr_b16 v[104:105], v27 offset:36864
    ds_read_b64_tr_b16 v[106:107], v27 offset:37376
    s_waitcnt lgkmcnt(7)
    v_mfma_f32_32x32x16_bf16 v[32:47], v[116:119], v[100:103], v[32:47]
    s_add_u32 m0, s55, 116736
    s_nop 0
    buffer_load_dwordx4 v20, s[8:11], s73 offen lds
    ds_read_b64_tr_b16 v[108:109], v27 offset:37888
    ds_read_b64_tr_b16 v[110:111], v27 offset:38400
    s_waitcnt lgkmcnt(7)
    v_mfma_f32_32x32x16_bf16 v[48:63], v[120:123], v[100:103], v[48:63]
    ds_read_b64_tr_b16 v[112:113], v27 offset:38912
    ds_read_b64_tr_b16 v[114:115], v27 offset:39424
    s_waitcnt lgkmcnt(7)
    v_mfma_f32_32x32x16_bf16 v[64:79], v[124:127], v[100:103], v[64:79]
    s_add_u32 m0, s55, 117760
    s_nop 0
    buffer_load_dwordx4 v21, s[8:11], s73 offen lds
    ds_read_b128 v[100:103], v25 offset:31680
    ds_read_b64_tr_b16 v[116:117], v27 offset:43008
    ds_read_b64_tr_b16 v[118:119], v27 offset:43520
    s_waitcnt lgkmcnt(7)
    v_mfma_f32_32x32x16_bf16 v[32:47], v[104:107], v[96:99], v[32:47]
    s_add_u32 m0, s55, 118784
    s_nop 0
    buffer_load_dwordx4 v22, s[8:11], s73 offen lds
    ds_read_b64_tr_b16 v[120:121], v27 offset:44032
    ds_read_b64_tr_b16 v[122:123], v27 offset:44544
    s_waitcnt lgkmcnt(7)
    v_mfma_f32_32x32x16_bf16 v[48:63], v[108:111], v[96:99], v[48:63]
    ds_read_b64_tr_b16 v[124:125], v27 offset:45056
    ds_read_b64_tr_b16 v[126:127], v27 offset:45568
    s_waitcnt lgkmcnt(7)
    v_mfma_f32_32x32x16_bf16 v[64:79], v[112:115], v[96:99], v[64:79]
    s_add_u32 m0, s55, 119808
    s_nop 0
    buffer_load_dwordx4 v23, s[8:11], s73 offen lds
    s_waitcnt lgkmcnt(4)
    v_mfma_f32_32x32x16_bf16 v[32:47], v[116:119], v[100:103], v[32:47]
    s_waitcnt lgkmcnt(2)
    v_mfma_f32_32x32x16_bf16 v[48:63], v[120:123], v[100:103], v[48:63]
    s_waitcnt lgkmcnt(0)
    v_mfma_f32_32x32x16_bf16 v[64:79], v[124:127], v[100:103], v[64:79]
    s_waitcnt vmcnt(12)
    s_barrier
    ds_read_b128 v[96:99], v25 offset:33792
    ds_read_b64_tr_b16 v[104:105], v26 offset:0
    ds_read_b64_tr_b16 v[106:107], v26 offset:512
    ds_read_b64_tr_b16 v[108:109], v26 offset:1024
    ds_read_b64_tr_b16 v[110:111], v26 offset:1536
    ds_read_b64_tr_b16 v[112:113], v26 offset:2048
    ds_read_b64_tr_b16 v[114:115], v26 offset:2560
    ds_read_b128 v[100:103], v25 offset:35904
    ds_read_b64_tr_b16 v[116:117], v26 offset:6144
    ds_read_b64_tr_b16 v[118:119], v26 offset:6656
    s_waitcnt lgkmcnt(7)
    v_mfma_f32_32x32x16_bf16 v[32:47], v[104:107], v[96:99], v[32:47]
    ds_read_b64_tr_b16 v[120:121], v26 offset:7168
    ds_read_b64_tr_b16 v[122:123], v26 offset:7680
    s_waitcnt lgkmcnt(7)
    v_mfma_f32_32x32x16_bf16 v[48:63], v[108:111], v[96:99], v[48:63]
    ds_read_b64_tr_b16 v[124:125], v26 offset:8192
    ds_read_b64_tr_b16 v[126:127], v26 offset:8704
    s_waitcnt lgkmcnt(7)
    v_mfma_f32_32x32x16_bf16 v[64:79], v[112:115], v[96:99], v[64:79]
    ds_read_b128 v[96:99], v25 offset:38016
    ds_read_b64_tr_b16 v[104:105], v26 offset:12288
    ds_read_b64_tr_b16 v[106:107], v26 offset:12800
    s_waitcnt lgkmcnt(7)
    v_mfma_f32_32x32x16_bf16 v[32:47], v[116:119], v[100:103], v[32:47]
    ds_read_b64_tr_b16 v[108:109], v26 offset:13312
    ds_read_b64_tr_b16 v[110:111], v26 offset:13824
    s_waitcnt lgkmcnt(7)
    v_mfma_f32_32x32x16_bf16 v[48:63], v[120:123], v[100:103], v[48:63]
    ds_read_b64_tr_b16 v[112:113], v26 offset:14336
    ds_read_b64_tr_b16 v[114:115], v26 offset:14848
    s_waitcnt lgkmcnt(7)
    v_mfma_f32_32x32x16_bf16 v[64:79], v[124:127], v[100:103], v[64:79]
    ds_read_b128 v[100:103], v25 offset:40128
    ds_read_b64_tr_b16 v[116:117], v26 offset:18432
    ds_read_b64_tr_b16 v[118:119], v26 offset:18944
    s_waitcnt lgkmcnt(7)
    v_mfma_f32_32x32x16_bf16 v[32:47], v[104:107], v[96:99], v[32:47]
    ds_read_b64_tr_b16 v[120:121], v26 offset:19456
    ds_read_b64_tr_b16 v[122:123], v26 offset:19968
    s_waitcnt lgkmcnt(7)
    v_mfma_f32_32x32x16_bf16 v[48:63], v[108:111], v[96:99], v[48:63]
    ds_read_b64_tr_b16 v[124:125], v26 offset:20480
    ds_read_b64_tr_b16 v[126:127], v26 offset:20992
    s_waitcnt lgkmcnt(7)
    v_mfma_f32_32x32x16_bf16 v[64:79], v[112:115], v[96:99], v[64:79]
    s_waitcnt lgkmcnt(4)
    v_mfma_f32_32x32x16_bf16 v[32:47], v[116:119], v[100:103], v[32:47]
    s_waitcnt lgkmcnt(2)
    v_mfma_f32_32x32x16_bf16 v[48:63], v[120:123], v[100:103], v[48:63]
    s_waitcnt lgkmcnt(0)
    v_mfma_f32_32x32x16_bf16 v[64:79], v[124:127], v[100:103], v[64:79]
    s_waitcnt vmcnt(6)
    s_barrier
    ds_read_b128 v[96:99], v25 offset:42240
    ds_read_b64_tr_b16 v[104:105], v26 offset:24576
    ds_read_b64_tr_b16 v[106:107], v26 offset:25088
    ds_read_b64_tr_b16 v[108:109], v26 offset:25600
    ds_read_b64_tr_b16 v[110:111], v26 offset:26112
    ds_read_b64_tr_b16 v[112:113], v26 offset:26624
    ds_read_b64_tr_b16 v[114:115], v26 offset:27136
    ds_read_b128 v[100:103], v25 offset:44352
    ds_read_b64_tr_b16 v[116:117], v26 offset:30720
    ds_read_b64_tr_b16 v[118:119], v26 offset:31232
    s_waitcnt lgkmcnt(7)
    v_mfma_f32_32x32x16_bf16 v[32:47], v[104:107], v[96:99], v[32:47]
    ds_read_b64_tr_b16 v[120:121], v26 offset:31744
    ds_read_b64_tr_b16 v[122:123], v26 offset:32256
    s_waitcnt lgkmcnt(7)
    v_mfma_f32_32x32x16_bf16 v[48:63], v[108:111], v[96:99], v[48:63]
    ds_read_b64_tr_b16 v[124:125], v26 offset:32768
    ds_read_b64_tr_b16 v[126:127], v26 offset:33280
    s_waitcnt lgkmcnt(7)
    v_mfma_f32_32x32x16_bf16 v[64:79], v[112:115], v[96:99], v[64:79]
    ds_read_b128 v[96:99], v25 offset:46464
    ds_read_b64_tr_b16 v[104:105], v26 offset:36864
    ds_read_b64_tr_b16 v[106:107], v26 offset:37376
    s_waitcnt lgkmcnt(7)
    v_mfma_f32_32x32x16_bf16 v[32:47], v[116:119], v[100:103], v[32:47]
    ds_read_b64_tr_b16 v[108:109], v26 offset:37888
    ds_read_b64_tr_b16 v[110:111], v26 offset:38400
    s_waitcnt lgkmcnt(7)
    v_mfma_f32_32x32x16_bf16 v[48:63], v[120:123], v[100:103], v[48:63]
    ds_read_b64_tr_b16 v[112:113], v26 offset:38912
    ds_read_b64_tr_b16 v[114:115], v26 offset:39424
    s_waitcnt lgkmcnt(7)
    v_mfma_f32_32x32x16_bf16 v[64:79], v[124:127], v[100:103], v[64:79]
    ds_read_b128 v[100:103], v25 offset:48576
    ds_read_b64_tr_b16 v[116:117], v26 offset:43008
    ds_read_b64_tr_b16 v[118:119], v26 offset:43520
    s_waitcnt lgkmcnt(7)
    v_mfma_f32_32x32x16_bf16 v[32:47], v[104:107], v[96:99], v[32:47]
    ds_read_b64_tr_b16 v[120:121], v26 offset:44032
    ds_read_b64_tr_b16 v[122:123], v26 offset:44544
    s_waitcnt lgkmcnt(7)
    v_mfma_f32_32x32x16_bf16 v[48:63], v[108:111], v[96:99], v[48:63]
    ds_read_b64_tr_b16 v[124:125], v26 offset:45056
    ds_read_b64_tr_b16 v[126:127], v26 offset:45568
    s_waitcnt lgkmcnt(7)
    v_mfma_f32_32x32x16_bf16 v[64:79], v[112:115], v[96:99], v[64:79]
    s_waitcnt lgkmcnt(4)
    v_mfma_f32_32x32x16_bf16 v[32:47], v[116:119], v[100:103], v[32:47]
    s_waitcnt lgkmcnt(2)
    v_mfma_f32_32x32x16_bf16 v[48:63], v[120:123], v[100:103], v[48:63]
    s_waitcnt lgkmcnt(0)
    v_mfma_f32_32x32x16_bf16 v[64:79], v[124:127], v[100:103], v[64:79]
    s_waitcnt vmcnt(0)
    s_barrier
    ds_read_b128 v[96:99], v25 offset:50688
    ds_read_b64_tr_b16 v[104:105], v27 offset:0
    ds_read_b64_tr_b16 v[106:107], v27 offset:512
    ds_read_b64_tr_b16 v[108:109], v27 offset:1024
    ds_read_b64_tr_b16 v[110:111], v27 offset:1536
    ds_read_b64_tr_b16 v[112:113], v27 offset:2048
    ds_read_b64_tr_b16 v[114:115], v27 offset:2560
    ds_read_b128 v[100:103], v25 offset:52800
    ds_read_b64_tr_b16 v[116:117], v27 offset:6144
    ds_read_b64_tr_b16 v[118:119], v27 offset:6656
    s_waitcnt lgkmcnt(7)
    v_mfma_f32_32x32x16_bf16 v[32:47], v[104:107], v[96:99], v[32:47]
    ds_read_b64_tr_b16 v[120:121], v27 offset:7168
    ds_read_b64_tr_b16 v[122:123], v27 offset:7680
    s_waitcnt lgkmcnt(7)
    v_mfma_f32_32x32x16_bf16 v[48:63], v[108:111], v[96:99], v[48:63]
    ds_read_b64_tr_b16 v[124:125], v27 offset:8192
    ds_read_b64_tr_b16 v[126:127], v27 offset:8704
    s_waitcnt lgkmcnt(7)
    v_mfma_f32_32x32x16_bf16 v[64:79], v[112:115], v[96:99], v[64:79]
    ds_read_b128 v[96:99], v25 offset:54912
    ds_read_b64_tr_b16 v[104:105], v27 offset:12288
    ds_read_b64_tr_b16 v[106:107], v27 offset:12800
    s_waitcnt lgkmcnt(7)
    v_mfma_f32_32x32x16_bf16 v[32:47], v[116:119], v[100:103], v[32:47]
    ds_read_b64_tr_b16 v[108:109], v27 offset:13312
    ds_read_b64_tr_b16 v[110:111], v27 offset:13824
    s_waitcnt lgkmcnt(7)
    v_mfma_f32_32x32x16_bf16 v[48:63], v[120:123], v[100:103], v[48:63]
    ds_read_b64_tr_b16 v[112:113], v27 offset:14336
    ds_read_b64_tr_b16 v[114:115], v27 offset:14848
    s_waitcnt lgkmcnt(7)
    v_mfma_f32_32x32x16_bf16 v[64:79], v[124:127], v[100:103], v[64:79]
    ds_read_b128 v[100:103], v25 offset:57024
    ds_read_b64_tr_b16 v[116:117], v27 offset:18432
    ds_read_b64_tr_b16 v[118:119], v27 offset:18944
    s_waitcnt lgkmcnt(7)
    v_mfma_f32_32x32x16_bf16 v[32:47], v[104:107], v[96:99], v[32:47]
    ds_read_b64_tr_b16 v[120:121], v27 offset:19456
    ds_read_b64_tr_b16 v[122:123], v27 offset:19968
    s_waitcnt lgkmcnt(7)
    v_mfma_f32_32x32x16_bf16 v[48:63], v[108:111], v[96:99], v[48:63]
    ds_read_b64_tr_b16 v[124:125], v27 offset:20480
    ds_read_b64_tr_b16 v[126:127], v27 offset:20992
    s_waitcnt lgkmcnt(7)
    v_mfma_f32_32x32x16_bf16 v[64:79], v[112:115], v[96:99], v[64:79]
    s_waitcnt lgkmcnt(4)
    v_mfma_f32_32x32x16_bf16 v[32:47], v[116:119], v[100:103], v[32:47]
    s_waitcnt lgkmcnt(2)
    v_mfma_f32_32x32x16_bf16 v[48:63], v[120:123], v[100:103], v[48:63]
    s_waitcnt lgkmcnt(0)
    v_mfma_f32_32x32x16_bf16 v[64:79], v[124:127], v[100:103], v[64:79]
    v_lshrrev_b32 v29, 5, v1
    v_and_b32 v30, 31, v1
    v_lshlrev_b32 v29, 15, v29
    v_lshl_add_u32 v29, v30, 4, v29
    s_mul_i32 s53, s49, 24
    s_lshr_b32 s54, s44, 1
    s_lshl_b32 s54, s54, 2
    s_add_u32 s53, s53, s54
    s_lshl_b32 s53, s53, 15
    s_lshl_b32 s54, s48, 10
    s_add_u32 s53, s53, s54
    s_and_b32 s54, s44, 1
    s_lshl_b32 s54, s54, 9
    s_add_u32 s53, s53, s54
    v_cvt_pk_bf16_f32 v128, v32, v33
    v_cvt_pk_bf16_f32 v129, v34, v35
    v_cvt_pk_bf16_f32 v130, v36, v37
    v_cvt_pk_bf16_f32 v131, v38, v39
    v_cvt_pk_bf16_f32 v132, v40, v41
    v_cvt_pk_bf16_f32 v133, v42, v43
    v_cvt_pk_bf16_f32 v134, v44, v45
    v_cvt_pk_bf16_f32 v135, v46, v47
    v_permlane32_swap_b32 v128, v130
    v_permlane32_swap_b32 v129, v131
    s_add_u32 s54, s53, 6291456
    buffer_store_dwordx4 v[128:131], v29, s[24:27], s54 offen sc1
    v_permlane32_swap_b32 v132, v134
    v_permlane32_swap_b32 v133, v135
    s_add_u32 s54, s53, 6356992
    buffer_store_dwordx4 v[132:135], v29, s[24:27], s54 offen sc1
    v_cvt_pk_bf16_f32 v136, v48, v49
    v_cvt_pk_bf16_f32 v137, v50, v51
    v_cvt_pk_bf16_f32 v138, v52, v53
    v_cvt_pk_bf16_f32 v139, v54, v55
    v_cvt_pk_bf16_f32 v140, v56, v57
    v_cvt_pk_bf16_f32 v141, v58, v59
    v_cvt_pk_bf16_f32 v142, v60, v61
    v_cvt_pk_bf16_f32 v143, v62, v63
    v_permlane32_swap_b32 v136, v138
    v_permlane32_swap_b32 v137, v139
    s_add_u32 s54, s53, 6553600
    buffer_store_dwordx4 v[136:139], v29, s[24:27], s54 offen sc1
    v_permlane32_swap_b32 v140, v142
    v_permlane32_swap_b32 v141, v143
    s_add_u32 s54, s53, 6619136
    buffer_store_dwordx4 v[140:143], v29, s[24:27], s54 offen sc1
    v_cvt_pk_bf16_f32 v144, v64, v65
    v_cvt_pk_bf16_f32 v145, v66, v67
    v_cvt_pk_bf16_f32 v146, v68, v69
    v_cvt_pk_bf16_f32 v147, v70, v71
    v_cvt_pk_bf16_f32 v148, v72, v73
    v_cvt_pk_bf16_f32 v149, v74, v75
    v_cvt_pk_bf16_f32 v150, v76, v77
    v_cvt_pk_bf16_f32 v151, v78, v79
    v_permlane32_swap_b32 v144, v146
    v_permlane32_swap_b32 v145, v147
    s_add_u32 s54, s53, 6815744
    buffer_store_dwordx4 v[144:147], v29, s[24:27], s54 offen sc1
    v_permlane32_swap_b32 v148, v150
    v_permlane32_swap_b32 v149, v151
    s_add_u32 s54, s53, 6881280
    buffer_store_dwordx4 v[148:151], v29, s[24:27], s54 offen sc1
    s_waitcnt vmcnt(0)
    s_barrier
    s_lshl_b32 s53, s48, 3
    s_add_u32 s53, s53, s49
    s_lshl_b32 s53, s53, 7
    s_add_u32 s53, s53, 12648448
    s_cmp_lg_u32 s44, 0
    s_cbranch_scc1 L_nopub4
    v_mov_b32 v29, 0
    v_mov_b32 v30, s47
    s_mov_b64 exec, 1
    buffer_store_dword v30, v29, s[24:27], s53 offen sc1
    s_mov_b64 exec, -1
L_nopub4:
    s_cmp_eq_u32 s75, 0
    s_cbranch_scc1 L_nop2
    s_lshl_b32 s53, s51, 5
    s_lshl_b32 s54, s44, 3
    s_add_u32 s53, s53, s54
    s_lshl_b32 s53, s53, 7
    s_add_u32 s53, s53, 12582912
    v_and_b32 v18, 7, v1
    v_lshlrev_b32 v18, 7, v18
    v_add_u32 v18, s53, v18
    s_lshl_b32 s53, s50, 7
    s_lshr_b32 s54, s44, 1
    s_lshl_b32 s54, s54, 6
    s_add_u32 s53, s53, s54
    v_lshrrev_b32 v19, 5, v1
    v_lshlrev_b32 v19, 3, v19
    s_lshl_b32 s58, s51, 18
    s_lshl_b32 s54, s44, 16
    s_add_u32 s58, s58, s54
    s_lshl_b32 s54, s50, 1
    s_add_u32 s54, s54, s51
    s_and_b32 s54, s54, 3
    s_xor_b32 s56, s54, 0
    s_mul_i32 s60, s56, 458752
    s_mul_i32 s64, s56, 16384
    s_add_u32 s64, s64, s58
    s_xor_b32 s56, s54, 1
    s_mul_i32 s61, s56, 458752
    s_mul_i32 s65, s56, 16384
    s_add_u32 s65, s65, s58
    s_xor_b32 s56, s54, 2
    s_mul_i32 s62, s56, 458752
    s_mul_i32 s66, s56, 16384
    s_add_u32 s66, s66, s58
    s_xor_b32 s56, s54, 3
    s_mul_i32 s63, s56, 458752
    s_mul_i32 s67, s56, 16384
    s_add_u32 s67, s67, s58
    buffer_load_dword v17, v18, s[24:27], 0 offen sc1
    buffer_load_dwordx2 v[20:21], v19, s[32:35], s53 offen offset:0
    buffer_load_dwordx2 v[22:23], v19, s[32:35], s53 offen offset:16
    buffer_load_dwordx2 v[24:25], v19, s[32:35], s53 offen offset:32
    buffer_load_dwordx2 v[26:27], v19, s[32:35], s53 offen offset:48
    s_add_u32 m0, s52, 0
    s_add_u32 s57, s60, 0
    buffer_load_dwordx4 v8, s[16:19], s57 offen nt lds
    buffer_load_dwordx4 v9, s[16:19], s57 offen offset:1024 nt lds
    s_add_u32 m0, s52, 8192
    s_add_u32 s57, s60, 57344
    buffer_load_dwordx4 v8, s[16:19], s57 offen nt lds
    buffer_load_dwordx4 v9, s[16:19], s57 offen offset:1024 nt lds
    s_waitcnt vmcnt(8)
    v_cmp_ne_u32 vcc, s47, v17
    s_nop 0
    s_cbranch_vccz L_ok6
    s_mov_b32 s59, 200000
L_spin5:
    buffer_load_dword v17, v18, s[24:27], 0 offen sc1
    s_waitcnt vmcnt(0)
    v_cmp_ne_u32 vcc, s47, v17
    s_nop 0
    s_cbranch_vccz L_ok6
    s_sub_u32 s59, s59, 1
    s_cbranch_scc0 L_spin5
L_ok6:
    s_add_u32 m0, s52, 16384
    s_add_u32 s57, s60, 114688
    buffer_load_dwordx4 v8, s[16:19], s57 offen nt lds
    buffer_load_dwordx4 v9, s[16:19], s57 offen offset:1024 nt lds
    s_add_u32 m0, s52, 24576
    s_add_u32 s57, s60, 172032
    buffer_load_dwordx4 v8, s[16:19], s57 offen nt lds
    buffer_load_dwordx4 v9, s[16:19], s57 offen offset:1024 nt lds
    s_waitcnt vmcnt(8)
    v_lshlrev_b32 v32, 16, v20
    v_and_b32 v33, 0xffff0000, v20
    v_lshlrev_b32 v34, 16, v21
    v_and_b32 v35, 0xffff0000, v21
    v_lshlrev_b32 v36, 16, v22
    v_and_b32 v37, 0xffff0000, v22
    v_lshlrev_b32 v38, 16, v23
    v_and_b32 v39, 0xffff0000, v23
    v_lshlrev_b32 v40, 16, v24
    v_and_b32 v41, 0xffff0000, v24
    v_lshlrev_b32 v42, 16, v25
    v_and_b32 v43, 0xffff0000, v25
    v_lshlrev_b32 v44, 16, v26
    v_and_b32 v45, 0xffff0000, v26
    v_lshlrev_b32 v46, 16, v27
    v_and_b32 v47, 0xffff0000, v27
    s_add_u32 s58, s64, 0
    buffer_load_dwordx4 v[96:99], v15, s[24:27], s58 offen offset:0 sc1
    buffer_load_dwordx4 v[100:103], v16, s[24:27], s58 offen offset:0 sc1
    s_add_u32 m0, s52, 32768
    s_add_u32 s57, s60, 229376
    buffer_load_dwordx4 v8, s[16:19], s57 offen nt lds
    buffer_load_dwordx4 v9, s[16:19], s57 offen offset:1024 nt lds
    buffer_load_dwordx4 v[104:107], v15, s[24:27], s58 offen offset:2048 sc1
    buffer_load_dwordx4 v[108:111], v16, s[24:27], s58 offen offset:2048 sc1
    s_add_u32 m0, s52, 40960
    s_add_u32 s57, s60, 286720
    buffer_load_dwordx4 v8, s[16:19], s57 offen nt lds
    buffer_load_dwordx4 v9, s[16:19], s57 offen offset:1024 nt lds
    s_add_u32 s58, s64, 4096
    buffer_load_dwordx4 v[112:115], v15, s[24:27], s58 offen offset:0 sc1
    buffer_load_dwordx4 v[116:119], v16, s[24:27], s58 offen offset:0 sc1
    s_add_u32 m0, s52, 49152
    s_add_u32 s57, s60, 344064
    buffer_load_dwordx4 v8, s[16:19], s57 offen nt lds
    buffer_load_dwordx4 v9, s[16:19], s57 offen offset:1024 nt lds
    buffer_load_dwordx4 v[120:123], v15, s[24:27], s58 offen offset:2048 sc1
    buffer_load_dwordx4 v[124:127], v16, s[24:27], s58 offen offset:2048 sc1
    s_add_u32 m0, s52, 57344
    s_add_u32 s57, s60, 401408
    buffer_load_dwordx4 v8, s[16:19], s57 offen nt lds
    buffer_load_dwordx4 v9, s[16:19], s57 offen offset:1024 nt lds
    s_add_u32 s58, s64, 8192
    buffer_load_dwordx4 v[128:131], v15, s[24:27], s58 offen offset:0 sc1
    buffer_load_dwordx4 v[132:135], v16, s[24:27], s58 offen offset:0 sc1
    s_waitcnt vmcnt(24)
    ds_read_b64_tr_b16 a[0:1], v2 offset:0
    ds_read_b64_tr_b16 a[2:3], v2 offset:512
    ds_read_b64_tr_b16 a[4:5], v2 offset:256
    ds_read_b64_tr_b16 a[6:7], v2 offset:768
    s_add_u32 m0, s52, 65536
    s_add_u32 s57, s61, 0
    buffer_load_dwordx4 v8, s[16:19], s57 offen nt lds
    buffer_load_dwordx4 v9, s[16:19], s57 offen offset:1024 nt lds
    s_waitcnt vmcnt(24)
    ds_read_b64_tr_b16 a[8:9], v2 offset:8192
    ds_read_b64_tr_b16 a[10:11], v2 offset:8704
    ds_read_b64_tr_b16 a[12:13], v2 offset:8448
    ds_read_b64_tr_b16 a[14:15], v2 offset:8960
    buffer_load_dwordx4 v[136:139], v15, s[24:27], s58 offen offset:2048 sc1
    buffer_load_dwordx4 v[140:143], v16, s[24:27], s58 offen offset:2048 sc1
    s_waitcnt vmcnt(24)
    ds_read_b64_tr_b16 a[16:17], v2 offset:16384
    ds_read_b64_tr_b16 a[18:19], v2 offset:16896
    ds_read_b64_tr_b16 a[20:21], v2 offset:16640
    ds_read_b64_tr_b16 a[22:23], v2 offset:17152
    s_add_u32 m0, s52, 73728
    s_add_u32 s57, s61, 57344
    buffer_load_dwordx4 v8, s[16:19], s57 offen nt lds
    buffer_load_dwordx4 v9, s[16:19], s57 offen offset:1024 nt lds
    s_waitcnt vmcnt(24)
    ds_read_b64_tr_b16 a[24:25], v2 offset:24576
    ds_read_b64_tr_b16 a[26:27], v2 offset:25088
    ds_read_b64_tr_b16 a[28:29], v2 offset:24832
    ds_read_b64_tr_b16 a[30:31], v2 offset:25344
    s_add_u32 s58, s64, 12288
    buffer_load_dwordx4 v[144:147], v15, s[24:27], s58 offen offset:0 sc1
    s_waitcnt vmcnt(24)
    s_waitcnt lgkmcnt(12)
    v_mfma_f32_32x32x16_bf16 v[32:47], a[0:3], v[96:99], v[32:47]
    buffer_load_dwordx4 v[148:151], v16, s[24:27], s58 offen offset:0 sc1
    v_mfma_f32_32x32x16_bf16 v[64:79], a[4:7], v[96:99], 0
    s_add_u32 m0, s52, 81920
    s_add_u32 s57, s61, 114688
    buffer_load_dwordx4 v8, s[16:19], s57 offen nt lds
    s_waitcnt vmcnt(25)
    v_mfma_f32_32x32x16_bf16 v[48:63], a[0:3], v[100:103], 0
    buffer_load_dwordx4 v9, s[16:19], s57 offen offset:1024 nt lds
    v_mfma_f32_32x32x16_bf16 v[80:95], a[4:7], v[100:103], 0
    s_waitcnt vmcnt(24)
    ds_read_b64_tr_b16 a[32:33], v2 offset:32768
    ds_read_b64_tr_b16 a[34:35], v2 offset:33280
    ds_read_b64_tr_b16 a[36:37], v2 offset:33024
    ds_read_b64_tr_b16 a[38:39], v2 offset:33536
    buffer_load_dwordx4 v[152:155], v15, s[24:27], s58 offen offset:2048 sc1
    s_waitcnt vmcnt(24)
    s_waitcnt lgkmcnt(12)
    v_mfma_f32_32x32x16_bf16 v[32:47], a[8:11], v[104:107], v[32:47]
    buffer_load_dwordx4 v[156:159], v16, s[24:27], s58 offen offset:2048 sc1
    v_mfma_f32_32x32x16_bf16 v[64:79], a[12:15], v[104:107], v[64:79]
    s_add_u32 m0, s52, 90112
    s_add_u32 s57, s61, 172032
    buffer_load_dwordx4 v8, s[16:19], s57 offen nt lds
    s_waitcnt vmcnt(25)
    v_mfma_f32_32x32x16_bf16 v[48:63], a[8:11], v[108:111], v[48:63]
    buffer_load_dwordx4 v9, s[16:19], s57 offen offset:1024 nt lds
    v_mfma_f32_32x32x16_bf16 v[80:95], a[12:15], v[108:111], v[80:95]
    s_waitcnt vmcnt(24)
    ds_read_b64_tr_b16 a[40:41], v2 offset:40960
    ds_read_b64_tr_b16 a[42:43], v2 offset:41472
    ds_read_b64_tr_b16 a[44:45], v2 offset:41216
    ds_read_b64_tr_b16 a[46:47], v2 offset:41728
    s_add_u32 s58, s65, 0
    buffer_load_dwordx4 v[160:163], v15, s[24:27], s58 offen offset:0 sc1
    s_waitcnt vmcnt(24)
    s_waitcnt lgkmcnt(12)
    v_mfma_f32_32x32x16_bf16 v[32:47], a[16:19], v[112:115], v[32:47]
    buffer_load_dwordx4 v[164:167], v16, s[24:27], s58 offen offset:0 sc1
    v_mfma_f32_32x32x16_bf16 v[64:79], a[20:23], v[112:115], v[64:79]
    s_add_u32 m0, s52, 98304
    s_add_u32 s57, s61, 229376
    buffer_load_dwordx4 v8, s[16:19], s57 offen nt lds
    s_waitcnt vmcnt(25)
    v_mfma_f32_32x32x16_bf16 v[48:63], a[16:19], v[116:119], v[48:63]
    buffer_load_dwordx4 v9, s[16:19], s57 offen offset:1024 nt lds
    v_mfma_f32_32x32x16_bf16 v[80:95], a[20:23], v[116:119], v[80:95]
    s_waitcnt vmcnt(24)
    ds_read_b64_tr_b16 a[48:49], v2 offset:49152
    ds_read_b64_tr_b16 a[50:51], v2 offset:49664
    ds_read_b64_tr_b16 a[52:53], v2 offset:49408
    ds_read_b64_tr_b16 a[54:55], v2 offset:49920
    buffer_load_dwordx4 v[168:171], v15, s[24:27], s58 offen offset:2048 sc1
    s_waitcnt vmcnt(24)
    s_waitcnt lgkmcnt(12)
    v_mfma_f32_32x32x16_bf16 v[32:47], a[24:27], v[120:123], v[32:47]
    buffer_load_dwordx4 v[172:175], v16, s[24:27], s58 offen offset:2048 sc1
    v_mfma_f32_32x32x16_bf16 v[64:79], a[28:31], v[120:123], v[64:79]
    s_add_u32 m0, s52, 106496
    s_add_u32 s57, s61, 286720
    buffer_load_dwordx4 v8, s[16:19], s57 offen nt lds
    s_waitcnt vmcnt(25)
    v_mfma_f32_32x32x16_bf16 v[48:63], a[24:27], v[124:127], v[48:63]
    buffer_load_dwordx4 v9, s[16:19], s57 offen offset:1024 nt lds
    v_mfma_f32_32x32x16_bf16 v[80:95], a[28:31], v[124:127], v[80:95]
    s_waitcnt vmcnt(24)
    ds_read_b64_tr_b16 a[56:57], v2 offset:57344
    ds_read_b64_tr_b16 a[58:59], v2 offset:57856
    ds_read_b64_tr_b16 a[60:61], v2 offset:57600
    ds_read_b64_tr_b16 a[62:63], v2 offset:58112
    s_add_u32 s58, s65, 4096
    buffer_load_dwordx4 v[176:179], v15, s[24:27], s58 offen offset:0 sc1
    s_waitcnt vmcnt(24)
    s_waitcnt lgkmcnt(12)
    v_mfma_f32_32x32x16_bf16 v[32:47], a[32:35], v[128:131], v[32:47]
    buffer_load_dwordx4 v[180:183], v16, s[24:27], s58 offen offset:0 sc1
    v_mfma_f32_32x32x16_bf16 v[64:79], a[36:39], v[128:131], v[64:79]
    s_add_u32 m0, s52, 114688
    s_add_u32 s57, s61, 344064
    buffer_load_dwordx4 v8, s[16:19], s57 offen nt lds
    s_waitcnt vmcnt(25)
    v_mfma_f32_32x32x16_bf16 v[48:63], a[32:35], v[132:135], v[48:63]
    buffer_load_dwordx4 v9, s[16:19], s57 offen offset:1024 nt lds
    v_mfma_f32_32x32x16_bf16 v[80:95], a[36:39], v[132:135], v[80:95]
    s_waitcnt vmcnt(24)
    ds_read_b64_tr_b16 a[64:65], v3 offset:0
    ds_read_b64_tr_b16 a[66:67], v3 offset:512
    ds_read_b64_tr_b16 a[68:69], v3 offset:256
    ds_read_b64_tr_b16 a[70:71], v3 offset:768
    buffer_load_dwordx4 v[184:187], v15, s[24:27], s58 offen offset:2048 sc1
    s_waitcnt vmcnt(24)
    s_waitcnt lgkmcnt(12)
    v_mfma_f32_32x32x16_bf16 v[32:47], a[40:43], v[136:139], v[32:47]
    buffer_load_dwordx4 v[188:191], v16, s[24:27], s58 offen offset:2048 sc1
    v_mfma_f32_32x32x16_bf16 v[64:79], a[44:47], v[136:139], v[64:79]
    s_add_u32 m0, s52, 122880
    s_add_u32 s57, s61, 401408
    buffer_load_dwordx4 v8, s[16:19], s57 offen nt lds
    s_waitcnt vmcnt(25)
    v_mfma_f32_32x32x16_bf16 v[48:63], a[40:43], v[140:143], v[48:63]
    buffer_load_dwordx4 v9, s[16:19], s57 offen offset:1024 nt lds
    v_mfma_f32_32x32x16_bf16 v[80:95], a[44:47], v[140:143], v[80:95]
    s_waitcnt vmcnt(24)
    ds_read_b64_tr_b16 a[72:73], v3 offset:8192
    ds_read_b64_tr_b16 a[74:75], v3 offset:8704
    ds_read_b64_tr_b16 a[76:77], v3 offset:8448
    ds_read_b64_tr_b16 a[78:79], v3 offset:8960
    s_add_u32 s58, s65, 8192
    buffer_load_dwordx4 v[192:195], v15, s[24:27], s58 offen offset:0 sc1
    s_waitcnt vmcnt(24)
    s_waitcnt lgkmcnt(12)
    v_mfma_f32_32x32x16_bf16 v[32:47], a[48:51], v[144:147], v[32:47]
    buffer_load_dwordx4 v[196:199], v16, s[24:27], s58 offen offset:0 sc1
    v_mfma_f32_32x32x16_bf16 v[64:79], a[52:55], v[144:147], v[64:79]
    s_add_u32 m0, s52, 131072
    s_add_u32 s57, s62, 0
    buffer_load_dwordx4 v8, s[16:19], s57 offen nt lds
    s_waitcnt vmcnt(25)
    v_mfma_f32_32x32x16_bf16 v[48:63], a[48:51], v[148:151], v[48:63]
    buffer_load_dwordx4 v9, s[16:19], s57 offen offset:1024 nt lds
    v_mfma_f32_32x32x16_bf16 v[80:95], a[52:55], v[148:151], v[80:95]
    s_waitcnt vmcnt(24)
    ds_read_b64_tr_b16 a[80:81], v3 offset:16384
    ds_read_b64_tr_b16 a[82:83], v3 offset:16896
    ds_read_b64_tr_b16 a[84:85], v3 offset:16640
    ds_read_b64_tr_b16 a[86:87], v3 offset:17152
    buffer_load_dwordx4 v[200:203], v15, s[24:27], s58 offen offset:2048 sc1
    s_waitcnt vmcnt(24)
    s_waitcnt lgkmcnt(12)
    v_mfma_f32_32x32x16_bf16 v[32:47], a[56:59], v[152:155], v[32:47]
    buffer_load_dwordx4 v[204:207], v16, s[24:27], s58 offen offset:2048 sc1
    v_mfma_f32_32x32x16_bf16 v[64:79], a[60:63], v[152:155], v[64:79]
    s_add_u32 m0, s52, 139264
    s_add_u32 s57, s62, 57344
    buffer_load_dwordx4 v8, s[16:19], s57 offen nt lds
    s_waitcnt vmcnt(25)
    v_mfma_f32_32x32x16_bf16 v[48:63], a[56:59], v[156:159], v[48:63]
    buffer_load_dwordx4 v9, s[16:19], s57 offen offset:1024 nt lds
    v_mfma_f32_32x32x16_bf16 v[80:95], a[60:63], v[156:159], v[80:95]
    s_waitcnt vmcnt(24)
    ds_read_b64_tr_b16 a[88:89], v3 offset:24576
    ds_read_b64_tr_b16 a[90:91], v3 offset:25088
    ds_read_b64_tr_b16 a[92:93], v3 offset:24832
    ds_read_b64_tr_b16 a[94:95], v3 offset:25344
    s_add_u32 s58, s65, 12288
    buffer_load_dwordx4 v[208:211], v15, s[24:27], s58 offen offset:0 sc1
    s_waitcnt vmcnt(24)
    s_waitcnt lgkmcnt(12)
    v_mfma_f32_32x32x16_bf16 v[32:47], a[64:67], v[160:163], v[32:47]
    buffer_load_dwordx4 v[212:215], v16, s[24:27], s58 offen offset:0 sc1
    v_mfma_f32_32x32x16_bf16 v[64:79], a[68:71], v[160:163], v[64:79]
    s_add_u32 m0, s52, 147456
    s_add_u32 s57, s62, 114688
    buffer_load_dwordx4 v8, s[16:19], s57 offen nt lds
    s_waitcnt vmcnt(25)
    v_mfma_f32_32x32x16_bf16 v[48:63], a[64:67], v[164:167], v[48:63]
    buffer_load_dwordx4 v9, s[16:19], s57 offen offset:1024 nt lds
    v_mfma_f32_32x32x16_bf16 v[80:95], a[68:71], v[164:167], v[80:95]
    s_waitcnt vmcnt(24)
    ds_read_b64_tr_b16 a[96:97], v3 offset:32768
    ds_read_b64_tr_b16 a[98:99], v3 offset:33280
    ds_read_b64_tr_b16 a[100:101], v3 offset:33024
    ds_read_b64_tr_b16 a[102:103], v3 offset:33536
    buffer_load_dwordx4 v[216:219], v15, s[24:27], s58 offen offset:2048 sc1
    s_waitcnt vmcnt(24)
    s_waitcnt lgkmcnt(12)
    v_mfma_f32_32x32x16_bf16 v[32:47], a[72:75], v[168:171], v[32:47]
    buffer_load_dwordx4 v[220:223], v16, s[24:27], s58 offen offset:2048 sc1
    v_mfma_f32_32x32x16_bf16 v[64:79], a[76:79], v[168:171], v[64:79]
    s_add_u32 m0, s52, 155648
    s_add_u32 s57, s62, 172032
    buffer_load_dwordx4 v8, s[16:19], s57 offen nt lds
    s_waitcnt vmcnt(25)
    v_mfma_f32_32x32x16_bf16 v[48:63], a[72:75], v[172:175], v[48:63]
    buffer_load_dwordx4 v9, s[16:19], s57 offen offset:1024 nt lds
    v_mfma_f32_32x32x16_bf16 v[80:95], a[76:79], v[172:175], v[80:95]
    s_waitcnt vmcnt(24)
    ds_read_b64_tr_b16 a[104:105], v3 offset:40960
    ds_read_b64_tr_b16 a[106:107], v3 offset:41472
    ds_read_b64_tr_b16 a[108:109], v3 offset:41216
    ds_read_b64_tr_b16 a[110:111], v3 offset:41728
    s_add_u32 s58, s66, 0
    buffer_load_dwordx4 v[224:227], v15, s[24:27], s58 offen offset:0 sc1
    s_waitcnt vmcnt(24)
    s_waitcnt lgkmcnt(12)
    v_mfma_f32_32x32x16_bf16 v[32:47], a[80:83], v[176:179], v[32:47]
    buffer_load_dwordx4 v[228:231], v16, s[24:27], s58 offen offset:0 sc1
    v_mfma_f32_32x32x16_bf16 v[64:79], a[84:87], v[176:179], v[64:79]
    s_add_u32 m0, s52, 0
    s_add_u32 s57, s62, 229376
    buffer_load_dwordx4 v8, s[16:19], s57 offen nt lds
    s_waitcnt vmcnt(25)
    v_mfma_f32_32x32x16_bf16 v[48:63], a[80:83], v[180:183], v[48:63]
    buffer_load_dwordx4 v9, s[16:19], s57 offen offset:1024 nt lds
    v_mfma_f32_32x32x16_bf16 v[80:95], a[84:87], v[180:183], v[80:95]
    s_waitcnt vmcnt(24)
    ds_read_b64_tr_b16 a[112:113], v3 offset:49152
    ds_read_b64_tr_b16 a[114:115], v3 offset:49664
    ds_read_b64_tr_b16 a[116:117], v3 offset:49408
    ds_read_b64_tr_b16 a[118:119], v3 offset:49920
    buffer_load_dwordx4 v[232:235], v15, s[24:27], s58 offen offset:2048 sc1
    s_waitcnt vmcnt(24)
    s_waitcnt lgkmcnt(12)
    v_mfma_f32_32x32x16_bf16 v[32:47], a[88:91], v[184:187], v[32:47]
    buffer_load_dwordx4 v[236:239], v16, s[24:27], s58 offen offset:2048 sc1
    v_mfma_f32_32x32x16_bf16 v[64:79], a[92:95], v[184:187], v[64:79]
    s_add_u32 m0, s52, 8192
    s_add_u32 s57, s62, 286720
    buffer_load_dwordx4 v8, s[16:19], s57 offen nt lds
    s_waitcnt vmcnt(25)
    v_mfma_f32_32x32x16_bf16 v[48:63], a[88:91], v[188:191], v[48:63]
    buffer_load_dwordx4 v9, s[16:19], s57 offen offset:1024 nt lds
    v_mfma_f32_32x32x16_bf16 v[80:95], a[92:95], v[188:191], v[80:95]
    s_waitcnt vmcnt(24)
    ds_read_b64_tr_b16 a[120:121], v3 offset:57344
    ds_read_b64_tr_b16 a[122:123], v3 offset:57856
    ds_read_b64_tr_b16 a[124:125], v3 offset:57600
    ds_read_b64_tr_b16 a[126:127], v3 offset:58112
    s_add_u32 s58, s66, 4096
    buffer_load_dwordx4 v[240:243], v15, s[24:27], s58 offen offset:0 sc1
    s_waitcnt vmcnt(24)
    s_waitcnt lgkmcnt(12)
    v_mfma_f32_32x32x16_bf16 v[32:47], a[96:99], v[192:195], v[32:47]
    buffer_load_dwordx4 v[244:247], v16, s[24:27], s58 offen offset:0 sc1
    v_mfma_f32_32x32x16_bf16 v[64:79], a[100:103], v[192:195], v[64:79]
    s_add_u32 m0, s52, 16384
    s_add_u32 s57, s62, 344064
    buffer_load_dwordx4 v8, s[16:19], s57 offen nt lds
    s_waitcnt vmcnt(25)
    v_mfma_f32_32x32x16_bf16 v[48:63], a[96:99], v[196:199], v[48:63]
    buffer_load_dwordx4 v9, s[16:19], s57 offen offset:1024 nt lds
    v_mfma_f32_32x32x16_bf16 v[80:95], a[100:103], v[196:199], v[80:95]
    s_waitcnt vmcnt(24)
    ds_read_b64_tr_b16 a[128:129], v4 offset:0
    ds_read_b64_tr_b16 a[130:131], v4 offset:512
    ds_read_b64_tr_b16 a[132:133], v4 offset:256
    ds_read_b64_tr_b16 a[134:135], v4 offset:768
    buffer_load_dwordx4 v[248:251], v15, s[24:27], s58 offen offset:2048 sc1
    s_waitcnt vmcnt(24)
    s_waitcnt lgkmcnt(12)
    v_mfma_f32_32x32x16_bf16 v[32:47], a[104:107], v[200:203], v[32:47]
    buffer_load_dwordx4 v[252:255], v16, s[24:27], s58 offen offset:2048 sc1
    v_mfma_f32_32x32x16_bf16 v[64:79], a[108:111], v[200:203], v[64:79]
    s_add_u32 m0, s52, 24576
    s_add_u32 s57, s62, 401408
    buffer_load_dwordx4 v8, s[16:19], s57 offen nt lds
    s_waitcnt vmcnt(25)
    v_mfma_f32_32x32x16_bf16 v[48:63], a[104:107], v[204:207], v[48:63]
    buffer_load_dwordx4 v9, s[16:19], s57 offen offset:1024 nt lds
    v_mfma_f32_32x32x16_bf16 v[80:95], a[108:111], v[204:207], v[80:95]
    s_waitcnt vmcnt(24)
    ds_read_b64_tr_b16 a[136:137], v4 offset:8192
    ds_read_b64_tr_b16 a[138:139], v4 offset:8704
    ds_read_b64_tr_b16 a[140:141], v4 offset:8448
    ds_read_b64_tr_b16 a[142:143], v4 offset:8960
    s_add_u32 s58, s66, 8192
    buffer_load_dwordx4 v[96:99], v15, s[24:27], s58 offen offset:0 sc1
    s_waitcnt vmcnt(24)
    s_waitcnt lgkmcnt(12)
    v_mfma_f32_32x32x16_bf16 v[32:47], a[112:115], v[208:211], v[32:47]
    buffer_load_dwordx4 v[100:103], v16, s[24:27], s58 offen offset:0 sc1
    v_mfma_f32_32x32x16_bf16 v[64:79], a[116:119], v[208:211], v[64:79]
    s_add_u32 m0, s52, 32768
    s_add_u32 s57, s63, 0
    buffer_load_dwordx4 v8, s[16:19], s57 offen nt lds
    s_waitcnt vmcnt(25)
    v_mfma_f32_32x32x16_bf16 v[48:63], a[112:115], v[212:215], v[48:63]
    buffer_load_dwordx4 v9, s[16:19], s57 offen offset:1024 nt lds
    v_mfma_f32_32x32x16_bf16 v[80:95], a[116:119], v[212:215], v[80:95]
    s_waitcnt vmcnt(24)
    ds_read_b64_tr_b16 a[144:145], v4 offset:16384
    ds_read_b64_tr_b16 a[146:147], v4 offset:16896
    ds_read_b64_tr_b16 a[148:149], v4 offset:16640
    ds_read_b64_tr_b16 a[150:151], v4 offset:17152
    buffer_load_dwordx4 v[104:107], v15, s[24:27], s58 offen offset:2048 sc1
    s_waitcnt vmcnt(24)
    s_waitcnt lgkmcnt(12)
    v_mfma_f32_32x32x16_bf16 v[32:47], a[120:123], v[216:219], v[32:47]
    buffer_load_dwordx4 v[108:111], v16, s[24:27], s58 offen offset:2048 sc1
    v_mfma_f32_32x32x16_bf16 v[64:79], a[124:127], v[216:219], v[64:79]
    s_add_u32 m0, s52, 40960
    s_add_u32 s57, s63, 57344
    buffer_load_dwordx4 v8, s[16:19], s57 offen nt lds
    s_waitcnt vmcnt(25)
    v_mfma_f32_32x32x16_bf16 v[48:63], a[120:123], v[220:223], v[48:63]
    buffer_load_dwordx4 v9, s[16:19], s57 offen offset:1024 nt lds
    v_mfma_f32_32x32x16_bf16 v[80:95], a[124:127], v[220:223], v[80:95]
    s_waitcnt vmcnt(24)
    ds_read_b64_tr_b16 a[152:153], v4 offset:24576
    ds_read_b64_tr_b16 a[154:155], v4 offset:25088
    ds_read_b64_tr_b16 a[156:157], v4 offset:24832
    ds_read_b64_tr_b16 a[158:159], v4 offset:25344
    s_add_u32 s58, s66, 12288
    buffer_load_dwordx4 v[112:115], v15, s[24:27], s58 offen offset:0 sc1
    s_waitcnt vmcnt(24)
    s_waitcnt lgkmcnt(12)
    v_mfma_f32_32x32x16_bf16 v[32:47], a[128:131], v[224:227], v[32:47]
    buffer_load_dwordx4 v[116:119], v16, s[24:27], s58 offen offset:0 sc1
    v_mfma_f32_32x32x16_bf16 v[64:79], a[132:135], v[224:227], v[64:79]
    s_add_u32 m0, s52, 49152
    s_add_u32 s57, s63, 114688
    buffer_load_dwordx4 v8, s[16:19], s57 offen nt lds
    s_waitcnt vmcnt(25)
    v_mfma_f32_32x32x16_bf16 v[48:63], a[128:131], v[228:231], v[48:63]
    buffer_load_dwordx4 v9, s[16:19], s57 offen offset:1024 nt lds
    v_mfma_f32_32x32x16_bf16 v[80:95], a[132:135], v[228:231], v[80:95]
    s_waitcnt vmcnt(24)
    ds_read_b64_tr_b16 a[160:161], v2 offset:0
    ds_read_b64_tr_b16 a[162:163], v2 offset:512
    ds_read_b64_tr_b16 a[164:165], v2 offset:256
    ds_read_b64_tr_b16 a[166:167], v2 offset:768
    buffer_load_dwordx4 v[120:123], v15, s[24:27], s58 offen offset:2048 sc1
    s_waitcnt vmcnt(24)
    s_waitcnt lgkmcnt(12)
    v_mfma_f32_32x32x16_bf16 v[32:47], a[136:139], v[232:235], v[32:47]
    buffer_load_dwordx4 v[124:127], v16, s[24:27], s58 offen offset:2048 sc1
    v_mfma_f32_32x32x16_bf16 v[64:79], a[140:143], v[232:235], v[64:79]
    s_add_u32 m0, s52, 57344
    s_add_u32 s57, s63, 172032
    buffer_load_dwordx4 v8, s[16:19], s57 offen nt lds
    s_waitcnt vmcnt(25)
    v_mfma_f32_32x32x16_bf16 v[48:63], a[136:139], v[236:239], v[48:63]
    buffer_load_dwordx4 v9, s[16:19], s57 offen offset:1024 nt lds
    v_mfma_f32_32x32x16_bf16 v[80:95], a[140:143], v[236:239], v[80:95]
    s_waitcnt vmcnt(24)
    ds_read_b64_tr_b16 a[168:169], v2 offset:8192
    ds_read_b64_tr_b16 a[170:171], v2 offset:8704
    ds_read_b64_tr_b16 a[172:173], v2 offset:8448
    ds_read_b64_tr_b16 a[174:175], v2 offset:8960
    s_add_u32 s58, s67, 0
    buffer_load_dwordx4 v[128:131], v15, s[24:27], s58 offen offset:0 sc1
    s_waitcnt vmcnt(24)
    s_waitcnt lgkmcnt(12)
    v_mfma_f32_32x32x16_bf16 v[32:47], a[144:147], v[240:243], v[32:47]
    buffer_load_dwordx4 v[132:135], v16, s[24:27], s58 offen offset:0 sc1
    v_mfma_f32_32x32x16_bf16 v[64:79], a[148:151], v[240:243], v[64:79]
    s_add_u32 m0, s52, 65536
    s_add_u32 s57, s63, 229376
    buffer_load_dwordx4 v8, s[16:19], s57 offen nt lds
    s_waitcnt vmcnt(25)
    v_mfma_f32_32x32x16_bf16 v[48:63], a[144:147], v[244:247], v[48:63]
    buffer_load_dwordx4 v9, s[16:19], s57 offen offset:1024 nt lds
    v_mfma_f32_32x32x16_bf16 v[80:95], a[148:151], v[244:247], v[80:95]
    s_waitcnt vmcnt(24)
    ds_read_b64_tr_b16 a[176:177], v2 offset:16384
    ds_read_b64_tr_b16 a[178:179], v2 offset:16896
    ds_read_b64_tr_b16 a[180:181], v2 offset:16640
    ds_read_b64_tr_b16 a[182:183], v2 offset:17152
    buffer_load_dwordx4 v[136:139], v15, s[24:27], s58 offen offset:2048 sc1
    s_waitcnt vmcnt(24)
    s_waitcnt lgkmcnt(12)
    v_mfma_f32_32x32x16_bf16 v[32:47], a[152:155], v[248:251], v[32:47]
    buffer_load_dwordx4 v[140:143], v16, s[24:27], s58 offen offset:2048 sc1
    v_mfma_f32_32x32x16_bf16 v[64:79], a[156:159], v[248:251], v[64:79]
    s_add_u32 m0, s52, 73728
    s_add_u32 s57, s63, 286720
    buffer_load_dwordx4 v8, s[16:19], s57 offen nt lds
    s_waitcnt vmcnt(25)
    v_mfma_f32_32x32x16_bf16 v[48:63], a[152:155], v[252:255], v[48:63]
    buffer_load_dwordx4 v9, s[16:19], s57 offen offset:1024 nt lds
    v_mfma_f32_32x32x16_bf16 v[80:95], a[156:159], v[252:255], v[80:95]
    s_waitcnt vmcnt(24)
    ds_read_b64_tr_b16 a[184:185], v2 offset:24576
    ds_read_b64_tr_b16 a[186:187], v2 offset:25088
    ds_read_b64_tr_b16 a[188:189], v2 offset:24832
    ds_read_b64_tr_b16 a[190:191], v2 offset:25344
    s_add_u32 s58, s67, 4096
    buffer_load_dwordx4 v[144:147], v15, s[24:27], s58 offen offset:0 sc1
    s_waitcnt vmcnt(24)
    s_waitcnt lgkmcnt(12)
    v_mfma_f32_32x32x16_bf16 v[32:47], a[160:163], v[96:99], v[32:47]
    buffer_load_dwordx4 v[148:151], v16, s[24:27], s58 offen offset:0 sc1
    v_mfma_f32_32x32x16_bf16 v[64:79], a[164:167], v[96:99], v[64:79]
    s_add_u32 m0, s52, 81920
    s_add_u32 s57, s63, 344064
    buffer_load_dwordx4 v8, s[16:19], s57 offen nt lds
    s_waitcnt vmcnt(25)
    v_mfma_f32_32x32x16_bf16 v[48:63], a[160:163], v[100:103], v[48:63]
    buffer_load_dwordx4 v9, s[16:19], s57 offen offset:1024 nt lds
    v_mfma_f32_32x32x16_bf16 v[80:95], a[164:167], v[100:103], v[80:95]
    s_waitcnt vmcnt(24)
    ds_read_b64_tr_b16 a[192:193], v2 offset:32768
    ds_read_b64_tr_b16 a[194:195], v2 offset:33280
    ds_read_b64_tr_b16 a[196:197], v2 offset:33024
    ds_read_b64_tr_b16 a[198:199], v2 offset:33536
    buffer_load_dwordx4 v[152:155], v15, s[24:27], s58 offen offset:2048 sc1
    s_waitcnt vmcnt(24)
    s_waitcnt lgkmcnt(12)
    v_mfma_f32_32x32x16_bf16 v[32:47], a[168:171], v[104:107], v[32:47]
    buffer_load_dwordx4 v[156:159], v16, s[24:27], s58 offen offset:2048 sc1
    v_mfma_f32_32x32x16_bf16 v[64:79], a[172:175], v[104:107], v[64:79]
    s_add_u32 m0, s52, 90112
    s_add_u32 s57, s63, 401408
    buffer_load_dwordx4 v8, s[16:19], s57 offen nt lds
    s_waitcnt vmcnt(25)
    v_mfma_f32_32x32x16_bf16 v[48:63], a[168:171], v[108:111], v[48:63]
    buffer_load_dwordx4 v9, s[16:19], s57 offen offset:1024 nt lds
    v_mfma_f32_32x32x16_bf16 v[80:95], a[172:175], v[108:111], v[80:95]
    s_waitcnt vmcnt(24)
    ds_read_b64_tr_b16 a[200:201], v2 offset:40960
    ds_read_b64_tr_b16 a[202:203], v2 offset:41472
    ds_read_b64_tr_b16 a[204:205], v2 offset:41216
    ds_read_b64_tr_b16 a[206:207], v2 offset:41728
    s_add_u32 s58, s67, 8192
    buffer_load_dwordx4 v[160:163], v15, s[24:27], s58 offen offset:0 sc1
    s_waitcnt vmcnt(24)
    s_waitcnt lgkmcnt(12)
    v_mfma_f32_32x32x16_bf16 v[32:47], a[176:179], v[112:115], v[32:47]
    buffer_load_dwordx4 v[164:167], v16, s[24:27], s58 offen offset:0 sc1
    v_mfma_f32_32x32x16_bf16 v[64:79], a[180:183], v[112:115], v[64:79]
    buffer_load_dwordx4 v[168:171], v15, s[24:27], s58 offen offset:2048 sc1
    s_waitcnt vmcnt(25)
    v_mfma_f32_32x32x16_bf16 v[48:63], a[176:179], v[116:119], v[48:63]
    buffer_load_dwordx4 v[172:175], v16, s[24:27], s58 offen offset:2048 sc1
    v_mfma_f32_32x32x16_bf16 v[80:95], a[180:183], v[116:119], v[80:95]
    s_waitcnt vmcnt(24)
    ds_read_b64_tr_b16 a[208:209], v2 offset:49152
    ds_read_b64_tr_b16 a[210:211], v2 offset:49664
    ds_read_b64_tr_b16 a[212:213], v2 offset:49408
    ds_read_b64_tr_b16 a[214:215], v2 offset:49920
    s_add_u32 s58, s67, 12288
    buffer_load_dwordx4 v[176:179], v15, s[24:27], s58 offen offset:0 sc1
    s_waitcnt vmcnt(24)
    s_waitcnt lgkmcnt(12)
    v_mfma_f32_32x32x16_bf16 v[32:47], a[184:187], v[120:123], v[32:47]
    buffer_load_dwordx4 v[180:183], v16, s[24:27], s58 offen offset:0 sc1
    v_mfma_f32_32x32x16_bf16 v[64:79], a[188:191], v[120:123], v[64:79]
    buffer_load_dwordx4 v[184:187], v15, s[24:27], s58 offen offset:2048 sc1
    s_waitcnt vmcnt(25)
    v_mfma_f32_32x32x16_bf16 v[48:63], a[184:187], v[124:127], v[48:63]
    buffer_load_dwordx4 v[188:191], v16, s[24:27], s58 offen offset:2048 sc1
    v_mfma_f32_32x32x16_bf16 v[80:95], a[188:191], v[124:127], v[80:95]
    s_waitcnt vmcnt(24)
    ds_read_b64_tr_b16 a[216:217], v2 offset:57344
    ds_read_b64_tr_b16 a[218:219], v2 offset:57856
    ds_read_b64_tr_b16 a[220:221], v2 offset:57600
    ds_read_b64_tr_b16 a[222:223], v2 offset:58112
    s_waitcnt vmcnt(23)
    s_waitcnt lgkmcnt(12)
    v_mfma_f32_32x32x16_bf16 v[32:47], a[192:195], v[128:131], v[32:47]
    v_mfma_f32_32x32x16_bf16 v[64:79], a[196:199], v[128:131], v[64:79]
    s_waitcnt vmcnt(22)
    v_mfma_f32_32x32x16_bf16 v[48:63], a[192:195], v[132:135], v[48:63]
    v_mfma_f32_32x32x16_bf16 v[80:95], a[196:199], v[132:135], v[80:95]
    s_waitcnt vmcnt(20)
    ds_read_b64_tr_b16 a[224:225], v3 offset:0
    ds_read_b64_tr_b16 a[226:227], v3 offset:512
    ds_read_b64_tr_b16 a[228:229], v3 offset:256
    ds_read_b64_tr_b16 a[230:231], v3 offset:768
    s_waitcnt vmcnt(19)
    s_waitcnt lgkmcnt(12)
    v_mfma_f32_32x32x16_bf16 v[32:47], a[200:203], v[136:139], v[32:47]
    v_mfma_f32_32x32x16_bf16 v[64:79], a[204:207], v[136:139], v[64:79]
    s_waitcnt vmcnt(18)
    v_mfma_f32_32x32x16_bf16 v[48:63], a[200:203], v[140:143], v[48:63]
    v_mfma_f32_32x32x16_bf16 v[80:95], a[204:207], v[140:143], v[80:95]
    s_waitcnt vmcnt(16)
    ds_read_b64_tr_b16 a[232:233], v3 offset:8192
    ds_read_b64_tr_b16 a[234:235], v3 offset:8704
    ds_read_b64_tr_b16 a[236:237], v3 offset:8448
    ds_read_b64_tr_b16 a[238:239], v3 offset:8960
    s_waitcnt vmcnt(15)
    s_waitcnt lgkmcnt(12)
    v_mfma_f32_32x32x16_bf16 v[32:47], a[208:211], v[144:147], v[32:47]
    v_mfma_f32_32x32x16_bf16 v[64:79], a[212:215], v[144:147], v[64:79]
    s_waitcnt vmcnt(14)
    v_mfma_f32_32x32x16_bf16 v[48:63], a[208:211], v[148:151], v[48:63]
    v_mfma_f32_32x32x16_bf16 v[80:95], a[212:215], v[148:151], v[80:95]
    s_waitcnt vmcnt(12)
    ds_read_b64_tr_b16 a[240:241], v3 offset:16384
    ds_read_b64_tr_b16 a[242:243], v3 offset:16896
    ds_read_b64_tr_b16 a[244:245], v3 offset:16640
    ds_read_b64_tr_b16 a[246:247], v3 offset:17152
    s_waitcnt vmcnt(11)
    s_waitcnt lgkmcnt(12)
    v_mfma_f32_32x32x16_bf16 v[32:47], a[216:219], v[152:155], v[32:47]
    v_mfma_f32_32x32x16_bf16 v[64:79], a[220:223], v[152:155], v[64:79]
    s_waitcnt vmcnt(10)
    v_mfma_f32_32x32x16_bf16 v[48:63], a[216:219], v[156:159], v[48:63]
    v_mfma_f32_32x32x16_bf16 v[80:95], a[220:223], v[156:159], v[80:95]
    s_waitcnt vmcnt(8)
    ds_read_b64_tr_b16 a[248:249], v3 offset:24576
    ds_read_b64_tr_b16 a[250:251], v3 offset:25088
    ds_read_b64_tr_b16 a[252:253], v3 offset:24832
    ds_read_b64_tr_b16 a[254:255], v3 offset:25344
    s_waitcnt vmcnt(7)
    s_waitcnt lgkmcnt(12)
    v_mfma_f32_32x32x16_bf16 v[32:47], a[224:227], v[160:163], v[32:47]
    v_mfma_f32_32x32x16_bf16 v[64:79], a[228:231], v[160:163], v[64:79]
    s_waitcnt vmcnt(6)
    v_mfma_f32_32x32x16_bf16 v[48:63], a[224:227], v[164:167], v[48:63]
    v_mfma_f32_32x32x16_bf16 v[80:95], a[228:231], v[164:167], v[80:95]
    s_waitcnt vmcnt(5)
    s_waitcnt lgkmcnt(8)
    v_mfma_f32_32x32x16_bf16 v[32:47], a[232:235], v[168:171], v[32:47]
    v_mfma_f32_32x32x16_bf16 v[64:79], a[236:239], v[168:171], v[64:79]
    s_waitcnt vmcnt(4)
    v_mfma_f32_32x32x16_bf16 v[48:63], a[232:235], v[172:175], v[48:63]
    v_mfma_f32_32x32x16_bf16 v[80:95], a[236:239], v[172:175], v[80:95]
    s_waitcnt vmcnt(3)
    s_waitcnt lgkmcnt(4)
    v_mfma_f32_32x32x16_bf16 v[32:47], a[240:243], v[176:179], v[32:47]
    v_mfma_f32_32x32x16_bf16 v[64:79], a[244:247], v[176:179], v[64:79]
    s_waitcnt vmcnt(2)
    v_mfma_f32_32x32x16_bf16 v[48:63], a[240:243], v[180:183], v[48:63]
    v_mfma_f32_32x32x16_bf16 v[80:95], a[244:247], v[180:183], v[80:95]
    s_waitcnt vmcnt(1)
    s_waitcnt lgkmcnt(0)
    v_mfma_f32_32x32x16_bf16 v[32:47], a[248:251], v[184:187], v[32:47]
    v_mfma_f32_32x32x16_bf16 v[64:79], a[252:255], v[184:187], v[64:79]
    s_waitcnt vmcnt(0)
    v_mfma_f32_32x32x16_bf16 v[48:63], a[248:251], v[188:191], v[48:63]
    v_mfma_f32_32x32x16_bf16 v[80:95], a[252:255], v[188:191], v[80:95]
    v_add_u32 v19, s52, v14
    v_xor_b32 v20, 2048, v19
    v_xor_b32 v21, 4096, v19
    v_xor_b32 v22, 6144, v19
    s_nop 6
    ds_write_b128 v19, v[48:51] offset:0
    ds_write_b128 v19, v[52:55] offset:1024
    ds_write_b128 v19, v[56:59] offset:8192
    ds_write_b128 v19, v[60:63] offset:9216
    ds_write_b128 v19, v[64:67] offset:16384
    ds_write_b128 v19, v[68:71] offset:17408
    ds_write_b128 v19, v[72:75] offset:24576
    ds_write_b128 v19, v[76:79] offset:25600
    ds_write_b128 v19, v[80:83] offset:32768
    ds_write_b128 v19, v[84:87] offset:33792
    ds_write_b128 v19, v[88:91] offset:40960
    ds_write_b128 v19, v[92:95] offset:41984
    s_waitcnt lgkmcnt(0)
    s_barrier
    ds_read_b128 v[96:99], v20 offset:0
    ds_read_b128 v[112:115], v21 offset:16384
    ds_read_b128 v[128:131], v22 offset:32768
    ds_read_b128 v[100:103], v20 offset:1024
    ds_read_b128 v[116:119], v21 offset:17408
    ds_read_b128 v[132:135], v22 offset:33792
    ds_read_b128 v[104:107], v20 offset:8192
    ds_read_b128 v[120:123], v21 offset:24576
    ds_read_b128 v[136:139], v22 offset:40960
    ds_read_b128 v[108:111], v20 offset:9216
    ds_read_b128 v[124:127], v21 offset:25600
    ds_read_b128 v[140:143], v22 offset:41984
    s_mov_b32 s76, 0xbdd2d3e8
    v_mov_b32 v24, 0xc0135761
    s_mul_i32 s53, s51, 229376
    s_lshl_b32 s54, s50, 13
    s_add_u32 s53, s53, s54
    s_lshr_b32 s54, s44, 1
    s_lshl_b32 s54, s54, 12
    s_add_u32 s53, s53, s54
    s_add_u32 s53, s53, 2097152
    s_waitcnt lgkmcnt(9)
    v_pk_add_f32 v[96:97], v[96:97], v[112:113]
    v_pk_add_f32 v[32:33], v[32:33], v[128:129]
    v_pk_add_f32 v[98:99], v[98:99], v[114:115]
    v_pk_add_f32 v[34:35], v[34:35], v[130:131]
    v_pk_add_f32 v[32:33], v[32:33], v[96:97]
    v_pk_add_f32 v[34:35], v[34:35], v[98:99]
    v_mul_f32 v160, v32, v32
    v_mul_f32 v161, v33, v33
    v_mul_f32 v162, v34, v34
    v_mul_f32 v163, v35, v35
    v_fma_f32 v160, v160, s76, v24
    v_fma_f32 v161, v161, s76, v24
    v_fma_f32 v162, v162, s76, v24
    v_fma_f32 v163, v163, s76, v24
    v_mul_f32 v160, v160, v32
    v_mul_f32 v161, v161, v33
    v_mul_f32 v162, v162, v34
    v_mul_f32 v163, v163, v35
    v_exp_f32 v160, v160
    v_exp_f32 v161, v161
    v_exp_f32 v162, v162
    v_exp_f32 v163, v163
    v_add_f32 v160, 1.0, v160
    v_add_f32 v161, 1.0, v161
    v_add_f32 v162, 1.0, v162
    v_add_f32 v163, 1.0, v163
    v_rcp_f32 v160, v160
    v_rcp_f32 v161, v161
    v_rcp_f32 v162, v162
    v_rcp_f32 v163, v163
    v_mul_f32 v160, v160, v32
    v_mul_f32 v161, v161, v33
    v_mul_f32 v162, v162, v34
    v_mul_f32 v163, v163, v35
    v_cvt_pk_bf16_f32 v168, v160, v161
    v_cvt_pk_bf16_f32 v169, v162, v163
    s_waitcnt lgkmcnt(6)
    v_pk_add_f32 v[100:101], v[100:101], v[116:117]
    v_pk_add_f32 v[36:37], v[36:37], v[132:133]
    v_pk_add_f32 v[102:103], v[102:103], v[118:119]
    v_pk_add_f32 v[38:39], v[38:39], v[134:135]
    v_pk_add_f32 v[36:37], v[36:37], v[100:101]
    v_pk_add_f32 v[38:39], v[38:39], v[102:103]
    v_mul_f32 v160, v36, v36
    v_mul_f32 v161, v37, v37
    v_mul_f32 v162, v38, v38
    v_mul_f32 v163, v39, v39
    v_fma_f32 v160, v160, s76, v24
    v_fma_f32 v161, v161, s76, v24
    v_fma_f32 v162, v162, s76, v24
    v_fma_f32 v163, v163, s76, v24
    v_mul_f32 v160, v160, v36
    v_mul_f32 v161, v161, v37
    v_mul_f32 v162, v162, v38
    v_mul_f32 v163, v163, v39
    v_exp_f32 v160, v160
    v_exp_f32 v161, v161
    v_exp_f32 v162, v162
    v_exp_f32 v163, v163
    v_add_f32 v160, 1.0, v160
    v_add_f32 v161, 1.0, v161
    v_add_f32 v162, 1.0, v162
    v_add_f32 v163, 1.0, v163
    v_rcp_f32 v160, v160
    v_rcp_f32 v161, v161
    v_rcp_f32 v162, v162
    v_rcp_f32 v163, v163
    v_mul_f32 v160, v160, v36
    v_mul_f32 v161, v161, v37
    v_mul_f32 v162, v162, v38
    v_mul_f32 v163, v163, v39
    v_cvt_pk_bf16_f32 v170, v160, v161
    v_cvt_pk_bf16_f32 v171, v162, v163
    buffer_store_dwordx4 v[168:171], v15, s[24:27], s53 offen offset:0 sc1
    s_waitcnt lgkmcnt(3)
    v_pk_add_f32 v[104:105], v[104:105], v[120:121]
    v_pk_add_f32 v[40:41], v[40:41], v[136:137]
    v_pk_add_f32 v[106:107], v[106:107], v[122:123]
    v_pk_add_f32 v[42:43], v[42:43], v[138:139]
    v_pk_add_f32 v[40:41], v[40:41], v[104:105]
    v_pk_add_f32 v[42:43], v[42:43], v[106:107]
    v_mul_f32 v160, v40, v40
    v_mul_f32 v161, v41, v41
    v_mul_f32 v162, v42, v42
    v_mul_f32 v163, v43, v43
    v_fma_f32 v160, v160, s76, v24
    v_fma_f32 v161, v161, s76, v24
    v_fma_f32 v162, v162, s76, v24
    v_fma_f32 v163, v163, s76, v24
    v_mul_f32 v160, v160, v40
    v_mul_f32 v161, v161, v41
    v_mul_f32 v162, v162, v42
    v_mul_f32 v163, v163, v43
    v_exp_f32 v160, v160
    v_exp_f32 v161, v161
    v_exp_f32 v162, v162
    v_exp_f32 v163, v163
    v_add_f32 v160, 1.0, v160
    v_add_f32 v161, 1.0, v161
    v_add_f32 v162, 1.0, v162
    v_add_f32 v163, 1.0, v163
    v_rcp_f32 v160, v160
    v_rcp_f32 v161, v161
    v_rcp_f32 v162, v162
    v_rcp_f32 v163, v163
    v_mul_f32 v160, v160, v40
    v_mul_f32 v161, v161, v41
    v_mul_f32 v162, v162, v42
    v_mul_f32 v163, v163, v43
    v_cvt_pk_bf16_f32 v172, v160, v161
    v_cvt_pk_bf16_f32 v173, v162, v163
    s_waitcnt lgkmcnt(0)
    v_pk_add_f32 v[108:109], v[108:109], v[124:125]
    v_pk_add_f32 v[44:45], v[44:45], v[140:141]
    v_pk_add_f32 v[110:111], v[110:111], v[126:127]
    v_pk_add_f32 v[46:47], v[46:47], v[142:143]
    v_pk_add_f32 v[44:45], v[44:45], v[108:109]
    v_pk_add_f32 v[46:47], v[46:47], v[110:111]
    v_mul_f32 v160, v44, v44
    v_mul_f32 v161, v45, v45
    v_mul_f32 v162, v46, v46
    v_mul_f32 v163, v47, v47
    v_fma_f32 v160, v160, s76, v24
    v_fma_f32 v161, v161, s76, v24
    v_fma_f32 v162, v162, s76, v24
    v_fma_f32 v163, v163, s76, v24
    v_mul_f32 v160, v160, v44
    v_mul_f32 v161, v161, v45
    v_mul_f32 v162, v162, v46
    v_mul_f32 v163, v163, v47
    v_exp_f32 v160, v160
    v_exp_f32 v161, v161
    v_exp_f32 v162, v162
    v_exp_f32 v163, v163
    v_add_f32 v160, 1.0, v160
    v_add_f32 v161, 1.0, v161
    v_add_f32 v162, 1.0, v162
    v_add_f32 v163, 1.0, v163
    v_rcp_f32 v160, v160
    v_rcp_f32 v161, v161
    v_rcp_f32 v162, v162
    v_rcp_f32 v163, v163
    v_mul_f32 v160, v160, v44
    v_mul_f32 v161, v161, v45
    v_mul_f32 v162, v162, v46
    v_mul_f32 v163, v163, v47
    v_cvt_pk_bf16_f32 v174, v160, v161
    v_cvt_pk_bf16_f32 v175, v162, v163
    buffer_store_dwordx4 v[172:175], v15, s[24:27], s53 offen offset:2048 sc1
    s_waitcnt vmcnt(0)
    s_barrier
    s_lshl_b32 s53, s51, 5
    s_add_u32 s53, s53, s50
    s_lshl_b32 s53, s53, 7
    s_add_u32 s53, s53, 12713984
    s_cmp_lg_u32 s44, 0
    s_cbranch_scc1 L_nopub7
    v_mov_b32 v29, 0
    v_mov_b32 v30, s47
    s_mov_b64 exec, 1
    buffer_store_dword v30, v29, s[24:27], s53 offen sc1
    s_mov_b64 exec, -1
L_nopub7:
L_p3:
    v_and_b32 v21, 7, v1
    v_min_u32 v21, 6, v21
    v_lshlrev_b32 v21, 7, v21
    s_lshl_b32 s53, s45, 10
    s_add_u32 s53, s53, 12779520
    v_add_u32 v18, s53, v21
    s_lshl_b32 s53, s49, 5
    s_mul_i32 s54, s44, 7
    s_add_u32 s53, s53, s54
    s_lshl_b32 s53, s53, 7
    s_add_u32 s53, s53, 12713984
    v_add_u32 v20, s53, v21
    s_lshl_b32 s76, s48, 16
    s_lshl_b32 s54, s44, 14
    s_add_u32 s76, s76, s54
    s_add_u32 s76, s76, 4194304
    s_mul_i32 s77, s49, 229376
    s_mul_i32 s54, s44, 57344
    s_add_u32 s77, s77, s54
    s_add_u32 s77, s77, 2097152
    s_lshl_b32 s54, s48, 1
    s_add_u32 s54, s54, s49
    s_and_b32 s54, s54, 3
    s_xor_b32 s56, s54, 0
    s_mul_i32 s60, s56, 458752
    s_mul_i32 s64, s56, 14336
    s_add_u32 s64, s64, s77
    s_xor_b32 s56, s54, 1
    s_mul_i32 s61, s56, 458752
    s_mul_i32 s65, s56, 14336
    s_add_u32 s65, s65, s77
    s_xor_b32 s56, s54, 2
    s_mul_i32 s62, s56, 458752
    s_mul_i32 s66, s56, 14336
    s_add_u32 s66, s66, s77
    s_xor_b32 s56, s54, 3
    s_mul_i32 s63, s56, 458752
    s_mul_i32 s67, s56, 14336
    s_add_u32 s67, s67, s77
    v_lshrrev_b32 v24, 3, v0
    v_and_b32 v25, 7, v0
    v_mul_u32_u24 v22, 896, v24
    v_lshl_add_u32 v22, v25, 4, v22
    v_lshlrev_b32 v23, 1, v24
    s_mul_i32 s78, s48, 57344
    s_lshl_b32 s54, s49, 7
    s_add_u32 s78, s78, s54
    s_add_u32 s79, s78, 28672
    s_lshl_b32 s80, s48, 7
    buffer_load_dwordx4 v[240:243], v22, s[4:7], s78 offen
    buffer_load_dwordx4 v[244:247], v22, s[4:7], s79 offen
    buffer_load_ushort v248, v23, s[36:39], s80 offen
    buffer_load_ushort v249, v23, s[36:39], s80 offen offset:64
    s_add_u32 m0, s52, 0
    s_mov_b32 s57, 0
    buffer_load_dwordx4 v12, s[12:15], s57 offen lds
    buffer_load_dwordx4 v13, s[12:15], s57 offen offset:1024 lds
    s_add_u32 m0, s52, 8192
    s_mov_b32 s57, 14336
    buffer_load_dwordx4 v12, s[12:15], s57 offen lds
    buffer_load_dwordx4 v13, s[12:15], s57 offen offset:1024 lds
    s_add_u32 m0, s52, 16384
    s_mov_b32 s57, 21504
    buffer_load_dwordx4 v12, s[12:15], s57 offen lds
    buffer_load_dwordx4 v13, s[12:15], s57 offen offset:1024 lds
    s_add_u32 m0, s52, 24576
    s_mov_b32 s57, 35840
    buffer_load_dwordx4 v12, s[12:15], s57 offen lds
    buffer_load_dwordx4 v13, s[12:15], s57 offen offset:1024 lds
    s_add_u32 m0, s52, 32768
    s_mov_b32 s57, 50176
    buffer_load_dwordx4 v12, s[12:15], s57 offen lds
    buffer_load_dwordx4 v13, s[12:15], s57 offen offset:1024 lds
    s_add_u32 m0, s52, 40960
    s_mov_b32 s57, 64512
    buffer_load_dwordx4 v12, s[12:15], s57 offen lds
    buffer_load_dwordx4 v13, s[12:15], s57 offen offset:1024 lds
    s_add_u32 m0, s52, 49152
    s_mov_b32 s57, 71680
    buffer_load_dwordx4 v12, s[12:15], s57 offen lds
    buffer_load_dwordx4 v13, s[12:15], s57 offen offset:1024 lds
    s_add_u32 m0, s52, 57344
    s_mov_b32 s57, 86016
    buffer_load_dwordx4 v12, s[12:15], s57 offen lds
    buffer_load_dwordx4 v13, s[12:15], s57 offen offset:1024 lds
    s_add_u32 m0, s52, 65536
    s_add_u32 s57, s60, 0
    buffer_load_dwordx4 v10, s[20:23], s57 offen nt lds
    buffer_load_dwordx4 v11, s[20:23], s57 offen offset:1024 nt lds
    s_add_u32 m0, s52, 73728
    s_add_u32 s57, s60, 65536
    buffer_load_dwordx4 v10, s[20:23], s57 offen nt lds
    buffer_load_dwordx4 v11, s[20:23], s57 offen offset:1024 nt lds
    s_add_u32 m0, s52, 81920
    s_add_u32 s57, s60, 131072
    buffer_load_dwordx4 v10, s[20:23], s57 offen nt lds
    buffer_load_dwordx4 v11, s[20:23], s57 offen offset:1024 nt lds
    s_add_u32 m0, s52, 90112
    s_add_u32 s57, s60, 196608
    buffer_load_dwordx4 v10, s[20:23], s57 offen nt lds
    buffer_load_dwordx4 v11, s[20:23], s57 offen offset:1024 nt lds
    s_add_u32 m0, s52, 98304
    s_add_u32 s57, s60, 262144
    buffer_load_dwordx4 v10, s[20:23], s57 offen nt lds
    buffer_load_dwordx4 v11, s[20:23], s57 offen offset:1024 nt lds
    s_waitcnt vmcnt(24)
    ds_read_b64_tr_b16 a[0:1], v2 offset:0
    ds_read_b64_tr_b16 a[2:3], v2 offset:512
    ds_read_b64_tr_b16 a[4:5], v2 offset:256
    ds_read_b64_tr_b16 a[6:7], v2 offset:768
    s_add_u32 m0, s52, 106496
    s_add_u32 s57, s60, 327680
    buffer_load_dwordx4 v10, s[20:23], s57 offen nt lds
    buffer_load_dwordx4 v11, s[20:23], s57 offen offset:1024 nt lds
    s_waitcnt vmcnt(24)
    ds_read_b64_tr_b16 a[8:9], v2 offset:8192
    ds_read_b64_tr_b16 a[10:11], v2 offset:8704
    ds_read_b64_tr_b16 a[12:13], v2 offset:8448
    ds_read_b64_tr_b16 a[14:15], v2 offset:8960
    s_add_u32 m0, s52, 114688
    s_add_u32 s57, s60, 393216
    buffer_load_dwordx4 v10, s[20:23], s57 offen nt lds
    buffer_load_dwordx4 v11, s[20:23], s57 offen offset:1024 nt lds
    s_waitcnt vmcnt(24)
    ds_read_b64_tr_b16 a[16:17], v2 offset:16384
    ds_read_b64_tr_b16 a[18:19], v2 offset:16896
    ds_read_b64_tr_b16 a[20:21], v2 offset:16640
    ds_read_b64_tr_b16 a[22:23], v2 offset:17152
    s_add_u32 m0, s52, 122880
    s_add_u32 s57, s61, 0
    buffer_load_dwordx4 v10, s[20:23], s57 offen nt lds
    buffer_load_dwordx4 v11, s[20:23], s57 offen offset:1024 nt lds
    s_waitcnt vmcnt(24)
    ds_read_b64_tr_b16 a[24:25], v2 offset:24576
    ds_read_b64_tr_b16 a[26:27], v2 offset:25088
    ds_read_b64_tr_b16 a[28:29], v2 offset:24832
    ds_read_b64_tr_b16 a[30:31], v2 offset:25344
    s_add_u32 m0, s52, 131072
    s_add_u32 s57, s61, 65536
    buffer_load_dwordx4 v10, s[20:23], s57 offen nt lds
    buffer_load_dwordx4 v11, s[20:23], s57 offen offset:1024 nt lds
    s_waitcnt vmcnt(24)
    ds_read_b64_tr_b16 a[32:33], v2 offset:32768
    ds_read_b64_tr_b16 a[34:35], v2 offset:33280
    ds_read_b64_tr_b16 a[36:37], v2 offset:33024
    ds_read_b64_tr_b16 a[38:39], v2 offset:33536
    s_add_u32 m0, s52, 139264
    s_add_u32 s57, s61, 131072
    buffer_load_dwordx4 v10, s[20:23], s57 offen nt lds
    buffer_load_dwordx4 v11, s[20:23], s57 offen offset:1024 nt lds
    s_waitcnt vmcnt(24)
    ds_read_b64_tr_b16 a[40:41], v2 offset:40960
    ds_read_b64_tr_b16 a[42:43], v2 offset:41472
    ds_read_b64_tr_b16 a[44:45], v2 offset:41216
    ds_read_b64_tr_b16 a[46:47], v2 offset:41728
    s_add_u32 m0, s52, 147456
    s_add_u32 s57, s61, 196608
    buffer_load_dwordx4 v10, s[20:23], s57 offen nt lds
    buffer_load_dwordx4 v11, s[20:23], s57 offen offset:1024 nt lds
    s_waitcnt vmcnt(24)
    ds_read_b64_tr_b16 a[48:49], v2 offset:49152
    ds_read_b64_tr_b16 a[50:51], v2 offset:49664
    ds_read_b64_tr_b16 a[52:53], v2 offset:49408
    ds_read_b64_tr_b16 a[54:55], v2 offset:49920
    s_add_u32 m0, s52, 155648
    s_add_u32 s57, s61, 262144
    buffer_load_dwordx4 v10, s[20:23], s57 offen nt lds
    buffer_load_dwordx4 v11, s[20:23], s57 offen offset:1024 nt lds
    s_waitcnt vmcnt(24)
    ds_read_b64_tr_b16 a[56:57], v2 offset:57344
    ds_read_b64_tr_b16 a[58:59], v2 offset:57856
    ds_read_b64_tr_b16 a[60:61], v2 offset:57600
    ds_read_b64_tr_b16 a[62:63], v2 offset:58112
    s_waitcnt lgkmcnt(15)
    s_add_u32 m0, s52, 0
    s_add_u32 s57, s61, 327680
    buffer_load_dwordx4 v10, s[20:23], s57 offen nt lds
    buffer_load_dwordx4 v11, s[20:23], s57 offen offset:1024 nt lds
    s_waitcnt vmcnt(24)
    ds_read_b64_tr_b16 a[64:65], v6 offset:0
    ds_read_b64_tr_b16 a[66:67], v6 offset:1024
    ds_read_b64_tr_b16 a[68:69], v6 offset:256
    ds_read_b64_tr_b16 a[70:71], v6 offset:1280
    s_add_u32 m0, s52, 8192
    s_add_u32 s57, s61, 393216
    buffer_load_dwordx4 v10, s[20:23], s57 offen nt lds
    buffer_load_dwordx4 v11, s[20:23], s57 offen offset:1024 nt lds
    s_waitcnt vmcnt(24)
    ds_read_b64_tr_b16 a[72:73], v6 offset:8192
    ds_read_b64_tr_b16 a[74:75], v6 offset:9216
    ds_read_b64_tr_b16 a[76:77], v6 offset:8448
    ds_read_b64_tr_b16 a[78:79], v6 offset:9472
    s_add_u32 m0, s52, 16384
    s_add_u32 s57, s62, 0
    buffer_load_dwordx4 v10, s[20:23], s57 offen nt lds
    buffer_load_dwordx4 v11, s[20:23], s57 offen offset:1024 nt lds
    s_waitcnt vmcnt(24)
    ds_read_b64_tr_b16 a[80:81], v6 offset:16384
    ds_read_b64_tr_b16 a[82:83], v6 offset:17408
    ds_read_b64_tr_b16 a[84:85], v6 offset:16640
    ds_read_b64_tr_b16 a[86:87], v6 offset:17664
    s_add_u32 m0, s52, 24576
    s_add_u32 s57, s62, 65536
    buffer_load_dwordx4 v10, s[20:23], s57 offen nt lds
    buffer_load_dwordx4 v11, s[20:23], s57 offen offset:1024 nt lds
    s_waitcnt vmcnt(24)
    ds_read_b64_tr_b16 a[88:89], v6 offset:24576
    ds_read_b64_tr_b16 a[90:91], v6 offset:25600
    ds_read_b64_tr_b16 a[92:93], v6 offset:24832
    ds_read_b64_tr_b16 a[94:95], v6 offset:25856
    s_waitcnt lgkmcnt(15)
    s_add_u32 m0, s52, 32768
    s_add_u32 s57, s62, 131072
    buffer_load_dwordx4 v10, s[20:23], s57 offen nt lds
    buffer_load_dwordx4 v11, s[20:23], s57 offen offset:1024 nt lds
    s_waitcnt vmcnt(24)
    ds_read_b64_tr_b16 a[96:97], v6 offset:32768
    ds_read_b64_tr_b16 a[98:99], v6 offset:33792
    ds_read_b64_tr_b16 a[100:101], v6 offset:33024
    ds_read_b64_tr_b16 a[102:103], v6 offset:34048
    s_add_u32 m0, s52, 40960
    s_add_u32 s57, s62, 196608
    buffer_load_dwordx4 v10, s[20:23], s57 offen nt lds
    buffer_load_dwordx4 v11, s[20:23], s57 offen offset:1024 nt lds
    s_waitcnt vmcnt(24)
    ds_read_b64_tr_b16 a[104:105], v6 offset:40960
    ds_read_b64_tr_b16 a[106:107], v6 offset:41984
    ds_read_b64_tr_b16 a[108:109], v6 offset:41216
    ds_read_b64_tr_b16 a[110:111], v6 offset:42240
    s_add_u32 m0, s52, 49152
    s_add_u32 s57, s62, 262144
    buffer_load_dwordx4 v10, s[20:23], s57 offen nt lds
    buffer_load_dwordx4 v11, s[20:23], s57 offen offset:1024 nt lds
    s_waitcnt vmcnt(24)
    ds_read_b64_tr_b16 a[112:113], v6 offset:49152
    ds_read_b64_tr_b16 a[114:115], v6 offset:50176
    ds_read_b64_tr_b16 a[116:117], v6 offset:49408
    ds_read_b64_tr_b16 a[118:119], v6 offset:50432
    s_add_u32 m0, s52, 57344
    s_add_u32 s57, s62, 327680
    buffer_load_dwordx4 v10, s[20:23], s57 offen nt lds
    buffer_load_dwordx4 v11, s[20:23], s57 offen offset:1024 nt lds
    s_waitcnt vmcnt(24)
    ds_read_b64_tr_b16 a[120:121], v6 offset:57344
    ds_read_b64_tr_b16 a[122:123], v6 offset:58368
    ds_read_b64_tr_b16 a[124:125], v6 offset:57600
    ds_read_b64_tr_b16 a[126:127], v6 offset:58624
    buffer_load_dword v17, v18, s[24:27], 0 offen sc1
    s_waitcnt lgkmcnt(15)
    s_add_u32 m0, s52, 65536
    s_add_u32 s57, s62, 393216
    buffer_load_dwordx4 v10, s[20:23], s57 offen nt lds
    s_waitcnt vmcnt(24)
    ds_read_b64_tr_b16 a[128:129], v7 offset:0
    ds_read_b64_tr_b16 a[130:131], v7 offset:1024
    ds_read_b64_tr_b16 a[132:133], v7 offset:256
    ds_read_b64_tr_b16 a[134:135], v7 offset:1280
    buffer_load_dwordx4 v11, s[20:23], s57 offen offset:1024 nt lds
    s_add_u32 m0, s52, 73728
    s_add_u32 s57, s63, 0
    buffer_load_dwordx4 v10, s[20:23], s57 offen nt lds
    s_waitcnt vmcnt(24)
    ds_read_b64_tr_b16 a[136:137], v7 offset:8192
    ds_read_b64_tr_b16 a[138:139], v7 offset:9216
    ds_read_b64_tr_b16 a[140:141], v7 offset:8448
    ds_read_b64_tr_b16 a[142:143], v7 offset:9472
    buffer_load_dwordx4 v11, s[20:23], s57 offen offset:1024 nt lds
    s_add_u32 m0, s52, 81920
    s_add_u32 s57, s63, 65536
    buffer_load_dwordx4 v10, s[20:23], s57 offen nt lds
    s_waitcnt vmcnt(24)
    ds_read_b64_tr_b16 a[144:145], v7 offset:16384
    ds_read_b64_tr_b16 a[146:147], v7 offset:17408
    ds_read_b64_tr_b16 a[148:149], v7 offset:16640
    ds_read_b64_tr_b16 a[150:151], v7 offset:17664
    buffer_load_dwordx4 v11, s[20:23], s57 offen offset:1024 nt lds
    s_add_u32 m0, s52, 90112
    s_add_u32 s57, s63, 131072
    buffer_load_dwordx4 v10, s[20:23], s57 offen nt lds
    s_waitcnt vmcnt(24)
    ds_read_b64_tr_b16 a[152:153], v7 offset:24576
    ds_read_b64_tr_b16 a[154:155], v7 offset:25600
    ds_read_b64_tr_b16 a[156:157], v7 offset:24832
    ds_read_b64_tr_b16 a[158:159], v7 offset:25856
    buffer_load_dwordx4 v11, s[20:23], s57 offen offset:1024 nt lds
    s_waitcnt vmcnt(23)
    ds_read_b64_tr_b16 a[160:161], v5 offset:0
    ds_read_b64_tr_b16 a[162:163], v5 offset:1024
    ds_read_b64_tr_b16 a[164:165], v5 offset:256
    ds_read_b64_tr_b16 a[166:167], v5 offset:1280
    s_waitcnt vmcnt(21)
    ds_read_b64_tr_b16 a[168:169], v5 offset:8192
    ds_read_b64_tr_b16 a[170:171], v5 offset:9216
    ds_read_b64_tr_b16 a[172:173], v5 offset:8448
    ds_read_b64_tr_b16 a[174:175], v5 offset:9472
    s_waitcnt vmcnt(19)
    ds_read_b64_tr_b16 a[176:177], v5 offset:16384
    ds_read_b64_tr_b16 a[178:179], v5 offset:17408
    ds_read_b64_tr_b16 a[180:181], v5 offset:16640
    ds_read_b64_tr_b16 a[182:183], v5 offset:17664
    s_waitcnt vmcnt(17)
    ds_read_b64_tr_b16 a[184:185], v5 offset:24576
    ds_read_b64_tr_b16 a[186:187], v5 offset:25600
    ds_read_b64_tr_b16 a[188:189], v5 offset:24832
    ds_read_b64_tr_b16 a[190:191], v5 offset:25856
    s_waitcnt vmcnt(15)
    ds_read_b64_tr_b16 a[192:193], v5 offset:32768
    ds_read_b64_tr_b16 a[194:195], v5 offset:33792
    ds_read_b64_tr_b16 a[196:197], v5 offset:33024
    ds_read_b64_tr_b16 a[198:199], v5 offset:34048
    s_waitcnt vmcnt(13)
    ds_read_b64_tr_b16 a[200:201], v5 offset:40960
    ds_read_b64_tr_b16 a[202:203], v5 offset:41984
    ds_read_b64_tr_b16 a[204:205], v5 offset:41216
    ds_read_b64_tr_b16 a[206:207], v5 offset:42240
    s_waitcnt vmcnt(11)
    ds_read_b64_tr_b16 a[208:209], v5 offset:49152
    ds_read_b64_tr_b16 a[210:211], v5 offset:50176
    ds_read_b64_tr_b16 a[212:213], v5 offset:49408
    ds_read_b64_tr_b16 a[214:215], v5 offset:50432
    s_waitcnt vmcnt(9)
    ds_read_b64_tr_b16 a[216:217], v5 offset:57344
    ds_read_b64_tr_b16 a[218:219], v5 offset:58368
    ds_read_b64_tr_b16 a[220:221], v5 offset:57600
    ds_read_b64_tr_b16 a[222:223], v5 offset:58624
    s_waitcnt vmcnt(8)
    v_cmp_ne_u32 vcc, s47, v17
    s_nop 0
    s_cbranch_vccz L_ok9
    s_mov_b32 s59, 200000
L_spin8:
    buffer_load_dword v17, v18, s[24:27], 0 offen sc1
    s_waitcnt vmcnt(0)
    v_cmp_ne_u32 vcc, s47, v17
    s_nop 0
    s_cbranch_vccz L_ok9
    s_sub_u32 s59, s59, 1
    s_cbranch_scc0 L_spin8
L_ok9:
    buffer_load_dwordx4 v[96:99], v14, s[24:27], s76 offen offset:0 sc1
    buffer_load_dwordx4 v[100:103], v14, s[24:27], s76 offen offset:1024 sc1
    buffer_load_dwordx4 v[104:107], v14, s[24:27], s76 offen offset:2048 sc1
    buffer_load_dwordx4 v[108:111], v14, s[24:27], s76 offen offset:3072 sc1
    s_add_u32 s76, s76, 4096
    buffer_load_dwordx4 v[112:115], v14, s[24:27], s76 offen offset:0 sc1
    buffer_load_dwordx4 v[116:119], v14, s[24:27], s76 offen offset:1024 sc1
    buffer_load_dwordx4 v[120:123], v14, s[24:27], s76 offen offset:2048 sc1
    buffer_load_dwordx4 v[124:127], v14, s[24:27], s76 offen offset:3072 sc1
    s_add_u32 s76, s76, 4096
    buffer_load_dwordx4 v[128:131], v14, s[24:27], s76 offen offset:0 sc1
    buffer_load_dwordx4 v[132:135], v14, s[24:27], s76 offen offset:1024 sc1
    buffer_load_dwordx4 v[136:139], v14, s[24:27], s76 offen offset:2048 sc1
    buffer_load_dwordx4 v[140:143], v14, s[24:27], s76 offen offset:3072 sc1
    s_add_u32 s76, s76, 4096
    buffer_load_dwordx4 v[144:147], v14, s[24:27], s76 offen offset:0 sc1
    buffer_load_dwordx4 v[148:151], v14, s[24:27], s76 offen offset:1024 sc1
    buffer_load_dwordx4 v[152:155], v14, s[24:27], s76 offen offset:2048 sc1
    buffer_load_dwordx4 v[156:159], v14, s[24:27], s76 offen offset:3072 sc1
    buffer_load_dword v19, v20, s[24:27], 0 offen sc1
    s_waitcnt lgkmcnt(15)
    s_add_u32 m0, s52, 98304
    s_add_u32 s57, s63, 196608
    buffer_load_dwordx4 v10, s[20:23], s57 offen nt lds
    s_waitcnt vmcnt(24)
    ds_read_b64_tr_b16 a[224:225], v6 offset:0
    ds_read_b64_tr_b16 a[226:227], v6 offset:1024
    ds_read_b64_tr_b16 a[228:229], v6 offset:256
    ds_read_b64_tr_b16 a[230:231], v6 offset:1280
    buffer_load_dwordx4 v11, s[20:23], s57 offen offset:1024 nt lds
    s_add_u32 m0, s52, 106496
    s_add_u32 s57, s63, 262144
    buffer_load_dwordx4 v10, s[20:23], s57 offen nt lds
    s_waitcnt vmcnt(24)
    ds_read_b64_tr_b16 a[232:233], v6 offset:8192
    ds_read_b64_tr_b16 a[234:235], v6 offset:9216
    ds_read_b64_tr_b16 a[236:237], v6 offset:8448
    ds_read_b64_tr_b16 a[238:239], v6 offset:9472
    buffer_load_dwordx4 v11, s[20:23], s57 offen offset:1024 nt lds
    s_add_u32 m0, s52, 114688
    s_add_u32 s57, s63, 327680
    buffer_load_dwordx4 v10, s[20:23], s57 offen nt lds
    s_waitcnt vmcnt(24)
    ds_read_b64_tr_b16 a[240:241], v6 offset:16384
    ds_read_b64_tr_b16 a[242:243], v6 offset:17408
    ds_read_b64_tr_b16 a[244:245], v6 offset:16640
    ds_read_b64_tr_b16 a[246:247], v6 offset:17664
    buffer_load_dwordx4 v11, s[20:23], s57 offen offset:1024 nt lds
    s_add_u32 m0, s52, 122880
    s_add_u32 s57, s63, 393216
    buffer_load_dwordx4 v10, s[20:23], s57 offen nt lds
    s_waitcnt vmcnt(24)
    ds_read_b64_tr_b16 a[248:249], v6 offset:24576
    ds_read_b64_tr_b16 a[250:251], v6 offset:25600
    ds_read_b64_tr_b16 a[252:253], v6 offset:24832
    ds_read_b64_tr_b16 a[254:255], v6 offset:25856
    buffer_load_dwordx4 v11, s[20:23], s57 offen offset:1024 nt lds
    s_waitcnt vmcnt(24)
    v_mfma_f32_32x32x16_bf16 v[32:47], a[0:3], v[96:99], 0
    v_mfma_f32_32x32x16_bf16 v[64:79], a[4:7], v[96:99], 0
    s_waitcnt vmcnt(23)
    v_mfma_f32_32x32x16_bf16 v[48:63], a[0:3], v[100:103], 0
    v_mfma_f32_32x32x16_bf16 v[80:95], a[4:7], v[100:103], 0
    s_waitcnt vmcnt(22)
    v_mfma_f32_32x32x16_bf16 v[32:47], a[8:11], v[104:107], v[32:47]
    v_mfma_f32_32x32x16_bf16 v[64:79], a[12:15], v[104:107], v[64:79]
    s_waitcnt vmcnt(21)
    v_mfma_f32_32x32x16_bf16 v[48:63], a[8:11], v[108:111], v[48:63]
    v_mfma_f32_32x32x16_bf16 v[80:95], a[12:15], v[108:111], v[80:95]
    s_waitcnt vmcnt(20)
    v_mfma_f32_32x32x16_bf16 v[32:47], a[16:19], v[112:115], v[32:47]
    v_mfma_f32_32x32x16_bf16 v[64:79], a[20:23], v[112:115], v[64:79]
    s_waitcnt vmcnt(19)
    v_mfma_f32_32x32x16_bf16 v[48:63], a[16:19], v[116:119], v[48:63]
    v_mfma_f32_32x32x16_bf16 v[80:95], a[20:23], v[116:119], v[80:95]
    s_waitcnt vmcnt(18)
    v_mfma_f32_32x32x16_bf16 v[32:47], a[24:27], v[120:123], v[32:47]
    v_mfma_f32_32x32x16_bf16 v[64:79], a[28:31], v[120:123], v[64:79]
    s_waitcnt vmcnt(17)
    v_mfma_f32_32x32x16_bf16 v[48:63], a[24:27], v[124:127], v[48:63]
    v_mfma_f32_32x32x16_bf16 v[80:95], a[28:31], v[124:127], v[80:95]
    s_waitcnt vmcnt(8)
    v_cmp_ne_u32 vcc, s47, v19
    s_nop 0
    s_cbranch_vccz L_ok11
    s_mov_b32 s59, 200000
L_spin10:
    buffer_load_dword v19, v20, s[24:27], 0 offen sc1
    s_waitcnt vmcnt(0)
    v_cmp_ne_u32 vcc, s47, v19
    s_nop 0
    s_cbranch_vccz L_ok11
    s_sub_u32 s59, s59, 1
    s_cbranch_scc0 L_spin10
L_ok11:
    s_add_u32 s77, s64, 0
    buffer_load_dwordx4 v[160:163], v14, s[24:27], s77 offen offset:0 sc1
    buffer_load_dwordx4 v[164:167], v14, s[24:27], s77 offen offset:1024 sc1
    buffer_load_dwordx4 v[168:171], v14, s[24:27], s77 offen offset:2048 sc1
    buffer_load_dwordx4 v[172:175], v14, s[24:27], s77 offen offset:3072 sc1
    s_add_u32 s77, s64, 4096
    buffer_load_dwordx4 v[176:179], v14, s[24:27], s77 offen offset:0 sc1
    buffer_load_dwordx4 v[180:183], v14, s[24:27], s77 offen offset:1024 sc1
    buffer_load_dwordx4 v[184:187], v14, s[24:27], s77 offen offset:2048 sc1
    buffer_load_dwordx4 v[188:191], v14, s[24:27], s77 offen offset:3072 sc1
    v_mfma_f32_32x32x16_bf16 v[32:47], a[32:35], v[128:131], v[32:47]
    s_add_u32 s77, s64, 8192
    buffer_load_dwordx4 v[192:195], v14, s[24:27], s77 offen offset:0 sc1
    v_mfma_f32_32x32x16_bf16 v[64:79], a[36:39], v[128:131], v[64:79]
    buffer_load_dwordx4 v[196:199], v14, s[24:27], s77 offen offset:1024 sc1
    v_mfma_f32_32x32x16_bf16 v[48:63], a[32:35], v[132:135], v[48:63]
    buffer_load_dwordx4 v[200:203], v14, s[24:27], s77 offen offset:2048 sc1
    v_mfma_f32_32x32x16_bf16 v[80:95], a[36:39], v[132:135], v[80:95]
    v_mfma_f32_32x32x16_bf16 v[32:47], a[40:43], v[136:139], v[32:47]
    v_mfma_f32_32x32x16_bf16 v[64:79], a[44:47], v[136:139], v[64:79]
    buffer_load_dwordx4 v[204:207], v14, s[24:27], s77 offen offset:3072 sc1
    v_mfma_f32_32x32x16_bf16 v[48:63], a[40:43], v[140:143], v[48:63]
    s_add_u32 s77, s64, 12288
    buffer_load_dwordx4 v[208:211], v14, s[24:27], s77 offen offset:0 sc1
    v_mfma_f32_32x32x16_bf16 v[80:95], a[44:47], v[140:143], v[80:95]
    v_mfma_f32_32x32x16_bf16 v[32:47], a[48:51], v[144:147], v[32:47]
    v_mfma_f32_32x32x16_bf16 v[64:79], a[52:55], v[144:147], v[64:79]
    buffer_load_dwordx4 v[212:215], v14, s[24:27], s77 offen offset:1024 sc1
    v_mfma_f32_32x32x16_bf16 v[48:63], a[48:51], v[148:151], v[48:63]
    s_add_u32 s77, s65, 0
    buffer_load_dwordx4 v[216:219], v14, s[24:27], s77 offen offset:0 sc1
    v_mfma_f32_32x32x16_bf16 v[80:95], a[52:55], v[148:151], v[80:95]
    v_mfma_f32_32x32x16_bf16 v[32:47], a[56:59], v[152:155], v[32:47]
    v_mfma_f32_32x32x16_bf16 v[64:79], a[60:63], v[152:155], v[64:79]
    buffer_load_dwordx4 v[220:223], v14, s[24:27], s77 offen offset:1024 sc1
    v_mfma_f32_32x32x16_bf16 v[48:63], a[56:59], v[156:159], v[48:63]
    buffer_load_dwordx4 v[224:227], v14, s[24:27], s77 offen offset:2048 sc1
    v_mfma_f32_32x32x16_bf16 v[80:95], a[60:63], v[156:159], v[80:95]
    buffer_load_dwordx4 v[228:231], v14, s[24:27], s77 offen offset:3072 sc1
    s_waitcnt vmcnt(24)
    ds_read_b64_tr_b16 a[0:1], v6 offset:32768
    ds_read_b64_tr_b16 a[2:3], v6 offset:33792
    ds_read_b64_tr_b16 a[4:5], v6 offset:33024
    ds_read_b64_tr_b16 a[6:7], v6 offset:34048
    s_add_u32 s77, s65, 4096
    buffer_load_dwordx4 v[232:235], v14, s[24:27], s77 offen offset:0 sc1
    buffer_load_dwordx4 v[236:239], v14, s[24:27], s77 offen offset:1024 sc1
    s_waitcnt vmcnt(24)
    ds_read_b64_tr_b16 a[8:9], v6 offset:40960
    ds_read_b64_tr_b16 a[10:11], v6 offset:41984
    ds_read_b64_tr_b16 a[12:13], v6 offset:41216
    ds_read_b64_tr_b16 a[14:15], v6 offset:42240
    buffer_load_dwordx4 v[96:99], v14, s[24:27], s77 offen offset:2048 sc1
    buffer_load_dwordx4 v[100:103], v14, s[24:27], s77 offen offset:3072 sc1
    s_waitcnt vmcnt(24)
    ds_read_b64_tr_b16 a[16:17], v6 offset:49152
    ds_read_b64_tr_b16 a[18:19], v6 offset:50176
    ds_read_b64_tr_b16 a[20:21], v6 offset:49408
    ds_read_b64_tr_b16 a[22:23], v6 offset:50432
    s_add_u32 s77, s65, 8192
    buffer_load_dwordx4 v[104:107], v14, s[24:27], s77 offen offset:0 sc1
    buffer_load_dwordx4 v[108:111], v14, s[24:27], s77 offen offset:1024 sc1
    s_waitcnt vmcnt(24)
    ds_read_b64_tr_b16 a[24:25], v6 offset:57344
    ds_read_b64_tr_b16 a[26:27], v6 offset:58368
    ds_read_b64_tr_b16 a[28:29], v6 offset:57600
    ds_read_b64_tr_b16 a[30:31], v6 offset:58624
    buffer_load_dwordx4 v[112:115], v14, s[24:27], s77 offen offset:2048 sc1
    s_waitcnt vmcnt(24)
    v_mfma_f32_32x32x16_bf16 v[32:47], v[160:163], a[64:67], v[32:47]
    buffer_load_dwordx4 v[116:119], v14, s[24:27], s77 offen offset:3072 sc1
    v_mfma_f32_32x32x16_bf16 v[48:63], v[160:163], a[68:71], v[48:63]
    s_add_u32 s77, s65, 12288
    buffer_load_dwordx4 v[120:123], v14, s[24:27], s77 offen offset:0 sc1
    s_waitcnt vmcnt(25)
    v_mfma_f32_32x32x16_bf16 v[64:79], v[164:167], a[64:67], v[64:79]
    buffer_load_dwordx4 v[124:127], v14, s[24:27], s77 offen offset:1024 sc1
    v_mfma_f32_32x32x16_bf16 v[80:95], v[164:167], a[68:71], v[80:95]
    s_waitcnt vmcnt(25)
    v_mfma_f32_32x32x16_bf16 v[32:47], v[168:171], a[72:75], v[32:47]
    v_mfma_f32_32x32x16_bf16 v[48:63], v[168:171], a[76:79], v[48:63]
    s_add_u32 s77, s66, 0
    buffer_load_dwordx4 v[128:131], v14, s[24:27], s77 offen offset:0 sc1
    s_waitcnt vmcnt(25)
    v_mfma_f32_32x32x16_bf16 v[64:79], v[172:175], a[72:75], v[64:79]
    buffer_load_dwordx4 v[132:135], v14, s[24:27], s77 offen offset:1024 sc1
    v_mfma_f32_32x32x16_bf16 v[80:95], v[172:175], a[76:79], v[80:95]
    s_waitcnt vmcnt(25)
    v_mfma_f32_32x32x16_bf16 v[32:47], v[176:179], a[80:83], v[32:47]
    v_mfma_f32_32x32x16_bf16 v[48:63], v[176:179], a[84:87], v[48:63]
    buffer_load_dwordx4 v[136:139], v14, s[24:27], s77 offen offset:2048 sc1
    s_waitcnt vmcnt(25)
    v_mfma_f32_32x32x16_bf16 v[64:79], v[180:183], a[80:83], v[64:79]
    buffer_load_dwordx4 v[140:143], v14, s[24:27], s77 offen offset:3072 sc1
    v_mfma_f32_32x32x16_bf16 v[80:95], v[180:183], a[84:87], v[80:95]
    s_waitcnt vmcnt(25)
    v_mfma_f32_32x32x16_bf16 v[32:47], v[184:187], a[88:91], v[32:47]
    v_mfma_f32_32x32x16_bf16 v[48:63], v[184:187], a[92:95], v[48:63]
    s_add_u32 s77, s66, 4096
    buffer_load_dwordx4 v[144:147], v14, s[24:27], s77 offen offset:0 sc1
    s_waitcnt vmcnt(25)
    v_mfma_f32_32x32x16_bf16 v[64:79], v[188:191], a[88:91], v[64:79]
    buffer_load_dwordx4 v[148:151], v14, s[24:27], s77 offen offset:1024 sc1
    v_mfma_f32_32x32x16_bf16 v[80:95], v[188:191], a[92:95], v[80:95]
    s_waitcnt vmcnt(25)
    v_mfma_f32_32x32x16_bf16 v[32:47], v[192:195], a[96:99], v[32:47]
    v_mfma_f32_32x32x16_bf16 v[48:63], v[192:195], a[100:103], v[48:63]
    buffer_load_dwordx4 v[152:155], v14, s[24:27], s77 offen offset:2048 sc1
    s_waitcnt vmcnt(25)
    v_mfma_f32_32x32x16_bf16 v[64:79], v[196:199], a[96:99], v[64:79]
    buffer_load_dwordx4 v[156:159], v14, s[24:27], s77 offen offset:3072 sc1
    v_mfma_f32_32x32x16_bf16 v[80:95], v[196:199], a[100:103], v[80:95]
    s_waitcnt vmcnt(25)
    v_mfma_f32_32x32x16_bf16 v[32:47], v[200:203], a[104:107], v[32:47]
    v_mfma_f32_32x32x16_bf16 v[48:63], v[200:203], a[108:111], v[48:63]
    s_add_u32 s77, s66, 8192
    buffer_load_dwordx4 v[160:163], v14, s[24:27], s77 offen offset:0 sc1
    s_waitcnt vmcnt(25)
    v_mfma_f32_32x32x16_bf16 v[64:79], v[204:207], a[104:107], v[64:79]
    buffer_load_dwordx4 v[164:167], v14, s[24:27], s77 offen offset:1024 sc1
    v_mfma_f32_32x32x16_bf16 v[80:95], v[204:207], a[108:111], v[80:95]
    s_waitcnt vmcnt(25)
    v_mfma_f32_32x32x16_bf16 v[32:47], v[208:211], a[112:115], v[32:47]
    v_mfma_f32_32x32x16_bf16 v[48:63], v[208:211], a[116:119], v[48:63]
    buffer_load_dwordx4 v[168:171], v14, s[24:27], s77 offen offset:2048 sc1
    s_waitcnt vmcnt(25)
    v_mfma_f32_32x32x16_bf16 v[64:79], v[212:215], a[112:115], v[64:79]
    buffer_load_dwordx4 v[172:175], v14, s[24:27], s77 offen offset:3072 sc1
    v_mfma_f32_32x32x16_bf16 v[80:95], v[212:215], a[116:119], v[80:95]
    s_waitcnt vmcnt(25)
    v_mfma_f32_32x32x16_bf16 v[32:47], v[216:219], a[120:123], v[32:47]
    v_mfma_f32_32x32x16_bf16 v[48:63], v[216:219], a[124:127], v[48:63]
    s_add_u32 s77, s66, 12288
    buffer_load_dwordx4 v[176:179], v14, s[24:27], s77 offen offset:0 sc1
    s_waitcnt vmcnt(25)
    v_mfma_f32_32x32x16_bf16 v[64:79], v[220:223], a[120:123], v[64:79]
    buffer_load_dwordx4 v[180:183], v14, s[24:27], s77 offen offset:1024 sc1
    v_mfma_f32_32x32x16_bf16 v[80:95], v[220:223], a[124:127], v[80:95]
    s_waitcnt vmcnt(25)
    v_mfma_f32_32x32x16_bf16 v[32:47], v[224:227], a[128:131], v[32:47]
    v_mfma_f32_32x32x16_bf16 v[48:63], v[224:227], a[132:135], v[48:63]
    s_add_u32 s77, s67, 0
    buffer_load_dwordx4 v[184:187], v14, s[24:27], s77 offen offset:0 sc1
    s_waitcnt vmcnt(25)
    v_mfma_f32_32x32x16_bf16 v[64:79], v[228:231], a[128:131], v[64:79]
    buffer_load_dwordx4 v[188:191], v14, s[24:27], s77 offen offset:1024 sc1
    v_mfma_f32_32x32x16_bf16 v[80:95], v[228:231], a[132:135], v[80:95]
    s_waitcnt vmcnt(25)
    v_mfma_f32_32x32x16_bf16 v[32:47], v[232:235], a[136:139], v[32:47]
    v_mfma_f32_32x32x16_bf16 v[48:63], v[232:235], a[140:143], v[48:63]
    buffer_load_dwordx4 v[192:195], v14, s[24:27], s77 offen offset:2048 sc1
    s_waitcnt vmcnt(25)
    v_mfma_f32_32x32x16_bf16 v[64:79], v[236:239], a[136:139], v[64:79]
    buffer_load_dwordx4 v[196:199], v14, s[24:27], s77 offen offset:3072 sc1
    v_mfma_f32_32x32x16_bf16 v[80:95], v[236:239], a[140:143], v[80:95]
    s_waitcnt vmcnt(25)
    v_mfma_f32_32x32x16_bf16 v[32:47], v[96:99], a[144:147], v[32:47]
    v_mfma_f32_32x32x16_bf16 v[48:63], v[96:99], a[148:151], v[48:63]
    s_add_u32 s77, s67, 4096
    buffer_load_dwordx4 v[200:203], v14, s[24:27], s77 offen offset:0 sc1
    s_waitcnt vmcnt(25)
    v_mfma_f32_32x32x16_bf16 v[64:79], v[100:103], a[144:147], v[64:79]
    buffer_load_dwordx4 v[204:207], v14, s[24:27], s77 offen offset:1024 sc1
    v_mfma_f32_32x32x16_bf16 v[80:95], v[100:103], a[148:151], v[80:95]
    s_waitcnt vmcnt(25)
    v_mfma_f32_32x32x16_bf16 v[32:47], v[104:107], a[152:155], v[32:47]
    v_mfma_f32_32x32x16_bf16 v[48:63], v[104:107], a[156:159], v[48:63]
    buffer_load_dwordx4 v[208:211], v14, s[24:27], s77 offen offset:2048 sc1
    s_waitcnt vmcnt(25)
    v_mfma_f32_32x32x16_bf16 v[64:79], v[108:111], a[152:155], v[64:79]
    buffer_load_dwordx4 v[212:215], v14, s[24:27], s77 offen offset:3072 sc1
    v_mfma_f32_32x32x16_bf16 v[80:95], v[108:111], a[156:159], v[80:95]
    s_waitcnt vmcnt(25)
    v_mfma_f32_32x32x16_bf16 v[32:47], v[112:115], a[160:163], v[32:47]
    v_mfma_f32_32x32x16_bf16 v[48:63], v[112:115], a[164:167], v[48:63]
    s_add_u32 s77, s67, 8192
    buffer_load_dwordx4 v[216:219], v14, s[24:27], s77 offen offset:0 sc1
    s_waitcnt vmcnt(25)
    v_mfma_f32_32x32x16_bf16 v[64:79], v[116:119], a[160:163], v[64:79]
    buffer_load_dwordx4 v[220:223], v14, s[24:27], s77 offen offset:1024 sc1
    v_mfma_f32_32x32x16_bf16 v[80:95], v[116:119], a[164:167], v[80:95]
    s_waitcnt vmcnt(25)
    v_mfma_f32_32x32x16_bf16 v[32:47], v[120:123], a[168:171], v[32:47]
    v_mfma_f32_32x32x16_bf16 v[48:63], v[120:123], a[172:175], v[48:63]
    buffer_load_dwordx4 v[224:227], v14, s[24:27], s77 offen offset:2048 sc1
    s_waitcnt vmcnt(25)
    v_mfma_f32_32x32x16_bf16 v[64:79], v[124:127], a[168:171], v[64:79]
    buffer_load_dwordx4 v[228:231], v14, s[24:27], s77 offen offset:3072 sc1
    v_mfma_f32_32x32x16_bf16 v[80:95], v[124:127], a[172:175], v[80:95]
    s_waitcnt vmcnt(25)
    v_mfma_f32_32x32x16_bf16 v[32:47], v[128:131], a[176:179], v[32:47]
    v_mfma_f32_32x32x16_bf16 v[48:63], v[128:131], a[180:183], v[48:63]
    s_add_u32 s77, s67, 12288
    buffer_load_dwordx4 v[232:235], v14, s[24:27], s77 offen offset:0 sc1
    s_waitcnt vmcnt(25)
    v_mfma_f32_32x32x16_bf16 v[64:79], v[132:135], a[176:179], v[64:79]
    buffer_load_dwordx4 v[236:239], v14, s[24:27], s77 offen offset:1024 sc1
    v_mfma_f32_32x32x16_bf16 v[80:95], v[132:135], a[180:183], v[80:95]
    s_waitcnt vmcnt(25)
    v_mfma_f32_32x32x16_bf16 v[32:47], v[136:139], a[184:187], v[32:47]
    v_mfma_f32_32x32x16_bf16 v[48:63], v[136:139], a[188:191], v[48:63]
    s_waitcnt vmcnt(24)
    v_mfma_f32_32x32x16_bf16 v[64:79], v[140:143], a[184:187], v[64:79]
    v_mfma_f32_32x32x16_bf16 v[80:95], v[140:143], a[188:191], v[80:95]
    s_waitcnt vmcnt(23)
    s_waitcnt lgkmcnt(15)
    v_mfma_f32_32x32x16_bf16 v[32:47], v[144:147], a[192:195], v[32:47]
    v_mfma_f32_32x32x16_bf16 v[48:63], v[144:147], a[196:199], v[48:63]
    s_waitcnt vmcnt(22)
    v_mfma_f32_32x32x16_bf16 v[64:79], v[148:151], a[192:195], v[64:79]
    v_mfma_f32_32x32x16_bf16 v[80:95], v[148:151], a[196:199], v[80:95]
    s_waitcnt vmcnt(21)
    v_mfma_f32_32x32x16_bf16 v[32:47], v[152:155], a[200:203], v[32:47]
    v_mfma_f32_32x32x16_bf16 v[48:63], v[152:155], a[204:207], v[48:63]
    s_waitcnt vmcnt(20)
    v_mfma_f32_32x32x16_bf16 v[64:79], v[156:159], a[200:203], v[64:79]
    v_mfma_f32_32x32x16_bf16 v[80:95], v[156:159], a[204:207], v[80:95]
    s_waitcnt vmcnt(19)
    v_mfma_f32_32x32x16_bf16 v[32:47], v[160:163], a[208:211], v[32:47]
    v_mfma_f32_32x32x16_bf16 v[48:63], v[160:163], a[212:215], v[48:63]
    s_waitcnt vmcnt(18)
    v_mfma_f32_32x32x16_bf16 v[64:79], v[164:167], a[208:211], v[64:79]
    v_mfma_f32_32x32x16_bf16 v[80:95], v[164:167], a[212:215], v[80:95]
    s_waitcnt vmcnt(17)
    v_mfma_f32_32x32x16_bf16 v[32:47], v[168:171], a[216:219], v[32:47]
    v_mfma_f32_32x32x16_bf16 v[48:63], v[168:171], a[220:223], v[48:63]
    s_waitcnt vmcnt(16)
    v_mfma_f32_32x32x16_bf16 v[64:79], v[172:175], a[216:219], v[64:79]
    v_mfma_f32_32x32x16_bf16 v[80:95], v[172:175], a[220:223], v[80:95]
    s_waitcnt vmcnt(15)
    v_mfma_f32_32x32x16_bf16 v[32:47], v[176:179], a[224:227], v[32:47]
    v_mfma_f32_32x32x16_bf16 v[48:63], v[176:179], a[228:231], v[48:63]
    s_waitcnt vmcnt(14)
    v_mfma_f32_32x32x16_bf16 v[64:79], v[180:183], a[224:227], v[64:79]
    v_mfma_f32_32x32x16_bf16 v[80:95], v[180:183], a[228:231], v[80:95]
    s_waitcnt vmcnt(13)
    v_mfma_f32_32x32x16_bf16 v[32:47], v[184:187], a[232:235], v[32:47]
    v_mfma_f32_32x32x16_bf16 v[48:63], v[184:187], a[236:239], v[48:63]
    s_waitcnt vmcnt(12)
    v_mfma_f32_32x32x16_bf16 v[64:79], v[188:191], a[232:235], v[64:79]
    v_mfma_f32_32x32x16_bf16 v[80:95], v[188:191], a[236:239], v[80:95]
    s_waitcnt vmcnt(11)
    v_mfma_f32_32x32x16_bf16 v[32:47], v[192:195], a[240:243], v[32:47]
    v_mfma_f32_32x32x16_bf16 v[48:63], v[192:195], a[244:247], v[48:63]
    s_waitcnt vmcnt(10)
    v_mfma_f32_32x32x16_bf16 v[64:79], v[196:199], a[240:243], v[64:79]
    v_mfma_f32_32x32x16_bf16 v[80:95], v[196:199], a[244:247], v[80:95]
    s_waitcnt vmcnt(9)
    v_mfma_f32_32x32x16_bf16 v[32:47], v[200:203], a[248:251], v[32:47]
    v_mfma_f32_32x32x16_bf16 v[48:63], v[200:203], a[252:255], v[48:63]
    s_waitcnt vmcnt(8)
    v_mfma_f32_32x32x16_bf16 v[64:79], v[204:207], a[248:251], v[64:79]
    v_mfma_f32_32x32x16_bf16 v[80:95], v[204:207], a[252:255], v[80:95]
    s_waitcnt vmcnt(7)
    s_waitcnt lgkmcnt(12)
    v_mfma_f32_32x32x16_bf16 v[32:47], v[208:211], a[0:3], v[32:47]
    v_mfma_f32_32x32x16_bf16 v[48:63], v[208:211], a[4:7], v[48:63]
    s_waitcnt vmcnt(6)
    v_mfma_f32_32x32x16_bf16 v[64:79], v[212:215], a[0:3], v[64:79]
    v_mfma_f32_32x32x16_bf16 v[80:95], v[212:215], a[4:7], v[80:95]
    s_waitcnt vmcnt(5)
    s_waitcnt lgkmcnt(8)
    v_mfma_f32_32x32x16_bf16 v[32:47], v[216:219], a[8:11], v[32:47]
    v_mfma_f32_32x32x16_bf16 v[48:63], v[216:219], a[12:15], v[48:63]
    s_waitcnt vmcnt(4)
    v_mfma_f32_32x32x16_bf16 v[64:79], v[220:223], a[8:11], v[64:79]
    v_mfma_f32_32x32x16_bf16 v[80:95], v[220:223], a[12:15], v[80:95]
    s_waitcnt vmcnt(3)
    s_waitcnt lgkmcnt(4)
    v_mfma_f32_32x32x16_bf16 v[32:47], v[224:227], a[16:19], v[32:47]
    v_mfma_f32_32x32x16_bf16 v[48:63], v[224:227], a[20:23], v[48:63]
    s_waitcnt vmcnt(2)
    v_mfma_f32_32x32x16_bf16 v[64:79], v[228:231], a[16:19], v[64:79]
    v_mfma_f32_32x32x16_bf16 v[80:95], v[228:231], a[20:23], v[80:95]
    s_waitcnt vmcnt(1)
    s_waitcnt lgkmcnt(0)
    v_mfma_f32_32x32x16_bf16 v[32:47], v[232:235], a[24:27], v[32:47]
    v_mfma_f32_32x32x16_bf16 v[48:63], v[232:235], a[28:31], v[48:63]
    s_waitcnt vmcnt(0)
    v_mfma_f32_32x32x16_bf16 v[64:79], v[236:239], a[24:27], v[64:79]
    v_mfma_f32_32x32x16_bf16 v[80:95], v[236:239], a[28:31], v[80:95]
    v_and_b32 v24, 31, v1
    v_lshrrev_b32 v25, 3, v24
    v_and_b32 v26, 7, v24
    v_lshlrev_b32 v96, 13, v25
    v_lshl_add_u32 v96, v26, 8, v96
    v_lshl_add_u32 v96, v26, 4, v96
    v_add_u32 v96, s52, v96
    v_lshrrev_b32 v25, 5, v1
    v_bfe_u32 v27, v1, 1, 1
    v_xor_b32 v25, v25, v27
    v_lshl_add_u32 v96, v25, 7, v96
    v_xor_b32 v97, 16, v96
    v_xor_b32 v98, 32, v96
    v_xor_b32 v99, 48, v96
    v_xor_b32 v100, 64, v96
    v_xor_b32 v101, 80, v96
    v_xor_b32 v102, 96, v96
    v_xor_b32 v103, 112, v96
    v_lshrrev_b32 v24, 3, v0
    v_and_b32 v25, 7, v0
    v_and_b32 v26, 7, v24
    v_xor_b32 v25, v25, v26
    v_lshrrev_b32 v27, 3, v24
    v_lshlrev_b32 v104, 13, v27
    v_lshl_add_u32 v104, v26, 8, v104
    v_lshl_add_u32 v104, v25, 4, v104
    v_bfe_u32 v27, v24, 1, 1
    v_lshl_add_u32 v104, v27, 7, v104
    v_xor_b32 v105, 128, v104
    ds_write_b128 v96, v[32:35] offset:0
    ds_write_b128 v97, v[36:39] offset:0
    ds_write_b128 v98, v[40:43] offset:0
    ds_write_b128 v99, v[44:47] offset:0
    ds_write_b128 v96, v[48:51] offset:32768
    ds_write_b128 v97, v[52:55] offset:32768
    ds_write_b128 v98, v[56:59] offset:32768
    ds_write_b128 v99, v[60:63] offset:32768
    ds_write_b128 v100, v[64:67] offset:0
    ds_write_b128 v101, v[68:71] offset:0
    ds_write_b128 v102, v[72:75] offset:0
    ds_write_b128 v103, v[76:79] offset:0
    ds_write_b128 v100, v[80:83] offset:32768
    ds_write_b128 v101, v[84:87] offset:32768
    ds_write_b128 v102, v[88:91] offset:32768
    ds_write_b128 v103, v[92:95] offset:32768
    s_waitcnt lgkmcnt(0)
    s_barrier
    ds_read_b128 v[112:115], v104 offset:0
    ds_read_b128 v[116:119], v104 offset:2048
    ds_read_b128 v[120:123], v104 offset:4096
    ds_read_b128 v[124:127], v104 offset:6144
    ds_read_b128 v[128:131], v105 offset:0
    ds_read_b128 v[132:135], v105 offset:2048
    ds_read_b128 v[136:139], v105 offset:4096
    ds_read_b128 v[140:143], v105 offset:6144
    ds_read_b128 v[144:147], v104 offset:32768
    ds_read_b128 v[148:151], v104 offset:34816
    ds_read_b128 v[152:155], v104 offset:36864
    ds_read_b128 v[156:159], v104 offset:38912
    ds_read_b128 v[160:163], v105 offset:32768
    ds_read_b128 v[164:167], v105 offset:34816
    ds_read_b128 v[168:171], v105 offset:36864
    ds_read_b128 v[172:175], v105 offset:38912
    v_lshlrev_b32 v248, 16, v248
    v_lshlrev_b32 v32, 16, v240
    v_and_b32 v33, 0xffff0000, v240
    v_lshlrev_b32 v34, 16, v241
    v_and_b32 v35, 0xffff0000, v241
    v_lshlrev_b32 v36, 16, v242
    v_and_b32 v37, 0xffff0000, v242
    v_lshlrev_b32 v38, 16, v243
    v_and_b32 v39, 0xffff0000, v243
    v_add_f32 v32, v32, v248
    v_add_f32 v33, v33, v248
    v_add_f32 v34, v34, v248
    v_add_f32 v35, v35, v248
    v_add_f32 v36, v36, v248
    v_add_f32 v37, v37, v248
    v_add_f32 v38, v38, v248
    v_add_f32 v39, v39, v248
    v_lshlrev_b32 v249, 16, v249
    v_lshlrev_b32 v40, 16, v244
    v_and_b32 v41, 0xffff0000, v244
    v_lshlrev_b32 v42, 16, v245
    v_and_b32 v43, 0xffff0000, v245
    v_lshlrev_b32 v44, 16, v246
    v_and_b32 v45, 0xffff0000, v246
    v_lshlrev_b32 v46, 16, v247
    v_and_b32 v47, 0xffff0000, v247
    v_add_f32 v40, v40, v249
    v_add_f32 v41, v41, v249
    v_add_f32 v42, v42, v249
    v_add_f32 v43, v43, v249
    v_add_f32 v44, v44, v249
    v_add_f32 v45, v45, v249
    v_add_f32 v46, v46, v249
    v_add_f32 v47, v47, v249
    s_waitcnt lgkmcnt(12)
    v_pk_add_f32 v[112:113], v[112:113], v[116:117]
    v_pk_add_f32 v[120:121], v[120:121], v[124:125]
    v_pk_add_f32 v[114:115], v[114:115], v[118:119]
    v_pk_add_f32 v[122:123], v[122:123], v[126:127]
    v_pk_add_f32 v[32:33], v[32:33], v[112:113]
    v_pk_add_f32 v[34:35], v[34:35], v[114:115]
    v_pk_add_f32 v[32:33], v[32:33], v[120:121]
    v_pk_add_f32 v[34:35], v[34:35], v[122:123]
    v_cvt_pk_bf16_f32 v48, v32, v33
    v_cvt_pk_bf16_f32 v49, v34, v35
    s_waitcnt lgkmcnt(8)
    v_pk_add_f32 v[128:129], v[128:129], v[132:133]
    v_pk_add_f32 v[136:137], v[136:137], v[140:141]
    v_pk_add_f32 v[130:131], v[130:131], v[134:135]
    v_pk_add_f32 v[138:139], v[138:139], v[142:143]
    v_pk_add_f32 v[36:37], v[36:37], v[128:129]
    v_pk_add_f32 v[38:39], v[38:39], v[130:131]
    v_pk_add_f32 v[36:37], v[36:37], v[136:137]
    v_pk_add_f32 v[38:39], v[38:39], v[138:139]
    v_cvt_pk_bf16_f32 v50, v36, v37
    v_cvt_pk_bf16_f32 v51, v38, v39
    buffer_store_dwordx4 v[48:51], v22, s[28:31], s78 offen
    s_waitcnt lgkmcnt(4)
    v_pk_add_f32 v[144:145], v[144:145], v[148:149]
    v_pk_add_f32 v[152:153], v[152:153], v[156:157]
    v_pk_add_f32 v[146:147], v[146:147], v[150:151]
    v_pk_add_f32 v[154:155], v[154:155], v[158:159]
    v_pk_add_f32 v[40:41], v[40:41], v[144:145]
    v_pk_add_f32 v[42:43], v[42:43], v[146:147]
    v_pk_add_f32 v[40:41], v[40:41], v[152:153]
    v_pk_add_f32 v[42:43], v[42:43], v[154:155]
    v_cvt_pk_bf16_f32 v52, v40, v41
    v_cvt_pk_bf16_f32 v53, v42, v43
    s_waitcnt lgkmcnt(0)
    v_pk_add_f32 v[160:161], v[160:161], v[164:165]
    v_pk_add_f32 v[168:169], v[168:169], v[172:173]
    v_pk_add_f32 v[162:163], v[162:163], v[166:167]
    v_pk_add_f32 v[170:171], v[170:171], v[174:175]
    v_pk_add_f32 v[44:45], v[44:45], v[160:161]
    v_pk_add_f32 v[46:47], v[46:47], v[162:163]
    v_pk_add_f32 v[44:45], v[44:45], v[168:169]
    v_pk_add_f32 v[46:47], v[46:47], v[170:171]
    v_cvt_pk_bf16_f32 v54, v44, v45
    v_cvt_pk_bf16_f32 v55, v46, v47
    buffer_store_dwordx4 v[52:55], v22, s[28:31], s79 offen
    s_endpgm
L_helper:
    s_waitcnt vmcnt(0) lgkmcnt(0)
    v_mov_b32 v10, 0
    v_mov_b32 v11, 0
    v_mov_b32 v12, 0
    v_mov_b32 v13, 0
    s_sub_u32 s53, s46, 28
    s_lshl_b32 s53, s53, 2
    s_add_u32 s53, s53, s44
    s_getpc_b64 s[98:99]
L_pc:
    s_sub_u32 s98, s98, L_pc-parallel_sum__sliding_local_dilated__mixer_token_mlp__prompt_kernel
    s_subb_u32 s99, s99, 0
    v_and_b32 v17, 15, v1
    v_lshlrev_b32 v17, 7, v17
    s_lshl_b32 s54, s53, 11
    v_add_u32 v17, s54, v17
    v_min_u32 v17, L_codeend-parallel_sum__sliding_local_dilated__mixer_token_mlp__prompt_kernel-4, v17
    global_load_dword v18, v17, s[98:99]
    v_lshrrev_b32 v17, 2, v1
    v_lshlrev_b32 v17, 12, v17
    v_and_b32 v19, 3, v1
    v_lshl_add_u32 v17, v19, 7, v17
    s_mul_i32 s54, s53, 458752
    s_lshl_b32 s56, s45, 9
    s_add_u32 s54, s54, s56
    buffer_load_dword v20, v17, s[20:23], s54 offen
    s_add_u32 s54, s54, 65536
    buffer_load_dword v21, v17, s[20:23], s54 offen
    s_add_u32 s54, s54, 65536
    buffer_load_dword v22, v17, s[20:23], s54 offen
    s_add_u32 s54, s54, 65536
    buffer_load_dword v23, v17, s[20:23], s54 offen
    s_add_u32 s54, s54, 65536
    buffer_load_dword v24, v17, s[20:23], s54 offen
    s_add_u32 s54, s54, 65536
    buffer_load_dword v25, v17, s[20:23], s54 offen
    s_add_u32 s54, s54, 65536
    buffer_load_dword v26, v17, s[20:23], s54 offen
    s_add_u32 s54, s54, 65536
    v_lshlrev_b32 v17, 7, v1
    s_lshl_b32 s54, s53, 15
    buffer_load_dword v20, v17, s[12:15], s54 offen
    s_add_u32 s54, s54, 8192
    buffer_load_dword v21, v17, s[12:15], s54 offen
    s_add_u32 s54, s54, 8192
    buffer_load_dword v22, v17, s[12:15], s54 offen
    s_add_u32 s54, s54, 8192
    buffer_load_dword v23, v17, s[12:15], s54 offen
    s_add_u32 s54, s54, 8192
    v_mov_b32 v29, 0
    buffer_load_dword v29, v29, s[40:43], 0 offen sc1
    s_waitcnt vmcnt(0)
    v_mov_b32 v30, 0
    v_cmp_eq_u32 vcc, 0, v29
    s_nop 0
    s_cbranch_vccz L_ok13
    s_mov_b32 s59, 200000
L_spin12:
    buffer_load_dword v29, v30, s[40:43], 0 offen sc1
    s_waitcnt vmcnt(0)
    v_cmp_eq_u32 vcc, 0, v29
    s_nop 0
    s_cbranch_vccz L_ok13
    s_sub_u32 s59, s59, 1
    s_cbranch_scc0 L_spin12
L_ok13:
    v_readfirstlane_b32 s47, v29
    s_branch L_attn
L_nop2:
    s_cmp_lt_u32 s46, 25
    s_cbranch_scc1 L_p3
L_attn:
    s_waitcnt vmcnt(0) lgkmcnt(0)
    v_and_b32 v17, 15, v1
    v_lshrrev_b32 v18, 4, v1
    v_lshrrev_b32 v28, 3, v1
    v_min_u32 v28, 4, v28
    s_lshl_b32 s53, s45, 2
    s_sub_u32 s53, s53, 1
    v_add_u32 v28, s53, v28
    v_max_i32 v28, 0, v28
    v_and_b32 v29, 7, v1
    v_min_u32 v29, 6, v29
    v_lshl_add_u32 v28, v28, 3, v29
    v_lshlrev_b32 v28, 7, v28
    v_add_u32 v28, 12648448, v28
    buffer_load_dword v29, v28, s[24:27], 0 offen sc1
    v_lshlrev_b32 v19, 15, v18
    v_lshl_add_u32 v19, v17, 4, v19
    v_lshrrev_b32 v23, 1, v18
    v_lshlrev_b32 v20, 11, v23
    v_and_b32 v23, 1, v18
    v_lshl_add_u32 v20, v23, 9, v20
    v_lshl_add_u32 v20, v17, 4, v20
    s_lshl_b32 s53, s44, 12
    v_add_u32 v21, s53, v14
    v_and_b32 v23, 3, v1
    v_lshlrev_b32 v22, 8, v23
    v_lshrrev_b32 v23, 2, v1
    v_lshl_add_u32 v22, v23, 4, v22
    v_add_u32 v22, s53, v22
    v_and_b32 v23, 1, v17
    v_cmp_eq_u32 s[76:77], 1, v23
    v_lshl_add_u32 v23, v18, 2, v23
    v_cmp_le_u32 s[78:79], v23, v17
    v_add_u32 v23, 2, v23
    v_cmp_le_u32 s[80:81], v23, v17
    v_mov_b32 v23, 0xffff
    v_mov_b32 v30, 0xffff0000
    v_cndmask_b32 v23, v23, v30, s[76:77]
    v_cndmask_b32 v24, v23, 0, s[78:79]
    v_cndmask_b32 v25, v23, 0, s[80:81]
    v_cndmask_b32 v26, 0, v23, s[78:79]
    v_cndmask_b32 v27, 0, v23, s[80:81]
    s_sub_u32 s90, s46, 25
    s_lshl_b32 s90, s90, 2
    s_add_u32 s90, s90, s44
    s_waitcnt vmcnt(0)
    v_cmp_ne_u32 vcc, s47, v29
    s_nop 0
    s_cbranch_vccz L_ok15
    s_mov_b32 s59, 200000
L_spin14:
    buffer_load_dword v29, v28, s[24:27], 0 offen sc1
    s_waitcnt vmcnt(0)
    v_cmp_ne_u32 vcc, s47, v29
    s_nop 0
    s_cbranch_vccz L_ok15
    s_sub_u32 s59, s59, 1
    s_cbranch_scc0 L_spin14
L_ok15:
    s_and_b32 s53, s90, 15
    s_mul_i32 s53, s53, 7
    s_lshr_b32 s53, s53, 1
    s_lshl_b32 s53, s53, 15
    s_lshr_b32 s54, s90, 4
    s_lshl_b32 s56, s45, 3
    s_add_u32 s54, s54, s56
    s_lshl_b32 s54, s54, 9
    s_add_u32 s91, s53, s54
    s_add_u32 s91, s91, 6291456
    s_cmp_eq_u32 s54, 0
    s_cselect_b32 s56, 0, 256
    s_add_u32 s92, s91, 1835008
    s_sub_u32 s93, s92, s56
    buffer_load_dwordx4 v[96:99], v19, s[24:27], s91 offen offset:0 sc1
    buffer_load_dwordx4 v[100:103], v19, s[24:27], s91 offen offset:256 sc1
    buffer_load_dwordx4 v[104:107], v19, s[24:27], s93 offen sc1
    buffer_load_dwordx4 v[108:111], v19, s[24:27], s92 offen offset:0 sc1
    buffer_load_dwordx4 v[112:115], v19, s[24:27], s92 offen offset:256 sc1
    s_add_u32 s92, s92, 1835008
    s_add_u32 s93, s93, 1835008
    buffer_load_dwordx4 v[116:119], v19, s[24:27], s93 offen sc1
    buffer_load_dwordx4 v[120:123], v19, s[24:27], s92 offen offset:0 sc1
    buffer_load_dwordx4 v[124:127], v19, s[24:27], s92 offen offset:256 sc1
L_attn_loop:
    s_bitcmp1_b32 s90, 0
    s_cselect_b32 s82, 0xffff, 0
    s_mov_b32 s83, 0
    s_mov_b32 s84, 0
    s_cselect_b32 s85, 0, 0xffff0000
    s_lshr_b32 s54, s90, 4
    s_lshl_b32 s56, s45, 3
    s_add_u32 s54, s54, s56
    s_lshr_b32 s94, s54, 1
    s_lshl_b32 s94, s94, 16
    s_and_b32 s56, s54, 1
    s_lshl_b32 s56, s56, 10
    s_add_u32 s94, s94, s56
    s_and_b32 s56, s90, 15
    s_lshl_b32 s56, s56, 12
    s_add_u32 s94, s94, s56
    s_add_u32 s94, s94, 4194304
    s_cmp_eq_u32 s54, 0
    s_cselect_b64 s[86:87], -1, 0
    s_andn2_b64 s[88:89], s[86:87], s[80:81]
    s_andn2_b64 s[86:87], s[86:87], s[78:79]
    s_waitcnt vmcnt(0) lgkmcnt(0)
    ds_write_b128 v21, v[116:119] offset:0
    ds_write_b128 v21, v[120:123] offset:1024
    ds_write_b128 v21, v[124:127] offset:2048
    v_cndmask_b32 v96, v96, 0, s[82:83]
    v_cndmask_b32 v97, v97, 0, s[82:83]
    v_cndmask_b32 v98, v98, 0, s[84:85]
    v_cndmask_b32 v99, v99, 0, s[84:85]
    v_cndmask_b32 v100, v100, 0, s[82:83]
    v_cndmask_b32 v101, v101, 0, s[82:83]
    v_cndmask_b32 v102, v102, 0, s[84:85]
    v_cndmask_b32 v103, v103, 0, s[84:85]
    ds_read_b64_tr_b16 v[144:145], v22 offset:0
    ds_read_b64_tr_b16 v[146:147], v22 offset:1024
    ds_read_b64_tr_b16 v[148:149], v22 offset:2048
    ds_read_b64_tr_b16 v[150:151], v22 offset:8
    ds_read_b64_tr_b16 v[152:153], v22 offset:1032
    ds_read_b64_tr_b16 v[154:155], v22 offset:2056
    v_mfma_f32_16x16x32_bf16 v[128:131], v[104:107], v[96:99], 0
    v_mfma_f32_16x16x32_bf16 v[132:135], v[108:111], v[96:99], 0
    v_mfma_f32_16x16x32_bf16 v[136:139], v[108:111], v[100:103], 0
    v_mfma_f32_16x16x32_bf16 v[140:143], v[112:115], v[100:103], 0
    s_waitcnt lgkmcnt(0)
    s_add_u32 s95, s90, 28
    s_min_u32 s90, s95, 127
    s_and_b32 s53, s90, 15
    s_mul_i32 s53, s53, 7
    s_lshr_b32 s53, s53, 1
    s_lshl_b32 s53, s53, 15
    s_lshr_b32 s54, s90, 4
    s_lshl_b32 s56, s45, 3
    s_add_u32 s54, s54, s56
    s_lshl_b32 s54, s54, 9
    s_add_u32 s91, s53, s54
    s_add_u32 s91, s91, 6291456
    s_cmp_eq_u32 s54, 0
    s_cselect_b32 s56, 0, 256
    s_add_u32 s92, s91, 1835008
    s_sub_u32 s93, s92, s56
    buffer_load_dwordx4 v[96:99], v19, s[24:27], s91 offen offset:0 sc1
    buffer_load_dwordx4 v[100:103], v19, s[24:27], s91 offen offset:256 sc1
    buffer_load_dwordx4 v[104:107], v19, s[24:27], s93 offen sc1
    buffer_load_dwordx4 v[108:111], v19, s[24:27], s92 offen offset:0 sc1
    buffer_load_dwordx4 v[112:115], v19, s[24:27], s92 offen offset:256 sc1
    s_add_u32 s92, s92, 1835008
    s_add_u32 s93, s93, 1835008
    buffer_load_dwordx4 v[116:119], v19, s[24:27], s93 offen sc1
    buffer_load_dwordx4 v[120:123], v19, s[24:27], s92 offen offset:0 sc1
    buffer_load_dwordx4 v[124:127], v19, s[24:27], s92 offen offset:256 sc1
    s_mov_b32 s53, 0x3e8b97f6
    v_mov_b32 v23, 0xf149f2ca
    v_cndmask_b32 v188, v128, v129, s[76:77]
    v_cndmask_b32 v189, v130, v131, s[76:77]
    v_cndmask_b32 v190, v132, v133, s[76:77]
    v_cndmask_b32 v191, v134, v135, s[76:77]
    v_cndmask_b32 v188, v188, v190, s[78:79]
    v_cndmask_b32 v189, v189, v191, s[80:81]
    v_cndmask_b32 v196, v136, v137, s[76:77]
    v_cndmask_b32 v197, v138, v139, s[76:77]
    v_cndmask_b32 v198, v140, v141, s[76:77]
    v_cndmask_b32 v199, v142, v143, s[76:77]
    v_cndmask_b32 v196, v196, v198, s[78:79]
    v_cndmask_b32 v197, v197, v199, s[80:81]
    v_cndmask_b32 v188, v188, v23, s[86:87]
    v_cndmask_b32 v189, v189, v23, s[88:89]
    v_max_f32 v190, v188, v189
    v_max_f32 v198, v196, v197
    v_mov_b32 v191, v190
    v_mov_b32 v199, v198
    s_nop 0
    v_permlane16_swap_b32 v190, v191
    v_permlane16_swap_b32 v198, v199
    v_max_f32 v190, v190, v191
    v_max_f32 v198, v198, v199
    v_mov_b32 v191, v190
    v_mov_b32 v199, v198
    s_nop 0
    v_permlane32_swap_b32 v190, v191
    v_permlane32_swap_b32 v198, v199
    v_max_f32 v190, v190, v191
    v_max_f32 v198, v198, v199
    v_sub_f32 v188, v188, v190
    v_sub_f32 v189, v189, v190
    v_sub_f32 v196, v196, v198
    v_sub_f32 v197, v197, v198
    v_mul_f32 v188, s53, v188
    v_mul_f32 v189, s53, v189
    v_mul_f32 v196, s53, v196
    v_mul_f32 v197, s53, v197
    v_exp_f32 v188, v188
    v_exp_f32 v189, v189
    v_exp_f32 v196, v196
    v_exp_f32 v197, v197
    v_add_f32 v190, v188, v189
    v_add_f32 v198, v196, v197
    v_mov_b32 v191, v190
    v_mov_b32 v199, v198
    s_nop 0
    v_permlane16_swap_b32 v190, v191
    v_permlane16_swap_b32 v198, v199
    v_add_f32 v190, v190, v191
    v_add_f32 v198, v198, v199
    v_mov_b32 v191, v190
    v_mov_b32 v199, v198
    s_nop 0
    v_permlane32_swap_b32 v190, v191
    v_permlane32_swap_b32 v198, v199
    v_add_f32 v190, v190, v191
    v_add_f32 v198, v198, v199
    v_rcp_f32 v190, v190
    v_rcp_f32 v198, v198
    v_mul_f32 v188, v188, v190
    v_mul_f32 v189, v189, v190
    v_mul_f32 v196, v196, v198
    v_mul_f32 v197, v197, v198
    v_cvt_pk_bf16_f32 v188, v188, v188
    v_cvt_pk_bf16_f32 v189, v189, v189
    v_cvt_pk_bf16_f32 v196, v196, v196
    v_cvt_pk_bf16_f32 v197, v197, v197
    v_and_b32 v156, v188, v24
    v_and_b32 v157, v189, v25
    v_and_b32 v158, v188, v26
    v_and_b32 v159, v189, v27
    v_and_b32 v160, v196, v24
    v_and_b32 v161, v197, v25
    v_and_b32 v162, v196, v26
    v_and_b32 v163, v197, v27
    v_mfma_f32_16x16x32_bf16 v[164:167], v[144:147], v[156:159], 0
    v_mfma_f32_16x16x32_bf16 v[168:171], v[150:153], v[156:159], 0
    v_mfma_f32_16x16x32_bf16 v[172:175], v[146:149], v[160:163], 0
    v_mfma_f32_16x16x32_bf16 v[176:179], v[152:155], v[160:163], 0
    s_nop 4
    v_cvt_pk_bf16_f32 v180, v164, v165
    v_cvt_pk_bf16_f32 v181, v166, v167
    v_cvt_pk_bf16_f32 v182, v168, v169
    v_cvt_pk_bf16_f32 v183, v170, v171
    v_cndmask_b32 v180, v180, 0, s[82:83]
    v_cndmask_b32 v181, v181, 0, s[82:83]
    v_cndmask_b32 v182, v182, 0, s[84:85]
    v_cndmask_b32 v183, v183, 0, s[84:85]
    buffer_store_dwordx4 v[180:183], v20, s[24:27], s94 offen offset:0 sc1
    v_cvt_pk_bf16_f32 v184, v172, v173
    v_cvt_pk_bf16_f32 v185, v174, v175
    v_cvt_pk_bf16_f32 v186, v176, v177
    v_cvt_pk_bf16_f32 v187, v178, v179
    v_cndmask_b32 v184, v184, 0, s[82:83]
    v_cndmask_b32 v185, v185, 0, s[82:83]
    v_cndmask_b32 v186, v186, 0, s[84:85]
    v_cndmask_b32 v187, v187, 0, s[84:85]
    buffer_store_dwordx4 v[184:187], v20, s[24:27], s94 offen offset:256 sc1
    s_cmp_lt_u32 s95, 128
    s_cbranch_scc1 L_attn_loop
    s_waitcnt vmcnt(0) lgkmcnt(0)
    s_barrier
    s_lshl_b32 s53, s45, 3
    s_add_u32 s53, s53, s46
    s_sub_u32 s53, s53, 25
    s_lshl_b32 s53, s53, 7
    s_add_u32 s53, s53, 12779520
    s_cmp_lg_u32 s44, 0
    s_cbranch_scc1 L_nopub16
    v_mov_b32 v29, 0
    v_mov_b32 v30, s47
    s_mov_b64 exec, 1
    buffer_store_dword v30, v29, s[24:27], s53 offen sc1
    s_mov_b64 exec, -1
L_nopub16:
    s_cmp_lt_u32 s46, 28
    s_cbranch_scc1 L_p3
L_end:
    s_endpgm
L_codeend:
.section .rodata,"a"
.p2align 6
.amdhsa_kernel parallel_sum__sliding_local_dilated__mixer_token_mlp__prompt_kernel
  .amdhsa_next_free_vgpr 512
  .amdhsa_next_free_sgpr 102
  .amdhsa_accum_offset 256
  .amdhsa_group_segment_fixed_size 0
  .amdhsa_kernarg_size 88
  .amdhsa_user_sgpr_count 2
  .amdhsa_user_sgpr_kernarg_segment_ptr 1
  .amdhsa_system_sgpr_workgroup_id_x 1
  .amdhsa_float_denorm_mode_32 3
.end_amdhsa_kernel
```

```asm
; @launch grid=(256,1,1) block=(256,1,1) lds=163840
.amdgcn_target "amdgcn-amd-amdhsa--gfx950"
.text
.globl parallel_sum__sliding_local_dilated__mixer_token_mlp__prompt_kernel
.p2align 8
.type parallel_sum__sliding_local_dilated__mixer_token_mlp__prompt_kernel,@function
parallel_sum__sliding_local_dilated__mixer_token_mlp__prompt_kernel:
    s_cmp_ge_u32 s2, 256
    s_cbranch_scc1 L_end
    s_load_dwordx2 s[4:5], s[0:1], 0
    s_load_dwordx16 s[76:91], s[0:1], 0
    s_load_dwordx4 s[92:95], s[0:1], 64
    s_load_dwordx2 s[24:25], s[0:1], 80
    s_lshr_b32 s46, s2, 3
    s_getpc_b64 s[98:99]
L_pc:
    s_lshl_b32 s53, s46, 10
    v_lshrrev_b32 v18, 5, v0
    v_lshl_add_u32 v18, v18, 7, s53
    v_min_u32 v18, L_codeend-L_pc-4, v18
    v_mov_b32 v21, s99
    v_add_co_u32 v20, vcc, s98, v18
    s_nop 1
    v_addc_co_u32 v21, vcc, 0, v21, vcc
    global_load_dword v255, v[20:21], off
    v_lshrrev_b32 v18, 6, v0
    v_and_b32 v1, 63, v0
    s_and_b32 s45, s2, 7
    v_readfirstlane_b32 s44, v18
    s_mul_i32 s53, s46, 37
    s_lshr_b32 s53, s53, 8
    s_mul_i32 s54, s53, 7
    s_sub_u32 s49, s46, s54
    s_lshl_b32 s48, s45, 2
    s_add_u32 s48, s48, s53
    v_lshrrev_b32 v29, 2, v0
    v_mul_u32_u24 v17, 896, v29
    v_and_b32 v30, 3, v0
    v_lshl_add_u32 v17, v30, 4, v17
    s_mul_i32 s53, s48, 57344
    v_add_u32 v17, s53, v17
    s_lshl_b32 s3, s48, 1
    s_add_u32 s3, s3, s49
    s_mul_i32 s56, s3, 37
    s_lshr_b32 s56, s56, 8
    s_mul_i32 s56, s56, 7
    s_sub_u32 s3, s3, s56
    s_lshl_b32 s58, s3, 7
    s_mov_b32 s6, 1835008
    s_mov_b32 s7, 0x20000
    s_cmp_ge_u32 s46, 28
    s_waitcnt lgkmcnt(0)
    s_cbranch_scc1 L_helper
    s_mul_i32 s67, s58, 1344
    buffer_load_dwordx4 v[32:35], v17, s[4:7], s58 offen offset:0
    buffer_load_dwordx4 v[36:39], v17, s[4:7], s58 offen offset:64
    s_add_u32 s58, s58, 128
    s_cmp_eq_u32 s58, 896
    s_cselect_b32 s58, 0, s58
    s_mul_i32 s68, s58, 1344
    buffer_load_dwordx4 v[40:43], v17, s[4:7], s58 offen offset:0
    buffer_load_dwordx4 v[44:47], v17, s[4:7], s58 offen offset:64
    s_add_u32 s58, s58, 128
    s_cmp_eq_u32 s58, 896
    s_cselect_b32 s58, 0, s58
    s_mul_i32 s69, s58, 1344
    buffer_load_dwordx4 v[48:51], v17, s[4:7], s58 offen offset:0
    buffer_load_dwordx4 v[52:55], v17, s[4:7], s58 offen offset:64
    s_add_u32 s58, s58, 128
    s_cmp_eq_u32 s58, 896
    s_cselect_b32 s58, 0, s58
    s_mul_i32 s70, s58, 1344
    buffer_load_dwordx4 v[56:59], v17, s[4:7], s58 offen offset:0
    buffer_load_dwordx4 v[60:63], v17, s[4:7], s58 offen offset:64
    s_add_u32 s58, s58, 128
    s_cmp_eq_u32 s58, 896
    s_cselect_b32 s58, 0, s58
    s_mul_i32 s71, s58, 1344
    buffer_load_dwordx4 v[64:67], v17, s[4:7], s58 offen offset:0
    buffer_load_dwordx4 v[68:71], v17, s[4:7], s58 offen offset:64
    s_add_u32 s58, s58, 128
    s_cmp_eq_u32 s58, 896
    s_cselect_b32 s58, 0, s58
    s_mul_i32 s72, s58, 1344
    buffer_load_dwordx4 v[72:75], v17, s[4:7], s58 offen offset:0
    s_mov_b64 s[8:9], s[78:79]
    s_mov_b32 s10, 1204224
    s_mov_b32 s11, s7
    s_mov_b32 s26, 16777216
    s_mov_b32 s27, s7
    s_mov_b64 s[40:41], s[94:95]
    s_mov_b32 s42, 256
    s_mov_b32 s43, s7
    s_mov_b64 s[16:17], s[84:85]
    s_mov_b32 s18, 7340032
    s_mov_b32 s19, s7
    s_mov_b64 s[20:21], s[88:89]
    s_mov_b32 s22, 7340032
    s_mov_b32 s23, s7
    s_mov_b64 s[12:13], s[80:81]
    s_mov_b32 s14, 401408
    s_mov_b32 s15, s7
    s_mov_b64 s[28:29], s[92:93]
    s_mov_b32 s30, 1835008
    s_mov_b32 s31, s7
    s_mov_b64 s[32:33], s[86:87]
    s_mov_b32 s34, 3584
    s_mov_b32 s35, s7
    s_mov_b64 s[36:37], s[90:91]
    s_mov_b32 s38, 4096
    s_mov_b32 s39, s7
    s_lshl_b32 s52, s44, 11
    v_lshlrev_b32 v12, 4, v1
    v_lshrrev_b32 v210, 5, v1
    v_bfe_u32 v211, v1, 2, 2
    v_lshl_add_u32 v208, v210, 2, v211
    v_bfe_u32 v212, v1, 4, 1
    v_lshlrev_b32 v209, 4, v30
    v_lshl_add_u32 v209, v212, 6, v209
    s_mul_i32 s53, s44, 43008
    s_mul_i32 s54, s49, 384
    s_add_u32 s53, s53, s54
    v_mul_u32_u24 v18, 2688, v208
    v_add3_u32 v18, v18, v209, s53
    s_mul_i32 s55, s44, 6144
    v_add_u32 v19, 128, v18
    v_add_u32 v20, 256, v18
    v_add_u32 v21, 21504, v18
    v_add_u32 v22, 21632, v18
    v_add_u32 v23, 21760, v18
    v_mul_u32_u24 v24, 1056, v30
    v_lshl_add_u32 v24, v29, 4, v24
    v_lshlrev_b32 v213, 6, v211
    v_lshl_add_u32 v213, v212, 5, v213
    v_lshl_add_u32 v213, v30, 3, v213
    s_and_b32 s53, s44, 1
    s_lshl_b32 s53, s53, 9
    v_and_b32 v214, 31, v1
    v_mul_u32_u24 v25, 1056, v210
    v_lshl_add_u32 v25, v214, 4, v25
    v_add_u32 v25, s53, v25
    s_lshr_b32 s53, s44, 1
    s_lshl_b32 s53, s53, 8
    s_add_u32 s53, s53, 65536
    v_mul_u32_u24 v26, 3072, v210
    v_add3_u32 v26, v26, v213, s53
    v_add_u32 v27, 49152, v26
    v_bfe_u32 v215, v1, 1, 1
    v_lshl_add_u32 v215, v212, 1, v215
    v_mul_u32_u24 v28, 1056, v215
    v_lshl_add_u32 v215, v210, 3, v211
    v_lshl_add_u32 v28, v215, 4, v28
    v_and_b32 v215, 1, v1
    v_lshl_add_u32 v28, v215, 3, v28
    s_lshl_b32 s53, s44, 8
    v_add_u32 v28, s53, v28
    s_mov_b32 s74, 0x3f803f80
    s_mov_b32 s63, 0xffff0000
    v_mov_b32 v216, 0
    v_mov_b32 v217, 0
    buffer_load_dwordx4 v[76:79], v17, s[4:7], s58 offen offset:64
    s_add_u32 s58, s58, 128
    s_cmp_eq_u32 s58, 896
    s_cselect_b32 s58, 0, s58
    s_mul_i32 s73, s58, 1344
    buffer_load_dwordx4 v[80:83], v17, s[4:7], s58 offen offset:0
    buffer_load_dwordx4 v[84:87], v17, s[4:7], s58 offen offset:64
    s_add_u32 m0, s55, 65536
    s_nop 0
    buffer_load_dwordx4 v18, s[8:11], s67 offen lds
    s_add_u32 m0, s55, 66560
    s_nop 0
    buffer_load_dwordx4 v19, s[8:11], s67 offen lds
    s_waitcnt vmcnt(15)
    v_dot2c_f32_bf16 v216, s74, v32
    v_dot2c_f32_bf16 v217, v32, v32
    v_lshlrev_b32 v96, 16, v32
    v_and_b32 v97, s63, v32
    v_dot2c_f32_bf16 v216, s74, v33
    v_dot2c_f32_bf16 v217, v33, v33
    v_lshlrev_b32 v98, 16, v33
    v_and_b32 v99, s63, v33
    v_dot2c_f32_bf16 v216, s74, v34
    v_dot2c_f32_bf16 v217, v34, v34
    v_lshlrev_b32 v100, 16, v34
    v_and_b32 v101, s63, v34
    v_dot2c_f32_bf16 v216, s74, v35
    v_dot2c_f32_bf16 v217, v35, v35
    v_lshlrev_b32 v102, 16, v35
    v_and_b32 v103, s63, v35
    s_waitcnt vmcnt(14)
    v_dot2c_f32_bf16 v216, s74, v36
    v_dot2c_f32_bf16 v217, v36, v36
    v_lshlrev_b32 v104, 16, v36
    v_and_b32 v105, s63, v36
    v_dot2c_f32_bf16 v216, s74, v37
    v_dot2c_f32_bf16 v217, v37, v37
    v_lshlrev_b32 v106, 16, v37
    v_and_b32 v107, s63, v37
    v_dot2c_f32_bf16 v216, s74, v38
    v_dot2c_f32_bf16 v217, v38, v38
    v_lshlrev_b32 v108, 16, v38
    v_and_b32 v109, s63, v38
    v_dot2c_f32_bf16 v216, s74, v39
    v_dot2c_f32_bf16 v217, v39, v39
    v_lshlrev_b32 v110, 16, v39
    v_and_b32 v111, s63, v39
    s_waitcnt vmcnt(13)
    v_dot2c_f32_bf16 v216, s74, v40
    v_dot2c_f32_bf16 v217, v40, v40
    v_lshlrev_b32 v112, 16, v40
    v_and_b32 v113, s63, v40
    v_dot2c_f32_bf16 v216, s74, v41
    v_dot2c_f32_bf16 v217, v41, v41
    v_lshlrev_b32 v114, 16, v41
    v_and_b32 v115, s63, v41
    v_dot2c_f32_bf16 v216, s74, v42
    v_dot2c_f32_bf16 v217, v42, v42
    v_lshlrev_b32 v116, 16, v42
    v_and_b32 v117, s63, v42
    v_dot2c_f32_bf16 v216, s74, v43
    v_dot2c_f32_bf16 v217, v43, v43
    v_lshlrev_b32 v118, 16, v43
    v_and_b32 v119, s63, v43
    s_waitcnt vmcnt(12)
    v_dot2c_f32_bf16 v216, s74, v44
    v_dot2c_f32_bf16 v217, v44, v44
    v_lshlrev_b32 v120, 16, v44
    v_and_b32 v121, s63, v44
    s_add_u32 m0, s55, 67584
    s_nop 0
    buffer_load_dwordx4 v20, s[8:11], s67 offen lds
    v_dot2c_f32_bf16 v216, s74, v45
    v_dot2c_f32_bf16 v217, v45, v45
    v_lshlrev_b32 v122, 16, v45
    v_and_b32 v123, s63, v45
    v_dot2c_f32_bf16 v216, s74, v46
    v_dot2c_f32_bf16 v217, v46, v46
    v_lshlrev_b32 v124, 16, v46
    v_and_b32 v125, s63, v46
    v_dot2c_f32_bf16 v216, s74, v47
    v_dot2c_f32_bf16 v217, v47, v47
    v_lshlrev_b32 v126, 16, v47
    v_and_b32 v127, s63, v47
    s_waitcnt vmcnt(12)
    v_dot2c_f32_bf16 v216, s74, v48
    v_dot2c_f32_bf16 v217, v48, v48
    v_lshlrev_b32 v128, 16, v48
    v_and_b32 v129, s63, v48
    v_dot2c_f32_bf16 v216, s74, v49
    v_dot2c_f32_bf16 v217, v49, v49
    v_lshlrev_b32 v130, 16, v49
    v_and_b32 v131, s63, v49
    v_dot2c_f32_bf16 v216, s74, v50
    v_dot2c_f32_bf16 v217, v50, v50
    v_lshlrev_b32 v132, 16, v50
    v_and_b32 v133, s63, v50
    v_dot2c_f32_bf16 v216, s74, v51
    v_dot2c_f32_bf16 v217, v51, v51
    v_lshlrev_b32 v134, 16, v51
    v_and_b32 v135, s63, v51
    s_waitcnt vmcnt(11)
    v_dot2c_f32_bf16 v216, s74, v52
    v_dot2c_f32_bf16 v217, v52, v52
    v_lshlrev_b32 v136, 16, v52
    v_and_b32 v137, s63, v52
    v_dot2c_f32_bf16 v216, s74, v53
    v_dot2c_f32_bf16 v217, v53, v53
    v_lshlrev_b32 v138, 16, v53
    v_and_b32 v139, s63, v53
    v_dot2c_f32_bf16 v216, s74, v54
    v_dot2c_f32_bf16 v217, v54, v54
    v_lshlrev_b32 v140, 16, v54
    v_and_b32 v141, s63, v54
    v_dot2c_f32_bf16 v216, s74, v55
    v_dot2c_f32_bf16 v217, v55, v55
    v_lshlrev_b32 v142, 16, v55
    v_and_b32 v143, s63, v55
    s_waitcnt vmcnt(10)
    v_dot2c_f32_bf16 v216, s74, v56
    v_dot2c_f32_bf16 v217, v56, v56
    v_lshlrev_b32 v144, 16, v56
    v_and_b32 v145, s63, v56
    v_dot2c_f32_bf16 v216, s74, v57
    v_dot2c_f32_bf16 v217, v57, v57
    v_lshlrev_b32 v146, 16, v57
    v_and_b32 v147, s63, v57
    s_add_u32 m0, s55, 68608
    s_nop 0
    buffer_load_dwordx4 v21, s[8:11], s67 offen lds
    v_dot2c_f32_bf16 v216, s74, v58
    v_dot2c_f32_bf16 v217, v58, v58
    v_lshlrev_b32 v148, 16, v58
    v_and_b32 v149, s63, v58
    v_dot2c_f32_bf16 v216, s74, v59
    v_dot2c_f32_bf16 v217, v59, v59
    v_lshlrev_b32 v150, 16, v59
    v_and_b32 v151, s63, v59
    s_waitcnt vmcnt(10)
    v_dot2c_f32_bf16 v216, s74, v60
    v_dot2c_f32_bf16 v217, v60, v60
    v_lshlrev_b32 v152, 16, v60
    v_and_b32 v153, s63, v60
    v_dot2c_f32_bf16 v216, s74, v61
    v_dot2c_f32_bf16 v217, v61, v61
    v_lshlrev_b32 v154, 16, v61
    v_and_b32 v155, s63, v61
    v_dot2c_f32_bf16 v216, s74, v62
    v_dot2c_f32_bf16 v217, v62, v62
    v_lshlrev_b32 v156, 16, v62
    v_and_b32 v157, s63, v62
    v_dot2c_f32_bf16 v216, s74, v63
    v_dot2c_f32_bf16 v217, v63, v63
    v_lshlrev_b32 v158, 16, v63
    v_and_b32 v159, s63, v63
    s_waitcnt vmcnt(9)
    v_dot2c_f32_bf16 v216, s74, v64
    v_dot2c_f32_bf16 v217, v64, v64
    v_lshlrev_b32 v160, 16, v64
    v_and_b32 v161, s63, v64
    v_dot2c_f32_bf16 v216, s74, v65
    v_dot2c_f32_bf16 v217, v65, v65
    v_lshlrev_b32 v162, 16, v65
    v_and_b32 v163, s63, v65
    v_dot2c_f32_bf16 v216, s74, v66
    v_dot2c_f32_bf16 v217, v66, v66
    v_lshlrev_b32 v164, 16, v66
    v_and_b32 v165, s63, v66
    v_dot2c_f32_bf16 v216, s74, v67
    v_dot2c_f32_bf16 v217, v67, v67
    v_lshlrev_b32 v166, 16, v67
    v_and_b32 v167, s63, v67
    s_waitcnt vmcnt(8)
    v_dot2c_f32_bf16 v216, s74, v68
    v_dot2c_f32_bf16 v217, v68, v68
    v_lshlrev_b32 v168, 16, v68
    v_and_b32 v169, s63, v68
    v_dot2c_f32_bf16 v216, s74, v69
    v_dot2c_f32_bf16 v217, v69, v69
    v_lshlrev_b32 v170, 16, v69
    v_and_b32 v171, s63, v69
    v_dot2c_f32_bf16 v216, s74, v70
    v_dot2c_f32_bf16 v217, v70, v70
    v_lshlrev_b32 v172, 16, v70
    v_and_b32 v173, s63, v70
    s_add_u32 m0, s55, 69632
    s_nop 0
    buffer_load_dwordx4 v22, s[8:11], s67 offen lds
    v_dot2c_f32_bf16 v216, s74, v71
    v_dot2c_f32_bf16 v217, v71, v71
    v_lshlrev_b32 v174, 16, v71
    v_and_b32 v175, s63, v71
    s_waitcnt vmcnt(8)
    v_dot2c_f32_bf16 v216, s74, v72
    v_dot2c_f32_bf16 v217, v72, v72
    v_lshlrev_b32 v176, 16, v72
    v_and_b32 v177, s63, v72
    v_dot2c_f32_bf16 v216, s74, v73
    v_dot2c_f32_bf16 v217, v73, v73
    v_lshlrev_b32 v178, 16, v73
    v_and_b32 v179, s63, v73
    v_dot2c_f32_bf16 v216, s74, v74
    v_dot2c_f32_bf16 v217, v74, v74
    v_lshlrev_b32 v180, 16, v74
    v_and_b32 v181, s63, v74
    v_dot2c_f32_bf16 v216, s74, v75
    v_dot2c_f32_bf16 v217, v75, v75
    v_lshlrev_b32 v182, 16, v75
    v_and_b32 v183, s63, v75
    s_waitcnt vmcnt(7)
    v_dot2c_f32_bf16 v216, s74, v76
    v_dot2c_f32_bf16 v217, v76, v76
    v_lshlrev_b32 v184, 16, v76
    v_and_b32 v185, s63, v76
    v_dot2c_f32_bf16 v216, s74, v77
    v_dot2c_f32_bf16 v217, v77, v77
    v_lshlrev_b32 v186, 16, v77
    v_and_b32 v187, s63, v77
    v_dot2c_f32_bf16 v216, s74, v78
    v_dot2c_f32_bf16 v217, v78, v78
    v_lshlrev_b32 v188, 16, v78
    v_and_b32 v189, s63, v78
    v_dot2c_f32_bf16 v216, s74, v79
    v_dot2c_f32_bf16 v217, v79, v79
    v_lshlrev_b32 v190, 16, v79
    v_and_b32 v191, s63, v79
    s_waitcnt vmcnt(6)
    v_dot2c_f32_bf16 v216, s74, v80
    v_dot2c_f32_bf16 v217, v80, v80
    v_lshlrev_b32 v192, 16, v80
    v_and_b32 v193, s63, v80
    v_dot2c_f32_bf16 v216, s74, v81
    v_dot2c_f32_bf16 v217, v81, v81
    v_lshlrev_b32 v194, 16, v81
    v_and_b32 v195, s63, v81
    v_dot2c_f32_bf16 v216, s74, v82
    v_dot2c_f32_bf16 v217, v82, v82
    v_lshlrev_b32 v196, 16, v82
    v_and_b32 v197, s63, v82
    v_dot2c_f32_bf16 v216, s74, v83
    v_dot2c_f32_bf16 v217, v83, v83
    v_lshlrev_b32 v198, 16, v83
    v_and_b32 v199, s63, v83
    s_add_u32 m0, s55, 70656
    s_nop 0
    buffer_load_dwordx4 v23, s[8:11], s67 offen lds
    s_waitcnt vmcnt(6)
    v_dot2c_f32_bf16 v216, s74, v84
    v_dot2c_f32_bf16 v217, v84, v84
    v_lshlrev_b32 v200, 16, v84
    v_and_b32 v201, s63, v84
    v_dot2c_f32_bf16 v216, s74, v85
    v_dot2c_f32_bf16 v217, v85, v85
    v_lshlrev_b32 v202, 16, v85
    v_and_b32 v203, s63, v85
    v_dot2c_f32_bf16 v216, s74, v86
    v_dot2c_f32_bf16 v217, v86, v86
    v_lshlrev_b32 v204, 16, v86
    v_and_b32 v205, s63, v86
    v_dot2c_f32_bf16 v216, s74, v87
    v_dot2c_f32_bf16 v217, v87, v87
    v_lshlrev_b32 v206, 16, v87
    v_and_b32 v207, s63, v87
    v_add_f32_dpp v216, v216, v216 quad_perm:[1,0,3,2] row_mask:0xf bank_mask:0xf
    v_add_f32_dpp v217, v217, v217 quad_perm:[1,0,3,2] row_mask:0xf bank_mask:0xf
    s_nop 0
    v_add_f32_dpp v216, v216, v216 quad_perm:[2,3,0,1] row_mask:0xf bank_mask:0xf
    v_add_f32_dpp v217, v217, v217 quad_perm:[2,3,0,1] row_mask:0xf bank_mask:0xf
    v_mul_f32 v218, 0x3b124925, v216
    v_mul_f32 v219, 0x3b124925, v217
    v_fma_f32 v219, -v218, v218, v219
    v_max_f32 v219, 0, v219
    v_cvt_pk_bf16_f32 v220, v219, v219
    v_and_b32 v220, s63, v220
    v_add_f32 v220, 0x3727c5ac, v220
    v_cvt_pk_bf16_f32 v220, v220, v220
    v_and_b32 v220, s63, v220
    v_sqrt_f32 v220, v220
    s_nop 0
    v_cvt_pk_bf16_f32 v220, v220, v220
    v_and_b32 v220, s63, v220
    s_add_u32 m0, s55, 90112
    s_nop 0
    buffer_load_dwordx4 v18, s[8:11], s68 offen lds
    v_rcp_f32 v220, v220
    s_nop 0
    v_mul_f32 v219, v219, v220
    v_mul_f32 v219, v219, v220
    v_cvt_pk_bf16_f32 v224, v219, v219
    v_and_b32 v224, s63, v224
    v_add_f32 v224, 0x3727c5ac, v224
    v_cvt_pk_bf16_f32 v224, v224, v224
    v_and_b32 v224, s63, v224
    v_sqrt_f32 v224, v224
    s_nop 0
    v_cvt_pk_bf16_f32 v224, v224, v224
    v_and_b32 v224, s63, v224
    v_rcp_f32 v224, v224
    s_nop 0
    v_mul_f32 v224, v224, v220
    v_mul_f32 v222, v218, v220
    v_mul_f32 v226, v218, v224
    v_pk_fma_f32 v[228:229], v[96:97], v[224:225], v[226:227] op_sel_hi:[1,0,0] neg_lo:[0,0,1] neg_hi:[0,0,1]
    v_pk_fma_f32 v[230:231], v[98:99], v[224:225], v[226:227] op_sel_hi:[1,0,0] neg_lo:[0,0,1] neg_hi:[0,0,1]
    v_pk_fma_f32 v[232:233], v[100:101], v[224:225], v[226:227] op_sel_hi:[1,0,0] neg_lo:[0,0,1] neg_hi:[0,0,1]
    v_pk_fma_f32 v[234:235], v[102:103], v[224:225], v[226:227] op_sel_hi:[1,0,0] neg_lo:[0,0,1] neg_hi:[0,0,1]
    v_pk_fma_f32 v[236:237], v[104:105], v[224:225], v[226:227] op_sel_hi:[1,0,0] neg_lo:[0,0,1] neg_hi:[0,0,1]
    v_pk_fma_f32 v[238:239], v[106:107], v[224:225], v[226:227] op_sel_hi:[1,0,0] neg_lo:[0,0,1] neg_hi:[0,0,1]
    v_pk_fma_f32 v[240:241], v[108:109], v[224:225], v[226:227] op_sel_hi:[1,0,0] neg_lo:[0,0,1] neg_hi:[0,0,1]
    v_pk_fma_f32 v[242:243], v[110:111], v[224:225], v[226:227] op_sel_hi:[1,0,0] neg_lo:[0,0,1] neg_hi:[0,0,1]
    v_cvt_pk_bf16_f32 v244, v228, v229
    v_cvt_pk_bf16_f32 v245, v230, v231
    v_cvt_pk_bf16_f32 v246, v232, v233
    v_cvt_pk_bf16_f32 v247, v234, v235
    v_cvt_pk_bf16_f32 v248, v236, v237
    v_cvt_pk_bf16_f32 v249, v238, v239
    v_cvt_pk_bf16_f32 v250, v240, v241
    v_cvt_pk_bf16_f32 v251, v242, v243
    s_mul_i32 s64, s3, 268032
    s_add_u32 m0, s55, 91136
    s_nop 0
    buffer_load_dwordx4 v19, s[8:11], s68 offen lds
    s_lshl_b32 s65, s48, 13
    s_add_u32 s64, s64, s65
    s_add_u32 s64, s64, s52
    s_lshr_b32 s65, s48, 3
    s_mul_i32 s65, s65, 1280
    s_add_u32 s64, s64, s65
    ds_write_b128 v24, v[244:247]
    ds_write_b128 v24, v[248:251] offset:4224
    ds_read_b64_tr_b16 v[228:229], v28 offset:0
    ds_read_b64_tr_b16 v[230:231], v28 offset:64
    ds_read_b64_tr_b16 v[232:233], v28 offset:4224
    ds_read_b64_tr_b16 v[234:235], v28 offset:4288
    v_pk_fma_f32 v[96:97], v[96:97], v[220:221], v[222:223] op_sel_hi:[1,0,0] neg_lo:[0,0,1] neg_hi:[0,0,1]
    v_pk_fma_f32 v[98:99], v[98:99], v[220:221], v[222:223] op_sel_hi:[1,0,0] neg_lo:[0,0,1] neg_hi:[0,0,1]
    v_pk_fma_f32 v[100:101], v[100:101], v[220:221], v[222:223] op_sel_hi:[1,0,0] neg_lo:[0,0,1] neg_hi:[0,0,1]
    v_pk_fma_f32 v[102:103], v[102:103], v[220:221], v[222:223] op_sel_hi:[1,0,0] neg_lo:[0,0,1] neg_hi:[0,0,1]
    v_cvt_pk_bf16_f32 v32, v96, v97
    v_cvt_pk_bf16_f32 v33, v98, v99
    v_cvt_pk_bf16_f32 v34, v100, v101
    v_cvt_pk_bf16_f32 v35, v102, v103
    ds_write_b128 v24, v[32:35] offset:0
    v_pk_fma_f32 v[104:105], v[104:105], v[220:221], v[222:223] op_sel_hi:[1,0,0] neg_lo:[0,0,1] neg_hi:[0,0,1]
    v_pk_fma_f32 v[106:107], v[106:107], v[220:221], v[222:223] op_sel_hi:[1,0,0] neg_lo:[0,0,1] neg_hi:[0,0,1]
    v_pk_fma_f32 v[108:109], v[108:109], v[220:221], v[222:223] op_sel_hi:[1,0,0] neg_lo:[0,0,1] neg_hi:[0,0,1]
    v_pk_fma_f32 v[110:111], v[110:111], v[220:221], v[222:223] op_sel_hi:[1,0,0] neg_lo:[0,0,1] neg_hi:[0,0,1]
    v_cvt_pk_bf16_f32 v36, v104, v105
    v_cvt_pk_bf16_f32 v37, v106, v107
    v_cvt_pk_bf16_f32 v38, v108, v109
    v_cvt_pk_bf16_f32 v39, v110, v111
    ds_write_b128 v24, v[36:39] offset:4224
    s_add_u32 m0, s55, 92160
    s_nop 0
    buffer_load_dwordx4 v20, s[8:11], s68 offen lds
    s_waitcnt lgkmcnt(2)
    buffer_store_dwordx4 v[228:231], v12, s[24:27], s64 offen offset:0 sc1
    buffer_store_dwordx4 v[232:235], v12, s[24:27], s64 offen offset:1024 sc1
    v_pk_fma_f32 v[112:113], v[112:113], v[220:221], v[222:223] op_sel_hi:[1,0,0] neg_lo:[0,0,1] neg_hi:[0,0,1]
    v_pk_fma_f32 v[114:115], v[114:115], v[220:221], v[222:223] op_sel_hi:[1,0,0] neg_lo:[0,0,1] neg_hi:[0,0,1]
    v_pk_fma_f32 v[116:117], v[116:117], v[220:221], v[222:223] op_sel_hi:[1,0,0] neg_lo:[0,0,1] neg_hi:[0,0,1]
    v_pk_fma_f32 v[118:119], v[118:119], v[220:221], v[222:223] op_sel_hi:[1,0,0] neg_lo:[0,0,1] neg_hi:[0,0,1]
    v_cvt_pk_bf16_f32 v40, v112, v113
    v_cvt_pk_bf16_f32 v41, v114, v115
    v_cvt_pk_bf16_f32 v42, v116, v117
    v_cvt_pk_bf16_f32 v43, v118, v119
    ds_write_b128 v24, v[40:43] offset:8448
    v_pk_fma_f32 v[120:121], v[120:121], v[220:221], v[222:223] op_sel_hi:[1,0,0] neg_lo:[0,0,1] neg_hi:[0,0,1]
    v_pk_fma_f32 v[122:123], v[122:123], v[220:221], v[222:223] op_sel_hi:[1,0,0] neg_lo:[0,0,1] neg_hi:[0,0,1]
    v_pk_fma_f32 v[124:125], v[124:125], v[220:221], v[222:223] op_sel_hi:[1,0,0] neg_lo:[0,0,1] neg_hi:[0,0,1]
    v_pk_fma_f32 v[126:127], v[126:127], v[220:221], v[222:223] op_sel_hi:[1,0,0] neg_lo:[0,0,1] neg_hi:[0,0,1]
    v_cvt_pk_bf16_f32 v44, v120, v121
    v_cvt_pk_bf16_f32 v45, v122, v123
    v_cvt_pk_bf16_f32 v46, v124, v125
    v_cvt_pk_bf16_f32 v47, v126, v127
    ds_write_b128 v24, v[44:47] offset:12672
    v_pk_fma_f32 v[128:129], v[128:129], v[220:221], v[222:223] op_sel_hi:[1,0,0] neg_lo:[0,0,1] neg_hi:[0,0,1]
    v_pk_fma_f32 v[130:131], v[130:131], v[220:221], v[222:223] op_sel_hi:[1,0,0] neg_lo:[0,0,1] neg_hi:[0,0,1]
    v_pk_fma_f32 v[132:133], v[132:133], v[220:221], v[222:223] op_sel_hi:[1,0,0] neg_lo:[0,0,1] neg_hi:[0,0,1]
    v_pk_fma_f32 v[134:135], v[134:135], v[220:221], v[222:223] op_sel_hi:[1,0,0] neg_lo:[0,0,1] neg_hi:[0,0,1]
    v_cvt_pk_bf16_f32 v48, v128, v129
    v_cvt_pk_bf16_f32 v49, v130, v131
    v_cvt_pk_bf16_f32 v50, v132, v133
    v_cvt_pk_bf16_f32 v51, v134, v135
    ds_write_b128 v24, v[48:51] offset:16896
    s_add_u32 m0, s55, 93184
    s_nop 0
    buffer_load_dwordx4 v21, s[8:11], s68 offen lds
    v_pk_fma_f32 v[136:137], v[136:137], v[220:221], v[222:223] op_sel_hi:[1,0,0] neg_lo:[0,0,1] neg_hi:[0,0,1]
    v_pk_fma_f32 v[138:139], v[138:139], v[220:221], v[222:223] op_sel_hi:[1,0,0] neg_lo:[0,0,1] neg_hi:[0,0,1]
    v_pk_fma_f32 v[140:141], v[140:141], v[220:221], v[222:223] op_sel_hi:[1,0,0] neg_lo:[0,0,1] neg_hi:[0,0,1]
    v_pk_fma_f32 v[142:143], v[142:143], v[220:221], v[222:223] op_sel_hi:[1,0,0] neg_lo:[0,0,1] neg_hi:[0,0,1]
    v_cvt_pk_bf16_f32 v52, v136, v137
    v_cvt_pk_bf16_f32 v53, v138, v139
    v_cvt_pk_bf16_f32 v54, v140, v141
    v_cvt_pk_bf16_f32 v55, v142, v143
    ds_write_b128 v24, v[52:55] offset:21120
    v_pk_fma_f32 v[144:145], v[144:145], v[220:221], v[222:223] op_sel_hi:[1,0,0] neg_lo:[0,0,1] neg_hi:[0,0,1]
    v_pk_fma_f32 v[146:147], v[146:147], v[220:221], v[222:223] op_sel_hi:[1,0,0] neg_lo:[0,0,1] neg_hi:[0,0,1]
    v_pk_fma_f32 v[148:149], v[148:149], v[220:221], v[222:223] op_sel_hi:[1,0,0] neg_lo:[0,0,1] neg_hi:[0,0,1]
    v_pk_fma_f32 v[150:151], v[150:151], v[220:221], v[222:223] op_sel_hi:[1,0,0] neg_lo:[0,0,1] neg_hi:[0,0,1]
    v_cvt_pk_bf16_f32 v56, v144, v145
    v_cvt_pk_bf16_f32 v57, v146, v147
    v_cvt_pk_bf16_f32 v58, v148, v149
    v_cvt_pk_bf16_f32 v59, v150, v151
    ds_write_b128 v24, v[56:59] offset:25344
    v_pk_fma_f32 v[152:153], v[152:153], v[220:221], v[222:223] op_sel_hi:[1,0,0] neg_lo:[0,0,1] neg_hi:[0,0,1]
    v_pk_fma_f32 v[154:155], v[154:155], v[220:221], v[222:223] op_sel_hi:[1,0,0] neg_lo:[0,0,1] neg_hi:[0,0,1]
    v_pk_fma_f32 v[156:157], v[156:157], v[220:221], v[222:223] op_sel_hi:[1,0,0] neg_lo:[0,0,1] neg_hi:[0,0,1]
    v_pk_fma_f32 v[158:159], v[158:159], v[220:221], v[222:223] op_sel_hi:[1,0,0] neg_lo:[0,0,1] neg_hi:[0,0,1]
    v_cvt_pk_bf16_f32 v60, v152, v153
    v_cvt_pk_bf16_f32 v61, v154, v155
    v_cvt_pk_bf16_f32 v62, v156, v157
    v_cvt_pk_bf16_f32 v63, v158, v159
    ds_write_b128 v24, v[60:63] offset:29568
    s_add_u32 m0, s55, 94208
    s_nop 0
    buffer_load_dwordx4 v22, s[8:11], s68 offen lds
    v_pk_fma_f32 v[160:161], v[160:161], v[220:221], v[222:223] op_sel_hi:[1,0,0] neg_lo:[0,0,1] neg_hi:[0,0,1]
    v_pk_fma_f32 v[162:163], v[162:163], v[220:221], v[222:223] op_sel_hi:[1,0,0] neg_lo:[0,0,1] neg_hi:[0,0,1]
    v_pk_fma_f32 v[164:165], v[164:165], v[220:221], v[222:223] op_sel_hi:[1,0,0] neg_lo:[0,0,1] neg_hi:[0,0,1]
    v_pk_fma_f32 v[166:167], v[166:167], v[220:221], v[222:223] op_sel_hi:[1,0,0] neg_lo:[0,0,1] neg_hi:[0,0,1]
    v_cvt_pk_bf16_f32 v64, v160, v161
    v_cvt_pk_bf16_f32 v65, v162, v163
    v_cvt_pk_bf16_f32 v66, v164, v165
    v_cvt_pk_bf16_f32 v67, v166, v167
    ds_write_b128 v24, v[64:67] offset:33792
    v_pk_fma_f32 v[168:169], v[168:169], v[220:221], v[222:223] op_sel_hi:[1,0,0] neg_lo:[0,0,1] neg_hi:[0,0,1]
    v_pk_fma_f32 v[170:171], v[170:171], v[220:221], v[222:223] op_sel_hi:[1,0,0] neg_lo:[0,0,1] neg_hi:[0,0,1]
    v_pk_fma_f32 v[172:173], v[172:173], v[220:221], v[222:223] op_sel_hi:[1,0,0] neg_lo:[0,0,1] neg_hi:[0,0,1]
    v_pk_fma_f32 v[174:175], v[174:175], v[220:221], v[222:223] op_sel_hi:[1,0,0] neg_lo:[0,0,1] neg_hi:[0,0,1]
    v_cvt_pk_bf16_f32 v68, v168, v169
    v_cvt_pk_bf16_f32 v69, v170, v171
    v_cvt_pk_bf16_f32 v70, v172, v173
    v_cvt_pk_bf16_f32 v71, v174, v175
    ds_write_b128 v24, v[68:71] offset:38016
    v_pk_fma_f32 v[176:177], v[176:177], v[220:221], v[222:223] op_sel_hi:[1,0,0] neg_lo:[0,0,1] neg_hi:[0,0,1]
    v_pk_fma_f32 v[178:179], v[178:179], v[220:221], v[222:223] op_sel_hi:[1,0,0] neg_lo:[0,0,1] neg_hi:[0,0,1]
    v_pk_fma_f32 v[180:181], v[180:181], v[220:221], v[222:223] op_sel_hi:[1,0,0] neg_lo:[0,0,1] neg_hi:[0,0,1]
    v_pk_fma_f32 v[182:183], v[182:183], v[220:221], v[222:223] op_sel_hi:[1,0,0] neg_lo:[0,0,1] neg_hi:[0,0,1]
    v_cvt_pk_bf16_f32 v72, v176, v177
    v_cvt_pk_bf16_f32 v73, v178, v179
    v_cvt_pk_bf16_f32 v74, v180, v181
    v_cvt_pk_bf16_f32 v75, v182, v183
    ds_write_b128 v24, v[72:75] offset:42240
    s_add_u32 m0, s55, 95232
    s_nop 0
    buffer_load_dwordx4 v23, s[8:11], s68 offen lds
    v_pk_fma_f32 v[184:185], v[184:185], v[220:221], v[222:223] op_sel_hi:[1,0,0] neg_lo:[0,0,1] neg_hi:[0,0,1]
    v_pk_fma_f32 v[186:187], v[186:187], v[220:221], v[222:223] op_sel_hi:[1,0,0] neg_lo:[0,0,1] neg_hi:[0,0,1]
    v_pk_fma_f32 v[188:189], v[188:189], v[220:221], v[222:223] op_sel_hi:[1,0,0] neg_lo:[0,0,1] neg_hi:[0,0,1]
    v_pk_fma_f32 v[190:191], v[190:191], v[220:221], v[222:223] op_sel_hi:[1,0,0] neg_lo:[0,0,1] neg_hi:[0,0,1]
    v_cvt_pk_bf16_f32 v76, v184, v185
    v_cvt_pk_bf16_f32 v77, v186, v187
    v_cvt_pk_bf16_f32 v78, v188, v189
    v_cvt_pk_bf16_f32 v79, v190, v191
    ds_write_b128 v24, v[76:79] offset:46464
    v_pk_fma_f32 v[192:193], v[192:193], v[220:221], v[222:223] op_sel_hi:[1,0,0] neg_lo:[0,0,1] neg_hi:[0,0,1]
    v_pk_fma_f32 v[194:195], v[194:195], v[220:221], v[222:223] op_sel_hi:[1,0,0] neg_lo:[0,0,1] neg_hi:[0,0,1]
    v_pk_fma_f32 v[196:197], v[196:197], v[220:221], v[222:223] op_sel_hi:[1,0,0] neg_lo:[0,0,1] neg_hi:[0,0,1]
    v_pk_fma_f32 v[198:199], v[198:199], v[220:221], v[222:223] op_sel_hi:[1,0,0] neg_lo:[0,0,1] neg_hi:[0,0,1]
    v_cvt_pk_bf16_f32 v80, v192, v193
    v_cvt_pk_bf16_f32 v81, v194, v195
    v_cvt_pk_bf16_f32 v82, v196, v197
    v_cvt_pk_bf16_f32 v83, v198, v199
    ds_write_b128 v24, v[80:83] offset:50688
    v_pk_fma_f32 v[200:201], v[200:201], v[220:221], v[222:223] op_sel_hi:[1,0,0] neg_lo:[0,0,1] neg_hi:[0,0,1]
    v_pk_fma_f32 v[202:203], v[202:203], v[220:221], v[222:223] op_sel_hi:[1,0,0] neg_lo:[0,0,1] neg_hi:[0,0,1]
    v_pk_fma_f32 v[204:205], v[204:205], v[220:221], v[222:223] op_sel_hi:[1,0,0] neg_lo:[0,0,1] neg_hi:[0,0,1]
    v_pk_fma_f32 v[206:207], v[206:207], v[220:221], v[222:223] op_sel_hi:[1,0,0] neg_lo:[0,0,1] neg_hi:[0,0,1]
    v_cvt_pk_bf16_f32 v84, v200, v201
    v_cvt_pk_bf16_f32 v85, v202, v203
    v_cvt_pk_bf16_f32 v86, v204, v205
    v_cvt_pk_bf16_f32 v87, v206, v207
    ds_write_b128 v24, v[84:87] offset:54912
    s_add_u32 m0, s55, 114688
    s_nop 0
    buffer_load_dwordx4 v18, s[8:11], s69 offen lds
    s_waitcnt vmcnt(9)
    s_waitcnt lgkmcnt(0)
    s_barrier
    ds_read_b128 v[96:99], v25 offset:0
    ds_read_b64_tr_b16 v[104:105], v26 offset:0
    ds_read_b64_tr_b16 v[106:107], v26 offset:512
    ds_read_b64_tr_b16 v[108:109], v26 offset:1024
    ds_read_b64_tr_b16 v[110:111], v26 offset:1536
    ds_read_b64_tr_b16 v[112:113], v26 offset:2048
    ds_read_b64_tr_b16 v[114:115], v26 offset:2560
    ds_read_b128 v[100:103], v25 offset:2112
    ds_read_b64_tr_b16 v[116:117], v26 offset:6144
    ds_read_b64_tr_b16 v[118:119], v26 offset:6656
    s_waitcnt lgkmcnt(7)
    v_mfma_f32_32x32x16_bf16 v[32:47], v[104:107], v[96:99], 0
    s_add_u32 s53, s52, 65536
    v_lshl_add_u32 v2, v210, 10, v213
    s_add_u32 m0, s55, 115712
    s_nop 0
    buffer_load_dwordx4 v19, s[8:11], s69 offen lds
    ds_read_b64_tr_b16 v[120:121], v26 offset:7168
    ds_read_b64_tr_b16 v[122:123], v26 offset:7680
    s_waitcnt lgkmcnt(7)
    v_mfma_f32_32x32x16_bf16 v[48:63], v[108:111], v[96:99], 0
    v_add_u32 v2, s53, v2
    v_add_u32 v3, 65536, v2
    ds_read_b64_tr_b16 v[124:125], v26 offset:8192
    ds_read_b64_tr_b16 v[126:127], v26 offset:8704
    s_waitcnt lgkmcnt(7)
    v_mfma_f32_32x32x16_bf16 v[64:79], v[112:115], v[96:99], 0
    v_lshl_add_u32 v4, v210, 9, v213
    v_add_u32 v4, s53, v4
    s_add_u32 m0, s55, 116736
    s_nop 0
    buffer_load_dwordx4 v20, s[8:11], s69 offen lds
    ds_read_b128 v[96:99], v25 offset:4224
    ds_read_b64_tr_b16 v[104:105], v26 offset:12288
    ds_read_b64_tr_b16 v[106:107], v26 offset:12800
    s_waitcnt lgkmcnt(7)
    v_mfma_f32_32x32x16_bf16 v[32:47], v[116:119], v[100:103], v[32:47]
    v_add_u32 v5, 65536, v4
    s_lshr_b32 s53, s45, 1
    ds_read_b64_tr_b16 v[108:109], v26 offset:13312
    ds_read_b64_tr_b16 v[110:111], v26 offset:13824
    s_waitcnt lgkmcnt(7)
    v_mfma_f32_32x32x16_bf16 v[48:63], v[120:123], v[100:103], v[48:63]
    s_mul_i32 s53, s53, 49
    s_and_b32 s54, s45, 1
    s_add_u32 m0, s55, 117760
    s_nop 0
    buffer_load_dwordx4 v21, s[8:11], s69 offen lds
    ds_read_b64_tr_b16 v[112:113], v26 offset:14336
    ds_read_b64_tr_b16 v[114:115], v26 offset:14848
    s_waitcnt lgkmcnt(7)
    v_mfma_f32_32x32x16_bf16 v[64:79], v[124:127], v[100:103], v[64:79]
    s_mul_i32 s56, s54, 25
    s_add_u32 s53, s53, s56
    ds_read_b128 v[100:103], v25 offset:6336
    ds_read_b64_tr_b16 v[116:117], v26 offset:18432
    ds_read_b64_tr_b16 v[118:119], v26 offset:18944
    s_waitcnt lgkmcnt(7)
    v_mfma_f32_32x32x16_bf16 v[32:47], v[104:107], v[96:99], v[32:47]
    s_add_u32 s54, s54, s46
    s_cmp_eq_u32 s54, 6
    s_cselect_b32 s75, 1, 0
    s_cselect_b32 s56, 24, 0
    s_add_u32 m0, s55, 118784
    s_nop 0
    buffer_load_dwordx4 v22, s[8:11], s69 offen lds
    ds_read_b64_tr_b16 v[120:121], v26 offset:19456
    ds_read_b64_tr_b16 v[122:123], v26 offset:19968
    s_waitcnt lgkmcnt(7)
    v_mfma_f32_32x32x16_bf16 v[48:63], v[108:111], v[96:99], v[48:63]
    s_and_b32 s54, s48, 3
    s_sub_u32 s54, s46, s54
    ds_read_b64_tr_b16 v[124:125], v26 offset:20480
    ds_read_b64_tr_b16 v[126:127], v26 offset:20992
    s_waitcnt lgkmcnt(7)
    v_mfma_f32_32x32x16_bf16 v[64:79], v[112:115], v[96:99], v[64:79]
    s_cmp_lt_u32 s49, 6
    s_cselect_b32 s75, 1, s75
    s_cselect_b32 s54, s54, s56
    s_add_u32 s53, s53, s54
    s_add_u32 m0, s55, 119808
    s_nop 0
    buffer_load_dwordx4 v23, s[8:11], s69 offen lds
    s_waitcnt vmcnt(6)
    s_waitcnt lgkmcnt(0)
    s_barrier
    ds_read_b128 v[96:99], v25 offset:8448
    ds_read_b64_tr_b16 v[104:105], v26 offset:24576
    ds_read_b64_tr_b16 v[106:107], v26 offset:25088
    v_mfma_f32_32x32x16_bf16 v[32:47], v[116:119], v[100:103], v[32:47]
    s_mul_i32 s50, s53, 9363
    s_lshr_b32 s50, s50, 16
    ds_read_b64_tr_b16 v[108:109], v26 offset:25600
    ds_read_b64_tr_b16 v[110:111], v26 offset:26112
    v_mfma_f32_32x32x16_bf16 v[48:63], v[120:123], v[100:103], v[48:63]
    s_mul_i32 s54, s50, 7
    s_sub_u32 s51, s53, s54
    buffer_load_dword v29, off, s[40:43], 0 sc1
    ds_read_b64_tr_b16 v[112:113], v26 offset:26624
    ds_read_b64_tr_b16 v[114:115], v26 offset:27136
    v_mfma_f32_32x32x16_bf16 v[64:79], v[124:127], v[100:103], v[64:79]
    s_mul_i32 s53, s44, 1835008
    s_lshl_b32 s54, s50, 7
    s_add_u32 m0, s55, 139264
    s_nop 0
    buffer_load_dwordx4 v18, s[8:11], s70 offen lds
    ds_read_b128 v[100:103], v25 offset:10560
    ds_read_b64_tr_b16 v[116:117], v26 offset:30720
    ds_read_b64_tr_b16 v[118:119], v26 offset:31232
    s_waitcnt lgkmcnt(7)
    v_mfma_f32_32x32x16_bf16 v[32:47], v[104:107], v[96:99], v[32:47]
    s_add_u32 s53, s53, s54
    s_lshr_b32 s54, s44, 1
    ds_read_b64_tr_b16 v[120:121], v26 offset:31744
    ds_read_b64_tr_b16 v[122:123], v26 offset:32256
    s_waitcnt lgkmcnt(7)
    v_mfma_f32_32x32x16_bf16 v[48:63], v[108:111], v[96:99], v[48:63]
    s_lshl_b32 s54, s54, 6
    v_xor_b32 v215, s54, v209
    s_add_u32 m0, s55, 140288
    s_nop 0
    buffer_load_dwordx4 v19, s[8:11], s70 offen lds
    ds_read_b64_tr_b16 v[124:125], v26 offset:32768
    ds_read_b64_tr_b16 v[126:127], v26 offset:33280
    s_waitcnt lgkmcnt(7)
    v_mfma_f32_32x32x16_bf16 v[64:79], v[112:115], v[96:99], v[64:79]
    v_mul_u32_u24 v6, 3584, v208
    v_add3_u32 v6, v6, v215, s53
    ds_read_b128 v[96:99], v25 offset:12672
    ds_read_b64_tr_b16 v[104:105], v26 offset:36864
    ds_read_b64_tr_b16 v[106:107], v26 offset:37376
    s_waitcnt lgkmcnt(7)
    v_mfma_f32_32x32x16_bf16 v[32:47], v[116:119], v[100:103], v[32:47]
    v_add_u32 v7, 27648, v6
    v_lshrrev_b32 v250, 2, v1
    s_add_u32 m0, s55, 141312
    s_nop 0
    buffer_load_dwordx4 v20, s[8:11], s70 offen lds
    ds_read_b64_tr_b16 v[108:109], v26 offset:37888
    ds_read_b64_tr_b16 v[110:111], v26 offset:38400
    s_waitcnt lgkmcnt(7)
    v_mfma_f32_32x32x16_bf16 v[48:63], v[120:123], v[100:103], v[48:63]
    v_and_b32 v251, 3, v1
    v_lshlrev_b32 v251, 7, v251
    ds_read_b64_tr_b16 v[112:113], v26 offset:38912
    ds_read_b64_tr_b16 v[114:115], v26 offset:39424
    s_waitcnt lgkmcnt(7)
    v_mfma_f32_32x32x16_bf16 v[64:79], v[124:127], v[100:103], v[64:79]
    s_mul_i32 s66, s46, 10
    s_add_u32 s66, s66, 256
    s_add_u32 m0, s55, 142336
    s_nop 0
    buffer_load_dwordx4 v21, s[8:11], s70 offen lds
    ds_read_b128 v[100:103], v25 offset:14784
    ds_read_b64_tr_b16 v[116:117], v26 offset:43008
    ds_read_b64_tr_b16 v[118:119], v26 offset:43520
    s_waitcnt lgkmcnt(7)
    v_mfma_f32_32x32x16_bf16 v[32:47], v[104:107], v[96:99], v[32:47]
    s_add_u32 s54, s66, 10
    s_min_u32 s54, s54, 512
    ds_read_b64_tr_b16 v[120:121], v26 offset:44032
    ds_read_b64_tr_b16 v[122:123], v26 offset:44544
    s_waitcnt lgkmcnt(7)
    v_mfma_f32_32x32x16_bf16 v[48:63], v[108:111], v[96:99], v[48:63]
    v_add_u32 v250, s66, v250
    v_mov_b32 v249, 0x7fffffff
    s_add_u32 m0, s55, 143360
    s_nop 0
    buffer_load_dwordx4 v22, s[8:11], s70 offen lds
    ds_read_b64_tr_b16 v[124:125], v26 offset:45056
    ds_read_b64_tr_b16 v[126:127], v26 offset:45568
    s_waitcnt lgkmcnt(7)
    v_mfma_f32_32x32x16_bf16 v[64:79], v[112:115], v[96:99], v[64:79]
    v_mul_u32_u24 v252, 3584, v250
    v_add_u32 v252, v252, v251
    s_waitcnt vmcnt(6)
    s_waitcnt lgkmcnt(0)
    s_barrier
    ds_read_b128 v[96:99], v25 offset:16896
    ds_read_b64_tr_b16 v[104:105], v27 offset:0
    ds_read_b64_tr_b16 v[106:107], v27 offset:512
    v_mfma_f32_32x32x16_bf16 v[32:47], v[116:119], v[100:103], v[32:47]
    v_cmp_gt_u32 vcc, s54, v250
    v_add_u32 v250, 16, v250
    s_nop 0
    v_cndmask_b32 v252, v249, v252, vcc
    s_mul_i32 s66, s44, 1835008
    s_add_u32 m0, s55, 144384
    s_nop 0
    buffer_load_dwordx4 v23, s[8:11], s70 offen lds
    ds_read_b64_tr_b16 v[108:109], v27 offset:1024
    ds_read_b64_tr_b16 v[110:111], v27 offset:1536
    v_mfma_f32_32x32x16_bf16 v[48:63], v[120:123], v[100:103], v[48:63]
    s_mul_i32 s54, s45, 7
    s_lshr_b32 s54, s54, 1
    ds_read_b64_tr_b16 v[112:113], v27 offset:2048
    ds_read_b64_tr_b16 v[114:115], v27 offset:2560
    v_mfma_f32_32x32x16_bf16 v[64:79], v[124:127], v[100:103], v[64:79]
    s_lshl_b32 s54, s54, 7
    s_add_u32 s66, s66, s54
    s_add_u32 m0, s55, 65536
    s_nop 0
    buffer_load_dwordx4 v18, s[8:11], s71 offen lds
    ds_read_b128 v[100:103], v25 offset:19008
    ds_read_b64_tr_b16 v[116:117], v27 offset:6144
    ds_read_b64_tr_b16 v[118:119], v27 offset:6656
    s_waitcnt lgkmcnt(7)
    v_mfma_f32_32x32x16_bf16 v[32:47], v[104:107], v[96:99], v[32:47]
    s_mul_i32 s53, s44, 1835008
    s_lshl_b32 s54, s48, 7
    ds_read_b64_tr_b16 v[120:121], v27 offset:7168
    ds_read_b64_tr_b16 v[122:123], v27 offset:7680
    s_waitcnt lgkmcnt(7)
    v_mfma_f32_32x32x16_bf16 v[48:63], v[108:111], v[96:99], v[48:63]
    s_add_u32 s53, s53, s54
    v_lshlrev_b32 v8, 12, v208
    s_add_u32 m0, s55, 66560
    s_nop 0
    buffer_load_dwordx4 v19, s[8:11], s71 offen lds
    ds_read_b64_tr_b16 v[124:125], v27 offset:8192
    ds_read_b64_tr_b16 v[126:127], v27 offset:8704
    s_waitcnt lgkmcnt(7)
    v_mfma_f32_32x32x16_bf16 v[64:79], v[112:115], v[96:99], v[64:79]
    v_add3_u32 v8, v8, v209, s53
    v_add_u32 v9, 31744, v8
    ds_read_b128 v[96:99], v25 offset:21120
    ds_read_b64_tr_b16 v[104:105], v27 offset:12288
    ds_read_b64_tr_b16 v[106:107], v27 offset:12800
    s_waitcnt lgkmcnt(7)
    v_mfma_f32_32x32x16_bf16 v[32:47], v[116:119], v[100:103], v[32:47]
    s_mul_i32 s53, s44, 100352
    s_lshl_b32 s54, s49, 7
    s_add_u32 m0, s55, 67584
    s_nop 0
    buffer_load_dwordx4 v20, s[8:11], s71 offen lds
    ds_read_b64_tr_b16 v[108:109], v27 offset:13312
    ds_read_b64_tr_b16 v[110:111], v27 offset:13824
    s_waitcnt lgkmcnt(7)
    v_mfma_f32_32x32x16_bf16 v[48:63], v[120:123], v[100:103], v[48:63]
    s_add_u32 s53, s53, s54
    s_and_b32 s54, s48, 0
    ds_read_b64_tr_b16 v[112:113], v27 offset:14336
    ds_read_b64_tr_b16 v[114:115], v27 offset:14848
    s_waitcnt lgkmcnt(7)
    v_mfma_f32_32x32x16_bf16 v[64:79], v[124:127], v[100:103], v[64:79]
    s_lshl_b32 s54, s54, 6
    v_xor_b32 v215, s54, v209
    s_add_u32 m0, s55, 68608
    s_nop 0
    buffer_load_dwordx4 v21, s[8:11], s71 offen lds
    ds_read_b128 v[100:103], v25 offset:23232
    ds_read_b64_tr_b16 v[116:117], v27 offset:18432
    ds_read_b64_tr_b16 v[118:119], v27 offset:18944
    s_waitcnt lgkmcnt(7)
    v_mfma_f32_32x32x16_bf16 v[32:47], v[104:107], v[96:99], v[32:47]
    v_mul_u32_u24 v10, 896, v208
    v_add3_u32 v10, v10, v215, s53
    ds_read_b64_tr_b16 v[120:121], v27 offset:19456
    ds_read_b64_tr_b16 v[122:123], v27 offset:19968
    s_waitcnt lgkmcnt(7)
    v_mfma_f32_32x32x16_bf16 v[48:63], v[108:111], v[96:99], v[48:63]
    v_add_u32 v11, 6144, v10
    s_lshl_b32 s54, s54, 4
    s_add_u32 m0, s55, 69632
    s_nop 0
    buffer_load_dwordx4 v22, s[8:11], s71 offen lds
    ds_read_b64_tr_b16 v[124:125], v27 offset:20480
    ds_read_b64_tr_b16 v[126:127], v27 offset:20992
    s_waitcnt lgkmcnt(7)
    v_mfma_f32_32x32x16_bf16 v[64:79], v[112:115], v[96:99], v[64:79]
    v_add_u32 v15, s54, v12
    v_xor_b32 v16, 1024, v15
    s_add_u32 m0, s55, 70656
    s_nop 0
    buffer_load_dwordx4 v23, s[8:11], s71 offen lds
    s_waitcnt vmcnt(6)
    v_cmp_eq_u32 vcc, 0, v29
    s_nop 0
    s_cbranch_vccz L_ok2
    s_mov_b32 s59, 20000
L_spin1:
    buffer_load_dword v29, off, s[40:43], 0 sc1
    s_waitcnt vmcnt(0)
    v_cmp_eq_u32 vcc, 0, v29
    s_nop 0
    s_cbranch_vccz L_ok2
    s_sub_u32 s59, s59, 1
    s_cbranch_scc0 L_spin1
L_ok2:
    v_readfirstlane_b32 s47, v29
    s_waitcnt lgkmcnt(0)
    s_barrier
    s_cmp_lg_u32 s44, 0
    s_cbranch_scc1 L_nopub3
    s_lshl_b32 s62, s3, 5
    s_add_u32 s62, s62, s48
    s_lshl_b32 s62, s62, 7
    s_add_u32 s62, s62, 12582912
    v_mov_b32 v30, s47
    s_mov_b64 exec, 1
    buffer_store_dword v30, off, s[24:27], s62 sc1
    s_mov_b64 exec, -1
L_nopub3:
    ds_read_b128 v[96:99], v25 offset:25344
    ds_read_b64_tr_b16 v[104:105], v27 offset:24576
    ds_read_b64_tr_b16 v[106:107], v27 offset:25088
    v_mfma_f32_32x32x16_bf16 v[32:47], v[116:119], v[100:103], v[32:47]
    s_xor_b32 s53, s44, 0
    s_and_b32 s53, s53, 1
    ds_read_b64_tr_b16 v[108:109], v27 offset:25600
    ds_read_b64_tr_b16 v[110:111], v27 offset:26112
    v_mfma_f32_32x32x16_bf16 v[48:63], v[120:123], v[100:103], v[48:63]
    s_lshl_b32 s53, s53, 10
    v_add_u32 v13, s53, v12
    s_add_u32 m0, s55, 90112
    s_nop 0
    buffer_load_dwordx4 v18, s[8:11], s72 offen lds
    ds_read_b64_tr_b16 v[112:113], v27 offset:26624
    ds_read_b64_tr_b16 v[114:115], v27 offset:27136
    v_mfma_f32_32x32x16_bf16 v[64:79], v[124:127], v[100:103], v[64:79]
    v_xor_b32 v14, 1024, v13
    s_lshl_b32 s53, s51, 5
    ds_read_b128 v[100:103], v25 offset:27456
    ds_read_b64_tr_b16 v[116:117], v27 offset:30720
    ds_read_b64_tr_b16 v[118:119], v27 offset:31232
    s_waitcnt lgkmcnt(7)
    v_mfma_f32_32x32x16_bf16 v[32:47], v[104:107], v[96:99], v[32:47]
    s_lshl_b32 s54, s44, 3
    s_add_u32 s53, s53, s54
    s_add_u32 m0, s55, 91136
    s_nop 0
    buffer_load_dwordx4 v19, s[8:11], s72 offen lds
    ds_read_b64_tr_b16 v[120:121], v27 offset:31744
    ds_read_b64_tr_b16 v[122:123], v27 offset:32256
    s_waitcnt lgkmcnt(7)
    v_mfma_f32_32x32x16_bf16 v[48:63], v[108:111], v[96:99], v[48:63]
    s_lshl_b32 s53, s53, 7
    s_add_u32 s53, s53, 12582912
    ds_read_b64_tr_b16 v[124:125], v27 offset:32768
    ds_read_b64_tr_b16 v[126:127], v27 offset:33280
    s_waitcnt lgkmcnt(7)
    v_mfma_f32_32x32x16_bf16 v[64:79], v[112:115], v[96:99], v[64:79]
    v_and_b32 v185, 7, v1
    v_lshlrev_b32 v185, 7, v185
    s_add_u32 m0, s55, 92160
    s_nop 0
    buffer_load_dwordx4 v20, s[8:11], s72 offen lds
    ds_read_b128 v[96:99], v25 offset:29568
    ds_read_b64_tr_b16 v[104:105], v27 offset:36864
    ds_read_b64_tr_b16 v[106:107], v27 offset:37376
    s_waitcnt lgkmcnt(7)
    v_mfma_f32_32x32x16_bf16 v[32:47], v[116:119], v[100:103], v[32:47]
    v_add_u32 v185, s53, v185
    s_lshl_b32 s53, s50, 7
    ds_read_b64_tr_b16 v[108:109], v27 offset:37888
    ds_read_b64_tr_b16 v[110:111], v27 offset:38400
    s_waitcnt lgkmcnt(7)
    v_mfma_f32_32x32x16_bf16 v[48:63], v[120:123], v[100:103], v[48:63]
    s_lshr_b32 s54, s44, 1
    s_lshl_b32 s54, s54, 6
    s_add_u32 m0, s55, 93184
    s_nop 0
    buffer_load_dwordx4 v21, s[8:11], s72 offen lds
    ds_read_b64_tr_b16 v[112:113], v27 offset:38912
    ds_read_b64_tr_b16 v[114:115], v27 offset:39424
    s_waitcnt lgkmcnt(7)
    v_mfma_f32_32x32x16_bf16 v[64:79], v[124:127], v[100:103], v[64:79]
    s_add_u32 s53, s53, s54
    v_lshrrev_b32 v186, 5, v1
    ds_read_b128 v[100:103], v25 offset:31680
    ds_read_b64_tr_b16 v[116:117], v27 offset:43008
    ds_read_b64_tr_b16 v[118:119], v27 offset:43520
    s_waitcnt lgkmcnt(7)
    v_mfma_f32_32x32x16_bf16 v[32:47], v[104:107], v[96:99], v[32:47]
    v_lshl_add_u32 v186, v186, 3, s53
    s_mul_i32 s60, s51, 268032
    s_add_u32 m0, s55, 94208
    s_nop 0
    buffer_load_dwordx4 v22, s[8:11], s72 offen lds
    ds_read_b64_tr_b16 v[120:121], v27 offset:44032
    ds_read_b64_tr_b16 v[122:123], v27 offset:44544
    s_waitcnt lgkmcnt(7)
    v_mfma_f32_32x32x16_bf16 v[48:63], v[108:111], v[96:99], v[48:63]
    s_mul_i32 s54, s44, 66816
    s_add_u32 s60, s60, s54
    ds_read_b64_tr_b16 v[124:125], v27 offset:45056
    ds_read_b64_tr_b16 v[126:127], v27 offset:45568
    s_waitcnt lgkmcnt(7)
    v_mfma_f32_32x32x16_bf16 v[64:79], v[112:115], v[96:99], v[64:79]
    s_add_u32 m0, s55, 95232
    s_nop 0
    buffer_load_dwordx4 v23, s[8:11], s72 offen lds
    s_waitcnt vmcnt(6)
    s_waitcnt lgkmcnt(0)
    s_barrier
    ds_read_b128 v[96:99], v25 offset:33792
    ds_read_b64_tr_b16 v[104:105], v26 offset:0
    ds_read_b64_tr_b16 v[106:107], v26 offset:512
    v_mfma_f32_32x32x16_bf16 v[32:47], v[116:119], v[100:103], v[32:47]
    ds_read_b64_tr_b16 v[108:109], v26 offset:1024
    ds_read_b64_tr_b16 v[110:111], v26 offset:1536
    v_mfma_f32_32x32x16_bf16 v[48:63], v[120:123], v[100:103], v[48:63]
    s_add_u32 m0, s55, 114688
    s_nop 0
    buffer_load_dwordx4 v18, s[8:11], s73 offen lds
    ds_read_b64_tr_b16 v[112:113], v26 offset:2048
    ds_read_b64_tr_b16 v[114:115], v26 offset:2560
    v_mfma_f32_32x32x16_bf16 v[64:79], v[124:127], v[100:103], v[64:79]
    ds_read_b128 v[100:103], v25 offset:35904
    ds_read_b64_tr_b16 v[116:117], v26 offset:6144
    ds_read_b64_tr_b16 v[118:119], v26 offset:6656
    s_waitcnt lgkmcnt(7)
    v_mfma_f32_32x32x16_bf16 v[32:47], v[104:107], v[96:99], v[32:47]
    s_add_u32 m0, s55, 115712
    s_nop 0
    buffer_load_dwordx4 v19, s[8:11], s73 offen lds
    ds_read_b64_tr_b16 v[120:121], v26 offset:7168
    ds_read_b64_tr_b16 v[122:123], v26 offset:7680
    s_waitcnt lgkmcnt(7)
    v_mfma_f32_32x32x16_bf16 v[48:63], v[108:111], v[96:99], v[48:63]
    ds_read_b64_tr_b16 v[124:125], v26 offset:8192
    ds_read_b64_tr_b16 v[126:127], v26 offset:8704
    s_waitcnt lgkmcnt(7)
    v_mfma_f32_32x32x16_bf16 v[64:79], v[112:115], v[96:99], v[64:79]
    s_add_u32 m0, s55, 116736
    s_nop 0
    buffer_load_dwordx4 v20, s[8:11], s73 offen lds
    ds_read_b128 v[96:99], v25 offset:38016
    ds_read_b64_tr_b16 v[104:105], v26 offset:12288
    ds_read_b64_tr_b16 v[106:107], v26 offset:12800
    s_waitcnt lgkmcnt(7)
    v_mfma_f32_32x32x16_bf16 v[32:47], v[116:119], v[100:103], v[32:47]
    ds_read_b64_tr_b16 v[108:109], v26 offset:13312
    ds_read_b64_tr_b16 v[110:111], v26 offset:13824
    s_waitcnt lgkmcnt(7)
    v_mfma_f32_32x32x16_bf16 v[48:63], v[120:123], v[100:103], v[48:63]
    s_add_u32 m0, s55, 117760
    s_nop 0
    buffer_load_dwordx4 v21, s[8:11], s73 offen lds
    ds_read_b64_tr_b16 v[112:113], v26 offset:14336
    ds_read_b64_tr_b16 v[114:115], v26 offset:14848
    s_waitcnt lgkmcnt(7)
    v_mfma_f32_32x32x16_bf16 v[64:79], v[124:127], v[100:103], v[64:79]
    ds_read_b128 v[100:103], v25 offset:40128
    ds_read_b64_tr_b16 v[116:117], v26 offset:18432
    ds_read_b64_tr_b16 v[118:119], v26 offset:18944
    s_waitcnt lgkmcnt(7)
    v_mfma_f32_32x32x16_bf16 v[32:47], v[104:107], v[96:99], v[32:47]
    s_add_u32 m0, s55, 118784
    s_nop 0
    buffer_load_dwordx4 v22, s[8:11], s73 offen lds
    ds_read_b64_tr_b16 v[120:121], v26 offset:19456
    ds_read_b64_tr_b16 v[122:123], v26 offset:19968
    s_waitcnt lgkmcnt(7)
    v_mfma_f32_32x32x16_bf16 v[48:63], v[108:111], v[96:99], v[48:63]
    ds_read_b64_tr_b16 v[124:125], v26 offset:20480
    ds_read_b64_tr_b16 v[126:127], v26 offset:20992
    s_waitcnt lgkmcnt(7)
    v_mfma_f32_32x32x16_bf16 v[64:79], v[112:115], v[96:99], v[64:79]
    s_add_u32 m0, s55, 119808
    s_nop 0
    buffer_load_dwordx4 v23, s[8:11], s73 offen lds
    s_waitcnt vmcnt(6)
    s_waitcnt lgkmcnt(0)
    s_barrier
    ds_read_b128 v[96:99], v25 offset:42240
    ds_read_b64_tr_b16 v[104:105], v26 offset:24576
    ds_read_b64_tr_b16 v[106:107], v26 offset:25088
    v_mfma_f32_32x32x16_bf16 v[32:47], v[116:119], v[100:103], v[32:47]
    ds_read_b64_tr_b16 v[108:109], v26 offset:25600
    ds_read_b64_tr_b16 v[110:111], v26 offset:26112
    v_mfma_f32_32x32x16_bf16 v[48:63], v[120:123], v[100:103], v[48:63]
    buffer_load_dword v254, v252, s[16:19], s66 offen
    ds_read_b64_tr_b16 v[112:113], v26 offset:26624
    ds_read_b64_tr_b16 v[114:115], v26 offset:27136
    v_mfma_f32_32x32x16_bf16 v[64:79], v[124:127], v[100:103], v[64:79]
    ds_read_b128 v[100:103], v25 offset:44352
    ds_read_b64_tr_b16 v[116:117], v26 offset:30720
    ds_read_b64_tr_b16 v[118:119], v26 offset:31232
    s_waitcnt lgkmcnt(7)
    v_mfma_f32_32x32x16_bf16 v[32:47], v[104:107], v[96:99], v[32:47]
    ds_read_b64_tr_b16 v[120:121], v26 offset:31744
    ds_read_b64_tr_b16 v[122:123], v26 offset:32256
    s_waitcnt lgkmcnt(7)
    v_mfma_f32_32x32x16_bf16 v[48:63], v[108:111], v[96:99], v[48:63]
    ds_read_b64_tr_b16 v[124:125], v26 offset:32768
    ds_read_b64_tr_b16 v[126:127], v26 offset:33280
    s_waitcnt lgkmcnt(7)
    v_mfma_f32_32x32x16_bf16 v[64:79], v[112:115], v[96:99], v[64:79]
    ds_read_b128 v[96:99], v25 offset:46464
    ds_read_b64_tr_b16 v[104:105], v26 offset:36864
    ds_read_b64_tr_b16 v[106:107], v26 offset:37376
    s_waitcnt lgkmcnt(7)
    v_mfma_f32_32x32x16_bf16 v[32:47], v[116:119], v[100:103], v[32:47]
    ds_read_b64_tr_b16 v[108:109], v26 offset:37888
    ds_read_b64_tr_b16 v[110:111], v26 offset:38400
    s_waitcnt lgkmcnt(7)
    v_mfma_f32_32x32x16_bf16 v[48:63], v[120:123], v[100:103], v[48:63]
    ds_read_b64_tr_b16 v[112:113], v26 offset:38912
    ds_read_b64_tr_b16 v[114:115], v26 offset:39424
    s_waitcnt lgkmcnt(7)
    v_mfma_f32_32x32x16_bf16 v[64:79], v[124:127], v[100:103], v[64:79]
    ds_read_b128 v[100:103], v25 offset:48576
    ds_read_b64_tr_b16 v[116:117], v26 offset:43008
    ds_read_b64_tr_b16 v[118:119], v26 offset:43520
    s_waitcnt lgkmcnt(7)
    v_mfma_f32_32x32x16_bf16 v[32:47], v[104:107], v[96:99], v[32:47]
    ds_read_b64_tr_b16 v[120:121], v26 offset:44032
    ds_read_b64_tr_b16 v[122:123], v26 offset:44544
    s_waitcnt lgkmcnt(7)
    v_mfma_f32_32x32x16_bf16 v[48:63], v[108:111], v[96:99], v[48:63]
    ds_read_b64_tr_b16 v[124:125], v26 offset:45056
    ds_read_b64_tr_b16 v[126:127], v26 offset:45568
    s_waitcnt lgkmcnt(7)
    v_mfma_f32_32x32x16_bf16 v[64:79], v[112:115], v[96:99], v[64:79]
    s_waitcnt vmcnt(1)
    s_waitcnt lgkmcnt(0)
    s_barrier
    s_add_u32 m0, s52, 139264
    s_mov_b32 s57, 0
    buffer_load_dwordx4 v6, s[16:19], s57 offen lds
    ds_read_b128 v[96:99], v25 offset:50688
    ds_read_b64_tr_b16 v[104:105], v27 offset:0
    ds_read_b64_tr_b16 v[106:107], v27 offset:512
    v_mfma_f32_32x32x16_bf16 v[32:47], v[116:119], v[100:103], v[32:47]
    ds_read_b64_tr_b16 v[108:109], v27 offset:1024
    ds_read_b64_tr_b16 v[110:111], v27 offset:1536
    v_mfma_f32_32x32x16_bf16 v[48:63], v[120:123], v[100:103], v[48:63]
    buffer_load_dwordx4 v7, s[16:19], s57 offen offset:1024 lds
    ds_read_b64_tr_b16 v[112:113], v27 offset:2048
    ds_read_b64_tr_b16 v[114:115], v27 offset:2560
    v_mfma_f32_32x32x16_bf16 v[64:79], v[124:127], v[100:103], v[64:79]
    ds_read_b128 v[100:103], v25 offset:52800
    ds_read_b64_tr_b16 v[116:117], v27 offset:6144
    ds_read_b64_tr_b16 v[118:119], v27 offset:6656
    s_waitcnt lgkmcnt(7)
    v_mfma_f32_32x32x16_bf16 v[32:47], v[104:107], v[96:99], v[32:47]
    s_add_u32 m0, s52, 147456
    s_mov_b32 s57, 57344
    buffer_load_dwordx4 v6, s[16:19], s57 offen lds
    ds_read_b64_tr_b16 v[120:121], v27 offset:7168
    ds_read_b64_tr_b16 v[122:123], v27 offset:7680
    s_waitcnt lgkmcnt(7)
    v_mfma_f32_32x32x16_bf16 v[48:63], v[108:111], v[96:99], v[48:63]
    ds_read_b64_tr_b16 v[124:125], v27 offset:8192
    ds_read_b64_tr_b16 v[126:127], v27 offset:8704
    s_waitcnt lgkmcnt(7)
    v_mfma_f32_32x32x16_bf16 v[64:79], v[112:115], v[96:99], v[64:79]
    buffer_load_dwordx4 v7, s[16:19], s57 offen offset:1024 lds
    ds_read_b128 v[96:99], v25 offset:54912
    ds_read_b64_tr_b16 v[104:105], v27 offset:12288
    ds_read_b64_tr_b16 v[106:107], v27 offset:12800
    s_waitcnt lgkmcnt(7)
    v_mfma_f32_32x32x16_bf16 v[32:47], v[116:119], v[100:103], v[32:47]
    ds_read_b64_tr_b16 v[108:109], v27 offset:13312
    ds_read_b64_tr_b16 v[110:111], v27 offset:13824
    s_waitcnt lgkmcnt(7)
    v_mfma_f32_32x32x16_bf16 v[48:63], v[120:123], v[100:103], v[48:63]
    s_add_u32 m0, s52, 155648
    s_mov_b32 s57, 114688
    buffer_load_dwordx4 v6, s[16:19], s57 offen lds
    ds_read_b64_tr_b16 v[112:113], v27 offset:14336
    ds_read_b64_tr_b16 v[114:115], v27 offset:14848
    s_waitcnt lgkmcnt(7)
    v_mfma_f32_32x32x16_bf16 v[64:79], v[124:127], v[100:103], v[64:79]
    ds_read_b128 v[100:103], v25 offset:57024
    ds_read_b64_tr_b16 v[116:117], v27 offset:18432
    ds_read_b64_tr_b16 v[118:119], v27 offset:18944
    s_waitcnt lgkmcnt(7)
    v_mfma_f32_32x32x16_bf16 v[32:47], v[104:107], v[96:99], v[32:47]
    buffer_load_dwordx4 v7, s[16:19], s57 offen offset:1024 lds
    ds_read_b64_tr_b16 v[120:121], v27 offset:19456
    ds_read_b64_tr_b16 v[122:123], v27 offset:19968
    s_waitcnt lgkmcnt(7)
    v_mfma_f32_32x32x16_bf16 v[48:63], v[108:111], v[96:99], v[48:63]
    ds_read_b64_tr_b16 v[124:125], v27 offset:20480
    ds_read_b64_tr_b16 v[126:127], v27 offset:20992
    s_waitcnt lgkmcnt(7)
    v_mfma_f32_32x32x16_bf16 v[64:79], v[112:115], v[96:99], v[64:79]
    s_add_u32 m0, s52, 65536
    s_mov_b32 s57, 172032
    buffer_load_dwordx4 v6, s[16:19], s57 offen lds
    s_waitcnt lgkmcnt(0)
    s_barrier
    v_mfma_f32_32x32x16_bf16 v[32:47], v[116:119], v[100:103], v[32:47]
    v_mfma_f32_32x32x16_bf16 v[48:63], v[120:123], v[100:103], v[48:63]
    buffer_load_dwordx4 v7, s[16:19], s57 offen offset:1024 lds
    v_mfma_f32_32x32x16_bf16 v[64:79], v[124:127], v[100:103], v[64:79]
    v_lshrrev_b32 v29, 5, v1
    v_and_b32 v30, 31, v1
    v_lshlrev_b32 v29, 15, v29
    v_lshl_add_u32 v29, v30, 4, v29
    s_mul_i32 s64, s49, 24
    s_lshr_b32 s54, s44, 1
    s_lshl_b32 s54, s54, 2
    s_add_u32 s64, s64, s54
    s_lshl_b32 s64, s64, 15
    s_lshl_b32 s54, s48, 10
    s_add_u32 s64, s64, s54
    s_and_b32 s54, s44, 1
    s_lshl_b32 s54, s54, 9
    s_add_u32 s64, s64, s54
    s_add_u32 m0, s52, 73728
    s_mov_b32 s57, 229376
    buffer_load_dwordx4 v6, s[16:19], s57 offen lds
    v_cvt_pk_bf16_f32 v160, v32, v33
    v_cvt_pk_bf16_f32 v161, v34, v35
    v_cvt_pk_bf16_f32 v162, v36, v37
    v_cvt_pk_bf16_f32 v163, v38, v39
    v_cvt_pk_bf16_f32 v164, v40, v41
    v_cvt_pk_bf16_f32 v165, v42, v43
    v_cvt_pk_bf16_f32 v166, v44, v45
    v_cvt_pk_bf16_f32 v167, v46, v47
    s_add_u32 s54, s64, 6291456
    v_permlane32_swap_b32 v160, v162
    v_permlane32_swap_b32 v161, v163
    buffer_store_dwordx4 v[160:163], v29, s[24:27], s54 offen sc1
    s_add_u32 s54, s64, 6356992
    v_permlane32_swap_b32 v164, v166
    v_permlane32_swap_b32 v165, v167
    buffer_store_dwordx4 v[164:167], v29, s[24:27], s54 offen sc1
    v_cvt_pk_bf16_f32 v168, v48, v49
    v_cvt_pk_bf16_f32 v169, v50, v51
    v_cvt_pk_bf16_f32 v170, v52, v53
    v_cvt_pk_bf16_f32 v171, v54, v55
    v_cvt_pk_bf16_f32 v172, v56, v57
    v_cvt_pk_bf16_f32 v173, v58, v59
    v_cvt_pk_bf16_f32 v174, v60, v61
    v_cvt_pk_bf16_f32 v175, v62, v63
    s_add_u32 s54, s64, 6553600
    v_permlane32_swap_b32 v168, v170
    v_permlane32_swap_b32 v169, v171
    buffer_store_dwordx4 v[168:171], v29, s[24:27], s54 offen sc1
    s_add_u32 s54, s64, 6619136
    v_permlane32_swap_b32 v172, v174
    v_permlane32_swap_b32 v173, v175
    buffer_store_dwordx4 v[172:175], v29, s[24:27], s54 offen sc1
    v_cvt_pk_bf16_f32 v176, v64, v65
    v_cvt_pk_bf16_f32 v177, v66, v67
    v_cvt_pk_bf16_f32 v178, v68, v69
    v_cvt_pk_bf16_f32 v179, v70, v71
    v_cvt_pk_bf16_f32 v180, v72, v73
    v_cvt_pk_bf16_f32 v181, v74, v75
    v_cvt_pk_bf16_f32 v182, v76, v77
    v_cvt_pk_bf16_f32 v183, v78, v79
    s_add_u32 s54, s64, 6815744
    v_permlane32_swap_b32 v176, v178
    v_permlane32_swap_b32 v177, v179
    buffer_store_dwordx4 v[176:179], v29, s[24:27], s54 offen sc1
    s_add_u32 s54, s64, 6881280
    v_permlane32_swap_b32 v180, v182
    v_permlane32_swap_b32 v181, v183
    buffer_store_dwordx4 v[180:183], v29, s[24:27], s54 offen sc1
    s_cmp_eq_u32 s75, 0
    s_cbranch_scc1 L_nop2
    buffer_load_dwordx4 v7, s[16:19], s57 offen offset:1024 lds
    s_add_u32 m0, s52, 81920
    s_mov_b32 s57, 286720
    buffer_load_dwordx4 v6, s[16:19], s57 offen lds
    buffer_load_dwordx4 v7, s[16:19], s57 offen offset:1024 lds
    s_add_u32 m0, s52, 90112
    s_mov_b32 s57, 344064
    buffer_load_dwordx4 v6, s[16:19], s57 offen lds
    s_waitcnt vmcnt(17)
    ds_read_b64_tr_b16 a[0:1], v3 offset:8192
    ds_read_b64_tr_b16 a[2:3], v3 offset:8704
    ds_read_b64_tr_b16 a[4:5], v3 offset:8448
    ds_read_b64_tr_b16 a[6:7], v3 offset:8960
    buffer_load_dwordx4 v7, s[16:19], s57 offen offset:1024 lds
    s_add_u32 m0, s52, 98304
    s_mov_b32 s57, 401408
    buffer_load_dwordx4 v6, s[16:19], s57 offen lds
    s_waitcnt vmcnt(17)
    ds_read_b64_tr_b16 a[8:9], v3 offset:16384
    ds_read_b64_tr_b16 a[10:11], v3 offset:16896
    ds_read_b64_tr_b16 a[12:13], v3 offset:16640
    ds_read_b64_tr_b16 a[14:15], v3 offset:17152
    buffer_load_dwordx4 v7, s[16:19], s57 offen offset:1024 lds
    s_add_u32 m0, s52, 106496
    s_mov_b32 s57, 458752
    buffer_load_dwordx4 v6, s[16:19], s57 offen lds
    s_waitcnt vmcnt(17)
    ds_read_b64_tr_b16 a[16:17], v3 offset:24576
    ds_read_b64_tr_b16 a[18:19], v3 offset:25088
    ds_read_b64_tr_b16 a[20:21], v3 offset:24832
    ds_read_b64_tr_b16 a[22:23], v3 offset:25344
    buffer_load_dwordx4 v7, s[16:19], s57 offen offset:1024 lds
    s_add_u32 m0, s52, 114688
    s_mov_b32 s57, 516096
    buffer_load_dwordx4 v6, s[16:19], s57 offen lds
    s_waitcnt vmcnt(17)
    ds_read_b64_tr_b16 a[24:25], v2 offset:0
    ds_read_b64_tr_b16 a[26:27], v2 offset:512
    ds_read_b64_tr_b16 a[28:29], v2 offset:256
    ds_read_b64_tr_b16 a[30:31], v2 offset:768
    buffer_load_dwordx4 v7, s[16:19], s57 offen offset:1024 lds
    s_add_u32 m0, s52, 122880
    s_mov_b32 s57, 573440
    buffer_load_dwordx4 v6, s[16:19], s57 offen lds
    s_waitcnt vmcnt(11)
    ds_read_b64_tr_b16 a[32:33], v2 offset:8192
    ds_read_b64_tr_b16 a[34:35], v2 offset:8704
    ds_read_b64_tr_b16 a[36:37], v2 offset:8448
    ds_read_b64_tr_b16 a[38:39], v2 offset:8960
    buffer_load_dwordx4 v7, s[16:19], s57 offen offset:1024 lds
    s_add_u32 m0, s52, 131072
    s_mov_b32 s57, 630784
    buffer_load_dwordx4 v6, s[16:19], s57 offen lds
    s_waitcnt vmcnt(11)
    ds_read_b64_tr_b16 a[40:41], v2 offset:16384
    ds_read_b64_tr_b16 a[42:43], v2 offset:16896
    ds_read_b64_tr_b16 a[44:45], v2 offset:16640
    ds_read_b64_tr_b16 a[46:47], v2 offset:17152
    buffer_load_dwordx4 v7, s[16:19], s57 offen offset:1024 lds
    s_waitcnt lgkmcnt(15)
    s_add_u32 m0, s52, 139264
    s_mov_b32 s57, 688128
    buffer_load_dwordx4 v6, s[16:19], s57 offen lds
    s_waitcnt vmcnt(11)
    ds_read_b64_tr_b16 a[48:49], v2 offset:24576
    ds_read_b64_tr_b16 a[50:51], v2 offset:25088
    ds_read_b64_tr_b16 a[52:53], v2 offset:24832
    ds_read_b64_tr_b16 a[54:55], v2 offset:25344
    buffer_load_dwordx4 v7, s[16:19], s57 offen offset:1024 lds
    s_add_u32 m0, s52, 147456
    s_mov_b32 s57, 745472
    buffer_load_dwordx4 v6, s[16:19], s57 offen lds
    s_waitcnt vmcnt(11)
    ds_read_b64_tr_b16 a[56:57], v2 offset:32768
    ds_read_b64_tr_b16 a[58:59], v2 offset:33280
    ds_read_b64_tr_b16 a[60:61], v2 offset:33024
    ds_read_b64_tr_b16 a[62:63], v2 offset:33536
    buffer_load_dwordx4 v7, s[16:19], s57 offen offset:1024 lds
    s_waitcnt lgkmcnt(15)
    s_add_u32 m0, s52, 155648
    s_mov_b32 s57, 802816
    buffer_load_dwordx4 v6, s[16:19], s57 offen lds
    s_waitcnt vmcnt(11)
    ds_read_b64_tr_b16 a[64:65], v2 offset:40960
    ds_read_b64_tr_b16 a[66:67], v2 offset:41472
    ds_read_b64_tr_b16 a[68:69], v2 offset:41216
    ds_read_b64_tr_b16 a[70:71], v2 offset:41728
    buffer_load_dwordx4 v7, s[16:19], s57 offen offset:1024 lds
    s_add_u32 m0, s52, 65536
    s_mov_b32 s57, 860160
    buffer_load_dwordx4 v6, s[16:19], s57 offen lds
    s_waitcnt vmcnt(11)
    ds_read_b64_tr_b16 a[72:73], v2 offset:49152
    ds_read_b64_tr_b16 a[74:75], v2 offset:49664
    ds_read_b64_tr_b16 a[76:77], v2 offset:49408
    ds_read_b64_tr_b16 a[78:79], v2 offset:49920
    buffer_load_dwordx4 v7, s[16:19], s57 offen offset:1024 lds
    s_waitcnt lgkmcnt(15)
    s_add_u32 m0, s52, 73728
    s_mov_b32 s57, 917504
    buffer_load_dwordx4 v6, s[16:19], s57 offen lds
    s_waitcnt vmcnt(11)
    ds_read_b64_tr_b16 a[80:81], v2 offset:57344
    ds_read_b64_tr_b16 a[82:83], v2 offset:57856
    ds_read_b64_tr_b16 a[84:85], v2 offset:57600
    ds_read_b64_tr_b16 a[86:87], v2 offset:58112
    buffer_load_dwordx4 v7, s[16:19], s57 offen offset:1024 lds
    s_add_u32 m0, s52, 81920
    s_mov_b32 s57, 974848
    buffer_load_dwordx4 v6, s[16:19], s57 offen lds
    s_waitcnt vmcnt(11)
    ds_read_b64_tr_b16 a[88:89], v3 offset:0
    ds_read_b64_tr_b16 a[90:91], v3 offset:512
    ds_read_b64_tr_b16 a[92:93], v3 offset:256
    ds_read_b64_tr_b16 a[94:95], v3 offset:768
    s_barrier
    s_cmp_lg_u32 s44, 0
    s_cbranch_scc1 L_nopub4
    s_lshl_b32 s62, s48, 3
    s_add_u32 s62, s62, s49
    s_lshl_b32 s62, s62, 7
    s_add_u32 s62, s62, 12648448
    v_mov_b32 v30, s47
    s_mov_b64 exec, 1
    buffer_store_dword v30, off, s[24:27], s62 sc1
    s_mov_b64 exec, -1
L_nopub4:
    buffer_load_dwordx4 v7, s[16:19], s57 offen offset:1024 lds
    s_waitcnt lgkmcnt(15)
    s_add_u32 m0, s52, 90112
    s_mov_b32 s57, 1032192
    buffer_load_dwordx4 v6, s[16:19], s57 offen lds
    s_waitcnt vmcnt(11)
    ds_read_b64_tr_b16 a[96:97], v3 offset:8192
    ds_read_b64_tr_b16 a[98:99], v3 offset:8704
    ds_read_b64_tr_b16 a[100:101], v3 offset:8448
    ds_read_b64_tr_b16 a[102:103], v3 offset:8960
    buffer_load_dwordx4 v7, s[16:19], s57 offen offset:1024 lds
    s_add_u32 m0, s52, 98304
    s_mov_b32 s57, 1089536
    buffer_load_dwordx4 v6, s[16:19], s57 offen lds
    s_waitcnt vmcnt(11)
    ds_read_b64_tr_b16 a[104:105], v3 offset:16384
    ds_read_b64_tr_b16 a[106:107], v3 offset:16896
    ds_read_b64_tr_b16 a[108:109], v3 offset:16640
    ds_read_b64_tr_b16 a[110:111], v3 offset:17152
    buffer_load_dwordx4 v7, s[16:19], s57 offen offset:1024 lds
    s_waitcnt lgkmcnt(15)
    s_add_u32 m0, s52, 106496
    s_mov_b32 s57, 1146880
    buffer_load_dwordx4 v6, s[16:19], s57 offen lds
    s_waitcnt vmcnt(11)
    ds_read_b64_tr_b16 a[112:113], v3 offset:24576
    ds_read_b64_tr_b16 a[114:115], v3 offset:25088
    ds_read_b64_tr_b16 a[116:117], v3 offset:24832
    ds_read_b64_tr_b16 a[118:119], v3 offset:25344
    buffer_load_dwordx4 v7, s[16:19], s57 offen offset:1024 lds
    s_add_u32 m0, s52, 114688
    s_mov_b32 s57, 1204224
    buffer_load_dwordx4 v6, s[16:19], s57 offen lds
    s_waitcnt vmcnt(11)
    ds_read_b64_tr_b16 a[120:121], v2 offset:0
    ds_read_b64_tr_b16 a[122:123], v2 offset:512
    ds_read_b64_tr_b16 a[124:125], v2 offset:256
    ds_read_b64_tr_b16 a[126:127], v2 offset:768
    buffer_load_dwordx4 v7, s[16:19], s57 offen offset:1024 lds
    s_waitcnt lgkmcnt(15)
    s_add_u32 m0, s52, 122880
    s_mov_b32 s57, 1261568
    buffer_load_dwordx4 v6, s[16:19], s57 offen lds
    s_waitcnt vmcnt(11)
    ds_read_b64_tr_b16 a[128:129], v2 offset:8192
    ds_read_b64_tr_b16 a[130:131], v2 offset:8704
    ds_read_b64_tr_b16 a[132:133], v2 offset:8448
    ds_read_b64_tr_b16 a[134:135], v2 offset:8960
    buffer_load_dwordx4 v7, s[16:19], s57 offen offset:1024 lds
    s_add_u32 m0, s52, 131072
    s_mov_b32 s57, 1318912
    buffer_load_dwordx4 v6, s[16:19], s57 offen lds
    s_waitcnt vmcnt(11)
    ds_read_b64_tr_b16 a[136:137], v2 offset:16384
    ds_read_b64_tr_b16 a[138:139], v2 offset:16896
    ds_read_b64_tr_b16 a[140:141], v2 offset:16640
    ds_read_b64_tr_b16 a[142:143], v2 offset:17152
    buffer_load_dwordx4 v7, s[16:19], s57 offen offset:1024 lds
    s_waitcnt lgkmcnt(15)
    s_add_u32 m0, s52, 139264
    s_mov_b32 s57, 1376256
    buffer_load_dwordx4 v6, s[16:19], s57 offen lds
    s_waitcnt vmcnt(11)
    ds_read_b64_tr_b16 a[144:145], v2 offset:24576
    ds_read_b64_tr_b16 a[146:147], v2 offset:25088
    ds_read_b64_tr_b16 a[148:149], v2 offset:24832
    ds_read_b64_tr_b16 a[150:151], v2 offset:25344
    buffer_load_dwordx4 v7, s[16:19], s57 offen offset:1024 lds
    s_add_u32 m0, s52, 147456
    s_mov_b32 s57, 1433600
    buffer_load_dwordx4 v6, s[16:19], s57 offen lds
    s_waitcnt vmcnt(11)
    ds_read_b64_tr_b16 a[152:153], v2 offset:32768
    ds_read_b64_tr_b16 a[154:155], v2 offset:33280
    ds_read_b64_tr_b16 a[156:157], v2 offset:33024
    ds_read_b64_tr_b16 a[158:159], v2 offset:33536
    buffer_load_dwordx4 v7, s[16:19], s57 offen offset:1024 lds
    s_waitcnt lgkmcnt(15)
    s_add_u32 m0, s52, 155648
    s_mov_b32 s57, 1490944
    buffer_load_dwordx4 v6, s[16:19], s57 offen lds
    s_waitcnt vmcnt(11)
    ds_read_b64_tr_b16 a[160:161], v2 offset:40960
    ds_read_b64_tr_b16 a[162:163], v2 offset:41472
    ds_read_b64_tr_b16 a[164:165], v2 offset:41216
    ds_read_b64_tr_b16 a[166:167], v2 offset:41728
    buffer_load_dwordx4 v7, s[16:19], s57 offen offset:1024 lds
    s_add_u32 m0, s52, 65536
    s_mov_b32 s57, 1548288
    buffer_load_dwordx4 v6, s[16:19], s57 offen lds
    s_waitcnt vmcnt(11)
    ds_read_b64_tr_b16 a[168:169], v2 offset:49152
    ds_read_b64_tr_b16 a[170:171], v2 offset:49664
    ds_read_b64_tr_b16 a[172:173], v2 offset:49408
    ds_read_b64_tr_b16 a[174:175], v2 offset:49920
    buffer_load_dwordx4 v7, s[16:19], s57 offen offset:1024 lds
    s_waitcnt lgkmcnt(15)
    s_add_u32 m0, s52, 73728
    s_mov_b32 s57, 1605632
    buffer_load_dwordx4 v6, s[16:19], s57 offen lds
    s_waitcnt vmcnt(11)
    ds_read_b64_tr_b16 a[176:177], v2 offset:57344
    ds_read_b64_tr_b16 a[178:179], v2 offset:57856
    ds_read_b64_tr_b16 a[180:181], v2 offset:57600
    ds_read_b64_tr_b16 a[182:183], v2 offset:58112
    buffer_load_dwordx4 v7, s[16:19], s57 offen offset:1024 lds
    s_add_u32 m0, s52, 81920
    s_mov_b32 s57, 1662976
    buffer_load_dwordx4 v6, s[16:19], s57 offen lds
    s_waitcnt vmcnt(11)
    ds_read_b64_tr_b16 a[184:185], v3 offset:0
    ds_read_b64_tr_b16 a[186:187], v3 offset:512
    ds_read_b64_tr_b16 a[188:189], v3 offset:256
    ds_read_b64_tr_b16 a[190:191], v3 offset:768
    buffer_load_dwordx4 v7, s[16:19], s57 offen offset:1024 lds
    buffer_load_dword v184, v185, s[24:27], 0 offen sc1
    s_waitcnt vmcnt(11)
    ds_read_b64_tr_b16 a[192:193], v3 offset:8192
    ds_read_b64_tr_b16 a[194:195], v3 offset:8704
    ds_read_b64_tr_b16 a[196:197], v3 offset:8448
    ds_read_b64_tr_b16 a[198:199], v3 offset:8960
    buffer_load_dwordx2 v[188:189], v186, s[32:35], 0 offen offset:0
    buffer_load_dwordx2 v[190:191], v186, s[32:35], 0 offen offset:16
    s_waitcnt vmcnt(11)
    ds_read_b64_tr_b16 a[200:201], v3 offset:16384
    ds_read_b64_tr_b16 a[202:203], v3 offset:16896
    ds_read_b64_tr_b16 a[204:205], v3 offset:16640
    ds_read_b64_tr_b16 a[206:207], v3 offset:17152
    buffer_load_dwordx2 v[192:193], v186, s[32:35], 0 offen offset:32
    buffer_load_dwordx2 v[194:195], v186, s[32:35], 0 offen offset:48
    s_waitcnt vmcnt(11)
    ds_read_b64_tr_b16 a[208:209], v3 offset:24576
    ds_read_b64_tr_b16 a[210:211], v3 offset:25088
    ds_read_b64_tr_b16 a[212:213], v3 offset:24832
    ds_read_b64_tr_b16 a[214:215], v3 offset:25344
    s_waitcnt lgkmcnt(15)
    s_add_u32 m0, s52, 90112
    s_mov_b32 s57, 1720320
    buffer_load_dwordx4 v6, s[16:19], s57 offen lds
    buffer_load_dwordx4 v7, s[16:19], s57 offen offset:1024 lds
    s_waitcnt vmcnt(11)
    ds_read_b64_tr_b16 a[216:217], v2 offset:0
    ds_read_b64_tr_b16 a[218:219], v2 offset:512
    ds_read_b64_tr_b16 a[220:221], v2 offset:256
    ds_read_b64_tr_b16 a[222:223], v2 offset:768
    v_and_b32 v207, 7, v1
    v_min_u32 v207, 6, v207
    v_lshlrev_b32 v207, 7, v207
    s_lshl_b32 s53, s45, 3
    s_add_u32 s53, s53, s44
    s_lshl_b32 s53, s53, 7
    s_add_u32 s53, s53, 12779520
    v_mov_b32 v202, s53
    s_lshl_b32 s53, s49, 5
    s_mul_i32 s54, s44, 7
    s_add_u32 s53, s53, s54
    s_lshl_b32 s53, s53, 7
    s_add_u32 s53, s53, 12713984
    v_add_u32 v204, s53, v207
    s_lshl_b32 s88, s48, 16
    s_lshl_b32 s54, s44, 14
    s_add_u32 s88, s88, s54
    s_add_u32 s88, s88, 4194304
    v_lshrrev_b32 v207, 3, v0
    v_and_b32 v218, 7, v0
    v_mul_u32_u24 v205, 896, v207
    v_lshl_add_u32 v205, v218, 4, v205
    v_lshlrev_b32 v206, 1, v207
    s_mul_i32 s89, s48, 57344
    s_lshl_b32 s54, s49, 7
    s_add_u32 s89, s89, s54
    s_add_u32 s90, s89, 28672
    s_lshl_b32 s91, s48, 7
    s_mul_i32 s61, s49, 235264
    s_mul_i32 s54, s44, 58624
    s_add_u32 s61, s61, s54
    s_add_u32 s61, s61, 2097152
    s_add_u32 m0, s52, 98304
    s_mov_b32 s57, 1777664
    buffer_load_dwordx4 v6, s[16:19], s57 offen lds
    buffer_load_dwordx4 v7, s[16:19], s57 offen offset:1024 lds
    s_waitcnt vmcnt(8)
    v_cmp_ne_u32 vcc, s47, v184
    s_nop 0
    s_cbranch_vccz L_ok6
    s_mov_b32 s59, 20000
L_spin5:
    buffer_load_dword v184, v185, s[24:27], 0 offen sc1
    s_waitcnt vmcnt(0)
    v_cmp_ne_u32 vcc, s47, v184
    s_nop 0
    s_cbranch_vccz L_ok6
    s_sub_u32 s59, s59, 1
    s_cbranch_scc0 L_spin5
L_ok6:
    s_add_u32 s58, s60, 0
    buffer_load_dwordx4 v[96:99], v14, s[24:27], s58 offen offset:0 sc1
    buffer_load_dwordx4 v[100:103], v14, s[24:27], s58 offen offset:2048 sc1
    s_add_u32 s58, s60, 4096
    buffer_load_dwordx4 v[104:107], v14, s[24:27], s58 offen offset:0 sc1
    buffer_load_dwordx4 v[108:111], v14, s[24:27], s58 offen offset:2048 sc1
    s_add_u32 s58, s60, 8192
    buffer_load_dwordx4 v[112:115], v14, s[24:27], s58 offen offset:0 sc1
    buffer_load_dwordx4 v[116:119], v14, s[24:27], s58 offen offset:2048 sc1
    s_add_u32 s58, s60, 12288
    buffer_load_dwordx4 v[120:123], v14, s[24:27], s58 offen offset:0 sc1
    s_waitcnt vmcnt(11)
    v_lshlrev_b32 v32, 16, v188
    v_and_b32 v33, 0xffff0000, v188
    v_lshlrev_b32 v34, 16, v189
    v_and_b32 v35, 0xffff0000, v189
    v_lshlrev_b32 v36, 16, v190
    v_and_b32 v37, 0xffff0000, v190
    v_lshlrev_b32 v38, 16, v191
    v_and_b32 v39, 0xffff0000, v191
    v_lshlrev_b32 v40, 16, v192
    v_and_b32 v41, 0xffff0000, v192
    v_lshlrev_b32 v42, 16, v193
    v_and_b32 v43, 0xffff0000, v193
    v_lshlrev_b32 v44, 16, v194
    v_and_b32 v45, 0xffff0000, v194
    v_lshlrev_b32 v46, 16, v195
    v_and_b32 v47, 0xffff0000, v195
    buffer_load_dwordx4 v[124:127], v14, s[24:27], s58 offen offset:2048 sc1
    v_add_u32 v196, s52, v12
    v_xor_b32 v197, 2048, v196
    v_xor_b32 v198, 4096, v196
    v_xor_b32 v199, 6144, v196
    v_mov_b32 v186, 0xbdd2d3e8
    v_mov_b32 v187, 0xc0135761
    s_mul_i32 s64, s51, 235264
    s_lshl_b32 s54, s50, 13
    s_add_u32 s64, s64, s54
    s_mul_i32 s54, s50, 37
    s_lshr_b32 s54, s54, 8
    s_mul_i32 s54, s54, 1280
    s_add_u32 s64, s64, s54
    s_lshr_b32 s54, s44, 1
    s_lshl_b32 s54, s54, 12
    s_add_u32 s64, s64, s54
    s_add_u32 s64, s64, 2097152
    s_add_u32 s58, s60, 16384
    buffer_load_dwordx4 v[128:131], v14, s[24:27], s58 offen offset:0 sc1
    ds_read_b64_tr_b16 a[224:225], v2 offset:8192
    ds_read_b64_tr_b16 a[226:227], v2 offset:8704
    ds_read_b64_tr_b16 a[228:229], v2 offset:8448
    ds_read_b64_tr_b16 a[230:231], v2 offset:8960
    ds_read_b64_tr_b16 a[232:233], v2 offset:16384
    ds_read_b64_tr_b16 a[234:235], v2 offset:16896
    ds_read_b64_tr_b16 a[236:237], v2 offset:16640
    ds_read_b64_tr_b16 a[238:239], v2 offset:17152
    s_waitcnt vmcnt(11)
    ds_read_b64_tr_b16 a[240:241], v2 offset:24576
    ds_read_b64_tr_b16 a[242:243], v2 offset:25088
    ds_read_b64_tr_b16 a[244:245], v2 offset:24832
    ds_read_b64_tr_b16 a[246:247], v2 offset:25344
    buffer_load_dwordx4 v[132:135], v14, s[24:27], s58 offen offset:2048 sc1
    s_add_u32 s58, s60, 20480
    buffer_load_dwordx4 v[136:139], v14, s[24:27], s58 offen offset:0 sc1
    s_waitcnt vmcnt(11)
    ds_read_b64_tr_b16 a[248:249], v2 offset:32768
    ds_read_b64_tr_b16 a[250:251], v2 offset:33280
    ds_read_b64_tr_b16 a[252:253], v2 offset:33024
    ds_read_b64_tr_b16 a[254:255], v2 offset:33536
    buffer_load_dwordx4 v[140:143], v14, s[24:27], s58 offen offset:2048 sc1
    s_waitcnt vmcnt(11)
    v_mfma_f32_32x32x16_bf16 v[48:63], a[0:3], v[96:99], 0
    v_mfma_f32_32x32x16_bf16 v[80:95], a[4:7], v[96:99], 0
    s_add_u32 s58, s60, 24576
    buffer_load_dwordx4 v[144:147], v14, s[24:27], s58 offen offset:0 sc1
    s_waitcnt vmcnt(11)
    v_mfma_f32_32x32x16_bf16 v[48:63], a[8:11], v[100:103], v[48:63]
    v_mfma_f32_32x32x16_bf16 v[80:95], a[12:15], v[100:103], v[80:95]
    buffer_load_dwordx4 v[148:151], v14, s[24:27], s58 offen offset:2048 sc1
    s_waitcnt vmcnt(11)
    v_mfma_f32_32x32x16_bf16 v[48:63], a[16:19], v[104:107], v[48:63]
    v_mfma_f32_32x32x16_bf16 v[80:95], a[20:23], v[104:107], v[80:95]
    s_add_u32 s58, s60, 28672
    buffer_load_dwordx4 v[152:155], v14, s[24:27], s58 offen offset:0 sc1
    s_waitcnt vmcnt(11)
    v_mfma_f32_32x32x16_bf16 v[48:63], a[24:27], v[108:111], v[48:63]
    v_mfma_f32_32x32x16_bf16 v[80:95], a[28:31], v[108:111], v[80:95]
    buffer_load_dwordx4 v[156:159], v14, s[24:27], s58 offen offset:2048 sc1
    s_waitcnt vmcnt(11)
    v_mfma_f32_32x32x16_bf16 v[48:63], a[32:35], v[112:115], v[48:63]
    v_mfma_f32_32x32x16_bf16 v[80:95], a[36:39], v[112:115], v[80:95]
    s_add_u32 s58, s60, 32768
    buffer_load_dwordx4 v[96:99], v14, s[24:27], s58 offen offset:0 sc1
    s_waitcnt vmcnt(11)
    v_mfma_f32_32x32x16_bf16 v[48:63], a[40:43], v[116:119], v[48:63]
    v_mfma_f32_32x32x16_bf16 v[80:95], a[44:47], v[116:119], v[80:95]
    buffer_load_dwordx4 v[100:103], v14, s[24:27], s58 offen offset:2048 sc1
    s_waitcnt vmcnt(11)
    v_mfma_f32_32x32x16_bf16 v[48:63], a[48:51], v[120:123], v[48:63]
    v_mfma_f32_32x32x16_bf16 v[80:95], a[52:55], v[120:123], v[80:95]
    s_add_u32 s58, s60, 36864
    buffer_load_dwordx4 v[104:107], v14, s[24:27], s58 offen offset:0 sc1
    s_waitcnt vmcnt(11)
    v_mfma_f32_32x32x16_bf16 v[48:63], a[56:59], v[124:127], v[48:63]
    v_mfma_f32_32x32x16_bf16 v[80:95], a[60:63], v[124:127], v[80:95]
    buffer_load_dwordx4 v[108:111], v14, s[24:27], s58 offen offset:2048 sc1
    s_waitcnt vmcnt(11)
    v_mfma_f32_32x32x16_bf16 v[48:63], a[64:67], v[128:131], v[48:63]
    v_mfma_f32_32x32x16_bf16 v[80:95], a[68:71], v[128:131], v[80:95]
    s_add_u32 s58, s60, 40960
    buffer_load_dwordx4 v[112:115], v14, s[24:27], s58 offen offset:0 sc1
    s_waitcnt vmcnt(11)
    v_mfma_f32_32x32x16_bf16 v[48:63], a[72:75], v[132:135], v[48:63]
    v_mfma_f32_32x32x16_bf16 v[80:95], a[76:79], v[132:135], v[80:95]
    buffer_load_dwordx4 v[116:119], v14, s[24:27], s58 offen offset:2048 sc1
    s_waitcnt vmcnt(11)
    v_mfma_f32_32x32x16_bf16 v[48:63], a[80:83], v[136:139], v[48:63]
    v_mfma_f32_32x32x16_bf16 v[80:95], a[84:87], v[136:139], v[80:95]
    s_add_u32 s58, s60, 45056
    buffer_load_dwordx4 v[120:123], v14, s[24:27], s58 offen offset:0 sc1
    s_waitcnt vmcnt(11)
    v_mfma_f32_32x32x16_bf16 v[48:63], a[88:91], v[140:143], v[48:63]
    v_mfma_f32_32x32x16_bf16 v[80:95], a[92:95], v[140:143], v[80:95]
    buffer_load_dwordx4 v[124:127], v14, s[24:27], s58 offen offset:2048 sc1
    s_waitcnt vmcnt(11)
    v_mfma_f32_32x32x16_bf16 v[48:63], a[96:99], v[144:147], v[48:63]
    v_mfma_f32_32x32x16_bf16 v[80:95], a[100:103], v[144:147], v[80:95]
    s_add_u32 s58, s60, 49152
    buffer_load_dwordx4 v[128:131], v14, s[24:27], s58 offen offset:0 sc1
    s_waitcnt vmcnt(11)
    v_mfma_f32_32x32x16_bf16 v[48:63], a[104:107], v[148:151], v[48:63]
    v_mfma_f32_32x32x16_bf16 v[80:95], a[108:111], v[148:151], v[80:95]
    buffer_load_dwordx4 v[132:135], v14, s[24:27], s58 offen offset:2048 sc1
    s_waitcnt vmcnt(11)
    v_mfma_f32_32x32x16_bf16 v[48:63], a[112:115], v[152:155], v[48:63]
    v_mfma_f32_32x32x16_bf16 v[80:95], a[116:119], v[152:155], v[80:95]
    s_add_u32 s58, s60, 53248
    buffer_load_dwordx4 v[136:139], v14, s[24:27], s58 offen offset:0 sc1
    s_waitcnt vmcnt(11)
    v_mfma_f32_32x32x16_bf16 v[48:63], a[120:123], v[156:159], v[48:63]
    v_mfma_f32_32x32x16_bf16 v[80:95], a[124:127], v[156:159], v[80:95]
    buffer_load_dwordx4 v[140:143], v14, s[24:27], s58 offen offset:2048 sc1
    s_waitcnt vmcnt(11)
    v_mfma_f32_32x32x16_bf16 v[48:63], a[128:131], v[96:99], v[48:63]
    v_mfma_f32_32x32x16_bf16 v[80:95], a[132:135], v[96:99], v[80:95]
    s_add_u32 s58, s60, 57344
    buffer_load_dwordx4 v[144:147], v14, s[24:27], s58 offen offset:0 sc1
    s_waitcnt vmcnt(11)
    v_mfma_f32_32x32x16_bf16 v[48:63], a[136:139], v[100:103], v[48:63]
    v_mfma_f32_32x32x16_bf16 v[80:95], a[140:143], v[100:103], v[80:95]
    buffer_load_dwordx4 v[148:151], v14, s[24:27], s58 offen offset:2048 sc1
    s_waitcnt vmcnt(11)
    v_mfma_f32_32x32x16_bf16 v[48:63], a[144:147], v[104:107], v[48:63]
    v_mfma_f32_32x32x16_bf16 v[80:95], a[148:151], v[104:107], v[80:95]
    s_add_u32 s58, s60, 61440
    buffer_load_dwordx4 v[152:155], v14, s[24:27], s58 offen offset:0 sc1
    s_waitcnt vmcnt(11)
    v_mfma_f32_32x32x16_bf16 v[48:63], a[152:155], v[108:111], v[48:63]
    v_mfma_f32_32x32x16_bf16 v[80:95], a[156:159], v[108:111], v[80:95]
    buffer_load_dwordx4 v[156:159], v14, s[24:27], s58 offen offset:2048 sc1
    s_waitcnt vmcnt(11)
    v_mfma_f32_32x32x16_bf16 v[48:63], a[160:163], v[112:115], v[48:63]
    v_mfma_f32_32x32x16_bf16 v[80:95], a[164:167], v[112:115], v[80:95]
    s_add_u32 s58, s60, 0
    buffer_load_dwordx4 v[96:99], v13, s[24:27], s58 offen offset:0 sc1
    s_waitcnt vmcnt(11)
    v_mfma_f32_32x32x16_bf16 v[48:63], a[168:171], v[116:119], v[48:63]
    v_mfma_f32_32x32x16_bf16 v[80:95], a[172:175], v[116:119], v[80:95]
    buffer_load_dwordx4 v[100:103], v13, s[24:27], s58 offen offset:2048 sc1
    s_waitcnt vmcnt(11)
    v_mfma_f32_32x32x16_bf16 v[48:63], a[176:179], v[120:123], v[48:63]
    v_mfma_f32_32x32x16_bf16 v[80:95], a[180:183], v[120:123], v[80:95]
    s_add_u32 s58, s60, 4096
    buffer_load_dwordx4 v[104:107], v13, s[24:27], s58 offen offset:0 sc1
    s_waitcnt vmcnt(11)
    s_waitcnt lgkmcnt(15)
    v_mfma_f32_32x32x16_bf16 v[48:63], a[184:187], v[124:127], v[48:63]
    v_mfma_f32_32x32x16_bf16 v[80:95], a[188:191], v[124:127], v[80:95]
    buffer_load_dwordx4 v[108:111], v13, s[24:27], s58 offen offset:2048 sc1
    s_waitcnt vmcnt(11)
    v_mfma_f32_32x32x16_bf16 v[48:63], a[192:195], v[128:131], v[48:63]
    v_mfma_f32_32x32x16_bf16 v[80:95], a[196:199], v[128:131], v[80:95]
    s_add_u32 s58, s60, 8192
    buffer_load_dwordx4 v[112:115], v13, s[24:27], s58 offen offset:0 sc1
    s_waitcnt vmcnt(11)
    v_mfma_f32_32x32x16_bf16 v[48:63], a[200:203], v[132:135], v[48:63]
    v_mfma_f32_32x32x16_bf16 v[80:95], a[204:207], v[132:135], v[80:95]
    buffer_load_dwordx4 v[116:119], v13, s[24:27], s58 offen offset:2048 sc1
    s_waitcnt vmcnt(11)
    v_mfma_f32_32x32x16_bf16 v[48:63], a[208:211], v[136:139], v[48:63]
    v_mfma_f32_32x32x16_bf16 v[80:95], a[212:215], v[136:139], v[80:95]
    s_add_u32 s58, s60, 12288
    buffer_load_dwordx4 v[120:123], v13, s[24:27], s58 offen offset:0 sc1
    s_waitcnt vmcnt(11)
    v_mfma_f32_32x32x16_bf16 v[48:63], a[216:219], v[140:143], v[48:63]
    v_mfma_f32_32x32x16_bf16 v[80:95], a[220:223], v[140:143], v[80:95]
    buffer_load_dwordx4 v[124:127], v13, s[24:27], s58 offen offset:2048 sc1
    s_waitcnt vmcnt(11)
    s_waitcnt lgkmcnt(12)
    v_mfma_f32_32x32x16_bf16 v[48:63], a[224:227], v[144:147], v[48:63]
    v_mfma_f32_32x32x16_bf16 v[80:95], a[228:231], v[144:147], v[80:95]
    s_add_u32 s58, s60, 16384
    buffer_load_dwordx4 v[128:131], v13, s[24:27], s58 offen offset:0 sc1
    s_waitcnt vmcnt(11)
    s_waitcnt lgkmcnt(8)
    v_mfma_f32_32x32x16_bf16 v[48:63], a[232:235], v[148:151], v[48:63]
    v_mfma_f32_32x32x16_bf16 v[80:95], a[236:239], v[148:151], v[80:95]
    buffer_load_dwordx4 v[132:135], v13, s[24:27], s58 offen offset:2048 sc1
    s_waitcnt vmcnt(11)
    s_waitcnt lgkmcnt(4)
    v_mfma_f32_32x32x16_bf16 v[48:63], a[240:243], v[152:155], v[48:63]
    v_mfma_f32_32x32x16_bf16 v[80:95], a[244:247], v[152:155], v[80:95]
    s_add_u32 s58, s60, 20480
    buffer_load_dwordx4 v[136:139], v13, s[24:27], s58 offen offset:0 sc1
    s_waitcnt vmcnt(11)
    s_waitcnt lgkmcnt(0)
    v_mfma_f32_32x32x16_bf16 v[48:63], a[248:251], v[156:159], v[48:63]
    v_mfma_f32_32x32x16_bf16 v[80:95], a[252:255], v[156:159], v[80:95]
    buffer_load_dwordx4 v[140:143], v13, s[24:27], s58 offen offset:2048 sc1
    s_waitcnt vmcnt(11)
    v_mfma_f32_32x32x16_bf16 v[32:47], a[0:3], v[96:99], v[32:47]
    v_mfma_f32_32x32x16_bf16 v[64:79], a[4:7], v[96:99], 0
    s_add_u32 s58, s60, 24576
    buffer_load_dwordx4 v[144:147], v13, s[24:27], s58 offen offset:0 sc1
    s_waitcnt vmcnt(11)
    v_mfma_f32_32x32x16_bf16 v[32:47], a[8:11], v[100:103], v[32:47]
    v_mfma_f32_32x32x16_bf16 v[64:79], a[12:15], v[100:103], v[64:79]
    buffer_load_dwordx4 v[148:151], v13, s[24:27], s58 offen offset:2048 sc1
    s_waitcnt vmcnt(11)
    v_mfma_f32_32x32x16_bf16 v[32:47], a[16:19], v[104:107], v[32:47]
    v_mfma_f32_32x32x16_bf16 v[64:79], a[20:23], v[104:107], v[64:79]
    s_add_u32 s58, s60, 28672
    buffer_load_dwordx4 v[152:155], v13, s[24:27], s58 offen offset:0 sc1
    s_waitcnt vmcnt(11)
    v_mfma_f32_32x32x16_bf16 v[32:47], a[24:27], v[108:111], v[32:47]
    v_mfma_f32_32x32x16_bf16 v[64:79], a[28:31], v[108:111], v[64:79]
    buffer_load_dwordx4 v[156:159], v13, s[24:27], s58 offen offset:2048 sc1
    s_waitcnt vmcnt(11)
    v_mfma_f32_32x32x16_bf16 v[32:47], a[32:35], v[112:115], v[32:47]
    v_mfma_f32_32x32x16_bf16 v[64:79], a[36:39], v[112:115], v[64:79]
    s_add_u32 s58, s60, 32768
    buffer_load_dwordx4 v[96:99], v13, s[24:27], s58 offen offset:0 sc1
    ds_write_b128 v196, v[48:51] offset:0
    s_waitcnt vmcnt(11)
    v_mfma_f32_32x32x16_bf16 v[32:47], a[40:43], v[116:119], v[32:47]
    v_mfma_f32_32x32x16_bf16 v[64:79], a[44:47], v[116:119], v[64:79]
    buffer_load_dwordx4 v[100:103], v13, s[24:27], s58 offen offset:2048 sc1
    ds_write_b128 v196, v[52:55] offset:1024
    s_waitcnt vmcnt(11)
    v_mfma_f32_32x32x16_bf16 v[32:47], a[48:51], v[120:123], v[32:47]
    v_mfma_f32_32x32x16_bf16 v[64:79], a[52:55], v[120:123], v[64:79]
    s_add_u32 s58, s60, 36864
    buffer_load_dwordx4 v[104:107], v13, s[24:27], s58 offen offset:0 sc1
    ds_write_b128 v196, v[56:59] offset:8192
    s_waitcnt vmcnt(11)
    v_mfma_f32_32x32x16_bf16 v[32:47], a[56:59], v[124:127], v[32:47]
    v_mfma_f32_32x32x16_bf16 v[64:79], a[60:63], v[124:127], v[64:79]
    buffer_load_dwordx4 v[108:111], v13, s[24:27], s58 offen offset:2048 sc1
    ds_write_b128 v196, v[60:63] offset:9216
    s_waitcnt vmcnt(11)
    v_mfma_f32_32x32x16_bf16 v[32:47], a[64:67], v[128:131], v[32:47]
    v_mfma_f32_32x32x16_bf16 v[64:79], a[68:71], v[128:131], v[64:79]
    s_add_u32 s58, s60, 40960
    buffer_load_dwordx4 v[112:115], v13, s[24:27], s58 offen offset:0 sc1
    ds_write_b128 v196, v[80:83] offset:32768
    s_waitcnt vmcnt(11)
    v_mfma_f32_32x32x16_bf16 v[32:47], a[72:75], v[132:135], v[32:47]
    v_mfma_f32_32x32x16_bf16 v[64:79], a[76:79], v[132:135], v[64:79]
    buffer_load_dwordx4 v[116:119], v13, s[24:27], s58 offen offset:2048 sc1
    ds_write_b128 v196, v[84:87] offset:33792
    s_waitcnt vmcnt(11)
    v_mfma_f32_32x32x16_bf16 v[32:47], a[80:83], v[136:139], v[32:47]
    v_mfma_f32_32x32x16_bf16 v[64:79], a[84:87], v[136:139], v[64:79]
    s_add_u32 s58, s60, 45056
    buffer_load_dwordx4 v[120:123], v13, s[24:27], s58 offen offset:0 sc1
    ds_write_b128 v196, v[88:91] offset:40960
    s_waitcnt vmcnt(11)
    v_mfma_f32_32x32x16_bf16 v[32:47], a[88:91], v[140:143], v[32:47]
    v_mfma_f32_32x32x16_bf16 v[64:79], a[92:95], v[140:143], v[64:79]
    buffer_load_dwordx4 v[124:127], v13, s[24:27], s58 offen offset:2048 sc1
    ds_write_b128 v196, v[92:95] offset:41984
    s_waitcnt vmcnt(11)
    v_mfma_f32_32x32x16_bf16 v[32:47], a[96:99], v[144:147], v[32:47]
    v_mfma_f32_32x32x16_bf16 v[64:79], a[100:103], v[144:147], v[64:79]
    s_add_u32 s58, s60, 49152
    buffer_load_dwordx4 v[128:131], v13, s[24:27], s58 offen offset:0 sc1
    s_waitcnt vmcnt(11)
    v_mfma_f32_32x32x16_bf16 v[32:47], a[104:107], v[148:151], v[32:47]
    v_mfma_f32_32x32x16_bf16 v[64:79], a[108:111], v[148:151], v[64:79]
    buffer_load_dwordx4 v[132:135], v13, s[24:27], s58 offen offset:2048 sc1
    s_waitcnt vmcnt(11)
    v_mfma_f32_32x32x16_bf16 v[32:47], a[112:115], v[152:155], v[32:47]
    v_mfma_f32_32x32x16_bf16 v[64:79], a[116:119], v[152:155], v[64:79]
    s_add_u32 s58, s60, 53248
    buffer_load_dwordx4 v[136:139], v13, s[24:27], s58 offen offset:0 sc1
    s_waitcnt vmcnt(11)
    v_mfma_f32_32x32x16_bf16 v[32:47], a[120:123], v[156:159], v[32:47]
    v_mfma_f32_32x32x16_bf16 v[64:79], a[124:127], v[156:159], v[64:79]
    buffer_load_dwordx4 v[140:143], v13, s[24:27], s58 offen offset:2048 sc1
    s_waitcnt vmcnt(11)
    v_mfma_f32_32x32x16_bf16 v[32:47], a[128:131], v[96:99], v[32:47]
    v_mfma_f32_32x32x16_bf16 v[64:79], a[132:135], v[96:99], v[64:79]
    s_add_u32 s58, s60, 57344
    buffer_load_dwordx4 v[144:147], v13, s[24:27], s58 offen offset:0 sc1
    s_waitcnt vmcnt(11)
    v_mfma_f32_32x32x16_bf16 v[32:47], a[136:139], v[100:103], v[32:47]
    v_mfma_f32_32x32x16_bf16 v[64:79], a[140:143], v[100:103], v[64:79]
    buffer_load_dwordx4 v[148:151], v13, s[24:27], s58 offen offset:2048 sc1
    s_waitcnt vmcnt(11)
    v_mfma_f32_32x32x16_bf16 v[32:47], a[144:147], v[104:107], v[32:47]
    v_mfma_f32_32x32x16_bf16 v[64:79], a[148:151], v[104:107], v[64:79]
    s_add_u32 s58, s60, 61440
    buffer_load_dwordx4 v[152:155], v13, s[24:27], s58 offen offset:0 sc1
    s_waitcnt vmcnt(11)
    v_mfma_f32_32x32x16_bf16 v[32:47], a[152:155], v[108:111], v[32:47]
    v_mfma_f32_32x32x16_bf16 v[64:79], a[156:159], v[108:111], v[64:79]
    buffer_load_dwordx4 v[156:159], v13, s[24:27], s58 offen offset:2048 sc1
    s_waitcnt vmcnt(11)
    v_mfma_f32_32x32x16_bf16 v[32:47], a[160:163], v[112:115], v[32:47]
    v_mfma_f32_32x32x16_bf16 v[64:79], a[164:167], v[112:115], v[64:79]
    s_add_u32 m0, s52, 106496
    s_mov_b32 s57, 0
    buffer_load_dwordx4 v8, s[20:23], s57 offen lds
    s_waitcnt vmcnt(11)
    v_mfma_f32_32x32x16_bf16 v[32:47], a[168:171], v[116:119], v[32:47]
    v_mfma_f32_32x32x16_bf16 v[64:79], a[172:175], v[116:119], v[64:79]
    buffer_load_dwordx4 v9, s[20:23], s57 offen offset:1024 lds
    s_waitcnt vmcnt(11)
    v_mfma_f32_32x32x16_bf16 v[32:47], a[176:179], v[120:123], v[32:47]
    v_mfma_f32_32x32x16_bf16 v[64:79], a[180:183], v[120:123], v[64:79]
    s_add_u32 m0, s52, 114688
    s_mov_b32 s57, 65536
    buffer_load_dwordx4 v8, s[20:23], s57 offen lds
    s_waitcnt vmcnt(11)
    v_mfma_f32_32x32x16_bf16 v[32:47], a[184:187], v[124:127], v[32:47]
    v_mfma_f32_32x32x16_bf16 v[64:79], a[188:191], v[124:127], v[64:79]
    buffer_load_dwordx4 v9, s[20:23], s57 offen offset:1024 lds
    s_waitcnt vmcnt(11)
    v_mfma_f32_32x32x16_bf16 v[32:47], a[192:195], v[128:131], v[32:47]
    v_mfma_f32_32x32x16_bf16 v[64:79], a[196:199], v[128:131], v[64:79]
    s_add_u32 m0, s52, 122880
    s_mov_b32 s57, 131072
    buffer_load_dwordx4 v8, s[20:23], s57 offen lds
    s_waitcnt vmcnt(11)
    v_mfma_f32_32x32x16_bf16 v[32:47], a[200:203], v[132:135], v[32:47]
    v_mfma_f32_32x32x16_bf16 v[64:79], a[204:207], v[132:135], v[64:79]
    buffer_load_dwordx4 v9, s[20:23], s57 offen offset:1024 lds
    s_waitcnt vmcnt(11)
    v_mfma_f32_32x32x16_bf16 v[32:47], a[208:211], v[136:139], v[32:47]
    v_mfma_f32_32x32x16_bf16 v[64:79], a[212:215], v[136:139], v[64:79]
    s_add_u32 m0, s52, 131072
    s_mov_b32 s57, 196608
    buffer_load_dwordx4 v8, s[20:23], s57 offen lds
    s_waitcnt vmcnt(11)
    v_mfma_f32_32x32x16_bf16 v[32:47], a[216:219], v[140:143], v[32:47]
    v_mfma_f32_32x32x16_bf16 v[64:79], a[220:223], v[140:143], v[64:79]
    buffer_load_dwordx4 v9, s[20:23], s57 offen offset:1024 lds
    s_waitcnt vmcnt(11)
    v_mfma_f32_32x32x16_bf16 v[32:47], a[224:227], v[144:147], v[32:47]
    v_mfma_f32_32x32x16_bf16 v[64:79], a[228:231], v[144:147], v[64:79]
    s_add_u32 m0, s52, 139264
    s_mov_b32 s57, 262144
    buffer_load_dwordx4 v8, s[20:23], s57 offen lds
    s_waitcnt vmcnt(11)
    v_mfma_f32_32x32x16_bf16 v[32:47], a[232:235], v[148:151], v[32:47]
    v_mfma_f32_32x32x16_bf16 v[64:79], a[236:239], v[148:151], v[64:79]
    buffer_load_dwordx4 v9, s[20:23], s57 offen offset:1024 lds
    s_waitcnt vmcnt(11)
    v_mfma_f32_32x32x16_bf16 v[32:47], a[240:243], v[152:155], v[32:47]
    v_mfma_f32_32x32x16_bf16 v[64:79], a[244:247], v[152:155], v[64:79]
    s_add_u32 m0, s52, 147456
    s_mov_b32 s57, 327680
    buffer_load_dwordx4 v8, s[20:23], s57 offen lds
    s_waitcnt vmcnt(11)
    v_mfma_f32_32x32x16_bf16 v[32:47], a[248:251], v[156:159], v[32:47]
    v_mfma_f32_32x32x16_bf16 v[64:79], a[252:255], v[156:159], v[64:79]
    buffer_load_dwordx4 v9, s[20:23], s57 offen offset:1024 lds
    s_add_u32 m0, s52, 155648
    s_mov_b32 s57, 393216
    buffer_load_dwordx4 v8, s[20:23], s57 offen lds
    buffer_load_dwordx4 v9, s[20:23], s57 offen offset:1024 lds
    s_add_u32 m0, s52, 65536
    s_mov_b32 s57, 458752
    buffer_load_dwordx4 v8, s[20:23], s57 offen lds
    buffer_load_dwordx4 v9, s[20:23], s57 offen offset:1024 lds
    s_nop 2
    ds_write_b128 v196, v[64:67] offset:16384
    ds_write_b128 v196, v[68:71] offset:17408
    ds_write_b128 v196, v[72:75] offset:24576
    ds_write_b128 v196, v[76:79] offset:25600
    s_waitcnt lgkmcnt(0)
    s_barrier
    ds_read_b128 v[160:163], v197 offset:0
    ds_read_b128 v[176:179], v198 offset:16384
    ds_read_b128 v[240:243], v199 offset:32768
    ds_read_b128 v[164:167], v197 offset:1024
    ds_read_b128 v[180:183], v198 offset:17408
    ds_read_b128 v[244:247], v199 offset:33792
    ds_read_b128 v[168:171], v197 offset:8192
    ds_read_b128 v[232:235], v198 offset:24576
    ds_read_b128 v[248:251], v199 offset:40960
    ds_read_b128 v[172:175], v197 offset:9216
    ds_read_b128 v[236:239], v198 offset:25600
    ds_read_b128 v[252:255], v199 offset:41984
    s_add_u32 m0, s52, 73728
    s_mov_b32 s57, 524288
    buffer_load_dwordx4 v8, s[20:23], s57 offen lds
    s_waitcnt lgkmcnt(9)
    v_pk_add_f32 v[160:161], v[160:161], v[176:177]
    v_pk_add_f32 v[32:33], v[32:33], v[240:241]
    v_pk_add_f32 v[162:163], v[162:163], v[178:179]
    v_pk_add_f32 v[34:35], v[34:35], v[242:243]
    v_pk_add_f32 v[32:33], v[32:33], v[160:161]
    v_pk_add_f32 v[34:35], v[34:35], v[162:163]
    v_pk_mul_f32 v[48:49], v[32:33], v[32:33]
    v_pk_mul_f32 v[50:51], v[34:35], v[34:35]
    v_pk_fma_f32 v[48:49], v[48:49], v[186:187], v[186:187] op_sel:[0,0,1] op_sel_hi:[1,0,1]
    v_pk_fma_f32 v[50:51], v[50:51], v[186:187], v[186:187] op_sel:[0,0,1] op_sel_hi:[1,0,1]
    v_pk_mul_f32 v[48:49], v[48:49], v[32:33]
    v_pk_mul_f32 v[50:51], v[50:51], v[34:35]
    v_exp_f32 v48, v48
    v_exp_f32 v49, v49
    v_exp_f32 v50, v50
    v_exp_f32 v51, v51
    buffer_load_dwordx4 v9, s[20:23], s57 offen offset:1024 lds
    v_pk_add_f32 v[48:49], v[48:49], 1.0 op_sel_hi:[1,0]
    v_pk_add_f32 v[50:51], v[50:51], 1.0 op_sel_hi:[1,0]
    v_rcp_f32 v48, v48
    v_rcp_f32 v49, v49
    v_rcp_f32 v50, v50
    v_rcp_f32 v51, v51
    v_pk_mul_f32 v[48:49], v[48:49], v[32:33]
    v_pk_mul_f32 v[50:51], v[50:51], v[34:35]
    v_cvt_pk_bf16_f32 v56, v48, v49
    v_cvt_pk_bf16_f32 v57, v50, v51
    s_waitcnt lgkmcnt(6)
    v_pk_add_f32 v[164:165], v[164:165], v[180:181]
    v_pk_add_f32 v[36:37], v[36:37], v[244:245]
    v_pk_add_f32 v[166:167], v[166:167], v[182:183]
    v_pk_add_f32 v[38:39], v[38:39], v[246:247]
    v_pk_add_f32 v[36:37], v[36:37], v[164:165]
    v_pk_add_f32 v[38:39], v[38:39], v[166:167]
    v_pk_mul_f32 v[48:49], v[36:37], v[36:37]
    v_pk_mul_f32 v[50:51], v[38:39], v[38:39]
    s_add_u32 m0, s52, 81920
    s_mov_b32 s57, 589824
    buffer_load_dwordx4 v8, s[20:23], s57 offen lds
    v_pk_fma_f32 v[48:49], v[48:49], v[186:187], v[186:187] op_sel:[0,0,1] op_sel_hi:[1,0,1]
    v_pk_fma_f32 v[50:51], v[50:51], v[186:187], v[186:187] op_sel:[0,0,1] op_sel_hi:[1,0,1]
    v_pk_mul_f32 v[48:49], v[48:49], v[36:37]
    v_pk_mul_f32 v[50:51], v[50:51], v[38:39]
    v_exp_f32 v48, v48
    v_exp_f32 v49, v49
    v_exp_f32 v50, v50
    v_exp_f32 v51, v51
    v_pk_add_f32 v[48:49], v[48:49], 1.0 op_sel_hi:[1,0]
    v_pk_add_f32 v[50:51], v[50:51], 1.0 op_sel_hi:[1,0]
    v_rcp_f32 v48, v48
    v_rcp_f32 v49, v49
    v_rcp_f32 v50, v50
    v_rcp_f32 v51, v51
    v_pk_mul_f32 v[48:49], v[48:49], v[36:37]
    v_pk_mul_f32 v[50:51], v[50:51], v[38:39]
    buffer_load_dwordx4 v9, s[20:23], s57 offen offset:1024 lds
    v_cvt_pk_bf16_f32 v58, v48, v49
    v_cvt_pk_bf16_f32 v59, v50, v51
    buffer_store_dwordx4 v[56:59], v13, s[24:27], s64 offen offset:0 sc1
    s_waitcnt lgkmcnt(3)
    v_pk_add_f32 v[168:169], v[168:169], v[232:233]
    v_pk_add_f32 v[40:41], v[40:41], v[248:249]
    v_pk_add_f32 v[170:171], v[170:171], v[234:235]
    v_pk_add_f32 v[42:43], v[42:43], v[250:251]
    v_pk_add_f32 v[40:41], v[40:41], v[168:169]
    v_pk_add_f32 v[42:43], v[42:43], v[170:171]
    v_pk_mul_f32 v[48:49], v[40:41], v[40:41]
    v_pk_mul_f32 v[50:51], v[42:43], v[42:43]
    v_pk_fma_f32 v[48:49], v[48:49], v[186:187], v[186:187] op_sel:[0,0,1] op_sel_hi:[1,0,1]
    v_pk_fma_f32 v[50:51], v[50:51], v[186:187], v[186:187] op_sel:[0,0,1] op_sel_hi:[1,0,1]
    v_pk_mul_f32 v[48:49], v[48:49], v[40:41]
    v_pk_mul_f32 v[50:51], v[50:51], v[42:43]
    v_exp_f32 v48, v48
    v_exp_f32 v49, v49
    v_exp_f32 v50, v50
    v_exp_f32 v51, v51
    s_add_u32 m0, s52, 90112
    s_mov_b32 s57, 655360
    buffer_load_dwordx4 v8, s[20:23], s57 offen lds
    v_pk_add_f32 v[48:49], v[48:49], 1.0 op_sel_hi:[1,0]
    v_pk_add_f32 v[50:51], v[50:51], 1.0 op_sel_hi:[1,0]
    v_rcp_f32 v48, v48
    v_rcp_f32 v49, v49
    v_rcp_f32 v50, v50
    v_rcp_f32 v51, v51
    v_pk_mul_f32 v[48:49], v[48:49], v[40:41]
    v_pk_mul_f32 v[50:51], v[50:51], v[42:43]
    v_cvt_pk_bf16_f32 v60, v48, v49
    v_cvt_pk_bf16_f32 v61, v50, v51
    s_waitcnt lgkmcnt(0)
    v_pk_add_f32 v[172:173], v[172:173], v[236:237]
    v_pk_add_f32 v[44:45], v[44:45], v[252:253]
    v_pk_add_f32 v[174:175], v[174:175], v[238:239]
    v_pk_add_f32 v[46:47], v[46:47], v[254:255]
    v_pk_add_f32 v[44:45], v[44:45], v[172:173]
    v_pk_add_f32 v[46:47], v[46:47], v[174:175]
    v_pk_mul_f32 v[48:49], v[44:45], v[44:45]
    v_pk_mul_f32 v[50:51], v[46:47], v[46:47]
    buffer_load_dwordx4 v9, s[20:23], s57 offen offset:1024 lds
    v_pk_fma_f32 v[48:49], v[48:49], v[186:187], v[186:187] op_sel:[0,0,1] op_sel_hi:[1,0,1]
    v_pk_fma_f32 v[50:51], v[50:51], v[186:187], v[186:187] op_sel:[0,0,1] op_sel_hi:[1,0,1]
    v_pk_mul_f32 v[48:49], v[48:49], v[44:45]
    v_pk_mul_f32 v[50:51], v[50:51], v[46:47]
    v_exp_f32 v48, v48
    v_exp_f32 v49, v49
    v_exp_f32 v50, v50
    v_exp_f32 v51, v51
    v_pk_add_f32 v[48:49], v[48:49], 1.0 op_sel_hi:[1,0]
    v_pk_add_f32 v[50:51], v[50:51], 1.0 op_sel_hi:[1,0]
    v_rcp_f32 v48, v48
    v_rcp_f32 v49, v49
    v_rcp_f32 v50, v50
    v_rcp_f32 v51, v51
    v_pk_mul_f32 v[48:49], v[48:49], v[44:45]
    v_pk_mul_f32 v[50:51], v[50:51], v[46:47]
    s_add_u32 m0, s52, 98304
    s_mov_b32 s57, 720896
    buffer_load_dwordx4 v8, s[20:23], s57 offen lds
    v_cvt_pk_bf16_f32 v62, v48, v49
    v_cvt_pk_bf16_f32 v63, v50, v51
    buffer_store_dwordx4 v[60:63], v13, s[24:27], s64 offen offset:2048 sc1
    s_waitcnt vmcnt(23)
    ds_read_b64_tr_b16 a[0:1], v4 offset:40960
    ds_read_b64_tr_b16 a[2:3], v4 offset:41984
    ds_read_b64_tr_b16 a[4:5], v4 offset:41216
    ds_read_b64_tr_b16 a[6:7], v4 offset:42240
    s_waitcnt vmcnt(21)
    ds_read_b64_tr_b16 a[8:9], v4 offset:49152
    ds_read_b64_tr_b16 a[10:11], v4 offset:50176
    ds_read_b64_tr_b16 a[12:13], v4 offset:49408
    ds_read_b64_tr_b16 a[14:15], v4 offset:50432
    s_waitcnt vmcnt(19)
    ds_read_b64_tr_b16 a[16:17], v4 offset:57344
    ds_read_b64_tr_b16 a[18:19], v4 offset:58368
    ds_read_b64_tr_b16 a[20:21], v4 offset:57600
    ds_read_b64_tr_b16 a[22:23], v4 offset:58624
    s_waitcnt vmcnt(17)
    ds_read_b64_tr_b16 a[24:25], v5 offset:0
    ds_read_b64_tr_b16 a[26:27], v5 offset:1024
    ds_read_b64_tr_b16 a[28:29], v5 offset:256
    ds_read_b64_tr_b16 a[30:31], v5 offset:1280
    buffer_load_dwordx4 v9, s[20:23], s57 offen offset:1024 lds
    s_waitcnt vmcnt(16)
    ds_read_b64_tr_b16 a[32:33], v5 offset:8192
    ds_read_b64_tr_b16 a[34:35], v5 offset:9216
    ds_read_b64_tr_b16 a[36:37], v5 offset:8448
    ds_read_b64_tr_b16 a[38:39], v5 offset:9472
    s_waitcnt vmcnt(14)
    ds_read_b64_tr_b16 a[40:41], v5 offset:16384
    ds_read_b64_tr_b16 a[42:43], v5 offset:17408
    ds_read_b64_tr_b16 a[44:45], v5 offset:16640
    ds_read_b64_tr_b16 a[46:47], v5 offset:17664
    s_waitcnt vmcnt(12)
    ds_read_b64_tr_b16 a[48:49], v5 offset:24576
    ds_read_b64_tr_b16 a[50:51], v5 offset:25600
    ds_read_b64_tr_b16 a[52:53], v5 offset:24832
    ds_read_b64_tr_b16 a[54:55], v5 offset:25856
    s_waitcnt vmcnt(10)
    ds_read_b64_tr_b16 a[56:57], v4 offset:0
    ds_read_b64_tr_b16 a[58:59], v4 offset:1024
    ds_read_b64_tr_b16 a[60:61], v4 offset:256
    ds_read_b64_tr_b16 a[62:63], v4 offset:1280
    s_waitcnt lgkmcnt(15)
    s_add_u32 m0, s52, 106496
    s_mov_b32 s57, 786432
    buffer_load_dwordx4 v8, s[20:23], s57 offen lds
    s_waitcnt vmcnt(9)
    ds_read_b64_tr_b16 a[64:65], v4 offset:8192
    ds_read_b64_tr_b16 a[66:67], v4 offset:9216
    ds_read_b64_tr_b16 a[68:69], v4 offset:8448
    ds_read_b64_tr_b16 a[70:71], v4 offset:9472
    s_waitcnt vmcnt(7)
    ds_read_b64_tr_b16 a[72:73], v4 offset:16384
    ds_read_b64_tr_b16 a[74:75], v4 offset:17408
    ds_read_b64_tr_b16 a[76:77], v4 offset:16640
    ds_read_b64_tr_b16 a[78:79], v4 offset:17664
    s_waitcnt vmcnt(4)
    ds_read_b64_tr_b16 a[80:81], v4 offset:24576
    ds_read_b64_tr_b16 a[82:83], v4 offset:25600
    ds_read_b64_tr_b16 a[84:85], v4 offset:24832
    ds_read_b64_tr_b16 a[86:87], v4 offset:25856
    buffer_load_dwordx4 v9, s[20:23], s57 offen offset:1024 lds
    s_add_u32 m0, s52, 114688
    s_mov_b32 s57, 851968
    buffer_load_dwordx4 v8, s[20:23], s57 offen lds
    buffer_load_dwordx4 v9, s[20:23], s57 offen offset:1024 lds
    s_add_u32 m0, s52, 122880
    s_mov_b32 s57, 917504
    buffer_load_dwordx4 v8, s[20:23], s57 offen lds
    buffer_load_dwordx4 v9, s[20:23], s57 offen offset:1024 lds
    s_add_u32 m0, s52, 131072
    s_mov_b32 s57, 983040
    buffer_load_dwordx4 v8, s[20:23], s57 offen lds
    buffer_load_dwordx4 v9, s[20:23], s57 offen offset:1024 lds
    s_waitcnt lgkmcnt(15)
    s_add_u32 m0, s52, 139264
    s_mov_b32 s57, 1048576
    buffer_load_dwordx4 v8, s[20:23], s57 offen lds
    s_waitcnt vmcnt(10)
    s_barrier
    s_cmp_lg_u32 s44, 0
    s_cbranch_scc1 L_nopub7
    s_lshl_b32 s62, s51, 5
    s_add_u32 s62, s62, s50
    s_lshl_b32 s62, s62, 7
    s_add_u32 s62, s62, 12713984
    v_mov_b32 v30, s47
    s_mov_b64 exec, 1
    buffer_store_dword v30, off, s[24:27], s62 sc1
    s_mov_b64 exec, -1
L_nopub7:
L_p3join:
    v_and_b32 v230, 31, v1
    v_lshrrev_b32 v231, 3, v230
    v_and_b32 v230, 7, v230
    v_lshlrev_b32 v220, 13, v231
    v_lshl_add_u32 v220, v230, 8, v220
    v_lshl_add_u32 v220, v230, 4, v220
    v_add_u32 v220, s52, v220
    v_lshrrev_b32 v230, 5, v1
    v_bfe_u32 v231, v1, 1, 1
    v_xor_b32 v230, v230, v231
    v_lshl_add_u32 v220, v230, 7, v220
    s_and_b32 s65, s48, 0
    buffer_load_dwordx4 v9, s[20:23], s57 offen offset:1024 lds
    s_lshl_b32 s65, s65, 6
    v_xor_b32 v220, s65, v220
    v_xor_b32 v221, 16, v220
    v_xor_b32 v222, 32, v220
    v_xor_b32 v223, 48, v220
    v_xor_b32 v224, 64, v220
    v_xor_b32 v225, 80, v220
    v_xor_b32 v226, 96, v220
    v_xor_b32 v227, 112, v220
    v_lshrrev_b32 v218, 3, v0
    v_and_b32 v219, 7, v0
    v_and_b32 v230, 7, v218
    v_xor_b32 v219, v219, v230
    v_lshrrev_b32 v231, 3, v218
    v_lshlrev_b32 v228, 13, v231
    v_lshl_add_u32 v228, v230, 8, v228
    s_add_u32 m0, s52, 147456
    s_mov_b32 s57, 1114112
    buffer_load_dwordx4 v8, s[20:23], s57 offen lds
    v_lshl_add_u32 v228, v219, 4, v228
    v_bfe_u32 v231, v218, 1, 1
    v_lshl_add_u32 v228, v231, 7, v228
    v_xor_b32 v229, 128, v228
    s_waitcnt vmcnt(11)
    ds_read_b64_tr_b16 a[88:89], v4 offset:32768
    ds_read_b64_tr_b16 a[90:91], v4 offset:33792
    ds_read_b64_tr_b16 a[92:93], v4 offset:33024
    ds_read_b64_tr_b16 a[94:95], v4 offset:34048
    buffer_load_dwordx4 v9, s[20:23], s57 offen offset:1024 lds
    s_add_u32 m0, s52, 155648
    s_mov_b32 s57, 1179648
    buffer_load_dwordx4 v8, s[20:23], s57 offen lds
    s_waitcnt vmcnt(11)
    ds_read_b64_tr_b16 a[96:97], v4 offset:40960
    ds_read_b64_tr_b16 a[98:99], v4 offset:41984
    ds_read_b64_tr_b16 a[100:101], v4 offset:41216
    ds_read_b64_tr_b16 a[102:103], v4 offset:42240
    buffer_load_dwordx4 v9, s[20:23], s57 offen offset:1024 lds
    s_waitcnt lgkmcnt(15)
    s_add_u32 m0, s52, 65536
    s_mov_b32 s57, 1245184
    buffer_load_dwordx4 v8, s[20:23], s57 offen lds
    s_waitcnt vmcnt(11)
    ds_read_b64_tr_b16 a[104:105], v4 offset:49152
    ds_read_b64_tr_b16 a[106:107], v4 offset:50176
    ds_read_b64_tr_b16 a[108:109], v4 offset:49408
    ds_read_b64_tr_b16 a[110:111], v4 offset:50432
    buffer_load_dwordx4 v9, s[20:23], s57 offen offset:1024 lds
    s_add_u32 m0, s52, 73728
    s_mov_b32 s57, 1310720
    buffer_load_dwordx4 v8, s[20:23], s57 offen lds
    s_waitcnt vmcnt(11)
    ds_read_b64_tr_b16 a[112:113], v4 offset:57344
    ds_read_b64_tr_b16 a[114:115], v4 offset:58368
    ds_read_b64_tr_b16 a[116:117], v4 offset:57600
    ds_read_b64_tr_b16 a[118:119], v4 offset:58624
    buffer_load_dwordx4 v9, s[20:23], s57 offen offset:1024 lds
    s_waitcnt lgkmcnt(15)
    s_add_u32 m0, s52, 81920
    s_mov_b32 s57, 1376256
    buffer_load_dwordx4 v8, s[20:23], s57 offen lds
    s_waitcnt vmcnt(11)
    ds_read_b64_tr_b16 a[120:121], v5 offset:0
    ds_read_b64_tr_b16 a[122:123], v5 offset:1024
    ds_read_b64_tr_b16 a[124:125], v5 offset:256
    ds_read_b64_tr_b16 a[126:127], v5 offset:1280
    buffer_load_dwordx4 v9, s[20:23], s57 offen offset:1024 lds
    s_add_u32 m0, s52, 90112
    s_mov_b32 s57, 1441792
    buffer_load_dwordx4 v8, s[20:23], s57 offen lds
    s_waitcnt vmcnt(11)
    ds_read_b64_tr_b16 a[128:129], v5 offset:8192
    ds_read_b64_tr_b16 a[130:131], v5 offset:9216
    ds_read_b64_tr_b16 a[132:133], v5 offset:8448
    ds_read_b64_tr_b16 a[134:135], v5 offset:9472
    buffer_load_dwordx4 v9, s[20:23], s57 offen offset:1024 lds
    s_waitcnt lgkmcnt(15)
    s_add_u32 m0, s52, 98304
    s_mov_b32 s57, 1507328
    buffer_load_dwordx4 v8, s[20:23], s57 offen lds
    s_waitcnt vmcnt(11)
    ds_read_b64_tr_b16 a[136:137], v5 offset:16384
    ds_read_b64_tr_b16 a[138:139], v5 offset:17408
    ds_read_b64_tr_b16 a[140:141], v5 offset:16640
    ds_read_b64_tr_b16 a[142:143], v5 offset:17664
    buffer_load_dwordx4 v9, s[20:23], s57 offen offset:1024 lds
    s_add_u32 m0, s52, 106496
    s_mov_b32 s57, 1572864
    buffer_load_dwordx4 v8, s[20:23], s57 offen lds
    s_waitcnt vmcnt(11)
    ds_read_b64_tr_b16 a[144:145], v5 offset:24576
    ds_read_b64_tr_b16 a[146:147], v5 offset:25600
    ds_read_b64_tr_b16 a[148:149], v5 offset:24832
    ds_read_b64_tr_b16 a[150:151], v5 offset:25856
    buffer_load_dwordx4 v9, s[20:23], s57 offen offset:1024 lds
    s_waitcnt lgkmcnt(15)
    s_add_u32 m0, s52, 114688
    s_mov_b32 s57, 1638400
    buffer_load_dwordx4 v8, s[20:23], s57 offen lds
    s_waitcnt vmcnt(11)
    ds_read_b64_tr_b16 a[152:153], v4 offset:0
    ds_read_b64_tr_b16 a[154:155], v4 offset:1024
    ds_read_b64_tr_b16 a[156:157], v4 offset:256
    ds_read_b64_tr_b16 a[158:159], v4 offset:1280
    buffer_load_dwordx4 v9, s[20:23], s57 offen offset:1024 lds
    s_add_u32 m0, s52, 122880
    s_mov_b32 s57, 1703936
    buffer_load_dwordx4 v8, s[20:23], s57 offen lds
    s_waitcnt vmcnt(11)
    ds_read_b64_tr_b16 a[160:161], v4 offset:8192
    ds_read_b64_tr_b16 a[162:163], v4 offset:9216
    ds_read_b64_tr_b16 a[164:165], v4 offset:8448
    ds_read_b64_tr_b16 a[166:167], v4 offset:9472
    buffer_load_dwordx4 v9, s[20:23], s57 offen offset:1024 lds
    s_waitcnt lgkmcnt(15)
    s_add_u32 m0, s52, 131072
    s_mov_b32 s57, 1769472
    buffer_load_dwordx4 v8, s[20:23], s57 offen lds
    s_waitcnt vmcnt(11)
    ds_read_b64_tr_b16 a[168:169], v4 offset:16384
    ds_read_b64_tr_b16 a[170:171], v4 offset:17408
    ds_read_b64_tr_b16 a[172:173], v4 offset:16640
    ds_read_b64_tr_b16 a[174:175], v4 offset:17664
    buffer_load_dwordx4 v9, s[20:23], s57 offen offset:1024 lds
    buffer_load_dwordx4 v[208:211], v205, s[4:7], s89 offen
    s_waitcnt vmcnt(11)
    ds_read_b64_tr_b16 a[176:177], v4 offset:24576
    ds_read_b64_tr_b16 a[178:179], v4 offset:25600
    ds_read_b64_tr_b16 a[180:181], v4 offset:24832
    ds_read_b64_tr_b16 a[182:183], v4 offset:25856
    buffer_load_dwordx4 v[212:215], v205, s[4:7], s90 offen
    buffer_load_ushort v216, v206, s[36:39], s91 offen
    s_waitcnt vmcnt(11)
    ds_read_b64_tr_b16 a[184:185], v4 offset:32768
    ds_read_b64_tr_b16 a[186:187], v4 offset:33792
    ds_read_b64_tr_b16 a[188:189], v4 offset:33024
    ds_read_b64_tr_b16 a[190:191], v4 offset:34048
    buffer_load_ushort v217, v206, s[36:39], s91 offen offset:64
    s_add_u32 m0, s52, 139264
    s_mov_b32 s57, 0
    buffer_load_dwordx4 v10, s[12:15], s57 offen lds
    s_waitcnt vmcnt(11)
    ds_read_b64_tr_b16 a[192:193], v4 offset:40960
    ds_read_b64_tr_b16 a[194:195], v4 offset:41984
    ds_read_b64_tr_b16 a[196:197], v4 offset:41216
    ds_read_b64_tr_b16 a[198:199], v4 offset:42240
    buffer_load_dwordx4 v11, s[12:15], s57 offen offset:1024 lds
    s_waitcnt lgkmcnt(15)
    s_add_u32 m0, s52, 147456
    s_mov_b32 s57, 14336
    buffer_load_dwordx4 v10, s[12:15], s57 offen lds
    s_waitcnt vmcnt(11)
    ds_read_b64_tr_b16 a[200:201], v4 offset:49152
    ds_read_b64_tr_b16 a[202:203], v4 offset:50176
    ds_read_b64_tr_b16 a[204:205], v4 offset:49408
    ds_read_b64_tr_b16 a[206:207], v4 offset:50432
    buffer_load_dwordx4 v11, s[12:15], s57 offen offset:1024 lds
    s_add_u32 m0, s52, 155648
    s_mov_b32 s57, 21504
    buffer_load_dwordx4 v10, s[12:15], s57 offen lds
    s_waitcnt vmcnt(11)
    ds_read_b64_tr_b16 a[208:209], v4 offset:57344
    ds_read_b64_tr_b16 a[210:211], v4 offset:58368
    ds_read_b64_tr_b16 a[212:213], v4 offset:57600
    ds_read_b64_tr_b16 a[214:215], v4 offset:58624
    buffer_load_dwordx4 v11, s[12:15], s57 offen offset:1024 lds
    s_add_u32 m0, s52, 65536
    s_mov_b32 s57, 35840
    buffer_load_dwordx4 v10, s[12:15], s57 offen lds
    s_waitcnt vmcnt(11)
    ds_read_b64_tr_b16 a[216:217], v5 offset:0
    ds_read_b64_tr_b16 a[218:219], v5 offset:1024
    ds_read_b64_tr_b16 a[220:221], v5 offset:256
    ds_read_b64_tr_b16 a[222:223], v5 offset:1280
    buffer_load_dwordx4 v11, s[12:15], s57 offen offset:1024 lds
    s_add_u32 m0, s52, 73728
    s_mov_b32 s57, 50176
    buffer_load_dwordx4 v10, s[12:15], s57 offen lds
    buffer_load_dwordx4 v11, s[12:15], s57 offen offset:1024 lds
    buffer_load_dword v203, v204, s[24:27], 0 offen sc1
    s_waitcnt vmcnt(11)
    v_lshlrev_b32 v216, 16, v216
    v_lshlrev_b32 v232, 16, v208
    v_and_b32 v233, 0xffff0000, v208
    v_lshlrev_b32 v234, 16, v209
    s_waitcnt lgkmcnt(15)
    s_add_u32 m0, s52, 81920
    s_mov_b32 s57, 64512
    buffer_load_dwordx4 v10, s[12:15], s57 offen lds
    v_and_b32 v235, 0xffff0000, v209
    v_lshlrev_b32 v236, 16, v210
    v_and_b32 v237, 0xffff0000, v210
    v_lshlrev_b32 v238, 16, v211
    v_and_b32 v239, 0xffff0000, v211
    v_add_f32 v232, v232, v216
    v_add_f32 v233, v233, v216
    v_add_f32 v234, v234, v216
    v_add_f32 v235, v235, v216
    v_add_f32 v236, v236, v216
    v_add_f32 v237, v237, v216
    v_add_f32 v238, v238, v216
    v_add_f32 v239, v239, v216
    v_lshlrev_b32 v217, 16, v217
    v_lshlrev_b32 v240, 16, v212
    v_and_b32 v241, 0xffff0000, v212
    buffer_load_dwordx4 v11, s[12:15], s57 offen offset:1024 lds
    v_lshlrev_b32 v242, 16, v213
    v_and_b32 v243, 0xffff0000, v213
    v_lshlrev_b32 v244, 16, v214
    v_and_b32 v245, 0xffff0000, v214
    v_lshlrev_b32 v246, 16, v215
    v_and_b32 v247, 0xffff0000, v215
    v_add_f32 v240, v240, v217
    v_add_f32 v241, v241, v217
    v_add_f32 v242, v242, v217
    v_add_f32 v243, v243, v217
    v_add_f32 v244, v244, v217
    v_add_f32 v245, v245, v217
    v_add_f32 v246, v246, v217
    v_add_f32 v247, v247, v217
    s_waitcnt vmcnt(11)
    ds_read_b64_tr_b16 a[224:225], v3 offset:8192
    ds_read_b64_tr_b16 a[226:227], v3 offset:8704
    ds_read_b64_tr_b16 a[228:229], v3 offset:8448
    ds_read_b64_tr_b16 a[230:231], v3 offset:8960
    s_add_u32 m0, s52, 90112
    s_mov_b32 s57, 71680
    buffer_load_dwordx4 v10, s[12:15], s57 offen lds
    buffer_load_dwordx4 v11, s[12:15], s57 offen offset:1024 lds
    s_waitcnt vmcnt(11)
    ds_read_b64_tr_b16 a[232:233], v3 offset:16384
    ds_read_b64_tr_b16 a[234:235], v3 offset:16896
    ds_read_b64_tr_b16 a[236:237], v3 offset:16640
    ds_read_b64_tr_b16 a[238:239], v3 offset:17152
    s_add_u32 m0, s52, 98304
    s_mov_b32 s57, 86016
    buffer_load_dwordx4 v10, s[12:15], s57 offen lds
    buffer_load_dwordx4 v11, s[12:15], s57 offen offset:1024 lds
    s_waitcnt vmcnt(11)
    ds_read_b64_tr_b16 a[240:241], v3 offset:24576
    ds_read_b64_tr_b16 a[242:243], v3 offset:25088
    ds_read_b64_tr_b16 a[244:245], v3 offset:24832
    ds_read_b64_tr_b16 a[246:247], v3 offset:25344
    s_waitcnt vmcnt(9)
    ds_read_b64_tr_b16 a[248:249], v2 offset:0
    ds_read_b64_tr_b16 a[250:251], v2 offset:512
    ds_read_b64_tr_b16 a[252:253], v2 offset:256
    ds_read_b64_tr_b16 a[254:255], v2 offset:768
    s_waitcnt vmcnt(6)
    v_cmp_ne_u32 vcc, s47, v203
    s_nop 0
    s_cbranch_vccz L_ok9
    s_mov_b32 s59, 20000
L_spin8:
    buffer_load_dword v203, v204, s[24:27], 0 offen sc1
    s_waitcnt vmcnt(0)
    v_cmp_ne_u32 vcc, s47, v203
    s_nop 0
    s_cbranch_vccz L_ok9
    s_sub_u32 s59, s59, 1
    s_cbranch_scc0 L_spin8
L_ok9:
    s_add_u32 s58, s61, 0
    buffer_load_dwordx4 v[96:99], v16, s[24:27], s58 offen offset:0 sc1
    buffer_load_dwordx4 v[100:103], v16, s[24:27], s58 offen offset:2048 sc1
    s_add_u32 s58, s61, 4096
    buffer_load_dwordx4 v[104:107], v16, s[24:27], s58 offen offset:0 sc1
    buffer_load_dwordx4 v[108:111], v16, s[24:27], s58 offen offset:2048 sc1
    s_add_u32 s58, s61, 8192
    buffer_load_dwordx4 v[112:115], v16, s[24:27], s58 offen offset:0 sc1
    buffer_load_dwordx4 v[116:119], v16, s[24:27], s58 offen offset:2048 sc1
    s_add_u32 s58, s61, 12288
    buffer_load_dwordx4 v[120:123], v16, s[24:27], s58 offen offset:0 sc1
    buffer_load_dwordx4 v[124:127], v16, s[24:27], s58 offen offset:2048 sc1
    s_add_u32 s58, s61, 16384
    buffer_load_dwordx4 v[128:131], v16, s[24:27], s58 offen offset:0 sc1
    buffer_load_dwordx4 v[132:135], v16, s[24:27], s58 offen offset:2048 sc1
    s_add_u32 s58, s61, 20480
    buffer_load_dwordx4 v[136:139], v16, s[24:27], s58 offen offset:0 sc1
    buffer_load_dwordx4 v[140:143], v16, s[24:27], s58 offen offset:2048 sc1
    s_waitcnt vmcnt(11)
    v_mfma_f32_32x32x16_bf16 v[64:79], v[96:99], a[0:3], 0
    v_mfma_f32_32x32x16_bf16 v[80:95], v[96:99], a[4:7], 0
    s_add_u32 s58, s61, 24576
    buffer_load_dwordx4 v[144:147], v16, s[24:27], s58 offen offset:0 sc1
    s_waitcnt vmcnt(11)
    v_mfma_f32_32x32x16_bf16 v[64:79], v[100:103], a[8:11], v[64:79]
    v_mfma_f32_32x32x16_bf16 v[80:95], v[100:103], a[12:15], v[80:95]
    buffer_load_dwordx4 v[148:151], v16, s[24:27], s58 offen offset:2048 sc1
    s_waitcnt vmcnt(11)
    v_mfma_f32_32x32x16_bf16 v[64:79], v[104:107], a[16:19], v[64:79]
    v_mfma_f32_32x32x16_bf16 v[80:95], v[104:107], a[20:23], v[80:95]
    s_add_u32 s58, s61, 28672
    buffer_load_dwordx4 v[152:155], v16, s[24:27], s58 offen offset:0 sc1
    s_waitcnt vmcnt(11)
    v_mfma_f32_32x32x16_bf16 v[64:79], v[108:111], a[24:27], v[64:79]
    v_mfma_f32_32x32x16_bf16 v[80:95], v[108:111], a[28:31], v[80:95]
    buffer_load_dwordx4 v[156:159], v16, s[24:27], s58 offen offset:2048 sc1
    s_waitcnt vmcnt(11)
    v_mfma_f32_32x32x16_bf16 v[64:79], v[112:115], a[32:35], v[64:79]
    v_mfma_f32_32x32x16_bf16 v[80:95], v[112:115], a[36:39], v[80:95]
    s_add_u32 s58, s61, 32768
    buffer_load_dwordx4 v[96:99], v16, s[24:27], s58 offen offset:0 sc1
    s_waitcnt vmcnt(11)
    v_mfma_f32_32x32x16_bf16 v[64:79], v[116:119], a[40:43], v[64:79]
    v_mfma_f32_32x32x16_bf16 v[80:95], v[116:119], a[44:47], v[80:95]
    buffer_load_dwordx4 v[100:103], v16, s[24:27], s58 offen offset:2048 sc1
    s_waitcnt vmcnt(11)
    v_mfma_f32_32x32x16_bf16 v[64:79], v[120:123], a[48:51], v[64:79]
    v_mfma_f32_32x32x16_bf16 v[80:95], v[120:123], a[52:55], v[80:95]
    s_add_u32 s58, s61, 36864
    buffer_load_dwordx4 v[104:107], v16, s[24:27], s58 offen offset:0 sc1
    s_waitcnt vmcnt(11)
    v_mfma_f32_32x32x16_bf16 v[64:79], v[124:127], a[56:59], v[64:79]
    v_mfma_f32_32x32x16_bf16 v[80:95], v[124:127], a[60:63], v[80:95]
    buffer_load_dwordx4 v[108:111], v16, s[24:27], s58 offen offset:2048 sc1
    s_waitcnt vmcnt(11)
    v_mfma_f32_32x32x16_bf16 v[64:79], v[128:131], a[64:67], v[64:79]
    v_mfma_f32_32x32x16_bf16 v[80:95], v[128:131], a[68:71], v[80:95]
    s_add_u32 s58, s61, 40960
    buffer_load_dwordx4 v[112:115], v16, s[24:27], s58 offen offset:0 sc1
    s_waitcnt vmcnt(11)
    v_mfma_f32_32x32x16_bf16 v[64:79], v[132:135], a[72:75], v[64:79]
    v_mfma_f32_32x32x16_bf16 v[80:95], v[132:135], a[76:79], v[80:95]
    buffer_load_dword v201, v202, s[24:27], 0 offen sc1
    s_waitcnt vmcnt(11)
    v_mfma_f32_32x32x16_bf16 v[64:79], v[136:139], a[80:83], v[64:79]
    buffer_load_dwordx4 v[116:119], v16, s[24:27], s58 offen offset:2048 sc1
    v_mfma_f32_32x32x16_bf16 v[80:95], v[136:139], a[84:87], v[80:95]
    s_waitcnt vmcnt(11)
    v_mfma_f32_32x32x16_bf16 v[64:79], v[140:143], a[88:91], v[64:79]
    s_add_u32 s58, s61, 45056
    buffer_load_dwordx4 v[120:123], v16, s[24:27], s58 offen offset:0 sc1
    v_mfma_f32_32x32x16_bf16 v[80:95], v[140:143], a[92:95], v[80:95]
    s_waitcnt vmcnt(11)
    v_mfma_f32_32x32x16_bf16 v[64:79], v[144:147], a[96:99], v[64:79]
    buffer_load_dwordx4 v[124:127], v16, s[24:27], s58 offen offset:2048 sc1
    v_mfma_f32_32x32x16_bf16 v[80:95], v[144:147], a[100:103], v[80:95]
    s_waitcnt vmcnt(11)
    v_mfma_f32_32x32x16_bf16 v[64:79], v[148:151], a[104:107], v[64:79]
    s_add_u32 s58, s61, 49152
    buffer_load_dwordx4 v[128:131], v16, s[24:27], s58 offen offset:0 sc1
    v_mfma_f32_32x32x16_bf16 v[80:95], v[148:151], a[108:111], v[80:95]
    s_waitcnt vmcnt(11)
    v_mfma_f32_32x32x16_bf16 v[64:79], v[152:155], a[112:115], v[64:79]
    buffer_load_dwordx4 v[132:135], v16, s[24:27], s58 offen offset:2048 sc1
    v_mfma_f32_32x32x16_bf16 v[80:95], v[152:155], a[116:119], v[80:95]
    s_waitcnt vmcnt(11)
    v_mfma_f32_32x32x16_bf16 v[64:79], v[156:159], a[120:123], v[64:79]
    s_add_u32 s58, s61, 53248
    buffer_load_dwordx4 v[136:139], v16, s[24:27], s58 offen offset:0 sc1
    v_mfma_f32_32x32x16_bf16 v[80:95], v[156:159], a[124:127], v[80:95]
    s_waitcnt vmcnt(11)
    v_mfma_f32_32x32x16_bf16 v[64:79], v[96:99], a[128:131], v[64:79]
    buffer_load_dwordx4 v[140:143], v16, s[24:27], s58 offen offset:2048 sc1
    v_mfma_f32_32x32x16_bf16 v[80:95], v[96:99], a[132:135], v[80:95]
    s_waitcnt vmcnt(11)
    v_mfma_f32_32x32x16_bf16 v[64:79], v[100:103], a[136:139], v[64:79]
    v_mfma_f32_32x32x16_bf16 v[80:95], v[100:103], a[140:143], v[80:95]
    s_waitcnt vmcnt(10)
    v_mfma_f32_32x32x16_bf16 v[64:79], v[104:107], a[144:147], v[64:79]
    v_mfma_f32_32x32x16_bf16 v[80:95], v[104:107], a[148:151], v[80:95]
    s_waitcnt vmcnt(9)
    v_mfma_f32_32x32x16_bf16 v[64:79], v[108:111], a[152:155], v[64:79]
    v_mfma_f32_32x32x16_bf16 v[80:95], v[108:111], a[156:159], v[80:95]
    s_waitcnt vmcnt(8)
    v_mfma_f32_32x32x16_bf16 v[64:79], v[112:115], a[160:163], v[64:79]
    v_mfma_f32_32x32x16_bf16 v[80:95], v[112:115], a[164:167], v[80:95]
    s_waitcnt vmcnt(7)
    v_cmp_ne_u32 vcc, s47, v201
    s_nop 0
    s_cbranch_vccz L_ok11
    s_mov_b32 s59, 20000
L_spin10:
    buffer_load_dword v201, v202, s[24:27], 0 offen sc1
    s_waitcnt vmcnt(0)
    v_cmp_ne_u32 vcc, s47, v201
    s_nop 0
    s_cbranch_vccz L_ok11
    s_sub_u32 s59, s59, 1
    s_cbranch_scc0 L_spin10
L_ok11:
    buffer_load_dwordx4 v[144:147], v12, s[24:27], s88 offen offset:0 sc1
    buffer_load_dwordx4 v[148:151], v12, s[24:27], s88 offen offset:1024 sc1
    buffer_load_dwordx4 v[152:155], v12, s[24:27], s88 offen offset:2048 sc1
    buffer_load_dwordx4 v[156:159], v12, s[24:27], s88 offen offset:3072 sc1
    s_add_u32 s88, s88, 4096
    buffer_load_dwordx4 v[96:99], v12, s[24:27], s88 offen offset:0 sc1
    s_waitcnt vmcnt(11)
    v_mfma_f32_32x32x16_bf16 v[64:79], v[116:119], a[168:171], v[64:79]
    v_mfma_f32_32x32x16_bf16 v[80:95], v[116:119], a[172:175], v[80:95]
    buffer_load_dwordx4 v[100:103], v12, s[24:27], s88 offen offset:1024 sc1
    s_waitcnt vmcnt(11)
    v_mfma_f32_32x32x16_bf16 v[64:79], v[120:123], a[176:179], v[64:79]
    v_mfma_f32_32x32x16_bf16 v[80:95], v[120:123], a[180:183], v[80:95]
    buffer_load_dwordx4 v[104:107], v12, s[24:27], s88 offen offset:2048 sc1
    s_waitcnt vmcnt(11)
    v_mfma_f32_32x32x16_bf16 v[64:79], v[124:127], a[184:187], v[64:79]
    v_mfma_f32_32x32x16_bf16 v[80:95], v[124:127], a[188:191], v[80:95]
    buffer_load_dwordx4 v[108:111], v12, s[24:27], s88 offen offset:3072 sc1
    s_waitcnt vmcnt(11)
    s_waitcnt lgkmcnt(15)
    v_mfma_f32_32x32x16_bf16 v[64:79], v[128:131], a[192:195], v[64:79]
    v_mfma_f32_32x32x16_bf16 v[80:95], v[128:131], a[196:199], v[80:95]
    s_add_u32 s88, s88, 4096
    buffer_load_dwordx4 v[112:115], v12, s[24:27], s88 offen offset:0 sc1
    s_waitcnt vmcnt(11)
    v_mfma_f32_32x32x16_bf16 v[64:79], v[132:135], a[200:203], v[64:79]
    v_mfma_f32_32x32x16_bf16 v[80:95], v[132:135], a[204:207], v[80:95]
    buffer_load_dwordx4 v[116:119], v12, s[24:27], s88 offen offset:1024 sc1
    s_waitcnt vmcnt(11)
    v_mfma_f32_32x32x16_bf16 v[64:79], v[136:139], a[208:211], v[64:79]
    v_mfma_f32_32x32x16_bf16 v[80:95], v[136:139], a[212:215], v[80:95]
    buffer_load_dwordx4 v[120:123], v12, s[24:27], s88 offen offset:2048 sc1
    s_waitcnt vmcnt(11)
    v_mfma_f32_32x32x16_bf16 v[64:79], v[140:143], a[216:219], v[64:79]
    v_mfma_f32_32x32x16_bf16 v[80:95], v[140:143], a[220:223], v[80:95]
    buffer_load_dwordx4 v[124:127], v12, s[24:27], s88 offen offset:3072 sc1
    s_waitcnt vmcnt(11)
    s_waitcnt lgkmcnt(12)
    v_mfma_f32_32x32x16_bf16 v[32:47], a[224:227], v[144:147], 0
    v_mfma_f32_32x32x16_bf16 v[64:79], a[228:231], v[144:147], v[64:79]
    s_add_u32 s88, s88, 4096
    buffer_load_dwordx4 v[128:131], v12, s[24:27], s88 offen offset:0 sc1
    s_waitcnt vmcnt(11)
    v_mfma_f32_32x32x16_bf16 v[48:63], a[224:227], v[148:151], 0
    v_mfma_f32_32x32x16_bf16 v[80:95], a[228:231], v[148:151], v[80:95]
    buffer_load_dwordx4 v[132:135], v12, s[24:27], s88 offen offset:1024 sc1
    ds_read_b64_tr_b16 a[224:225], v2 offset:8192
    ds_read_b64_tr_b16 a[226:227], v2 offset:8704
    ds_read_b64_tr_b16 a[228:229], v2 offset:8448
    ds_read_b64_tr_b16 a[230:231], v2 offset:8960
    s_waitcnt vmcnt(11)
    s_waitcnt lgkmcnt(12)
    v_mfma_f32_32x32x16_bf16 v[32:47], a[232:235], v[152:155], v[32:47]
    v_mfma_f32_32x32x16_bf16 v[64:79], a[236:239], v[152:155], v[64:79]
    buffer_load_dwordx4 v[136:139], v12, s[24:27], s88 offen offset:2048 sc1
    s_waitcnt vmcnt(11)
    v_mfma_f32_32x32x16_bf16 v[48:63], a[232:235], v[156:159], v[48:63]
    v_mfma_f32_32x32x16_bf16 v[80:95], a[236:239], v[156:159], v[80:95]
    buffer_load_dwordx4 v[140:143], v12, s[24:27], s88 offen offset:3072 sc1
    ds_read_b64_tr_b16 a[232:233], v2 offset:16384
    ds_read_b64_tr_b16 a[234:235], v2 offset:16896
    ds_read_b64_tr_b16 a[236:237], v2 offset:16640
    ds_read_b64_tr_b16 a[238:239], v2 offset:17152
    s_waitcnt vmcnt(11)
    s_waitcnt lgkmcnt(12)
    v_mfma_f32_32x32x16_bf16 v[32:47], a[240:243], v[96:99], v[32:47]
    v_mfma_f32_32x32x16_bf16 v[64:79], a[244:247], v[96:99], v[64:79]
    s_add_u32 s58, s61, 0
    buffer_load_dwordx4 v[144:147], v15, s[24:27], s58 offen offset:0 sc1
    s_waitcnt vmcnt(11)
    v_mfma_f32_32x32x16_bf16 v[48:63], a[240:243], v[100:103], v[48:63]
    v_mfma_f32_32x32x16_bf16 v[80:95], a[244:247], v[100:103], v[80:95]
    buffer_load_dwordx4 v[148:151], v15, s[24:27], s58 offen offset:2048 sc1
    ds_read_b64_tr_b16 a[240:241], v2 offset:24576
    ds_read_b64_tr_b16 a[242:243], v2 offset:25088
    ds_read_b64_tr_b16 a[244:245], v2 offset:24832
    ds_read_b64_tr_b16 a[246:247], v2 offset:25344
    s_waitcnt vmcnt(11)
    s_waitcnt lgkmcnt(12)
    v_mfma_f32_32x32x16_bf16 v[32:47], a[248:251], v[104:107], v[32:47]
    v_mfma_f32_32x32x16_bf16 v[64:79], a[252:255], v[104:107], v[64:79]
    s_add_u32 s58, s61, 4096
    buffer_load_dwordx4 v[152:155], v15, s[24:27], s58 offen offset:0 sc1
    s_waitcnt vmcnt(11)
    v_mfma_f32_32x32x16_bf16 v[48:63], a[248:251], v[108:111], v[48:63]
    v_mfma_f32_32x32x16_bf16 v[80:95], a[252:255], v[108:111], v[80:95]
    buffer_load_dwordx4 v[156:159], v15, s[24:27], s58 offen offset:2048 sc1
    ds_read_b64_tr_b16 a[248:249], v2 offset:32768
    ds_read_b64_tr_b16 a[250:251], v2 offset:33280
    ds_read_b64_tr_b16 a[252:253], v2 offset:33024
    ds_read_b64_tr_b16 a[254:255], v2 offset:33536
    s_waitcnt vmcnt(11)
    s_waitcnt lgkmcnt(12)
    v_mfma_f32_32x32x16_bf16 v[32:47], a[224:227], v[112:115], v[32:47]
    v_mfma_f32_32x32x16_bf16 v[64:79], a[228:231], v[112:115], v[64:79]
    s_add_u32 s58, s61, 8192
    buffer_load_dwordx4 v[96:99], v15, s[24:27], s58 offen offset:0 sc1
    s_waitcnt vmcnt(11)
    v_mfma_f32_32x32x16_bf16 v[48:63], a[224:227], v[116:119], v[48:63]
    v_mfma_f32_32x32x16_bf16 v[80:95], a[228:231], v[116:119], v[80:95]
    buffer_load_dwordx4 v[100:103], v15, s[24:27], s58 offen offset:2048 sc1
    s_waitcnt vmcnt(11)
    s_waitcnt lgkmcnt(8)
    v_mfma_f32_32x32x16_bf16 v[32:47], a[232:235], v[120:123], v[32:47]
    v_mfma_f32_32x32x16_bf16 v[64:79], a[236:239], v[120:123], v[64:79]
    s_add_u32 s58, s61, 12288
    buffer_load_dwordx4 v[104:107], v15, s[24:27], s58 offen offset:0 sc1
    s_waitcnt vmcnt(11)
    v_mfma_f32_32x32x16_bf16 v[48:63], a[232:235], v[124:127], v[48:63]
    v_mfma_f32_32x32x16_bf16 v[80:95], a[236:239], v[124:127], v[80:95]
    buffer_load_dwordx4 v[108:111], v15, s[24:27], s58 offen offset:2048 sc1
    s_waitcnt vmcnt(11)
    s_waitcnt lgkmcnt(4)
    v_mfma_f32_32x32x16_bf16 v[32:47], a[240:243], v[128:131], v[32:47]
    v_mfma_f32_32x32x16_bf16 v[64:79], a[244:247], v[128:131], v[64:79]
    s_add_u32 s58, s61, 16384
    buffer_load_dwordx4 v[112:115], v15, s[24:27], s58 offen offset:0 sc1
    s_waitcnt vmcnt(11)
    v_mfma_f32_32x32x16_bf16 v[48:63], a[240:243], v[132:135], v[48:63]
    v_mfma_f32_32x32x16_bf16 v[80:95], a[244:247], v[132:135], v[80:95]
    buffer_load_dwordx4 v[116:119], v15, s[24:27], s58 offen offset:2048 sc1
    s_waitcnt vmcnt(11)
    s_waitcnt lgkmcnt(0)
    v_mfma_f32_32x32x16_bf16 v[32:47], a[248:251], v[136:139], v[32:47]
    v_mfma_f32_32x32x16_bf16 v[64:79], a[252:255], v[136:139], v[64:79]
    s_add_u32 s58, s61, 20480
    buffer_load_dwordx4 v[120:123], v15, s[24:27], s58 offen offset:0 sc1
    s_waitcnt vmcnt(11)
    v_mfma_f32_32x32x16_bf16 v[48:63], a[248:251], v[140:143], v[48:63]
    v_mfma_f32_32x32x16_bf16 v[80:95], a[252:255], v[140:143], v[80:95]
    buffer_load_dwordx4 v[124:127], v15, s[24:27], s58 offen offset:2048 sc1
    s_waitcnt vmcnt(11)
    v_mfma_f32_32x32x16_bf16 v[32:47], v[144:147], a[0:3], v[32:47]
    v_mfma_f32_32x32x16_bf16 v[48:63], v[144:147], a[4:7], v[48:63]
    s_add_u32 s58, s61, 24576
    buffer_load_dwordx4 v[128:131], v15, s[24:27], s58 offen offset:0 sc1
    s_waitcnt vmcnt(11)
    v_mfma_f32_32x32x16_bf16 v[32:47], v[148:151], a[8:11], v[32:47]
    v_mfma_f32_32x32x16_bf16 v[48:63], v[148:151], a[12:15], v[48:63]
    buffer_load_dwordx4 v[132:135], v15, s[24:27], s58 offen offset:2048 sc1
    s_waitcnt vmcnt(11)
    v_mfma_f32_32x32x16_bf16 v[32:47], v[152:155], a[16:19], v[32:47]
    v_mfma_f32_32x32x16_bf16 v[48:63], v[152:155], a[20:23], v[48:63]
    s_add_u32 s58, s61, 28672
    buffer_load_dwordx4 v[136:139], v15, s[24:27], s58 offen offset:0 sc1
    s_waitcnt vmcnt(11)
    v_mfma_f32_32x32x16_bf16 v[32:47], v[156:159], a[24:27], v[32:47]
    v_mfma_f32_32x32x16_bf16 v[48:63], v[156:159], a[28:31], v[48:63]
    buffer_load_dwordx4 v[140:143], v15, s[24:27], s58 offen offset:2048 sc1
    s_waitcnt vmcnt(11)
    v_mfma_f32_32x32x16_bf16 v[32:47], v[96:99], a[32:35], v[32:47]
    v_mfma_f32_32x32x16_bf16 v[48:63], v[96:99], a[36:39], v[48:63]
    s_add_u32 s58, s61, 32768
    buffer_load_dwordx4 v[144:147], v15, s[24:27], s58 offen offset:0 sc1
    ds_write_b128 v224, v[64:67] offset:0
    s_waitcnt vmcnt(11)
    v_mfma_f32_32x32x16_bf16 v[32:47], v[100:103], a[40:43], v[32:47]
    v_mfma_f32_32x32x16_bf16 v[48:63], v[100:103], a[44:47], v[48:63]
    buffer_load_dwordx4 v[148:151], v15, s[24:27], s58 offen offset:2048 sc1
    ds_write_b128 v225, v[68:71] offset:0
    s_waitcnt vmcnt(11)
    v_mfma_f32_32x32x16_bf16 v[32:47], v[104:107], a[48:51], v[32:47]
    v_mfma_f32_32x32x16_bf16 v[48:63], v[104:107], a[52:55], v[48:63]
    s_add_u32 s58, s61, 36864
    buffer_load_dwordx4 v[152:155], v15, s[24:27], s58 offen offset:0 sc1
    ds_write_b128 v226, v[72:75] offset:0
    s_waitcnt vmcnt(11)
    v_mfma_f32_32x32x16_bf16 v[32:47], v[108:111], a[56:59], v[32:47]
    v_mfma_f32_32x32x16_bf16 v[48:63], v[108:111], a[60:63], v[48:63]
    buffer_load_dwordx4 v[156:159], v15, s[24:27], s58 offen offset:2048 sc1
    ds_write_b128 v227, v[76:79] offset:0
    s_waitcnt vmcnt(11)
    v_mfma_f32_32x32x16_bf16 v[32:47], v[112:115], a[64:67], v[32:47]
    v_mfma_f32_32x32x16_bf16 v[48:63], v[112:115], a[68:71], v[48:63]
    s_add_u32 s58, s61, 40960
    buffer_load_dwordx4 v[96:99], v15, s[24:27], s58 offen offset:0 sc1
    ds_write_b128 v224, v[80:83] offset:32768
    s_waitcnt vmcnt(11)
    v_mfma_f32_32x32x16_bf16 v[32:47], v[116:119], a[72:75], v[32:47]
    v_mfma_f32_32x32x16_bf16 v[48:63], v[116:119], a[76:79], v[48:63]
    buffer_load_dwordx4 v[100:103], v15, s[24:27], s58 offen offset:2048 sc1
    ds_write_b128 v225, v[84:87] offset:32768
    s_waitcnt vmcnt(11)
    v_mfma_f32_32x32x16_bf16 v[32:47], v[120:123], a[80:83], v[32:47]
    v_mfma_f32_32x32x16_bf16 v[48:63], v[120:123], a[84:87], v[48:63]
    s_add_u32 s58, s61, 45056
    buffer_load_dwordx4 v[104:107], v15, s[24:27], s58 offen offset:0 sc1
    ds_write_b128 v226, v[88:91] offset:32768
    s_waitcnt vmcnt(11)
    v_mfma_f32_32x32x16_bf16 v[32:47], v[124:127], a[88:91], v[32:47]
    v_mfma_f32_32x32x16_bf16 v[48:63], v[124:127], a[92:95], v[48:63]
    buffer_load_dwordx4 v[108:111], v15, s[24:27], s58 offen offset:2048 sc1
    ds_write_b128 v227, v[92:95] offset:32768
    s_waitcnt vmcnt(11)
    v_mfma_f32_32x32x16_bf16 v[32:47], v[128:131], a[96:99], v[32:47]
    v_mfma_f32_32x32x16_bf16 v[48:63], v[128:131], a[100:103], v[48:63]
    s_add_u32 s58, s61, 49152
    buffer_load_dwordx4 v[112:115], v15, s[24:27], s58 offen offset:0 sc1
    s_waitcnt vmcnt(11)
    v_mfma_f32_32x32x16_bf16 v[32:47], v[132:135], a[104:107], v[32:47]
    v_mfma_f32_32x32x16_bf16 v[48:63], v[132:135], a[108:111], v[48:63]
    buffer_load_dwordx4 v[116:119], v15, s[24:27], s58 offen offset:2048 sc1
    s_waitcnt vmcnt(11)
    v_mfma_f32_32x32x16_bf16 v[32:47], v[136:139], a[112:115], v[32:47]
    v_mfma_f32_32x32x16_bf16 v[48:63], v[136:139], a[116:119], v[48:63]
    s_add_u32 s58, s61, 53248
    buffer_load_dwordx4 v[120:123], v15, s[24:27], s58 offen offset:0 sc1
    s_waitcnt vmcnt(11)
    v_mfma_f32_32x32x16_bf16 v[32:47], v[140:143], a[120:123], v[32:47]
    v_mfma_f32_32x32x16_bf16 v[48:63], v[140:143], a[124:127], v[48:63]
    buffer_load_dwordx4 v[124:127], v15, s[24:27], s58 offen offset:2048 sc1
    s_waitcnt vmcnt(11)
    v_mfma_f32_32x32x16_bf16 v[32:47], v[144:147], a[128:131], v[32:47]
    v_mfma_f32_32x32x16_bf16 v[48:63], v[144:147], a[132:135], v[48:63]
    s_waitcnt vmcnt(10)
    v_mfma_f32_32x32x16_bf16 v[32:47], v[148:151], a[136:139], v[32:47]
    v_mfma_f32_32x32x16_bf16 v[48:63], v[148:151], a[140:143], v[48:63]
    s_waitcnt vmcnt(9)
    v_mfma_f32_32x32x16_bf16 v[32:47], v[152:155], a[144:147], v[32:47]
    v_mfma_f32_32x32x16_bf16 v[48:63], v[152:155], a[148:151], v[48:63]
    s_waitcnt vmcnt(8)
    v_mfma_f32_32x32x16_bf16 v[32:47], v[156:159], a[152:155], v[32:47]
    v_mfma_f32_32x32x16_bf16 v[48:63], v[156:159], a[156:159], v[48:63]
    s_waitcnt vmcnt(7)
    v_mfma_f32_32x32x16_bf16 v[32:47], v[96:99], a[160:163], v[32:47]
    v_mfma_f32_32x32x16_bf16 v[48:63], v[96:99], a[164:167], v[48:63]
    s_waitcnt vmcnt(6)
    v_mfma_f32_32x32x16_bf16 v[32:47], v[100:103], a[168:171], v[32:47]
    v_mfma_f32_32x32x16_bf16 v[48:63], v[100:103], a[172:175], v[48:63]
    s_waitcnt vmcnt(5)
    v_mfma_f32_32x32x16_bf16 v[32:47], v[104:107], a[176:179], v[32:47]
    v_mfma_f32_32x32x16_bf16 v[48:63], v[104:107], a[180:183], v[48:63]
    s_waitcnt vmcnt(4)
    v_mfma_f32_32x32x16_bf16 v[32:47], v[108:111], a[184:187], v[32:47]
    v_mfma_f32_32x32x16_bf16 v[48:63], v[108:111], a[188:191], v[48:63]
    s_waitcnt vmcnt(3)
    v_mfma_f32_32x32x16_bf16 v[32:47], v[112:115], a[192:195], v[32:47]
    v_mfma_f32_32x32x16_bf16 v[48:63], v[112:115], a[196:199], v[48:63]
    s_waitcnt vmcnt(2)
    v_mfma_f32_32x32x16_bf16 v[32:47], v[116:119], a[200:203], v[32:47]
    v_mfma_f32_32x32x16_bf16 v[48:63], v[116:119], a[204:207], v[48:63]
    s_waitcnt vmcnt(1)
    v_mfma_f32_32x32x16_bf16 v[32:47], v[120:123], a[208:211], v[32:47]
    v_mfma_f32_32x32x16_bf16 v[48:63], v[120:123], a[212:215], v[48:63]
    s_waitcnt vmcnt(0)
    v_mfma_f32_32x32x16_bf16 v[32:47], v[124:127], a[216:219], v[32:47]
    v_mfma_f32_32x32x16_bf16 v[48:63], v[124:127], a[220:223], v[48:63]
    s_nop 10
    ds_write_b128 v220, v[32:35] offset:0
    ds_write_b128 v221, v[36:39] offset:0
    ds_write_b128 v222, v[40:43] offset:0
    ds_write_b128 v223, v[44:47] offset:0
    ds_write_b128 v220, v[48:51] offset:32768
    ds_write_b128 v221, v[52:55] offset:32768
    ds_write_b128 v222, v[56:59] offset:32768
    ds_write_b128 v223, v[60:63] offset:32768
    s_waitcnt lgkmcnt(0)
    s_barrier
    ds_read_b128 v[96:99], v228 offset:0
    ds_read_b128 v[100:103], v228 offset:2048
    ds_read_b128 v[104:107], v228 offset:4096
    ds_read_b128 v[108:111], v228 offset:6144
    ds_read_b128 v[112:115], v229 offset:0
    ds_read_b128 v[116:119], v229 offset:2048
    ds_read_b128 v[120:123], v229 offset:4096
    ds_read_b128 v[124:127], v229 offset:6144
    ds_read_b128 v[128:131], v228 offset:32768
    ds_read_b128 v[132:135], v228 offset:34816
    ds_read_b128 v[136:139], v228 offset:36864
    ds_read_b128 v[140:143], v228 offset:38912
    ds_read_b128 v[144:147], v229 offset:32768
    ds_read_b128 v[148:151], v229 offset:34816
    ds_read_b128 v[152:155], v229 offset:36864
    ds_read_b128 v[156:159], v229 offset:38912
    s_waitcnt lgkmcnt(12)
    v_pk_add_f32 v[96:97], v[96:97], v[100:101]
    v_pk_add_f32 v[104:105], v[104:105], v[108:109]
    v_pk_add_f32 v[98:99], v[98:99], v[102:103]
    v_pk_add_f32 v[106:107], v[106:107], v[110:111]
    v_pk_add_f32 v[232:233], v[232:233], v[96:97]
    v_pk_add_f32 v[234:235], v[234:235], v[98:99]
    v_pk_add_f32 v[232:233], v[232:233], v[104:105]
    v_pk_add_f32 v[234:235], v[234:235], v[106:107]
    v_cvt_pk_bf16_f32 v248, v232, v233
    v_cvt_pk_bf16_f32 v249, v234, v235
    s_waitcnt lgkmcnt(8)
    v_pk_add_f32 v[112:113], v[112:113], v[116:117]
    v_pk_add_f32 v[120:121], v[120:121], v[124:125]
    v_pk_add_f32 v[114:115], v[114:115], v[118:119]
    v_pk_add_f32 v[122:123], v[122:123], v[126:127]
    v_pk_add_f32 v[236:237], v[236:237], v[112:113]
    v_pk_add_f32 v[238:239], v[238:239], v[114:115]
    v_pk_add_f32 v[236:237], v[236:237], v[120:121]
    v_pk_add_f32 v[238:239], v[238:239], v[122:123]
    v_cvt_pk_bf16_f32 v250, v236, v237
    v_cvt_pk_bf16_f32 v251, v238, v239
    buffer_store_dwordx4 v[248:251], v205, s[28:31], s89 offen
    s_waitcnt lgkmcnt(4)
    v_pk_add_f32 v[128:129], v[128:129], v[132:133]
    v_pk_add_f32 v[136:137], v[136:137], v[140:141]
    v_pk_add_f32 v[130:131], v[130:131], v[134:135]
    v_pk_add_f32 v[138:139], v[138:139], v[142:143]
    v_pk_add_f32 v[240:241], v[240:241], v[128:129]
    v_pk_add_f32 v[242:243], v[242:243], v[130:131]
    v_pk_add_f32 v[240:241], v[240:241], v[136:137]
    v_pk_add_f32 v[242:243], v[242:243], v[138:139]
    v_cvt_pk_bf16_f32 v252, v240, v241
    v_cvt_pk_bf16_f32 v253, v242, v243
    s_waitcnt lgkmcnt(0)
    v_pk_add_f32 v[144:145], v[144:145], v[148:149]
    v_pk_add_f32 v[152:153], v[152:153], v[156:157]
    v_pk_add_f32 v[146:147], v[146:147], v[150:151]
    v_pk_add_f32 v[154:155], v[154:155], v[158:159]
    v_pk_add_f32 v[244:245], v[244:245], v[144:145]
    v_pk_add_f32 v[246:247], v[246:247], v[146:147]
    v_pk_add_f32 v[244:245], v[244:245], v[152:153]
    v_pk_add_f32 v[246:247], v[246:247], v[154:155]
    v_cvt_pk_bf16_f32 v254, v244, v245
    v_cvt_pk_bf16_f32 v255, v246, v247
    buffer_store_dwordx4 v[252:255], v205, s[28:31], s90 offen
    s_endpgm
L_helper:
    s_mov_b64 s[8:9], s[78:79]
    s_mov_b32 s10, 1204224
    s_mov_b32 s11, s7
    s_mov_b32 s26, 16777216
    s_mov_b32 s27, s7
    s_mov_b64 s[40:41], s[94:95]
    s_mov_b32 s42, 256
    s_mov_b32 s43, s7
    s_mov_b64 s[16:17], s[84:85]
    s_mov_b32 s18, 7340032
    s_mov_b32 s19, s7
    s_mov_b64 s[20:21], s[88:89]
    s_mov_b32 s22, 7340032
    s_mov_b32 s23, s7
    s_mov_b64 s[12:13], s[80:81]
    s_mov_b32 s14, 401408
    s_mov_b32 s15, s7
    s_mov_b64 s[28:29], s[92:93]
    s_mov_b32 s30, 1835008
    s_mov_b32 s31, s7
    s_mov_b64 s[32:33], s[86:87]
    s_mov_b32 s34, 3584
    s_mov_b32 s35, s7
    s_mov_b64 s[36:37], s[90:91]
    s_mov_b32 s38, 4096
    s_mov_b32 s39, s7
    s_lshl_b32 s52, s44, 11
    v_lshlrev_b32 v12, 4, v1
    s_sub_u32 s66, s46, 28
    s_lshl_b32 s66, s66, 2
    s_add_u32 s66, s66, s44
    s_or_b32 s53, s45, s66
    s_cmp_lg_u32 s53, 0
    s_cbranch_scc1 L_nononce
    s_memrealtime s[98:99]
    s_waitcnt lgkmcnt(0)
    s_or_b32 s98, s98, 1
    v_mov_b32 v19, s98
    s_mov_b64 exec, 1
    buffer_store_dword v19, off, s[40:43], 0 sc1
    s_mov_b64 exec, -1
L_nononce:
    v_lshrrev_b32 v17, 2, v1
    v_mul_u32_u24 v17, 3584, v17
    v_and_b32 v19, 3, v1
    v_lshl_add_u32 v17, v19, 7, v17
    s_lshr_b32 s54, s66, 2
    s_lshl_b32 s54, s54, 5
    s_add_u32 s54, s54, s44
    s_mul_i32 s54, s54, 57344
    s_mul_i32 s56, s45, 7
    s_lshr_b32 s56, s56, 1
    s_lshl_b32 s56, s56, 7
    s_add_u32 s54, s54, s56
    buffer_load_dword v20, v17, s[16:19], s54 offen
    s_add_u32 s54, s54, 229376
    buffer_load_dword v21, v17, s[16:19], s54 offen
    s_add_u32 s54, s54, 229376
    buffer_load_dword v22, v17, s[16:19], s54 offen
    s_add_u32 s54, s54, 229376
    buffer_load_dword v23, v17, s[16:19], s54 offen
    s_add_u32 s54, s54, 229376
    v_lshrrev_b32 v17, 2, v1
    v_lshlrev_b32 v17, 12, v17
    v_and_b32 v19, 3, v1
    v_lshl_add_u32 v17, v19, 7, v17
    s_lshr_b32 s54, s66, 2
    s_mul_i32 s54, s54, 28
    s_add_u32 s54, s54, s44
    s_lshl_b32 s54, s54, 16
    s_lshl_b32 s56, s45, 9
    s_add_u32 s54, s54, s56
    buffer_load_dword v240, v17, s[20:23], s54 offen
    s_add_u32 s54, s54, 262144
    buffer_load_dword v241, v17, s[20:23], s54 offen
    s_add_u32 s54, s54, 262144
    buffer_load_dword v242, v17, s[20:23], s54 offen
    s_add_u32 s54, s54, 262144
    buffer_load_dword v243, v17, s[20:23], s54 offen
    s_add_u32 s54, s54, 262144
    buffer_load_dword v29, off, s[40:43], 0 sc1
    v_and_b32 v17, 15, v1
    v_lshrrev_b32 v18, 4, v1
    v_lshrrev_b32 v11, 3, v1
    v_min_u32 v11, 4, v11
    s_lshl_b32 s53, s45, 2
    s_sub_u32 s53, s53, 1
    v_add_u32 v11, s53, v11
    v_max_i32 v11, 0, v11
    v_and_b32 v13, 7, v1
    v_min_u32 v13, 6, v13
    v_lshl_add_u32 v11, v11, 3, v13
    v_lshlrev_b32 v11, 7, v11
    v_add_u32 v11, 12648448, v11
    v_lshlrev_b32 v2, 15, v18
    v_lshl_add_u32 v2, v17, 4, v2
    v_lshrrev_b32 v13, 1, v18
    v_lshlrev_b32 v3, 11, v13
    v_and_b32 v13, 1, v18
    v_lshl_add_u32 v3, v13, 9, v3
    v_lshl_add_u32 v3, v17, 4, v3
    v_add_u32 v4, s52, v12
    v_and_b32 v13, 3, v1
    v_lshlrev_b32 v5, 8, v13
    v_lshrrev_b32 v13, 2, v1
    v_lshl_add_u32 v5, v13, 4, v5
    v_add_u32 v5, s52, v5
    v_and_b32 v13, 1, v17
    v_cmp_eq_u32 s[76:77], 1, v13
    v_lshl_add_u32 v13, v18, 2, v13
    v_cmp_le_u32 s[78:79], v13, v17
    v_add_u32 v13, 2, v13
    v_cmp_le_u32 s[80:81], v13, v17
    v_mov_b32 v13, 0xffff
    v_mov_b32 v14, 0xffff0000
    v_cndmask_b32 v13, v13, v14, s[76:77]
    v_cndmask_b32 v6, v13, 0, s[78:79]
    v_cndmask_b32 v7, v13, 0, s[80:81]
    v_cndmask_b32 v8, 0, v13, s[78:79]
    v_cndmask_b32 v9, 0, v13, s[80:81]
    s_mov_b32 s95, 0x3e8b97f6
    v_mov_b32 v10, 0xf149f2ca
    s_bitcmp1_b32 s66, 0
    s_cselect_b32 s82, 0xffff, 0
    s_mov_b32 s83, 0
    s_mov_b32 s84, 0
    s_cselect_b32 s85, 0, 0xffff0000
    s_cmp_eq_u32 s45, 0
    s_cselect_b32 s56, 0, 256
    s_cselect_b64 s[86:87], -1, 0
    s_andn2_b64 s[88:89], s[86:87], s[80:81]
    s_andn2_b64 s[86:87], s[86:87], s[78:79]
    s_mul_i32 s91, s66, 7
    s_lshr_b32 s91, s91, 1
    s_lshl_b32 s91, s91, 15
    s_lshl_b32 s54, s45, 12
    s_add_u32 s91, s91, s54
    s_add_u32 s91, s91, 6291456
    s_add_u32 s92, s91, 1835008
    s_add_u32 s93, s91, 3670016
    s_lshl_b32 s94, s45, 18
    s_lshl_b32 s54, s66, 12
    s_add_u32 s94, s94, s54
    s_add_u32 s94, s94, 4194304
    s_waitcnt vmcnt(0)
    v_cmp_eq_u32 vcc, 0, v29
    s_nop 0
    s_cbranch_vccz L_ok13
    s_mov_b32 s59, 20000
L_spin12:
    buffer_load_dword v29, off, s[40:43], 0 sc1
    s_waitcnt vmcnt(0)
    v_cmp_eq_u32 vcc, 0, v29
    s_nop 0
    s_cbranch_vccz L_ok13
    s_sub_u32 s59, s59, 1
    s_cbranch_scc0 L_spin12
L_ok13:
    v_readfirstlane_b32 s47, v29
    buffer_load_dword v29, v11, s[24:27], 0 offen sc1
    s_waitcnt vmcnt(0)
    v_cmp_ne_u32 vcc, s47, v29
    s_nop 0
    s_cbranch_vccz L_ok15
    s_mov_b32 s59, 20000
L_spin14:
    buffer_load_dword v29, v11, s[24:27], 0 offen sc1
    s_waitcnt vmcnt(0)
    v_cmp_ne_u32 vcc, s47, v29
    s_nop 0
    s_cbranch_vccz L_ok15
    s_sub_u32 s59, s59, 1
    s_cbranch_scc0 L_spin14
L_ok15:
    s_sub_u32 s53, s92, s56
    s_sub_u32 s54, s93, s56
    buffer_load_dwordx4 v[192:195], v2, s[24:27], s53 offen sc1
    buffer_load_dwordx4 v[196:199], v2, s[24:27], s54 offen sc1
    buffer_load_dwordx4 v[96:99], v2, s[24:27], s91 offen offset:0 sc1
    buffer_load_dwordx4 v[100:103], v2, s[24:27], s91 offen offset:256 sc1
    buffer_load_dwordx4 v[104:107], v2, s[24:27], s92 offen offset:0 sc1
    buffer_load_dwordx4 v[108:111], v2, s[24:27], s92 offen offset:256 sc1
    buffer_load_dwordx4 v[112:115], v2, s[24:27], s93 offen offset:0 sc1
    buffer_load_dwordx4 v[116:119], v2, s[24:27], s93 offen offset:256 sc1
    buffer_load_dwordx4 v[120:123], v2, s[24:27], s91 offen offset:512 sc1
    buffer_load_dwordx4 v[124:127], v2, s[24:27], s91 offen offset:768 sc1
    buffer_load_dwordx4 v[128:131], v2, s[24:27], s92 offen offset:512 sc1
    buffer_load_dwordx4 v[132:135], v2, s[24:27], s92 offen offset:768 sc1
    buffer_load_dwordx4 v[136:139], v2, s[24:27], s93 offen offset:512 sc1
    buffer_load_dwordx4 v[140:143], v2, s[24:27], s93 offen offset:768 sc1
    s_waitcnt vmcnt(12)
    ds_write_b128 v4, v[196:199]
    ds_read_b64_tr_b16 v[52:53], v5 offset:0
    ds_read_b64_tr_b16 v[58:59], v5 offset:8
    s_mov_b32 s90, 0
    s_waitcnt vmcnt(6) lgkmcnt(0)
L_attn_loop:
    s_waitcnt vmcnt(8)
    v_mov_b32 v48, v52
    v_mov_b32 v49, v53
    v_mov_b32 v54, v58
    v_mov_b32 v55, v59
    ds_write_b128 v4, v[112:115] offset:0
    ds_write_b128 v4, v[116:119] offset:1024
    v_cndmask_b32 v96, v96, 0, s[82:83]
    v_cndmask_b32 v97, v97, 0, s[82:83]
    v_cndmask_b32 v98, v98, 0, s[84:85]
    v_cndmask_b32 v99, v99, 0, s[84:85]
    v_cndmask_b32 v100, v100, 0, s[82:83]
    v_cndmask_b32 v101, v101, 0, s[82:83]
    v_cndmask_b32 v102, v102, 0, s[84:85]
    v_cndmask_b32 v103, v103, 0, s[84:85]
    ds_read_b64_tr_b16 v[50:51], v5 offset:0
    ds_read_b64_tr_b16 v[52:53], v5 offset:1024
    ds_read_b64_tr_b16 v[56:57], v5 offset:8
    ds_read_b64_tr_b16 v[58:59], v5 offset:1032
    v_mfma_f32_16x16x32_bf16 v[32:35], v[192:195], v[96:99], 0
    v_mfma_f32_16x16x32_bf16 v[36:39], v[104:107], v[96:99], 0
    v_mfma_f32_16x16x32_bf16 v[40:43], v[104:107], v[100:103], 0
    v_mfma_f32_16x16x32_bf16 v[44:47], v[108:111], v[100:103], 0
    buffer_load_dwordx4 v[144:147], v2, s[24:27], s91 offen offset:1024 sc1
    buffer_load_dwordx4 v[148:151], v2, s[24:27], s91 offen offset:1280 sc1
    buffer_load_dwordx4 v[152:155], v2, s[24:27], s92 offen offset:1024 sc1
    buffer_load_dwordx4 v[156:159], v2, s[24:27], s92 offen offset:1280 sc1
    buffer_load_dwordx4 v[160:163], v2, s[24:27], s93 offen offset:1024 sc1
    buffer_load_dwordx4 v[164:167], v2, s[24:27], s93 offen offset:1280 sc1
    v_cndmask_b32 v200, v32, v33, s[76:77]
    v_cndmask_b32 v201, v34, v35, s[76:77]
    v_cndmask_b32 v202, v36, v37, s[76:77]
    v_cndmask_b32 v203, v38, v39, s[76:77]
    v_cndmask_b32 v200, v200, v202, s[78:79]
    v_cndmask_b32 v201, v201, v203, s[80:81]
    v_cndmask_b32 v208, v40, v41, s[76:77]
    v_cndmask_b32 v209, v42, v43, s[76:77]
    v_cndmask_b32 v210, v44, v45, s[76:77]
    v_cndmask_b32 v211, v46, v47, s[76:77]
    v_cndmask_b32 v208, v208, v210, s[78:79]
    v_cndmask_b32 v209, v209, v211, s[80:81]
    v_cndmask_b32 v200, v200, v10, s[86:87]
    v_cndmask_b32 v201, v201, v10, s[88:89]
    s_mov_b64 s[86:87], 0
    s_mov_b64 s[88:89], 0
    v_max_f32 v202, v200, v201
    v_max_f32 v210, v208, v209
    v_mov_b32 v203, v202
    v_mov_b32 v211, v210
    s_nop 0
    v_permlane16_swap_b32 v202, v203
    v_permlane16_swap_b32 v210, v211
    v_max_f32 v202, v202, v203
    v_max_f32 v210, v210, v211
    v_mov_b32 v203, v202
    v_mov_b32 v211, v210
    s_nop 0
    v_permlane32_swap_b32 v202, v203
    v_permlane32_swap_b32 v210, v211
    v_max_f32 v202, v202, v203
    v_max_f32 v210, v210, v211
    v_sub_f32 v200, v200, v202
    v_sub_f32 v201, v201, v202
    v_sub_f32 v208, v208, v210
    v_sub_f32 v209, v209, v210
    v_mul_f32 v200, s95, v200
    v_mul_f32 v201, s95, v201
    v_mul_f32 v208, s95, v208
    v_mul_f32 v209, s95, v209
    v_exp_f32 v200, v200
    v_exp_f32 v201, v201
    v_exp_f32 v208, v208
    v_exp_f32 v209, v209
    v_add_f32 v202, v200, v201
    v_add_f32 v210, v208, v209
    v_mov_b32 v203, v202
    v_mov_b32 v211, v210
    s_nop 0
    v_permlane16_swap_b32 v202, v203
    v_permlane16_swap_b32 v210, v211
    v_add_f32 v202, v202, v203
    v_add_f32 v210, v210, v211
    v_mov_b32 v203, v202
    v_mov_b32 v211, v210
    s_nop 0
    v_permlane32_swap_b32 v202, v203
    v_permlane32_swap_b32 v210, v211
    v_add_f32 v202, v202, v203
    v_add_f32 v210, v210, v211
    v_rcp_f32 v202, v202
    v_rcp_f32 v210, v210
    v_mul_f32 v200, v200, v202
    v_mul_f32 v201, v201, v202
    v_mul_f32 v208, v208, v210
    v_mul_f32 v209, v209, v210
    v_cvt_pk_bf16_f32 v200, v200, v200
    v_cvt_pk_bf16_f32 v201, v201, v201
    v_cvt_pk_bf16_f32 v208, v208, v208
    v_cvt_pk_bf16_f32 v209, v209, v209
    v_and_b32 v60, v200, v6
    v_and_b32 v61, v201, v7
    v_and_b32 v62, v200, v8
    v_and_b32 v63, v201, v9
    v_and_b32 v64, v208, v6
    v_and_b32 v65, v209, v7
    v_and_b32 v66, v208, v8
    v_and_b32 v67, v209, v9
    s_waitcnt lgkmcnt(0)
    v_mfma_f32_16x16x32_bf16 v[68:71], v[48:51], v[60:63], 0
    v_mfma_f32_16x16x32_bf16 v[72:75], v[54:57], v[60:63], 0
    v_mfma_f32_16x16x32_bf16 v[76:79], v[50:53], v[64:67], 0
    v_mfma_f32_16x16x32_bf16 v[80:83], v[56:59], v[64:67], 0
    s_nop 4
    v_cvt_pk_bf16_f32 v84, v68, v69
    v_cvt_pk_bf16_f32 v85, v70, v71
    v_cvt_pk_bf16_f32 v86, v72, v73
    v_cvt_pk_bf16_f32 v87, v74, v75
    v_cndmask_b32 v84, v84, 0, s[82:83]
    v_cndmask_b32 v85, v85, 0, s[82:83]
    v_cndmask_b32 v86, v86, 0, s[84:85]
    v_cndmask_b32 v87, v87, 0, s[84:85]
    buffer_store_dwordx4 v[84:87], v3, s[24:27], s94 offen offset:0 sc1
    v_cvt_pk_bf16_f32 v88, v76, v77
    v_cvt_pk_bf16_f32 v89, v78, v79
    v_cvt_pk_bf16_f32 v90, v80, v81
    v_cvt_pk_bf16_f32 v91, v82, v83
    v_cndmask_b32 v88, v88, 0, s[82:83]
    v_cndmask_b32 v89, v89, 0, s[82:83]
    v_cndmask_b32 v90, v90, 0, s[84:85]
    v_cndmask_b32 v91, v91, 0, s[84:85]
    buffer_store_dwordx4 v[88:91], v3, s[24:27], s94 offen offset:256 sc1
    s_waitcnt vmcnt(8)
    v_mov_b32 v48, v52
    v_mov_b32 v49, v53
    v_mov_b32 v54, v58
    v_mov_b32 v55, v59
    ds_write_b128 v4, v[136:139] offset:0
    ds_write_b128 v4, v[140:143] offset:1024
    v_cndmask_b32 v120, v120, 0, s[82:83]
    v_cndmask_b32 v121, v121, 0, s[82:83]
    v_cndmask_b32 v122, v122, 0, s[84:85]
    v_cndmask_b32 v123, v123, 0, s[84:85]
    v_cndmask_b32 v124, v124, 0, s[82:83]
    v_cndmask_b32 v125, v125, 0, s[82:83]
    v_cndmask_b32 v126, v126, 0, s[84:85]
    v_cndmask_b32 v127, v127, 0, s[84:85]
    ds_read_b64_tr_b16 v[50:51], v5 offset:0
    ds_read_b64_tr_b16 v[52:53], v5 offset:1024
    ds_read_b64_tr_b16 v[56:57], v5 offset:8
    ds_read_b64_tr_b16 v[58:59], v5 offset:1032
    v_mfma_f32_16x16x32_bf16 v[32:35], v[108:111], v[120:123], 0
    v_mfma_f32_16x16x32_bf16 v[36:39], v[128:131], v[120:123], 0
    v_mfma_f32_16x16x32_bf16 v[40:43], v[128:131], v[124:127], 0
    v_mfma_f32_16x16x32_bf16 v[44:47], v[132:135], v[124:127], 0
    buffer_load_dwordx4 v[168:171], v2, s[24:27], s91 offen offset:1536 sc1
    buffer_load_dwordx4 v[172:175], v2, s[24:27], s91 offen offset:1792 sc1
    buffer_load_dwordx4 v[176:179], v2, s[24:27], s92 offen offset:1536 sc1
    buffer_load_dwordx4 v[180:183], v2, s[24:27], s92 offen offset:1792 sc1
    buffer_load_dwordx4 v[184:187], v2, s[24:27], s93 offen offset:1536 sc1
    buffer_load_dwordx4 v[188:191], v2, s[24:27], s93 offen offset:1792 sc1
    v_cndmask_b32 v200, v32, v33, s[76:77]
    v_cndmask_b32 v201, v34, v35, s[76:77]
    v_cndmask_b32 v202, v36, v37, s[76:77]
    v_cndmask_b32 v203, v38, v39, s[76:77]
    v_cndmask_b32 v200, v200, v202, s[78:79]
    v_cndmask_b32 v201, v201, v203, s[80:81]
    v_cndmask_b32 v208, v40, v41, s[76:77]
    v_cndmask_b32 v209, v42, v43, s[76:77]
    v_cndmask_b32 v210, v44, v45, s[76:77]
    v_cndmask_b32 v211, v46, v47, s[76:77]
    v_cndmask_b32 v208, v208, v210, s[78:79]
    v_cndmask_b32 v209, v209, v211, s[80:81]
    v_max_f32 v202, v200, v201
    v_max_f32 v210, v208, v209
    v_mov_b32 v203, v202
    v_mov_b32 v211, v210
    s_nop 0
    v_permlane16_swap_b32 v202, v203
    v_permlane16_swap_b32 v210, v211
    v_max_f32 v202, v202, v203
    v_max_f32 v210, v210, v211
    v_mov_b32 v203, v202
    v_mov_b32 v211, v210
    s_nop 0
    v_permlane32_swap_b32 v202, v203
    v_permlane32_swap_b32 v210, v211
    v_max_f32 v202, v202, v203
    v_max_f32 v210, v210, v211
    v_sub_f32 v200, v200, v202
    v_sub_f32 v201, v201, v202
    v_sub_f32 v208, v208, v210
    v_sub_f32 v209, v209, v210
    v_mul_f32 v200, s95, v200
    v_mul_f32 v201, s95, v201
    v_mul_f32 v208, s95, v208
    v_mul_f32 v209, s95, v209
    v_exp_f32 v200, v200
    v_exp_f32 v201, v201
    v_exp_f32 v208, v208
    v_exp_f32 v209, v209
    v_add_f32 v202, v200, v201
    v_add_f32 v210, v208, v209
    v_mov_b32 v203, v202
    v_mov_b32 v211, v210
    s_nop 0
    v_permlane16_swap_b32 v202, v203
    v_permlane16_swap_b32 v210, v211
    v_add_f32 v202, v202, v203
    v_add_f32 v210, v210, v211
    v_mov_b32 v203, v202
    v_mov_b32 v211, v210
    s_nop 0
    v_permlane32_swap_b32 v202, v203
    v_permlane32_swap_b32 v210, v211
    v_add_f32 v202, v202, v203
    v_add_f32 v210, v210, v211
    v_rcp_f32 v202, v202
    v_rcp_f32 v210, v210
    v_mul_f32 v200, v200, v202
    v_mul_f32 v201, v201, v202
    v_mul_f32 v208, v208, v210
    v_mul_f32 v209, v209, v210
    v_cvt_pk_bf16_f32 v200, v200, v200
    v_cvt_pk_bf16_f32 v201, v201, v201
    v_cvt_pk_bf16_f32 v208, v208, v208
    v_cvt_pk_bf16_f32 v209, v209, v209
    v_and_b32 v60, v200, v6
    v_and_b32 v61, v201, v7
    v_and_b32 v62, v200, v8
    v_and_b32 v63, v201, v9
    v_and_b32 v64, v208, v6
    v_and_b32 v65, v209, v7
    v_and_b32 v66, v208, v8
    v_and_b32 v67, v209, v9
    s_waitcnt lgkmcnt(0)
    v_mfma_f32_16x16x32_bf16 v[68:71], v[48:51], v[60:63], 0
    v_mfma_f32_16x16x32_bf16 v[72:75], v[54:57], v[60:63], 0
    v_mfma_f32_16x16x32_bf16 v[76:79], v[50:53], v[64:67], 0
    v_mfma_f32_16x16x32_bf16 v[80:83], v[56:59], v[64:67], 0
    s_nop 4
    v_cvt_pk_bf16_f32 v84, v68, v69
    v_cvt_pk_bf16_f32 v85, v70, v71
    v_cvt_pk_bf16_f32 v86, v72, v73
    v_cvt_pk_bf16_f32 v87, v74, v75
    v_cndmask_b32 v84, v84, 0, s[82:83]
    v_cndmask_b32 v85, v85, 0, s[82:83]
    v_cndmask_b32 v86, v86, 0, s[84:85]
    v_cndmask_b32 v87, v87, 0, s[84:85]
    buffer_store_dwordx4 v[84:87], v3, s[24:27], s94 offen offset:1024 sc1
    v_cvt_pk_bf16_f32 v88, v76, v77
    v_cvt_pk_bf16_f32 v89, v78, v79
    v_cvt_pk_bf16_f32 v90, v80, v81
    v_cvt_pk_bf16_f32 v91, v82, v83
    v_cndmask_b32 v88, v88, 0, s[82:83]
    v_cndmask_b32 v89, v89, 0, s[82:83]
    v_cndmask_b32 v90, v90, 0, s[84:85]
    v_cndmask_b32 v91, v91, 0, s[84:85]
    buffer_store_dwordx4 v[88:91], v3, s[24:27], s94 offen offset:1280 sc1
    s_add_u32 s94, s94, 65536
    s_waitcnt vmcnt(8)
    v_mov_b32 v48, v52
    v_mov_b32 v49, v53
    v_mov_b32 v54, v58
    v_mov_b32 v55, v59
    ds_write_b128 v4, v[160:163] offset:0
    ds_write_b128 v4, v[164:167] offset:1024
    v_cndmask_b32 v144, v144, 0, s[82:83]
    v_cndmask_b32 v145, v145, 0, s[82:83]
    v_cndmask_b32 v146, v146, 0, s[84:85]
    v_cndmask_b32 v147, v147, 0, s[84:85]
    v_cndmask_b32 v148, v148, 0, s[82:83]
    v_cndmask_b32 v149, v149, 0, s[82:83]
    v_cndmask_b32 v150, v150, 0, s[84:85]
    v_cndmask_b32 v151, v151, 0, s[84:85]
    ds_read_b64_tr_b16 v[50:51], v5 offset:0
    ds_read_b64_tr_b16 v[52:53], v5 offset:1024
    ds_read_b64_tr_b16 v[56:57], v5 offset:8
    ds_read_b64_tr_b16 v[58:59], v5 offset:1032
    v_mfma_f32_16x16x32_bf16 v[32:35], v[132:135], v[144:147], 0
    v_mfma_f32_16x16x32_bf16 v[36:39], v[152:155], v[144:147], 0
    v_mfma_f32_16x16x32_bf16 v[40:43], v[152:155], v[148:151], 0
    v_mfma_f32_16x16x32_bf16 v[44:47], v[156:159], v[148:151], 0
    s_cmp_eq_u32 s90, 0
    s_cselect_b32 s53, 2048, 0
    s_add_u32 s91, s91, s53
    s_add_u32 s92, s92, s53
    s_add_u32 s93, s93, s53
    buffer_load_dwordx4 v[96:99], v2, s[24:27], s91 offen offset:0 sc1
    buffer_load_dwordx4 v[100:103], v2, s[24:27], s91 offen offset:256 sc1
    buffer_load_dwordx4 v[104:107], v2, s[24:27], s92 offen offset:0 sc1
    buffer_load_dwordx4 v[108:111], v2, s[24:27], s92 offen offset:256 sc1
    buffer_load_dwordx4 v[112:115], v2, s[24:27], s93 offen offset:0 sc1
    buffer_load_dwordx4 v[116:119], v2, s[24:27], s93 offen offset:256 sc1
    v_cndmask_b32 v200, v32, v33, s[76:77]
    v_cndmask_b32 v201, v34, v35, s[76:77]
    v_cndmask_b32 v202, v36, v37, s[76:77]
    v_cndmask_b32 v203, v38, v39, s[76:77]
    v_cndmask_b32 v200, v200, v202, s[78:79]
    v_cndmask_b32 v201, v201, v203, s[80:81]
    v_cndmask_b32 v208, v40, v41, s[76:77]
    v_cndmask_b32 v209, v42, v43, s[76:77]
    v_cndmask_b32 v210, v44, v45, s[76:77]
    v_cndmask_b32 v211, v46, v47, s[76:77]
    v_cndmask_b32 v208, v208, v210, s[78:79]
    v_cndmask_b32 v209, v209, v211, s[80:81]
    v_max_f32 v202, v200, v201
    v_max_f32 v210, v208, v209
    v_mov_b32 v203, v202
    v_mov_b32 v211, v210
    s_nop 0
    v_permlane16_swap_b32 v202, v203
    v_permlane16_swap_b32 v210, v211
    v_max_f32 v202, v202, v203
    v_max_f32 v210, v210, v211
    v_mov_b32 v203, v202
    v_mov_b32 v211, v210
    s_nop 0
    v_permlane32_swap_b32 v202, v203
    v_permlane32_swap_b32 v210, v211
    v_max_f32 v202, v202, v203
    v_max_f32 v210, v210, v211
    v_sub_f32 v200, v200, v202
    v_sub_f32 v201, v201, v202
    v_sub_f32 v208, v208, v210
    v_sub_f32 v209, v209, v210
    v_mul_f32 v200, s95, v200
    v_mul_f32 v201, s95, v201
    v_mul_f32 v208, s95, v208
    v_mul_f32 v209, s95, v209
    v_exp_f32 v200, v200
    v_exp_f32 v201, v201
    v_exp_f32 v208, v208
    v_exp_f32 v209, v209
    v_add_f32 v202, v200, v201
    v_add_f32 v210, v208, v209
    v_mov_b32 v203, v202
    v_mov_b32 v211, v210
    s_nop 0
    v_permlane16_swap_b32 v202, v203
    v_permlane16_swap_b32 v210, v211
    v_add_f32 v202, v202, v203
    v_add_f32 v210, v210, v211
    v_mov_b32 v203, v202
    v_mov_b32 v211, v210
    s_nop 0
    v_permlane32_swap_b32 v202, v203
    v_permlane32_swap_b32 v210, v211
    v_add_f32 v202, v202, v203
    v_add_f32 v210, v210, v211
    v_rcp_f32 v202, v202
    v_rcp_f32 v210, v210
    v_mul_f32 v200, v200, v202
    v_mul_f32 v201, v201, v202
    v_mul_f32 v208, v208, v210
    v_mul_f32 v209, v209, v210
    v_cvt_pk_bf16_f32 v200, v200, v200
    v_cvt_pk_bf16_f32 v201, v201, v201
    v_cvt_pk_bf16_f32 v208, v208, v208
    v_cvt_pk_bf16_f32 v209, v209, v209
    v_and_b32 v60, v200, v6
    v_and_b32 v61, v201, v7
    v_and_b32 v62, v200, v8
    v_and_b32 v63, v201, v9
    v_and_b32 v64, v208, v6
    v_and_b32 v65, v209, v7
    v_and_b32 v66, v208, v8
    v_and_b32 v67, v209, v9
    s_waitcnt lgkmcnt(0)
    v_mfma_f32_16x16x32_bf16 v[68:71], v[48:51], v[60:63], 0
    v_mfma_f32_16x16x32_bf16 v[72:75], v[54:57], v[60:63], 0
    v_mfma_f32_16x16x32_bf16 v[76:79], v[50:53], v[64:67], 0
    v_mfma_f32_16x16x32_bf16 v[80:83], v[56:59], v[64:67], 0
    s_nop 4
    v_cvt_pk_bf16_f32 v84, v68, v69
    v_cvt_pk_bf16_f32 v85, v70, v71
    v_cvt_pk_bf16_f32 v86, v72, v73
    v_cvt_pk_bf16_f32 v87, v74, v75
    v_cndmask_b32 v84, v84, 0, s[82:83]
    v_cndmask_b32 v85, v85, 0, s[82:83]
    v_cndmask_b32 v86, v86, 0, s[84:85]
    v_cndmask_b32 v87, v87, 0, s[84:85]
    buffer_store_dwordx4 v[84:87], v3, s[24:27], s94 offen offset:0 sc1
    v_cvt_pk_bf16_f32 v88, v76, v77
    v_cvt_pk_bf16_f32 v89, v78, v79
    v_cvt_pk_bf16_f32 v90, v80, v81
    v_cvt_pk_bf16_f32 v91, v82, v83
    v_cndmask_b32 v88, v88, 0, s[82:83]
    v_cndmask_b32 v89, v89, 0, s[82:83]
    v_cndmask_b32 v90, v90, 0, s[84:85]
    v_cndmask_b32 v91, v91, 0, s[84:85]
    buffer_store_dwordx4 v[88:91], v3, s[24:27], s94 offen offset:256 sc1
    s_waitcnt vmcnt(8)
    v_mov_b32 v48, v52
    v_mov_b32 v49, v53
    v_mov_b32 v54, v58
    v_mov_b32 v55, v59
    ds_write_b128 v4, v[184:187] offset:0
    ds_write_b128 v4, v[188:191] offset:1024
    v_cndmask_b32 v168, v168, 0, s[82:83]
    v_cndmask_b32 v169, v169, 0, s[82:83]
    v_cndmask_b32 v170, v170, 0, s[84:85]
    v_cndmask_b32 v171, v171, 0, s[84:85]
    v_cndmask_b32 v172, v172, 0, s[82:83]
    v_cndmask_b32 v173, v173, 0, s[82:83]
    v_cndmask_b32 v174, v174, 0, s[84:85]
    v_cndmask_b32 v175, v175, 0, s[84:85]
    ds_read_b64_tr_b16 v[50:51], v5 offset:0
    ds_read_b64_tr_b16 v[52:53], v5 offset:1024
    ds_read_b64_tr_b16 v[56:57], v5 offset:8
    ds_read_b64_tr_b16 v[58:59], v5 offset:1032
    v_mfma_f32_16x16x32_bf16 v[32:35], v[156:159], v[168:171], 0
    v_mfma_f32_16x16x32_bf16 v[36:39], v[176:179], v[168:171], 0
    v_mfma_f32_16x16x32_bf16 v[40:43], v[176:179], v[172:175], 0
    v_mfma_f32_16x16x32_bf16 v[44:47], v[180:183], v[172:175], 0
    v_mov_b32 v192, v180
    v_mov_b32 v193, v181
    v_mov_b32 v194, v182
    v_mov_b32 v195, v183
    buffer_load_dwordx4 v[120:123], v2, s[24:27], s91 offen offset:512 sc1
    buffer_load_dwordx4 v[124:127], v2, s[24:27], s91 offen offset:768 sc1
    buffer_load_dwordx4 v[128:131], v2, s[24:27], s92 offen offset:512 sc1
    buffer_load_dwordx4 v[132:135], v2, s[24:27], s92 offen offset:768 sc1
    buffer_load_dwordx4 v[136:139], v2, s[24:27], s93 offen offset:512 sc1
    buffer_load_dwordx4 v[140:143], v2, s[24:27], s93 offen offset:768 sc1
    v_cndmask_b32 v200, v32, v33, s[76:77]
    v_cndmask_b32 v201, v34, v35, s[76:77]
    v_cndmask_b32 v202, v36, v37, s[76:77]
    v_cndmask_b32 v203, v38, v39, s[76:77]
    v_cndmask_b32 v200, v200, v202, s[78:79]
    v_cndmask_b32 v201, v201, v203, s[80:81]
    v_cndmask_b32 v208, v40, v41, s[76:77]
    v_cndmask_b32 v209, v42, v43, s[76:77]
    v_cndmask_b32 v210, v44, v45, s[76:77]
    v_cndmask_b32 v211, v46, v47, s[76:77]
    v_cndmask_b32 v208, v208, v210, s[78:79]
    v_cndmask_b32 v209, v209, v211, s[80:81]
    v_max_f32 v202, v200, v201
    v_max_f32 v210, v208, v209
    v_mov_b32 v203, v202
    v_mov_b32 v211, v210
    s_nop 0
    v_permlane16_swap_b32 v202, v203
    v_permlane16_swap_b32 v210, v211
    v_max_f32 v202, v202, v203
    v_max_f32 v210, v210, v211
    v_mov_b32 v203, v202
    v_mov_b32 v211, v210
    s_nop 0
    v_permlane32_swap_b32 v202, v203
    v_permlane32_swap_b32 v210, v211
    v_max_f32 v202, v202, v203
    v_max_f32 v210, v210, v211
    v_sub_f32 v200, v200, v202
    v_sub_f32 v201, v201, v202
    v_sub_f32 v208, v208, v210
    v_sub_f32 v209, v209, v210
    v_mul_f32 v200, s95, v200
    v_mul_f32 v201, s95, v201
    v_mul_f32 v208, s95, v208
    v_mul_f32 v209, s95, v209
    v_exp_f32 v200, v200
    v_exp_f32 v201, v201
    v_exp_f32 v208, v208
    v_exp_f32 v209, v209
    v_add_f32 v202, v200, v201
    v_add_f32 v210, v208, v209
    v_mov_b32 v203, v202
    v_mov_b32 v211, v210
    s_nop 0
    v_permlane16_swap_b32 v202, v203
    v_permlane16_swap_b32 v210, v211
    v_add_f32 v202, v202, v203
    v_add_f32 v210, v210, v211
    v_mov_b32 v203, v202
    v_mov_b32 v211, v210
    s_nop 0
    v_permlane32_swap_b32 v202, v203
    v_permlane32_swap_b32 v210, v211
    v_add_f32 v202, v202, v203
    v_add_f32 v210, v210, v211
    v_rcp_f32 v202, v202
    v_rcp_f32 v210, v210
    v_mul_f32 v200, v200, v202
    v_mul_f32 v201, v201, v202
    v_mul_f32 v208, v208, v210
    v_mul_f32 v209, v209, v210
    v_cvt_pk_bf16_f32 v200, v200, v200
    v_cvt_pk_bf16_f32 v201, v201, v201
    v_cvt_pk_bf16_f32 v208, v208, v208
    v_cvt_pk_bf16_f32 v209, v209, v209
    v_and_b32 v60, v200, v6
    v_and_b32 v61, v201, v7
    v_and_b32 v62, v200, v8
    v_and_b32 v63, v201, v9
    v_and_b32 v64, v208, v6
    v_and_b32 v65, v209, v7
    v_and_b32 v66, v208, v8
    v_and_b32 v67, v209, v9
    s_waitcnt lgkmcnt(0)
    v_mfma_f32_16x16x32_bf16 v[68:71], v[48:51], v[60:63], 0
    v_mfma_f32_16x16x32_bf16 v[72:75], v[54:57], v[60:63], 0
    v_mfma_f32_16x16x32_bf16 v[76:79], v[50:53], v[64:67], 0
    v_mfma_f32_16x16x32_bf16 v[80:83], v[56:59], v[64:67], 0
    s_nop 4
    v_cvt_pk_bf16_f32 v84, v68, v69
    v_cvt_pk_bf16_f32 v85, v70, v71
    v_cvt_pk_bf16_f32 v86, v72, v73
    v_cvt_pk_bf16_f32 v87, v74, v75
    v_cndmask_b32 v84, v84, 0, s[82:83]
    v_cndmask_b32 v85, v85, 0, s[82:83]
    v_cndmask_b32 v86, v86, 0, s[84:85]
    v_cndmask_b32 v87, v87, 0, s[84:85]
    buffer_store_dwordx4 v[84:87], v3, s[24:27], s94 offen offset:1024 sc1
    v_cvt_pk_bf16_f32 v88, v76, v77
    v_cvt_pk_bf16_f32 v89, v78, v79
    v_cvt_pk_bf16_f32 v90, v80, v81
    v_cvt_pk_bf16_f32 v91, v82, v83
    v_cndmask_b32 v88, v88, 0, s[82:83]
    v_cndmask_b32 v89, v89, 0, s[82:83]
    v_cndmask_b32 v90, v90, 0, s[84:85]
    v_cndmask_b32 v91, v91, 0, s[84:85]
    buffer_store_dwordx4 v[88:91], v3, s[24:27], s94 offen offset:1280 sc1
    s_add_u32 s94, s94, 65536
    s_add_u32 s90, s90, 1
    s_cmp_lt_u32 s90, 2
    s_cbranch_scc1 L_attn_loop
    s_waitcnt vmcnt(0) lgkmcnt(0)
    s_barrier
    s_sub_u32 s54, s46, 28
    s_cmp_lg_u32 s44, 0
    s_cbranch_scc1 L_nopub16
    s_lshl_b32 s62, s45, 3
    s_add_u32 s62, s62, s54
    s_lshl_b32 s62, s62, 7
    s_add_u32 s62, s62, 12779520
    v_mov_b32 v30, s47
    s_mov_b64 exec, 1
    buffer_store_dword v30, off, s[24:27], s62 sc1
    s_mov_b64 exec, -1
L_nopub16:
L_end:
    s_endpgm
L_nop2:
    s_waitcnt vmcnt(0) lgkmcnt(0)
    s_barrier
    s_cmp_lg_u32 s44, 0
    s_cbranch_scc1 L_nopub17
    s_lshl_b32 s62, s48, 3
    s_add_u32 s62, s62, s49
    s_lshl_b32 s62, s62, 7
    s_add_u32 s62, s62, 12648448
    v_mov_b32 v30, s47
    s_mov_b64 exec, 1
    buffer_store_dword v30, off, s[24:27], s62 sc1
    s_mov_b64 exec, -1
L_nopub17:
    s_and_b32 s66, s48, 3
    s_cbranch_scc0 L_p3alt
    s_sub_u32 s66, s66, 1
    v_lshrrev_b32 v17, 2, v1
    v_lshlrev_b32 v17, 12, v17
    v_and_b32 v18, 3, v1
    v_lshl_add_u32 v17, v18, 7, v17
    s_mul_i32 s54, s44, 28
    s_add_u32 s54, s54, s66
    s_add_u32 s54, s54, 16
    s_lshl_b32 s54, s54, 16
    s_lshl_b32 s56, s45, 9
    s_add_u32 s54, s54, s56
    buffer_load_dword v96, v17, s[20:23], s54 offen
    s_add_u32 s54, s54, 196608
    buffer_load_dword v97, v17, s[20:23], s54 offen
    s_add_u32 s54, s54, 196608
    buffer_load_dword v98, v17, s[20:23], s54 offen
    s_add_u32 s54, s54, 196608
    buffer_load_dword v99, v17, s[20:23], s54 offen
    s_add_u32 s54, s54, 196608
L_p3alt:
    v_and_b32 v207, 7, v1
    v_min_u32 v207, 6, v207
    v_lshlrev_b32 v207, 7, v207
    s_lshl_b32 s53, s45, 3
    s_add_u32 s53, s53, s44
    s_lshl_b32 s53, s53, 7
    s_add_u32 s53, s53, 12779520
    v_mov_b32 v202, s53
    s_lshl_b32 s53, s49, 5
    s_mul_i32 s54, s44, 7
    s_add_u32 s53, s53, s54
    s_lshl_b32 s53, s53, 7
    s_add_u32 s53, s53, 12713984
    v_add_u32 v204, s53, v207
    s_lshl_b32 s88, s48, 16
    s_lshl_b32 s54, s44, 14
    s_add_u32 s88, s88, s54
    s_add_u32 s88, s88, 4194304
    v_lshrrev_b32 v207, 3, v0
    v_and_b32 v218, 7, v0
    v_mul_u32_u24 v205, 896, v207
    v_lshl_add_u32 v205, v218, 4, v205
    v_lshlrev_b32 v206, 1, v207
    s_mul_i32 s89, s48, 57344
    s_lshl_b32 s54, s49, 7
    s_add_u32 s89, s89, s54
    s_add_u32 s90, s89, 28672
    s_lshl_b32 s91, s48, 7
    s_mul_i32 s61, s49, 235264
    s_mul_i32 s54, s44, 58624
    s_add_u32 s61, s61, s54
    s_add_u32 s61, s61, 2097152
    s_add_u32 m0, s52, 106496
    s_mov_b32 s57, 0
    buffer_load_dwordx4 v8, s[20:23], s57 offen lds
    buffer_load_dwordx4 v9, s[20:23], s57 offen offset:1024 lds
    s_add_u32 m0, s52, 114688
    s_mov_b32 s57, 65536
    buffer_load_dwordx4 v8, s[20:23], s57 offen lds
    buffer_load_dwordx4 v9, s[20:23], s57 offen offset:1024 lds
    s_add_u32 m0, s52, 122880
    s_mov_b32 s57, 131072
    buffer_load_dwordx4 v8, s[20:23], s57 offen lds
    buffer_load_dwordx4 v9, s[20:23], s57 offen offset:1024 lds
    s_add_u32 m0, s52, 131072
    s_mov_b32 s57, 196608
    buffer_load_dwordx4 v8, s[20:23], s57 offen lds
    buffer_load_dwordx4 v9, s[20:23], s57 offen offset:1024 lds
    s_add_u32 m0, s52, 139264
    s_mov_b32 s57, 262144
    buffer_load_dwordx4 v8, s[20:23], s57 offen lds
    buffer_load_dwordx4 v9, s[20:23], s57 offen offset:1024 lds
    s_add_u32 m0, s52, 147456
    s_mov_b32 s57, 327680
    buffer_load_dwordx4 v8, s[20:23], s57 offen lds
    buffer_load_dwordx4 v9, s[20:23], s57 offen offset:1024 lds
    s_add_u32 m0, s52, 155648
    s_mov_b32 s57, 393216
    buffer_load_dwordx4 v8, s[20:23], s57 offen lds
    buffer_load_dwordx4 v9, s[20:23], s57 offen offset:1024 lds
    s_add_u32 m0, s52, 65536
    s_mov_b32 s57, 458752
    buffer_load_dwordx4 v8, s[20:23], s57 offen lds
    buffer_load_dwordx4 v9, s[20:23], s57 offen offset:1024 lds
    s_add_u32 m0, s52, 73728
    s_mov_b32 s57, 524288
    buffer_load_dwordx4 v8, s[20:23], s57 offen lds
    buffer_load_dwordx4 v9, s[20:23], s57 offen offset:1024 lds
    s_add_u32 m0, s52, 81920
    s_mov_b32 s57, 589824
    buffer_load_dwordx4 v8, s[20:23], s57 offen lds
    buffer_load_dwordx4 v9, s[20:23], s57 offen offset:1024 lds
    s_add_u32 m0, s52, 90112
    s_mov_b32 s57, 655360
    buffer_load_dwordx4 v8, s[20:23], s57 offen lds
    buffer_load_dwordx4 v9, s[20:23], s57 offen offset:1024 lds
    s_add_u32 m0, s52, 98304
    s_mov_b32 s57, 720896
    buffer_load_dwordx4 v8, s[20:23], s57 offen lds
    s_waitcnt vmcnt(21)
    ds_read_b64_tr_b16 a[0:1], v4 offset:40960
    ds_read_b64_tr_b16 a[2:3], v4 offset:41984
    ds_read_b64_tr_b16 a[4:5], v4 offset:41216
    ds_read_b64_tr_b16 a[6:7], v4 offset:42240
    s_waitcnt vmcnt(19)
    ds_read_b64_tr_b16 a[8:9], v4 offset:49152
    ds_read_b64_tr_b16 a[10:11], v4 offset:50176
    ds_read_b64_tr_b16 a[12:13], v4 offset:49408
    ds_read_b64_tr_b16 a[14:15], v4 offset:50432
    s_waitcnt vmcnt(17)
    ds_read_b64_tr_b16 a[16:17], v4 offset:57344
    ds_read_b64_tr_b16 a[18:19], v4 offset:58368
    ds_read_b64_tr_b16 a[20:21], v4 offset:57600
    ds_read_b64_tr_b16 a[22:23], v4 offset:58624
    s_waitcnt vmcnt(15)
    ds_read_b64_tr_b16 a[24:25], v5 offset:0
    ds_read_b64_tr_b16 a[26:27], v5 offset:1024
    ds_read_b64_tr_b16 a[28:29], v5 offset:256
    ds_read_b64_tr_b16 a[30:31], v5 offset:1280
    buffer_load_dwordx4 v9, s[20:23], s57 offen offset:1024 lds
    s_waitcnt vmcnt(14)
    ds_read_b64_tr_b16 a[32:33], v5 offset:8192
    ds_read_b64_tr_b16 a[34:35], v5 offset:9216
    ds_read_b64_tr_b16 a[36:37], v5 offset:8448
    ds_read_b64_tr_b16 a[38:39], v5 offset:9472
    s_waitcnt vmcnt(12)
    ds_read_b64_tr_b16 a[40:41], v5 offset:16384
    ds_read_b64_tr_b16 a[42:43], v5 offset:17408
    ds_read_b64_tr_b16 a[44:45], v5 offset:16640
    ds_read_b64_tr_b16 a[46:47], v5 offset:17664
    s_waitcnt vmcnt(10)
    ds_read_b64_tr_b16 a[48:49], v5 offset:24576
    ds_read_b64_tr_b16 a[50:51], v5 offset:25600
    ds_read_b64_tr_b16 a[52:53], v5 offset:24832
    ds_read_b64_tr_b16 a[54:55], v5 offset:25856
    s_waitcnt vmcnt(8)
    ds_read_b64_tr_b16 a[56:57], v4 offset:0
    ds_read_b64_tr_b16 a[58:59], v4 offset:1024
    ds_read_b64_tr_b16 a[60:61], v4 offset:256
    ds_read_b64_tr_b16 a[62:63], v4 offset:1280
    s_waitcnt lgkmcnt(15)
    s_add_u32 m0, s52, 106496
    s_mov_b32 s57, 786432
    buffer_load_dwordx4 v8, s[20:23], s57 offen lds
    s_waitcnt vmcnt(7)
    ds_read_b64_tr_b16 a[64:65], v4 offset:8192
    ds_read_b64_tr_b16 a[66:67], v4 offset:9216
    ds_read_b64_tr_b16 a[68:69], v4 offset:8448
    ds_read_b64_tr_b16 a[70:71], v4 offset:9472
    s_waitcnt vmcnt(5)
    ds_read_b64_tr_b16 a[72:73], v4 offset:16384
    ds_read_b64_tr_b16 a[74:75], v4 offset:17408
    ds_read_b64_tr_b16 a[76:77], v4 offset:16640
    ds_read_b64_tr_b16 a[78:79], v4 offset:17664
    s_waitcnt vmcnt(3)
    ds_read_b64_tr_b16 a[80:81], v4 offset:24576
    ds_read_b64_tr_b16 a[82:83], v4 offset:25600
    ds_read_b64_tr_b16 a[84:85], v4 offset:24832
    ds_read_b64_tr_b16 a[86:87], v4 offset:25856
    buffer_load_dwordx4 v9, s[20:23], s57 offen offset:1024 lds
    s_add_u32 m0, s52, 114688
    s_mov_b32 s57, 851968
    buffer_load_dwordx4 v8, s[20:23], s57 offen lds
    buffer_load_dwordx4 v9, s[20:23], s57 offen offset:1024 lds
    s_add_u32 m0, s52, 122880
    s_mov_b32 s57, 917504
    buffer_load_dwordx4 v8, s[20:23], s57 offen lds
    buffer_load_dwordx4 v9, s[20:23], s57 offen offset:1024 lds
    s_add_u32 m0, s52, 131072
    s_mov_b32 s57, 983040
    buffer_load_dwordx4 v8, s[20:23], s57 offen lds
    buffer_load_dwordx4 v9, s[20:23], s57 offen offset:1024 lds
    s_waitcnt lgkmcnt(15)
    s_add_u32 m0, s52, 139264
    s_mov_b32 s57, 1048576
    buffer_load_dwordx4 v8, s[20:23], s57 offen lds
    s_waitcnt vmcnt(0) lgkmcnt(0)
    s_branch L_p3join
L_codeend:
.section .rodata,"a"
.p2align 6
.amdhsa_kernel parallel_sum__sliding_local_dilated__mixer_token_mlp__prompt_kernel
  .amdhsa_next_free_vgpr 512
  .amdhsa_next_free_sgpr 102
  .amdhsa_accum_offset 256
  .amdhsa_group_segment_fixed_size 0
  .amdhsa_kernarg_size 88
  .amdhsa_user_sgpr_count 2
  .amdhsa_user_sgpr_kernarg_segment_ptr 1
  .amdhsa_system_sgpr_workgroup_id_x 1
  .amdhsa_float_denorm_mode_32 3
.end_amdhsa_kernel
```

```asm
; @launch grid=(256,1,1) block=(256,1,1) lds=163840
.amdgcn_target "amdgcn-amd-amdhsa--gfx950"
.text
.globl parallel_sum__sliding_local_dilated__mixer_token_mlp__prompt_kernel
.p2align 8
.type parallel_sum__sliding_local_dilated__mixer_token_mlp__prompt_kernel,@function
parallel_sum__sliding_local_dilated__mixer_token_mlp__prompt_kernel:
    s_cmp_ge_u32 s2, 256
    s_cbranch_scc1 L_end
    s_load_dwordx2 s[4:5], s[0:1], 0
    s_load_dwordx16 s[76:91], s[0:1], 0
    s_load_dwordx4 s[92:95], s[0:1], 64
    s_load_dwordx2 s[24:25], s[0:1], 80
    s_lshr_b32 s46, s2, 3
    s_getpc_b64 s[98:99]
L_pc:
    s_lshl_b32 s53, s46, 10
    v_lshrrev_b32 v18, 5, v0
    v_lshl_add_u32 v18, v18, 7, s53
    v_min_u32 v18, L_codeend-L_pc-4, v18
    v_mov_b32 v21, s99
    v_add_co_u32 v20, vcc, s98, v18
    s_nop 1
    v_addc_co_u32 v21, vcc, 0, v21, vcc
    global_load_dword v255, v[20:21], off
    v_lshrrev_b32 v18, 6, v0
    v_and_b32 v1, 63, v0
    s_and_b32 s45, s2, 7
    v_readfirstlane_b32 s44, v18
    s_and_b32 s53, s46, 7
    s_lshr_b32 s54, s46, 3
    s_and_b32 s56, s2, 1
    s_lshl2_add_u32 s49, s56, s54
    s_lshl1_add_u32 s56, s53, s56
    s_cmp_eq_u32 s54, 3
    s_cselect_b32 s49, 3, s49
    s_cselect_b32 s53, s56, s53
    s_and_b32 s48, s2, 6
    s_lshl2_add_u32 s48, s48, s53
    s_lshl1_add_u32 s3, s49, s48
    v_lshrrev_b32 v29, 2, v0
    v_mul_u32_u24 v17, 896, v29
    v_and_b32 v30, 3, v0
    v_lshl_add_u32 v17, v30, 4, v17
    s_mul_i32 s53, s48, 57344
    v_add_u32 v17, s53, v17
    s_mul_i32 s56, s3, 37
    s_lshr_b32 s56, s56, 8
    s_mul_i32 s56, s56, 7
    s_sub_u32 s3, s3, s56
    s_lshl_b32 s58, s3, 7
    s_mov_b32 s6, 1835008
    s_mov_b32 s7, 0x20000
    s_cmp_ge_u32 s46, 28
    s_waitcnt lgkmcnt(0)
    s_cbranch_scc1 L_helper
    s_mul_i32 s67, s58, 1344
    buffer_load_dwordx4 v[32:35], v17, s[4:7], s58 offen offset:0
    buffer_load_dwordx4 v[36:39], v17, s[4:7], s58 offen offset:64
    s_add_u32 s58, s58, 128
    s_cmp_eq_u32 s58, 896
    s_cselect_b32 s58, 0, s58
    s_mul_i32 s68, s58, 1344
    buffer_load_dwordx4 v[40:43], v17, s[4:7], s58 offen offset:0
    buffer_load_dwordx4 v[44:47], v17, s[4:7], s58 offen offset:64
    s_add_u32 s58, s58, 128
    s_cmp_eq_u32 s58, 896
    s_cselect_b32 s58, 0, s58
    s_mul_i32 s69, s58, 1344
    buffer_load_dwordx4 v[48:51], v17, s[4:7], s58 offen offset:0
    buffer_load_dwordx4 v[52:55], v17, s[4:7], s58 offen offset:64
    s_add_u32 s58, s58, 128
    s_cmp_eq_u32 s58, 896
    s_cselect_b32 s58, 0, s58
    s_mul_i32 s70, s58, 1344
    buffer_load_dwordx4 v[56:59], v17, s[4:7], s58 offen offset:0
    buffer_load_dwordx4 v[60:63], v17, s[4:7], s58 offen offset:64
    s_add_u32 s58, s58, 128
    s_cmp_eq_u32 s58, 896
    s_cselect_b32 s58, 0, s58
    s_mul_i32 s71, s58, 1344
    buffer_load_dwordx4 v[64:67], v17, s[4:7], s58 offen offset:0
    buffer_load_dwordx4 v[68:71], v17, s[4:7], s58 offen offset:64
    s_add_u32 s58, s58, 128
    s_cmp_eq_u32 s58, 896
    s_cselect_b32 s58, 0, s58
    s_mul_i32 s72, s58, 1344
    buffer_load_dwordx4 v[72:75], v17, s[4:7], s58 offen offset:0
    s_mov_b64 s[8:9], s[78:79]
    s_mov_b32 s10, 1204224
    s_mov_b32 s11, s7
    s_mov_b32 s26, 16777216
    s_mov_b32 s27, s7
    s_mov_b64 s[40:41], s[94:95]
    s_mov_b32 s42, 256
    s_mov_b32 s43, s7
    s_mov_b64 s[16:17], s[84:85]
    s_mov_b32 s18, 7340032
    s_mov_b32 s19, s7
    s_mov_b64 s[20:21], s[88:89]
    s_mov_b32 s22, 7340032
    s_mov_b32 s23, s7
    s_mov_b64 s[12:13], s[80:81]
    s_mov_b32 s14, 401408
    s_mov_b32 s15, s7
    s_mov_b64 s[28:29], s[92:93]
    s_mov_b32 s30, 1835008
    s_mov_b32 s31, s7
    s_mov_b64 s[32:33], s[86:87]
    s_mov_b32 s34, 3584
    s_mov_b32 s35, s7
    s_mov_b64 s[36:37], s[90:91]
    s_mov_b32 s38, 4096
    s_mov_b32 s39, s7
    s_lshl_b32 s52, s44, 11
    v_lshlrev_b32 v12, 4, v1
    v_lshrrev_b32 v210, 5, v1
    v_bfe_u32 v211, v1, 2, 2
    v_lshl_add_u32 v208, v210, 2, v211
    v_bfe_u32 v212, v1, 4, 1
    v_lshlrev_b32 v209, 4, v30
    v_lshl_add_u32 v209, v212, 6, v209
    s_mul_i32 s53, s44, 43008
    s_mul_i32 s54, s49, 384
    s_add_u32 s53, s53, s54
    v_mul_u32_u24 v18, 2688, v208
    v_add3_u32 v18, v18, v209, s53
    s_mul_i32 s55, s44, 6144
    v_add_u32 v19, 128, v18
    v_add_u32 v20, 256, v18
    v_add_u32 v21, 21504, v18
    v_add_u32 v22, 21632, v18
    v_add_u32 v23, 21760, v18
    v_lshlrev_b32 v24, 4, v29
    v_lshlrev_b32 v214, 5, v30
    v_xor_b32 v24, v24, v214
    v_lshl_add_u32 v24, v30, 10, v24
    v_lshlrev_b32 v213, 6, v211
    v_lshl_add_u32 v213, v212, 5, v213
    v_lshl_add_u32 v213, v30, 3, v213
    s_and_b32 s53, s44, 1
    s_lshl_b32 s53, s53, 9
    v_and_b32 v214, 31, v1
    v_lshlrev_b32 v214, 4, v214
    v_lshlrev_b32 v215, 5, v210
    v_xor_b32 v214, v214, v215
    v_lshl_add_u32 v25, v210, 10, v214
    v_add_u32 v25, s53, v25
    v_xor_b32 v252, 64, v25
    s_lshr_b32 s53, s44, 1
    s_lshl_b32 s53, s53, 8
    s_add_u32 s53, s53, 65536
    v_mul_u32_u24 v26, 3072, v210
    v_add3_u32 v26, v26, v213, s53
    v_add_u32 v27, 49152, v26
    v_bfe_u32 v215, v1, 1, 1
    v_lshl_add_u32 v215, v212, 1, v215
    v_lshl_add_u32 v214, v210, 3, v211
    v_lshlrev_b32 v214, 4, v214
    v_lshlrev_b32 v28, 5, v215
    v_xor_b32 v28, v28, v214
    v_lshl_add_u32 v28, v215, 10, v28
    v_and_b32 v215, 1, v1
    v_lshl_add_u32 v28, v215, 3, v28
    s_lshl_b32 s53, s44, 8
    v_add_u32 v28, s53, v28
    v_xor_b32 v253, 64, v28
    s_mov_b32 s74, 0x3f803f80
    s_mov_b32 s63, 0xffff0000
    v_mov_b32 v216, 0
    v_mov_b32 v217, 0
    v_lshl_add_u32 v16, v210, 10, v213
    v_add_u32 v16, s52, v16
    v_add_u32 v2, 65536, v16
    v_add_u32 v3, 65536, v2
    s_mul_i32 s64, s3, 268032
    s_lshl_b32 s65, s48, 13
    s_add_u32 s64, s64, s65
    s_add_u32 s64, s64, s52
    s_lshr_b32 s65, s48, 3
    s_mul_i32 s65, s65, 1280
    s_add_u32 s64, s64, s65
    s_mul_i32 s65, s46, 37
    s_lshr_b32 s65, s65, 8
    s_mul_i32 s54, s65, 7
    s_sub_u32 s77, s46, s54
    s_lshl2_add_u32 s76, s45, s65
    s_lshr_b32 s53, s45, 1
    s_mul_i32 s53, s53, 49
    s_and_b32 s54, s45, 1
    s_mul_i32 s56, s54, 25
    s_add_u32 s53, s53, s56
    s_add_u32 s54, s54, s46
    s_cmp_eq_u32 s54, 6
    s_cselect_b32 s75, 1, 0
    s_cselect_b32 s56, 24, 0
    s_sub_u32 s54, s46, s65
    s_cmp_lt_u32 s77, 6
    s_cselect_b32 s75, 1, s75
    s_cselect_b32 s54, s54, s56
    s_add_u32 s53, s53, s54
    s_mul_i32 s50, s53, 9363
    s_lshr_b32 s50, s50, 16
    s_mul_i32 s54, s50, 7
    s_sub_u32 s51, s53, s54
    s_mul_i32 s53, s44, 1835008
    s_lshl_b32 s54, s50, 7
    s_add_u32 s53, s53, s54
    s_lshr_b32 s54, s44, 1
    s_lshl_b32 s54, s54, 6
    v_xor_b32 v215, s54, v209
    v_mul_u32_u24 v6, 3584, v208
    v_add3_u32 v6, v6, v215, s53
    v_add_u32 v7, 27648, v6
    v_lshrrev_b32 v214, 2, v1
    s_mul_i32 s66, s46, 5
    s_add_u32 s66, s66, 384
    s_add_u32 s54, s66, 5
    s_min_u32 s54, s54, 512
    v_add_u32 v214, s66, v214
    v_mul_u32_u24 v254, 3584, v214
    v_lshl_add_u32 v254, v30, 7, v254
    v_cmp_gt_u32 vcc, s54, v214
    v_mov_b32 v215, 0x7fffffff
    s_mul_i32 s66, s44, 1835008
    v_cndmask_b32 v254, v215, v254, vcc
    s_mul_i32 s54, s45, 7
    s_lshr_b32 s54, s54, 1
    s_lshl_b32 s54, s54, 7
    s_add_u32 s66, s66, s54
    buffer_load_dwordx4 v[76:79], v17, s[4:7], s58 offen offset:64
    s_add_u32 s58, s58, 128
    s_cmp_eq_u32 s58, 896
    s_cselect_b32 s58, 0, s58
    s_mul_i32 s73, s58, 1344
    buffer_load_dwordx4 v[80:83], v17, s[4:7], s58 offen offset:0
    buffer_load_dwordx4 v[84:87], v17, s[4:7], s58 offen offset:64
    s_add_u32 m0, s55, 65536
    s_nop 0
    buffer_load_dwordx4 v18, s[8:11], s67 offen lds
    s_add_u32 m0, s55, 66560
    s_nop 0
    buffer_load_dwordx4 v19, s[8:11], s67 offen lds
    s_add_u32 m0, s55, 67584
    s_nop 0
    buffer_load_dwordx4 v20, s[8:11], s67 offen lds
    s_add_u32 m0, s55, 68608
    s_nop 0
    buffer_load_dwordx4 v21, s[8:11], s67 offen lds
    s_waitcnt vmcnt(17)
    v_dot2c_f32_bf16 v216, s74, v32
    v_dot2c_f32_bf16 v217, v32, v32
    v_lshlrev_b32 v96, 16, v32
    v_and_b32 v97, s63, v32
    v_dot2c_f32_bf16 v216, s74, v33
    v_dot2c_f32_bf16 v217, v33, v33
    v_lshlrev_b32 v98, 16, v33
    v_and_b32 v99, s63, v33
    v_dot2c_f32_bf16 v216, s74, v34
    v_dot2c_f32_bf16 v217, v34, v34
    v_lshlrev_b32 v100, 16, v34
    v_and_b32 v101, s63, v34
    v_dot2c_f32_bf16 v216, s74, v35
    v_dot2c_f32_bf16 v217, v35, v35
    v_lshlrev_b32 v102, 16, v35
    v_and_b32 v103, s63, v35
    s_waitcnt vmcnt(16)
    v_dot2c_f32_bf16 v216, s74, v36
    v_dot2c_f32_bf16 v217, v36, v36
    v_lshlrev_b32 v104, 16, v36
    v_and_b32 v105, s63, v36
    v_dot2c_f32_bf16 v216, s74, v37
    v_dot2c_f32_bf16 v217, v37, v37
    v_lshlrev_b32 v106, 16, v37
    v_and_b32 v107, s63, v37
    v_dot2c_f32_bf16 v216, s74, v38
    v_dot2c_f32_bf16 v217, v38, v38
    v_lshlrev_b32 v108, 16, v38
    v_and_b32 v109, s63, v38
    v_dot2c_f32_bf16 v216, s74, v39
    v_dot2c_f32_bf16 v217, v39, v39
    v_lshlrev_b32 v110, 16, v39
    v_and_b32 v111, s63, v39
    s_waitcnt vmcnt(15)
    v_dot2c_f32_bf16 v216, s74, v40
    v_dot2c_f32_bf16 v217, v40, v40
    v_lshlrev_b32 v112, 16, v40
    v_and_b32 v113, s63, v40
    v_dot2c_f32_bf16 v216, s74, v41
    v_dot2c_f32_bf16 v217, v41, v41
    v_lshlrev_b32 v114, 16, v41
    v_and_b32 v115, s63, v41
    v_dot2c_f32_bf16 v216, s74, v42
    v_dot2c_f32_bf16 v217, v42, v42
    v_lshlrev_b32 v116, 16, v42
    v_and_b32 v117, s63, v42
    v_dot2c_f32_bf16 v216, s74, v43
    v_dot2c_f32_bf16 v217, v43, v43
    v_lshlrev_b32 v118, 16, v43
    v_and_b32 v119, s63, v43
    s_waitcnt vmcnt(14)
    v_dot2c_f32_bf16 v216, s74, v44
    v_dot2c_f32_bf16 v217, v44, v44
    v_lshlrev_b32 v120, 16, v44
    v_and_b32 v121, s63, v44
    s_add_u32 m0, s55, 69632
    s_nop 0
    buffer_load_dwordx4 v22, s[8:11], s67 offen lds
    v_dot2c_f32_bf16 v216, s74, v45
    v_dot2c_f32_bf16 v217, v45, v45
    v_lshlrev_b32 v122, 16, v45
    v_and_b32 v123, s63, v45
    v_dot2c_f32_bf16 v216, s74, v46
    v_dot2c_f32_bf16 v217, v46, v46
    v_lshlrev_b32 v124, 16, v46
    v_and_b32 v125, s63, v46
    v_dot2c_f32_bf16 v216, s74, v47
    v_dot2c_f32_bf16 v217, v47, v47
    v_lshlrev_b32 v126, 16, v47
    v_and_b32 v127, s63, v47
    s_waitcnt vmcnt(14)
    v_dot2c_f32_bf16 v216, s74, v48
    v_dot2c_f32_bf16 v217, v48, v48
    v_lshlrev_b32 v128, 16, v48
    v_and_b32 v129, s63, v48
    v_dot2c_f32_bf16 v216, s74, v49
    v_dot2c_f32_bf16 v217, v49, v49
    v_lshlrev_b32 v130, 16, v49
    v_and_b32 v131, s63, v49
    v_dot2c_f32_bf16 v216, s74, v50
    v_dot2c_f32_bf16 v217, v50, v50
    v_lshlrev_b32 v132, 16, v50
    v_and_b32 v133, s63, v50
    v_dot2c_f32_bf16 v216, s74, v51
    v_dot2c_f32_bf16 v217, v51, v51
    v_lshlrev_b32 v134, 16, v51
    v_and_b32 v135, s63, v51
    s_waitcnt vmcnt(13)
    v_dot2c_f32_bf16 v216, s74, v52
    v_dot2c_f32_bf16 v217, v52, v52
    v_lshlrev_b32 v136, 16, v52
    v_and_b32 v137, s63, v52
    v_dot2c_f32_bf16 v216, s74, v53
    v_dot2c_f32_bf16 v217, v53, v53
    v_lshlrev_b32 v138, 16, v53
    v_and_b32 v139, s63, v53
    v_dot2c_f32_bf16 v216, s74, v54
    v_dot2c_f32_bf16 v217, v54, v54
    v_lshlrev_b32 v140, 16, v54
    v_and_b32 v141, s63, v54
    v_dot2c_f32_bf16 v216, s74, v55
    v_dot2c_f32_bf16 v217, v55, v55
    v_lshlrev_b32 v142, 16, v55
    v_and_b32 v143, s63, v55
    s_waitcnt vmcnt(12)
    v_dot2c_f32_bf16 v216, s74, v56
    v_dot2c_f32_bf16 v217, v56, v56
    v_lshlrev_b32 v144, 16, v56
    v_and_b32 v145, s63, v56
    s_add_u32 m0, s55, 70656
    s_nop 0
    buffer_load_dwordx4 v23, s[8:11], s67 offen lds
    v_dot2c_f32_bf16 v216, s74, v57
    v_dot2c_f32_bf16 v217, v57, v57
    v_lshlrev_b32 v146, 16, v57
    v_and_b32 v147, s63, v57
    v_dot2c_f32_bf16 v216, s74, v58
    v_dot2c_f32_bf16 v217, v58, v58
    v_lshlrev_b32 v148, 16, v58
    v_and_b32 v149, s63, v58
    v_dot2c_f32_bf16 v216, s74, v59
    v_dot2c_f32_bf16 v217, v59, v59
    v_lshlrev_b32 v150, 16, v59
    v_and_b32 v151, s63, v59
    s_waitcnt vmcnt(12)
    v_dot2c_f32_bf16 v216, s74, v60
    v_dot2c_f32_bf16 v217, v60, v60
    v_lshlrev_b32 v152, 16, v60
    v_and_b32 v153, s63, v60
    v_dot2c_f32_bf16 v216, s74, v61
    v_dot2c_f32_bf16 v217, v61, v61
    v_lshlrev_b32 v154, 16, v61
    v_and_b32 v155, s63, v61
    v_dot2c_f32_bf16 v216, s74, v62
    v_dot2c_f32_bf16 v217, v62, v62
    v_lshlrev_b32 v156, 16, v62
    v_and_b32 v157, s63, v62
    v_dot2c_f32_bf16 v216, s74, v63
    v_dot2c_f32_bf16 v217, v63, v63
    v_lshlrev_b32 v158, 16, v63
    v_and_b32 v159, s63, v63
    s_waitcnt vmcnt(11)
    v_dot2c_f32_bf16 v216, s74, v64
    v_dot2c_f32_bf16 v217, v64, v64
    v_lshlrev_b32 v160, 16, v64
    v_and_b32 v161, s63, v64
    v_dot2c_f32_bf16 v216, s74, v65
    v_dot2c_f32_bf16 v217, v65, v65
    v_lshlrev_b32 v162, 16, v65
    v_and_b32 v163, s63, v65
    v_dot2c_f32_bf16 v216, s74, v66
    v_dot2c_f32_bf16 v217, v66, v66
    v_lshlrev_b32 v164, 16, v66
    v_and_b32 v165, s63, v66
    v_dot2c_f32_bf16 v216, s74, v67
    v_dot2c_f32_bf16 v217, v67, v67
    v_lshlrev_b32 v166, 16, v67
    v_and_b32 v167, s63, v67
    s_waitcnt vmcnt(10)
    v_dot2c_f32_bf16 v216, s74, v68
    v_dot2c_f32_bf16 v217, v68, v68
    v_lshlrev_b32 v168, 16, v68
    v_and_b32 v169, s63, v68
    v_dot2c_f32_bf16 v216, s74, v69
    v_dot2c_f32_bf16 v217, v69, v69
    v_lshlrev_b32 v170, 16, v69
    v_and_b32 v171, s63, v69
    s_add_u32 m0, s55, 90112
    s_nop 0
    buffer_load_dwordx4 v18, s[8:11], s68 offen lds
    v_dot2c_f32_bf16 v216, s74, v70
    v_dot2c_f32_bf16 v217, v70, v70
    v_lshlrev_b32 v172, 16, v70
    v_and_b32 v173, s63, v70
    v_dot2c_f32_bf16 v216, s74, v71
    v_dot2c_f32_bf16 v217, v71, v71
    v_lshlrev_b32 v174, 16, v71
    v_and_b32 v175, s63, v71
    s_waitcnt vmcnt(10)
    v_dot2c_f32_bf16 v216, s74, v72
    v_dot2c_f32_bf16 v217, v72, v72
    v_lshlrev_b32 v176, 16, v72
    v_and_b32 v177, s63, v72
    v_dot2c_f32_bf16 v216, s74, v73
    v_dot2c_f32_bf16 v217, v73, v73
    v_lshlrev_b32 v178, 16, v73
    v_and_b32 v179, s63, v73
    v_dot2c_f32_bf16 v216, s74, v74
    v_dot2c_f32_bf16 v217, v74, v74
    v_lshlrev_b32 v180, 16, v74
    v_and_b32 v181, s63, v74
    v_dot2c_f32_bf16 v216, s74, v75
    v_dot2c_f32_bf16 v217, v75, v75
    v_lshlrev_b32 v182, 16, v75
    v_and_b32 v183, s63, v75
    s_waitcnt vmcnt(9)
    v_dot2c_f32_bf16 v216, s74, v76
    v_dot2c_f32_bf16 v217, v76, v76
    v_lshlrev_b32 v184, 16, v76
    v_and_b32 v185, s63, v76
    v_dot2c_f32_bf16 v216, s74, v77
    v_dot2c_f32_bf16 v217, v77, v77
    v_lshlrev_b32 v186, 16, v77
    v_and_b32 v187, s63, v77
    v_dot2c_f32_bf16 v216, s74, v78
    v_dot2c_f32_bf16 v217, v78, v78
    v_lshlrev_b32 v188, 16, v78
    v_and_b32 v189, s63, v78
    v_dot2c_f32_bf16 v216, s74, v79
    v_dot2c_f32_bf16 v217, v79, v79
    v_lshlrev_b32 v190, 16, v79
    v_and_b32 v191, s63, v79
    s_waitcnt vmcnt(8)
    v_dot2c_f32_bf16 v216, s74, v80
    v_dot2c_f32_bf16 v217, v80, v80
    v_lshlrev_b32 v192, 16, v80
    v_and_b32 v193, s63, v80
    v_dot2c_f32_bf16 v216, s74, v81
    v_dot2c_f32_bf16 v217, v81, v81
    v_lshlrev_b32 v194, 16, v81
    v_and_b32 v195, s63, v81
    s_add_u32 m0, s55, 91136
    s_nop 0
    buffer_load_dwordx4 v19, s[8:11], s68 offen lds
    v_dot2c_f32_bf16 v216, s74, v82
    v_dot2c_f32_bf16 v217, v82, v82
    v_lshlrev_b32 v196, 16, v82
    v_and_b32 v197, s63, v82
    v_dot2c_f32_bf16 v216, s74, v83
    v_dot2c_f32_bf16 v217, v83, v83
    v_lshlrev_b32 v198, 16, v83
    v_and_b32 v199, s63, v83
    s_waitcnt vmcnt(8)
    v_dot2c_f32_bf16 v216, s74, v84
    v_dot2c_f32_bf16 v217, v84, v84
    v_lshlrev_b32 v200, 16, v84
    v_and_b32 v201, s63, v84
    v_dot2c_f32_bf16 v216, s74, v85
    v_dot2c_f32_bf16 v217, v85, v85
    v_lshlrev_b32 v202, 16, v85
    v_and_b32 v203, s63, v85
    v_dot2c_f32_bf16 v216, s74, v86
    v_dot2c_f32_bf16 v217, v86, v86
    v_lshlrev_b32 v204, 16, v86
    v_and_b32 v205, s63, v86
    v_dot2c_f32_bf16 v216, s74, v87
    v_dot2c_f32_bf16 v217, v87, v87
    v_lshlrev_b32 v206, 16, v87
    v_and_b32 v207, s63, v87
    v_add_f32_dpp v216, v216, v216 quad_perm:[1,0,3,2] row_mask:0xf bank_mask:0xf
    v_add_f32_dpp v217, v217, v217 quad_perm:[1,0,3,2] row_mask:0xf bank_mask:0xf
    s_nop 0
    v_add_f32_dpp v216, v216, v216 quad_perm:[2,3,0,1] row_mask:0xf bank_mask:0xf
    v_add_f32_dpp v217, v217, v217 quad_perm:[2,3,0,1] row_mask:0xf bank_mask:0xf
    v_mul_f32 v218, 0x3b124925, v216
    v_mul_f32 v219, 0x3b124925, v217
    v_fma_f32 v219, -v218, v218, v219
    v_max_f32 v219, 0, v219
    s_add_u32 m0, s55, 92160
    s_nop 0
    buffer_load_dwordx4 v20, s[8:11], s68 offen lds
    v_cvt_pk_bf16_f32 v220, 0, v219
    v_add_f32 v220, 0x3727c5ac, v220
    v_cvt_pk_bf16_f32 v220, 0, v220
    v_sqrt_f32 v220, v220
    s_nop 0
    v_cvt_pk_bf16_f32 v220, 0, v220
    v_rcp_f32 v220, v220
    s_nop 0
    v_mul_f32 v219, v219, v220
    v_mul_f32 v222, v218, v220
    v_mul_f32 v219, v219, v220
    v_cvt_pk_bf16_f32 v224, 0, v219
    v_add_f32 v224, 0x3727c5ac, v224
    v_cvt_pk_bf16_f32 v224, 0, v224
    v_sqrt_f32 v224, v224
    s_nop 0
    v_cvt_pk_bf16_f32 v224, 0, v224
    v_rcp_f32 v224, v224
    s_nop 0
    v_mul_f32 v224, v224, v220
    v_mul_f32 v226, v218, v224
    v_pk_fma_f32 v[228:229], v[96:97], v[224:225], v[226:227] op_sel_hi:[1,0,0] neg_lo:[0,0,1] neg_hi:[0,0,1]
    v_pk_fma_f32 v[230:231], v[98:99], v[224:225], v[226:227] op_sel_hi:[1,0,0] neg_lo:[0,0,1] neg_hi:[0,0,1]
    v_pk_fma_f32 v[232:233], v[100:101], v[224:225], v[226:227] op_sel_hi:[1,0,0] neg_lo:[0,0,1] neg_hi:[0,0,1]
    v_pk_fma_f32 v[234:235], v[102:103], v[224:225], v[226:227] op_sel_hi:[1,0,0] neg_lo:[0,0,1] neg_hi:[0,0,1]
    v_pk_fma_f32 v[236:237], v[104:105], v[224:225], v[226:227] op_sel_hi:[1,0,0] neg_lo:[0,0,1] neg_hi:[0,0,1]
    v_pk_fma_f32 v[238:239], v[106:107], v[224:225], v[226:227] op_sel_hi:[1,0,0] neg_lo:[0,0,1] neg_hi:[0,0,1]
    v_pk_fma_f32 v[240:241], v[108:109], v[224:225], v[226:227] op_sel_hi:[1,0,0] neg_lo:[0,0,1] neg_hi:[0,0,1]
    v_pk_fma_f32 v[242:243], v[110:111], v[224:225], v[226:227] op_sel_hi:[1,0,0] neg_lo:[0,0,1] neg_hi:[0,0,1]
    v_cvt_pk_bf16_f32 v244, v228, v229
    v_cvt_pk_bf16_f32 v245, v230, v231
    v_cvt_pk_bf16_f32 v246, v232, v233
    v_cvt_pk_bf16_f32 v247, v234, v235
    v_cvt_pk_bf16_f32 v248, v236, v237
    v_cvt_pk_bf16_f32 v249, v238, v239
    v_cvt_pk_bf16_f32 v250, v240, v241
    s_add_u32 m0, s55, 93184
    s_nop 0
    buffer_load_dwordx4 v21, s[8:11], s68 offen lds
    v_cvt_pk_bf16_f32 v251, v242, v243
    ds_write_b128 v24, v[244:247]
    ds_write_b128 v24, v[248:251] offset:4096
    ds_read_b64_tr_b16 v[228:229], v28 offset:0
    ds_read_b64_tr_b16 v[230:231], v253 offset:0
    ds_read_b64_tr_b16 v[232:233], v28 offset:4096
    ds_read_b64_tr_b16 v[234:235], v253 offset:4096
    v_pk_fma_f32 v[96:97], v[96:97], v[220:221], v[222:223] op_sel_hi:[1,0,0] neg_lo:[0,0,1] neg_hi:[0,0,1]
    v_pk_fma_f32 v[98:99], v[98:99], v[220:221], v[222:223] op_sel_hi:[1,0,0] neg_lo:[0,0,1] neg_hi:[0,0,1]
    v_pk_fma_f32 v[100:101], v[100:101], v[220:221], v[222:223] op_sel_hi:[1,0,0] neg_lo:[0,0,1] neg_hi:[0,0,1]
    v_pk_fma_f32 v[102:103], v[102:103], v[220:221], v[222:223] op_sel_hi:[1,0,0] neg_lo:[0,0,1] neg_hi:[0,0,1]
    v_cvt_pk_bf16_f32 v80, v96, v97
    v_cvt_pk_bf16_f32 v81, v98, v99
    v_cvt_pk_bf16_f32 v82, v100, v101
    v_cvt_pk_bf16_f32 v83, v102, v103
    ds_write_b128 v24, v[80:83] offset:0
    v_pk_fma_f32 v[104:105], v[104:105], v[220:221], v[222:223] op_sel_hi:[1,0,0] neg_lo:[0,0,1] neg_hi:[0,0,1]
    v_pk_fma_f32 v[106:107], v[106:107], v[220:221], v[222:223] op_sel_hi:[1,0,0] neg_lo:[0,0,1] neg_hi:[0,0,1]
    v_pk_fma_f32 v[108:109], v[108:109], v[220:221], v[222:223] op_sel_hi:[1,0,0] neg_lo:[0,0,1] neg_hi:[0,0,1]
    v_pk_fma_f32 v[110:111], v[110:111], v[220:221], v[222:223] op_sel_hi:[1,0,0] neg_lo:[0,0,1] neg_hi:[0,0,1]
    v_cvt_pk_bf16_f32 v84, v104, v105
    v_cvt_pk_bf16_f32 v85, v106, v107
    v_cvt_pk_bf16_f32 v86, v108, v109
    v_cvt_pk_bf16_f32 v87, v110, v111
    ds_write_b128 v24, v[84:87] offset:4096
    s_add_u32 m0, s55, 94208
    s_nop 0
    buffer_load_dwordx4 v22, s[8:11], s68 offen lds
    s_waitcnt lgkmcnt(2)
    buffer_store_dwordx4 v[228:231], v12, s[24:27], s64 offen offset:0 sc1
    buffer_store_dwordx4 v[232:235], v12, s[24:27], s64 offen offset:1024 sc1
    v_pk_fma_f32 v[112:113], v[112:113], v[220:221], v[222:223] op_sel_hi:[1,0,0] neg_lo:[0,0,1] neg_hi:[0,0,1]
    v_pk_fma_f32 v[114:115], v[114:115], v[220:221], v[222:223] op_sel_hi:[1,0,0] neg_lo:[0,0,1] neg_hi:[0,0,1]
    v_pk_fma_f32 v[116:117], v[116:117], v[220:221], v[222:223] op_sel_hi:[1,0,0] neg_lo:[0,0,1] neg_hi:[0,0,1]
    v_pk_fma_f32 v[118:119], v[118:119], v[220:221], v[222:223] op_sel_hi:[1,0,0] neg_lo:[0,0,1] neg_hi:[0,0,1]
    v_cvt_pk_bf16_f32 v88, v112, v113
    v_cvt_pk_bf16_f32 v89, v114, v115
    v_cvt_pk_bf16_f32 v90, v116, v117
    v_cvt_pk_bf16_f32 v91, v118, v119
    ds_write_b128 v24, v[88:91] offset:8192
    v_pk_fma_f32 v[120:121], v[120:121], v[220:221], v[222:223] op_sel_hi:[1,0,0] neg_lo:[0,0,1] neg_hi:[0,0,1]
    v_pk_fma_f32 v[122:123], v[122:123], v[220:221], v[222:223] op_sel_hi:[1,0,0] neg_lo:[0,0,1] neg_hi:[0,0,1]
    v_pk_fma_f32 v[124:125], v[124:125], v[220:221], v[222:223] op_sel_hi:[1,0,0] neg_lo:[0,0,1] neg_hi:[0,0,1]
    v_pk_fma_f32 v[126:127], v[126:127], v[220:221], v[222:223] op_sel_hi:[1,0,0] neg_lo:[0,0,1] neg_hi:[0,0,1]
    v_cvt_pk_bf16_f32 v92, v120, v121
    v_cvt_pk_bf16_f32 v93, v122, v123
    v_cvt_pk_bf16_f32 v94, v124, v125
    v_cvt_pk_bf16_f32 v95, v126, v127
    ds_write_b128 v24, v[92:95] offset:12288
    s_add_u32 m0, s55, 95232
    s_nop 0
    buffer_load_dwordx4 v23, s[8:11], s68 offen lds
    v_pk_fma_f32 v[128:129], v[128:129], v[220:221], v[222:223] op_sel_hi:[1,0,0] neg_lo:[0,0,1] neg_hi:[0,0,1]
    v_pk_fma_f32 v[130:131], v[130:131], v[220:221], v[222:223] op_sel_hi:[1,0,0] neg_lo:[0,0,1] neg_hi:[0,0,1]
    v_pk_fma_f32 v[132:133], v[132:133], v[220:221], v[222:223] op_sel_hi:[1,0,0] neg_lo:[0,0,1] neg_hi:[0,0,1]
    v_pk_fma_f32 v[134:135], v[134:135], v[220:221], v[222:223] op_sel_hi:[1,0,0] neg_lo:[0,0,1] neg_hi:[0,0,1]
    s_waitcnt lgkmcnt(3)
    v_cvt_pk_bf16_f32 v80, v128, v129
    v_cvt_pk_bf16_f32 v81, v130, v131
    v_cvt_pk_bf16_f32 v82, v132, v133
    v_cvt_pk_bf16_f32 v83, v134, v135
    ds_write_b128 v24, v[80:83] offset:16384
    v_pk_fma_f32 v[136:137], v[136:137], v[220:221], v[222:223] op_sel_hi:[1,0,0] neg_lo:[0,0,1] neg_hi:[0,0,1]
    v_pk_fma_f32 v[138:139], v[138:139], v[220:221], v[222:223] op_sel_hi:[1,0,0] neg_lo:[0,0,1] neg_hi:[0,0,1]
    v_pk_fma_f32 v[140:141], v[140:141], v[220:221], v[222:223] op_sel_hi:[1,0,0] neg_lo:[0,0,1] neg_hi:[0,0,1]
    v_pk_fma_f32 v[142:143], v[142:143], v[220:221], v[222:223] op_sel_hi:[1,0,0] neg_lo:[0,0,1] neg_hi:[0,0,1]
    s_waitcnt lgkmcnt(3)
    v_cvt_pk_bf16_f32 v84, v136, v137
    v_cvt_pk_bf16_f32 v85, v138, v139
    v_cvt_pk_bf16_f32 v86, v140, v141
    v_cvt_pk_bf16_f32 v87, v142, v143
    ds_write_b128 v24, v[84:87] offset:20480
    v_pk_fma_f32 v[144:145], v[144:145], v[220:221], v[222:223] op_sel_hi:[1,0,0] neg_lo:[0,0,1] neg_hi:[0,0,1]
    v_pk_fma_f32 v[146:147], v[146:147], v[220:221], v[222:223] op_sel_hi:[1,0,0] neg_lo:[0,0,1] neg_hi:[0,0,1]
    v_pk_fma_f32 v[148:149], v[148:149], v[220:221], v[222:223] op_sel_hi:[1,0,0] neg_lo:[0,0,1] neg_hi:[0,0,1]
    v_pk_fma_f32 v[150:151], v[150:151], v[220:221], v[222:223] op_sel_hi:[1,0,0] neg_lo:[0,0,1] neg_hi:[0,0,1]
    s_waitcnt lgkmcnt(3)
    v_cvt_pk_bf16_f32 v88, v144, v145
    v_cvt_pk_bf16_f32 v89, v146, v147
    v_cvt_pk_bf16_f32 v90, v148, v149
    v_cvt_pk_bf16_f32 v91, v150, v151
    ds_write_b128 v24, v[88:91] offset:24576
    buffer_load_dword v29, off, s[40:43], 0 sc1
    v_pk_fma_f32 v[152:153], v[152:153], v[220:221], v[222:223] op_sel_hi:[1,0,0] neg_lo:[0,0,1] neg_hi:[0,0,1]
    v_pk_fma_f32 v[154:155], v[154:155], v[220:221], v[222:223] op_sel_hi:[1,0,0] neg_lo:[0,0,1] neg_hi:[0,0,1]
    v_pk_fma_f32 v[156:157], v[156:157], v[220:221], v[222:223] op_sel_hi:[1,0,0] neg_lo:[0,0,1] neg_hi:[0,0,1]
    v_pk_fma_f32 v[158:159], v[158:159], v[220:221], v[222:223] op_sel_hi:[1,0,0] neg_lo:[0,0,1] neg_hi:[0,0,1]
    s_waitcnt lgkmcnt(3)
    v_cvt_pk_bf16_f32 v92, v152, v153
    v_cvt_pk_bf16_f32 v93, v154, v155
    v_cvt_pk_bf16_f32 v94, v156, v157
    v_cvt_pk_bf16_f32 v95, v158, v159
    ds_write_b128 v24, v[92:95] offset:28672
    s_add_u32 m0, s55, 114688
    s_nop 0
    buffer_load_dwordx4 v18, s[8:11], s69 offen lds
    v_pk_fma_f32 v[160:161], v[160:161], v[220:221], v[222:223] op_sel_hi:[1,0,0] neg_lo:[0,0,1] neg_hi:[0,0,1]
    v_pk_fma_f32 v[162:163], v[162:163], v[220:221], v[222:223] op_sel_hi:[1,0,0] neg_lo:[0,0,1] neg_hi:[0,0,1]
    v_pk_fma_f32 v[164:165], v[164:165], v[220:221], v[222:223] op_sel_hi:[1,0,0] neg_lo:[0,0,1] neg_hi:[0,0,1]
    v_pk_fma_f32 v[166:167], v[166:167], v[220:221], v[222:223] op_sel_hi:[1,0,0] neg_lo:[0,0,1] neg_hi:[0,0,1]
    s_waitcnt lgkmcnt(3)
    v_cvt_pk_bf16_f32 v80, v160, v161
    v_cvt_pk_bf16_f32 v81, v162, v163
    v_cvt_pk_bf16_f32 v82, v164, v165
    v_cvt_pk_bf16_f32 v83, v166, v167
    ds_write_b128 v24, v[80:83] offset:32768
    v_pk_fma_f32 v[168:169], v[168:169], v[220:221], v[222:223] op_sel_hi:[1,0,0] neg_lo:[0,0,1] neg_hi:[0,0,1]
    v_pk_fma_f32 v[170:171], v[170:171], v[220:221], v[222:223] op_sel_hi:[1,0,0] neg_lo:[0,0,1] neg_hi:[0,0,1]
    v_pk_fma_f32 v[172:173], v[172:173], v[220:221], v[222:223] op_sel_hi:[1,0,0] neg_lo:[0,0,1] neg_hi:[0,0,1]
    v_pk_fma_f32 v[174:175], v[174:175], v[220:221], v[222:223] op_sel_hi:[1,0,0] neg_lo:[0,0,1] neg_hi:[0,0,1]
    s_waitcnt lgkmcnt(3)
    v_cvt_pk_bf16_f32 v84, v168, v169
    v_cvt_pk_bf16_f32 v85, v170, v171
    v_cvt_pk_bf16_f32 v86, v172, v173
    v_cvt_pk_bf16_f32 v87, v174, v175
    ds_write_b128 v24, v[84:87] offset:36864
    s_add_u32 m0, s55, 115712
    s_nop 0
    buffer_load_dwordx4 v19, s[8:11], s69 offen lds
    v_pk_fma_f32 v[176:177], v[176:177], v[220:221], v[222:223] op_sel_hi:[1,0,0] neg_lo:[0,0,1] neg_hi:[0,0,1]
    v_pk_fma_f32 v[178:179], v[178:179], v[220:221], v[222:223] op_sel_hi:[1,0,0] neg_lo:[0,0,1] neg_hi:[0,0,1]
    v_pk_fma_f32 v[180:181], v[180:181], v[220:221], v[222:223] op_sel_hi:[1,0,0] neg_lo:[0,0,1] neg_hi:[0,0,1]
    v_pk_fma_f32 v[182:183], v[182:183], v[220:221], v[222:223] op_sel_hi:[1,0,0] neg_lo:[0,0,1] neg_hi:[0,0,1]
    s_waitcnt lgkmcnt(3)
    v_cvt_pk_bf16_f32 v88, v176, v177
    v_cvt_pk_bf16_f32 v89, v178, v179
    v_cvt_pk_bf16_f32 v90, v180, v181
    v_cvt_pk_bf16_f32 v91, v182, v183
    ds_write_b128 v24, v[88:91] offset:40960
    v_pk_fma_f32 v[184:185], v[184:185], v[220:221], v[222:223] op_sel_hi:[1,0,0] neg_lo:[0,0,1] neg_hi:[0,0,1]
    v_pk_fma_f32 v[186:187], v[186:187], v[220:221], v[222:223] op_sel_hi:[1,0,0] neg_lo:[0,0,1] neg_hi:[0,0,1]
    v_pk_fma_f32 v[188:189], v[188:189], v[220:221], v[222:223] op_sel_hi:[1,0,0] neg_lo:[0,0,1] neg_hi:[0,0,1]
    v_pk_fma_f32 v[190:191], v[190:191], v[220:221], v[222:223] op_sel_hi:[1,0,0] neg_lo:[0,0,1] neg_hi:[0,0,1]
    s_waitcnt lgkmcnt(3)
    v_cvt_pk_bf16_f32 v92, v184, v185
    v_cvt_pk_bf16_f32 v93, v186, v187
    v_cvt_pk_bf16_f32 v94, v188, v189
    v_cvt_pk_bf16_f32 v95, v190, v191
    ds_write_b128 v24, v[92:95] offset:45056
    s_add_u32 m0, s55, 116736
    s_nop 0
    buffer_load_dwordx4 v20, s[8:11], s69 offen lds
    v_pk_fma_f32 v[192:193], v[192:193], v[220:221], v[222:223] op_sel_hi:[1,0,0] neg_lo:[0,0,1] neg_hi:[0,0,1]
    v_pk_fma_f32 v[194:195], v[194:195], v[220:221], v[222:223] op_sel_hi:[1,0,0] neg_lo:[0,0,1] neg_hi:[0,0,1]
    v_pk_fma_f32 v[196:197], v[196:197], v[220:221], v[222:223] op_sel_hi:[1,0,0] neg_lo:[0,0,1] neg_hi:[0,0,1]
    v_pk_fma_f32 v[198:199], v[198:199], v[220:221], v[222:223] op_sel_hi:[1,0,0] neg_lo:[0,0,1] neg_hi:[0,0,1]
    s_waitcnt lgkmcnt(3)
    v_cvt_pk_bf16_f32 v80, v192, v193
    v_cvt_pk_bf16_f32 v81, v194, v195
    v_cvt_pk_bf16_f32 v82, v196, v197
    v_cvt_pk_bf16_f32 v83, v198, v199
    ds_write_b128 v24, v[80:83] offset:49152
    v_pk_fma_f32 v[200:201], v[200:201], v[220:221], v[222:223] op_sel_hi:[1,0,0] neg_lo:[0,0,1] neg_hi:[0,0,1]
    v_pk_fma_f32 v[202:203], v[202:203], v[220:221], v[222:223] op_sel_hi:[1,0,0] neg_lo:[0,0,1] neg_hi:[0,0,1]
    v_pk_fma_f32 v[204:205], v[204:205], v[220:221], v[222:223] op_sel_hi:[1,0,0] neg_lo:[0,0,1] neg_hi:[0,0,1]
    v_pk_fma_f32 v[206:207], v[206:207], v[220:221], v[222:223] op_sel_hi:[1,0,0] neg_lo:[0,0,1] neg_hi:[0,0,1]
    s_waitcnt lgkmcnt(3)
    v_cvt_pk_bf16_f32 v84, v200, v201
    v_cvt_pk_bf16_f32 v85, v202, v203
    v_cvt_pk_bf16_f32 v86, v204, v205
    v_cvt_pk_bf16_f32 v87, v206, v207
    ds_write_b128 v24, v[84:87] offset:53248
    s_add_u32 m0, s55, 117760
    s_nop 0
    buffer_load_dwordx4 v21, s[8:11], s69 offen lds
    s_waitcnt vmcnt(13)
    s_barrier
    ds_read_b128 a[224:227], v25 offset:0
    ds_read_b64_tr_b16 a[232:233], v26 offset:0
    ds_read_b64_tr_b16 a[234:235], v26 offset:512
    ds_read_b64_tr_b16 a[236:237], v26 offset:1024
    ds_read_b64_tr_b16 a[238:239], v26 offset:1536
    ds_read_b64_tr_b16 a[240:241], v26 offset:2048
    ds_read_b64_tr_b16 a[242:243], v26 offset:2560
    ds_read_b128 a[228:231], v252 offset:2048
    ds_read_b64_tr_b16 a[244:245], v26 offset:6144
    ds_read_b64_tr_b16 a[246:247], v26 offset:6656
    s_waitcnt lgkmcnt(7)
    v_mfma_f32_32x32x16_bf16 v[32:47], a[232:235], a[224:227], 0
    s_add_u32 m0, s55, 118784
    s_nop 0
    buffer_load_dwordx4 v22, s[8:11], s69 offen lds
    ds_read_b64_tr_b16 a[248:249], v26 offset:7168
    ds_read_b64_tr_b16 a[250:251], v26 offset:7680
    s_waitcnt lgkmcnt(7)
    v_mfma_f32_32x32x16_bf16 v[48:63], a[236:239], a[224:227], 0
    s_add_u32 m0, s55, 119808
    s_nop 0
    buffer_load_dwordx4 v23, s[8:11], s69 offen lds
    ds_read_b64_tr_b16 a[252:253], v26 offset:8192
    ds_read_b64_tr_b16 a[254:255], v26 offset:8704
    s_waitcnt lgkmcnt(7)
    v_mfma_f32_32x32x16_bf16 v[64:79], a[240:243], a[224:227], 0
    ds_read_b128 a[224:227], v25 offset:4096
    ds_read_b64_tr_b16 a[232:233], v26 offset:12288
    ds_read_b64_tr_b16 a[234:235], v26 offset:12800
    s_waitcnt lgkmcnt(7)
    v_mfma_f32_32x32x16_bf16 v[32:47], a[244:247], a[228:231], v[32:47]
    s_add_u32 m0, s55, 139264
    s_nop 0
    buffer_load_dwordx4 v18, s[8:11], s70 offen lds
    ds_read_b64_tr_b16 a[236:237], v26 offset:13312
    ds_read_b64_tr_b16 a[238:239], v26 offset:13824
    s_waitcnt lgkmcnt(7)
    v_mfma_f32_32x32x16_bf16 v[48:63], a[248:251], a[228:231], v[48:63]
    s_add_u32 m0, s55, 140288
    s_nop 0
    buffer_load_dwordx4 v19, s[8:11], s70 offen lds
    ds_read_b64_tr_b16 a[240:241], v26 offset:14336
    ds_read_b64_tr_b16 a[242:243], v26 offset:14848
    s_waitcnt lgkmcnt(7)
    v_mfma_f32_32x32x16_bf16 v[64:79], a[252:255], a[228:231], v[64:79]
    ds_read_b128 a[228:231], v252 offset:6144
    ds_read_b64_tr_b16 a[244:245], v26 offset:18432
    ds_read_b64_tr_b16 a[246:247], v26 offset:18944
    s_waitcnt lgkmcnt(7)
    v_mfma_f32_32x32x16_bf16 v[32:47], a[232:235], a[224:227], v[32:47]
    s_add_u32 m0, s55, 141312
    s_nop 0
    buffer_load_dwordx4 v20, s[8:11], s70 offen lds
    ds_read_b64_tr_b16 a[248:249], v26 offset:19456
    ds_read_b64_tr_b16 a[250:251], v26 offset:19968
    s_waitcnt lgkmcnt(7)
    v_mfma_f32_32x32x16_bf16 v[48:63], a[236:239], a[224:227], v[48:63]
    s_add_u32 m0, s55, 142336
    s_nop 0
    buffer_load_dwordx4 v21, s[8:11], s70 offen lds
    ds_read_b64_tr_b16 a[252:253], v26 offset:20480
    ds_read_b64_tr_b16 a[254:255], v26 offset:20992
    s_waitcnt lgkmcnt(7)
    v_mfma_f32_32x32x16_bf16 v[64:79], a[240:243], a[224:227], v[64:79]
    s_waitcnt vmcnt(11)
    s_barrier
    s_add_u32 m0, s55, 143360
    s_nop 0
    buffer_load_dwordx4 v22, s[8:11], s70 offen lds
    ds_read_b128 a[224:227], v25 offset:8192
    ds_read_b64_tr_b16 a[232:233], v26 offset:24576
    ds_read_b64_tr_b16 a[234:235], v26 offset:25088
    s_waitcnt lgkmcnt(7)
    v_mfma_f32_32x32x16_bf16 v[32:47], a[244:247], a[228:231], v[32:47]
    ds_read_b64_tr_b16 a[236:237], v26 offset:25600
    ds_read_b64_tr_b16 a[238:239], v26 offset:26112
    s_waitcnt lgkmcnt(7)
    v_mfma_f32_32x32x16_bf16 v[48:63], a[248:251], a[228:231], v[48:63]
    s_add_u32 m0, s55, 144384
    s_nop 0
    buffer_load_dwordx4 v23, s[8:11], s70 offen lds
    ds_read_b64_tr_b16 a[240:241], v26 offset:26624
    ds_read_b64_tr_b16 a[242:243], v26 offset:27136
    s_waitcnt lgkmcnt(7)
    v_mfma_f32_32x32x16_bf16 v[64:79], a[252:255], a[228:231], v[64:79]
    s_add_u32 m0, s52, 57344
    s_mov_b32 s57, 0
    buffer_load_dwordx4 v6, s[16:19], s57 offen lds
    ds_read_b128 a[228:231], v252 offset:10240
    ds_read_b64_tr_b16 a[244:245], v26 offset:30720
    ds_read_b64_tr_b16 a[246:247], v26 offset:31232
    s_waitcnt lgkmcnt(7)
    v_mfma_f32_32x32x16_bf16 v[32:47], a[232:235], a[224:227], v[32:47]
    ds_read_b64_tr_b16 a[248:249], v26 offset:31744
    ds_read_b64_tr_b16 a[250:251], v26 offset:32256
    s_waitcnt lgkmcnt(7)
    v_mfma_f32_32x32x16_bf16 v[48:63], a[236:239], a[224:227], v[48:63]
    buffer_load_dwordx4 v7, s[16:19], s57 offen offset:1024 lds
    ds_read_b64_tr_b16 a[252:253], v26 offset:32768
    ds_read_b64_tr_b16 a[254:255], v26 offset:33280
    s_waitcnt lgkmcnt(7)
    v_mfma_f32_32x32x16_bf16 v[64:79], a[240:243], a[224:227], v[64:79]
    ds_read_b128 a[224:227], v25 offset:12288
    ds_read_b64_tr_b16 a[232:233], v26 offset:36864
    ds_read_b64_tr_b16 a[234:235], v26 offset:37376
    s_waitcnt lgkmcnt(7)
    v_mfma_f32_32x32x16_bf16 v[32:47], a[244:247], a[228:231], v[32:47]
    ds_read_b64_tr_b16 a[236:237], v26 offset:37888
    ds_read_b64_tr_b16 a[238:239], v26 offset:38400
    s_waitcnt lgkmcnt(7)
    v_mfma_f32_32x32x16_bf16 v[48:63], a[248:251], a[228:231], v[48:63]
    ds_read_b64_tr_b16 a[240:241], v26 offset:38912
    ds_read_b64_tr_b16 a[242:243], v26 offset:39424
    s_waitcnt lgkmcnt(7)
    v_mfma_f32_32x32x16_bf16 v[64:79], a[252:255], a[228:231], v[64:79]
    ds_read_b128 a[228:231], v252 offset:14336
    ds_read_b64_tr_b16 a[244:245], v26 offset:43008
    ds_read_b64_tr_b16 a[246:247], v26 offset:43520
    s_waitcnt lgkmcnt(7)
    v_mfma_f32_32x32x16_bf16 v[32:47], a[232:235], a[224:227], v[32:47]
    ds_read_b64_tr_b16 a[248:249], v26 offset:44032
    ds_read_b64_tr_b16 a[250:251], v26 offset:44544
    s_waitcnt lgkmcnt(7)
    v_mfma_f32_32x32x16_bf16 v[48:63], a[236:239], a[224:227], v[48:63]
    ds_read_b64_tr_b16 a[252:253], v26 offset:45056
    ds_read_b64_tr_b16 a[254:255], v26 offset:45568
    s_waitcnt lgkmcnt(7)
    v_mfma_f32_32x32x16_bf16 v[64:79], a[240:243], a[224:227], v[64:79]
    s_waitcnt vmcnt(8)
    s_barrier
    s_add_u32 m0, s55, 65536
    s_nop 0
    buffer_load_dwordx4 v18, s[8:11], s71 offen lds
    ds_read_b128 a[224:227], v25 offset:16384
    ds_read_b64_tr_b16 a[232:233], v27 offset:0
    ds_read_b64_tr_b16 a[234:235], v27 offset:512
    s_waitcnt lgkmcnt(7)
    v_mfma_f32_32x32x16_bf16 v[32:47], a[244:247], a[228:231], v[32:47]
    s_add_u32 m0, s55, 66560
    s_nop 0
    buffer_load_dwordx4 v19, s[8:11], s71 offen lds
    ds_read_b64_tr_b16 a[236:237], v27 offset:1024
    ds_read_b64_tr_b16 a[238:239], v27 offset:1536
    s_waitcnt lgkmcnt(7)
    v_mfma_f32_32x32x16_bf16 v[48:63], a[248:251], a[228:231], v[48:63]
    ds_read_b64_tr_b16 a[240:241], v27 offset:2048
    ds_read_b64_tr_b16 a[242:243], v27 offset:2560
    s_waitcnt lgkmcnt(7)
    v_mfma_f32_32x32x16_bf16 v[64:79], a[252:255], a[228:231], v[64:79]
    s_add_u32 m0, s55, 67584
    s_nop 0
    buffer_load_dwordx4 v20, s[8:11], s71 offen lds
    ds_read_b128 a[228:231], v252 offset:18432
    ds_read_b64_tr_b16 a[244:245], v27 offset:6144
    ds_read_b64_tr_b16 a[246:247], v27 offset:6656
    s_waitcnt lgkmcnt(7)
    v_mfma_f32_32x32x16_bf16 v[32:47], a[232:235], a[224:227], v[32:47]
    s_add_u32 m0, s55, 68608
    s_nop 0
    buffer_load_dwordx4 v21, s[8:11], s71 offen lds
    ds_read_b64_tr_b16 a[248:249], v27 offset:7168
    ds_read_b64_tr_b16 a[250:251], v27 offset:7680
    s_waitcnt lgkmcnt(7)
    v_mfma_f32_32x32x16_bf16 v[48:63], a[236:239], a[224:227], v[48:63]
    ds_read_b64_tr_b16 a[252:253], v27 offset:8192
    ds_read_b64_tr_b16 a[254:255], v27 offset:8704
    s_waitcnt lgkmcnt(7)
    v_mfma_f32_32x32x16_bf16 v[64:79], a[240:243], a[224:227], v[64:79]
    s_add_u32 m0, s55, 69632
    s_nop 0
    buffer_load_dwordx4 v22, s[8:11], s71 offen lds
    ds_read_b128 a[224:227], v25 offset:20480
    ds_read_b64_tr_b16 a[232:233], v27 offset:12288
    ds_read_b64_tr_b16 a[234:235], v27 offset:12800
    s_waitcnt lgkmcnt(7)
    v_mfma_f32_32x32x16_bf16 v[32:47], a[244:247], a[228:231], v[32:47]
    s_add_u32 m0, s55, 70656
    s_nop 0
    buffer_load_dwordx4 v23, s[8:11], s71 offen lds
    ds_read_b64_tr_b16 a[236:237], v27 offset:13312
    ds_read_b64_tr_b16 a[238:239], v27 offset:13824
    s_waitcnt lgkmcnt(7)
    v_mfma_f32_32x32x16_bf16 v[48:63], a[248:251], a[228:231], v[48:63]
    ds_read_b64_tr_b16 a[240:241], v27 offset:14336
    ds_read_b64_tr_b16 a[242:243], v27 offset:14848
    s_waitcnt lgkmcnt(7)
    v_mfma_f32_32x32x16_bf16 v[64:79], a[252:255], a[228:231], v[64:79]
    s_add_u32 m0, s52, 0
    s_mov_b32 s57, 57344
    buffer_load_dwordx4 v6, s[16:19], s57 offen lds
    ds_read_b128 a[228:231], v252 offset:22528
    ds_read_b64_tr_b16 a[244:245], v27 offset:18432
    ds_read_b64_tr_b16 a[246:247], v27 offset:18944
    s_waitcnt lgkmcnt(7)
    v_mfma_f32_32x32x16_bf16 v[32:47], a[232:235], a[224:227], v[32:47]
    buffer_load_dwordx4 v7, s[16:19], s57 offen offset:1024 lds
    ds_read_b64_tr_b16 a[248:249], v27 offset:19456
    ds_read_b64_tr_b16 a[250:251], v27 offset:19968
    s_waitcnt lgkmcnt(7)
    v_mfma_f32_32x32x16_bf16 v[48:63], a[236:239], a[224:227], v[48:63]
    ds_read_b64_tr_b16 a[252:253], v27 offset:20480
    ds_read_b64_tr_b16 a[254:255], v27 offset:20992
    s_waitcnt lgkmcnt(7)
    v_mfma_f32_32x32x16_bf16 v[64:79], a[240:243], a[224:227], v[64:79]
    s_waitcnt vmcnt(10)
    v_cmp_eq_u32 vcc, 0, v29
    s_nop 0
    s_cbranch_vccz L_ok2
    s_mov_b32 s59, 20000
L_spin1:
    buffer_load_dword v29, off, s[40:43], 0 sc1
    s_waitcnt vmcnt(0)
    v_cmp_eq_u32 vcc, 0, v29
    s_nop 0
    s_cbranch_vccz L_ok2
    s_sub_u32 s59, s59, 1
    s_cbranch_scc0 L_spin1
L_ok2:
    v_readfirstlane_b32 s47, v29
    s_barrier
    s_cmp_lg_u32 s44, 0
    s_cbranch_scc1 L_nopub3
    s_lshl_b32 s62, s3, 5
    s_add_u32 s62, s62, s48
    s_lshl_b32 s62, s62, 7
    s_add_u32 s62, s62, 12582912
    v_mov_b32 v30, s47
    s_mov_b64 exec, 1
    buffer_store_dword v30, off, s[24:27], s62 sc1
    s_mov_b64 exec, -1
L_nopub3:
    s_add_u32 m0, s55, 90112
    s_nop 0
    buffer_load_dwordx4 v18, s[8:11], s72 offen lds
    ds_read_b128 a[224:227], v25 offset:24576
    ds_read_b64_tr_b16 a[232:233], v27 offset:24576
    ds_read_b64_tr_b16 a[234:235], v27 offset:25088
    s_waitcnt lgkmcnt(7)
    v_mfma_f32_32x32x16_bf16 v[32:47], a[244:247], a[228:231], v[32:47]
    s_add_u32 m0, s55, 91136
    s_nop 0
    buffer_load_dwordx4 v19, s[8:11], s72 offen lds
    s_waitcnt vmcnt(10)
    ds_read_b64_tr_b16 a[0:1], v16 offset:57344
    ds_read_b64_tr_b16 a[2:3], v16 offset:57856
    ds_read_b64_tr_b16 a[4:5], v16 offset:57600
    ds_read_b64_tr_b16 a[6:7], v16 offset:58112
    ds_read_b64_tr_b16 a[236:237], v27 offset:25600
    ds_read_b64_tr_b16 a[238:239], v27 offset:26112
    s_waitcnt lgkmcnt(11)
    v_mfma_f32_32x32x16_bf16 v[48:63], a[248:251], a[228:231], v[48:63]
    s_add_u32 m0, s55, 92160
    s_nop 0
    buffer_load_dwordx4 v20, s[8:11], s72 offen lds
    ds_read_b64_tr_b16 a[240:241], v27 offset:26624
    ds_read_b64_tr_b16 a[242:243], v27 offset:27136
    s_waitcnt lgkmcnt(11)
    v_mfma_f32_32x32x16_bf16 v[64:79], a[252:255], a[228:231], v[64:79]
    ds_read_b128 a[228:231], v252 offset:26624
    ds_read_b64_tr_b16 a[244:245], v27 offset:30720
    ds_read_b64_tr_b16 a[246:247], v27 offset:31232
    s_waitcnt lgkmcnt(11)
    v_mfma_f32_32x32x16_bf16 v[32:47], a[232:235], a[224:227], v[32:47]
    s_add_u32 m0, s55, 93184
    s_nop 0
    buffer_load_dwordx4 v21, s[8:11], s72 offen lds
    ds_read_b64_tr_b16 a[248:249], v27 offset:31744
    ds_read_b64_tr_b16 a[250:251], v27 offset:32256
    s_waitcnt lgkmcnt(7)
    v_mfma_f32_32x32x16_bf16 v[48:63], a[236:239], a[224:227], v[48:63]
    s_add_u32 m0, s55, 94208
    s_nop 0
    buffer_load_dwordx4 v22, s[8:11], s72 offen lds
    ds_read_b64_tr_b16 a[252:253], v27 offset:32768
    ds_read_b64_tr_b16 a[254:255], v27 offset:33280
    s_waitcnt lgkmcnt(7)
    v_mfma_f32_32x32x16_bf16 v[64:79], a[240:243], a[224:227], v[64:79]
    ds_read_b128 a[224:227], v25 offset:28672
    ds_read_b64_tr_b16 a[232:233], v27 offset:36864
    ds_read_b64_tr_b16 a[234:235], v27 offset:37376
    s_waitcnt lgkmcnt(7)
    v_mfma_f32_32x32x16_bf16 v[32:47], a[244:247], a[228:231], v[32:47]
    s_add_u32 m0, s55, 95232
    s_nop 0
    buffer_load_dwordx4 v23, s[8:11], s72 offen lds
    ds_read_b64_tr_b16 a[236:237], v27 offset:37888
    ds_read_b64_tr_b16 a[238:239], v27 offset:38400
    s_waitcnt lgkmcnt(7)
    v_mfma_f32_32x32x16_bf16 v[48:63], a[248:251], a[228:231], v[48:63]
    s_add_u32 m0, s52, 8192
    s_mov_b32 s57, 114688
    buffer_load_dwordx4 v6, s[16:19], s57 offen lds
    ds_read_b64_tr_b16 a[240:241], v27 offset:38912
    ds_read_b64_tr_b16 a[242:243], v27 offset:39424
    s_waitcnt lgkmcnt(7)
    v_mfma_f32_32x32x16_bf16 v[64:79], a[252:255], a[228:231], v[64:79]
    ds_read_b128 a[228:231], v252 offset:30720
    ds_read_b64_tr_b16 a[244:245], v27 offset:43008
    ds_read_b64_tr_b16 a[246:247], v27 offset:43520
    s_waitcnt lgkmcnt(7)
    v_mfma_f32_32x32x16_bf16 v[32:47], a[232:235], a[224:227], v[32:47]
    buffer_load_dwordx4 v7, s[16:19], s57 offen offset:1024 lds
    ds_read_b64_tr_b16 a[248:249], v27 offset:44032
    ds_read_b64_tr_b16 a[250:251], v27 offset:44544
    s_waitcnt lgkmcnt(7)
    v_mfma_f32_32x32x16_bf16 v[48:63], a[236:239], a[224:227], v[48:63]
    ds_read_b64_tr_b16 a[252:253], v27 offset:45056
    ds_read_b64_tr_b16 a[254:255], v27 offset:45568
    s_waitcnt lgkmcnt(7)
    v_mfma_f32_32x32x16_bf16 v[64:79], a[240:243], a[224:227], v[64:79]
    s_waitcnt vmcnt(10)
    s_barrier
    s_add_u32 m0, s55, 114688
    s_nop 0
    buffer_load_dwordx4 v18, s[8:11], s73 offen lds
    ds_read_b128 a[224:227], v25 offset:32768
    ds_read_b64_tr_b16 a[232:233], v26 offset:0
    ds_read_b64_tr_b16 a[234:235], v26 offset:512
    s_waitcnt lgkmcnt(7)
    v_mfma_f32_32x32x16_bf16 v[32:47], a[244:247], a[228:231], v[32:47]
    s_add_u32 m0, s55, 115712
    s_nop 0
    buffer_load_dwordx4 v19, s[8:11], s73 offen lds
    s_waitcnt vmcnt(10)
    ds_read_b64_tr_b16 a[8:9], v16 offset:0
    ds_read_b64_tr_b16 a[10:11], v16 offset:512
    ds_read_b64_tr_b16 a[12:13], v16 offset:256
    ds_read_b64_tr_b16 a[14:15], v16 offset:768
    ds_read_b64_tr_b16 a[236:237], v26 offset:1024
    ds_read_b64_tr_b16 a[238:239], v26 offset:1536
    s_waitcnt lgkmcnt(11)
    v_mfma_f32_32x32x16_bf16 v[48:63], a[248:251], a[228:231], v[48:63]
    s_add_u32 m0, s55, 116736
    s_nop 0
    buffer_load_dwordx4 v20, s[8:11], s73 offen lds
    ds_read_b64_tr_b16 a[240:241], v26 offset:2048
    ds_read_b64_tr_b16 a[242:243], v26 offset:2560
    s_waitcnt lgkmcnt(11)
    v_mfma_f32_32x32x16_bf16 v[64:79], a[252:255], a[228:231], v[64:79]
    ds_read_b128 a[228:231], v252 offset:34816
    ds_read_b64_tr_b16 a[244:245], v26 offset:6144
    ds_read_b64_tr_b16 a[246:247], v26 offset:6656
    s_waitcnt lgkmcnt(11)
    v_mfma_f32_32x32x16_bf16 v[32:47], a[232:235], a[224:227], v[32:47]
    s_add_u32 m0, s55, 117760
    s_nop 0
    buffer_load_dwordx4 v21, s[8:11], s73 offen lds
    ds_read_b64_tr_b16 a[248:249], v26 offset:7168
    ds_read_b64_tr_b16 a[250:251], v26 offset:7680
    s_waitcnt lgkmcnt(7)
    v_mfma_f32_32x32x16_bf16 v[48:63], a[236:239], a[224:227], v[48:63]
    s_add_u32 m0, s55, 118784
    s_nop 0
    buffer_load_dwordx4 v22, s[8:11], s73 offen lds
    ds_read_b64_tr_b16 a[252:253], v26 offset:8192
    ds_read_b64_tr_b16 a[254:255], v26 offset:8704
    s_waitcnt lgkmcnt(7)
    v_mfma_f32_32x32x16_bf16 v[64:79], a[240:243], a[224:227], v[64:79]
    ds_read_b128 a[224:227], v25 offset:36864
    ds_read_b64_tr_b16 a[232:233], v26 offset:12288
    ds_read_b64_tr_b16 a[234:235], v26 offset:12800
    s_waitcnt lgkmcnt(7)
    v_mfma_f32_32x32x16_bf16 v[32:47], a[244:247], a[228:231], v[32:47]
    s_add_u32 m0, s55, 119808
    s_nop 0
    buffer_load_dwordx4 v23, s[8:11], s73 offen lds
    ds_read_b64_tr_b16 a[236:237], v26 offset:13312
    ds_read_b64_tr_b16 a[238:239], v26 offset:13824
    s_waitcnt lgkmcnt(7)
    v_mfma_f32_32x32x16_bf16 v[48:63], a[248:251], a[228:231], v[48:63]
    buffer_load_dword v255, v254, s[16:19], s66 offen
    ds_read_b64_tr_b16 a[240:241], v26 offset:14336
    ds_read_b64_tr_b16 a[242:243], v26 offset:14848
    s_waitcnt lgkmcnt(7)
    v_mfma_f32_32x32x16_bf16 v[64:79], a[252:255], a[228:231], v[64:79]
    ds_read_b128 a[228:231], v252 offset:38912
    ds_read_b64_tr_b16 a[244:245], v26 offset:18432
    ds_read_b64_tr_b16 a[246:247], v26 offset:18944
    s_waitcnt lgkmcnt(7)
    v_mfma_f32_32x32x16_bf16 v[32:47], a[232:235], a[224:227], v[32:47]
    s_add_u32 m0, s52, 16384
    s_mov_b32 s57, 172032
    buffer_load_dwordx4 v6, s[16:19], s57 offen lds
    ds_read_b64_tr_b16 a[248:249], v26 offset:19456
    ds_read_b64_tr_b16 a[250:251], v26 offset:19968
    s_waitcnt lgkmcnt(7)
    v_mfma_f32_32x32x16_bf16 v[48:63], a[236:239], a[224:227], v[48:63]
    buffer_load_dwordx4 v7, s[16:19], s57 offen offset:1024 lds
    ds_read_b64_tr_b16 a[252:253], v26 offset:20480
    ds_read_b64_tr_b16 a[254:255], v26 offset:20992
    s_waitcnt lgkmcnt(7)
    v_mfma_f32_32x32x16_bf16 v[64:79], a[240:243], a[224:227], v[64:79]
    s_waitcnt vmcnt(11)
    s_barrier
    s_add_u32 m0, s52, 139264
    s_mov_b32 s57, 229376
    buffer_load_dwordx4 v6, s[16:19], s57 offen lds
    s_waitcnt vmcnt(10)
    ds_read_b64_tr_b16 a[16:17], v16 offset:8192
    ds_read_b64_tr_b16 a[18:19], v16 offset:8704
    ds_read_b64_tr_b16 a[20:21], v16 offset:8448
    ds_read_b64_tr_b16 a[22:23], v16 offset:8960
    ds_read_b128 a[224:227], v25 offset:40960
    ds_read_b64_tr_b16 a[232:233], v26 offset:24576
    ds_read_b64_tr_b16 a[234:235], v26 offset:25088
    s_waitcnt lgkmcnt(11)
    v_mfma_f32_32x32x16_bf16 v[32:47], a[244:247], a[228:231], v[32:47]
    buffer_load_dwordx4 v7, s[16:19], s57 offen offset:1024 lds
    ds_read_b64_tr_b16 a[236:237], v26 offset:25600
    ds_read_b64_tr_b16 a[238:239], v26 offset:26112
    s_waitcnt lgkmcnt(11)
    v_mfma_f32_32x32x16_bf16 v[48:63], a[248:251], a[228:231], v[48:63]
    ds_read_b64_tr_b16 a[240:241], v26 offset:26624
    ds_read_b64_tr_b16 a[242:243], v26 offset:27136
    s_waitcnt lgkmcnt(11)
    v_mfma_f32_32x32x16_bf16 v[64:79], a[252:255], a[228:231], v[64:79]
    s_add_u32 m0, s52, 147456
    s_mov_b32 s57, 286720
    buffer_load_dwordx4 v6, s[16:19], s57 offen lds
    ds_read_b128 a[228:231], v252 offset:43008
    ds_read_b64_tr_b16 a[244:245], v26 offset:30720
    ds_read_b64_tr_b16 a[246:247], v26 offset:31232
    s_waitcnt lgkmcnt(7)
    v_mfma_f32_32x32x16_bf16 v[32:47], a[232:235], a[224:227], v[32:47]
    buffer_load_dwordx4 v7, s[16:19], s57 offen offset:1024 lds
    ds_read_b64_tr_b16 a[248:249], v26 offset:31744
    ds_read_b64_tr_b16 a[250:251], v26 offset:32256
    s_waitcnt lgkmcnt(7)
    v_mfma_f32_32x32x16_bf16 v[48:63], a[236:239], a[224:227], v[48:63]
    ds_read_b64_tr_b16 a[252:253], v26 offset:32768
    ds_read_b64_tr_b16 a[254:255], v26 offset:33280
    s_waitcnt lgkmcnt(7)
    v_mfma_f32_32x32x16_bf16 v[64:79], a[240:243], a[224:227], v[64:79]
    s_add_u32 m0, s52, 155648
    s_mov_b32 s57, 344064
    buffer_load_dwordx4 v6, s[16:19], s57 offen lds
    ds_read_b128 a[224:227], v25 offset:45056
    ds_read_b64_tr_b16 a[232:233], v26 offset:36864
    ds_read_b64_tr_b16 a[234:235], v26 offset:37376
    s_waitcnt lgkmcnt(7)
    v_mfma_f32_32x32x16_bf16 v[32:47], a[244:247], a[228:231], v[32:47]
    buffer_load_dwordx4 v7, s[16:19], s57 offen offset:1024 lds
    ds_read_b64_tr_b16 a[236:237], v26 offset:37888
    ds_read_b64_tr_b16 a[238:239], v26 offset:38400
    s_waitcnt lgkmcnt(7)
    v_mfma_f32_32x32x16_bf16 v[48:63], a[248:251], a[228:231], v[48:63]
    ds_read_b64_tr_b16 a[240:241], v26 offset:38912
    ds_read_b64_tr_b16 a[242:243], v26 offset:39424
    s_waitcnt lgkmcnt(7)
    v_mfma_f32_32x32x16_bf16 v[64:79], a[252:255], a[228:231], v[64:79]
    s_add_u32 m0, s52, 24576
    s_mov_b32 s57, 401408
    buffer_load_dwordx4 v6, s[16:19], s57 offen lds
    ds_read_b128 a[228:231], v252 offset:47104
    ds_read_b64_tr_b16 a[244:245], v26 offset:43008
    ds_read_b64_tr_b16 a[246:247], v26 offset:43520
    s_waitcnt lgkmcnt(7)
    v_mfma_f32_32x32x16_bf16 v[32:47], a[232:235], a[224:227], v[32:47]
    buffer_load_dwordx4 v7, s[16:19], s57 offen offset:1024 lds
    ds_read_b64_tr_b16 a[248:249], v26 offset:44032
    ds_read_b64_tr_b16 a[250:251], v26 offset:44544
    s_waitcnt lgkmcnt(7)
    v_mfma_f32_32x32x16_bf16 v[48:63], a[236:239], a[224:227], v[48:63]
    ds_read_b64_tr_b16 a[252:253], v26 offset:45056
    ds_read_b64_tr_b16 a[254:255], v26 offset:45568
    s_waitcnt lgkmcnt(7)
    v_mfma_f32_32x32x16_bf16 v[64:79], a[240:243], a[224:227], v[64:79]
    s_waitcnt vmcnt(11)
    s_barrier
    s_add_u32 m0, s52, 65536
    s_mov_b32 s57, 458752
    buffer_load_dwordx4 v6, s[16:19], s57 offen lds
    ds_read_b128 a[224:227], v25 offset:49152
    ds_read_b64_tr_b16 a[232:233], v27 offset:0
    ds_read_b64_tr_b16 a[234:235], v27 offset:512
    s_waitcnt lgkmcnt(7)
    v_mfma_f32_32x32x16_bf16 v[32:47], a[244:247], a[228:231], v[32:47]
    buffer_load_dwordx4 v7, s[16:19], s57 offen offset:1024 lds
    s_waitcnt vmcnt(10)
    ds_read_b64_tr_b16 a[24:25], v16 offset:16384
    ds_read_b64_tr_b16 a[26:27], v16 offset:16896
    ds_read_b64_tr_b16 a[28:29], v16 offset:16640
    ds_read_b64_tr_b16 a[30:31], v16 offset:17152
    ds_read_b64_tr_b16 a[236:237], v27 offset:1024
    ds_read_b64_tr_b16 a[238:239], v27 offset:1536
    s_waitcnt lgkmcnt(11)
    v_mfma_f32_32x32x16_bf16 v[48:63], a[248:251], a[228:231], v[48:63]
    s_add_u32 m0, s52, 73728
    s_mov_b32 s57, 516096
    buffer_load_dwordx4 v6, s[16:19], s57 offen lds
    ds_read_b64_tr_b16 a[240:241], v27 offset:2048
    ds_read_b64_tr_b16 a[242:243], v27 offset:2560
    s_waitcnt lgkmcnt(11)
    v_mfma_f32_32x32x16_bf16 v[64:79], a[252:255], a[228:231], v[64:79]
    ds_read_b128 a[228:231], v252 offset:51200
    ds_read_b64_tr_b16 a[244:245], v27 offset:6144
    ds_read_b64_tr_b16 a[246:247], v27 offset:6656
    s_waitcnt lgkmcnt(11)
    v_mfma_f32_32x32x16_bf16 v[32:47], a[232:235], a[224:227], v[32:47]
    buffer_load_dwordx4 v7, s[16:19], s57 offen offset:1024 lds
    s_waitcnt vmcnt(10)
    ds_read_b64_tr_b16 a[32:33], v3 offset:8192
    ds_read_b64_tr_b16 a[34:35], v3 offset:8704
    ds_read_b64_tr_b16 a[36:37], v3 offset:8448
    ds_read_b64_tr_b16 a[38:39], v3 offset:8960
    ds_read_b64_tr_b16 a[248:249], v27 offset:7168
    ds_read_b64_tr_b16 a[250:251], v27 offset:7680
    s_waitcnt lgkmcnt(11)
    v_mfma_f32_32x32x16_bf16 v[48:63], a[236:239], a[224:227], v[48:63]
    s_add_u32 m0, s52, 81920
    s_mov_b32 s57, 573440
    buffer_load_dwordx4 v6, s[16:19], s57 offen lds
    ds_read_b64_tr_b16 a[252:253], v27 offset:8192
    ds_read_b64_tr_b16 a[254:255], v27 offset:8704
    s_waitcnt lgkmcnt(11)
    v_mfma_f32_32x32x16_bf16 v[64:79], a[240:243], a[224:227], v[64:79]
    buffer_load_dwordx4 v7, s[16:19], s57 offen offset:1024 lds
    s_waitcnt vmcnt(10)
    ds_read_b64_tr_b16 a[40:41], v3 offset:16384
    ds_read_b64_tr_b16 a[42:43], v3 offset:16896
    ds_read_b64_tr_b16 a[44:45], v3 offset:16640
    ds_read_b64_tr_b16 a[46:47], v3 offset:17152
    ds_read_b128 a[224:227], v25 offset:53248
    ds_read_b64_tr_b16 a[232:233], v27 offset:12288
    ds_read_b64_tr_b16 a[234:235], v27 offset:12800
    s_waitcnt lgkmcnt(15)
    v_mfma_f32_32x32x16_bf16 v[32:47], a[244:247], a[228:231], v[32:47]
    s_add_u32 m0, s52, 32768
    s_mov_b32 s57, 630784
    buffer_load_dwordx4 v6, s[16:19], s57 offen lds
    ds_read_b64_tr_b16 a[236:237], v27 offset:13312
    ds_read_b64_tr_b16 a[238:239], v27 offset:13824
    s_waitcnt lgkmcnt(11)
    v_mfma_f32_32x32x16_bf16 v[48:63], a[248:251], a[228:231], v[48:63]
    ds_read_b64_tr_b16 a[240:241], v27 offset:14336
    ds_read_b64_tr_b16 a[242:243], v27 offset:14848
    s_waitcnt lgkmcnt(11)
    v_mfma_f32_32x32x16_bf16 v[64:79], a[252:255], a[228:231], v[64:79]
    buffer_load_dwordx4 v7, s[16:19], s57 offen offset:1024 lds
    s_waitcnt vmcnt(10)
    ds_read_b64_tr_b16 a[48:49], v3 offset:24576
    ds_read_b64_tr_b16 a[50:51], v3 offset:25088
    ds_read_b64_tr_b16 a[52:53], v3 offset:24832
    ds_read_b64_tr_b16 a[54:55], v3 offset:25344
    ds_read_b128 a[228:231], v252 offset:55296
    ds_read_b64_tr_b16 a[244:245], v27 offset:18432
    ds_read_b64_tr_b16 a[246:247], v27 offset:18944
    s_waitcnt lgkmcnt(11)
    v_mfma_f32_32x32x16_bf16 v[32:47], a[232:235], a[224:227], v[32:47]
    ds_read_b64_tr_b16 a[248:249], v27 offset:19456
    ds_read_b64_tr_b16 a[250:251], v27 offset:19968
    s_waitcnt lgkmcnt(11)
    v_mfma_f32_32x32x16_bf16 v[48:63], a[236:239], a[224:227], v[48:63]
    ds_read_b64_tr_b16 a[252:253], v27 offset:20480
    ds_read_b64_tr_b16 a[254:255], v27 offset:20992
    s_waitcnt lgkmcnt(11)
    v_mfma_f32_32x32x16_bf16 v[64:79], a[240:243], a[224:227], v[64:79]
    s_barrier
    s_add_u32 m0, s52, 90112
    s_mov_b32 s57, 688128
    buffer_load_dwordx4 v6, s[16:19], s57 offen lds
    s_waitcnt lgkmcnt(4)
    v_mfma_f32_32x32x16_bf16 v[32:47], a[244:247], a[228:231], v[32:47]
    buffer_load_dwordx4 v7, s[16:19], s57 offen offset:1024 lds
    s_waitcnt vmcnt(10)
    ds_read_b64_tr_b16 a[56:57], v16 offset:24576
    ds_read_b64_tr_b16 a[58:59], v16 offset:25088
    ds_read_b64_tr_b16 a[60:61], v16 offset:24832
    ds_read_b64_tr_b16 a[62:63], v16 offset:25344
    s_waitcnt lgkmcnt(6)
    v_mfma_f32_32x32x16_bf16 v[48:63], a[248:251], a[228:231], v[48:63]
    s_add_u32 m0, s52, 98304
    s_mov_b32 s57, 745472
    buffer_load_dwordx4 v6, s[16:19], s57 offen lds
    s_waitcnt lgkmcnt(4)
    v_mfma_f32_32x32x16_bf16 v[64:79], a[252:255], a[228:231], v[64:79]
    s_barrier
    buffer_load_dwordx4 v7, s[16:19], s57 offen offset:1024 lds
    s_waitcnt vmcnt(10)
    ds_read_b64_tr_b16 a[64:65], v2 offset:0
    ds_read_b64_tr_b16 a[66:67], v2 offset:512
    ds_read_b64_tr_b16 a[68:69], v2 offset:256
    ds_read_b64_tr_b16 a[70:71], v2 offset:768
    v_lshrrev_b32 v29, 5, v1
    v_and_b32 v30, 31, v1
    v_lshlrev_b32 v29, 15, v29
    v_lshl_add_u32 v29, v30, 4, v29
    s_mul_i32 s64, s49, 24
    s_lshr_b32 s54, s44, 1
    s_lshl2_add_u32 s64, s54, s64
    s_lshl_b32 s64, s64, 15
    s_lshl_b32 s54, s48, 10
    s_add_u32 s64, s64, s54
    s_and_b32 s54, s44, 1
    s_lshl_b32 s54, s54, 9
    s_add_u32 s93, s64, s54
    v_cvt_pk_bf16_f32 v160, v32, v33
    v_cvt_pk_bf16_f32 v161, v34, v35
    v_cvt_pk_bf16_f32 v162, v36, v37
    v_cvt_pk_bf16_f32 v163, v38, v39
    v_cvt_pk_bf16_f32 v164, v40, v41
    v_cvt_pk_bf16_f32 v165, v42, v43
    v_cvt_pk_bf16_f32 v166, v44, v45
    v_cvt_pk_bf16_f32 v167, v46, v47
    v_permlane32_swap_b32 v160, v162
    v_permlane32_swap_b32 v161, v163
    v_permlane32_swap_b32 v164, v166
    v_permlane32_swap_b32 v165, v167
    v_cvt_pk_bf16_f32 v168, v48, v49
    v_cvt_pk_bf16_f32 v169, v50, v51
    v_cvt_pk_bf16_f32 v170, v52, v53
    v_cvt_pk_bf16_f32 v171, v54, v55
    v_cvt_pk_bf16_f32 v172, v56, v57
    v_cvt_pk_bf16_f32 v173, v58, v59
    v_cvt_pk_bf16_f32 v174, v60, v61
    v_cvt_pk_bf16_f32 v175, v62, v63
    v_permlane32_swap_b32 v168, v170
    v_permlane32_swap_b32 v169, v171
    v_permlane32_swap_b32 v172, v174
    v_permlane32_swap_b32 v173, v175
    v_cvt_pk_bf16_f32 v176, v64, v65
    v_cvt_pk_bf16_f32 v177, v66, v67
    v_cvt_pk_bf16_f32 v178, v68, v69
    v_cvt_pk_bf16_f32 v179, v70, v71
    v_cvt_pk_bf16_f32 v180, v72, v73
    v_cvt_pk_bf16_f32 v181, v74, v75
    v_cvt_pk_bf16_f32 v182, v76, v77
    v_cvt_pk_bf16_f32 v183, v78, v79
    v_permlane32_swap_b32 v176, v178
    v_permlane32_swap_b32 v177, v179
    v_permlane32_swap_b32 v180, v182
    v_permlane32_swap_b32 v181, v183
    s_cmp_eq_u32 s75, 0
    s_cbranch_scc1 L_nop2
    s_add_u32 s94, s93, 6291456
    buffer_store_dwordx4 v[160:163], v29, s[24:27], s94 offen sc1
    s_lshl_b32 s53, s51, 5
    s_lshl3_add_u32 s53, s44, s53
    s_lshl_b32 s53, s53, 7
    s_add_u32 s53, s53, 12582912
    v_and_b32 v185, 7, v1
    v_lshl_add_u32 v185, v185, 7, s53
    s_lshl_b32 s53, s50, 7
    s_lshr_b32 s54, s44, 1
    s_add_u32 m0, s52, 106496
    s_mov_b32 s57, 802816
    buffer_load_dwordx4 v6, s[16:19], s57 offen lds
    s_waitcnt vmcnt(10)
    ds_read_b64_tr_b16 a[72:73], v2 offset:8192
    ds_read_b64_tr_b16 a[74:75], v2 offset:8704
    ds_read_b64_tr_b16 a[76:77], v2 offset:8448
    ds_read_b64_tr_b16 a[78:79], v2 offset:8960
    s_lshl_b32 s54, s54, 6
    s_add_u32 s53, s53, s54
    v_lshrrev_b32 v186, 5, v1
    v_lshl_add_u32 v186, v186, 3, s53
    s_mul_i32 s60, s51, 268032
    s_mul_i32 s54, s44, 66816
    s_add_u32 s60, s60, s54
    s_and_b32 s53, s44, 1
    s_lshl_b32 s53, s53, 10
    v_add_u32 v13, s53, v12
    v_xor_b32 v14, 1024, v13
    s_mul_i32 s64, s51, 235264
    buffer_load_dwordx4 v7, s[16:19], s57 offen offset:1024 lds
    s_lshl_b32 s54, s50, 13
    s_add_u32 s64, s64, s54
    s_mul_i32 s54, s50, 37
    s_lshr_b32 s54, s54, 8
    s_mul_i32 s54, s54, 1280
    s_add_u32 s64, s64, s54
    s_lshr_b32 s54, s44, 1
    s_lshl_b32 s54, s54, 12
    s_add_u32 s64, s64, s54
    s_add_u32 s64, s64, 2097152
    v_add_u32 v196, s52, v12
    v_xor_b32 v197, 2048, v196
    v_xor_b32 v198, 4096, v196
    v_xor_b32 v199, 6144, v196
    s_add_u32 s53, s52, 65536
    v_lshl_add_u32 v4, v210, 9, v213
    v_add_u32 v4, s53, v4
    v_add_u32 v5, 65536, v4
    s_add_u32 s94, s93, 6356992
    buffer_store_dwordx4 v[164:167], v29, s[24:27], s94 offen sc1
    s_waitcnt vmcnt(10)
    ds_read_b64_tr_b16 a[80:81], v2 offset:16384
    ds_read_b64_tr_b16 a[82:83], v2 offset:16896
    ds_read_b64_tr_b16 a[84:85], v2 offset:16640
    ds_read_b64_tr_b16 a[86:87], v2 offset:17152
    s_mul_i32 s53, s44, 1835008
    s_lshl_b32 s91, s76, 7
    s_add_u32 s53, s53, s91
    v_lshlrev_b32 v8, 12, v208
    v_add3_u32 v8, v8, v209, s53
    v_add_u32 v9, 31744, v8
    s_mul_i32 s53, s44, 100352
    s_lshl_b32 s54, s77, 7
    s_add_u32 s53, s53, s54
    v_mul_u32_u24 v10, 896, v208
    v_add3_u32 v10, v10, v209, s53
    v_add_u32 v11, 6144, v10
    s_add_u32 m0, s52, 40960
    s_mov_b32 s57, 860160
    buffer_load_dwordx4 v6, s[16:19], s57 offen lds
    s_mul_i32 s89, s76, 57344
    s_add_u32 s89, s89, s54
    s_add_u32 s90, s89, 28672
    v_add_u32 v15, 1024, v12
    v_and_b32 v207, 7, v1
    v_min_u32 v207, 6, v207
    s_lshl3_add_u32 s53, s45, s44
    s_lshl_b32 s53, s53, 7
    s_add_u32 s53, s53, 12779520
    v_mov_b32 v202, s53
    s_lshl_b32 s53, s77, 5
    s_mul_i32 s54, s44, 7
    s_add_u32 s53, s53, s54
    s_lshl_b32 s53, s53, 7
    s_add_u32 s53, s53, 12713984
    v_lshl_add_u32 v204, v207, 7, s53
    buffer_load_dwordx4 v7, s[16:19], s57 offen offset:1024 lds
    s_waitcnt vmcnt(10)
    ds_read_b64_tr_b16 a[88:89], v16 offset:32768
    ds_read_b64_tr_b16 a[90:91], v16 offset:33280
    ds_read_b64_tr_b16 a[92:93], v16 offset:33024
    ds_read_b64_tr_b16 a[94:95], v16 offset:33536
    s_lshl_b32 s88, s76, 16
    s_lshl_b32 s54, s44, 14
    s_add_u32 s88, s88, s54
    s_add_u32 s88, s88, 4194304
    s_mul_i32 s61, s77, 235264
    s_mul_i32 s54, s44, 58624
    s_add_u32 s61, s61, s54
    s_add_u32 s61, s61, 2097152
    v_lshrrev_b32 v218, 3, v0
    v_and_b32 v219, 7, v0
    v_mul_u32_u24 v205, 896, v218
    v_lshl_add_u32 v205, v219, 4, v205
    s_add_u32 s94, s93, 6553600
    buffer_store_dwordx4 v[168:171], v29, s[24:27], s94 offen sc1
    v_lshlrev_b32 v206, 1, v218
    v_and_b32 v230, 7, v218
    v_xor_b32 v219, v219, v230
    v_lshrrev_b32 v231, 3, v218
    v_lshlrev_b32 v228, 13, v231
    v_lshl_add_u32 v228, v230, 8, v228
    v_lshl_add_u32 v228, v219, 4, v228
    v_bfe_u32 v231, v218, 1, 1
    v_lshl_add_u32 v228, v231, 7, v228
    v_xor_b32 v229, 128, v228
    v_bfe_u32 v231, v1, 3, 2
    v_and_b32 v230, 7, v1
    v_lshlrev_b32 v220, 13, v231
    v_lshl_add_u32 v220, v230, 8, v220
    v_lshl_add_u32 v220, v230, 4, v220
    v_add_u32 v220, s52, v220
    s_add_u32 m0, s52, 114688
    s_mov_b32 s57, 917504
    buffer_load_dwordx4 v6, s[16:19], s57 offen lds
    s_waitcnt vmcnt(10)
    ds_read_b64_tr_b16 a[96:97], v2 offset:24576
    ds_read_b64_tr_b16 a[98:99], v2 offset:25088
    ds_read_b64_tr_b16 a[100:101], v2 offset:24832
    ds_read_b64_tr_b16 a[102:103], v2 offset:25344
    v_bfe_u32 v231, v1, 1, 1
    v_xor_b32 v230, v210, v231
    v_lshl_add_u32 v220, v230, 7, v220
    v_xor_b32 v221, 16, v220
    v_xor_b32 v222, 32, v220
    v_xor_b32 v223, 48, v220
    v_xor_b32 v224, 64, v220
    v_xor_b32 v225, 80, v220
    v_xor_b32 v226, 96, v220
    v_xor_b32 v227, 112, v220
    buffer_load_dwordx4 v7, s[16:19], s57 offen offset:1024 lds
    s_add_u32 s94, s93, 6619136
    buffer_store_dwordx4 v[172:175], v29, s[24:27], s94 offen sc1
    s_waitcnt vmcnt(10)
    ds_read_b64_tr_b16 a[104:105], v2 offset:32768
    ds_read_b64_tr_b16 a[106:107], v2 offset:33280
    ds_read_b64_tr_b16 a[108:109], v2 offset:33024
    ds_read_b64_tr_b16 a[110:111], v2 offset:33536
    s_add_u32 m0, s52, 122880
    s_mov_b32 s57, 974848
    buffer_load_dwordx4 v6, s[16:19], s57 offen lds
    buffer_load_dwordx4 v7, s[16:19], s57 offen offset:1024 lds
    s_add_u32 s94, s93, 6815744
    buffer_store_dwordx4 v[176:179], v29, s[24:27], s94 offen sc1
    s_waitcnt vmcnt(10)
    ds_read_b64_tr_b16 a[112:113], v2 offset:40960
    ds_read_b64_tr_b16 a[114:115], v2 offset:41472
    ds_read_b64_tr_b16 a[116:117], v2 offset:41216
    ds_read_b64_tr_b16 a[118:119], v2 offset:41728
    s_add_u32 m0, s52, 131072
    s_mov_b32 s57, 1032192
    buffer_load_dwordx4 v6, s[16:19], s57 offen lds
    buffer_load_dwordx4 v7, s[16:19], s57 offen offset:1024 lds
    s_add_u32 s94, s93, 6881280
    buffer_store_dwordx4 v[180:183], v29, s[24:27], s94 offen sc1
    s_waitcnt vmcnt(10)
    ds_read_b64_tr_b16 a[120:121], v16 offset:40960
    ds_read_b64_tr_b16 a[122:123], v16 offset:41472
    ds_read_b64_tr_b16 a[124:125], v16 offset:41216
    ds_read_b64_tr_b16 a[126:127], v16 offset:41728
    s_add_u32 m0, s52, 139264
    s_mov_b32 s57, 1089536
    buffer_load_dwordx4 v6, s[16:19], s57 offen lds
    buffer_load_dwordx4 v7, s[16:19], s57 offen offset:1024 lds
    s_add_u32 m0, s52, 147456
    s_mov_b32 s57, 1146880
    buffer_load_dwordx4 v6, s[16:19], s57 offen lds
    s_waitcnt vmcnt(10)
    ds_read_b64_tr_b16 a[128:129], v2 offset:49152
    ds_read_b64_tr_b16 a[130:131], v2 offset:49664
    ds_read_b64_tr_b16 a[132:133], v2 offset:49408
    ds_read_b64_tr_b16 a[134:135], v2 offset:49920
    buffer_load_dwordx4 v7, s[16:19], s57 offen offset:1024 lds
    s_add_u32 m0, s52, 155648
    s_mov_b32 s57, 1204224
    buffer_load_dwordx4 v6, s[16:19], s57 offen lds
    buffer_load_dwordx4 v7, s[16:19], s57 offen offset:1024 lds
    s_waitcnt vmcnt(10)
    ds_read_b64_tr_b16 a[136:137], v2 offset:57344
    ds_read_b64_tr_b16 a[138:139], v2 offset:57856
    ds_read_b64_tr_b16 a[140:141], v2 offset:57600
    ds_read_b64_tr_b16 a[142:143], v2 offset:58112
    s_waitcnt lgkmcnt(15)
    s_add_u32 m0, s52, 65536
    s_mov_b32 s57, 1261568
    buffer_load_dwordx4 v6, s[16:19], s57 offen lds
    buffer_load_dwordx4 v7, s[16:19], s57 offen offset:1024 lds
    s_add_u32 m0, s52, 73728
    s_mov_b32 s57, 1318912
    buffer_load_dwordx4 v6, s[16:19], s57 offen lds
    s_waitcnt vmcnt(10)
    ds_read_b64_tr_b16 a[144:145], v3 offset:0
    ds_read_b64_tr_b16 a[146:147], v3 offset:512
    ds_read_b64_tr_b16 a[148:149], v3 offset:256
    ds_read_b64_tr_b16 a[150:151], v3 offset:768
    buffer_load_dwordx4 v7, s[16:19], s57 offen offset:1024 lds
    s_add_u32 m0, s52, 81920
    s_mov_b32 s57, 1376256
    buffer_load_dwordx4 v6, s[16:19], s57 offen lds
    buffer_load_dwordx4 v7, s[16:19], s57 offen offset:1024 lds
    s_waitcnt vmcnt(10)
    ds_read_b64_tr_b16 a[152:153], v3 offset:8192
    ds_read_b64_tr_b16 a[154:155], v3 offset:8704
    ds_read_b64_tr_b16 a[156:157], v3 offset:8448
    ds_read_b64_tr_b16 a[158:159], v3 offset:8960
    s_add_u32 m0, s52, 90112
    s_mov_b32 s57, 1433600
    buffer_load_dwordx4 v6, s[16:19], s57 offen lds
    buffer_load_dwordx4 v7, s[16:19], s57 offen offset:1024 lds
    s_waitcnt vmcnt(10)
    ds_read_b64_tr_b16 a[160:161], v3 offset:16384
    ds_read_b64_tr_b16 a[162:163], v3 offset:16896
    ds_read_b64_tr_b16 a[164:165], v3 offset:16640
    ds_read_b64_tr_b16 a[166:167], v3 offset:17152
    s_barrier
    s_cmp_lg_u32 s44, 0
    s_cbranch_scc1 L_nopub4
    s_lshl_b32 s62, s48, 3
    s_add_u32 s62, s62, s49
    s_lshl_b32 s62, s62, 7
    s_add_u32 s62, s62, 12648448
    v_mov_b32 v30, s47
    s_mov_b64 exec, 1
    buffer_store_dword v30, off, s[24:27], s62 sc1
    s_mov_b64 exec, -1
L_nopub4:
    buffer_load_dword v184, v185, s[24:27], 0 offen sc1
    buffer_load_dwordx2 v[188:189], v186, s[32:35], 0 offen offset:0
    s_waitcnt vmcnt(10)
    ds_read_b64_tr_b16 a[168:169], v3 offset:24576
    ds_read_b64_tr_b16 a[170:171], v3 offset:25088
    ds_read_b64_tr_b16 a[172:173], v3 offset:24832
    ds_read_b64_tr_b16 a[174:175], v3 offset:25344
    buffer_load_dwordx2 v[190:191], v186, s[32:35], 0 offen offset:16
    buffer_load_dwordx2 v[192:193], v186, s[32:35], 0 offen offset:32
    s_waitcnt vmcnt(10)
    ds_read_b64_tr_b16 a[176:177], v2 offset:0
    ds_read_b64_tr_b16 a[178:179], v2 offset:512
    ds_read_b64_tr_b16 a[180:181], v2 offset:256
    ds_read_b64_tr_b16 a[182:183], v2 offset:768
    buffer_load_dwordx2 v[194:195], v186, s[32:35], 0 offen offset:48
    s_add_u32 m0, s52, 98304
    s_mov_b32 s57, 1490944
    buffer_load_dwordx4 v6, s[16:19], s57 offen lds
    s_waitcnt vmcnt(10)
    ds_read_b64_tr_b16 a[184:185], v2 offset:8192
    ds_read_b64_tr_b16 a[186:187], v2 offset:8704
    ds_read_b64_tr_b16 a[188:189], v2 offset:8448
    ds_read_b64_tr_b16 a[190:191], v2 offset:8960
    buffer_load_dwordx4 v7, s[16:19], s57 offen offset:1024 lds
    s_waitcnt lgkmcnt(15)
    s_add_u32 m0, s52, 106496
    s_mov_b32 s57, 1548288
    buffer_load_dwordx4 v6, s[16:19], s57 offen lds
    s_waitcnt vmcnt(10)
    ds_read_b64_tr_b16 a[192:193], v2 offset:16384
    ds_read_b64_tr_b16 a[194:195], v2 offset:16896
    ds_read_b64_tr_b16 a[196:197], v2 offset:16640
    ds_read_b64_tr_b16 a[198:199], v2 offset:17152
    buffer_load_dwordx4 v7, s[16:19], s57 offen offset:1024 lds
    s_add_u32 m0, s52, 114688
    s_mov_b32 s57, 1605632
    buffer_load_dwordx4 v6, s[16:19], s57 offen lds
    s_waitcnt vmcnt(10)
    ds_read_b64_tr_b16 a[200:201], v2 offset:24576
    ds_read_b64_tr_b16 a[202:203], v2 offset:25088
    ds_read_b64_tr_b16 a[204:205], v2 offset:24832
    ds_read_b64_tr_b16 a[206:207], v2 offset:25344
    buffer_load_dwordx4 v7, s[16:19], s57 offen offset:1024 lds
    s_waitcnt vmcnt(10)
    v_cmp_ne_u32 vcc, s47, v184
    s_nop 0
    s_cbranch_vccz L_ok6
    s_mov_b32 s59, 20000
L_spin5:
    buffer_load_dword v184, v185, s[24:27], 0 offen sc1
    s_waitcnt vmcnt(0)
    v_cmp_ne_u32 vcc, s47, v184
    s_nop 0
    s_cbranch_vccz L_ok6
    s_sub_u32 s59, s59, 1
    s_cbranch_scc0 L_spin5
L_ok6:
    s_add_u32 m0, s52, 122880
    s_mov_b32 s57, 1662976
    buffer_load_dwordx4 v6, s[16:19], s57 offen lds
    buffer_load_dwordx4 v7, s[16:19], s57 offen offset:1024 lds
    s_add_u32 m0, s52, 131072
    s_mov_b32 s57, 1720320
    buffer_load_dwordx4 v6, s[16:19], s57 offen lds
    buffer_load_dwordx4 v7, s[16:19], s57 offen offset:1024 lds
    s_waitcnt vmcnt(10)
    v_lshlrev_b32 v32, 16, v188
    v_and_b32 v33, s63, v188
    v_lshlrev_b32 v34, 16, v189
    v_and_b32 v35, s63, v189
    v_lshlrev_b32 v36, 16, v190
    v_and_b32 v37, s63, v190
    v_lshlrev_b32 v38, 16, v191
    v_and_b32 v39, s63, v191
    v_lshlrev_b32 v40, 16, v192
    v_and_b32 v41, s63, v192
    v_lshlrev_b32 v42, 16, v193
    v_and_b32 v43, s63, v193
    v_lshlrev_b32 v44, 16, v194
    v_and_b32 v45, s63, v194
    v_lshlrev_b32 v46, 16, v195
    v_and_b32 v47, s63, v195
    s_add_u32 m0, s52, 139264
    s_mov_b32 s57, 1777664
    buffer_load_dwordx4 v6, s[16:19], s57 offen lds
    v_mov_b32 v186, 0xbdd2d3e8
    v_mov_b32 v187, 0xc0135761
    buffer_load_dwordx4 v7, s[16:19], s57 offen offset:1024 lds
    s_waitcnt vmcnt(10)
    ds_read_b64_tr_b16 a[208:209], v2 offset:32768
    ds_read_b64_tr_b16 a[210:211], v2 offset:33280
    ds_read_b64_tr_b16 a[212:213], v2 offset:33024
    ds_read_b64_tr_b16 a[214:215], v2 offset:33536
    s_add_u32 s58, s60, 0
    buffer_load_dwordx4 v[96:99], v14, s[24:27], s58 offen offset:0 sc1
    buffer_load_dwordx4 v[100:103], v14, s[24:27], s58 offen offset:2048 sc1
    s_waitcnt vmcnt(10)
    ds_read_b64_tr_b16 a[216:217], v2 offset:40960
    ds_read_b64_tr_b16 a[218:219], v2 offset:41472
    ds_read_b64_tr_b16 a[220:221], v2 offset:41216
    ds_read_b64_tr_b16 a[222:223], v2 offset:41728
    s_add_u32 s58, s60, 4096
    buffer_load_dwordx4 v[104:107], v14, s[24:27], s58 offen offset:0 sc1
    buffer_load_dwordx4 v[108:111], v14, s[24:27], s58 offen offset:2048 sc1
    s_waitcnt vmcnt(10)
    ds_read_b64_tr_b16 a[224:225], v2 offset:49152
    ds_read_b64_tr_b16 a[226:227], v2 offset:49664
    ds_read_b64_tr_b16 a[228:229], v2 offset:49408
    ds_read_b64_tr_b16 a[230:231], v2 offset:49920
    s_add_u32 s58, s60, 8192
    buffer_load_dwordx4 v[112:115], v14, s[24:27], s58 offen offset:0 sc1
    buffer_load_dwordx4 v[116:119], v14, s[24:27], s58 offen offset:2048 sc1
    s_waitcnt vmcnt(10)
    ds_read_b64_tr_b16 a[232:233], v2 offset:57344
    ds_read_b64_tr_b16 a[234:235], v2 offset:57856
    ds_read_b64_tr_b16 a[236:237], v2 offset:57600
    ds_read_b64_tr_b16 a[238:239], v2 offset:58112
    s_add_u32 s58, s60, 12288
    buffer_load_dwordx4 v[120:123], v14, s[24:27], s58 offen offset:0 sc1
    buffer_load_dwordx4 v[124:127], v14, s[24:27], s58 offen offset:2048 sc1
    s_waitcnt vmcnt(10)
    ds_read_b64_tr_b16 a[240:241], v3 offset:0
    ds_read_b64_tr_b16 a[242:243], v3 offset:512
    ds_read_b64_tr_b16 a[244:245], v3 offset:256
    ds_read_b64_tr_b16 a[246:247], v3 offset:768
    s_add_u32 s58, s60, 16384
    buffer_load_dwordx4 v[128:131], v14, s[24:27], s58 offen offset:0 sc1
    buffer_load_dwordx4 v[132:135], v14, s[24:27], s58 offen offset:2048 sc1
    s_waitcnt vmcnt(10)
    ds_read_b64_tr_b16 a[248:249], v3 offset:8192
    ds_read_b64_tr_b16 a[250:251], v3 offset:8704
    ds_read_b64_tr_b16 a[252:253], v3 offset:8448
    ds_read_b64_tr_b16 a[254:255], v3 offset:8960
    s_add_u32 s58, s60, 20480
    buffer_load_dwordx4 v[136:139], v14, s[24:27], s58 offen offset:0 sc1
    s_waitcnt vmcnt(10)
    v_mfma_f32_32x32x16_bf16 v[48:63], a[0:3], v[96:99], 0
    v_mfma_f32_32x32x16_bf16 v[80:95], a[4:7], v[96:99], 0
    buffer_load_dwordx4 v[140:143], v14, s[24:27], s58 offen offset:2048 sc1
    s_waitcnt vmcnt(10)
    v_mfma_f32_32x32x16_bf16 v[48:63], a[8:11], v[100:103], v[48:63]
    v_mfma_f32_32x32x16_bf16 v[80:95], a[12:15], v[100:103], v[80:95]
    s_add_u32 s58, s60, 24576
    buffer_load_dwordx4 v[144:147], v14, s[24:27], s58 offen offset:0 sc1
    s_waitcnt vmcnt(10)
    v_mfma_f32_32x32x16_bf16 v[48:63], a[16:19], v[104:107], v[48:63]
    v_mfma_f32_32x32x16_bf16 v[80:95], a[20:23], v[104:107], v[80:95]
    buffer_load_dwordx4 v[148:151], v14, s[24:27], s58 offen offset:2048 sc1
    s_waitcnt vmcnt(10)
    v_mfma_f32_32x32x16_bf16 v[48:63], a[24:27], v[108:111], v[48:63]
    v_mfma_f32_32x32x16_bf16 v[80:95], a[28:31], v[108:111], v[80:95]
    s_add_u32 s58, s60, 28672
    buffer_load_dwordx4 v[152:155], v14, s[24:27], s58 offen offset:0 sc1
    s_waitcnt vmcnt(10)
    v_mfma_f32_32x32x16_bf16 v[48:63], a[32:35], v[112:115], v[48:63]
    v_mfma_f32_32x32x16_bf16 v[80:95], a[36:39], v[112:115], v[80:95]
    buffer_load_dwordx4 v[156:159], v14, s[24:27], s58 offen offset:2048 sc1
    s_waitcnt vmcnt(10)
    v_mfma_f32_32x32x16_bf16 v[48:63], a[40:43], v[116:119], v[48:63]
    v_mfma_f32_32x32x16_bf16 v[80:95], a[44:47], v[116:119], v[80:95]
    s_add_u32 s58, s60, 32768
    buffer_load_dwordx4 v[96:99], v14, s[24:27], s58 offen offset:0 sc1
    s_waitcnt vmcnt(10)
    v_mfma_f32_32x32x16_bf16 v[48:63], a[48:51], v[120:123], v[48:63]
    v_mfma_f32_32x32x16_bf16 v[80:95], a[52:55], v[120:123], v[80:95]
    buffer_load_dwordx4 v[100:103], v14, s[24:27], s58 offen offset:2048 sc1
    s_waitcnt vmcnt(10)
    v_mfma_f32_32x32x16_bf16 v[48:63], a[56:59], v[124:127], v[48:63]
    v_mfma_f32_32x32x16_bf16 v[80:95], a[60:63], v[124:127], v[80:95]
    s_add_u32 s58, s60, 36864
    buffer_load_dwordx4 v[104:107], v14, s[24:27], s58 offen offset:0 sc1
    s_waitcnt vmcnt(10)
    v_mfma_f32_32x32x16_bf16 v[48:63], a[64:67], v[128:131], v[48:63]
    v_mfma_f32_32x32x16_bf16 v[80:95], a[68:71], v[128:131], v[80:95]
    buffer_load_dwordx4 v[108:111], v14, s[24:27], s58 offen offset:2048 sc1
    s_waitcnt vmcnt(10)
    v_mfma_f32_32x32x16_bf16 v[48:63], a[72:75], v[132:135], v[48:63]
    v_mfma_f32_32x32x16_bf16 v[80:95], a[76:79], v[132:135], v[80:95]
    s_add_u32 s58, s60, 40960
    buffer_load_dwordx4 v[112:115], v14, s[24:27], s58 offen offset:0 sc1
    s_waitcnt vmcnt(10)
    v_mfma_f32_32x32x16_bf16 v[48:63], a[80:83], v[136:139], v[48:63]
    v_mfma_f32_32x32x16_bf16 v[80:95], a[84:87], v[136:139], v[80:95]
    buffer_load_dwordx4 v[116:119], v14, s[24:27], s58 offen offset:2048 sc1
    s_waitcnt vmcnt(10)
    v_mfma_f32_32x32x16_bf16 v[48:63], a[88:91], v[140:143], v[48:63]
    v_mfma_f32_32x32x16_bf16 v[80:95], a[92:95], v[140:143], v[80:95]
    s_add_u32 s58, s60, 45056
    buffer_load_dwordx4 v[120:123], v14, s[24:27], s58 offen offset:0 sc1
    s_waitcnt vmcnt(10)
    v_mfma_f32_32x32x16_bf16 v[48:63], a[96:99], v[144:147], v[48:63]
    v_mfma_f32_32x32x16_bf16 v[80:95], a[100:103], v[144:147], v[80:95]
    buffer_load_dwordx4 v[124:127], v14, s[24:27], s58 offen offset:2048 sc1
    s_waitcnt vmcnt(10)
    v_mfma_f32_32x32x16_bf16 v[48:63], a[104:107], v[148:151], v[48:63]
    v_mfma_f32_32x32x16_bf16 v[80:95], a[108:111], v[148:151], v[80:95]
    s_add_u32 s58, s60, 49152
    buffer_load_dwordx4 v[128:131], v14, s[24:27], s58 offen offset:0 sc1
    s_waitcnt vmcnt(10)
    v_mfma_f32_32x32x16_bf16 v[48:63], a[112:115], v[152:155], v[48:63]
    v_mfma_f32_32x32x16_bf16 v[80:95], a[116:119], v[152:155], v[80:95]
    buffer_load_dwordx4 v[132:135], v14, s[24:27], s58 offen offset:2048 sc1
    s_waitcnt vmcnt(10)
    v_mfma_f32_32x32x16_bf16 v[48:63], a[120:123], v[156:159], v[48:63]
    v_mfma_f32_32x32x16_bf16 v[80:95], a[124:127], v[156:159], v[80:95]
    s_add_u32 s58, s60, 53248
    buffer_load_dwordx4 v[136:139], v14, s[24:27], s58 offen offset:0 sc1
    s_waitcnt vmcnt(10)
    v_mfma_f32_32x32x16_bf16 v[48:63], a[128:131], v[96:99], v[48:63]
    v_mfma_f32_32x32x16_bf16 v[80:95], a[132:135], v[96:99], v[80:95]
    buffer_load_dwordx4 v[140:143], v14, s[24:27], s58 offen offset:2048 sc1
    s_waitcnt vmcnt(10)
    v_mfma_f32_32x32x16_bf16 v[48:63], a[136:139], v[100:103], v[48:63]
    v_mfma_f32_32x32x16_bf16 v[80:95], a[140:143], v[100:103], v[80:95]
    s_add_u32 s58, s60, 57344
    buffer_load_dwordx4 v[144:147], v14, s[24:27], s58 offen offset:0 sc1
    s_waitcnt vmcnt(10)
    v_mfma_f32_32x32x16_bf16 v[48:63], a[144:147], v[104:107], v[48:63]
    v_mfma_f32_32x32x16_bf16 v[80:95], a[148:151], v[104:107], v[80:95]
    buffer_load_dwordx4 v[148:151], v14, s[24:27], s58 offen offset:2048 sc1
    s_waitcnt vmcnt(10)
    v_mfma_f32_32x32x16_bf16 v[48:63], a[152:155], v[108:111], v[48:63]
    v_mfma_f32_32x32x16_bf16 v[80:95], a[156:159], v[108:111], v[80:95]
    s_add_u32 s58, s60, 61440
    buffer_load_dwordx4 v[152:155], v14, s[24:27], s58 offen offset:0 sc1
    s_waitcnt vmcnt(10)
    s_waitcnt lgkmcnt(15)
    v_mfma_f32_32x32x16_bf16 v[48:63], a[160:163], v[112:115], v[48:63]
    v_mfma_f32_32x32x16_bf16 v[80:95], a[164:167], v[112:115], v[80:95]
    buffer_load_dwordx4 v[156:159], v14, s[24:27], s58 offen offset:2048 sc1
    s_waitcnt vmcnt(10)
    v_mfma_f32_32x32x16_bf16 v[48:63], a[168:171], v[116:119], v[48:63]
    v_mfma_f32_32x32x16_bf16 v[80:95], a[172:175], v[116:119], v[80:95]
    s_add_u32 s58, s60, 0
    buffer_load_dwordx4 v[96:99], v13, s[24:27], s58 offen offset:0 sc1
    s_waitcnt vmcnt(10)
    v_mfma_f32_32x32x16_bf16 v[48:63], a[176:179], v[120:123], v[48:63]
    v_mfma_f32_32x32x16_bf16 v[80:95], a[180:183], v[120:123], v[80:95]
    buffer_load_dwordx4 v[100:103], v13, s[24:27], s58 offen offset:2048 sc1
    s_waitcnt vmcnt(10)
    v_mfma_f32_32x32x16_bf16 v[48:63], a[184:187], v[124:127], v[48:63]
    v_mfma_f32_32x32x16_bf16 v[80:95], a[188:191], v[124:127], v[80:95]
    s_add_u32 s58, s60, 4096
    buffer_load_dwordx4 v[104:107], v13, s[24:27], s58 offen offset:0 sc1
    s_waitcnt vmcnt(10)
    v_mfma_f32_32x32x16_bf16 v[48:63], a[192:195], v[128:131], v[48:63]
    v_mfma_f32_32x32x16_bf16 v[80:95], a[196:199], v[128:131], v[80:95]
    buffer_load_dwordx4 v[108:111], v13, s[24:27], s58 offen offset:2048 sc1
    s_waitcnt vmcnt(10)
    v_mfma_f32_32x32x16_bf16 v[48:63], a[200:203], v[132:135], v[48:63]
    v_mfma_f32_32x32x16_bf16 v[80:95], a[204:207], v[132:135], v[80:95]
    s_add_u32 s58, s60, 8192
    buffer_load_dwordx4 v[112:115], v13, s[24:27], s58 offen offset:0 sc1
    s_waitcnt vmcnt(10)
    v_mfma_f32_32x32x16_bf16 v[48:63], a[208:211], v[136:139], v[48:63]
    v_mfma_f32_32x32x16_bf16 v[80:95], a[212:215], v[136:139], v[80:95]
    buffer_load_dwordx4 v[116:119], v13, s[24:27], s58 offen offset:2048 sc1
    s_waitcnt vmcnt(10)
    v_mfma_f32_32x32x16_bf16 v[48:63], a[216:219], v[140:143], v[48:63]
    v_mfma_f32_32x32x16_bf16 v[80:95], a[220:223], v[140:143], v[80:95]
    s_add_u32 s58, s60, 12288
    buffer_load_dwordx4 v[120:123], v13, s[24:27], s58 offen offset:0 sc1
    s_waitcnt vmcnt(10)
    s_waitcnt lgkmcnt(12)
    v_mfma_f32_32x32x16_bf16 v[48:63], a[224:227], v[144:147], v[48:63]
    v_mfma_f32_32x32x16_bf16 v[80:95], a[228:231], v[144:147], v[80:95]
    buffer_load_dwordx4 v[124:127], v13, s[24:27], s58 offen offset:2048 sc1
    s_waitcnt vmcnt(10)
    s_waitcnt lgkmcnt(8)
    v_mfma_f32_32x32x16_bf16 v[48:63], a[232:235], v[148:151], v[48:63]
    v_mfma_f32_32x32x16_bf16 v[80:95], a[236:239], v[148:151], v[80:95]
    s_add_u32 s58, s60, 16384
    buffer_load_dwordx4 v[128:131], v13, s[24:27], s58 offen offset:0 sc1
    s_waitcnt vmcnt(10)
    s_waitcnt lgkmcnt(4)
    v_mfma_f32_32x32x16_bf16 v[48:63], a[240:243], v[152:155], v[48:63]
    v_mfma_f32_32x32x16_bf16 v[80:95], a[244:247], v[152:155], v[80:95]
    buffer_load_dwordx4 v[132:135], v13, s[24:27], s58 offen offset:2048 sc1
    s_waitcnt vmcnt(10)
    s_waitcnt lgkmcnt(0)
    v_mfma_f32_32x32x16_bf16 v[48:63], a[248:251], v[156:159], v[48:63]
    v_mfma_f32_32x32x16_bf16 v[80:95], a[252:255], v[156:159], v[80:95]
    s_add_u32 s58, s60, 20480
    buffer_load_dwordx4 v[136:139], v13, s[24:27], s58 offen offset:0 sc1
    s_waitcnt vmcnt(10)
    v_mfma_f32_32x32x16_bf16 v[32:47], a[0:3], v[96:99], v[32:47]
    v_mfma_f32_32x32x16_bf16 v[64:79], a[4:7], v[96:99], 0
    buffer_load_dwordx4 v[140:143], v13, s[24:27], s58 offen offset:2048 sc1
    s_waitcnt vmcnt(10)
    v_mfma_f32_32x32x16_bf16 v[32:47], a[8:11], v[100:103], v[32:47]
    v_mfma_f32_32x32x16_bf16 v[64:79], a[12:15], v[100:103], v[64:79]
    s_add_u32 s58, s60, 24576
    buffer_load_dwordx4 v[144:147], v13, s[24:27], s58 offen offset:0 sc1
    s_waitcnt vmcnt(10)
    v_mfma_f32_32x32x16_bf16 v[32:47], a[16:19], v[104:107], v[32:47]
    v_mfma_f32_32x32x16_bf16 v[64:79], a[20:23], v[104:107], v[64:79]
    buffer_load_dwordx4 v[148:151], v13, s[24:27], s58 offen offset:2048 sc1
    s_waitcnt vmcnt(10)
    v_mfma_f32_32x32x16_bf16 v[32:47], a[24:27], v[108:111], v[32:47]
    v_mfma_f32_32x32x16_bf16 v[64:79], a[28:31], v[108:111], v[64:79]
    s_add_u32 s58, s60, 28672
    buffer_load_dwordx4 v[152:155], v13, s[24:27], s58 offen offset:0 sc1
    s_waitcnt vmcnt(10)
    v_mfma_f32_32x32x16_bf16 v[32:47], a[32:35], v[112:115], v[32:47]
    v_mfma_f32_32x32x16_bf16 v[64:79], a[36:39], v[112:115], v[64:79]
    ds_write_b128 v196, v[48:51] offset:0
    buffer_load_dwordx4 v[156:159], v13, s[24:27], s58 offen offset:2048 sc1
    s_waitcnt vmcnt(10)
    v_mfma_f32_32x32x16_bf16 v[32:47], a[40:43], v[116:119], v[32:47]
    v_mfma_f32_32x32x16_bf16 v[64:79], a[44:47], v[116:119], v[64:79]
    ds_write_b128 v196, v[52:55] offset:1024
    s_add_u32 s58, s60, 32768
    buffer_load_dwordx4 v[96:99], v13, s[24:27], s58 offen offset:0 sc1
    s_waitcnt vmcnt(10)
    v_mfma_f32_32x32x16_bf16 v[32:47], a[48:51], v[120:123], v[32:47]
    v_mfma_f32_32x32x16_bf16 v[64:79], a[52:55], v[120:123], v[64:79]
    ds_write_b128 v196, v[56:59] offset:8192
    buffer_load_dwordx4 v[100:103], v13, s[24:27], s58 offen offset:2048 sc1
    s_waitcnt vmcnt(10)
    v_mfma_f32_32x32x16_bf16 v[32:47], a[56:59], v[124:127], v[32:47]
    v_mfma_f32_32x32x16_bf16 v[64:79], a[60:63], v[124:127], v[64:79]
    ds_write_b128 v196, v[60:63] offset:9216
    s_add_u32 s58, s60, 36864
    buffer_load_dwordx4 v[104:107], v13, s[24:27], s58 offen offset:0 sc1
    s_waitcnt vmcnt(10)
    v_mfma_f32_32x32x16_bf16 v[32:47], a[64:67], v[128:131], v[32:47]
    v_mfma_f32_32x32x16_bf16 v[64:79], a[68:71], v[128:131], v[64:79]
    ds_write_b128 v196, v[80:83] offset:32768
    buffer_load_dwordx4 v[108:111], v13, s[24:27], s58 offen offset:2048 sc1
    s_waitcnt vmcnt(10)
    v_mfma_f32_32x32x16_bf16 v[32:47], a[72:75], v[132:135], v[32:47]
    v_mfma_f32_32x32x16_bf16 v[64:79], a[76:79], v[132:135], v[64:79]
    ds_write_b128 v196, v[84:87] offset:33792
    s_add_u32 s58, s60, 40960
    buffer_load_dwordx4 v[112:115], v13, s[24:27], s58 offen offset:0 sc1
    s_waitcnt vmcnt(10)
    v_mfma_f32_32x32x16_bf16 v[32:47], a[80:83], v[136:139], v[32:47]
    v_mfma_f32_32x32x16_bf16 v[64:79], a[84:87], v[136:139], v[64:79]
    ds_write_b128 v196, v[88:91] offset:40960
    buffer_load_dwordx4 v[116:119], v13, s[24:27], s58 offen offset:2048 sc1
    s_waitcnt vmcnt(10)
    v_mfma_f32_32x32x16_bf16 v[32:47], a[88:91], v[140:143], v[32:47]
    v_mfma_f32_32x32x16_bf16 v[64:79], a[92:95], v[140:143], v[64:79]
    ds_write_b128 v196, v[92:95] offset:41984
    s_add_u32 s58, s60, 45056
    buffer_load_dwordx4 v[120:123], v13, s[24:27], s58 offen offset:0 sc1
    s_waitcnt vmcnt(10)
    v_mfma_f32_32x32x16_bf16 v[32:47], a[96:99], v[144:147], v[32:47]
    v_mfma_f32_32x32x16_bf16 v[64:79], a[100:103], v[144:147], v[64:79]
    buffer_load_dwordx4 v[124:127], v13, s[24:27], s58 offen offset:2048 sc1
    s_waitcnt vmcnt(10)
    v_mfma_f32_32x32x16_bf16 v[32:47], a[104:107], v[148:151], v[32:47]
    v_mfma_f32_32x32x16_bf16 v[64:79], a[108:111], v[148:151], v[64:79]
    s_add_u32 s58, s60, 49152
    buffer_load_dwordx4 v[128:131], v13, s[24:27], s58 offen offset:0 sc1
    s_waitcnt vmcnt(10)
    v_mfma_f32_32x32x16_bf16 v[32:47], a[112:115], v[152:155], v[32:47]
    v_mfma_f32_32x32x16_bf16 v[64:79], a[116:119], v[152:155], v[64:79]
    buffer_load_dwordx4 v[132:135], v13, s[24:27], s58 offen offset:2048 sc1
    s_waitcnt vmcnt(10)
    v_mfma_f32_32x32x16_bf16 v[32:47], a[120:123], v[156:159], v[32:47]
    v_mfma_f32_32x32x16_bf16 v[64:79], a[124:127], v[156:159], v[64:79]
    s_add_u32 s58, s60, 53248
    buffer_load_dwordx4 v[136:139], v13, s[24:27], s58 offen offset:0 sc1
    s_waitcnt vmcnt(10)
    v_mfma_f32_32x32x16_bf16 v[32:47], a[128:131], v[96:99], v[32:47]
    v_mfma_f32_32x32x16_bf16 v[64:79], a[132:135], v[96:99], v[64:79]
    buffer_load_dwordx4 v[140:143], v13, s[24:27], s58 offen offset:2048 sc1
    s_waitcnt vmcnt(10)
    v_mfma_f32_32x32x16_bf16 v[32:47], a[136:139], v[100:103], v[32:47]
    v_mfma_f32_32x32x16_bf16 v[64:79], a[140:143], v[100:103], v[64:79]
    s_add_u32 s58, s60, 57344
    buffer_load_dwordx4 v[144:147], v13, s[24:27], s58 offen offset:0 sc1
    s_waitcnt vmcnt(10)
    v_mfma_f32_32x32x16_bf16 v[32:47], a[144:147], v[104:107], v[32:47]
    v_mfma_f32_32x32x16_bf16 v[64:79], a[148:151], v[104:107], v[64:79]
    buffer_load_dwordx4 v[148:151], v13, s[24:27], s58 offen offset:2048 sc1
    s_waitcnt vmcnt(10)
    v_mfma_f32_32x32x16_bf16 v[32:47], a[152:155], v[108:111], v[32:47]
    v_mfma_f32_32x32x16_bf16 v[64:79], a[156:159], v[108:111], v[64:79]
    s_add_u32 s58, s60, 61440
    buffer_load_dwordx4 v[152:155], v13, s[24:27], s58 offen offset:0 sc1
    s_waitcnt vmcnt(10)
    v_mfma_f32_32x32x16_bf16 v[32:47], a[160:163], v[112:115], v[32:47]
    v_mfma_f32_32x32x16_bf16 v[64:79], a[164:167], v[112:115], v[64:79]
    buffer_load_dwordx4 v[156:159], v13, s[24:27], s58 offen offset:2048 sc1
    s_waitcnt vmcnt(10)
    v_mfma_f32_32x32x16_bf16 v[32:47], a[168:171], v[116:119], v[32:47]
    v_mfma_f32_32x32x16_bf16 v[64:79], a[172:175], v[116:119], v[64:79]
    buffer_load_dwordx4 v[208:211], v205, s[4:7], s89 offen
    s_waitcnt vmcnt(10)
    v_mfma_f32_32x32x16_bf16 v[32:47], a[176:179], v[120:123], v[32:47]
    v_mfma_f32_32x32x16_bf16 v[64:79], a[180:183], v[120:123], v[64:79]
    buffer_load_dwordx4 v[212:215], v205, s[4:7], s90 offen
    s_waitcnt vmcnt(10)
    v_mfma_f32_32x32x16_bf16 v[32:47], a[184:187], v[124:127], v[32:47]
    v_mfma_f32_32x32x16_bf16 v[64:79], a[188:191], v[124:127], v[64:79]
    buffer_load_ushort v216, v206, s[36:39], s91 offen
    s_waitcnt vmcnt(10)
    v_mfma_f32_32x32x16_bf16 v[32:47], a[192:195], v[128:131], v[32:47]
    v_mfma_f32_32x32x16_bf16 v[64:79], a[196:199], v[128:131], v[64:79]
    buffer_load_ushort v217, v206, s[36:39], s91 offen offset:64
    s_waitcnt vmcnt(10)
    v_mfma_f32_32x32x16_bf16 v[32:47], a[200:203], v[132:135], v[32:47]
    v_mfma_f32_32x32x16_bf16 v[64:79], a[204:207], v[132:135], v[64:79]
    s_waitcnt vmcnt(9)
    v_mfma_f32_32x32x16_bf16 v[32:47], a[208:211], v[136:139], v[32:47]
    v_mfma_f32_32x32x16_bf16 v[64:79], a[212:215], v[136:139], v[64:79]
    s_waitcnt vmcnt(8)
    v_mfma_f32_32x32x16_bf16 v[32:47], a[216:219], v[140:143], v[32:47]
    v_mfma_f32_32x32x16_bf16 v[64:79], a[220:223], v[140:143], v[64:79]
    s_waitcnt vmcnt(7)
    v_mfma_f32_32x32x16_bf16 v[32:47], a[224:227], v[144:147], v[32:47]
    v_mfma_f32_32x32x16_bf16 v[64:79], a[228:231], v[144:147], v[64:79]
    s_waitcnt vmcnt(6)
    v_mfma_f32_32x32x16_bf16 v[32:47], a[232:235], v[148:151], v[32:47]
    v_mfma_f32_32x32x16_bf16 v[64:79], a[236:239], v[148:151], v[64:79]
    s_waitcnt vmcnt(5)
    v_mfma_f32_32x32x16_bf16 v[32:47], a[240:243], v[152:155], v[32:47]
    v_mfma_f32_32x32x16_bf16 v[64:79], a[244:247], v[152:155], v[64:79]
    s_waitcnt vmcnt(4)
    v_mfma_f32_32x32x16_bf16 v[32:47], a[248:251], v[156:159], v[32:47]
    v_mfma_f32_32x32x16_bf16 v[64:79], a[252:255], v[156:159], v[64:79]
    s_nop 11
    ds_write_b128 v196, v[64:67] offset:16384
    ds_write_b128 v196, v[68:71] offset:17408
    ds_write_b128 v196, v[72:75] offset:24576
    ds_write_b128 v196, v[76:79] offset:25600
    s_add_u32 m0, s52, 147456
    s_mov_b32 s57, 0
    buffer_load_dwordx4 v8, s[20:23], s57 offen lds
    buffer_load_dwordx4 v9, s[20:23], s57 offen offset:1024 lds
    s_add_u32 m0, s52, 155648
    s_mov_b32 s57, 65536
    buffer_load_dwordx4 v8, s[20:23], s57 offen lds
    buffer_load_dwordx4 v9, s[20:23], s57 offen offset:1024 lds
    s_add_u32 m0, s52, 65536
    s_mov_b32 s57, 131072
    buffer_load_dwordx4 v8, s[20:23], s57 offen lds
    buffer_load_dwordx4 v9, s[20:23], s57 offen offset:1024 lds
    s_add_u32 m0, s52, 73728
    s_mov_b32 s57, 196608
    buffer_load_dwordx4 v8, s[20:23], s57 offen lds
    buffer_load_dwordx4 v9, s[20:23], s57 offen offset:1024 lds
    s_waitcnt lgkmcnt(0)
    s_barrier
    ds_read_b128 v[160:163], v197 offset:0
    ds_read_b128 v[176:179], v198 offset:16384
    ds_read_b128 v[240:243], v199 offset:32768
    ds_read_b128 v[164:167], v197 offset:1024
    ds_read_b128 v[180:183], v198 offset:17408
    ds_read_b128 v[244:247], v199 offset:33792
    ds_read_b128 v[168:171], v197 offset:8192
    ds_read_b128 v[232:235], v198 offset:24576
    ds_read_b128 v[248:251], v199 offset:40960
    ds_read_b128 v[172:175], v197 offset:9216
    ds_read_b128 v[236:239], v198 offset:25600
    ds_read_b128 v[252:255], v199 offset:41984
    s_add_u32 m0, s52, 81920
    s_mov_b32 s57, 262144
    buffer_load_dwordx4 v8, s[20:23], s57 offen lds
    buffer_load_dwordx4 v9, s[20:23], s57 offen offset:1024 lds
    s_add_u32 m0, s52, 90112
    s_mov_b32 s57, 327680
    buffer_load_dwordx4 v8, s[20:23], s57 offen lds
    s_waitcnt lgkmcnt(6)
    v_pk_add_f32 v[160:161], v[160:161], v[176:177]
    v_pk_add_f32 v[162:163], v[162:163], v[178:179]
    v_pk_add_f32 v[164:165], v[164:165], v[180:181]
    v_pk_add_f32 v[166:167], v[166:167], v[182:183]
    v_pk_add_f32 v[32:33], v[32:33], v[240:241]
    v_pk_add_f32 v[34:35], v[34:35], v[242:243]
    v_pk_add_f32 v[36:37], v[36:37], v[244:245]
    v_pk_add_f32 v[38:39], v[38:39], v[246:247]
    v_pk_add_f32 v[32:33], v[32:33], v[160:161]
    v_pk_add_f32 v[34:35], v[34:35], v[162:163]
    v_pk_add_f32 v[36:37], v[36:37], v[164:165]
    v_pk_add_f32 v[38:39], v[38:39], v[166:167]
    buffer_load_dwordx4 v9, s[20:23], s57 offen offset:1024 lds
    s_waitcnt vmcnt(10)
    ds_read_b64_tr_b16 a[0:1], v5 offset:16384
    ds_read_b64_tr_b16 a[2:3], v5 offset:17408
    ds_read_b64_tr_b16 a[4:5], v5 offset:16640
    ds_read_b64_tr_b16 a[6:7], v5 offset:17664
    v_pk_mul_f32 v[48:49], v[32:33], v[32:33]
    v_pk_mul_f32 v[50:51], v[34:35], v[34:35]
    v_pk_mul_f32 v[52:53], v[36:37], v[36:37]
    v_pk_mul_f32 v[54:55], v[38:39], v[38:39]
    s_add_u32 m0, s52, 98304
    s_mov_b32 s57, 393216
    buffer_load_dwordx4 v8, s[20:23], s57 offen lds
    v_pk_fma_f32 v[48:49], v[48:49], v[186:187], v[186:187] op_sel:[0,0,1] op_sel_hi:[1,0,1]
    v_pk_fma_f32 v[50:51], v[50:51], v[186:187], v[186:187] op_sel:[0,0,1] op_sel_hi:[1,0,1]
    v_pk_fma_f32 v[52:53], v[52:53], v[186:187], v[186:187] op_sel:[0,0,1] op_sel_hi:[1,0,1]
    v_pk_fma_f32 v[54:55], v[54:55], v[186:187], v[186:187] op_sel:[0,0,1] op_sel_hi:[1,0,1]
    v_pk_mul_f32 v[48:49], v[48:49], v[32:33]
    v_pk_mul_f32 v[50:51], v[50:51], v[34:35]
    v_pk_mul_f32 v[52:53], v[52:53], v[36:37]
    v_pk_mul_f32 v[54:55], v[54:55], v[38:39]
    v_exp_f32 v48, v48
    v_exp_f32 v49, v49
    v_exp_f32 v50, v50
    v_exp_f32 v51, v51
    buffer_load_dwordx4 v9, s[20:23], s57 offen offset:1024 lds
    s_waitcnt vmcnt(10)
    ds_read_b64_tr_b16 a[8:9], v5 offset:24576
    ds_read_b64_tr_b16 a[10:11], v5 offset:25600
    ds_read_b64_tr_b16 a[12:13], v5 offset:24832
    ds_read_b64_tr_b16 a[14:15], v5 offset:25856
    v_exp_f32 v52, v52
    v_exp_f32 v53, v53
    v_exp_f32 v54, v54
    v_exp_f32 v55, v55
    s_add_u32 m0, s52, 106496
    s_mov_b32 s57, 458752
    buffer_load_dwordx4 v8, s[20:23], s57 offen lds
    v_pk_add_f32 v[48:49], v[48:49], 1.0 op_sel_hi:[1,0]
    v_pk_add_f32 v[50:51], v[50:51], 1.0 op_sel_hi:[1,0]
    v_pk_add_f32 v[52:53], v[52:53], 1.0 op_sel_hi:[1,0]
    v_pk_add_f32 v[54:55], v[54:55], 1.0 op_sel_hi:[1,0]
    v_rcp_f32 v48, v48
    v_rcp_f32 v49, v49
    v_rcp_f32 v50, v50
    v_rcp_f32 v51, v51
    v_rcp_f32 v52, v52
    v_rcp_f32 v53, v53
    v_rcp_f32 v54, v54
    v_rcp_f32 v55, v55
    buffer_load_dwordx4 v9, s[20:23], s57 offen offset:1024 lds
    s_waitcnt vmcnt(10)
    ds_read_b64_tr_b16 a[16:17], v4 offset:0
    ds_read_b64_tr_b16 a[18:19], v4 offset:1024
    ds_read_b64_tr_b16 a[20:21], v4 offset:256
    ds_read_b64_tr_b16 a[22:23], v4 offset:1280
    v_pk_mul_f32 v[48:49], v[48:49], v[32:33]
    v_pk_mul_f32 v[50:51], v[50:51], v[34:35]
    v_pk_mul_f32 v[52:53], v[52:53], v[36:37]
    v_pk_mul_f32 v[54:55], v[54:55], v[38:39]
    s_add_u32 m0, s52, 114688
    s_mov_b32 s57, 524288
    buffer_load_dwordx4 v8, s[20:23], s57 offen lds
    v_cvt_pk_bf16_f32 v56, v48, v49
    v_cvt_pk_bf16_f32 v57, v50, v51
    v_cvt_pk_bf16_f32 v58, v52, v53
    v_cvt_pk_bf16_f32 v59, v54, v55
    buffer_store_dwordx4 v[56:59], v13, s[24:27], s64 offen offset:0 sc1
    s_waitcnt lgkmcnt(12)
    v_pk_add_f32 v[168:169], v[168:169], v[232:233]
    v_pk_add_f32 v[170:171], v[170:171], v[234:235]
    v_pk_add_f32 v[172:173], v[172:173], v[236:237]
    v_pk_add_f32 v[174:175], v[174:175], v[238:239]
    v_pk_add_f32 v[40:41], v[40:41], v[248:249]
    v_pk_add_f32 v[42:43], v[42:43], v[250:251]
    v_pk_add_f32 v[44:45], v[44:45], v[252:253]
    v_pk_add_f32 v[46:47], v[46:47], v[254:255]
    buffer_load_dwordx4 v9, s[20:23], s57 offen offset:1024 lds
    s_waitcnt vmcnt(11)
    ds_read_b64_tr_b16 a[24:25], v4 offset:8192
    ds_read_b64_tr_b16 a[26:27], v4 offset:9216
    ds_read_b64_tr_b16 a[28:29], v4 offset:8448
    ds_read_b64_tr_b16 a[30:31], v4 offset:9472
    v_pk_add_f32 v[40:41], v[40:41], v[168:169]
    v_pk_add_f32 v[42:43], v[42:43], v[170:171]
    v_pk_add_f32 v[44:45], v[44:45], v[172:173]
    v_pk_add_f32 v[46:47], v[46:47], v[174:175]
    s_add_u32 m0, s52, 122880
    s_mov_b32 s57, 589824
    buffer_load_dwordx4 v8, s[20:23], s57 offen lds
    v_pk_mul_f32 v[48:49], v[40:41], v[40:41]
    v_pk_mul_f32 v[50:51], v[42:43], v[42:43]
    v_pk_mul_f32 v[52:53], v[44:45], v[44:45]
    v_pk_mul_f32 v[54:55], v[46:47], v[46:47]
    v_pk_fma_f32 v[48:49], v[48:49], v[186:187], v[186:187] op_sel:[0,0,1] op_sel_hi:[1,0,1]
    v_pk_fma_f32 v[50:51], v[50:51], v[186:187], v[186:187] op_sel:[0,0,1] op_sel_hi:[1,0,1]
    v_pk_fma_f32 v[52:53], v[52:53], v[186:187], v[186:187] op_sel:[0,0,1] op_sel_hi:[1,0,1]
    v_pk_fma_f32 v[54:55], v[54:55], v[186:187], v[186:187] op_sel:[0,0,1] op_sel_hi:[1,0,1]
    v_pk_mul_f32 v[48:49], v[48:49], v[40:41]
    v_pk_mul_f32 v[50:51], v[50:51], v[42:43]
    v_pk_mul_f32 v[52:53], v[52:53], v[44:45]
    v_pk_mul_f32 v[54:55], v[54:55], v[46:47]
    buffer_load_dwordx4 v9, s[20:23], s57 offen offset:1024 lds
    s_waitcnt vmcnt(11)
    ds_read_b64_tr_b16 a[32:33], v4 offset:16384
    ds_read_b64_tr_b16 a[34:35], v4 offset:17408
    ds_read_b64_tr_b16 a[36:37], v4 offset:16640
    ds_read_b64_tr_b16 a[38:39], v4 offset:17664
    v_exp_f32 v48, v48
    v_exp_f32 v49, v49
    v_exp_f32 v50, v50
    v_exp_f32 v51, v51
    s_add_u32 m0, s52, 131072
    s_mov_b32 s57, 655360
    buffer_load_dwordx4 v8, s[20:23], s57 offen lds
    v_exp_f32 v52, v52
    v_exp_f32 v53, v53
    v_exp_f32 v54, v54
    v_exp_f32 v55, v55
    v_pk_add_f32 v[48:49], v[48:49], 1.0 op_sel_hi:[1,0]
    v_pk_add_f32 v[50:51], v[50:51], 1.0 op_sel_hi:[1,0]
    v_pk_add_f32 v[52:53], v[52:53], 1.0 op_sel_hi:[1,0]
    v_pk_add_f32 v[54:55], v[54:55], 1.0 op_sel_hi:[1,0]
    v_rcp_f32 v48, v48
    v_rcp_f32 v49, v49
    v_rcp_f32 v50, v50
    v_rcp_f32 v51, v51
    buffer_load_dwordx4 v9, s[20:23], s57 offen offset:1024 lds
    s_waitcnt vmcnt(11)
    ds_read_b64_tr_b16 a[40:41], v4 offset:24576
    ds_read_b64_tr_b16 a[42:43], v4 offset:25600
    ds_read_b64_tr_b16 a[44:45], v4 offset:24832
    ds_read_b64_tr_b16 a[46:47], v4 offset:25856
    v_rcp_f32 v52, v52
    v_rcp_f32 v53, v53
    v_rcp_f32 v54, v54
    v_rcp_f32 v55, v55
    s_add_u32 m0, s52, 139264
    s_mov_b32 s57, 720896
    buffer_load_dwordx4 v8, s[20:23], s57 offen lds
    v_pk_mul_f32 v[48:49], v[48:49], v[40:41]
    v_pk_mul_f32 v[50:51], v[50:51], v[42:43]
    v_pk_mul_f32 v[52:53], v[52:53], v[44:45]
    v_pk_mul_f32 v[54:55], v[54:55], v[46:47]
    v_cvt_pk_bf16_f32 v60, v48, v49
    v_cvt_pk_bf16_f32 v61, v50, v51
    v_cvt_pk_bf16_f32 v62, v52, v53
    v_cvt_pk_bf16_f32 v63, v54, v55
    buffer_store_dwordx4 v[60:63], v13, s[24:27], s64 offen offset:2048 sc1
    buffer_load_dwordx4 v9, s[20:23], s57 offen offset:1024 lds
    s_waitcnt vmcnt(12)
    ds_read_b64_tr_b16 a[48:49], v4 offset:32768
    ds_read_b64_tr_b16 a[50:51], v4 offset:33792
    ds_read_b64_tr_b16 a[52:53], v4 offset:33024
    ds_read_b64_tr_b16 a[54:55], v4 offset:34048
    s_waitcnt lgkmcnt(15)
    s_add_u32 m0, s52, 147456
    s_mov_b32 s57, 786432
    buffer_load_dwordx4 v8, s[20:23], s57 offen lds
    buffer_load_dwordx4 v9, s[20:23], s57 offen offset:1024 lds
    s_waitcnt vmcnt(12)
    ds_read_b64_tr_b16 a[56:57], v4 offset:40960
    ds_read_b64_tr_b16 a[58:59], v4 offset:41984
    ds_read_b64_tr_b16 a[60:61], v4 offset:41216
    ds_read_b64_tr_b16 a[62:63], v4 offset:42240
    s_add_u32 m0, s52, 155648
    s_mov_b32 s57, 851968
    buffer_load_dwordx4 v8, s[20:23], s57 offen lds
    buffer_load_dwordx4 v9, s[20:23], s57 offen offset:1024 lds
    s_waitcnt vmcnt(11)
    ds_read_b64_tr_b16 a[64:65], v4 offset:49152
    ds_read_b64_tr_b16 a[66:67], v4 offset:50176
    ds_read_b64_tr_b16 a[68:69], v4 offset:49408
    ds_read_b64_tr_b16 a[70:71], v4 offset:50432
    s_add_u32 m0, s52, 65536
    s_mov_b32 s57, 917504
    buffer_load_dwordx4 v8, s[20:23], s57 offen lds
    buffer_load_dwordx4 v9, s[20:23], s57 offen offset:1024 lds
    s_waitcnt vmcnt(11)
    ds_read_b64_tr_b16 a[72:73], v4 offset:57344
    ds_read_b64_tr_b16 a[74:75], v4 offset:58368
    ds_read_b64_tr_b16 a[76:77], v4 offset:57600
    ds_read_b64_tr_b16 a[78:79], v4 offset:58624
    s_waitcnt lgkmcnt(15)
    s_add_u32 m0, s52, 73728
    s_mov_b32 s57, 983040
    buffer_load_dwordx4 v8, s[20:23], s57 offen lds
    buffer_load_dwordx4 v9, s[20:23], s57 offen offset:1024 lds
    s_waitcnt vmcnt(11)
    ds_read_b64_tr_b16 a[80:81], v5 offset:0
    ds_read_b64_tr_b16 a[82:83], v5 offset:1024
    ds_read_b64_tr_b16 a[84:85], v5 offset:256
    ds_read_b64_tr_b16 a[86:87], v5 offset:1280
    s_add_u32 m0, s52, 81920
    s_mov_b32 s57, 1048576
    buffer_load_dwordx4 v8, s[20:23], s57 offen lds
    s_waitcnt vmcnt(10)
    s_barrier
    s_cmp_lg_u32 s44, 0
    s_cbranch_scc1 L_nopub7
    s_lshl_b32 s62, s51, 5
    s_add_u32 s62, s62, s50
    s_lshl_b32 s62, s62, 7
    s_add_u32 s62, s62, 12713984
    v_mov_b32 v30, s47
    s_mov_b64 exec, 1
    buffer_store_dword v30, off, s[24:27], s62 sc1
    s_mov_b64 exec, -1
L_nopub7:
L_p3join:
    v_lshlrev_b32 v216, 16, v216
    v_lshlrev_b32 v232, 16, v208
    v_and_b32 v233, s63, v208
    v_lshlrev_b32 v234, 16, v209
    v_and_b32 v235, s63, v209
    v_lshlrev_b32 v236, 16, v210
    v_and_b32 v237, s63, v210
    v_lshlrev_b32 v238, 16, v211
    v_and_b32 v239, s63, v211
    v_add_f32 v232, v232, v216
    v_add_f32 v233, v233, v216
    v_add_f32 v234, v234, v216
    buffer_load_dwordx4 v9, s[20:23], s57 offen offset:1024 lds
    s_waitcnt vmcnt(10)
    ds_read_b64_tr_b16 a[88:89], v5 offset:8192
    ds_read_b64_tr_b16 a[90:91], v5 offset:9216
    ds_read_b64_tr_b16 a[92:93], v5 offset:8448
    ds_read_b64_tr_b16 a[94:95], v5 offset:9472
    v_add_f32 v235, v235, v216
    v_add_f32 v236, v236, v216
    v_add_f32 v237, v237, v216
    v_add_f32 v238, v238, v216
    v_add_f32 v239, v239, v216
    v_lshlrev_b32 v217, 16, v217
    v_lshlrev_b32 v240, 16, v212
    v_and_b32 v241, s63, v212
    v_lshlrev_b32 v242, 16, v213
    v_and_b32 v243, s63, v213
    v_lshlrev_b32 v244, 16, v214
    v_and_b32 v245, s63, v214
    s_add_u32 m0, s52, 90112
    s_mov_b32 s57, 1114112
    buffer_load_dwordx4 v8, s[20:23], s57 offen lds
    v_lshlrev_b32 v246, 16, v215
    v_and_b32 v247, s63, v215
    v_add_f32 v240, v240, v217
    v_add_f32 v241, v241, v217
    v_add_f32 v242, v242, v217
    v_add_f32 v243, v243, v217
    v_add_f32 v244, v244, v217
    v_add_f32 v245, v245, v217
    v_add_f32 v246, v246, v217
    v_add_f32 v247, v247, v217
    buffer_load_dwordx4 v9, s[20:23], s57 offen offset:1024 lds
    s_waitcnt vmcnt(10)
    ds_read_b64_tr_b16 a[96:97], v5 offset:16384
    ds_read_b64_tr_b16 a[98:99], v5 offset:17408
    ds_read_b64_tr_b16 a[100:101], v5 offset:16640
    ds_read_b64_tr_b16 a[102:103], v5 offset:17664
    s_waitcnt lgkmcnt(15)
    s_add_u32 m0, s52, 98304
    s_mov_b32 s57, 1179648
    buffer_load_dwordx4 v8, s[20:23], s57 offen lds
    buffer_load_dwordx4 v9, s[20:23], s57 offen offset:1024 lds
    s_waitcnt vmcnt(10)
    ds_read_b64_tr_b16 a[104:105], v5 offset:24576
    ds_read_b64_tr_b16 a[106:107], v5 offset:25600
    ds_read_b64_tr_b16 a[108:109], v5 offset:24832
    ds_read_b64_tr_b16 a[110:111], v5 offset:25856
    s_add_u32 m0, s52, 106496
    s_mov_b32 s57, 1245184
    buffer_load_dwordx4 v8, s[20:23], s57 offen lds
    buffer_load_dwordx4 v9, s[20:23], s57 offen offset:1024 lds
    s_waitcnt vmcnt(10)
    ds_read_b64_tr_b16 a[112:113], v4 offset:0
    ds_read_b64_tr_b16 a[114:115], v4 offset:1024
    ds_read_b64_tr_b16 a[116:117], v4 offset:256
    ds_read_b64_tr_b16 a[118:119], v4 offset:1280
    s_add_u32 m0, s52, 114688
    s_mov_b32 s57, 1310720
    buffer_load_dwordx4 v8, s[20:23], s57 offen lds
    buffer_load_dwordx4 v9, s[20:23], s57 offen offset:1024 lds
    s_waitcnt vmcnt(10)
    ds_read_b64_tr_b16 a[120:121], v4 offset:8192
    ds_read_b64_tr_b16 a[122:123], v4 offset:9216
    ds_read_b64_tr_b16 a[124:125], v4 offset:8448
    ds_read_b64_tr_b16 a[126:127], v4 offset:9472
    s_waitcnt lgkmcnt(15)
    s_add_u32 m0, s52, 122880
    s_mov_b32 s57, 1376256
    buffer_load_dwordx4 v8, s[20:23], s57 offen lds
    buffer_load_dwordx4 v9, s[20:23], s57 offen offset:1024 lds
    s_waitcnt vmcnt(10)
    ds_read_b64_tr_b16 a[128:129], v4 offset:16384
    ds_read_b64_tr_b16 a[130:131], v4 offset:17408
    ds_read_b64_tr_b16 a[132:133], v4 offset:16640
    ds_read_b64_tr_b16 a[134:135], v4 offset:17664
    s_add_u32 m0, s52, 131072
    s_mov_b32 s57, 1441792
    buffer_load_dwordx4 v8, s[20:23], s57 offen lds
    buffer_load_dwordx4 v9, s[20:23], s57 offen offset:1024 lds
    s_waitcnt vmcnt(10)
    ds_read_b64_tr_b16 a[136:137], v4 offset:24576
    ds_read_b64_tr_b16 a[138:139], v4 offset:25600
    ds_read_b64_tr_b16 a[140:141], v4 offset:24832
    ds_read_b64_tr_b16 a[142:143], v4 offset:25856
    s_add_u32 m0, s52, 139264
    s_mov_b32 s57, 1507328
    buffer_load_dwordx4 v8, s[20:23], s57 offen lds
    buffer_load_dwordx4 v9, s[20:23], s57 offen offset:1024 lds
    s_waitcnt vmcnt(10)
    ds_read_b64_tr_b16 a[144:145], v4 offset:32768
    ds_read_b64_tr_b16 a[146:147], v4 offset:33792
    ds_read_b64_tr_b16 a[148:149], v4 offset:33024
    ds_read_b64_tr_b16 a[150:151], v4 offset:34048
    s_waitcnt lgkmcnt(15)
    s_add_u32 m0, s52, 147456
    s_mov_b32 s57, 1572864
    buffer_load_dwordx4 v8, s[20:23], s57 offen lds
    buffer_load_dwordx4 v9, s[20:23], s57 offen offset:1024 lds
    s_waitcnt vmcnt(10)
    ds_read_b64_tr_b16 a[152:153], v4 offset:40960
    ds_read_b64_tr_b16 a[154:155], v4 offset:41984
    ds_read_b64_tr_b16 a[156:157], v4 offset:41216
    ds_read_b64_tr_b16 a[158:159], v4 offset:42240
    s_add_u32 m0, s52, 155648
    s_mov_b32 s57, 1638400
    buffer_load_dwordx4 v8, s[20:23], s57 offen lds
    buffer_load_dwordx4 v9, s[20:23], s57 offen offset:1024 lds
    s_waitcnt vmcnt(10)
    ds_read_b64_tr_b16 a[160:161], v4 offset:49152
    ds_read_b64_tr_b16 a[162:163], v4 offset:50176
    ds_read_b64_tr_b16 a[164:165], v4 offset:49408
    ds_read_b64_tr_b16 a[166:167], v4 offset:50432
    s_add_u32 m0, s52, 65536
    s_mov_b32 s57, 1703936
    buffer_load_dwordx4 v8, s[20:23], s57 offen lds
    buffer_load_dwordx4 v9, s[20:23], s57 offen offset:1024 lds
    s_waitcnt vmcnt(10)
    ds_read_b64_tr_b16 a[168:169], v4 offset:57344
    ds_read_b64_tr_b16 a[170:171], v4 offset:58368
    ds_read_b64_tr_b16 a[172:173], v4 offset:57600
    ds_read_b64_tr_b16 a[174:175], v4 offset:58624
    s_waitcnt lgkmcnt(15)
    s_add_u32 m0, s52, 73728
    s_mov_b32 s57, 1769472
    buffer_load_dwordx4 v8, s[20:23], s57 offen lds
    buffer_load_dwordx4 v9, s[20:23], s57 offen offset:1024 lds
    s_waitcnt vmcnt(10)
    ds_read_b64_tr_b16 a[176:177], v5 offset:0
    ds_read_b64_tr_b16 a[178:179], v5 offset:1024
    ds_read_b64_tr_b16 a[180:181], v5 offset:256
    ds_read_b64_tr_b16 a[182:183], v5 offset:1280
    s_add_u32 m0, s52, 81920
    s_mov_b32 s57, 0
    buffer_load_dwordx4 v10, s[12:15], s57 offen lds
    buffer_load_dwordx4 v11, s[12:15], s57 offen offset:1024 lds
    s_waitcnt vmcnt(10)
    ds_read_b64_tr_b16 a[184:185], v5 offset:8192
    ds_read_b64_tr_b16 a[186:187], v5 offset:9216
    ds_read_b64_tr_b16 a[188:189], v5 offset:8448
    ds_read_b64_tr_b16 a[190:191], v5 offset:9472
    s_add_u32 m0, s52, 90112
    s_mov_b32 s57, 14336
    buffer_load_dwordx4 v10, s[12:15], s57 offen lds
    buffer_load_dwordx4 v11, s[12:15], s57 offen offset:1024 lds
    s_waitcnt vmcnt(10)
    ds_read_b64_tr_b16 a[192:193], v5 offset:16384
    ds_read_b64_tr_b16 a[194:195], v5 offset:17408
    ds_read_b64_tr_b16 a[196:197], v5 offset:16640
    ds_read_b64_tr_b16 a[198:199], v5 offset:17664
    s_waitcnt lgkmcnt(15)
    s_add_u32 m0, s52, 98304
    s_mov_b32 s57, 21504
    buffer_load_dwordx4 v10, s[12:15], s57 offen lds
    buffer_load_dwordx4 v11, s[12:15], s57 offen offset:1024 lds
    s_waitcnt vmcnt(10)
    ds_read_b64_tr_b16 a[200:201], v5 offset:24576
    ds_read_b64_tr_b16 a[202:203], v5 offset:25600
    ds_read_b64_tr_b16 a[204:205], v5 offset:24832
    ds_read_b64_tr_b16 a[206:207], v5 offset:25856
    s_add_u32 m0, s52, 106496
    s_mov_b32 s57, 35840
    buffer_load_dwordx4 v10, s[12:15], s57 offen lds
    buffer_load_dwordx4 v11, s[12:15], s57 offen offset:1024 lds
    s_waitcnt vmcnt(10)
    ds_read_b64_tr_b16 a[208:209], v4 offset:0
    ds_read_b64_tr_b16 a[210:211], v4 offset:1024
    ds_read_b64_tr_b16 a[212:213], v4 offset:256
    ds_read_b64_tr_b16 a[214:215], v4 offset:1280
    s_add_u32 m0, s52, 114688
    s_mov_b32 s57, 50176
    buffer_load_dwordx4 v10, s[12:15], s57 offen lds
    buffer_load_dwordx4 v11, s[12:15], s57 offen offset:1024 lds
    s_waitcnt vmcnt(10)
    ds_read_b64_tr_b16 a[216:217], v4 offset:8192
    ds_read_b64_tr_b16 a[218:219], v4 offset:9216
    ds_read_b64_tr_b16 a[220:221], v4 offset:8448
    ds_read_b64_tr_b16 a[222:223], v4 offset:9472
    buffer_load_dword v203, v204, s[24:27], 0 offen sc1
    s_waitcnt lgkmcnt(15)
    s_add_u32 m0, s52, 122880
    s_mov_b32 s57, 64512
    buffer_load_dwordx4 v10, s[12:15], s57 offen lds
    s_waitcnt vmcnt(10)
    ds_read_b64_tr_b16 a[224:225], v2 offset:16384
    ds_read_b64_tr_b16 a[226:227], v2 offset:16896
    ds_read_b64_tr_b16 a[228:229], v2 offset:16640
    ds_read_b64_tr_b16 a[230:231], v2 offset:17152
    buffer_load_dwordx4 v11, s[12:15], s57 offen offset:1024 lds
    s_add_u32 m0, s52, 131072
    s_mov_b32 s57, 71680
    buffer_load_dwordx4 v10, s[12:15], s57 offen lds
    s_waitcnt vmcnt(10)
    ds_read_b64_tr_b16 a[232:233], v2 offset:24576
    ds_read_b64_tr_b16 a[234:235], v2 offset:25088
    ds_read_b64_tr_b16 a[236:237], v2 offset:24832
    ds_read_b64_tr_b16 a[238:239], v2 offset:25344
    buffer_load_dwordx4 v11, s[12:15], s57 offen offset:1024 lds
    s_add_u32 m0, s52, 139264
    s_mov_b32 s57, 86016
    buffer_load_dwordx4 v10, s[12:15], s57 offen lds
    s_waitcnt vmcnt(10)
    ds_read_b64_tr_b16 a[240:241], v2 offset:32768
    ds_read_b64_tr_b16 a[242:243], v2 offset:33280
    ds_read_b64_tr_b16 a[244:245], v2 offset:33024
    ds_read_b64_tr_b16 a[246:247], v2 offset:33536
    buffer_load_dwordx4 v11, s[12:15], s57 offen offset:1024 lds
    s_waitcnt vmcnt(6)
    v_cmp_ne_u32 vcc, s47, v203
    s_nop 0
    s_cbranch_vccz L_ok9
    s_mov_b32 s59, 20000
L_spin8:
    buffer_load_dword v203, v204, s[24:27], 0 offen sc1
    s_waitcnt vmcnt(0)
    v_cmp_ne_u32 vcc, s47, v203
    s_nop 0
    s_cbranch_vccz L_ok9
    s_sub_u32 s59, s59, 1
    s_cbranch_scc0 L_spin8
L_ok9:
    s_add_u32 s58, s61, 0
    buffer_load_dwordx4 v[96:99], v15, s[24:27], s58 offen offset:0 sc1
    ds_read_b64_tr_b16 a[248:249], v2 offset:40960
    ds_read_b64_tr_b16 a[250:251], v2 offset:41472
    ds_read_b64_tr_b16 a[252:253], v2 offset:41216
    ds_read_b64_tr_b16 a[254:255], v2 offset:41728
    buffer_load_dwordx4 v[100:103], v15, s[24:27], s58 offen offset:2048 sc1
    s_add_u32 s58, s61, 4096
    buffer_load_dwordx4 v[104:107], v15, s[24:27], s58 offen offset:0 sc1
    buffer_load_dwordx4 v[108:111], v15, s[24:27], s58 offen offset:2048 sc1
    s_add_u32 s58, s61, 8192
    buffer_load_dwordx4 v[112:115], v15, s[24:27], s58 offen offset:0 sc1
    buffer_load_dwordx4 v[116:119], v15, s[24:27], s58 offen offset:2048 sc1
    s_add_u32 s58, s61, 12288
    buffer_load_dwordx4 v[120:123], v15, s[24:27], s58 offen offset:0 sc1
    buffer_load_dwordx4 v[124:127], v15, s[24:27], s58 offen offset:2048 sc1
    s_add_u32 s58, s61, 16384
    buffer_load_dwordx4 v[128:131], v15, s[24:27], s58 offen offset:0 sc1
    buffer_load_dwordx4 v[132:135], v15, s[24:27], s58 offen offset:2048 sc1
    s_add_u32 s58, s61, 20480
    buffer_load_dwordx4 v[136:139], v15, s[24:27], s58 offen offset:0 sc1
    s_waitcnt vmcnt(10)
    v_mfma_f32_32x32x16_bf16 v[64:79], v[96:99], a[0:3], 0
    v_mfma_f32_32x32x16_bf16 v[80:95], v[96:99], a[4:7], 0
    buffer_load_dwordx4 v[140:143], v15, s[24:27], s58 offen offset:2048 sc1
    s_waitcnt vmcnt(10)
    v_mfma_f32_32x32x16_bf16 v[64:79], v[100:103], a[8:11], v[64:79]
    v_mfma_f32_32x32x16_bf16 v[80:95], v[100:103], a[12:15], v[80:95]
    s_add_u32 s58, s61, 24576
    buffer_load_dwordx4 v[144:147], v15, s[24:27], s58 offen offset:0 sc1
    s_waitcnt vmcnt(10)
    v_mfma_f32_32x32x16_bf16 v[64:79], v[104:107], a[16:19], v[64:79]
    v_mfma_f32_32x32x16_bf16 v[80:95], v[104:107], a[20:23], v[80:95]
    buffer_load_dwordx4 v[148:151], v15, s[24:27], s58 offen offset:2048 sc1
    s_waitcnt vmcnt(10)
    v_mfma_f32_32x32x16_bf16 v[64:79], v[108:111], a[24:27], v[64:79]
    v_mfma_f32_32x32x16_bf16 v[80:95], v[108:111], a[28:31], v[80:95]
    s_add_u32 s58, s61, 28672
    buffer_load_dwordx4 v[152:155], v15, s[24:27], s58 offen offset:0 sc1
    s_waitcnt vmcnt(10)
    v_mfma_f32_32x32x16_bf16 v[64:79], v[112:115], a[32:35], v[64:79]
    v_mfma_f32_32x32x16_bf16 v[80:95], v[112:115], a[36:39], v[80:95]
    buffer_load_dwordx4 v[156:159], v15, s[24:27], s58 offen offset:2048 sc1
    s_waitcnt vmcnt(10)
    v_mfma_f32_32x32x16_bf16 v[64:79], v[116:119], a[40:43], v[64:79]
    v_mfma_f32_32x32x16_bf16 v[80:95], v[116:119], a[44:47], v[80:95]
    s_add_u32 s58, s61, 32768
    buffer_load_dwordx4 v[96:99], v15, s[24:27], s58 offen offset:0 sc1
    s_waitcnt vmcnt(10)
    v_mfma_f32_32x32x16_bf16 v[64:79], v[120:123], a[48:51], v[64:79]
    v_mfma_f32_32x32x16_bf16 v[80:95], v[120:123], a[52:55], v[80:95]
    buffer_load_dwordx4 v[100:103], v15, s[24:27], s58 offen offset:2048 sc1
    s_waitcnt vmcnt(10)
    v_mfma_f32_32x32x16_bf16 v[64:79], v[124:127], a[56:59], v[64:79]
    v_mfma_f32_32x32x16_bf16 v[80:95], v[124:127], a[60:63], v[80:95]
    buffer_load_dword v201, v202, s[24:27], 0 offen sc1
    s_waitcnt vmcnt(10)
    v_mfma_f32_32x32x16_bf16 v[64:79], v[128:131], a[64:67], v[64:79]
    v_mfma_f32_32x32x16_bf16 v[80:95], v[128:131], a[68:71], v[80:95]
    s_add_u32 s58, s61, 36864
    buffer_load_dwordx4 v[104:107], v15, s[24:27], s58 offen offset:0 sc1
    s_waitcnt vmcnt(10)
    v_mfma_f32_32x32x16_bf16 v[64:79], v[132:135], a[72:75], v[64:79]
    v_mfma_f32_32x32x16_bf16 v[80:95], v[132:135], a[76:79], v[80:95]
    buffer_load_dwordx4 v[108:111], v15, s[24:27], s58 offen offset:2048 sc1
    s_waitcnt vmcnt(10)
    v_mfma_f32_32x32x16_bf16 v[64:79], v[136:139], a[80:83], v[64:79]
    v_mfma_f32_32x32x16_bf16 v[80:95], v[136:139], a[84:87], v[80:95]
    s_add_u32 s58, s61, 40960
    buffer_load_dwordx4 v[112:115], v15, s[24:27], s58 offen offset:0 sc1
    s_waitcnt vmcnt(10)
    v_mfma_f32_32x32x16_bf16 v[64:79], v[140:143], a[88:91], v[64:79]
    v_mfma_f32_32x32x16_bf16 v[80:95], v[140:143], a[92:95], v[80:95]
    buffer_load_dwordx4 v[116:119], v15, s[24:27], s58 offen offset:2048 sc1
    s_waitcnt vmcnt(10)
    v_mfma_f32_32x32x16_bf16 v[64:79], v[144:147], a[96:99], v[64:79]
    v_mfma_f32_32x32x16_bf16 v[80:95], v[144:147], a[100:103], v[80:95]
    s_add_u32 s58, s61, 45056
    buffer_load_dwordx4 v[120:123], v15, s[24:27], s58 offen offset:0 sc1
    s_waitcnt vmcnt(10)
    v_mfma_f32_32x32x16_bf16 v[64:79], v[148:151], a[104:107], v[64:79]
    v_mfma_f32_32x32x16_bf16 v[80:95], v[148:151], a[108:111], v[80:95]
    buffer_load_dwordx4 v[124:127], v15, s[24:27], s58 offen offset:2048 sc1
    s_waitcnt vmcnt(10)
    v_mfma_f32_32x32x16_bf16 v[64:79], v[152:155], a[112:115], v[64:79]
    v_mfma_f32_32x32x16_bf16 v[80:95], v[152:155], a[116:119], v[80:95]
    s_add_u32 s58, s61, 49152
    buffer_load_dwordx4 v[128:131], v15, s[24:27], s58 offen offset:0 sc1
    s_waitcnt vmcnt(10)
    v_mfma_f32_32x32x16_bf16 v[64:79], v[156:159], a[120:123], v[64:79]
    v_mfma_f32_32x32x16_bf16 v[80:95], v[156:159], a[124:127], v[80:95]
    buffer_load_dwordx4 v[132:135], v15, s[24:27], s58 offen offset:2048 sc1
    s_waitcnt vmcnt(10)
    v_mfma_f32_32x32x16_bf16 v[64:79], v[96:99], a[128:131], v[64:79]
    v_mfma_f32_32x32x16_bf16 v[80:95], v[96:99], a[132:135], v[80:95]
    s_add_u32 s58, s61, 53248
    buffer_load_dwordx4 v[136:139], v15, s[24:27], s58 offen offset:0 sc1
    s_waitcnt vmcnt(10)
    v_mfma_f32_32x32x16_bf16 v[64:79], v[100:103], a[136:139], v[64:79]
    v_mfma_f32_32x32x16_bf16 v[80:95], v[100:103], a[140:143], v[80:95]
    buffer_load_dwordx4 v[140:143], v15, s[24:27], s58 offen offset:2048 sc1
    s_waitcnt vmcnt(10)
    v_cmp_ne_u32 vcc, s47, v201
    s_nop 0
    s_cbranch_vccz L_ok11
    s_mov_b32 s59, 20000
L_spin10:
    buffer_load_dword v201, v202, s[24:27], 0 offen sc1
    s_waitcnt vmcnt(0)
    v_cmp_ne_u32 vcc, s47, v201
    s_nop 0
    s_cbranch_vccz L_ok11
    s_sub_u32 s59, s59, 1
    s_cbranch_scc0 L_spin10
L_ok11:
    buffer_load_dwordx4 v[144:147], v12, s[24:27], s88 offen offset:0 sc1
    s_waitcnt vmcnt(10)
    v_mfma_f32_32x32x16_bf16 v[64:79], v[104:107], a[144:147], v[64:79]
    v_mfma_f32_32x32x16_bf16 v[80:95], v[104:107], a[148:151], v[80:95]
    buffer_load_dwordx4 v[148:151], v12, s[24:27], s88 offen offset:1024 sc1
    s_waitcnt vmcnt(10)
    v_mfma_f32_32x32x16_bf16 v[64:79], v[108:111], a[152:155], v[64:79]
    v_mfma_f32_32x32x16_bf16 v[80:95], v[108:111], a[156:159], v[80:95]
    buffer_load_dwordx4 v[152:155], v12, s[24:27], s88 offen offset:2048 sc1
    s_waitcnt vmcnt(10)
    v_mfma_f32_32x32x16_bf16 v[64:79], v[112:115], a[160:163], v[64:79]
    v_mfma_f32_32x32x16_bf16 v[80:95], v[112:115], a[164:167], v[80:95]
    buffer_load_dwordx4 v[156:159], v12, s[24:27], s88 offen offset:3072 sc1
    s_waitcnt vmcnt(10)
    v_mfma_f32_32x32x16_bf16 v[64:79], v[116:119], a[168:171], v[64:79]
    v_mfma_f32_32x32x16_bf16 v[80:95], v[116:119], a[172:175], v[80:95]
    s_add_u32 s88, s88, 4096
    buffer_load_dwordx4 v[96:99], v12, s[24:27], s88 offen offset:0 sc1
    s_waitcnt vmcnt(10)
    v_mfma_f32_32x32x16_bf16 v[64:79], v[120:123], a[176:179], v[64:79]
    v_mfma_f32_32x32x16_bf16 v[80:95], v[120:123], a[180:183], v[80:95]
    buffer_load_dwordx4 v[100:103], v12, s[24:27], s88 offen offset:1024 sc1
    s_waitcnt vmcnt(10)
    v_mfma_f32_32x32x16_bf16 v[64:79], v[124:127], a[184:187], v[64:79]
    v_mfma_f32_32x32x16_bf16 v[80:95], v[124:127], a[188:191], v[80:95]
    buffer_load_dwordx4 v[104:107], v12, s[24:27], s88 offen offset:2048 sc1
    s_waitcnt vmcnt(10)
    s_waitcnt lgkmcnt(15)
    v_mfma_f32_32x32x16_bf16 v[64:79], v[128:131], a[192:195], v[64:79]
    v_mfma_f32_32x32x16_bf16 v[80:95], v[128:131], a[196:199], v[80:95]
    buffer_load_dwordx4 v[108:111], v12, s[24:27], s88 offen offset:3072 sc1
    s_waitcnt vmcnt(10)
    v_mfma_f32_32x32x16_bf16 v[64:79], v[132:135], a[200:203], v[64:79]
    v_mfma_f32_32x32x16_bf16 v[80:95], v[132:135], a[204:207], v[80:95]
    s_add_u32 s88, s88, 4096
    buffer_load_dwordx4 v[112:115], v12, s[24:27], s88 offen offset:0 sc1
    s_waitcnt vmcnt(10)
    v_mfma_f32_32x32x16_bf16 v[64:79], v[136:139], a[208:211], v[64:79]
    v_mfma_f32_32x32x16_bf16 v[80:95], v[136:139], a[212:215], v[80:95]
    buffer_load_dwordx4 v[116:119], v12, s[24:27], s88 offen offset:1024 sc1
    s_waitcnt vmcnt(10)
    v_mfma_f32_32x32x16_bf16 v[64:79], v[140:143], a[216:219], v[64:79]
    v_mfma_f32_32x32x16_bf16 v[80:95], v[140:143], a[220:223], v[80:95]
    buffer_load_dwordx4 v[120:123], v12, s[24:27], s88 offen offset:2048 sc1
    s_waitcnt vmcnt(10)
    s_waitcnt lgkmcnt(12)
    v_mfma_f32_32x32x16_bf16 v[32:47], a[224:227], v[144:147], 0
    v_mfma_f32_32x32x16_bf16 v[64:79], a[228:231], v[144:147], v[64:79]
    buffer_load_dwordx4 v[124:127], v12, s[24:27], s88 offen offset:3072 sc1
    s_waitcnt vmcnt(10)
    v_mfma_f32_32x32x16_bf16 v[48:63], a[224:227], v[148:151], 0
    v_mfma_f32_32x32x16_bf16 v[80:95], a[228:231], v[148:151], v[80:95]
    ds_read_b64_tr_b16 a[224:225], v2 offset:49152
    ds_read_b64_tr_b16 a[226:227], v2 offset:49664
    ds_read_b64_tr_b16 a[228:229], v2 offset:49408
    ds_read_b64_tr_b16 a[230:231], v2 offset:49920
    s_add_u32 s88, s88, 4096
    buffer_load_dwordx4 v[128:131], v12, s[24:27], s88 offen offset:0 sc1
    s_waitcnt vmcnt(10)
    s_waitcnt lgkmcnt(12)
    v_mfma_f32_32x32x16_bf16 v[32:47], a[232:235], v[152:155], v[32:47]
    v_mfma_f32_32x32x16_bf16 v[64:79], a[236:239], v[152:155], v[64:79]
    buffer_load_dwordx4 v[132:135], v12, s[24:27], s88 offen offset:1024 sc1
    s_waitcnt vmcnt(10)
    v_mfma_f32_32x32x16_bf16 v[48:63], a[232:235], v[156:159], v[48:63]
    v_mfma_f32_32x32x16_bf16 v[80:95], a[236:239], v[156:159], v[80:95]
    ds_read_b64_tr_b16 a[232:233], v2 offset:57344
    ds_read_b64_tr_b16 a[234:235], v2 offset:57856
    ds_read_b64_tr_b16 a[236:237], v2 offset:57600
    ds_read_b64_tr_b16 a[238:239], v2 offset:58112
    buffer_load_dwordx4 v[136:139], v12, s[24:27], s88 offen offset:2048 sc1
    s_waitcnt vmcnt(10)
    s_waitcnt lgkmcnt(12)
    v_mfma_f32_32x32x16_bf16 v[32:47], a[240:243], v[96:99], v[32:47]
    v_mfma_f32_32x32x16_bf16 v[64:79], a[244:247], v[96:99], v[64:79]
    buffer_load_dwordx4 v[140:143], v12, s[24:27], s88 offen offset:3072 sc1
    s_waitcnt vmcnt(10)
    v_mfma_f32_32x32x16_bf16 v[48:63], a[240:243], v[100:103], v[48:63]
    v_mfma_f32_32x32x16_bf16 v[80:95], a[244:247], v[100:103], v[80:95]
    ds_read_b64_tr_b16 a[240:241], v3 offset:0
    ds_read_b64_tr_b16 a[242:243], v3 offset:512
    ds_read_b64_tr_b16 a[244:245], v3 offset:256
    ds_read_b64_tr_b16 a[246:247], v3 offset:768
    s_add_u32 s58, s61, 0
    buffer_load_dwordx4 v[144:147], v12, s[24:27], s58 offen offset:0 sc1
    s_waitcnt vmcnt(10)
    s_waitcnt lgkmcnt(12)
    v_mfma_f32_32x32x16_bf16 v[32:47], a[248:251], v[104:107], v[32:47]
    v_mfma_f32_32x32x16_bf16 v[64:79], a[252:255], v[104:107], v[64:79]
    buffer_load_dwordx4 v[148:151], v12, s[24:27], s58 offen offset:2048 sc1
    s_waitcnt vmcnt(10)
    v_mfma_f32_32x32x16_bf16 v[48:63], a[248:251], v[108:111], v[48:63]
    v_mfma_f32_32x32x16_bf16 v[80:95], a[252:255], v[108:111], v[80:95]
    ds_read_b64_tr_b16 a[248:249], v3 offset:8192
    ds_read_b64_tr_b16 a[250:251], v3 offset:8704
    ds_read_b64_tr_b16 a[252:253], v3 offset:8448
    ds_read_b64_tr_b16 a[254:255], v3 offset:8960
    s_add_u32 s58, s61, 4096
    buffer_load_dwordx4 v[152:155], v12, s[24:27], s58 offen offset:0 sc1
    s_waitcnt vmcnt(10)
    s_waitcnt lgkmcnt(12)
    v_mfma_f32_32x32x16_bf16 v[32:47], a[224:227], v[112:115], v[32:47]
    v_mfma_f32_32x32x16_bf16 v[64:79], a[228:231], v[112:115], v[64:79]
    buffer_load_dwordx4 v[156:159], v12, s[24:27], s58 offen offset:2048 sc1
    s_waitcnt vmcnt(10)
    v_mfma_f32_32x32x16_bf16 v[48:63], a[224:227], v[116:119], v[48:63]
    v_mfma_f32_32x32x16_bf16 v[80:95], a[228:231], v[116:119], v[80:95]
    s_add_u32 s58, s61, 8192
    buffer_load_dwordx4 v[96:99], v12, s[24:27], s58 offen offset:0 sc1
    s_waitcnt vmcnt(10)
    s_waitcnt lgkmcnt(8)
    v_mfma_f32_32x32x16_bf16 v[32:47], a[232:235], v[120:123], v[32:47]
    v_mfma_f32_32x32x16_bf16 v[64:79], a[236:239], v[120:123], v[64:79]
    buffer_load_dwordx4 v[100:103], v12, s[24:27], s58 offen offset:2048 sc1
    s_waitcnt vmcnt(10)
    v_mfma_f32_32x32x16_bf16 v[48:63], a[232:235], v[124:127], v[48:63]
    v_mfma_f32_32x32x16_bf16 v[80:95], a[236:239], v[124:127], v[80:95]
    s_add_u32 s58, s61, 12288
    buffer_load_dwordx4 v[104:107], v12, s[24:27], s58 offen offset:0 sc1
    s_waitcnt vmcnt(10)
    s_waitcnt lgkmcnt(4)
    v_mfma_f32_32x32x16_bf16 v[32:47], a[240:243], v[128:131], v[32:47]
    v_mfma_f32_32x32x16_bf16 v[64:79], a[244:247], v[128:131], v[64:79]
    buffer_load_dwordx4 v[108:111], v12, s[24:27], s58 offen offset:2048 sc1
    s_waitcnt vmcnt(10)
    v_mfma_f32_32x32x16_bf16 v[48:63], a[240:243], v[132:135], v[48:63]
    v_mfma_f32_32x32x16_bf16 v[80:95], a[244:247], v[132:135], v[80:95]
    s_add_u32 s58, s61, 16384
    buffer_load_dwordx4 v[112:115], v12, s[24:27], s58 offen offset:0 sc1
    s_waitcnt vmcnt(10)
    s_waitcnt lgkmcnt(0)
    v_mfma_f32_32x32x16_bf16 v[32:47], a[248:251], v[136:139], v[32:47]
    v_mfma_f32_32x32x16_bf16 v[64:79], a[252:255], v[136:139], v[64:79]
    buffer_load_dwordx4 v[116:119], v12, s[24:27], s58 offen offset:2048 sc1
    s_waitcnt vmcnt(10)
    v_mfma_f32_32x32x16_bf16 v[48:63], a[248:251], v[140:143], v[48:63]
    v_mfma_f32_32x32x16_bf16 v[80:95], a[252:255], v[140:143], v[80:95]
    s_add_u32 s58, s61, 20480
    buffer_load_dwordx4 v[120:123], v12, s[24:27], s58 offen offset:0 sc1
    s_waitcnt vmcnt(10)
    v_mfma_f32_32x32x16_bf16 v[32:47], v[144:147], a[0:3], v[32:47]
    v_mfma_f32_32x32x16_bf16 v[48:63], v[144:147], a[4:7], v[48:63]
    buffer_load_dwordx4 v[124:127], v12, s[24:27], s58 offen offset:2048 sc1
    s_waitcnt vmcnt(10)
    v_mfma_f32_32x32x16_bf16 v[32:47], v[148:151], a[8:11], v[32:47]
    v_mfma_f32_32x32x16_bf16 v[48:63], v[148:151], a[12:15], v[48:63]
    s_add_u32 s58, s61, 24576
    buffer_load_dwordx4 v[128:131], v12, s[24:27], s58 offen offset:0 sc1
    s_waitcnt vmcnt(10)
    v_mfma_f32_32x32x16_bf16 v[32:47], v[152:155], a[16:19], v[32:47]
    v_mfma_f32_32x32x16_bf16 v[48:63], v[152:155], a[20:23], v[48:63]
    buffer_load_dwordx4 v[132:135], v12, s[24:27], s58 offen offset:2048 sc1
    s_waitcnt vmcnt(10)
    v_mfma_f32_32x32x16_bf16 v[32:47], v[156:159], a[24:27], v[32:47]
    v_mfma_f32_32x32x16_bf16 v[48:63], v[156:159], a[28:31], v[48:63]
    s_add_u32 s58, s61, 28672
    buffer_load_dwordx4 v[136:139], v12, s[24:27], s58 offen offset:0 sc1
    s_waitcnt vmcnt(10)
    v_mfma_f32_32x32x16_bf16 v[32:47], v[96:99], a[32:35], v[32:47]
    v_mfma_f32_32x32x16_bf16 v[48:63], v[96:99], a[36:39], v[48:63]
    ds_write_b128 v224, v[64:67] offset:0
    buffer_load_dwordx4 v[140:143], v12, s[24:27], s58 offen offset:2048 sc1
    s_waitcnt vmcnt(10)
    v_mfma_f32_32x32x16_bf16 v[32:47], v[100:103], a[40:43], v[32:47]
    v_mfma_f32_32x32x16_bf16 v[48:63], v[100:103], a[44:47], v[48:63]
    ds_write_b128 v225, v[68:71] offset:0
    s_add_u32 s58, s61, 32768
    buffer_load_dwordx4 v[144:147], v12, s[24:27], s58 offen offset:0 sc1
    s_waitcnt vmcnt(10)
    v_mfma_f32_32x32x16_bf16 v[32:47], v[104:107], a[48:51], v[32:47]
    v_mfma_f32_32x32x16_bf16 v[48:63], v[104:107], a[52:55], v[48:63]
    ds_write_b128 v226, v[72:75] offset:0
    buffer_load_dwordx4 v[148:151], v12, s[24:27], s58 offen offset:2048 sc1
    s_waitcnt vmcnt(10)
    v_mfma_f32_32x32x16_bf16 v[32:47], v[108:111], a[56:59], v[32:47]
    v_mfma_f32_32x32x16_bf16 v[48:63], v[108:111], a[60:63], v[48:63]
    ds_write_b128 v227, v[76:79] offset:0
    s_add_u32 s58, s61, 36864
    buffer_load_dwordx4 v[152:155], v12, s[24:27], s58 offen offset:0 sc1
    s_waitcnt vmcnt(10)
    v_mfma_f32_32x32x16_bf16 v[32:47], v[112:115], a[64:67], v[32:47]
    v_mfma_f32_32x32x16_bf16 v[48:63], v[112:115], a[68:71], v[48:63]
    ds_write_b128 v224, v[80:83] offset:32768
    buffer_load_dwordx4 v[156:159], v12, s[24:27], s58 offen offset:2048 sc1
    s_waitcnt vmcnt(10)
    v_mfma_f32_32x32x16_bf16 v[32:47], v[116:119], a[72:75], v[32:47]
    v_mfma_f32_32x32x16_bf16 v[48:63], v[116:119], a[76:79], v[48:63]
    ds_write_b128 v225, v[84:87] offset:32768
    s_add_u32 s58, s61, 40960
    buffer_load_dwordx4 v[96:99], v12, s[24:27], s58 offen offset:0 sc1
    s_waitcnt vmcnt(10)
    v_mfma_f32_32x32x16_bf16 v[32:47], v[120:123], a[80:83], v[32:47]
    v_mfma_f32_32x32x16_bf16 v[48:63], v[120:123], a[84:87], v[48:63]
    ds_write_b128 v226, v[88:91] offset:32768
    buffer_load_dwordx4 v[100:103], v12, s[24:27], s58 offen offset:2048 sc1
    s_waitcnt vmcnt(10)
    v_mfma_f32_32x32x16_bf16 v[32:47], v[124:127], a[88:91], v[32:47]
    v_mfma_f32_32x32x16_bf16 v[48:63], v[124:127], a[92:95], v[48:63]
    ds_write_b128 v227, v[92:95] offset:32768
    s_add_u32 s58, s61, 45056
    buffer_load_dwordx4 v[104:107], v12, s[24:27], s58 offen offset:0 sc1
    s_waitcnt vmcnt(10)
    v_mfma_f32_32x32x16_bf16 v[32:47], v[128:131], a[96:99], v[32:47]
    v_mfma_f32_32x32x16_bf16 v[48:63], v[128:131], a[100:103], v[48:63]
    buffer_load_dwordx4 v[108:111], v12, s[24:27], s58 offen offset:2048 sc1
    s_waitcnt vmcnt(10)
    v_mfma_f32_32x32x16_bf16 v[32:47], v[132:135], a[104:107], v[32:47]
    v_mfma_f32_32x32x16_bf16 v[48:63], v[132:135], a[108:111], v[48:63]
    s_add_u32 s58, s61, 49152
    buffer_load_dwordx4 v[112:115], v12, s[24:27], s58 offen offset:0 sc1
    s_waitcnt vmcnt(10)
    v_mfma_f32_32x32x16_bf16 v[32:47], v[136:139], a[112:115], v[32:47]
    v_mfma_f32_32x32x16_bf16 v[48:63], v[136:139], a[116:119], v[48:63]
    buffer_load_dwordx4 v[116:119], v12, s[24:27], s58 offen offset:2048 sc1
    s_waitcnt vmcnt(10)
    v_mfma_f32_32x32x16_bf16 v[32:47], v[140:143], a[120:123], v[32:47]
    v_mfma_f32_32x32x16_bf16 v[48:63], v[140:143], a[124:127], v[48:63]
    s_add_u32 s58, s61, 53248
    buffer_load_dwordx4 v[120:123], v12, s[24:27], s58 offen offset:0 sc1
    s_waitcnt vmcnt(10)
    v_mfma_f32_32x32x16_bf16 v[32:47], v[144:147], a[128:131], v[32:47]
    v_mfma_f32_32x32x16_bf16 v[48:63], v[144:147], a[132:135], v[48:63]
    buffer_load_dwordx4 v[124:127], v12, s[24:27], s58 offen offset:2048 sc1
    s_waitcnt vmcnt(10)
    v_mfma_f32_32x32x16_bf16 v[32:47], v[148:151], a[136:139], v[32:47]
    v_mfma_f32_32x32x16_bf16 v[48:63], v[148:151], a[140:143], v[48:63]
    s_waitcnt vmcnt(9)
    v_mfma_f32_32x32x16_bf16 v[32:47], v[152:155], a[144:147], v[32:47]
    v_mfma_f32_32x32x16_bf16 v[48:63], v[152:155], a[148:151], v[48:63]
    s_waitcnt vmcnt(8)
    v_mfma_f32_32x32x16_bf16 v[32:47], v[156:159], a[152:155], v[32:47]
    v_mfma_f32_32x32x16_bf16 v[48:63], v[156:159], a[156:159], v[48:63]
    s_waitcnt vmcnt(7)
    v_mfma_f32_32x32x16_bf16 v[32:47], v[96:99], a[160:163], v[32:47]
    v_mfma_f32_32x32x16_bf16 v[48:63], v[96:99], a[164:167], v[48:63]
    s_waitcnt vmcnt(6)
    v_mfma_f32_32x32x16_bf16 v[32:47], v[100:103], a[168:171], v[32:47]
    v_mfma_f32_32x32x16_bf16 v[48:63], v[100:103], a[172:175], v[48:63]
    s_waitcnt vmcnt(5)
    v_mfma_f32_32x32x16_bf16 v[32:47], v[104:107], a[176:179], v[32:47]
    v_mfma_f32_32x32x16_bf16 v[48:63], v[104:107], a[180:183], v[48:63]
    s_waitcnt vmcnt(4)
    v_mfma_f32_32x32x16_bf16 v[32:47], v[108:111], a[184:187], v[32:47]
    v_mfma_f32_32x32x16_bf16 v[48:63], v[108:111], a[188:191], v[48:63]
    s_waitcnt vmcnt(3)
    v_mfma_f32_32x32x16_bf16 v[32:47], v[112:115], a[192:195], v[32:47]
    v_mfma_f32_32x32x16_bf16 v[48:63], v[112:115], a[196:199], v[48:63]
    s_waitcnt vmcnt(2)
    v_mfma_f32_32x32x16_bf16 v[32:47], v[116:119], a[200:203], v[32:47]
    v_mfma_f32_32x32x16_bf16 v[48:63], v[116:119], a[204:207], v[48:63]
    s_waitcnt vmcnt(1)
    v_mfma_f32_32x32x16_bf16 v[32:47], v[120:123], a[208:211], v[32:47]
    v_mfma_f32_32x32x16_bf16 v[48:63], v[120:123], a[212:215], v[48:63]
    s_waitcnt vmcnt(0)
    v_mfma_f32_32x32x16_bf16 v[32:47], v[124:127], a[216:219], v[32:47]
    v_mfma_f32_32x32x16_bf16 v[48:63], v[124:127], a[220:223], v[48:63]
    s_nop 10
    ds_write_b128 v220, v[32:35] offset:0
    ds_write_b128 v221, v[36:39] offset:0
    ds_write_b128 v222, v[40:43] offset:0
    ds_write_b128 v223, v[44:47] offset:0
    ds_write_b128 v220, v[48:51] offset:32768
    ds_write_b128 v221, v[52:55] offset:32768
    ds_write_b128 v222, v[56:59] offset:32768
    ds_write_b128 v223, v[60:63] offset:32768
    s_waitcnt lgkmcnt(0)
    s_barrier
    ds_read_b128 v[96:99], v228 offset:0
    ds_read_b128 v[100:103], v228 offset:2048
    ds_read_b128 v[104:107], v228 offset:4096
    ds_read_b128 v[108:111], v228 offset:6144
    ds_read_b128 v[112:115], v229 offset:0
    ds_read_b128 v[116:119], v229 offset:2048
    ds_read_b128 v[120:123], v229 offset:4096
    ds_read_b128 v[124:127], v229 offset:6144
    ds_read_b128 v[128:131], v228 offset:32768
    ds_read_b128 v[132:135], v228 offset:34816
    ds_read_b128 v[136:139], v228 offset:36864
    ds_read_b128 v[140:143], v228 offset:38912
    ds_read_b128 v[144:147], v229 offset:32768
    ds_read_b128 v[148:151], v229 offset:34816
    ds_read_b128 v[152:155], v229 offset:36864
    ds_read_b128 v[156:159], v229 offset:38912
    s_waitcnt lgkmcnt(12)
    v_pk_add_f32 v[96:97], v[96:97], v[100:101]
    v_pk_add_f32 v[104:105], v[104:105], v[108:109]
    v_pk_add_f32 v[98:99], v[98:99], v[102:103]
    v_pk_add_f32 v[106:107], v[106:107], v[110:111]
    v_pk_add_f32 v[232:233], v[232:233], v[96:97]
    v_pk_add_f32 v[234:235], v[234:235], v[98:99]
    v_pk_add_f32 v[232:233], v[232:233], v[104:105]
    v_pk_add_f32 v[234:235], v[234:235], v[106:107]
    v_cvt_pk_bf16_f32 v248, v232, v233
    v_cvt_pk_bf16_f32 v249, v234, v235
    s_waitcnt lgkmcnt(8)
    v_pk_add_f32 v[112:113], v[112:113], v[116:117]
    v_pk_add_f32 v[120:121], v[120:121], v[124:125]
    v_pk_add_f32 v[114:115], v[114:115], v[118:119]
    v_pk_add_f32 v[122:123], v[122:123], v[126:127]
    v_pk_add_f32 v[236:237], v[236:237], v[112:113]
    v_pk_add_f32 v[238:239], v[238:239], v[114:115]
    v_pk_add_f32 v[236:237], v[236:237], v[120:121]
    v_pk_add_f32 v[238:239], v[238:239], v[122:123]
    v_cvt_pk_bf16_f32 v250, v236, v237
    v_cvt_pk_bf16_f32 v251, v238, v239
    buffer_store_dwordx4 v[248:251], v205, s[28:31], s89 offen
    s_waitcnt lgkmcnt(4)
    v_pk_add_f32 v[128:129], v[128:129], v[132:133]
    v_pk_add_f32 v[136:137], v[136:137], v[140:141]
    v_pk_add_f32 v[130:131], v[130:131], v[134:135]
    v_pk_add_f32 v[138:139], v[138:139], v[142:143]
    v_pk_add_f32 v[240:241], v[240:241], v[128:129]
    v_pk_add_f32 v[242:243], v[242:243], v[130:131]
    v_pk_add_f32 v[240:241], v[240:241], v[136:137]
    v_pk_add_f32 v[242:243], v[242:243], v[138:139]
    v_cvt_pk_bf16_f32 v252, v240, v241
    v_cvt_pk_bf16_f32 v253, v242, v243
    s_waitcnt lgkmcnt(0)
    v_pk_add_f32 v[144:145], v[144:145], v[148:149]
    v_pk_add_f32 v[152:153], v[152:153], v[156:157]
    v_pk_add_f32 v[146:147], v[146:147], v[150:151]
    v_pk_add_f32 v[154:155], v[154:155], v[158:159]
    v_pk_add_f32 v[244:245], v[244:245], v[144:145]
    v_pk_add_f32 v[246:247], v[246:247], v[146:147]
    v_pk_add_f32 v[244:245], v[244:245], v[152:153]
    v_pk_add_f32 v[246:247], v[246:247], v[154:155]
    v_cvt_pk_bf16_f32 v254, v244, v245
    v_cvt_pk_bf16_f32 v255, v246, v247
    buffer_store_dwordx4 v[252:255], v205, s[28:31], s90 offen
    s_endpgm
L_helper:
    s_mov_b64 s[8:9], s[78:79]
    s_mov_b32 s10, 1204224
    s_mov_b32 s11, s7
    s_mov_b32 s26, 16777216
    s_mov_b32 s27, s7
    s_mov_b64 s[40:41], s[94:95]
    s_mov_b32 s42, 256
    s_mov_b32 s43, s7
    s_mov_b64 s[16:17], s[84:85]
    s_mov_b32 s18, 7340032
    s_mov_b32 s19, s7
    s_mov_b64 s[20:21], s[88:89]
    s_mov_b32 s22, 7340032
    s_mov_b32 s23, s7
    s_mov_b64 s[12:13], s[80:81]
    s_mov_b32 s14, 401408
    s_mov_b32 s15, s7
    s_mov_b64 s[28:29], s[92:93]
    s_mov_b32 s30, 1835008
    s_mov_b32 s31, s7
    s_mov_b64 s[32:33], s[86:87]
    s_mov_b32 s34, 3584
    s_mov_b32 s35, s7
    s_mov_b64 s[36:37], s[90:91]
    s_mov_b32 s38, 4096
    s_mov_b32 s39, s7
    s_lshl_b32 s52, s44, 11
    v_lshlrev_b32 v12, 4, v1
    s_sub_u32 s66, s46, 28
    s_lshl_b32 s66, s66, 2
    s_add_u32 s66, s66, s44
    s_or_b32 s53, s45, s66
    s_cmp_lg_u32 s53, 0
    s_cbranch_scc1 L_nononce
    s_memrealtime s[98:99]
    s_waitcnt lgkmcnt(0)
    s_or_b32 s98, s98, 1
    v_mov_b32 v19, s98
    s_mov_b64 exec, 1
    buffer_store_dword v19, off, s[40:43], 0 sc1
    s_mov_b64 exec, -1
L_nononce:
    v_lshlrev_b32 v17, 7, v1
    s_cmp_lg_u32 s66, 1
    s_cbranch_scc1 L_nob
    buffer_load_dword v250, v17, s[32:35], 0 offen
    buffer_load_dword v251, v17, s[36:39], 0 offen
L_nob:
    v_lshrrev_b32 v17, 2, v1
    v_mul_u32_u24 v17, 3584, v17
    v_and_b32 v19, 3, v1
    v_lshl_add_u32 v17, v19, 7, v17
    s_lshr_b32 s54, s66, 2
    s_lshl_b32 s54, s54, 5
    s_add_u32 s54, s54, s44
    s_mul_i32 s54, s54, 57344
    s_mul_i32 s56, s45, 7
    s_lshr_b32 s56, s56, 1
    s_lshl_b32 s56, s56, 7
    s_add_u32 s54, s54, s56
    buffer_load_dword v20, v17, s[16:19], s54 offen
    s_add_u32 s54, s54, 229376
    buffer_load_dword v21, v17, s[16:19], s54 offen
    s_add_u32 s54, s54, 229376
    buffer_load_dword v22, v17, s[16:19], s54 offen
    s_add_u32 s54, s54, 229376
    buffer_load_dword v23, v17, s[16:19], s54 offen
    s_add_u32 s54, s54, 229376
    buffer_load_dword v24, v17, s[16:19], s54 offen
    s_add_u32 s54, s54, 229376
    buffer_load_dword v25, v17, s[16:19], s54 offen
    s_add_u32 s54, s54, 229376
    v_lshrrev_b32 v17, 2, v1
    v_lshlrev_b32 v17, 12, v17
    v_and_b32 v19, 3, v1
    v_lshl_add_u32 v17, v19, 7, v17
    s_lshr_b32 s54, s66, 2
    s_mul_i32 s54, s54, 28
    s_add_u32 s54, s54, s44
    s_lshl_b32 s54, s54, 16
    s_lshl_b32 s56, s45, 9
    s_add_u32 s54, s54, s56
    buffer_load_dword v240, v17, s[20:23], s54 offen
    s_add_u32 s54, s54, 262144
    buffer_load_dword v241, v17, s[20:23], s54 offen
    s_add_u32 s54, s54, 262144
    buffer_load_dword v242, v17, s[20:23], s54 offen
    s_add_u32 s54, s54, 262144
    buffer_load_dword v243, v17, s[20:23], s54 offen
    s_add_u32 s54, s54, 262144
    buffer_load_dword v29, off, s[40:43], 0 sc1
    v_and_b32 v17, 15, v1
    v_lshrrev_b32 v18, 4, v1
    v_lshrrev_b32 v11, 3, v1
    v_min_u32 v11, 4, v11
    s_lshl_b32 s53, s45, 2
    s_sub_u32 s53, s53, 1
    v_add_u32 v11, s53, v11
    v_max_i32 v11, 0, v11
    v_and_b32 v13, 7, v1
    v_min_u32 v13, 6, v13
    v_lshl_add_u32 v11, v11, 3, v13
    v_lshlrev_b32 v11, 7, v11
    v_add_u32 v11, 12648448, v11
    v_lshlrev_b32 v2, 15, v18
    v_lshl_add_u32 v2, v17, 4, v2
    v_lshrrev_b32 v13, 1, v18
    v_lshlrev_b32 v3, 11, v13
    v_and_b32 v13, 1, v18
    v_lshl_add_u32 v3, v13, 9, v3
    v_lshl_add_u32 v3, v17, 4, v3
    v_add_u32 v4, s52, v12
    v_and_b32 v13, 3, v1
    v_lshlrev_b32 v5, 8, v13
    v_lshrrev_b32 v13, 2, v1
    v_lshl_add_u32 v5, v13, 4, v5
    v_add_u32 v5, s52, v5
    v_and_b32 v13, 1, v17
    v_cmp_eq_u32 s[76:77], 1, v13
    v_lshl_add_u32 v13, v18, 2, v13
    v_cmp_le_u32 s[78:79], v13, v17
    v_add_u32 v13, 2, v13
    v_cmp_le_u32 s[80:81], v13, v17
    v_mov_b32 v13, 0xffff
    v_mov_b32 v14, 0xffff0000
    v_cndmask_b32 v13, v13, v14, s[76:77]
    v_cndmask_b32 v6, v13, 0, s[78:79]
    v_cndmask_b32 v7, v13, 0, s[80:81]
    v_cndmask_b32 v8, 0, v13, s[78:79]
    v_cndmask_b32 v9, 0, v13, s[80:81]
    s_mov_b32 s95, 0x3e8b97f6
    v_mov_b32 v10, 0xf149f2ca
    s_bitcmp1_b32 s66, 0
    s_cselect_b32 s82, 0xffff, 0
    s_mov_b32 s83, 0
    s_mov_b32 s84, 0
    s_cselect_b32 s85, 0, 0xffff0000
    s_cmp_eq_u32 s45, 0
    s_cselect_b32 s56, 0, 256
    s_cselect_b64 s[86:87], -1, 0
    s_andn2_b64 s[88:89], s[86:87], s[80:81]
    s_andn2_b64 s[86:87], s[86:87], s[78:79]
    s_mul_i32 s91, s66, 7
    s_lshr_b32 s91, s91, 1
    s_lshl_b32 s91, s91, 15
    s_lshl_b32 s54, s45, 12
    s_add_u32 s91, s91, s54
    s_add_u32 s91, s91, 6291456
    s_add_u32 s92, s91, 1835008
    s_add_u32 s93, s91, 3670016
    s_lshl_b32 s94, s45, 18
    s_lshl_b32 s54, s66, 12
    s_add_u32 s94, s94, s54
    s_add_u32 s94, s94, 4194304
    s_waitcnt vmcnt(0)
    v_cmp_eq_u32 vcc, 0, v29
    s_nop 0
    s_cbranch_vccz L_ok13
    s_mov_b32 s59, 20000
L_spin12:
    buffer_load_dword v29, off, s[40:43], 0 sc1
    s_waitcnt vmcnt(0)
    v_cmp_eq_u32 vcc, 0, v29
    s_nop 0
    s_cbranch_vccz L_ok13
    s_sub_u32 s59, s59, 1
    s_cbranch_scc0 L_spin12
L_ok13:
    v_readfirstlane_b32 s47, v29
    buffer_load_dword v29, v11, s[24:27], 0 offen sc1
    s_waitcnt vmcnt(0)
    v_cmp_ne_u32 vcc, s47, v29
    s_nop 0
    s_cbranch_vccz L_ok15
    s_mov_b32 s59, 20000
L_spin14:
    buffer_load_dword v29, v11, s[24:27], 0 offen sc1
    s_waitcnt vmcnt(0)
    v_cmp_ne_u32 vcc, s47, v29
    s_nop 0
    s_cbranch_vccz L_ok15
    s_sub_u32 s59, s59, 1
    s_cbranch_scc0 L_spin14
L_ok15:
    s_sub_u32 s53, s92, s56
    s_sub_u32 s54, s93, s56
    buffer_load_dwordx4 v[192:195], v2, s[24:27], s53 offen sc1
    buffer_load_dwordx4 v[196:199], v2, s[24:27], s54 offen sc1
    buffer_load_dwordx4 v[96:99], v2, s[24:27], s91 offen offset:0 sc1
    buffer_load_dwordx4 v[100:103], v2, s[24:27], s91 offen offset:256 sc1
    buffer_load_dwordx4 v[104:107], v2, s[24:27], s92 offen offset:0 sc1
    buffer_load_dwordx4 v[108:111], v2, s[24:27], s92 offen offset:256 sc1
    buffer_load_dwordx4 v[112:115], v2, s[24:27], s93 offen offset:0 sc1
    buffer_load_dwordx4 v[116:119], v2, s[24:27], s93 offen offset:256 sc1
    buffer_load_dwordx4 v[120:123], v2, s[24:27], s91 offen offset:512 sc1
    buffer_load_dwordx4 v[124:127], v2, s[24:27], s91 offen offset:768 sc1
    buffer_load_dwordx4 v[128:131], v2, s[24:27], s92 offen offset:512 sc1
    buffer_load_dwordx4 v[132:135], v2, s[24:27], s92 offen offset:768 sc1
    buffer_load_dwordx4 v[136:139], v2, s[24:27], s93 offen offset:512 sc1
    buffer_load_dwordx4 v[140:143], v2, s[24:27], s93 offen offset:768 sc1
    s_waitcnt vmcnt(12)
    ds_write_b128 v4, v[196:199]
    ds_read_b64_tr_b16 v[52:53], v5 offset:0
    ds_read_b64_tr_b16 v[58:59], v5 offset:8
    s_mov_b32 s90, 0
    s_waitcnt vmcnt(6) lgkmcnt(0)
L_attn_loop:
    s_waitcnt vmcnt(8)
    v_mov_b32 v48, v52
    v_mov_b32 v49, v53
    v_mov_b32 v54, v58
    v_mov_b32 v55, v59
    ds_write_b128 v4, v[112:115] offset:0
    ds_write_b128 v4, v[116:119] offset:1024
    v_cndmask_b32 v96, v96, 0, s[82:83]
    v_cndmask_b32 v97, v97, 0, s[82:83]
    v_cndmask_b32 v98, v98, 0, s[84:85]
    v_cndmask_b32 v99, v99, 0, s[84:85]
    v_cndmask_b32 v100, v100, 0, s[82:83]
    v_cndmask_b32 v101, v101, 0, s[82:83]
    v_cndmask_b32 v102, v102, 0, s[84:85]
    v_cndmask_b32 v103, v103, 0, s[84:85]
    ds_read_b64_tr_b16 v[50:51], v5 offset:0
    ds_read_b64_tr_b16 v[52:53], v5 offset:1024
    ds_read_b64_tr_b16 v[56:57], v5 offset:8
    ds_read_b64_tr_b16 v[58:59], v5 offset:1032
    v_mfma_f32_16x16x32_bf16 v[32:35], v[192:195], v[96:99], 0
    v_mfma_f32_16x16x32_bf16 v[36:39], v[104:107], v[96:99], 0
    v_mfma_f32_16x16x32_bf16 v[40:43], v[104:107], v[100:103], 0
    v_mfma_f32_16x16x32_bf16 v[44:47], v[108:111], v[100:103], 0
    buffer_load_dwordx4 v[144:147], v2, s[24:27], s91 offen offset:1024 sc1
    buffer_load_dwordx4 v[148:151], v2, s[24:27], s91 offen offset:1280 sc1
    buffer_load_dwordx4 v[152:155], v2, s[24:27], s92 offen offset:1024 sc1
    buffer_load_dwordx4 v[156:159], v2, s[24:27], s92 offen offset:1280 sc1
    buffer_load_dwordx4 v[160:163], v2, s[24:27], s93 offen offset:1024 sc1
    buffer_load_dwordx4 v[164:167], v2, s[24:27], s93 offen offset:1280 sc1
    v_cndmask_b32 v200, v32, v33, s[76:77]
    v_cndmask_b32 v201, v34, v35, s[76:77]
    v_cndmask_b32 v202, v36, v37, s[76:77]
    v_cndmask_b32 v203, v38, v39, s[76:77]
    v_cndmask_b32 v200, v200, v202, s[78:79]
    v_cndmask_b32 v201, v201, v203, s[80:81]
    v_cndmask_b32 v208, v40, v41, s[76:77]
    v_cndmask_b32 v209, v42, v43, s[76:77]
    v_cndmask_b32 v210, v44, v45, s[76:77]
    v_cndmask_b32 v211, v46, v47, s[76:77]
    v_cndmask_b32 v208, v208, v210, s[78:79]
    v_cndmask_b32 v209, v209, v211, s[80:81]
    v_cndmask_b32 v200, v200, v10, s[86:87]
    v_cndmask_b32 v201, v201, v10, s[88:89]
    s_mov_b64 s[86:87], 0
    s_mov_b64 s[88:89], 0
    v_max_f32 v202, v200, v201
    v_max_f32 v210, v208, v209
    v_mov_b32 v203, v202
    v_mov_b32 v211, v210
    s_nop 0
    v_permlane16_swap_b32 v202, v203
    v_permlane16_swap_b32 v210, v211
    v_max_f32 v202, v202, v203
    v_max_f32 v210, v210, v211
    v_mov_b32 v203, v202
    v_mov_b32 v211, v210
    s_nop 0
    v_permlane32_swap_b32 v202, v203
    v_permlane32_swap_b32 v210, v211
    v_max_f32 v202, v202, v203
    v_max_f32 v210, v210, v211
    v_sub_f32 v200, v200, v202
    v_sub_f32 v201, v201, v202
    v_sub_f32 v208, v208, v210
    v_sub_f32 v209, v209, v210
    v_mul_f32 v200, s95, v200
    v_mul_f32 v201, s95, v201
    v_mul_f32 v208, s95, v208
    v_mul_f32 v209, s95, v209
    v_exp_f32 v200, v200
    v_exp_f32 v201, v201
    v_exp_f32 v208, v208
    v_exp_f32 v209, v209
    v_add_f32 v202, v200, v201
    v_add_f32 v210, v208, v209
    v_mov_b32 v203, v202
    v_mov_b32 v211, v210
    s_nop 0
    v_permlane16_swap_b32 v202, v203
    v_permlane16_swap_b32 v210, v211
    v_add_f32 v202, v202, v203
    v_add_f32 v210, v210, v211
    v_mov_b32 v203, v202
    v_mov_b32 v211, v210
    s_nop 0
    v_permlane32_swap_b32 v202, v203
    v_permlane32_swap_b32 v210, v211
    v_add_f32 v202, v202, v203
    v_add_f32 v210, v210, v211
    v_rcp_f32 v202, v202
    v_rcp_f32 v210, v210
    v_mul_f32 v200, v200, v202
    v_mul_f32 v201, v201, v202
    v_mul_f32 v208, v208, v210
    v_mul_f32 v209, v209, v210
    v_cvt_pk_bf16_f32 v200, v200, v200
    v_cvt_pk_bf16_f32 v201, v201, v201
    v_cvt_pk_bf16_f32 v208, v208, v208
    v_cvt_pk_bf16_f32 v209, v209, v209
    v_and_b32 v60, v200, v6
    v_and_b32 v61, v201, v7
    v_and_b32 v62, v200, v8
    v_and_b32 v63, v201, v9
    v_and_b32 v64, v208, v6
    v_and_b32 v65, v209, v7
    v_and_b32 v66, v208, v8
    v_and_b32 v67, v209, v9
    s_waitcnt lgkmcnt(0)
    v_mfma_f32_16x16x32_bf16 v[68:71], v[48:51], v[60:63], 0
    v_mfma_f32_16x16x32_bf16 v[72:75], v[54:57], v[60:63], 0
    v_mfma_f32_16x16x32_bf16 v[76:79], v[50:53], v[64:67], 0
    v_mfma_f32_16x16x32_bf16 v[80:83], v[56:59], v[64:67], 0
    s_nop 4
    v_cvt_pk_bf16_f32 v84, v68, v69
    v_cvt_pk_bf16_f32 v85, v70, v71
    v_cvt_pk_bf16_f32 v86, v72, v73
    v_cvt_pk_bf16_f32 v87, v74, v75
    v_cndmask_b32 v84, v84, 0, s[82:83]
    v_cndmask_b32 v85, v85, 0, s[82:83]
    v_cndmask_b32 v86, v86, 0, s[84:85]
    v_cndmask_b32 v87, v87, 0, s[84:85]
    buffer_store_dwordx4 v[84:87], v3, s[24:27], s94 offen offset:0 sc1
    v_cvt_pk_bf16_f32 v88, v76, v77
    v_cvt_pk_bf16_f32 v89, v78, v79
    v_cvt_pk_bf16_f32 v90, v80, v81
    v_cvt_pk_bf16_f32 v91, v82, v83
    v_cndmask_b32 v88, v88, 0, s[82:83]
    v_cndmask_b32 v89, v89, 0, s[82:83]
    v_cndmask_b32 v90, v90, 0, s[84:85]
    v_cndmask_b32 v91, v91, 0, s[84:85]
    buffer_store_dwordx4 v[88:91], v3, s[24:27], s94 offen offset:256 sc1
    s_waitcnt vmcnt(8)
    v_mov_b32 v48, v52
    v_mov_b32 v49, v53
    v_mov_b32 v54, v58
    v_mov_b32 v55, v59
    ds_write_b128 v4, v[136:139] offset:0
    ds_write_b128 v4, v[140:143] offset:1024
    v_cndmask_b32 v120, v120, 0, s[82:83]
    v_cndmask_b32 v121, v121, 0, s[82:83]
    v_cndmask_b32 v122, v122, 0, s[84:85]
    v_cndmask_b32 v123, v123, 0, s[84:85]
    v_cndmask_b32 v124, v124, 0, s[82:83]
    v_cndmask_b32 v125, v125, 0, s[82:83]
    v_cndmask_b32 v126, v126, 0, s[84:85]
    v_cndmask_b32 v127, v127, 0, s[84:85]
    ds_read_b64_tr_b16 v[50:51], v5 offset:0
    ds_read_b64_tr_b16 v[52:53], v5 offset:1024
    ds_read_b64_tr_b16 v[56:57], v5 offset:8
    ds_read_b64_tr_b16 v[58:59], v5 offset:1032
    v_mfma_f32_16x16x32_bf16 v[32:35], v[108:111], v[120:123], 0
    v_mfma_f32_16x16x32_bf16 v[36:39], v[128:131], v[120:123], 0
    v_mfma_f32_16x16x32_bf16 v[40:43], v[128:131], v[124:127], 0
    v_mfma_f32_16x16x32_bf16 v[44:47], v[132:135], v[124:127], 0
    buffer_load_dwordx4 v[168:171], v2, s[24:27], s91 offen offset:1536 sc1
    buffer_load_dwordx4 v[172:175], v2, s[24:27], s91 offen offset:1792 sc1
    buffer_load_dwordx4 v[176:179], v2, s[24:27], s92 offen offset:1536 sc1
    buffer_load_dwordx4 v[180:183], v2, s[24:27], s92 offen offset:1792 sc1
    buffer_load_dwordx4 v[184:187], v2, s[24:27], s93 offen offset:1536 sc1
    buffer_load_dwordx4 v[188:191], v2, s[24:27], s93 offen offset:1792 sc1
    v_cndmask_b32 v200, v32, v33, s[76:77]
    v_cndmask_b32 v201, v34, v35, s[76:77]
    v_cndmask_b32 v202, v36, v37, s[76:77]
    v_cndmask_b32 v203, v38, v39, s[76:77]
    v_cndmask_b32 v200, v200, v202, s[78:79]
    v_cndmask_b32 v201, v201, v203, s[80:81]
    v_cndmask_b32 v208, v40, v41, s[76:77]
    v_cndmask_b32 v209, v42, v43, s[76:77]
    v_cndmask_b32 v210, v44, v45, s[76:77]
    v_cndmask_b32 v211, v46, v47, s[76:77]
    v_cndmask_b32 v208, v208, v210, s[78:79]
    v_cndmask_b32 v209, v209, v211, s[80:81]
    v_max_f32 v202, v200, v201
    v_max_f32 v210, v208, v209
    v_mov_b32 v203, v202
    v_mov_b32 v211, v210
    s_nop 0
    v_permlane16_swap_b32 v202, v203
    v_permlane16_swap_b32 v210, v211
    v_max_f32 v202, v202, v203
    v_max_f32 v210, v210, v211
    v_mov_b32 v203, v202
    v_mov_b32 v211, v210
    s_nop 0
    v_permlane32_swap_b32 v202, v203
    v_permlane32_swap_b32 v210, v211
    v_max_f32 v202, v202, v203
    v_max_f32 v210, v210, v211
    v_sub_f32 v200, v200, v202
    v_sub_f32 v201, v201, v202
    v_sub_f32 v208, v208, v210
    v_sub_f32 v209, v209, v210
    v_mul_f32 v200, s95, v200
    v_mul_f32 v201, s95, v201
    v_mul_f32 v208, s95, v208
    v_mul_f32 v209, s95, v209
    v_exp_f32 v200, v200
    v_exp_f32 v201, v201
    v_exp_f32 v208, v208
    v_exp_f32 v209, v209
    v_add_f32 v202, v200, v201
    v_add_f32 v210, v208, v209
    v_mov_b32 v203, v202
    v_mov_b32 v211, v210
    s_nop 0
    v_permlane16_swap_b32 v202, v203
    v_permlane16_swap_b32 v210, v211
    v_add_f32 v202, v202, v203
    v_add_f32 v210, v210, v211
    v_mov_b32 v203, v202
    v_mov_b32 v211, v210
    s_nop 0
    v_permlane32_swap_b32 v202, v203
    v_permlane32_swap_b32 v210, v211
    v_add_f32 v202, v202, v203
    v_add_f32 v210, v210, v211
    v_rcp_f32 v202, v202
    v_rcp_f32 v210, v210
    v_mul_f32 v200, v200, v202
    v_mul_f32 v201, v201, v202
    v_mul_f32 v208, v208, v210
    v_mul_f32 v209, v209, v210
    v_cvt_pk_bf16_f32 v200, v200, v200
    v_cvt_pk_bf16_f32 v201, v201, v201
    v_cvt_pk_bf16_f32 v208, v208, v208
    v_cvt_pk_bf16_f32 v209, v209, v209
    v_and_b32 v60, v200, v6
    v_and_b32 v61, v201, v7
    v_and_b32 v62, v200, v8
    v_and_b32 v63, v201, v9
    v_and_b32 v64, v208, v6
    v_and_b32 v65, v209, v7
    v_and_b32 v66, v208, v8
    v_and_b32 v67, v209, v9
    s_waitcnt lgkmcnt(0)
    v_mfma_f32_16x16x32_bf16 v[68:71], v[48:51], v[60:63], 0
    v_mfma_f32_16x16x32_bf16 v[72:75], v[54:57], v[60:63], 0
    v_mfma_f32_16x16x32_bf16 v[76:79], v[50:53], v[64:67], 0
    v_mfma_f32_16x16x32_bf16 v[80:83], v[56:59], v[64:67], 0
    s_nop 4
    v_cvt_pk_bf16_f32 v84, v68, v69
    v_cvt_pk_bf16_f32 v85, v70, v71
    v_cvt_pk_bf16_f32 v86, v72, v73
    v_cvt_pk_bf16_f32 v87, v74, v75
    v_cndmask_b32 v84, v84, 0, s[82:83]
    v_cndmask_b32 v85, v85, 0, s[82:83]
    v_cndmask_b32 v86, v86, 0, s[84:85]
    v_cndmask_b32 v87, v87, 0, s[84:85]
    buffer_store_dwordx4 v[84:87], v3, s[24:27], s94 offen offset:1024 sc1
    v_cvt_pk_bf16_f32 v88, v76, v77
    v_cvt_pk_bf16_f32 v89, v78, v79
    v_cvt_pk_bf16_f32 v90, v80, v81
    v_cvt_pk_bf16_f32 v91, v82, v83
    v_cndmask_b32 v88, v88, 0, s[82:83]
    v_cndmask_b32 v89, v89, 0, s[82:83]
    v_cndmask_b32 v90, v90, 0, s[84:85]
    v_cndmask_b32 v91, v91, 0, s[84:85]
    buffer_store_dwordx4 v[88:91], v3, s[24:27], s94 offen offset:1280 sc1
    s_add_u32 s94, s94, 65536
    s_waitcnt vmcnt(8)
    v_mov_b32 v48, v52
    v_mov_b32 v49, v53
    v_mov_b32 v54, v58
    v_mov_b32 v55, v59
    ds_write_b128 v4, v[160:163] offset:0
    ds_write_b128 v4, v[164:167] offset:1024
    v_cndmask_b32 v144, v144, 0, s[82:83]
    v_cndmask_b32 v145, v145, 0, s[82:83]
    v_cndmask_b32 v146, v146, 0, s[84:85]
    v_cndmask_b32 v147, v147, 0, s[84:85]
    v_cndmask_b32 v148, v148, 0, s[82:83]
    v_cndmask_b32 v149, v149, 0, s[82:83]
    v_cndmask_b32 v150, v150, 0, s[84:85]
    v_cndmask_b32 v151, v151, 0, s[84:85]
    ds_read_b64_tr_b16 v[50:51], v5 offset:0
    ds_read_b64_tr_b16 v[52:53], v5 offset:1024
    ds_read_b64_tr_b16 v[56:57], v5 offset:8
    ds_read_b64_tr_b16 v[58:59], v5 offset:1032
    v_mfma_f32_16x16x32_bf16 v[32:35], v[132:135], v[144:147], 0
    v_mfma_f32_16x16x32_bf16 v[36:39], v[152:155], v[144:147], 0
    v_mfma_f32_16x16x32_bf16 v[40:43], v[152:155], v[148:151], 0
    v_mfma_f32_16x16x32_bf16 v[44:47], v[156:159], v[148:151], 0
    s_cmp_eq_u32 s90, 0
    s_cselect_b32 s53, 2048, 0
    s_add_u32 s91, s91, s53
    s_add_u32 s92, s92, s53
    s_add_u32 s93, s93, s53
    buffer_load_dwordx4 v[96:99], v2, s[24:27], s91 offen offset:0 sc1
    buffer_load_dwordx4 v[100:103], v2, s[24:27], s91 offen offset:256 sc1
    buffer_load_dwordx4 v[104:107], v2, s[24:27], s92 offen offset:0 sc1
    buffer_load_dwordx4 v[108:111], v2, s[24:27], s92 offen offset:256 sc1
    buffer_load_dwordx4 v[112:115], v2, s[24:27], s93 offen offset:0 sc1
    buffer_load_dwordx4 v[116:119], v2, s[24:27], s93 offen offset:256 sc1
    v_cndmask_b32 v200, v32, v33, s[76:77]
    v_cndmask_b32 v201, v34, v35, s[76:77]
    v_cndmask_b32 v202, v36, v37, s[76:77]
    v_cndmask_b32 v203, v38, v39, s[76:77]
    v_cndmask_b32 v200, v200, v202, s[78:79]
    v_cndmask_b32 v201, v201, v203, s[80:81]
    v_cndmask_b32 v208, v40, v41, s[76:77]
    v_cndmask_b32 v209, v42, v43, s[76:77]
    v_cndmask_b32 v210, v44, v45, s[76:77]
    v_cndmask_b32 v211, v46, v47, s[76:77]
    v_cndmask_b32 v208, v208, v210, s[78:79]
    v_cndmask_b32 v209, v209, v211, s[80:81]
    v_max_f32 v202, v200, v201
    v_max_f32 v210, v208, v209
    v_mov_b32 v203, v202
    v_mov_b32 v211, v210
    s_nop 0
    v_permlane16_swap_b32 v202, v203
    v_permlane16_swap_b32 v210, v211
    v_max_f32 v202, v202, v203
    v_max_f32 v210, v210, v211
    v_mov_b32 v203, v202
    v_mov_b32 v211, v210
    s_nop 0
    v_permlane32_swap_b32 v202, v203
    v_permlane32_swap_b32 v210, v211
    v_max_f32 v202, v202, v203
    v_max_f32 v210, v210, v211
    v_sub_f32 v200, v200, v202
    v_sub_f32 v201, v201, v202
    v_sub_f32 v208, v208, v210
    v_sub_f32 v209, v209, v210
    v_mul_f32 v200, s95, v200
    v_mul_f32 v201, s95, v201
    v_mul_f32 v208, s95, v208
    v_mul_f32 v209, s95, v209
    v_exp_f32 v200, v200
    v_exp_f32 v201, v201
    v_exp_f32 v208, v208
    v_exp_f32 v209, v209
    v_add_f32 v202, v200, v201
    v_add_f32 v210, v208, v209
    v_mov_b32 v203, v202
    v_mov_b32 v211, v210
    s_nop 0
    v_permlane16_swap_b32 v202, v203
    v_permlane16_swap_b32 v210, v211
    v_add_f32 v202, v202, v203
    v_add_f32 v210, v210, v211
    v_mov_b32 v203, v202
    v_mov_b32 v211, v210
    s_nop 0
    v_permlane32_swap_b32 v202, v203
    v_permlane32_swap_b32 v210, v211
    v_add_f32 v202, v202, v203
    v_add_f32 v210, v210, v211
    v_rcp_f32 v202, v202
    v_rcp_f32 v210, v210
    v_mul_f32 v200, v200, v202
    v_mul_f32 v201, v201, v202
    v_mul_f32 v208, v208, v210
    v_mul_f32 v209, v209, v210
    v_cvt_pk_bf16_f32 v200, v200, v200
    v_cvt_pk_bf16_f32 v201, v201, v201
    v_cvt_pk_bf16_f32 v208, v208, v208
    v_cvt_pk_bf16_f32 v209, v209, v209
    v_and_b32 v60, v200, v6
    v_and_b32 v61, v201, v7
    v_and_b32 v62, v200, v8
    v_and_b32 v63, v201, v9
    v_and_b32 v64, v208, v6
    v_and_b32 v65, v209, v7
    v_and_b32 v66, v208, v8
    v_and_b32 v67, v209, v9
    s_waitcnt lgkmcnt(0)
    v_mfma_f32_16x16x32_bf16 v[68:71], v[48:51], v[60:63], 0
    v_mfma_f32_16x16x32_bf16 v[72:75], v[54:57], v[60:63], 0
    v_mfma_f32_16x16x32_bf16 v[76:79], v[50:53], v[64:67], 0
    v_mfma_f32_16x16x32_bf16 v[80:83], v[56:59], v[64:67], 0
    s_nop 4
    v_cvt_pk_bf16_f32 v84, v68, v69
    v_cvt_pk_bf16_f32 v85, v70, v71
    v_cvt_pk_bf16_f32 v86, v72, v73
    v_cvt_pk_bf16_f32 v87, v74, v75
    v_cndmask_b32 v84, v84, 0, s[82:83]
    v_cndmask_b32 v85, v85, 0, s[82:83]
    v_cndmask_b32 v86, v86, 0, s[84:85]
    v_cndmask_b32 v87, v87, 0, s[84:85]
    buffer_store_dwordx4 v[84:87], v3, s[24:27], s94 offen offset:0 sc1
    v_cvt_pk_bf16_f32 v88, v76, v77
    v_cvt_pk_bf16_f32 v89, v78, v79
    v_cvt_pk_bf16_f32 v90, v80, v81
    v_cvt_pk_bf16_f32 v91, v82, v83
    v_cndmask_b32 v88, v88, 0, s[82:83]
    v_cndmask_b32 v89, v89, 0, s[82:83]
    v_cndmask_b32 v90, v90, 0, s[84:85]
    v_cndmask_b32 v91, v91, 0, s[84:85]
    buffer_store_dwordx4 v[88:91], v3, s[24:27], s94 offen offset:256 sc1
    s_waitcnt vmcnt(8)
    v_mov_b32 v48, v52
    v_mov_b32 v49, v53
    v_mov_b32 v54, v58
    v_mov_b32 v55, v59
    ds_write_b128 v4, v[184:187] offset:0
    ds_write_b128 v4, v[188:191] offset:1024
    v_cndmask_b32 v168, v168, 0, s[82:83]
    v_cndmask_b32 v169, v169, 0, s[82:83]
    v_cndmask_b32 v170, v170, 0, s[84:85]
    v_cndmask_b32 v171, v171, 0, s[84:85]
    v_cndmask_b32 v172, v172, 0, s[82:83]
    v_cndmask_b32 v173, v173, 0, s[82:83]
    v_cndmask_b32 v174, v174, 0, s[84:85]
    v_cndmask_b32 v175, v175, 0, s[84:85]
    ds_read_b64_tr_b16 v[50:51], v5 offset:0
    ds_read_b64_tr_b16 v[52:53], v5 offset:1024
    ds_read_b64_tr_b16 v[56:57], v5 offset:8
    ds_read_b64_tr_b16 v[58:59], v5 offset:1032
    v_mfma_f32_16x16x32_bf16 v[32:35], v[156:159], v[168:171], 0
    v_mfma_f32_16x16x32_bf16 v[36:39], v[176:179], v[168:171], 0
    v_mfma_f32_16x16x32_bf16 v[40:43], v[176:179], v[172:175], 0
    v_mfma_f32_16x16x32_bf16 v[44:47], v[180:183], v[172:175], 0
    v_mov_b32 v192, v180
    v_mov_b32 v193, v181
    v_mov_b32 v194, v182
    v_mov_b32 v195, v183
    buffer_load_dwordx4 v[120:123], v2, s[24:27], s91 offen offset:512 sc1
    buffer_load_dwordx4 v[124:127], v2, s[24:27], s91 offen offset:768 sc1
    buffer_load_dwordx4 v[128:131], v2, s[24:27], s92 offen offset:512 sc1
    buffer_load_dwordx4 v[132:135], v2, s[24:27], s92 offen offset:768 sc1
    buffer_load_dwordx4 v[136:139], v2, s[24:27], s93 offen offset:512 sc1
    buffer_load_dwordx4 v[140:143], v2, s[24:27], s93 offen offset:768 sc1
    v_cndmask_b32 v200, v32, v33, s[76:77]
    v_cndmask_b32 v201, v34, v35, s[76:77]
    v_cndmask_b32 v202, v36, v37, s[76:77]
    v_cndmask_b32 v203, v38, v39, s[76:77]
    v_cndmask_b32 v200, v200, v202, s[78:79]
    v_cndmask_b32 v201, v201, v203, s[80:81]
    v_cndmask_b32 v208, v40, v41, s[76:77]
    v_cndmask_b32 v209, v42, v43, s[76:77]
    v_cndmask_b32 v210, v44, v45, s[76:77]
    v_cndmask_b32 v211, v46, v47, s[76:77]
    v_cndmask_b32 v208, v208, v210, s[78:79]
    v_cndmask_b32 v209, v209, v211, s[80:81]
    v_max_f32 v202, v200, v201
    v_max_f32 v210, v208, v209
    v_mov_b32 v203, v202
    v_mov_b32 v211, v210
    s_nop 0
    v_permlane16_swap_b32 v202, v203
    v_permlane16_swap_b32 v210, v211
    v_max_f32 v202, v202, v203
    v_max_f32 v210, v210, v211
    v_mov_b32 v203, v202
    v_mov_b32 v211, v210
    s_nop 0
    v_permlane32_swap_b32 v202, v203
    v_permlane32_swap_b32 v210, v211
    v_max_f32 v202, v202, v203
    v_max_f32 v210, v210, v211
    v_sub_f32 v200, v200, v202
    v_sub_f32 v201, v201, v202
    v_sub_f32 v208, v208, v210
    v_sub_f32 v209, v209, v210
    v_mul_f32 v200, s95, v200
    v_mul_f32 v201, s95, v201
    v_mul_f32 v208, s95, v208
    v_mul_f32 v209, s95, v209
    v_exp_f32 v200, v200
    v_exp_f32 v201, v201
    v_exp_f32 v208, v208
    v_exp_f32 v209, v209
    v_add_f32 v202, v200, v201
    v_add_f32 v210, v208, v209
    v_mov_b32 v203, v202
    v_mov_b32 v211, v210
    s_nop 0
    v_permlane16_swap_b32 v202, v203
    v_permlane16_swap_b32 v210, v211
    v_add_f32 v202, v202, v203
    v_add_f32 v210, v210, v211
    v_mov_b32 v203, v202
    v_mov_b32 v211, v210
    s_nop 0
    v_permlane32_swap_b32 v202, v203
    v_permlane32_swap_b32 v210, v211
    v_add_f32 v202, v202, v203
    v_add_f32 v210, v210, v211
    v_rcp_f32 v202, v202
    v_rcp_f32 v210, v210
    v_mul_f32 v200, v200, v202
    v_mul_f32 v201, v201, v202
    v_mul_f32 v208, v208, v210
    v_mul_f32 v209, v209, v210
    v_cvt_pk_bf16_f32 v200, v200, v200
    v_cvt_pk_bf16_f32 v201, v201, v201
    v_cvt_pk_bf16_f32 v208, v208, v208
    v_cvt_pk_bf16_f32 v209, v209, v209
    v_and_b32 v60, v200, v6
    v_and_b32 v61, v201, v7
    v_and_b32 v62, v200, v8
    v_and_b32 v63, v201, v9
    v_and_b32 v64, v208, v6
    v_and_b32 v65, v209, v7
    v_and_b32 v66, v208, v8
    v_and_b32 v67, v209, v9
    s_waitcnt lgkmcnt(0)
    v_mfma_f32_16x16x32_bf16 v[68:71], v[48:51], v[60:63], 0
    v_mfma_f32_16x16x32_bf16 v[72:75], v[54:57], v[60:63], 0
    v_mfma_f32_16x16x32_bf16 v[76:79], v[50:53], v[64:67], 0
    v_mfma_f32_16x16x32_bf16 v[80:83], v[56:59], v[64:67], 0
    s_nop 4
    v_cvt_pk_bf16_f32 v84, v68, v69
    v_cvt_pk_bf16_f32 v85, v70, v71
    v_cvt_pk_bf16_f32 v86, v72, v73
    v_cvt_pk_bf16_f32 v87, v74, v75
    v_cndmask_b32 v84, v84, 0, s[82:83]
    v_cndmask_b32 v85, v85, 0, s[82:83]
    v_cndmask_b32 v86, v86, 0, s[84:85]
    v_cndmask_b32 v87, v87, 0, s[84:85]
    buffer_store_dwordx4 v[84:87], v3, s[24:27], s94 offen offset:1024 sc1
    v_cvt_pk_bf16_f32 v88, v76, v77
    v_cvt_pk_bf16_f32 v89, v78, v79
    v_cvt_pk_bf16_f32 v90, v80, v81
    v_cvt_pk_bf16_f32 v91, v82, v83
    v_cndmask_b32 v88, v88, 0, s[82:83]
    v_cndmask_b32 v89, v89, 0, s[82:83]
    v_cndmask_b32 v90, v90, 0, s[84:85]
    v_cndmask_b32 v91, v91, 0, s[84:85]
    buffer_store_dwordx4 v[88:91], v3, s[24:27], s94 offen offset:1280 sc1
    s_add_u32 s94, s94, 65536
    s_add_u32 s90, s90, 1
    s_cmp_lt_u32 s90, 2
    s_cbranch_scc1 L_attn_loop
    s_waitcnt vmcnt(0) lgkmcnt(0)
    s_barrier
    s_sub_u32 s54, s46, 28
    s_cmp_lg_u32 s44, 0
    s_cbranch_scc1 L_nopub16
    s_lshl_b32 s62, s45, 3
    s_add_u32 s62, s62, s54
    s_lshl_b32 s62, s62, 7
    s_add_u32 s62, s62, 12779520
    v_mov_b32 v30, s47
    s_mov_b64 exec, 1
    buffer_store_dword v30, off, s[24:27], s62 sc1
    s_mov_b64 exec, -1
L_nopub16:
L_end:
    s_endpgm
L_nop2:
    s_add_u32 s94, s93, 6291456
    buffer_store_dwordx4 v[160:163], v29, s[24:27], s94 offen sc1
    s_add_u32 s94, s93, 6356992
    buffer_store_dwordx4 v[164:167], v29, s[24:27], s94 offen sc1
    s_add_u32 s94, s93, 6553600
    buffer_store_dwordx4 v[168:171], v29, s[24:27], s94 offen sc1
    s_add_u32 s94, s93, 6619136
    buffer_store_dwordx4 v[172:175], v29, s[24:27], s94 offen sc1
    s_add_u32 s94, s93, 6815744
    buffer_store_dwordx4 v[176:179], v29, s[24:27], s94 offen sc1
    s_add_u32 s94, s93, 6881280
    buffer_store_dwordx4 v[180:183], v29, s[24:27], s94 offen sc1
    s_waitcnt vmcnt(0) lgkmcnt(0)
    s_barrier
    s_cmp_lg_u32 s44, 0
    s_cbranch_scc1 L_nopub17
    s_lshl_b32 s62, s48, 3
    s_add_u32 s62, s62, s49
    s_lshl_b32 s62, s62, 7
    s_add_u32 s62, s62, 12648448
    v_mov_b32 v30, s47
    s_mov_b64 exec, 1
    buffer_store_dword v30, off, s[24:27], s62 sc1
    s_mov_b64 exec, -1
L_nopub17:
    s_and_b32 s66, s76, 3
    s_cbranch_scc0 L_p3alt
    s_sub_u32 s66, s66, 1
    v_lshrrev_b32 v17, 2, v1
    v_lshlrev_b32 v17, 12, v17
    v_and_b32 v18, 3, v1
    v_lshl_add_u32 v17, v18, 7, v17
    s_mul_i32 s54, s44, 28
    s_add_u32 s54, s54, s66
    s_add_u32 s54, s54, 16
    s_lshl_b32 s54, s54, 16
    s_lshl_b32 s56, s45, 9
    s_add_u32 s54, s54, s56
    buffer_load_dword v96, v17, s[20:23], s54 offen
    s_add_u32 s54, s54, 196608
    buffer_load_dword v97, v17, s[20:23], s54 offen
    s_add_u32 s54, s54, 196608
    buffer_load_dword v98, v17, s[20:23], s54 offen
    s_add_u32 s54, s54, 196608
    buffer_load_dword v99, v17, s[20:23], s54 offen
    s_add_u32 s54, s54, 196608
L_p3alt:
    s_add_u32 s53, s52, 65536
    v_lshl_add_u32 v4, v210, 9, v213
    v_add_u32 v4, s53, v4
    v_add_u32 v5, 65536, v4
    s_mul_i32 s53, s44, 1835008
    s_lshl_b32 s91, s76, 7
    s_add_u32 s53, s53, s91
    v_lshlrev_b32 v8, 12, v208
    v_add3_u32 v8, v8, v209, s53
    v_add_u32 v9, 31744, v8
    s_mul_i32 s53, s44, 100352
    s_lshl_b32 s54, s77, 7
    s_add_u32 s53, s53, s54
    v_mul_u32_u24 v10, 896, v208
    v_add3_u32 v10, v10, v209, s53
    v_add_u32 v11, 6144, v10
    s_mul_i32 s89, s76, 57344
    s_add_u32 s89, s89, s54
    s_add_u32 s90, s89, 28672
    v_add_u32 v15, 1024, v12
    v_and_b32 v207, 7, v1
    v_min_u32 v207, 6, v207
    s_lshl3_add_u32 s53, s45, s44
    s_lshl_b32 s53, s53, 7
    s_add_u32 s53, s53, 12779520
    v_mov_b32 v202, s53
    s_lshl_b32 s53, s77, 5
    s_mul_i32 s54, s44, 7
    s_add_u32 s53, s53, s54
    s_lshl_b32 s53, s53, 7
    s_add_u32 s53, s53, 12713984
    v_lshl_add_u32 v204, v207, 7, s53
    s_lshl_b32 s88, s76, 16
    s_lshl_b32 s54, s44, 14
    s_add_u32 s88, s88, s54
    s_add_u32 s88, s88, 4194304
    s_mul_i32 s61, s77, 235264
    s_mul_i32 s54, s44, 58624
    s_add_u32 s61, s61, s54
    s_add_u32 s61, s61, 2097152
    v_lshrrev_b32 v218, 3, v0
    v_and_b32 v219, 7, v0
    v_mul_u32_u24 v205, 896, v218
    v_lshl_add_u32 v205, v219, 4, v205
    v_lshlrev_b32 v206, 1, v218
    v_and_b32 v230, 7, v218
    v_xor_b32 v219, v219, v230
    v_lshrrev_b32 v231, 3, v218
    v_lshlrev_b32 v228, 13, v231
    v_lshl_add_u32 v228, v230, 8, v228
    v_lshl_add_u32 v228, v219, 4, v228
    v_bfe_u32 v231, v218, 1, 1
    v_lshl_add_u32 v228, v231, 7, v228
    v_xor_b32 v229, 128, v228
    v_bfe_u32 v231, v1, 3, 2
    v_and_b32 v230, 7, v1
    v_lshlrev_b32 v220, 13, v231
    v_lshl_add_u32 v220, v230, 8, v220
    v_lshl_add_u32 v220, v230, 4, v220
    v_add_u32 v220, s52, v220
    v_bfe_u32 v231, v1, 1, 1
    v_xor_b32 v230, v210, v231
    v_lshl_add_u32 v220, v230, 7, v220
    v_xor_b32 v221, 16, v220
    v_xor_b32 v222, 32, v220
    v_xor_b32 v223, 48, v220
    v_xor_b32 v224, 64, v220
    v_xor_b32 v225, 80, v220
    v_xor_b32 v226, 96, v220
    v_xor_b32 v227, 112, v220
    buffer_load_dwordx4 v[208:211], v205, s[4:7], s89 offen
    buffer_load_dwordx4 v[212:215], v205, s[4:7], s90 offen
    buffer_load_ushort v216, v206, s[36:39], s91 offen
    buffer_load_ushort v217, v206, s[36:39], s91 offen offset:64
    s_add_u32 m0, s52, 147456
    s_mov_b32 s57, 0
    buffer_load_dwordx4 v8, s[20:23], s57 offen lds
    buffer_load_dwordx4 v9, s[20:23], s57 offen offset:1024 lds
    s_add_u32 m0, s52, 155648
    s_mov_b32 s57, 65536
    buffer_load_dwordx4 v8, s[20:23], s57 offen lds
    buffer_load_dwordx4 v9, s[20:23], s57 offen offset:1024 lds
    s_add_u32 m0, s52, 65536
    s_mov_b32 s57, 131072
    buffer_load_dwordx4 v8, s[20:23], s57 offen lds
    buffer_load_dwordx4 v9, s[20:23], s57 offen offset:1024 lds
    s_add_u32 m0, s52, 73728
    s_mov_b32 s57, 196608
    buffer_load_dwordx4 v8, s[20:23], s57 offen lds
    buffer_load_dwordx4 v9, s[20:23], s57 offen offset:1024 lds
    s_add_u32 m0, s52, 81920
    s_mov_b32 s57, 262144
    buffer_load_dwordx4 v8, s[20:23], s57 offen lds
    buffer_load_dwordx4 v9, s[20:23], s57 offen offset:1024 lds
    s_add_u32 m0, s52, 90112
    s_mov_b32 s57, 327680
    buffer_load_dwordx4 v8, s[20:23], s57 offen lds
    buffer_load_dwordx4 v9, s[20:23], s57 offen offset:1024 lds
    s_waitcnt vmcnt(10)
    ds_read_b64_tr_b16 a[0:1], v5 offset:16384
    ds_read_b64_tr_b16 a[2:3], v5 offset:17408
    ds_read_b64_tr_b16 a[4:5], v5 offset:16640
    ds_read_b64_tr_b16 a[6:7], v5 offset:17664
    s_add_u32 m0, s52, 98304
    s_mov_b32 s57, 393216
    buffer_load_dwordx4 v8, s[20:23], s57 offen lds
    buffer_load_dwordx4 v9, s[20:23], s57 offen offset:1024 lds
    s_waitcnt vmcnt(10)
    ds_read_b64_tr_b16 a[8:9], v5 offset:24576
    ds_read_b64_tr_b16 a[10:11], v5 offset:25600
    ds_read_b64_tr_b16 a[12:13], v5 offset:24832
    ds_read_b64_tr_b16 a[14:15], v5 offset:25856
    s_add_u32 m0, s52, 106496
    s_mov_b32 s57, 458752
    buffer_load_dwordx4 v8, s[20:23], s57 offen lds
    buffer_load_dwordx4 v9, s[20:23], s57 offen offset:1024 lds
    s_waitcnt vmcnt(10)
    ds_read_b64_tr_b16 a[16:17], v4 offset:0
    ds_read_b64_tr_b16 a[18:19], v4 offset:1024
    ds_read_b64_tr_b16 a[20:21], v4 offset:256
    ds_read_b64_tr_b16 a[22:23], v4 offset:1280
    s_add_u32 m0, s52, 114688
    s_mov_b32 s57, 524288
    buffer_load_dwordx4 v8, s[20:23], s57 offen lds
    buffer_load_dwordx4 v9, s[20:23], s57 offen offset:1024 lds
    s_waitcnt vmcnt(10)
    ds_read_b64_tr_b16 a[24:25], v4 offset:8192
    ds_read_b64_tr_b16 a[26:27], v4 offset:9216
    ds_read_b64_tr_b16 a[28:29], v4 offset:8448
    ds_read_b64_tr_b16 a[30:31], v4 offset:9472
    s_add_u32 m0, s52, 122880
    s_mov_b32 s57, 589824
    buffer_load_dwordx4 v8, s[20:23], s57 offen lds
    buffer_load_dwordx4 v9, s[20:23], s57 offen offset:1024 lds
    s_waitcnt vmcnt(10)
    ds_read_b64_tr_b16 a[32:33], v4 offset:16384
    ds_read_b64_tr_b16 a[34:35], v4 offset:17408
    ds_read_b64_tr_b16 a[36:37], v4 offset:16640
    ds_read_b64_tr_b16 a[38:39], v4 offset:17664
    s_add_u32 m0, s52, 131072
    s_mov_b32 s57, 655360
    buffer_load_dwordx4 v8, s[20:23], s57 offen lds
    buffer_load_dwordx4 v9, s[20:23], s57 offen offset:1024 lds
    s_waitcnt vmcnt(10)
    ds_read_b64_tr_b16 a[40:41], v4 offset:24576
    ds_read_b64_tr_b16 a[42:43], v4 offset:25600
    ds_read_b64_tr_b16 a[44:45], v4 offset:24832
    ds_read_b64_tr_b16 a[46:47], v4 offset:25856
    s_add_u32 m0, s52, 139264
    s_mov_b32 s57, 720896
    buffer_load_dwordx4 v8, s[20:23], s57 offen lds
    buffer_load_dwordx4 v9, s[20:23], s57 offen offset:1024 lds
    s_waitcnt vmcnt(10)
    ds_read_b64_tr_b16 a[48:49], v4 offset:32768
    ds_read_b64_tr_b16 a[50:51], v4 offset:33792
    ds_read_b64_tr_b16 a[52:53], v4 offset:33024
    ds_read_b64_tr_b16 a[54:55], v4 offset:34048
    s_waitcnt lgkmcnt(15)
    s_add_u32 m0, s52, 147456
    s_mov_b32 s57, 786432
    buffer_load_dwordx4 v8, s[20:23], s57 offen lds
    buffer_load_dwordx4 v9, s[20:23], s57 offen offset:1024 lds
    s_waitcnt vmcnt(10)
    ds_read_b64_tr_b16 a[56:57], v4 offset:40960
    ds_read_b64_tr_b16 a[58:59], v4 offset:41984
    ds_read_b64_tr_b16 a[60:61], v4 offset:41216
    ds_read_b64_tr_b16 a[62:63], v4 offset:42240
    s_add_u32 m0, s52, 155648
    s_mov_b32 s57, 851968
    buffer_load_dwordx4 v8, s[20:23], s57 offen lds
    buffer_load_dwordx4 v9, s[20:23], s57 offen offset:1024 lds
    s_waitcnt vmcnt(10)
    ds_read_b64_tr_b16 a[64:65], v4 offset:49152
    ds_read_b64_tr_b16 a[66:67], v4 offset:50176
    ds_read_b64_tr_b16 a[68:69], v4 offset:49408
    ds_read_b64_tr_b16 a[70:71], v4 offset:50432
    s_add_u32 m0, s52, 65536
    s_mov_b32 s57, 917504
    buffer_load_dwordx4 v8, s[20:23], s57 offen lds
    buffer_load_dwordx4 v9, s[20:23], s57 offen offset:1024 lds
    s_waitcnt vmcnt(10)
    ds_read_b64_tr_b16 a[72:73], v4 offset:57344
    ds_read_b64_tr_b16 a[74:75], v4 offset:58368
    ds_read_b64_tr_b16 a[76:77], v4 offset:57600
    ds_read_b64_tr_b16 a[78:79], v4 offset:58624
    s_waitcnt lgkmcnt(15)
    s_add_u32 m0, s52, 73728
    s_mov_b32 s57, 983040
    buffer_load_dwordx4 v8, s[20:23], s57 offen lds
    buffer_load_dwordx4 v9, s[20:23], s57 offen offset:1024 lds
    s_waitcnt vmcnt(10)
    ds_read_b64_tr_b16 a[80:81], v5 offset:0
    ds_read_b64_tr_b16 a[82:83], v5 offset:1024
    ds_read_b64_tr_b16 a[84:85], v5 offset:256
    ds_read_b64_tr_b16 a[86:87], v5 offset:1280
    s_add_u32 m0, s52, 81920
    s_mov_b32 s57, 1048576
    buffer_load_dwordx4 v8, s[20:23], s57 offen lds
    s_waitcnt vmcnt(0) lgkmcnt(0)
    s_branch L_p3join
L_codeend:
.section .rodata,"a"
.p2align 6
.amdhsa_kernel parallel_sum__sliding_local_dilated__mixer_token_mlp__prompt_kernel
  .amdhsa_next_free_vgpr 512
  .amdhsa_next_free_sgpr 102
  .amdhsa_accum_offset 256
  .amdhsa_group_segment_fixed_size 0
  .amdhsa_kernarg_size 88
  .amdhsa_user_sgpr_count 2
  .amdhsa_user_sgpr_kernarg_segment_ptr 1
  .amdhsa_system_sgpr_workgroup_id_x 1
  .amdhsa_float_denorm_mode_32 3
.end_amdhsa_kernel
```

```asm
; @launch grid=(256,1,1) block=(256,1,1) lds=163840
.amdgcn_target "amdgcn-amd-amdhsa--gfx950"
.text
.globl parallel_sum__sliding_local_dilated__mixer_token_mlp__prompt_kernel
.p2align 8
.type parallel_sum__sliding_local_dilated__mixer_token_mlp__prompt_kernel,@function
parallel_sum__sliding_local_dilated__mixer_token_mlp__prompt_kernel:
    s_cmp_ge_u32 s2, 256
    s_cbranch_scc1 L_end
    s_load_dwordx2 s[4:5], s[0:1], 0
    s_load_dwordx16 s[76:91], s[0:1], 0
    s_load_dwordx4 s[92:95], s[0:1], 64
    s_load_dwordx2 s[24:25], s[0:1], 80
    s_lshr_b32 s46, s2, 3
    s_getpc_b64 s[98:99]
L_pc:
    s_lshl_b32 s53, s46, 10
    v_lshrrev_b32 v25, 5, v0
    v_lshl_add_u32 v26, v25, 7, s53
    v_min_u32 v26, L_codeend-L_pc-4, v26
    v_mov_b32 v29, s99
    v_add_co_u32 v28, vcc, s98, v26
    s_nop 1
    v_addc_co_u32 v29, vcc, 0, v29, vcc
    global_load_dword v108, v[28:29], off
    v_and_b32 v26, 31, v0
    v_mul_u32_u24 v24, 896, v25
    v_lshl_add_u32 v24, v26, 4, v24
    s_mul_i32 s53, s2, 7168
    v_add_u32 v24, s53, v24
    v_cmp_gt_u32 vcc, 28, v26
    v_mov_b32 v27, 2130706432
    s_mov_b32 s6, 1835008
    s_mov_b32 s7, 0x20000
    v_cndmask_b32 v24, v27, v24, vcc
    v_lshrrev_b32 v27, 6, v0
    v_and_b32 v1, 63, v0
    s_waitcnt lgkmcnt(0)
    buffer_load_dwordx4 v[32:35], v24, s[4:7], 0 offen
    buffer_load_dwordx4 v[36:39], v24, s[4:7], 0 offen offset:448
    v_readfirstlane_b32 s44, v27
    s_and_b32 s45, s2, 7
    s_mov_b64 s[8:9], s[78:79]
    s_mov_b32 s10, 1204224
    s_mov_b32 s11, s7
    s_lshr_b32 s53, s45, 1
    s_add_u32 s54, s53, 1
    s_bfe_u32 s54, s54, 0x10001
    s_add_u32 s54, s54, 1
    s_mul_i32 s53, s53, 224
    s_andn2_b32 s53, s53, 127
    s_mul_i32 s55, s46, 43008
    s_add_u32 s53, s53, s55
    v_and_b32 v27, 3, v0
    v_min_u32 v27, s54, v27
    v_bfe_u32 v28, v0, 2, 2
    v_min_u32 v28, 2, v28
    v_mul_u32_u24 v28, 7, v28
    v_add_u32 v27, v27, v28
    v_lshrrev_b32 v28, 4, v0
    v_mul_u32_u24 v28, 21, v28
    v_add_lshl_u32 v27, v27, v28, 7
    buffer_load_dword v108, v27, s[8:11], s53 offen
    s_mov_b64 s[40:41], s[94:95]
    s_mov_b32 s42, 256
    s_mov_b32 s43, s7
    s_or_b32 s53, s2, s44
    s_cbranch_scc1 L_nononce
    s_memrealtime s[98:99]
    s_waitcnt lgkmcnt(0)
    s_or_b32 s98, s98, 1
    v_mov_b32 v28, s98
    s_mov_b64 exec, 1
    buffer_store_dword v28, off, s[40:43], 0 sc1
    s_mov_b64 exec, -1
L_nononce:
    s_mov_b64 s[16:17], s[84:85]
    s_mov_b32 s18, 7340032
    s_mov_b32 s19, s7
    s_mov_b32 s26, 16777216
    s_mov_b32 s27, s7
    s_mov_b64 s[20:21], s[88:89]
    s_mov_b32 s22, 7340032
    s_mov_b32 s23, s7
    s_mov_b64 s[12:13], s[80:81]
    s_mov_b32 s14, 401408
    s_mov_b32 s15, s7
    v_lshrrev_b32 v27, 4, v0
    v_min_u32 v27, 12, v27
    v_lshlrev_b32 v27, 7, v27
    s_mul_i32 s53, s2, 1664
    buffer_load_dword v108, v27, s[12:15], s53 offen
    s_mov_b64 s[28:29], s[92:93]
    s_mov_b32 s30, 1835008
    s_mov_b32 s31, s7
    s_mov_b64 s[32:33], s[86:87]
    s_mov_b32 s34, 3584
    s_mov_b32 s35, s7
    s_mov_b64 s[36:37], s[90:91]
    s_mov_b32 s38, 4096
    s_mov_b32 s39, s7
    s_lshl_b32 s52, s44, 12
    v_lshlrev_b32 v23, 4, v1
    s_cmp_ge_u32 s46, 24
    s_cbranch_scc1 L_role_a
    v_lshrrev_b32 v208, 4, v1
    v_bfe_u32 v209, v1, 2, 2
    v_and_b32 v210, 3, v1
    v_and_b32 v211, 15, v1
    v_lshrrev_b32 v212, 5, v1
    s_and_b32 s54, s45, 1
    s_mul_i32 s54, s54, 24
    s_cmp_ge_u32 s46, 21
    s_cselect_b32 s54, s54, 0
    s_mul_i32 s53, s45, 21
    s_add_u32 s53, s53, s46
    s_sub_u32 s53, s53, s54
    s_mul_i32 s50, s53, 171
    s_lshr_b32 s50, s50, 10
    s_mul_i32 s54, s50, 6
    s_sub_u32 s51, s53, s54
    s_lshl3_add_u32 s65, s51, 1
    s_mul_i32 s65, s65, 43
    s_lshr_b32 s65, s65, 7
    v_lshl_add_u32 v213, v212, 2, v209
    v_and_b32 v215, 1, v208
    v_lshlrev_b32 v214, 4, v210
    v_lshl_add_u32 v214, v215, 6, v214
    s_mul_i32 s53, s44, 1835008
    s_lshl_b32 s54, s50, 7
    s_add_u32 s53, s53, s54
    v_mul_u32_u24 v10, 3584, v213
    v_add3_u32 v10, v10, v214, s53
    v_xor_b32 v11, 32, v10
    s_add_u32 m0, s52, 49152
    s_add_u32 s57, s65, 0
    s_and_b32 s57, s57, 15
    s_mul_i32 s57, s57, 114688
    buffer_load_dwordx4 v10, s[16:19], s57 offen offset:0 lds
    s_add_u32 s57, s57, 27648
    buffer_load_dwordx4 v11, s[16:19], s57 offen offset:1024 lds
    v_mul_u32_u24 v109, 960, v25
    v_lshl_add_u32 v109, v26, 4, v109
    v_mul_u32_u24 v110, 960, v209
    v_lshl_add_u32 v110, v208, 5, v110
    v_lshl_add_u32 v110, v210, 3, v110
    s_lshl_b32 s53, s44, 7
    v_add_u32 v110, s53, v110
    v_mul_u32_u24 v111, 66816, v208
    v_lshl_add_u32 v111, v211, 4, v111
    s_mul_i32 s63, s44, 267264
    s_lshl_b32 s53, s2, 8
    s_add_u32 s63, s63, s53
    s_add_u32 s64, s63, 1069056
    s_cmp_eq_u32 s44, 3
    s_cselect_b32 s64, 2130706432, s64
    s_mov_b32 s62, 0x3f803f80
    s_mov_b32 s61, 0xffff0000
    s_mov_b32 s66, 6291456
    v_mov_b32 v96, 0
    v_mov_b32 v97, 0
    v_lshlrev_b32 v216, 6, v209
    v_lshl_add_u32 v216, v210, 3, v216
    v_lshl_add_u32 v216, v215, 5, v216
    s_add_u32 s53, s52, 49152
    v_lshl_add_u32 v2, v208, 10, v216
    v_add_u32 v2, s53, v2
    v_xor_b32 v3, 32, v2
    v_add_u32 v4, 65536, v2
    v_add_u32 v5, 65536, v3
    v_lshl_add_u32 v6, v208, 9, v216
    v_add_u32 v6, s53, v6
    v_xor_b32 v7, 32, v6
    v_add_u32 v8, 65536, v6
    v_add_u32 v9, 65536, v7
    s_waitcnt vmcnt(5)
    v_dot2c_f32_bf16 v96, s62, v32
    v_dot2c_f32_bf16 v97, v32, v32
    v_lshlrev_b32 v40, 16, v32
    v_and_b32 v41, s61, v32
    v_dot2c_f32_bf16 v96, s62, v33
    v_dot2c_f32_bf16 v97, v33, v33
    v_lshlrev_b32 v42, 16, v33
    v_and_b32 v43, s61, v33
    v_dot2c_f32_bf16 v96, s62, v34
    v_dot2c_f32_bf16 v97, v34, v34
    v_lshlrev_b32 v44, 16, v34
    v_and_b32 v45, s61, v34
    v_dot2c_f32_bf16 v96, s62, v35
    v_dot2c_f32_bf16 v97, v35, v35
    v_lshlrev_b32 v46, 16, v35
    v_and_b32 v47, s61, v35
    s_waitcnt vmcnt(4)
    v_dot2c_f32_bf16 v96, s62, v36
    v_dot2c_f32_bf16 v97, v36, v36
    v_lshlrev_b32 v48, 16, v36
    v_and_b32 v49, s61, v36
    v_dot2c_f32_bf16 v96, s62, v37
    v_dot2c_f32_bf16 v97, v37, v37
    v_lshlrev_b32 v50, 16, v37
    v_and_b32 v51, s61, v37
    v_dot2c_f32_bf16 v96, s62, v38
    v_dot2c_f32_bf16 v97, v38, v38
    v_lshlrev_b32 v52, 16, v38
    v_and_b32 v53, s61, v38
    v_dot2c_f32_bf16 v96, s62, v39
    v_dot2c_f32_bf16 v97, v39, v39
    v_lshlrev_b32 v54, 16, v39
    v_and_b32 v55, s61, v39
    buffer_load_dword v29, off, s[40:43], 0 sc1
    v_add_f32_dpp v96, v96, v96 quad_perm:[1,0,3,2] row_mask:0xf bank_mask:0xf
    v_add_f32_dpp v97, v97, v97 quad_perm:[1,0,3,2] row_mask:0xf bank_mask:0xf
    s_nop 0
    v_add_f32_dpp v96, v96, v96 quad_perm:[2,3,0,1] row_mask:0xf bank_mask:0xf
    v_add_f32_dpp v97, v97, v97 quad_perm:[2,3,0,1] row_mask:0xf bank_mask:0xf
    s_nop 0
    v_add_f32_dpp v96, v96, v96 row_half_mirror row_mask:0xf bank_mask:0xf
    v_add_f32_dpp v97, v97, v97 row_half_mirror row_mask:0xf bank_mask:0xf
    s_nop 0
    v_add_f32_dpp v96, v96, v96 row_mirror row_mask:0xf bank_mask:0xf
    v_add_f32_dpp v97, v97, v97 row_mirror row_mask:0xf bank_mask:0xf
    v_mov_b32 v98, v96
    v_mov_b32 v99, v97
    s_nop 0
    v_permlane16_swap_b32 v96, v98
    v_permlane16_swap_b32 v97, v99
    v_add_f32 v96, v96, v98
    v_add_f32 v97, v97, v99
    v_mul_f32 v98, 0x3b124925, v96
    v_mul_f32 v99, 0x3b124925, v97
    v_fma_f32 v99, -v98, v98, v99
    v_max_f32 v99, 0, v99
    v_cvt_pk_bf16_f32 v100, 0, v99
    v_add_f32 v100, 0x3727c5ac, v100
    v_cvt_pk_bf16_f32 v100, 0, v100
    v_sqrt_f32 v100, v100
    s_nop 0
    v_cvt_pk_bf16_f32 v100, 0, v100
    v_rcp_f32 v100, v100
    s_nop 0
    v_mul_f32 v99, v99, v100
    v_mul_f32 v102, v98, v100
    v_mul_f32 v99, v99, v100
    v_cvt_pk_bf16_f32 v104, 0, v99
    v_add_f32 v104, 0x3727c5ac, v104
    v_cvt_pk_bf16_f32 v104, 0, v104
    v_sqrt_f32 v104, v104
    s_nop 0
    v_cvt_pk_bf16_f32 v104, 0, v104
    v_rcp_f32 v104, v104
    s_nop 0
    v_mul_f32 v104, v104, v100
    v_mul_f32 v106, v98, v104
    v_pk_fma_f32 v[56:57], v[40:41], v[104:105], v[106:107] op_sel_hi:[1,0,0] neg_lo:[0,0,1] neg_hi:[0,0,1]
    v_pk_fma_f32 v[58:59], v[42:43], v[104:105], v[106:107] op_sel_hi:[1,0,0] neg_lo:[0,0,1] neg_hi:[0,0,1]
    v_pk_fma_f32 v[60:61], v[44:45], v[104:105], v[106:107] op_sel_hi:[1,0,0] neg_lo:[0,0,1] neg_hi:[0,0,1]
    v_pk_fma_f32 v[62:63], v[46:47], v[104:105], v[106:107] op_sel_hi:[1,0,0] neg_lo:[0,0,1] neg_hi:[0,0,1]
    v_pk_fma_f32 v[64:65], v[48:49], v[104:105], v[106:107] op_sel_hi:[1,0,0] neg_lo:[0,0,1] neg_hi:[0,0,1]
    v_pk_fma_f32 v[66:67], v[50:51], v[104:105], v[106:107] op_sel_hi:[1,0,0] neg_lo:[0,0,1] neg_hi:[0,0,1]
    v_pk_fma_f32 v[68:69], v[52:53], v[104:105], v[106:107] op_sel_hi:[1,0,0] neg_lo:[0,0,1] neg_hi:[0,0,1]
    v_pk_fma_f32 v[70:71], v[54:55], v[104:105], v[106:107] op_sel_hi:[1,0,0] neg_lo:[0,0,1] neg_hi:[0,0,1]
    v_cvt_pk_bf16_f32 v80, v56, v57
    v_cvt_pk_bf16_f32 v81, v58, v59
    v_cvt_pk_bf16_f32 v82, v60, v61
    v_cvt_pk_bf16_f32 v83, v62, v63
    v_cvt_pk_bf16_f32 v84, v64, v65
    v_cvt_pk_bf16_f32 v85, v66, v67
    v_cvt_pk_bf16_f32 v86, v68, v69
    v_cvt_pk_bf16_f32 v87, v70, v71
    ds_write_b128 v109, v[80:83] offset:0
    ds_write_b128 v109, v[84:87] offset:448
    v_pk_fma_f32 v[40:41], v[40:41], v[100:101], v[102:103] op_sel_hi:[1,0,0] neg_lo:[0,0,1] neg_hi:[0,0,1]
    v_pk_fma_f32 v[42:43], v[42:43], v[100:101], v[102:103] op_sel_hi:[1,0,0] neg_lo:[0,0,1] neg_hi:[0,0,1]
    v_pk_fma_f32 v[44:45], v[44:45], v[100:101], v[102:103] op_sel_hi:[1,0,0] neg_lo:[0,0,1] neg_hi:[0,0,1]
    v_pk_fma_f32 v[46:47], v[46:47], v[100:101], v[102:103] op_sel_hi:[1,0,0] neg_lo:[0,0,1] neg_hi:[0,0,1]
    v_pk_fma_f32 v[48:49], v[48:49], v[100:101], v[102:103] op_sel_hi:[1,0,0] neg_lo:[0,0,1] neg_hi:[0,0,1]
    v_pk_fma_f32 v[50:51], v[50:51], v[100:101], v[102:103] op_sel_hi:[1,0,0] neg_lo:[0,0,1] neg_hi:[0,0,1]
    v_pk_fma_f32 v[52:53], v[52:53], v[100:101], v[102:103] op_sel_hi:[1,0,0] neg_lo:[0,0,1] neg_hi:[0,0,1]
    v_pk_fma_f32 v[54:55], v[54:55], v[100:101], v[102:103] op_sel_hi:[1,0,0] neg_lo:[0,0,1] neg_hi:[0,0,1]
    v_cvt_pk_bf16_f32 v72, v40, v41
    v_cvt_pk_bf16_f32 v73, v42, v43
    v_cvt_pk_bf16_f32 v74, v44, v45
    v_cvt_pk_bf16_f32 v75, v46, v47
    v_cvt_pk_bf16_f32 v76, v48, v49
    v_cvt_pk_bf16_f32 v77, v50, v51
    v_cvt_pk_bf16_f32 v78, v52, v53
    v_cvt_pk_bf16_f32 v79, v54, v55
    s_waitcnt lgkmcnt(0)
    s_barrier
    ds_read_b64_tr_b16 v[88:89], v110 offset:0
    ds_read_b64_tr_b16 v[90:91], v110 offset:3840
    ds_read_b64_tr_b16 v[92:93], v110 offset:512
    ds_read_b64_tr_b16 v[94:95], v110 offset:4352
    buffer_store_dwordx4 v[72:75], v24, s[24:27], s66 offen offset:0 sc1
    buffer_store_dwordx4 v[76:79], v24, s[24:27], s66 offen offset:448 sc1
    s_waitcnt lgkmcnt(2)
    buffer_store_dwordx4 v[88:91], v111, s[24:27], s63 offen sc1
    s_waitcnt lgkmcnt(0)
    buffer_store_dwordx4 v[92:95], v111, s[24:27], s64 offen sc1
    s_add_u32 s57, s57, 27648
    buffer_load_dwordx4 v10, s[16:19], s57 offen offset:2048 lds
    s_add_u32 s57, s57, 27648
    buffer_load_dwordx4 v11, s[16:19], s57 offen offset:3072 lds
    s_add_u32 m0, s52, 65536
    s_add_u32 s57, s65, 1
    s_and_b32 s57, s57, 15
    s_mul_i32 s57, s57, 114688
    buffer_load_dwordx4 v10, s[16:19], s57 offen offset:0 lds
    s_add_u32 s57, s57, 27648
    buffer_load_dwordx4 v11, s[16:19], s57 offen offset:1024 lds
    s_add_u32 s57, s57, 27648
    buffer_load_dwordx4 v10, s[16:19], s57 offen offset:2048 lds
    s_add_u32 s57, s57, 27648
    buffer_load_dwordx4 v11, s[16:19], s57 offen offset:3072 lds
    s_add_u32 m0, s52, 81920
    s_add_u32 s57, s65, 2
    s_and_b32 s57, s57, 15
    s_mul_i32 s57, s57, 114688
    buffer_load_dwordx4 v10, s[16:19], s57 offen offset:0 lds
    s_add_u32 s57, s57, 27648
    buffer_load_dwordx4 v11, s[16:19], s57 offen offset:1024 lds
    s_add_u32 s57, s57, 27648
    buffer_load_dwordx4 v10, s[16:19], s57 offen offset:2048 lds
    s_add_u32 s57, s57, 27648
    buffer_load_dwordx4 v11, s[16:19], s57 offen offset:3072 lds
    s_waitcnt vmcnt(10)
    v_cmp_eq_u32 vcc, 0, v29
    s_nop 0
    s_cbranch_vccz L_ok2
    s_mov_b32 s59, 20000
L_spin1:
    buffer_load_dword v29, off, s[40:43], 0 sc1
    s_waitcnt vmcnt(0)
    v_cmp_eq_u32 vcc, 0, v29
    s_nop 0
    s_cbranch_vccz L_ok2
    s_sub_u32 s59, s59, 1
    s_cbranch_scc0 L_spin1
L_ok2:
    v_readfirstlane_b32 s47, v29
    s_barrier
    s_cmp_lg_u32 s44, 0
    s_cbranch_scc1 L_nopub3
    s_lshl_b32 s60, s2, 5
    s_add_u32 s60, s60, 12582912
    v_mov_b32 v30, s47
    s_mov_b64 exec, 1
    buffer_store_dword v30, off, s[24:27], s60 sc1
    s_mov_b64 exec, -1
L_nopub3:
    s_cmp_ge_u32 s46, 21
    s_cbranch_scc1 L_help
    s_lshl_b32 s53, s44, 11
    s_add_u32 s53, s53, 12582912
    v_lshl_add_u32 v18, v1, 5, s53
    s_lshl_b32 s53, s50, 7
    v_lshl_add_u32 v19, v208, 3, s53
    s_lshl2_add_u32 s67, s51, s44
    s_mul_i32 s67, s67, 58624
    s_lshl_b32 s53, s50, 11
    s_add_u32 s67, s67, s53
    s_add_u32 s67, s67, 2097152
    v_add_u32 v232, s52, v23
    v_xor_b32 v233, 4096, v232
    s_add_u32 m0, s52, 98304
    s_add_u32 s57, s65, 3
    s_and_b32 s57, s57, 15
    s_mul_i32 s57, s57, 114688
    buffer_load_dwordx4 v10, s[16:19], s57 offen offset:0 lds
    v_xor_b32 v234, 8192, v232
    v_xor_b32 v235, 12288, v232
    v_mov_b32 v236, 0xbdd2d3e8
    v_mov_b32 v237, 0xc0135761
    s_add_u32 s54, s51, 24
    s_mul_i32 s84, s54, 66816
    s_lshl2_add_u32 s84, s52, s84
    s_mul_i32 s83, s54, 58624
    s_add_u32 s83, s83, s53
    s_and_b32 s54, s44, 1
    s_lshl_b32 s54, s54, 10
    s_add_u32 s83, s83, s54
    s_add_u32 s83, s83, 2097152
    s_lshl1_add_u32 s54, s54, 49152
    v_add_u32 v243, s54, v23
    s_cmp_lt_u32 s51, 4
    s_cselect_b32 s84, s84, 2130706432
    s_cselect_b32 s83, s83, 2130706432
    s_cmp_lt_u32 s44, 2
    s_cselect_b32 s83, s83, 2130706432
    s_cmp_eq_u32 s44, 0
    s_cselect_b32 s85, 1.0, 0
    s_mul_i32 s53, s45, 7
    s_lshr_b32 s53, s53, 1
    s_sub_u32 s53, s50, s53
    s_lshl1_add_u32 s53, s53, s51
    s_sub_u32 s53, s53, 4
    s_mul_i32 s54, s44, 28
    s_add_u32 s54, s54, s53
    s_lshl_b32 s87, s54, 16
    s_lshl_b32 s54, s45, 9
    s_add_u32 s87, s87, s54
    s_cmp_ge_u32 s51, 4
    s_cselect_b32 s87, s87, 2130706432
    v_lshrrev_b32 v254, 2, v1
    v_lshlrev_b32 v254, 12, v254
    v_lshl_add_u32 v254, v210, 7, v254
    s_add_u32 s57, s57, 27648
    buffer_load_dwordx4 v11, s[16:19], s57 offen offset:1024 lds
    s_waitcnt vmcnt(10)
    ds_read_b64_tr_b16 a[0:1], v2 offset:0
    ds_read_b64_tr_b16 a[2:3], v2 offset:512
    ds_read_b64_tr_b16 a[4:5], v3 offset:0
    ds_read_b64_tr_b16 a[6:7], v3 offset:512
    s_mul_i32 s53, s46, 43
    s_lshr_b32 s53, s53, 8
    s_mul_i32 s54, s53, 6
    s_sub_u32 s49, s46, s54
    ds_read_b64_tr_b16 a[8:9], v2 offset:256
    ds_read_b64_tr_b16 a[10:11], v2 offset:768
    ds_read_b64_tr_b16 a[12:13], v3 offset:256
    ds_read_b64_tr_b16 a[14:15], v3 offset:768
    s_add_u32 s57, s57, 27648
    buffer_load_dwordx4 v10, s[16:19], s57 offen offset:2048 lds
    s_lshl2_add_u32 s48, s45, s53
    s_mul_i32 s53, s44, 1835008
    s_lshl_b32 s74, s48, 7
    s_add_u32 s53, s53, s74
    v_lshlrev_b32 v217, 5, v212
    v_xor_b32 v217, v217, v214
    v_lshlrev_b32 v12, 12, v213
    v_add3_u32 v12, v12, v217, s53
    s_mul_i32 s53, s44, 100352
    s_lshl_b32 s54, s49, 7
    s_add_u32 s55, s53, s54
    s_lshl_b32 s56, s44, 5
    s_add_u32 s57, s57, 27648
    buffer_load_dwordx4 v11, s[16:19], s57 offen offset:3072 lds
    v_xor_b32 v217, s56, v214
    v_mul_u32_u24 v13, 896, v213
    v_add3_u32 v13, v13, v217, s55
    v_xor_b32 v14, 32, v13
    s_mul_i32 s73, s48, 57344
    s_add_u32 s71, s73, s54
    s_add_u32 s72, s71, 28672
    v_lshrrev_b32 v217, 1, v1
    v_mul_u32_u24 v15, 896, v217
    v_and_b32 v217, 1, v1
    v_lshl_add_u32 v15, v217, 4, v15
    v_add_u32 v15, s53, v15
    s_lshl_b32 s54, s49, 5
    s_add_u32 s54, s54, 768
    s_add_u32 s68, s49, 24
    s_mul_i32 s68, s68, 58624
    s_add_u32 m0, s52, 114688
    s_add_u32 s57, s65, 4
    s_and_b32 s57, s57, 15
    s_mul_i32 s57, s57, 114688
    buffer_load_dwordx4 v10, s[16:19], s57 offen offset:0 lds
    s_mul_i32 s69, s44, 14336
    s_add_u32 s69, s69, 2097152
    s_add_u32 s68, s68, s69
    s_add_u32 s73, s73, s54
    s_mov_b32 s76, 0
    s_add_u32 s77, s76, 2048
    s_cmp_eq_u32 s77, 14336
    s_cselect_b32 s77, 0, s77
    s_add_u32 s78, s77, 2048
    s_cmp_eq_u32 s78, 14336
    s_cselect_b32 s78, 0, s78
    s_add_u32 s79, s78, 2048
    s_cmp_eq_u32 s79, 14336
    s_cselect_b32 s79, 0, s79
    s_add_u32 s80, s79, 2048
    s_cmp_eq_u32 s80, 14336
    s_cselect_b32 s80, 0, s80
    s_add_u32 s81, s80, 2048
    s_cmp_eq_u32 s81, 14336
    s_cselect_b32 s81, 0, s81
    s_add_u32 s82, s81, 2048
    s_cmp_eq_u32 s82, 14336
    s_cselect_b32 s82, 0, s82
    s_add_u32 s57, s57, 27648
    buffer_load_dwordx4 v11, s[16:19], s57 offen offset:1024 lds
    s_waitcnt vmcnt(10)
    ds_read_b64_tr_b16 a[16:17], v2 offset:16384
    ds_read_b64_tr_b16 a[18:19], v2 offset:16896
    ds_read_b64_tr_b16 a[20:21], v3 offset:16384
    ds_read_b64_tr_b16 a[22:23], v3 offset:16896
    s_cmp_lt_u32 s49, 4
    s_cselect_b32 s75, s54, 2130706432
    s_cselect_b32 s68, s68, 2130706432
    s_cselect_b32 s73, s73, 2130706432
    ds_read_b64_tr_b16 a[24:25], v2 offset:16640
    ds_read_b64_tr_b16 a[26:27], v2 offset:17152
    ds_read_b64_tr_b16 a[28:29], v3 offset:16640
    ds_read_b64_tr_b16 a[30:31], v3 offset:17152
    s_add_u32 s57, s57, 27648
    buffer_load_dwordx4 v10, s[16:19], s57 offen offset:2048 lds
    v_lshl_add_u32 v217, v208, 3, v209
    v_lshlrev_b32 v16, 5, v217
    v_lshl_add_u32 v16, v210, 3, v16
    v_add_u32 v16, s52, v16
    v_and_b32 v217, 7, v1
    v_min_u32 v218, 6, v217
    s_lshl_b32 s53, s49, 5
    s_mul_i32 s54, s44, 7
    s_add_u32 s53, s53, s54
    s_lshl_b32 s53, s53, 7
    s_add_u32 s53, s53, 12713984
    v_lshl_add_u32 v20, v218, 7, s53
    s_lshr_b32 s53, s48, 1
    s_lshl4_add_u32 s53, s44, s53
    s_lshl_b32 s53, s53, 7
    s_add_u32 s53, s53, 12779520
    s_add_u32 s57, s57, 27648
    buffer_load_dwordx4 v11, s[16:19], s57 offen offset:3072 lds
    v_mov_b32 v21, s53
    s_lshl_b32 s70, s48, 16
    s_add_u32 s70, s70, s52
    s_add_u32 s70, s70, 4194304
    v_lshrrev_b32 v218, 3, v0
    v_mul_u32_u24 v22, 896, v218
    v_lshl_add_u32 v22, v217, 4, v22
    v_lshlrev_b32 v25, 1, v218
    v_lshrrev_b32 v219, 4, v218
    v_lshlrev_b32 v244, 14, v219
    v_lshrrev_b32 v219, 1, v217
    v_lshl_add_u32 v244, v219, 12, v244
    v_and_b32 v219, 15, v218
    v_lshl_add_u32 v244, v219, 8, v244
    v_bfe_u32 v219, v218, 1, 1
    v_lshl_add_u32 v244, v219, 7, v244
    buffer_load_dwordx2 v[224:225], v19, s[32:35], 0 offen offset:0
    v_and_b32 v219, 7, v218
    v_xor_b32 v219, v219, v217
    v_lshl_add_u32 v244, v219, 4, v244
    v_xor_b32 v245, 128, v244
    buffer_load_dwordx2 v[226:227], v19, s[32:35], 0 offen offset:32
    s_waitcnt vmcnt(10)
    ds_read_b64_tr_b16 a[32:33], v2 offset:32768
    ds_read_b64_tr_b16 a[34:35], v2 offset:33280
    ds_read_b64_tr_b16 a[36:37], v3 offset:32768
    ds_read_b64_tr_b16 a[38:39], v3 offset:33280
    buffer_load_dwordx2 v[228:229], v19, s[32:35], 0 offen offset:64
    ds_read_b64_tr_b16 a[40:41], v2 offset:33024
    ds_read_b64_tr_b16 a[42:43], v2 offset:33536
    ds_read_b64_tr_b16 a[44:45], v3 offset:33024
    ds_read_b64_tr_b16 a[46:47], v3 offset:33536
    buffer_load_dwordx2 v[230:231], v19, s[32:35], 0 offen offset:96
    v_xor_b32 v246, 4096, v244
    v_xor_b32 v247, 4224, v244
    v_xor_b32 v248, 8192, v244
    v_xor_b32 v249, 8320, v244
    s_add_u32 m0, s52, 131072
    s_add_u32 s57, s65, 5
    s_and_b32 s57, s57, 15
    s_mul_i32 s57, s57, 114688
    buffer_load_dwordx4 v10, s[16:19], s57 offen offset:0 lds
    v_xor_b32 v250, 12288, v244
    v_xor_b32 v251, 12416, v244
    v_lshrrev_b32 v218, 2, v0
    v_mul_u32_u24 v26, 896, v218
    v_lshl_add_u32 v26, v210, 3, v26
    v_lshlrev_b32 v27, 1, v218
    v_bfe_u32 v219, v218, 1, 2
    v_xor_b32 v219, v219, v210
    v_lshlrev_b32 v252, 6, v218
    v_lshl_add_u32 v252, v219, 4, v252
    v_add_u32 v252, 65536, v252
    v_bfe_u32 v219, v1, 1, 2
    v_xor_b32 v219, v219, v208
    v_lshlrev_b32 v242, 6, v211
    v_lshl_add_u32 v242, v219, 4, v242
    s_add_u32 s53, s52, 65536
    s_add_u32 s57, s57, 27648
    buffer_load_dwordx4 v11, s[16:19], s57 offen offset:1024 lds
    s_waitcnt vmcnt(10)
    ds_read_b64_tr_b16 a[48:49], v2 offset:49152
    ds_read_b64_tr_b16 a[50:51], v2 offset:49664
    ds_read_b64_tr_b16 a[52:53], v3 offset:49152
    ds_read_b64_tr_b16 a[54:55], v3 offset:49664
    v_add_u32 v242, s53, v242
    v_xor_b32 v218, v217, v212
    v_lshlrev_b32 v238, 4, v218
    v_xor_b32 v238, s56, v238
    ds_read_b64_tr_b16 a[56:57], v2 offset:49408
    ds_read_b64_tr_b16 a[58:59], v2 offset:49920
    ds_read_b64_tr_b16 a[60:61], v3 offset:49408
    ds_read_b64_tr_b16 a[62:63], v3 offset:49920
    v_bfe_u32 v219, v1, 1, 1
    v_xor_b32 v219, v219, v215
    v_lshl_add_u32 v238, v219, 7, v238
    v_lshl_add_u32 v238, v211, 8, v238
    s_add_u32 s57, s57, 27648
    buffer_load_dwordx4 v10, s[16:19], s57 offen offset:2048 lds
    v_add_u32 v238, s52, v238
    v_xor_b32 v239, 32, v238
    v_xor_b32 v240, 64, v238
    v_xor_b32 v241, 96, v238
    s_add_u32 s57, s57, 27648
    buffer_load_dwordx4 v11, s[16:19], s57 offen offset:3072 lds
    s_add_u32 m0, s52, 147456
    s_add_u32 s57, s65, 6
    s_and_b32 s57, s57, 15
    s_mul_i32 s57, s57, 114688
    buffer_load_dwordx4 v10, s[16:19], s57 offen offset:0 lds
    s_add_u32 s57, s57, 27648
    buffer_load_dwordx4 v11, s[16:19], s57 offen offset:1024 lds
    s_waitcnt vmcnt(10)
    ds_read_b64_tr_b16 a[64:65], v4 offset:0
    ds_read_b64_tr_b16 a[66:67], v4 offset:512
    ds_read_b64_tr_b16 a[68:69], v5 offset:0
    ds_read_b64_tr_b16 a[70:71], v5 offset:512
    s_add_u32 s57, s57, 27648
    buffer_load_dwordx4 v10, s[16:19], s57 offen offset:2048 lds
    ds_read_b64_tr_b16 a[72:73], v4 offset:256
    ds_read_b64_tr_b16 a[74:75], v4 offset:768
    ds_read_b64_tr_b16 a[76:77], v5 offset:256
    ds_read_b64_tr_b16 a[78:79], v5 offset:768
    s_add_u32 s57, s57, 27648
    buffer_load_dwordx4 v11, s[16:19], s57 offen offset:3072 lds
    s_waitcnt lgkmcnt(15)
    s_add_u32 m0, s52, 49152
    s_add_u32 s57, s65, 7
    s_and_b32 s57, s57, 15
    s_mul_i32 s57, s57, 114688
    buffer_load_dwordx4 v10, s[16:19], s57 offen offset:0 lds
    s_add_u32 s57, s57, 27648
    buffer_load_dwordx4 v11, s[16:19], s57 offen offset:1024 lds
    s_waitcnt vmcnt(10)
    v_lshlrev_b32 v32, 16, v224
    v_and_b32 v33, s61, v224
    v_lshlrev_b32 v34, 16, v225
    v_and_b32 v35, s61, v225
    v_lshlrev_b32 v36, 16, v226
    v_and_b32 v37, s61, v226
    v_lshlrev_b32 v38, 16, v227
    v_and_b32 v39, s61, v227
    v_lshlrev_b32 v40, 16, v228
    v_and_b32 v41, s61, v228
    v_lshlrev_b32 v42, 16, v229
    v_and_b32 v43, s61, v229
    v_lshlrev_b32 v44, 16, v230
    v_and_b32 v45, s61, v230
    v_lshlrev_b32 v46, 16, v231
    v_and_b32 v47, s61, v231
    s_add_u32 s57, s57, 27648
    buffer_load_dwordx4 v10, s[16:19], s57 offen offset:2048 lds
    v_mul_f32 v96, s85, v32
    v_mul_f32 v97, s85, v33
    v_mul_f32 v98, s85, v34
    v_mul_f32 v99, s85, v35
    v_mul_f32 v100, s85, v36
    v_mul_f32 v101, s85, v37
    v_mul_f32 v102, s85, v38
    v_mul_f32 v103, s85, v39
    v_mul_f32 v104, s85, v40
    v_mul_f32 v105, s85, v41
    v_mul_f32 v106, s85, v42
    v_mul_f32 v107, s85, v43
    v_mul_f32 v108, s85, v44
    v_mul_f32 v109, s85, v45
    v_mul_f32 v110, s85, v46
    v_mul_f32 v111, s85, v47
    s_add_u32 s57, s57, 27648
    buffer_load_dwordx4 v11, s[16:19], s57 offen offset:3072 lds
    s_add_u32 m0, s52, 65536
    s_add_u32 s57, s65, 8
    s_and_b32 s57, s57, 15
    s_mul_i32 s57, s57, 114688
    buffer_load_dwordx4 v10, s[16:19], s57 offen offset:0 lds
    s_add_u32 s57, s57, 27648
    buffer_load_dwordx4 v11, s[16:19], s57 offen offset:1024 lds
    s_waitcnt vmcnt(10)
    ds_read_b64_tr_b16 a[80:81], v4 offset:16384
    ds_read_b64_tr_b16 a[82:83], v4 offset:16896
    ds_read_b64_tr_b16 a[84:85], v5 offset:16384
    ds_read_b64_tr_b16 a[86:87], v5 offset:16896
    s_add_u32 s57, s57, 27648
    buffer_load_dwordx4 v10, s[16:19], s57 offen offset:2048 lds
    ds_read_b64_tr_b16 a[88:89], v4 offset:16640
    ds_read_b64_tr_b16 a[90:91], v4 offset:17152
    ds_read_b64_tr_b16 a[92:93], v5 offset:16640
    ds_read_b64_tr_b16 a[94:95], v5 offset:17152
    s_add_u32 s57, s57, 27648
    buffer_load_dwordx4 v11, s[16:19], s57 offen offset:3072 lds
    s_add_u32 m0, s52, 81920
    s_add_u32 s57, s65, 9
    s_and_b32 s57, s57, 15
    s_mul_i32 s57, s57, 114688
    buffer_load_dwordx4 v10, s[16:19], s57 offen offset:0 lds
    s_add_u32 s57, s57, 27648
    buffer_load_dwordx4 v11, s[16:19], s57 offen offset:1024 lds
    s_waitcnt vmcnt(10)
    ds_read_b64_tr_b16 a[96:97], v4 offset:32768
    ds_read_b64_tr_b16 a[98:99], v4 offset:33280
    ds_read_b64_tr_b16 a[100:101], v5 offset:32768
    ds_read_b64_tr_b16 a[102:103], v5 offset:33280
    s_add_u32 s57, s57, 27648
    buffer_load_dwordx4 v10, s[16:19], s57 offen offset:2048 lds
    ds_read_b64_tr_b16 a[104:105], v4 offset:33024
    ds_read_b64_tr_b16 a[106:107], v4 offset:33536
    ds_read_b64_tr_b16 a[108:109], v5 offset:33024
    ds_read_b64_tr_b16 a[110:111], v5 offset:33536
    s_add_u32 s57, s57, 27648
    buffer_load_dwordx4 v11, s[16:19], s57 offen offset:3072 lds
    s_waitcnt lgkmcnt(15)
    s_add_u32 m0, s52, 98304
    s_add_u32 s57, s65, 10
    s_and_b32 s57, s57, 15
    s_mul_i32 s57, s57, 114688
    buffer_load_dwordx4 v10, s[16:19], s57 offen offset:0 lds
    s_add_u32 s57, s57, 27648
    buffer_load_dwordx4 v11, s[16:19], s57 offen offset:1024 lds
    s_waitcnt vmcnt(10)
    ds_read_b64_tr_b16 a[112:113], v2 offset:0
    ds_read_b64_tr_b16 a[114:115], v2 offset:512
    ds_read_b64_tr_b16 a[116:117], v3 offset:0
    ds_read_b64_tr_b16 a[118:119], v3 offset:512
    s_add_u32 s57, s57, 27648
    buffer_load_dwordx4 v10, s[16:19], s57 offen offset:2048 lds
    ds_read_b64_tr_b16 a[120:121], v2 offset:256
    ds_read_b64_tr_b16 a[122:123], v2 offset:768
    ds_read_b64_tr_b16 a[124:125], v3 offset:256
    ds_read_b64_tr_b16 a[126:127], v3 offset:768
    s_add_u32 s57, s57, 27648
    buffer_load_dwordx4 v11, s[16:19], s57 offen offset:3072 lds
    s_add_u32 m0, s52, 114688
    s_add_u32 s57, s65, 11
    s_and_b32 s57, s57, 15
    s_mul_i32 s57, s57, 114688
    buffer_load_dwordx4 v10, s[16:19], s57 offen offset:0 lds
    s_add_u32 s57, s57, 27648
    buffer_load_dwordx4 v11, s[16:19], s57 offen offset:1024 lds
    s_waitcnt vmcnt(10)
    ds_read_b64_tr_b16 a[128:129], v2 offset:16384
    ds_read_b64_tr_b16 a[130:131], v2 offset:16896
    ds_read_b64_tr_b16 a[132:133], v3 offset:16384
    ds_read_b64_tr_b16 a[134:135], v3 offset:16896
    s_add_u32 s57, s57, 27648
    buffer_load_dwordx4 v10, s[16:19], s57 offen offset:2048 lds
    ds_read_b64_tr_b16 a[136:137], v2 offset:16640
    ds_read_b64_tr_b16 a[138:139], v2 offset:17152
    ds_read_b64_tr_b16 a[140:141], v3 offset:16640
    ds_read_b64_tr_b16 a[142:143], v3 offset:17152
    s_add_u32 s57, s57, 27648
    buffer_load_dwordx4 v11, s[16:19], s57 offen offset:3072 lds
    s_waitcnt lgkmcnt(15)
    s_add_u32 m0, s52, 131072
    s_add_u32 s57, s65, 12
    s_and_b32 s57, s57, 15
    s_mul_i32 s57, s57, 114688
    buffer_load_dwordx4 v10, s[16:19], s57 offen offset:0 lds
    s_add_u32 s57, s57, 27648
    buffer_load_dwordx4 v11, s[16:19], s57 offen offset:1024 lds
    s_waitcnt vmcnt(10)
    ds_read_b64_tr_b16 a[144:145], v2 offset:32768
    ds_read_b64_tr_b16 a[146:147], v2 offset:33280
    ds_read_b64_tr_b16 a[148:149], v3 offset:32768
    ds_read_b64_tr_b16 a[150:151], v3 offset:33280
    s_add_u32 s57, s57, 27648
    buffer_load_dwordx4 v10, s[16:19], s57 offen offset:2048 lds
    ds_read_b64_tr_b16 a[152:153], v2 offset:33024
    ds_read_b64_tr_b16 a[154:155], v2 offset:33536
    ds_read_b64_tr_b16 a[156:157], v3 offset:33024
    ds_read_b64_tr_b16 a[158:159], v3 offset:33536
    s_add_u32 s57, s57, 27648
    buffer_load_dwordx4 v11, s[16:19], s57 offen offset:3072 lds
    buffer_load_dword v17, v18, s[24:27], 0 offen sc1
    s_add_u32 m0, s52, 147456
    s_add_u32 s57, s65, 13
    s_and_b32 s57, s57, 15
    s_mul_i32 s57, s57, 114688
    buffer_load_dwordx4 v10, s[16:19], s57 offen offset:0 lds
    s_waitcnt vmcnt(10)
    ds_read_b64_tr_b16 a[160:161], v2 offset:49152
    ds_read_b64_tr_b16 a[162:163], v2 offset:49664
    ds_read_b64_tr_b16 a[164:165], v3 offset:49152
    ds_read_b64_tr_b16 a[166:167], v3 offset:49664
    s_add_u32 s57, s57, 27648
    buffer_load_dwordx4 v11, s[16:19], s57 offen offset:1024 lds
    ds_read_b64_tr_b16 a[168:169], v2 offset:49408
    ds_read_b64_tr_b16 a[170:171], v2 offset:49920
    ds_read_b64_tr_b16 a[172:173], v3 offset:49408
    ds_read_b64_tr_b16 a[174:175], v3 offset:49920
    s_add_u32 s57, s57, 27648
    buffer_load_dwordx4 v10, s[16:19], s57 offen offset:2048 lds
    s_add_u32 s57, s57, 27648
    buffer_load_dwordx4 v11, s[16:19], s57 offen offset:3072 lds
    s_waitcnt lgkmcnt(15)
    s_add_u32 m0, s52, 49152
    s_add_u32 s57, s65, 14
    s_and_b32 s57, s57, 15
    s_mul_i32 s57, s57, 114688
    buffer_load_dwordx4 v10, s[16:19], s57 offen offset:0 lds
    s_waitcnt vmcnt(10)
    ds_read_b64_tr_b16 a[176:177], v4 offset:0
    ds_read_b64_tr_b16 a[178:179], v4 offset:512
    ds_read_b64_tr_b16 a[180:181], v5 offset:0
    ds_read_b64_tr_b16 a[182:183], v5 offset:512
    s_add_u32 s57, s57, 27648
    buffer_load_dwordx4 v11, s[16:19], s57 offen offset:1024 lds
    ds_read_b64_tr_b16 a[184:185], v4 offset:256
    ds_read_b64_tr_b16 a[186:187], v4 offset:768
    ds_read_b64_tr_b16 a[188:189], v5 offset:256
    ds_read_b64_tr_b16 a[190:191], v5 offset:768
    s_add_u32 s57, s57, 27648
    buffer_load_dwordx4 v10, s[16:19], s57 offen offset:2048 lds
    s_add_u32 s57, s57, 27648
    buffer_load_dwordx4 v11, s[16:19], s57 offen offset:3072 lds
    s_add_u32 m0, s52, 65536
    s_add_u32 s57, s65, 15
    s_and_b32 s57, s57, 15
    s_mul_i32 s57, s57, 114688
    buffer_load_dwordx4 v10, s[16:19], s57 offen offset:0 lds
    s_waitcnt vmcnt(10)
    ds_read_b64_tr_b16 a[192:193], v4 offset:16384
    ds_read_b64_tr_b16 a[194:195], v4 offset:16896
    ds_read_b64_tr_b16 a[196:197], v5 offset:16384
    ds_read_b64_tr_b16 a[198:199], v5 offset:16896
    s_add_u32 s57, s57, 27648
    buffer_load_dwordx4 v11, s[16:19], s57 offen offset:1024 lds
    ds_read_b64_tr_b16 a[200:201], v4 offset:16640
    ds_read_b64_tr_b16 a[202:203], v4 offset:17152
    ds_read_b64_tr_b16 a[204:205], v5 offset:16640
    ds_read_b64_tr_b16 a[206:207], v5 offset:17152
    s_waitcnt vmcnt(10)
    v_cmp_ne_u32 vcc, s47, v17
    s_nop 0
    s_cbranch_vccz L_ok5
    s_mov_b32 s59, 20000
L_spin4:
    buffer_load_dword v17, v18, s[24:27], 0 offen sc1
    s_waitcnt vmcnt(0)
    v_cmp_ne_u32 vcc, s47, v17
    s_nop 0
    s_cbranch_vccz L_ok5
    s_sub_u32 s59, s59, 1
    s_cbranch_scc0 L_spin4
L_ok5:
    s_add_u32 s57, s57, 27648
    buffer_load_dwordx4 v10, s[16:19], s57 offen offset:2048 lds
    s_add_u32 s57, s57, 27648
    buffer_load_dwordx4 v11, s[16:19], s57 offen offset:3072 lds
    buffer_load_dword v253, v254, s[20:23], s87 offen
    s_mov_b32 s66, s84
    s_lshl_b32 s86, s65, 10
    s_add_u32 s58, s86, s66
    buffer_load_dwordx4 v[112:115], v23, s[24:27], s58 offen offset:0 sc1
    s_waitcnt vmcnt(10)
    ds_read_b64_tr_b16 a[208:209], v4 offset:32768
    ds_read_b64_tr_b16 a[210:211], v4 offset:33280
    ds_read_b64_tr_b16 a[212:213], v5 offset:32768
    ds_read_b64_tr_b16 a[214:215], v5 offset:33280
    s_add_u32 s86, s86, 1024
    s_and_b32 s86, s86, 16383
    s_add_u32 s58, s86, s66
    buffer_load_dwordx4 v[116:119], v23, s[24:27], s58 offen offset:0 sc1
    ds_read_b64_tr_b16 a[216:217], v4 offset:33024
    ds_read_b64_tr_b16 a[218:219], v4 offset:33536
    ds_read_b64_tr_b16 a[220:221], v5 offset:33024
    ds_read_b64_tr_b16 a[222:223], v5 offset:33536
    s_add_u32 s86, s86, 1024
    s_and_b32 s86, s86, 16383
    s_add_u32 s58, s86, s66
    buffer_load_dwordx4 v[120:123], v23, s[24:27], s58 offen offset:0 sc1
    s_add_u32 s86, s86, 1024
    s_and_b32 s86, s86, 16383
    s_add_u32 s58, s86, s66
    buffer_load_dwordx4 v[124:127], v23, s[24:27], s58 offen offset:0 sc1
    s_add_u32 s86, s86, 1024
    s_and_b32 s86, s86, 16383
    s_add_u32 s58, s86, s66
    buffer_load_dwordx4 v[128:131], v23, s[24:27], s58 offen offset:0 sc1
    s_waitcnt vmcnt(10)
    ds_read_b64_tr_b16 a[224:225], v2 offset:0
    ds_read_b64_tr_b16 a[226:227], v2 offset:512
    ds_read_b64_tr_b16 a[228:229], v3 offset:0
    ds_read_b64_tr_b16 a[230:231], v3 offset:512
    s_add_u32 s86, s86, 1024
    s_and_b32 s86, s86, 16383
    s_add_u32 s58, s86, s66
    buffer_load_dwordx4 v[132:135], v23, s[24:27], s58 offen offset:0 sc1
    ds_read_b64_tr_b16 a[232:233], v2 offset:256
    ds_read_b64_tr_b16 a[234:235], v2 offset:768
    ds_read_b64_tr_b16 a[236:237], v3 offset:256
    ds_read_b64_tr_b16 a[238:239], v3 offset:768
    s_add_u32 s86, s86, 1024
    s_and_b32 s86, s86, 16383
    s_add_u32 s58, s86, s66
    buffer_load_dwordx4 v[136:139], v23, s[24:27], s58 offen offset:0 sc1
    s_add_u32 s86, s86, 1024
    s_and_b32 s86, s86, 16383
    s_add_u32 s58, s86, s66
    buffer_load_dwordx4 v[140:143], v23, s[24:27], s58 offen offset:0 sc1
    s_add_u32 s86, s86, 1024
    s_and_b32 s86, s86, 16383
    s_add_u32 s58, s86, s66
    buffer_load_dwordx4 v[144:147], v23, s[24:27], s58 offen offset:0 sc1
    s_waitcnt vmcnt(10)
    ds_read_b64_tr_b16 a[240:241], v2 offset:16384
    ds_read_b64_tr_b16 a[242:243], v2 offset:16896
    ds_read_b64_tr_b16 a[244:245], v3 offset:16384
    ds_read_b64_tr_b16 a[246:247], v3 offset:16896
    s_add_u32 s86, s86, 1024
    s_and_b32 s86, s86, 16383
    s_add_u32 s58, s86, s66
    buffer_load_dwordx4 v[148:151], v23, s[24:27], s58 offen offset:0 sc1
    ds_read_b64_tr_b16 a[248:249], v2 offset:16640
    ds_read_b64_tr_b16 a[250:251], v2 offset:17152
    ds_read_b64_tr_b16 a[252:253], v3 offset:16640
    ds_read_b64_tr_b16 a[254:255], v3 offset:17152
    s_waitcnt vmcnt(9)
    v_mfma_f32_16x16x32_bf16 v[96:99], a[0:3], v[112:115], v[96:99]
    s_add_u32 s86, s86, 1024
    s_and_b32 s86, s86, 16383
    v_mfma_f32_16x16x32_bf16 v[100:103], a[4:7], v[112:115], v[100:103]
    s_add_u32 s58, s86, s66
    buffer_load_dwordx4 v[152:155], v23, s[24:27], s58 offen offset:0 sc1
    v_mfma_f32_16x16x32_bf16 v[104:107], a[8:11], v[112:115], v[104:107]
    v_mfma_f32_16x16x32_bf16 v[108:111], a[12:15], v[112:115], v[108:111]
    s_waitcnt vmcnt(9)
    v_mfma_f32_16x16x32_bf16 v[96:99], a[16:19], v[116:119], v[96:99]
    s_add_u32 s86, s86, 1024
    s_and_b32 s86, s86, 16383
    v_mfma_f32_16x16x32_bf16 v[100:103], a[20:23], v[116:119], v[100:103]
    s_add_u32 s58, s86, s66
    buffer_load_dwordx4 v[156:159], v23, s[24:27], s58 offen offset:0 sc1
    v_mfma_f32_16x16x32_bf16 v[104:107], a[24:27], v[116:119], v[104:107]
    v_mfma_f32_16x16x32_bf16 v[108:111], a[28:31], v[116:119], v[108:111]
    s_waitcnt vmcnt(9)
    v_mfma_f32_16x16x32_bf16 v[96:99], a[32:35], v[120:123], v[96:99]
    s_add_u32 s86, s86, 1024
    s_and_b32 s86, s86, 16383
    v_mfma_f32_16x16x32_bf16 v[100:103], a[36:39], v[120:123], v[100:103]
    s_add_u32 s58, s86, s66
    buffer_load_dwordx4 v[112:115], v23, s[24:27], s58 offen offset:0 sc1
    v_mfma_f32_16x16x32_bf16 v[104:107], a[40:43], v[120:123], v[104:107]
    v_mfma_f32_16x16x32_bf16 v[108:111], a[44:47], v[120:123], v[108:111]
    s_waitcnt vmcnt(9)
    v_mfma_f32_16x16x32_bf16 v[96:99], a[48:51], v[124:127], v[96:99]
    s_add_u32 s86, s86, 1024
    s_and_b32 s86, s86, 16383
    v_mfma_f32_16x16x32_bf16 v[100:103], a[52:55], v[124:127], v[100:103]
    s_add_u32 s58, s86, s66
    buffer_load_dwordx4 v[116:119], v23, s[24:27], s58 offen offset:0 sc1
    v_mfma_f32_16x16x32_bf16 v[104:107], a[56:59], v[124:127], v[104:107]
    v_mfma_f32_16x16x32_bf16 v[108:111], a[60:63], v[124:127], v[108:111]
    s_waitcnt vmcnt(9)
    v_mfma_f32_16x16x32_bf16 v[96:99], a[64:67], v[128:131], v[96:99]
    s_add_u32 s86, s86, 1024
    s_and_b32 s86, s86, 16383
    v_mfma_f32_16x16x32_bf16 v[100:103], a[68:71], v[128:131], v[100:103]
    s_add_u32 s58, s86, s66
    buffer_load_dwordx4 v[120:123], v23, s[24:27], s58 offen offset:0 sc1
    v_mfma_f32_16x16x32_bf16 v[104:107], a[72:75], v[128:131], v[104:107]
    v_mfma_f32_16x16x32_bf16 v[108:111], a[76:79], v[128:131], v[108:111]
    s_waitcnt vmcnt(9)
    v_mfma_f32_16x16x32_bf16 v[96:99], a[80:83], v[132:135], v[96:99]
    s_add_u32 s86, s86, 1024
    s_and_b32 s86, s86, 16383
    v_mfma_f32_16x16x32_bf16 v[100:103], a[84:87], v[132:135], v[100:103]
    s_add_u32 s58, s86, s66
    buffer_load_dwordx4 v[124:127], v23, s[24:27], s58 offen offset:0 sc1
    v_mfma_f32_16x16x32_bf16 v[104:107], a[88:91], v[132:135], v[104:107]
    v_mfma_f32_16x16x32_bf16 v[108:111], a[92:95], v[132:135], v[108:111]
    s_waitcnt vmcnt(9)
    v_mfma_f32_16x16x32_bf16 v[96:99], a[96:99], v[136:139], v[96:99]
    s_xor_b32 s66, s44, 3
    s_lshl2_add_u32 s66, s51, s66
    s_mul_i32 s66, s66, 66816
    v_mfma_f32_16x16x32_bf16 v[100:103], a[100:103], v[136:139], v[100:103]
    s_lshl2_add_u32 s66, s52, s66
    s_lshl_b32 s86, s65, 10
    s_add_u32 s58, s86, s66
    v_mfma_f32_16x16x32_bf16 v[104:107], a[104:107], v[136:139], v[104:107]
    buffer_load_dwordx4 v[128:131], v23, s[24:27], s58 offen offset:0 sc1
    v_mfma_f32_16x16x32_bf16 v[108:111], a[108:111], v[136:139], v[108:111]
    s_waitcnt vmcnt(9)
    v_mfma_f32_16x16x32_bf16 v[96:99], a[112:115], v[140:143], v[96:99]
    s_add_u32 s86, s86, 1024
    s_and_b32 s86, s86, 16383
    v_mfma_f32_16x16x32_bf16 v[100:103], a[116:119], v[140:143], v[100:103]
    s_add_u32 s58, s86, s66
    buffer_load_dwordx4 v[132:135], v23, s[24:27], s58 offen offset:0 sc1
    v_mfma_f32_16x16x32_bf16 v[104:107], a[120:123], v[140:143], v[104:107]
    v_mfma_f32_16x16x32_bf16 v[108:111], a[124:127], v[140:143], v[108:111]
    s_waitcnt vmcnt(9)
    v_mfma_f32_16x16x32_bf16 v[96:99], a[128:131], v[144:147], v[96:99]
    s_add_u32 s86, s86, 1024
    s_and_b32 s86, s86, 16383
    v_mfma_f32_16x16x32_bf16 v[100:103], a[132:135], v[144:147], v[100:103]
    s_add_u32 s58, s86, s66
    buffer_load_dwordx4 v[136:139], v23, s[24:27], s58 offen offset:0 sc1
    v_mfma_f32_16x16x32_bf16 v[104:107], a[136:139], v[144:147], v[104:107]
    v_mfma_f32_16x16x32_bf16 v[108:111], a[140:143], v[144:147], v[108:111]
    s_waitcnt vmcnt(9)
    s_waitcnt lgkmcnt(15)
    v_mfma_f32_16x16x32_bf16 v[96:99], a[144:147], v[148:151], v[96:99]
    s_add_u32 s86, s86, 1024
    s_and_b32 s86, s86, 16383
    v_mfma_f32_16x16x32_bf16 v[100:103], a[148:151], v[148:151], v[100:103]
    s_add_u32 s58, s86, s66
    buffer_load_dwordx4 v[140:143], v23, s[24:27], s58 offen offset:0 sc1
    v_mfma_f32_16x16x32_bf16 v[104:107], a[152:155], v[148:151], v[104:107]
    v_mfma_f32_16x16x32_bf16 v[108:111], a[156:159], v[148:151], v[108:111]
    s_waitcnt vmcnt(9)
    v_mfma_f32_16x16x32_bf16 v[96:99], a[160:163], v[152:155], v[96:99]
    s_add_u32 s86, s86, 1024
    s_and_b32 s86, s86, 16383
    v_mfma_f32_16x16x32_bf16 v[100:103], a[164:167], v[152:155], v[100:103]
    s_add_u32 s58, s86, s66
    buffer_load_dwordx4 v[144:147], v23, s[24:27], s58 offen offset:0 sc1
    v_mfma_f32_16x16x32_bf16 v[104:107], a[168:171], v[152:155], v[104:107]
    v_mfma_f32_16x16x32_bf16 v[108:111], a[172:175], v[152:155], v[108:111]
    s_waitcnt vmcnt(9)
    v_mfma_f32_16x16x32_bf16 v[96:99], a[176:179], v[156:159], v[96:99]
    s_add_u32 s86, s86, 1024
    s_and_b32 s86, s86, 16383
    v_mfma_f32_16x16x32_bf16 v[100:103], a[180:183], v[156:159], v[100:103]
    s_add_u32 s58, s86, s66
    buffer_load_dwordx4 v[148:151], v23, s[24:27], s58 offen offset:0 sc1
    v_mfma_f32_16x16x32_bf16 v[104:107], a[184:187], v[156:159], v[104:107]
    v_mfma_f32_16x16x32_bf16 v[108:111], a[188:191], v[156:159], v[108:111]
    s_waitcnt vmcnt(9)
    v_mfma_f32_16x16x32_bf16 v[96:99], a[192:195], v[112:115], v[96:99]
    s_add_u32 s86, s86, 1024
    s_and_b32 s86, s86, 16383
    v_mfma_f32_16x16x32_bf16 v[100:103], a[196:199], v[112:115], v[100:103]
    s_add_u32 s58, s86, s66
    buffer_load_dwordx4 v[152:155], v23, s[24:27], s58 offen offset:0 sc1
    v_mfma_f32_16x16x32_bf16 v[104:107], a[200:203], v[112:115], v[104:107]
    v_mfma_f32_16x16x32_bf16 v[108:111], a[204:207], v[112:115], v[108:111]
    s_waitcnt vmcnt(9)
    v_mfma_f32_16x16x32_bf16 v[96:99], a[208:211], v[116:119], v[96:99]
    s_add_u32 s86, s86, 1024
    s_and_b32 s86, s86, 16383
    v_mfma_f32_16x16x32_bf16 v[100:103], a[212:215], v[116:119], v[100:103]
    s_add_u32 s58, s86, s66
    buffer_load_dwordx4 v[156:159], v23, s[24:27], s58 offen offset:0 sc1
    v_mfma_f32_16x16x32_bf16 v[104:107], a[216:219], v[116:119], v[104:107]
    v_mfma_f32_16x16x32_bf16 v[108:111], a[220:223], v[116:119], v[108:111]
    s_waitcnt vmcnt(9)
    s_waitcnt lgkmcnt(8)
    v_mfma_f32_16x16x32_bf16 v[96:99], a[224:227], v[120:123], v[96:99]
    s_add_u32 s86, s86, 1024
    s_and_b32 s86, s86, 16383
    v_mfma_f32_16x16x32_bf16 v[100:103], a[228:231], v[120:123], v[100:103]
    s_add_u32 s58, s86, s66
    buffer_load_dwordx4 v[112:115], v23, s[24:27], s58 offen offset:0 sc1
    v_mfma_f32_16x16x32_bf16 v[104:107], a[232:235], v[120:123], v[104:107]
    v_mfma_f32_16x16x32_bf16 v[108:111], a[236:239], v[120:123], v[108:111]
    s_waitcnt vmcnt(9)
    s_waitcnt lgkmcnt(0)
    v_mfma_f32_16x16x32_bf16 v[96:99], a[240:243], v[124:127], v[96:99]
    s_add_u32 s86, s86, 1024
    s_and_b32 s86, s86, 16383
    v_mfma_f32_16x16x32_bf16 v[100:103], a[244:247], v[124:127], v[100:103]
    s_add_u32 s58, s86, s66
    buffer_load_dwordx4 v[116:119], v23, s[24:27], s58 offen offset:0 sc1
    v_mfma_f32_16x16x32_bf16 v[104:107], a[248:251], v[124:127], v[104:107]
    v_mfma_f32_16x16x32_bf16 v[108:111], a[252:255], v[124:127], v[108:111]
    s_waitcnt vmcnt(9)
    v_mfma_f32_16x16x32_bf16 v[80:83], a[0:3], v[128:131], 0
    s_add_u32 s86, s86, 1024
    s_and_b32 s86, s86, 16383
    v_mfma_f32_16x16x32_bf16 v[84:87], a[4:7], v[128:131], 0
    s_add_u32 s58, s86, s66
    buffer_load_dwordx4 v[120:123], v23, s[24:27], s58 offen offset:0 sc1
    v_mfma_f32_16x16x32_bf16 v[88:91], a[8:11], v[128:131], 0
    v_mfma_f32_16x16x32_bf16 v[92:95], a[12:15], v[128:131], 0
    s_waitcnt vmcnt(9)
    v_mfma_f32_16x16x32_bf16 v[80:83], a[16:19], v[132:135], v[80:83]
    s_add_u32 s86, s86, 1024
    s_and_b32 s86, s86, 16383
    ds_write_b128 v232, v[96:99] offset:49152
    v_mfma_f32_16x16x32_bf16 v[84:87], a[20:23], v[132:135], v[84:87]
    s_add_u32 s58, s86, s66
    buffer_load_dwordx4 v[124:127], v23, s[24:27], s58 offen offset:0 sc1
    v_mfma_f32_16x16x32_bf16 v[88:91], a[24:27], v[132:135], v[88:91]
    v_mfma_f32_16x16x32_bf16 v[92:95], a[28:31], v[132:135], v[92:95]
    s_waitcnt vmcnt(9)
    v_mfma_f32_16x16x32_bf16 v[80:83], a[32:35], v[136:139], v[80:83]
    s_add_u32 s86, s86, 1024
    s_and_b32 s86, s86, 16383
    ds_write_b128 v232, v[100:103] offset:50176
    v_mfma_f32_16x16x32_bf16 v[84:87], a[36:39], v[136:139], v[84:87]
    s_add_u32 s58, s86, s66
    buffer_load_dwordx4 v[128:131], v23, s[24:27], s58 offen offset:0 sc1
    v_mfma_f32_16x16x32_bf16 v[88:91], a[40:43], v[136:139], v[88:91]
    v_mfma_f32_16x16x32_bf16 v[92:95], a[44:47], v[136:139], v[92:95]
    s_waitcnt vmcnt(9)
    v_mfma_f32_16x16x32_bf16 v[80:83], a[48:51], v[140:143], v[80:83]
    s_add_u32 s86, s86, 1024
    s_and_b32 s86, s86, 16383
    ds_write_b128 v232, v[104:107] offset:51200
    v_mfma_f32_16x16x32_bf16 v[84:87], a[52:55], v[140:143], v[84:87]
    s_add_u32 s58, s86, s66
    buffer_load_dwordx4 v[132:135], v23, s[24:27], s58 offen offset:0 sc1
    v_mfma_f32_16x16x32_bf16 v[88:91], a[56:59], v[140:143], v[88:91]
    v_mfma_f32_16x16x32_bf16 v[92:95], a[60:63], v[140:143], v[92:95]
    s_waitcnt vmcnt(9)
    v_mfma_f32_16x16x32_bf16 v[80:83], a[64:67], v[144:147], v[80:83]
    s_add_u32 s86, s86, 1024
    s_and_b32 s86, s86, 16383
    ds_write_b128 v232, v[108:111] offset:52224
    v_mfma_f32_16x16x32_bf16 v[84:87], a[68:71], v[144:147], v[84:87]
    s_add_u32 s58, s86, s66
    buffer_load_dwordx4 v[136:139], v23, s[24:27], s58 offen offset:0 sc1
    v_mfma_f32_16x16x32_bf16 v[88:91], a[72:75], v[144:147], v[88:91]
    v_mfma_f32_16x16x32_bf16 v[92:95], a[76:79], v[144:147], v[92:95]
    s_waitcnt vmcnt(9)
    v_mfma_f32_16x16x32_bf16 v[80:83], a[80:83], v[148:151], v[80:83]
    s_add_u32 s86, s86, 1024
    s_and_b32 s86, s86, 16383
    v_mfma_f32_16x16x32_bf16 v[84:87], a[84:87], v[148:151], v[84:87]
    s_add_u32 s58, s86, s66
    buffer_load_dwordx4 v[140:143], v23, s[24:27], s58 offen offset:0 sc1
    v_mfma_f32_16x16x32_bf16 v[88:91], a[88:91], v[148:151], v[88:91]
    v_mfma_f32_16x16x32_bf16 v[92:95], a[92:95], v[148:151], v[92:95]
    s_waitcnt vmcnt(9)
    v_mfma_f32_16x16x32_bf16 v[80:83], a[96:99], v[152:155], v[80:83]
    s_xor_b32 s66, s44, 2
    s_lshl2_add_u32 s66, s51, s66
    s_mul_i32 s66, s66, 66816
    v_mfma_f32_16x16x32_bf16 v[84:87], a[100:103], v[152:155], v[84:87]
    s_lshl2_add_u32 s66, s52, s66
    s_lshl_b32 s86, s65, 10
    s_add_u32 s58, s86, s66
    v_mfma_f32_16x16x32_bf16 v[88:91], a[104:107], v[152:155], v[88:91]
    buffer_load_dwordx4 v[144:147], v23, s[24:27], s58 offen offset:0 sc1
    v_mfma_f32_16x16x32_bf16 v[92:95], a[108:111], v[152:155], v[92:95]
    s_waitcnt vmcnt(9)
    v_mfma_f32_16x16x32_bf16 v[80:83], a[112:115], v[156:159], v[80:83]
    s_add_u32 s86, s86, 1024
    s_and_b32 s86, s86, 16383
    v_mfma_f32_16x16x32_bf16 v[84:87], a[116:119], v[156:159], v[84:87]
    s_add_u32 s58, s86, s66
    buffer_load_dwordx4 v[148:151], v23, s[24:27], s58 offen offset:0 sc1
    v_mfma_f32_16x16x32_bf16 v[88:91], a[120:123], v[156:159], v[88:91]
    v_mfma_f32_16x16x32_bf16 v[92:95], a[124:127], v[156:159], v[92:95]
    s_waitcnt vmcnt(9)
    v_mfma_f32_16x16x32_bf16 v[80:83], a[128:131], v[112:115], v[80:83]
    s_add_u32 s86, s86, 1024
    s_and_b32 s86, s86, 16383
    v_mfma_f32_16x16x32_bf16 v[84:87], a[132:135], v[112:115], v[84:87]
    s_add_u32 s58, s86, s66
    buffer_load_dwordx4 v[152:155], v23, s[24:27], s58 offen offset:0 sc1
    v_mfma_f32_16x16x32_bf16 v[88:91], a[136:139], v[112:115], v[88:91]
    v_mfma_f32_16x16x32_bf16 v[92:95], a[140:143], v[112:115], v[92:95]
    s_waitcnt vmcnt(9)
    v_mfma_f32_16x16x32_bf16 v[80:83], a[144:147], v[116:119], v[80:83]
    s_add_u32 s86, s86, 1024
    s_and_b32 s86, s86, 16383
    v_mfma_f32_16x16x32_bf16 v[84:87], a[148:151], v[116:119], v[84:87]
    s_add_u32 s58, s86, s66
    buffer_load_dwordx4 v[156:159], v23, s[24:27], s58 offen offset:0 sc1
    v_mfma_f32_16x16x32_bf16 v[88:91], a[152:155], v[116:119], v[88:91]
    v_mfma_f32_16x16x32_bf16 v[92:95], a[156:159], v[116:119], v[92:95]
    s_waitcnt vmcnt(9)
    v_mfma_f32_16x16x32_bf16 v[80:83], a[160:163], v[120:123], v[80:83]
    s_add_u32 s86, s86, 1024
    s_and_b32 s86, s86, 16383
    v_mfma_f32_16x16x32_bf16 v[84:87], a[164:167], v[120:123], v[84:87]
    s_add_u32 s58, s86, s66
    buffer_load_dwordx4 v[112:115], v23, s[24:27], s58 offen offset:0 sc1
    v_mfma_f32_16x16x32_bf16 v[88:91], a[168:171], v[120:123], v[88:91]
    v_mfma_f32_16x16x32_bf16 v[92:95], a[172:175], v[120:123], v[92:95]
    s_waitcnt vmcnt(9)
    v_mfma_f32_16x16x32_bf16 v[80:83], a[176:179], v[124:127], v[80:83]
    s_add_u32 s86, s86, 1024
    s_and_b32 s86, s86, 16383
    v_mfma_f32_16x16x32_bf16 v[84:87], a[180:183], v[124:127], v[84:87]
    s_add_u32 s58, s86, s66
    buffer_load_dwordx4 v[116:119], v23, s[24:27], s58 offen offset:0 sc1
    v_mfma_f32_16x16x32_bf16 v[88:91], a[184:187], v[124:127], v[88:91]
    v_mfma_f32_16x16x32_bf16 v[92:95], a[188:191], v[124:127], v[92:95]
    s_waitcnt vmcnt(9)
    v_mfma_f32_16x16x32_bf16 v[80:83], a[192:195], v[128:131], v[80:83]
    s_add_u32 s86, s86, 1024
    s_and_b32 s86, s86, 16383
    v_mfma_f32_16x16x32_bf16 v[84:87], a[196:199], v[128:131], v[84:87]
    s_add_u32 s58, s86, s66
    buffer_load_dwordx4 v[120:123], v23, s[24:27], s58 offen offset:0 sc1
    v_mfma_f32_16x16x32_bf16 v[88:91], a[200:203], v[128:131], v[88:91]
    v_mfma_f32_16x16x32_bf16 v[92:95], a[204:207], v[128:131], v[92:95]
    s_waitcnt vmcnt(9)
    v_mfma_f32_16x16x32_bf16 v[80:83], a[208:211], v[132:135], v[80:83]
    s_add_u32 s86, s86, 1024
    s_and_b32 s86, s86, 16383
    v_mfma_f32_16x16x32_bf16 v[84:87], a[212:215], v[132:135], v[84:87]
    s_add_u32 s58, s86, s66
    buffer_load_dwordx4 v[124:127], v23, s[24:27], s58 offen offset:0 sc1
    v_mfma_f32_16x16x32_bf16 v[88:91], a[216:219], v[132:135], v[88:91]
    v_mfma_f32_16x16x32_bf16 v[92:95], a[220:223], v[132:135], v[92:95]
    s_waitcnt vmcnt(9)
    v_mfma_f32_16x16x32_bf16 v[80:83], a[224:227], v[136:139], v[80:83]
    s_add_u32 s86, s86, 1024
    s_and_b32 s86, s86, 16383
    v_mfma_f32_16x16x32_bf16 v[84:87], a[228:231], v[136:139], v[84:87]
    s_add_u32 s58, s86, s66
    buffer_load_dwordx4 v[128:131], v23, s[24:27], s58 offen offset:0 sc1
    v_mfma_f32_16x16x32_bf16 v[88:91], a[232:235], v[136:139], v[88:91]
    v_mfma_f32_16x16x32_bf16 v[92:95], a[236:239], v[136:139], v[92:95]
    s_waitcnt vmcnt(9)
    v_mfma_f32_16x16x32_bf16 v[80:83], a[240:243], v[140:143], v[80:83]
    s_add_u32 s86, s86, 1024
    s_and_b32 s86, s86, 16383
    v_mfma_f32_16x16x32_bf16 v[84:87], a[244:247], v[140:143], v[84:87]
    s_add_u32 s58, s86, s66
    buffer_load_dwordx4 v[132:135], v23, s[24:27], s58 offen offset:0 sc1
    v_mfma_f32_16x16x32_bf16 v[88:91], a[248:251], v[140:143], v[88:91]
    v_mfma_f32_16x16x32_bf16 v[92:95], a[252:255], v[140:143], v[92:95]
    s_waitcnt vmcnt(9)
    v_mfma_f32_16x16x32_bf16 v[64:67], a[0:3], v[144:147], 0
    s_add_u32 s86, s86, 1024
    s_and_b32 s86, s86, 16383
    s_waitcnt lgkmcnt(0)
    s_barrier
    v_mfma_f32_16x16x32_bf16 v[68:71], a[4:7], v[144:147], 0
    s_add_u32 s58, s86, s66
    buffer_load_dwordx4 v[136:139], v23, s[24:27], s58 offen offset:0 sc1
    v_mfma_f32_16x16x32_bf16 v[72:75], a[8:11], v[144:147], 0
    v_mfma_f32_16x16x32_bf16 v[76:79], a[12:15], v[144:147], 0
    s_waitcnt vmcnt(9)
    v_mfma_f32_16x16x32_bf16 v[64:67], a[16:19], v[148:151], v[64:67]
    s_add_u32 s86, s86, 1024
    s_and_b32 s86, s86, 16383
    ds_write_b128 v232, v[80:83] offset:32768
    v_mfma_f32_16x16x32_bf16 v[68:71], a[20:23], v[148:151], v[68:71]
    s_add_u32 s58, s86, s66
    buffer_load_dwordx4 v[140:143], v23, s[24:27], s58 offen offset:0 sc1
    v_mfma_f32_16x16x32_bf16 v[72:75], a[24:27], v[148:151], v[72:75]
    v_mfma_f32_16x16x32_bf16 v[76:79], a[28:31], v[148:151], v[76:79]
    s_waitcnt vmcnt(9)
    v_mfma_f32_16x16x32_bf16 v[64:67], a[32:35], v[152:155], v[64:67]
    s_add_u32 s86, s86, 1024
    s_and_b32 s86, s86, 16383
    ds_write_b128 v232, v[84:87] offset:33792
    v_mfma_f32_16x16x32_bf16 v[68:71], a[36:39], v[152:155], v[68:71]
    s_add_u32 s58, s86, s66
    buffer_load_dwordx4 v[144:147], v23, s[24:27], s58 offen offset:0 sc1
    v_mfma_f32_16x16x32_bf16 v[72:75], a[40:43], v[152:155], v[72:75]
    v_mfma_f32_16x16x32_bf16 v[76:79], a[44:47], v[152:155], v[76:79]
    s_waitcnt vmcnt(9)
    v_mfma_f32_16x16x32_bf16 v[64:67], a[48:51], v[156:159], v[64:67]
    s_add_u32 s86, s86, 1024
    s_and_b32 s86, s86, 16383
    ds_write_b128 v232, v[88:91] offset:34816
    v_mfma_f32_16x16x32_bf16 v[68:71], a[52:55], v[156:159], v[68:71]
    s_add_u32 s58, s86, s66
    buffer_load_dwordx4 v[148:151], v23, s[24:27], s58 offen offset:0 sc1
    v_mfma_f32_16x16x32_bf16 v[72:75], a[56:59], v[156:159], v[72:75]
    v_mfma_f32_16x16x32_bf16 v[76:79], a[60:63], v[156:159], v[76:79]
    s_waitcnt vmcnt(9)
    v_mfma_f32_16x16x32_bf16 v[64:67], a[64:67], v[112:115], v[64:67]
    s_add_u32 s86, s86, 1024
    s_and_b32 s86, s86, 16383
    ds_write_b128 v232, v[92:95] offset:35840
    v_mfma_f32_16x16x32_bf16 v[68:71], a[68:71], v[112:115], v[68:71]
    s_add_u32 s58, s86, s66
    buffer_load_dwordx4 v[152:155], v23, s[24:27], s58 offen offset:0 sc1
    v_mfma_f32_16x16x32_bf16 v[72:75], a[72:75], v[112:115], v[72:75]
    v_mfma_f32_16x16x32_bf16 v[76:79], a[76:79], v[112:115], v[76:79]
    s_waitcnt vmcnt(9)
    v_mfma_f32_16x16x32_bf16 v[64:67], a[80:83], v[116:119], v[64:67]
    s_add_u32 s86, s86, 1024
    s_and_b32 s86, s86, 16383
    ds_read_b128 v[160:163], v243 offset:0
    v_mfma_f32_16x16x32_bf16 v[68:71], a[84:87], v[116:119], v[68:71]
    s_add_u32 s58, s86, s66
    buffer_load_dwordx4 v[156:159], v23, s[24:27], s58 offen offset:0 sc1
    ds_read_b128 v[164:167], v243 offset:1024
    v_mfma_f32_16x16x32_bf16 v[72:75], a[88:91], v[116:119], v[72:75]
    ds_read_b128 v[168:171], v243 offset:4096
    v_mfma_f32_16x16x32_bf16 v[76:79], a[92:95], v[116:119], v[76:79]
    ds_read_b128 v[172:175], v243 offset:5120
    s_waitcnt vmcnt(9)
    v_mfma_f32_16x16x32_bf16 v[64:67], a[96:99], v[120:123], v[64:67]
    s_xor_b32 s66, s44, 1
    s_lshl2_add_u32 s66, s51, s66
    s_mul_i32 s66, s66, 66816
    ds_read_b128 v[176:179], v243 offset:8192
    v_mfma_f32_16x16x32_bf16 v[68:71], a[100:103], v[120:123], v[68:71]
    s_lshl2_add_u32 s66, s52, s66
    s_lshl_b32 s86, s65, 10
    s_add_u32 s58, s86, s66
    ds_read_b128 v[180:183], v243 offset:9216
    v_mfma_f32_16x16x32_bf16 v[72:75], a[104:107], v[120:123], v[72:75]
    buffer_load_dwordx4 v[112:115], v23, s[24:27], s58 offen offset:0 sc1
    ds_read_b128 v[184:187], v243 offset:12288
    v_mfma_f32_16x16x32_bf16 v[76:79], a[108:111], v[120:123], v[76:79]
    ds_read_b128 v[188:191], v243 offset:13312
    s_waitcnt vmcnt(9)
    v_mfma_f32_16x16x32_bf16 v[64:67], a[112:115], v[124:127], v[64:67]
    s_add_u32 s86, s86, 1024
    s_and_b32 s86, s86, 16383
    v_mfma_f32_16x16x32_bf16 v[68:71], a[116:119], v[124:127], v[68:71]
    s_add_u32 s58, s86, s66
    buffer_load_dwordx4 v[116:119], v23, s[24:27], s58 offen offset:0 sc1
    v_mfma_f32_16x16x32_bf16 v[72:75], a[120:123], v[124:127], v[72:75]
    v_mfma_f32_16x16x32_bf16 v[76:79], a[124:127], v[124:127], v[76:79]
    s_waitcnt vmcnt(9)
    v_mfma_f32_16x16x32_bf16 v[64:67], a[128:131], v[128:131], v[64:67]
    s_add_u32 s86, s86, 1024
    s_and_b32 s86, s86, 16383
    v_mfma_f32_16x16x32_bf16 v[68:71], a[132:135], v[128:131], v[68:71]
    s_add_u32 s58, s86, s66
    buffer_load_dwordx4 v[120:123], v23, s[24:27], s58 offen offset:0 sc1
    v_mfma_f32_16x16x32_bf16 v[72:75], a[136:139], v[128:131], v[72:75]
    v_mfma_f32_16x16x32_bf16 v[76:79], a[140:143], v[128:131], v[76:79]
    s_waitcnt vmcnt(9)
    v_mfma_f32_16x16x32_bf16 v[64:67], a[144:147], v[132:135], v[64:67]
    s_add_u32 s86, s86, 1024
    s_and_b32 s86, s86, 16383
    s_waitcnt lgkmcnt(0)
    v_mfma_f32_16x16x32_bf16 v[68:71], a[148:151], v[132:135], v[68:71]
    s_add_u32 s58, s86, s66
    buffer_load_dwordx4 v[124:127], v23, s[24:27], s58 offen offset:0 sc1
    v_add_f32 v160, v160, v168
    v_mfma_f32_16x16x32_bf16 v[72:75], a[152:155], v[132:135], v[72:75]
    v_add_f32 v161, v161, v169
    v_mfma_f32_16x16x32_bf16 v[76:79], a[156:159], v[132:135], v[76:79]
    v_add_f32 v162, v162, v170
    s_waitcnt vmcnt(9)
    v_mfma_f32_16x16x32_bf16 v[64:67], a[160:163], v[136:139], v[64:67]
    s_add_u32 s86, s86, 1024
    s_and_b32 s86, s86, 16383
    v_add_f32 v163, v163, v171
    v_mfma_f32_16x16x32_bf16 v[68:71], a[164:167], v[136:139], v[68:71]
    s_add_u32 s58, s86, s66
    buffer_load_dwordx4 v[128:131], v23, s[24:27], s58 offen offset:0 sc1
    v_add_f32 v164, v164, v172
    v_mfma_f32_16x16x32_bf16 v[72:75], a[168:171], v[136:139], v[72:75]
    v_add_f32 v165, v165, v173
    v_mfma_f32_16x16x32_bf16 v[76:79], a[172:175], v[136:139], v[76:79]
    v_add_f32 v166, v166, v174
    s_waitcnt vmcnt(9)
    v_mfma_f32_16x16x32_bf16 v[64:67], a[176:179], v[140:143], v[64:67]
    s_add_u32 s86, s86, 1024
    s_and_b32 s86, s86, 16383
    v_add_f32 v167, v167, v175
    v_mfma_f32_16x16x32_bf16 v[68:71], a[180:183], v[140:143], v[68:71]
    s_add_u32 s58, s86, s66
    buffer_load_dwordx4 v[132:135], v23, s[24:27], s58 offen offset:0 sc1
    v_add_f32 v160, v160, v176
    v_mfma_f32_16x16x32_bf16 v[72:75], a[184:187], v[140:143], v[72:75]
    v_add_f32 v161, v161, v177
    v_mfma_f32_16x16x32_bf16 v[76:79], a[188:191], v[140:143], v[76:79]
    v_add_f32 v162, v162, v178
    s_waitcnt vmcnt(9)
    v_mfma_f32_16x16x32_bf16 v[64:67], a[192:195], v[144:147], v[64:67]
    s_add_u32 s86, s86, 1024
    s_and_b32 s86, s86, 16383
    v_add_f32 v163, v163, v179
    v_mfma_f32_16x16x32_bf16 v[68:71], a[196:199], v[144:147], v[68:71]
    s_add_u32 s58, s86, s66
    buffer_load_dwordx4 v[136:139], v23, s[24:27], s58 offen offset:0 sc1
    v_add_f32 v164, v164, v180
    v_mfma_f32_16x16x32_bf16 v[72:75], a[200:203], v[144:147], v[72:75]
    v_add_f32 v165, v165, v181
    v_mfma_f32_16x16x32_bf16 v[76:79], a[204:207], v[144:147], v[76:79]
    v_add_f32 v166, v166, v182
    s_waitcnt vmcnt(9)
    v_mfma_f32_16x16x32_bf16 v[64:67], a[208:211], v[148:151], v[64:67]
    s_add_u32 s86, s86, 1024
    s_and_b32 s86, s86, 16383
    v_add_f32 v167, v167, v183
    v_mfma_f32_16x16x32_bf16 v[68:71], a[212:215], v[148:151], v[68:71]
    s_add_u32 s58, s86, s66
    buffer_load_dwordx4 v[140:143], v23, s[24:27], s58 offen offset:0 sc1
    v_add_f32 v160, v160, v184
    v_mfma_f32_16x16x32_bf16 v[72:75], a[216:219], v[148:151], v[72:75]
    v_add_f32 v161, v161, v185
    v_mfma_f32_16x16x32_bf16 v[76:79], a[220:223], v[148:151], v[76:79]
    v_add_f32 v162, v162, v186
    s_waitcnt vmcnt(9)
    v_mfma_f32_16x16x32_bf16 v[64:67], a[224:227], v[152:155], v[64:67]
    s_add_u32 s86, s86, 1024
    s_and_b32 s86, s86, 16383
    v_add_f32 v163, v163, v187
    v_mfma_f32_16x16x32_bf16 v[68:71], a[228:231], v[152:155], v[68:71]
    s_add_u32 s58, s86, s66
    buffer_load_dwordx4 v[144:147], v23, s[24:27], s58 offen offset:0 sc1
    v_add_f32 v164, v164, v188
    v_mfma_f32_16x16x32_bf16 v[72:75], a[232:235], v[152:155], v[72:75]
    v_add_f32 v165, v165, v189
    v_mfma_f32_16x16x32_bf16 v[76:79], a[236:239], v[152:155], v[76:79]
    v_add_f32 v166, v166, v190
    s_waitcnt vmcnt(9)
    v_mfma_f32_16x16x32_bf16 v[64:67], a[240:243], v[156:159], v[64:67]
    s_add_u32 s86, s86, 1024
    s_and_b32 s86, s86, 16383
    v_add_f32 v167, v167, v191
    v_mfma_f32_16x16x32_bf16 v[68:71], a[244:247], v[156:159], v[68:71]
    s_add_u32 s58, s86, s66
    buffer_load_dwordx4 v[148:151], v23, s[24:27], s58 offen offset:0 sc1
    v_mfma_f32_16x16x32_bf16 v[72:75], a[248:251], v[156:159], v[72:75]
    v_mfma_f32_16x16x32_bf16 v[76:79], a[252:255], v[156:159], v[76:79]
    s_waitcnt vmcnt(9)
    v_mfma_f32_16x16x32_bf16 v[48:51], a[0:3], v[112:115], 0
    s_add_u32 s86, s86, 1024
    s_and_b32 s86, s86, 16383
    v_mfma_f32_16x16x32_bf16 v[52:55], a[4:7], v[112:115], 0
    s_add_u32 s58, s86, s66
    buffer_load_dwordx4 v[152:155], v23, s[24:27], s58 offen offset:0 sc1
    v_mfma_f32_16x16x32_bf16 v[56:59], a[8:11], v[112:115], 0
    v_mfma_f32_16x16x32_bf16 v[60:63], a[12:15], v[112:115], 0
    s_waitcnt vmcnt(9)
    v_mfma_f32_16x16x32_bf16 v[48:51], a[16:19], v[116:119], v[48:51]
    s_add_u32 s86, s86, 1024
    s_and_b32 s86, s86, 16383
    ds_write_b128 v232, v[64:67] offset:16384
    v_mfma_f32_16x16x32_bf16 v[52:55], a[20:23], v[116:119], v[52:55]
    s_add_u32 s58, s86, s66
    buffer_load_dwordx4 v[156:159], v23, s[24:27], s58 offen offset:0 sc1
    v_mfma_f32_16x16x32_bf16 v[56:59], a[24:27], v[116:119], v[56:59]
    v_mfma_f32_16x16x32_bf16 v[60:63], a[28:31], v[116:119], v[60:63]
    s_waitcnt vmcnt(9)
    v_mfma_f32_16x16x32_bf16 v[48:51], a[32:35], v[120:123], v[48:51]
    s_add_u32 s86, s86, 1024
    s_and_b32 s86, s86, 16383
    ds_write_b128 v232, v[68:71] offset:17408
    v_mfma_f32_16x16x32_bf16 v[52:55], a[36:39], v[120:123], v[52:55]
    s_add_u32 s58, s86, s66
    buffer_load_dwordx4 v[112:115], v23, s[24:27], s58 offen offset:0 sc1
    v_mfma_f32_16x16x32_bf16 v[56:59], a[40:43], v[120:123], v[56:59]
    v_mfma_f32_16x16x32_bf16 v[60:63], a[44:47], v[120:123], v[60:63]
    s_waitcnt vmcnt(9)
    v_mfma_f32_16x16x32_bf16 v[48:51], a[48:51], v[124:127], v[48:51]
    s_add_u32 s86, s86, 1024
    s_and_b32 s86, s86, 16383
    ds_write_b128 v232, v[72:75] offset:18432
    v_mfma_f32_16x16x32_bf16 v[52:55], a[52:55], v[124:127], v[52:55]
    s_add_u32 s58, s86, s66
    buffer_load_dwordx4 v[116:119], v23, s[24:27], s58 offen offset:0 sc1
    v_mfma_f32_16x16x32_bf16 v[56:59], a[56:59], v[124:127], v[56:59]
    v_mfma_f32_16x16x32_bf16 v[60:63], a[60:63], v[124:127], v[60:63]
    s_waitcnt vmcnt(9)
    v_mfma_f32_16x16x32_bf16 v[48:51], a[64:67], v[128:131], v[48:51]
    s_add_u32 s86, s86, 1024
    s_and_b32 s86, s86, 16383
    ds_write_b128 v232, v[76:79] offset:19456
    v_mfma_f32_16x16x32_bf16 v[52:55], a[68:71], v[128:131], v[52:55]
    s_add_u32 s58, s86, s66
    buffer_load_dwordx4 v[120:123], v23, s[24:27], s58 offen offset:0 sc1
    v_mfma_f32_16x16x32_bf16 v[56:59], a[72:75], v[128:131], v[56:59]
    v_mfma_f32_16x16x32_bf16 v[60:63], a[76:79], v[128:131], v[60:63]
    s_waitcnt vmcnt(9)
    v_mfma_f32_16x16x32_bf16 v[48:51], a[80:83], v[132:135], v[48:51]
    s_add_u32 s86, s86, 1024
    s_and_b32 s86, s86, 16383
    v_mul_f32 v192, v160, v160
    v_mul_f32 v193, v161, v161
    v_mfma_f32_16x16x32_bf16 v[52:55], a[84:87], v[132:135], v[52:55]
    s_add_u32 s58, s86, s66
    buffer_load_dwordx4 v[124:127], v23, s[24:27], s58 offen offset:0 sc1
    v_mul_f32 v194, v162, v162
    v_mul_f32 v195, v163, v163
    v_mfma_f32_16x16x32_bf16 v[56:59], a[88:91], v[132:135], v[56:59]
    v_mul_f32 v196, v164, v164
    v_mul_f32 v197, v165, v165
    v_mfma_f32_16x16x32_bf16 v[60:63], a[92:95], v[132:135], v[60:63]
    s_waitcnt vmcnt(9)
    v_mfma_f32_16x16x32_bf16 v[48:51], a[96:99], v[136:139], v[48:51]
    s_xor_b32 s66, s44, 0
    s_lshl2_add_u32 s66, s51, s66
    s_mul_i32 s66, s66, 66816
    v_mul_f32 v198, v166, v166
    v_mul_f32 v199, v167, v167
    v_mfma_f32_16x16x32_bf16 v[52:55], a[100:103], v[136:139], v[52:55]
    s_lshl2_add_u32 s66, s52, s66
    s_lshl_b32 s86, s65, 10
    s_add_u32 s58, s86, s66
    v_fma_f32 v192, v192, v236, v237
    v_fma_f32 v193, v193, v236, v237
    v_mfma_f32_16x16x32_bf16 v[56:59], a[104:107], v[136:139], v[56:59]
    buffer_load_dwordx4 v[128:131], v23, s[24:27], s58 offen offset:0 sc1
    v_fma_f32 v194, v194, v236, v237
    v_fma_f32 v195, v195, v236, v237
    v_mfma_f32_16x16x32_bf16 v[60:63], a[108:111], v[136:139], v[60:63]
    s_waitcnt vmcnt(9)
    v_mfma_f32_16x16x32_bf16 v[48:51], a[112:115], v[140:143], v[48:51]
    s_add_u32 s86, s86, 1024
    s_and_b32 s86, s86, 16383
    v_fma_f32 v196, v196, v236, v237
    v_fma_f32 v197, v197, v236, v237
    v_mfma_f32_16x16x32_bf16 v[52:55], a[116:119], v[140:143], v[52:55]
    s_add_u32 s58, s86, s66
    buffer_load_dwordx4 v[132:135], v23, s[24:27], s58 offen offset:0 sc1
    v_fma_f32 v198, v198, v236, v237
    v_fma_f32 v199, v199, v236, v237
    v_mfma_f32_16x16x32_bf16 v[56:59], a[120:123], v[140:143], v[56:59]
    v_mul_f32 v192, v192, v160
    v_mul_f32 v193, v193, v161
    v_mfma_f32_16x16x32_bf16 v[60:63], a[124:127], v[140:143], v[60:63]
    s_waitcnt vmcnt(9)
    v_mfma_f32_16x16x32_bf16 v[48:51], a[128:131], v[144:147], v[48:51]
    s_add_u32 s86, s86, 1024
    s_and_b32 s86, s86, 16383
    v_mul_f32 v194, v194, v162
    v_mul_f32 v195, v195, v163
    v_mfma_f32_16x16x32_bf16 v[52:55], a[132:135], v[144:147], v[52:55]
    s_add_u32 s58, s86, s66
    buffer_load_dwordx4 v[136:139], v23, s[24:27], s58 offen offset:0 sc1
    v_mul_f32 v196, v196, v164
    v_mul_f32 v197, v197, v165
    v_mfma_f32_16x16x32_bf16 v[56:59], a[136:139], v[144:147], v[56:59]
    v_mul_f32 v198, v198, v166
    v_mul_f32 v199, v199, v167
    v_mfma_f32_16x16x32_bf16 v[60:63], a[140:143], v[144:147], v[60:63]
    s_waitcnt vmcnt(9)
    v_mfma_f32_16x16x32_bf16 v[48:51], a[144:147], v[148:151], v[48:51]
    s_add_u32 s86, s86, 1024
    s_and_b32 s86, s86, 16383
    v_exp_f32 v192, v192
    v_exp_f32 v193, v193
    v_mfma_f32_16x16x32_bf16 v[52:55], a[148:151], v[148:151], v[52:55]
    s_add_u32 s58, s86, s66
    buffer_load_dwordx4 v[140:143], v23, s[24:27], s58 offen offset:0 sc1
    v_exp_f32 v194, v194
    v_exp_f32 v195, v195
    v_mfma_f32_16x16x32_bf16 v[56:59], a[152:155], v[148:151], v[56:59]
    v_exp_f32 v196, v196
    v_exp_f32 v197, v197
    v_mfma_f32_16x16x32_bf16 v[60:63], a[156:159], v[148:151], v[60:63]
    s_waitcnt vmcnt(9)
    v_mfma_f32_16x16x32_bf16 v[48:51], a[160:163], v[152:155], v[48:51]
    s_add_u32 s86, s86, 1024
    s_and_b32 s86, s86, 16383
    v_exp_f32 v198, v198
    v_exp_f32 v199, v199
    v_mfma_f32_16x16x32_bf16 v[52:55], a[164:167], v[152:155], v[52:55]
    s_add_u32 s58, s86, s66
    buffer_load_dwordx4 v[144:147], v23, s[24:27], s58 offen offset:0 sc1
    v_add_f32 v192, 1.0, v192
    v_add_f32 v193, 1.0, v193
    v_mfma_f32_16x16x32_bf16 v[56:59], a[168:171], v[152:155], v[56:59]
    v_add_f32 v194, 1.0, v194
    v_add_f32 v195, 1.0, v195
    v_mfma_f32_16x16x32_bf16 v[60:63], a[172:175], v[152:155], v[60:63]
    s_waitcnt vmcnt(9)
    v_mfma_f32_16x16x32_bf16 v[48:51], a[176:179], v[156:159], v[48:51]
    s_add_u32 s86, s86, 1024
    s_and_b32 s86, s86, 16383
    v_add_f32 v196, 1.0, v196
    v_add_f32 v197, 1.0, v197
    v_mfma_f32_16x16x32_bf16 v[52:55], a[180:183], v[156:159], v[52:55]
    s_add_u32 s58, s86, s66
    buffer_load_dwordx4 v[148:151], v23, s[24:27], s58 offen offset:0 sc1
    v_add_f32 v198, 1.0, v198
    v_add_f32 v199, 1.0, v199
    v_mfma_f32_16x16x32_bf16 v[56:59], a[184:187], v[156:159], v[56:59]
    v_rcp_f32 v192, v192
    v_rcp_f32 v193, v193
    v_mfma_f32_16x16x32_bf16 v[60:63], a[188:191], v[156:159], v[60:63]
    s_waitcnt vmcnt(9)
    v_mfma_f32_16x16x32_bf16 v[48:51], a[192:195], v[112:115], v[48:51]
    s_add_u32 s86, s86, 1024
    s_and_b32 s86, s86, 16383
    v_rcp_f32 v194, v194
    v_rcp_f32 v195, v195
    v_mfma_f32_16x16x32_bf16 v[52:55], a[196:199], v[112:115], v[52:55]
    s_add_u32 s58, s86, s66
    buffer_load_dwordx4 v[152:155], v23, s[24:27], s58 offen offset:0 sc1
    v_rcp_f32 v196, v196
    v_rcp_f32 v197, v197
    v_mfma_f32_16x16x32_bf16 v[56:59], a[200:203], v[112:115], v[56:59]
    v_rcp_f32 v198, v198
    v_rcp_f32 v199, v199
    v_mfma_f32_16x16x32_bf16 v[60:63], a[204:207], v[112:115], v[60:63]
    s_waitcnt vmcnt(9)
    v_mfma_f32_16x16x32_bf16 v[48:51], a[208:211], v[116:119], v[48:51]
    s_add_u32 s86, s86, 1024
    s_and_b32 s86, s86, 16383
    v_mul_f32 v192, v192, v160
    v_mul_f32 v193, v193, v161
    v_mfma_f32_16x16x32_bf16 v[52:55], a[212:215], v[116:119], v[52:55]
    s_add_u32 s58, s86, s66
    buffer_load_dwordx4 v[156:159], v23, s[24:27], s58 offen offset:0 sc1
    v_mul_f32 v194, v194, v162
    v_mul_f32 v195, v195, v163
    v_mfma_f32_16x16x32_bf16 v[56:59], a[216:219], v[116:119], v[56:59]
    v_mul_f32 v196, v196, v164
    v_mul_f32 v197, v197, v165
    v_mfma_f32_16x16x32_bf16 v[60:63], a[220:223], v[116:119], v[60:63]
    s_waitcnt vmcnt(9)
    v_mfma_f32_16x16x32_bf16 v[48:51], a[224:227], v[120:123], v[48:51]
    s_add_u32 s86, s86, 1024
    s_and_b32 s86, s86, 16383
    v_mul_f32 v198, v198, v166
    v_mul_f32 v199, v199, v167
    v_mfma_f32_16x16x32_bf16 v[52:55], a[228:231], v[120:123], v[52:55]
    s_add_u32 s58, s86, s66
    buffer_load_dwordx4 v[112:115], v23, s[24:27], s58 offen offset:0 sc1
    v_cvt_pk_bf16_f32 v96, v192, v193
    v_cvt_pk_bf16_f32 v97, v194, v195
    v_mfma_f32_16x16x32_bf16 v[56:59], a[232:235], v[120:123], v[56:59]
    v_cvt_pk_bf16_f32 v98, v196, v197
    v_cvt_pk_bf16_f32 v99, v198, v199
    v_mfma_f32_16x16x32_bf16 v[60:63], a[236:239], v[120:123], v[60:63]
    s_waitcnt vmcnt(9)
    v_mfma_f32_16x16x32_bf16 v[48:51], a[240:243], v[124:127], v[48:51]
    s_add_u32 s86, s86, 1024
    s_and_b32 s86, s86, 16383
    v_mfma_f32_16x16x32_bf16 v[52:55], a[244:247], v[124:127], v[52:55]
    s_add_u32 s58, s86, s66
    buffer_load_dwordx4 v[116:119], v23, s[24:27], s58 offen offset:0 sc1
    v_mfma_f32_16x16x32_bf16 v[56:59], a[248:251], v[124:127], v[56:59]
    v_mfma_f32_16x16x32_bf16 v[60:63], a[252:255], v[124:127], v[60:63]
    s_waitcnt vmcnt(9)
    v_mfma_f32_16x16x32_bf16 v[32:35], a[0:3], v[128:131], v[32:35]
    s_add_u32 s86, s86, 1024
    s_and_b32 s86, s86, 16383
    v_mfma_f32_16x16x32_bf16 v[36:39], a[4:7], v[128:131], v[36:39]
    s_add_u32 s58, s86, s66
    buffer_load_dwordx4 v[120:123], v23, s[24:27], s58 offen offset:0 sc1
    v_mfma_f32_16x16x32_bf16 v[40:43], a[8:11], v[128:131], v[40:43]
    v_mfma_f32_16x16x32_bf16 v[44:47], a[12:15], v[128:131], v[44:47]
    s_waitcnt vmcnt(9)
    v_mfma_f32_16x16x32_bf16 v[32:35], a[16:19], v[132:135], v[32:35]
    s_add_u32 s86, s86, 1024
    s_and_b32 s86, s86, 16383
    ds_write_b128 v232, v[48:51] offset:0
    v_mfma_f32_16x16x32_bf16 v[36:39], a[20:23], v[132:135], v[36:39]
    s_add_u32 s58, s86, s66
    buffer_load_dwordx4 v[124:127], v23, s[24:27], s58 offen offset:0 sc1
    v_mfma_f32_16x16x32_bf16 v[40:43], a[24:27], v[132:135], v[40:43]
    v_mfma_f32_16x16x32_bf16 v[44:47], a[28:31], v[132:135], v[44:47]
    s_waitcnt vmcnt(9)
    v_mfma_f32_16x16x32_bf16 v[32:35], a[32:35], v[136:139], v[32:35]
    s_add_u32 s86, s86, 1024
    s_and_b32 s86, s86, 16383
    ds_write_b128 v232, v[52:55] offset:1024
    v_mfma_f32_16x16x32_bf16 v[36:39], a[36:39], v[136:139], v[36:39]
    s_add_u32 s58, s86, s66
    buffer_load_dwordx4 v[128:131], v23, s[24:27], s58 offen offset:0 sc1
    v_mfma_f32_16x16x32_bf16 v[40:43], a[40:43], v[136:139], v[40:43]
    v_mfma_f32_16x16x32_bf16 v[44:47], a[44:47], v[136:139], v[44:47]
    s_waitcnt vmcnt(9)
    v_mfma_f32_16x16x32_bf16 v[32:35], a[48:51], v[140:143], v[32:35]
    s_add_u32 s86, s86, 1024
    s_and_b32 s86, s86, 16383
    ds_write_b128 v232, v[56:59] offset:2048
    v_mfma_f32_16x16x32_bf16 v[36:39], a[52:55], v[140:143], v[36:39]
    s_add_u32 s58, s86, s66
    buffer_load_dwordx4 v[132:135], v23, s[24:27], s58 offen offset:0 sc1
    v_mfma_f32_16x16x32_bf16 v[40:43], a[56:59], v[140:143], v[40:43]
    v_mfma_f32_16x16x32_bf16 v[44:47], a[60:63], v[140:143], v[44:47]
    s_waitcnt vmcnt(9)
    v_mfma_f32_16x16x32_bf16 v[32:35], a[64:67], v[144:147], v[32:35]
    s_add_u32 s86, s86, 1024
    s_and_b32 s86, s86, 16383
    ds_write_b128 v232, v[60:63] offset:3072
    v_mfma_f32_16x16x32_bf16 v[36:39], a[68:71], v[144:147], v[36:39]
    s_add_u32 s58, s86, s66
    buffer_load_dwordx4 v[136:139], v23, s[24:27], s58 offen offset:0 sc1
    v_mfma_f32_16x16x32_bf16 v[40:43], a[72:75], v[144:147], v[40:43]
    v_mfma_f32_16x16x32_bf16 v[44:47], a[76:79], v[144:147], v[44:47]
    s_waitcnt vmcnt(9)
    v_mfma_f32_16x16x32_bf16 v[32:35], a[80:83], v[148:151], v[32:35]
    s_add_u32 s86, s86, 1024
    s_and_b32 s86, s86, 16383
    v_mfma_f32_16x16x32_bf16 v[36:39], a[84:87], v[148:151], v[36:39]
    s_add_u32 s58, s86, s66
    buffer_load_dwordx4 v[140:143], v23, s[24:27], s58 offen offset:0 sc1
    v_mfma_f32_16x16x32_bf16 v[40:43], a[88:91], v[148:151], v[40:43]
    v_mfma_f32_16x16x32_bf16 v[44:47], a[92:95], v[148:151], v[44:47]
    buffer_load_dwordx4 v[216:219], v22, s[4:7], s71 offen
    s_waitcnt vmcnt(10)
    v_mfma_f32_16x16x32_bf16 v[32:35], a[96:99], v[152:155], v[32:35]
    v_mfma_f32_16x16x32_bf16 v[36:39], a[100:103], v[152:155], v[36:39]
    v_mfma_f32_16x16x32_bf16 v[40:43], a[104:107], v[152:155], v[40:43]
    v_mfma_f32_16x16x32_bf16 v[44:47], a[108:111], v[152:155], v[44:47]
    buffer_load_dwordx4 v[220:223], v22, s[4:7], s72 offen
    s_waitcnt vmcnt(10)
    v_mfma_f32_16x16x32_bf16 v[32:35], a[112:115], v[156:159], v[32:35]
    s_waitcnt lgkmcnt(0)
    s_barrier
    v_mfma_f32_16x16x32_bf16 v[36:39], a[116:119], v[156:159], v[36:39]
    v_mfma_f32_16x16x32_bf16 v[40:43], a[120:123], v[156:159], v[40:43]
    v_mfma_f32_16x16x32_bf16 v[44:47], a[124:127], v[156:159], v[44:47]
    buffer_load_dwordx2 v[226:227], v26, s[4:7], s73 offen
    s_waitcnt vmcnt(10)
    v_mfma_f32_16x16x32_bf16 v[32:35], a[128:131], v[112:115], v[32:35]
    ds_read_b128 v[160:163], v233 offset:0
    v_mfma_f32_16x16x32_bf16 v[36:39], a[132:135], v[112:115], v[36:39]
    ds_read_b128 v[176:179], v234 offset:16384
    v_mfma_f32_16x16x32_bf16 v[40:43], a[136:139], v[112:115], v[40:43]
    ds_read_b128 v[192:195], v235 offset:32768
    v_mfma_f32_16x16x32_bf16 v[44:47], a[140:143], v[112:115], v[44:47]
    ds_read_b128 v[164:167], v233 offset:1024
    buffer_load_ushort v224, v25, s[36:39], s74 offen
    s_waitcnt vmcnt(10)
    v_mfma_f32_16x16x32_bf16 v[32:35], a[144:147], v[116:119], v[32:35]
    ds_read_b128 v[180:183], v234 offset:17408
    v_mfma_f32_16x16x32_bf16 v[36:39], a[148:151], v[116:119], v[36:39]
    ds_read_b128 v[196:199], v235 offset:33792
    v_mfma_f32_16x16x32_bf16 v[40:43], a[152:155], v[116:119], v[40:43]
    ds_read_b128 v[168:171], v233 offset:2048
    v_mfma_f32_16x16x32_bf16 v[44:47], a[156:159], v[116:119], v[44:47]
    ds_read_b128 v[184:187], v234 offset:18432
    buffer_load_ushort v225, v25, s[36:39], s74 offen offset:64
    s_waitcnt vmcnt(10)
    v_mfma_f32_16x16x32_bf16 v[32:35], a[160:163], v[120:123], v[32:35]
    ds_read_b128 v[200:203], v235 offset:34816
    v_mfma_f32_16x16x32_bf16 v[36:39], a[164:167], v[120:123], v[36:39]
    ds_read_b128 v[172:175], v233 offset:3072
    v_mfma_f32_16x16x32_bf16 v[40:43], a[168:171], v[120:123], v[40:43]
    ds_read_b128 v[188:191], v234 offset:19456
    v_mfma_f32_16x16x32_bf16 v[44:47], a[172:175], v[120:123], v[44:47]
    ds_read_b128 v[204:207], v235 offset:35840
    buffer_load_ushort v228, v27, s[36:39], s74 offen
    s_waitcnt vmcnt(10)
    v_mfma_f32_16x16x32_bf16 v[32:35], a[176:179], v[124:127], v[32:35]
    s_waitcnt lgkmcnt(9)
    v_add_f32 v160, v160, v176
    v_mfma_f32_16x16x32_bf16 v[36:39], a[180:183], v[124:127], v[36:39]
    v_add_f32 v161, v161, v177
    v_add_f32 v162, v162, v178
    v_mfma_f32_16x16x32_bf16 v[40:43], a[184:187], v[124:127], v[40:43]
    v_add_f32 v163, v163, v179
    v_add_f32 v160, v160, v192
    v_mfma_f32_16x16x32_bf16 v[44:47], a[188:191], v[124:127], v[44:47]
    v_add_f32 v161, v161, v193
    v_add_f32 v162, v162, v194
    s_add_u32 m0, s52, 81920
    s_lshl_b32 s57, s76, 7
    buffer_load_dwordx4 v12, s[20:23], s57 offen offset:0 lds
    s_waitcnt vmcnt(10)
    v_mfma_f32_16x16x32_bf16 v[32:35], a[192:195], v[128:131], v[32:35]
    v_add_f32 v163, v163, v195
    s_waitcnt lgkmcnt(6)
    v_mfma_f32_16x16x32_bf16 v[36:39], a[196:199], v[128:131], v[36:39]
    v_add_f32 v164, v164, v180
    v_add_f32 v165, v165, v181
    v_mfma_f32_16x16x32_bf16 v[40:43], a[200:203], v[128:131], v[40:43]
    v_add_f32 v166, v166, v182
    v_add_f32 v167, v167, v183
    v_mfma_f32_16x16x32_bf16 v[44:47], a[204:207], v[128:131], v[44:47]
    v_add_f32 v164, v164, v196
    v_add_f32 v165, v165, v197
    s_add_u32 s57, s57, 31744
    buffer_load_dwordx4 v12, s[20:23], s57 offen offset:1024 lds
    s_waitcnt vmcnt(10)
    v_mfma_f32_16x16x32_bf16 v[32:35], a[208:211], v[132:135], v[32:35]
    v_add_f32 v166, v166, v198
    v_add_f32 v167, v167, v199
    v_mfma_f32_16x16x32_bf16 v[36:39], a[212:215], v[132:135], v[36:39]
    s_waitcnt lgkmcnt(3)
    v_add_f32 v168, v168, v184
    v_mfma_f32_16x16x32_bf16 v[40:43], a[216:219], v[132:135], v[40:43]
    v_add_f32 v169, v169, v185
    v_add_f32 v170, v170, v186
    v_mfma_f32_16x16x32_bf16 v[44:47], a[220:223], v[132:135], v[44:47]
    v_add_f32 v171, v171, v187
    v_add_f32 v168, v168, v200
    s_add_u32 s57, s57, 31744
    buffer_load_dwordx4 v12, s[20:23], s57 offen offset:2048 lds
    s_waitcnt vmcnt(10)
    v_mfma_f32_16x16x32_bf16 v[32:35], a[224:227], v[136:139], v[32:35]
    v_add_f32 v169, v169, v201
    v_add_f32 v170, v170, v202
    v_mfma_f32_16x16x32_bf16 v[36:39], a[228:231], v[136:139], v[36:39]
    v_add_f32 v171, v171, v203
    s_waitcnt lgkmcnt(0)
    v_mfma_f32_16x16x32_bf16 v[40:43], a[232:235], v[136:139], v[40:43]
    v_add_f32 v172, v172, v188
    v_add_f32 v173, v173, v189
    v_mfma_f32_16x16x32_bf16 v[44:47], a[236:239], v[136:139], v[44:47]
    v_add_f32 v174, v174, v190
    v_add_f32 v175, v175, v191
    s_add_u32 s57, s57, 31744
    buffer_load_dwordx4 v12, s[20:23], s57 offen offset:3072 lds
    s_waitcnt vmcnt(10)
    v_mfma_f32_16x16x32_bf16 v[32:35], a[240:243], v[140:143], v[32:35]
    v_add_f32 v172, v172, v204
    v_mfma_f32_16x16x32_bf16 v[36:39], a[244:247], v[140:143], v[36:39]
    v_add_f32 v173, v173, v205
    v_mfma_f32_16x16x32_bf16 v[40:43], a[248:251], v[140:143], v[40:43]
    v_add_f32 v174, v174, v206
    v_mfma_f32_16x16x32_bf16 v[44:47], a[252:255], v[140:143], v[44:47]
    v_add_f32 v175, v175, v207
    buffer_store_dwordx4 v[96:99], v23, s[24:27], s83 offen sc1
    s_add_u32 m0, s52, 98304
    s_lshl_b32 s57, s76, 7
    s_add_u32 s57, s57, 131072
    buffer_load_dwordx4 v12, s[20:23], s57 offen offset:0 lds
    v_pk_add_f32 v[32:33], v[32:33], v[160:161]
    v_pk_add_f32 v[34:35], v[34:35], v[162:163]
    v_pk_add_f32 v[36:37], v[36:37], v[164:165]
    v_pk_add_f32 v[38:39], v[38:39], v[166:167]
    v_pk_mul_f32 v[48:49], v[32:33], v[32:33]
    v_pk_mul_f32 v[50:51], v[34:35], v[34:35]
    v_pk_mul_f32 v[52:53], v[36:37], v[36:37]
    v_pk_mul_f32 v[54:55], v[38:39], v[38:39]
    s_add_u32 s57, s57, 31744
    buffer_load_dwordx4 v12, s[20:23], s57 offen offset:1024 lds
    v_pk_fma_f32 v[48:49], v[48:49], v[236:237], v[236:237] op_sel:[0,0,1] op_sel_hi:[1,0,1]
    v_pk_fma_f32 v[50:51], v[50:51], v[236:237], v[236:237] op_sel:[0,0,1] op_sel_hi:[1,0,1]
    v_pk_fma_f32 v[52:53], v[52:53], v[236:237], v[236:237] op_sel:[0,0,1] op_sel_hi:[1,0,1]
    v_pk_fma_f32 v[54:55], v[54:55], v[236:237], v[236:237] op_sel:[0,0,1] op_sel_hi:[1,0,1]
    v_pk_mul_f32 v[48:49], v[48:49], v[32:33]
    v_pk_mul_f32 v[50:51], v[50:51], v[34:35]
    v_pk_mul_f32 v[52:53], v[52:53], v[36:37]
    v_pk_mul_f32 v[54:55], v[54:55], v[38:39]
    s_add_u32 s57, s57, 31744
    buffer_load_dwordx4 v12, s[20:23], s57 offen offset:2048 lds
    v_exp_f32 v48, v48
    v_exp_f32 v49, v49
    v_exp_f32 v50, v50
    v_exp_f32 v51, v51
    v_exp_f32 v52, v52
    v_exp_f32 v53, v53
    v_exp_f32 v54, v54
    v_exp_f32 v55, v55
    v_pk_add_f32 v[48:49], v[48:49], 1.0 op_sel_hi:[1,0]
    v_pk_add_f32 v[50:51], v[50:51], 1.0 op_sel_hi:[1,0]
    v_pk_add_f32 v[52:53], v[52:53], 1.0 op_sel_hi:[1,0]
    v_pk_add_f32 v[54:55], v[54:55], 1.0 op_sel_hi:[1,0]
    s_add_u32 s57, s57, 31744
    buffer_load_dwordx4 v12, s[20:23], s57 offen offset:3072 lds
    v_rcp_f32 v48, v48
    v_rcp_f32 v49, v49
    v_rcp_f32 v50, v50
    v_rcp_f32 v51, v51
    v_rcp_f32 v52, v52
    v_rcp_f32 v53, v53
    v_rcp_f32 v54, v54
    v_rcp_f32 v55, v55
    s_add_u32 m0, s52, 114688
    s_lshl_b32 s57, s77, 7
    buffer_load_dwordx4 v12, s[20:23], s57 offen offset:0 lds
    v_pk_mul_f32 v[48:49], v[48:49], v[32:33]
    v_pk_mul_f32 v[50:51], v[50:51], v[34:35]
    v_pk_mul_f32 v[52:53], v[52:53], v[36:37]
    v_pk_mul_f32 v[54:55], v[54:55], v[38:39]
    v_cvt_pk_bf16_f32 v56, v48, v49
    v_cvt_pk_bf16_f32 v57, v50, v51
    v_cvt_pk_bf16_f32 v58, v52, v53
    v_cvt_pk_bf16_f32 v59, v54, v55
    buffer_store_dwordx4 v[56:59], v23, s[24:27], s67 offen offset:0 sc1
    v_pk_add_f32 v[40:41], v[40:41], v[168:169]
    v_pk_add_f32 v[42:43], v[42:43], v[170:171]
    v_pk_add_f32 v[44:45], v[44:45], v[172:173]
    v_pk_add_f32 v[46:47], v[46:47], v[174:175]
    s_add_u32 s57, s57, 31744
    buffer_load_dwordx4 v12, s[20:23], s57 offen offset:1024 lds
    v_pk_mul_f32 v[48:49], v[40:41], v[40:41]
    v_pk_mul_f32 v[50:51], v[42:43], v[42:43]
    v_pk_mul_f32 v[52:53], v[44:45], v[44:45]
    v_pk_mul_f32 v[54:55], v[46:47], v[46:47]
    v_pk_fma_f32 v[48:49], v[48:49], v[236:237], v[236:237] op_sel:[0,0,1] op_sel_hi:[1,0,1]
    v_pk_fma_f32 v[50:51], v[50:51], v[236:237], v[236:237] op_sel:[0,0,1] op_sel_hi:[1,0,1]
    v_pk_fma_f32 v[52:53], v[52:53], v[236:237], v[236:237] op_sel:[0,0,1] op_sel_hi:[1,0,1]
    v_pk_fma_f32 v[54:55], v[54:55], v[236:237], v[236:237] op_sel:[0,0,1] op_sel_hi:[1,0,1]
    s_add_u32 s57, s57, 31744
    buffer_load_dwordx4 v12, s[20:23], s57 offen offset:2048 lds
    v_pk_mul_f32 v[48:49], v[48:49], v[40:41]
    v_pk_mul_f32 v[50:51], v[50:51], v[42:43]
    v_pk_mul_f32 v[52:53], v[52:53], v[44:45]
    v_pk_mul_f32 v[54:55], v[54:55], v[46:47]
    v_exp_f32 v48, v48
    v_exp_f32 v49, v49
    v_exp_f32 v50, v50
    v_exp_f32 v51, v51
    v_exp_f32 v52, v52
    v_exp_f32 v53, v53
    v_exp_f32 v54, v54
    v_exp_f32 v55, v55
    s_add_u32 s57, s57, 31744
    buffer_load_dwordx4 v12, s[20:23], s57 offen offset:3072 lds
    v_pk_add_f32 v[48:49], v[48:49], 1.0 op_sel_hi:[1,0]
    v_pk_add_f32 v[50:51], v[50:51], 1.0 op_sel_hi:[1,0]
    v_pk_add_f32 v[52:53], v[52:53], 1.0 op_sel_hi:[1,0]
    v_pk_add_f32 v[54:55], v[54:55], 1.0 op_sel_hi:[1,0]
    v_rcp_f32 v48, v48
    v_rcp_f32 v49, v49
    v_rcp_f32 v50, v50
    v_rcp_f32 v51, v51
    s_add_u32 m0, s52, 131072
    s_lshl_b32 s57, s77, 7
    s_add_u32 s57, s57, 131072
    buffer_load_dwordx4 v12, s[20:23], s57 offen offset:0 lds
    v_rcp_f32 v52, v52
    v_rcp_f32 v53, v53
    v_rcp_f32 v54, v54
    v_rcp_f32 v55, v55
    v_pk_mul_f32 v[48:49], v[48:49], v[40:41]
    v_pk_mul_f32 v[50:51], v[50:51], v[42:43]
    v_pk_mul_f32 v[52:53], v[52:53], v[44:45]
    v_pk_mul_f32 v[54:55], v[54:55], v[46:47]
    v_cvt_pk_bf16_f32 v60, v48, v49
    v_cvt_pk_bf16_f32 v61, v50, v51
    v_cvt_pk_bf16_f32 v62, v52, v53
    v_cvt_pk_bf16_f32 v63, v54, v55
    buffer_store_dwordx4 v[60:63], v23, s[24:27], s67 offen offset:1024 sc1
    s_add_u32 s57, s57, 31744
    buffer_load_dwordx4 v12, s[20:23], s57 offen offset:1024 lds
    s_waitcnt vmcnt(13)
    ds_read_b64_tr_b16 a[0:1], v6 offset:32768
    ds_read_b64_tr_b16 a[2:3], v6 offset:34816
    ds_read_b64_tr_b16 a[4:5], v7 offset:32768
    ds_read_b64_tr_b16 a[6:7], v7 offset:34816
    ds_read_b64_tr_b16 a[8:9], v6 offset:33024
    ds_read_b64_tr_b16 a[10:11], v6 offset:35072
    ds_read_b64_tr_b16 a[12:13], v7 offset:33024
    ds_read_b64_tr_b16 a[14:15], v7 offset:35072
    s_add_u32 s57, s57, 31744
    buffer_load_dwordx4 v12, s[20:23], s57 offen offset:2048 lds
    s_add_u32 s57, s57, 31744
    buffer_load_dwordx4 v12, s[20:23], s57 offen offset:3072 lds
    s_add_u32 m0, s52, 147456
    s_lshl_b32 s57, s78, 7
    buffer_load_dwordx4 v12, s[20:23], s57 offen offset:0 lds
    s_add_u32 s57, s57, 31744
    buffer_load_dwordx4 v12, s[20:23], s57 offen offset:1024 lds
    s_waitcnt vmcnt(12)
    ds_read_b64_tr_b16 a[16:17], v6 offset:49152
    ds_read_b64_tr_b16 a[18:19], v6 offset:51200
    ds_read_b64_tr_b16 a[20:21], v7 offset:49152
    ds_read_b64_tr_b16 a[22:23], v7 offset:51200
    s_add_u32 s57, s57, 31744
    buffer_load_dwordx4 v12, s[20:23], s57 offen offset:2048 lds
    ds_read_b64_tr_b16 a[24:25], v6 offset:49408
    ds_read_b64_tr_b16 a[26:27], v6 offset:51456
    ds_read_b64_tr_b16 a[28:29], v7 offset:49408
    ds_read_b64_tr_b16 a[30:31], v7 offset:51456
    s_add_u32 s57, s57, 31744
    buffer_load_dwordx4 v12, s[20:23], s57 offen offset:3072 lds
    s_add_u32 m0, s52, 49152
    s_lshl_b32 s57, s78, 7
    s_add_u32 s57, s57, 131072
    buffer_load_dwordx4 v12, s[20:23], s57 offen offset:0 lds
    s_add_u32 s57, s57, 31744
    buffer_load_dwordx4 v12, s[20:23], s57 offen offset:1024 lds
    s_waitcnt vmcnt(11)
    ds_read_b64_tr_b16 a[32:33], v8 offset:0
    ds_read_b64_tr_b16 a[34:35], v8 offset:2048
    ds_read_b64_tr_b16 a[36:37], v9 offset:0
    ds_read_b64_tr_b16 a[38:39], v9 offset:2048
    s_add_u32 s57, s57, 31744
    buffer_load_dwordx4 v12, s[20:23], s57 offen offset:2048 lds
    ds_read_b64_tr_b16 a[40:41], v8 offset:256
    ds_read_b64_tr_b16 a[42:43], v8 offset:2304
    ds_read_b64_tr_b16 a[44:45], v9 offset:256
    ds_read_b64_tr_b16 a[46:47], v9 offset:2304
    s_add_u32 s57, s57, 31744
    buffer_load_dwordx4 v12, s[20:23], s57 offen offset:3072 lds
    s_waitcnt vmcnt(11)
    s_barrier
    s_cmp_lg_u32 s44, 0
    s_cbranch_scc1 L_nopub6
    s_lshl_b32 s60, s51, 5
    s_add_u32 s60, s60, s50
    s_lshl_b32 s60, s60, 7
    s_add_u32 s60, s60, 12713984
    v_mov_b32 v30, s47
    s_mov_b64 exec, 1
    buffer_store_dword v30, off, s[24:27], s60 sc1
    s_mov_b64 exec, -1
L_nopub6:
L_p3join:
    v_lshlrev_b32 v224, 16, v224
    v_lshlrev_b32 v176, 16, v216
    v_and_b32 v177, s61, v216
    v_lshlrev_b32 v178, 16, v217
    v_and_b32 v179, s61, v217
    v_lshlrev_b32 v180, 16, v218
    v_and_b32 v181, s61, v218
    v_lshlrev_b32 v182, 16, v219
    v_and_b32 v183, s61, v219
    v_add_f32 v176, v176, v224
    v_add_f32 v177, v177, v224
    v_add_f32 v178, v178, v224
    s_add_u32 m0, s52, 65536
    s_lshl_b32 s57, s79, 7
    buffer_load_dwordx4 v12, s[20:23], s57 offen offset:0 lds
    v_add_f32 v179, v179, v224
    v_add_f32 v180, v180, v224
    v_add_f32 v181, v181, v224
    v_add_f32 v182, v182, v224
    v_add_f32 v183, v183, v224
    v_lshlrev_b32 v225, 16, v225
    v_lshlrev_b32 v184, 16, v220
    v_and_b32 v185, s61, v220
    v_lshlrev_b32 v186, 16, v221
    v_and_b32 v187, s61, v221
    v_lshlrev_b32 v188, 16, v222
    v_and_b32 v189, s61, v222
    v_lshlrev_b32 v190, 16, v223
    v_and_b32 v191, s61, v223
    v_add_f32 v184, v184, v225
    v_add_f32 v185, v185, v225
    s_add_u32 s57, s57, 31744
    buffer_load_dwordx4 v12, s[20:23], s57 offen offset:1024 lds
    s_waitcnt vmcnt(10)
    ds_read_b64_tr_b16 a[48:49], v8 offset:16384
    ds_read_b64_tr_b16 a[50:51], v8 offset:18432
    ds_read_b64_tr_b16 a[52:53], v9 offset:16384
    ds_read_b64_tr_b16 a[54:55], v9 offset:18432
    v_add_f32 v186, v186, v225
    v_add_f32 v187, v187, v225
    v_add_f32 v188, v188, v225
    v_add_f32 v189, v189, v225
    ds_read_b64_tr_b16 a[56:57], v8 offset:16640
    ds_read_b64_tr_b16 a[58:59], v8 offset:18688
    ds_read_b64_tr_b16 a[60:61], v9 offset:16640
    ds_read_b64_tr_b16 a[62:63], v9 offset:18688
    v_add_f32 v190, v190, v225
    v_add_f32 v191, v191, v225
    v_lshlrev_b32 v228, 16, v228
    v_lshlrev_b32 v232, 16, v226
    s_add_u32 s57, s57, 31744
    buffer_load_dwordx4 v12, s[20:23], s57 offen offset:2048 lds
    v_and_b32 v233, s61, v226
    v_lshlrev_b32 v234, 16, v227
    v_and_b32 v235, s61, v227
    v_add_f32 v232, v232, v228
    v_add_f32 v233, v233, v228
    v_add_f32 v234, v234, v228
    v_add_f32 v235, v235, v228
    s_add_u32 s57, s57, 31744
    buffer_load_dwordx4 v12, s[20:23], s57 offen offset:3072 lds
    s_waitcnt lgkmcnt(15)
    s_add_u32 m0, s52, 81920
    s_lshl_b32 s57, s79, 7
    s_add_u32 s57, s57, 131072
    buffer_load_dwordx4 v12, s[20:23], s57 offen offset:0 lds
    s_add_u32 s57, s57, 31744
    buffer_load_dwordx4 v12, s[20:23], s57 offen offset:1024 lds
    s_waitcnt vmcnt(10)
    ds_read_b64_tr_b16 a[64:65], v8 offset:32768
    ds_read_b64_tr_b16 a[66:67], v8 offset:34816
    ds_read_b64_tr_b16 a[68:69], v9 offset:32768
    ds_read_b64_tr_b16 a[70:71], v9 offset:34816
    s_add_u32 s57, s57, 31744
    buffer_load_dwordx4 v12, s[20:23], s57 offen offset:2048 lds
    ds_read_b64_tr_b16 a[72:73], v8 offset:33024
    ds_read_b64_tr_b16 a[74:75], v8 offset:35072
    ds_read_b64_tr_b16 a[76:77], v9 offset:33024
    ds_read_b64_tr_b16 a[78:79], v9 offset:35072
    s_add_u32 s57, s57, 31744
    buffer_load_dwordx4 v12, s[20:23], s57 offen offset:3072 lds
    s_add_u32 m0, s52, 98304
    s_lshl_b32 s57, s80, 7
    buffer_load_dwordx4 v12, s[20:23], s57 offen offset:0 lds
    s_add_u32 s57, s57, 31744
    buffer_load_dwordx4 v12, s[20:23], s57 offen offset:1024 lds
    s_waitcnt vmcnt(10)
    ds_read_b64_tr_b16 a[80:81], v6 offset:0
    ds_read_b64_tr_b16 a[82:83], v6 offset:2048
    ds_read_b64_tr_b16 a[84:85], v7 offset:0
    ds_read_b64_tr_b16 a[86:87], v7 offset:2048
    s_add_u32 s57, s57, 31744
    buffer_load_dwordx4 v12, s[20:23], s57 offen offset:2048 lds
    ds_read_b64_tr_b16 a[88:89], v6 offset:256
    ds_read_b64_tr_b16 a[90:91], v6 offset:2304
    ds_read_b64_tr_b16 a[92:93], v7 offset:256
    ds_read_b64_tr_b16 a[94:95], v7 offset:2304
    s_add_u32 s57, s57, 31744
    buffer_load_dwordx4 v12, s[20:23], s57 offen offset:3072 lds
    s_waitcnt lgkmcnt(15)
    s_add_u32 m0, s52, 114688
    s_lshl_b32 s57, s80, 7
    s_add_u32 s57, s57, 131072
    buffer_load_dwordx4 v12, s[20:23], s57 offen offset:0 lds
    s_add_u32 s57, s57, 31744
    buffer_load_dwordx4 v12, s[20:23], s57 offen offset:1024 lds
    s_waitcnt vmcnt(10)
    ds_read_b64_tr_b16 a[96:97], v6 offset:16384
    ds_read_b64_tr_b16 a[98:99], v6 offset:18432
    ds_read_b64_tr_b16 a[100:101], v7 offset:16384
    ds_read_b64_tr_b16 a[102:103], v7 offset:18432
    s_add_u32 s57, s57, 31744
    buffer_load_dwordx4 v12, s[20:23], s57 offen offset:2048 lds
    ds_read_b64_tr_b16 a[104:105], v6 offset:16640
    ds_read_b64_tr_b16 a[106:107], v6 offset:18688
    ds_read_b64_tr_b16 a[108:109], v7 offset:16640
    ds_read_b64_tr_b16 a[110:111], v7 offset:18688
    s_add_u32 s57, s57, 31744
    buffer_load_dwordx4 v12, s[20:23], s57 offen offset:3072 lds
    s_add_u32 m0, s52, 131072
    s_lshl_b32 s57, s81, 7
    buffer_load_dwordx4 v12, s[20:23], s57 offen offset:0 lds
    s_add_u32 s57, s57, 31744
    buffer_load_dwordx4 v12, s[20:23], s57 offen offset:1024 lds
    s_waitcnt vmcnt(10)
    ds_read_b64_tr_b16 a[112:113], v6 offset:32768
    ds_read_b64_tr_b16 a[114:115], v6 offset:34816
    ds_read_b64_tr_b16 a[116:117], v7 offset:32768
    ds_read_b64_tr_b16 a[118:119], v7 offset:34816
    s_add_u32 s57, s57, 31744
    buffer_load_dwordx4 v12, s[20:23], s57 offen offset:2048 lds
    ds_read_b64_tr_b16 a[120:121], v6 offset:33024
    ds_read_b64_tr_b16 a[122:123], v6 offset:35072
    ds_read_b64_tr_b16 a[124:125], v7 offset:33024
    ds_read_b64_tr_b16 a[126:127], v7 offset:35072
    s_add_u32 s57, s57, 31744
    buffer_load_dwordx4 v12, s[20:23], s57 offen offset:3072 lds
    s_waitcnt lgkmcnt(15)
    s_add_u32 m0, s52, 147456
    s_lshl_b32 s57, s81, 7
    s_add_u32 s57, s57, 131072
    buffer_load_dwordx4 v12, s[20:23], s57 offen offset:0 lds
    s_add_u32 s57, s57, 31744
    buffer_load_dwordx4 v12, s[20:23], s57 offen offset:1024 lds
    s_waitcnt vmcnt(10)
    ds_read_b64_tr_b16 a[128:129], v6 offset:49152
    ds_read_b64_tr_b16 a[130:131], v6 offset:51200
    ds_read_b64_tr_b16 a[132:133], v7 offset:49152
    ds_read_b64_tr_b16 a[134:135], v7 offset:51200
    s_add_u32 s57, s57, 31744
    buffer_load_dwordx4 v12, s[20:23], s57 offen offset:2048 lds
    ds_read_b64_tr_b16 a[136:137], v6 offset:49408
    ds_read_b64_tr_b16 a[138:139], v6 offset:51456
    ds_read_b64_tr_b16 a[140:141], v7 offset:49408
    ds_read_b64_tr_b16 a[142:143], v7 offset:51456
    s_add_u32 s57, s57, 31744
    buffer_load_dwordx4 v12, s[20:23], s57 offen offset:3072 lds
    s_add_u32 m0, s52, 49152
    s_lshl_b32 s57, s82, 7
    buffer_load_dwordx4 v12, s[20:23], s57 offen offset:0 lds
    s_add_u32 s57, s57, 31744
    buffer_load_dwordx4 v12, s[20:23], s57 offen offset:1024 lds
    s_waitcnt vmcnt(10)
    ds_read_b64_tr_b16 a[144:145], v8 offset:0
    ds_read_b64_tr_b16 a[146:147], v8 offset:2048
    ds_read_b64_tr_b16 a[148:149], v9 offset:0
    ds_read_b64_tr_b16 a[150:151], v9 offset:2048
    s_add_u32 s57, s57, 31744
    buffer_load_dwordx4 v12, s[20:23], s57 offen offset:2048 lds
    ds_read_b64_tr_b16 a[152:153], v8 offset:256
    ds_read_b64_tr_b16 a[154:155], v8 offset:2304
    ds_read_b64_tr_b16 a[156:157], v9 offset:256
    ds_read_b64_tr_b16 a[158:159], v9 offset:2304
    s_add_u32 s57, s57, 31744
    buffer_load_dwordx4 v12, s[20:23], s57 offen offset:3072 lds
    s_waitcnt lgkmcnt(15)
    s_add_u32 m0, s52, 65536
    s_lshl_b32 s57, s82, 7
    s_add_u32 s57, s57, 131072
    buffer_load_dwordx4 v12, s[20:23], s57 offen offset:0 lds
    s_add_u32 s57, s57, 31744
    buffer_load_dwordx4 v12, s[20:23], s57 offen offset:1024 lds
    s_waitcnt vmcnt(10)
    ds_read_b64_tr_b16 a[160:161], v8 offset:16384
    ds_read_b64_tr_b16 a[162:163], v8 offset:18432
    ds_read_b64_tr_b16 a[164:165], v9 offset:16384
    ds_read_b64_tr_b16 a[166:167], v9 offset:18432
    s_add_u32 s57, s57, 31744
    buffer_load_dwordx4 v12, s[20:23], s57 offen offset:2048 lds
    ds_read_b64_tr_b16 a[168:169], v8 offset:16640
    ds_read_b64_tr_b16 a[170:171], v8 offset:18688
    ds_read_b64_tr_b16 a[172:173], v9 offset:16640
    ds_read_b64_tr_b16 a[174:175], v9 offset:18688
    s_add_u32 s57, s57, 31744
    buffer_load_dwordx4 v12, s[20:23], s57 offen offset:3072 lds
    s_add_u32 m0, s52, 81920
    s_mov_b32 s57, s75
    buffer_load_dwordx4 v15, s[12:15], s57 offen offset:0 lds
    s_add_u32 s57, s57, 24064
    buffer_load_dwordx4 v15, s[12:15], s57 offen offset:1024 lds
    s_waitcnt vmcnt(10)
    ds_read_b64_tr_b16 a[176:177], v8 offset:32768
    ds_read_b64_tr_b16 a[178:179], v8 offset:34816
    ds_read_b64_tr_b16 a[180:181], v9 offset:32768
    ds_read_b64_tr_b16 a[182:183], v9 offset:34816
    s_add_u32 s57, s57, 24064
    buffer_load_dwordx4 v15, s[12:15], s57 offen offset:2048 lds
    ds_read_b64_tr_b16 a[184:185], v8 offset:33024
    ds_read_b64_tr_b16 a[186:187], v8 offset:35072
    ds_read_b64_tr_b16 a[188:189], v9 offset:33024
    ds_read_b64_tr_b16 a[190:191], v9 offset:35072
    s_add_u32 s57, s57, 24064
    buffer_load_dwordx4 v15, s[12:15], s57 offen offset:3072 lds
    s_waitcnt lgkmcnt(15)
    s_add_u32 m0, s52, 98304
    s_mov_b32 s57, 0
    buffer_load_dwordx4 v13, s[12:15], s57 offen offset:0 lds
    s_add_u32 s57, s57, 6144
    buffer_load_dwordx4 v14, s[12:15], s57 offen offset:1024 lds
    s_waitcnt vmcnt(10)
    ds_read_b64_tr_b16 a[192:193], v6 offset:0
    ds_read_b64_tr_b16 a[194:195], v6 offset:2048
    ds_read_b64_tr_b16 a[196:197], v7 offset:0
    ds_read_b64_tr_b16 a[198:199], v7 offset:2048
    s_add_u32 s57, s57, 6144
    buffer_load_dwordx4 v13, s[12:15], s57 offen offset:2048 lds
    ds_read_b64_tr_b16 a[200:201], v6 offset:256
    ds_read_b64_tr_b16 a[202:203], v6 offset:2304
    ds_read_b64_tr_b16 a[204:205], v7 offset:256
    ds_read_b64_tr_b16 a[206:207], v7 offset:2304
    s_add_u32 s57, s57, 6144
    buffer_load_dwordx4 v14, s[12:15], s57 offen offset:3072 lds
    s_add_u32 m0, s52, 114688
    s_mov_b32 s57, 25088
    buffer_load_dwordx4 v13, s[12:15], s57 offen offset:0 lds
    s_add_u32 s57, s57, 6144
    buffer_load_dwordx4 v14, s[12:15], s57 offen offset:1024 lds
    s_waitcnt vmcnt(10)
    ds_read_b64_tr_b16 a[208:209], v6 offset:16384
    ds_read_b64_tr_b16 a[210:211], v6 offset:18432
    ds_read_b64_tr_b16 a[212:213], v7 offset:16384
    ds_read_b64_tr_b16 a[214:215], v7 offset:18432
    buffer_load_dword v17, v20, s[24:27], 0 offen sc1
    ds_read_b64_tr_b16 a[216:217], v6 offset:16640
    ds_read_b64_tr_b16 a[218:219], v6 offset:18688
    ds_read_b64_tr_b16 a[220:221], v7 offset:16640
    ds_read_b64_tr_b16 a[222:223], v7 offset:18688
    s_add_u32 s57, s57, 6144
    buffer_load_dwordx4 v13, s[12:15], s57 offen offset:2048 lds
    s_add_u32 s57, s57, 6144
    buffer_load_dwordx4 v14, s[12:15], s57 offen offset:3072 lds
    s_waitcnt lgkmcnt(15)
    s_add_u32 m0, s52, 131072
    s_mov_b32 s57, 50176
    buffer_load_dwordx4 v13, s[12:15], s57 offen offset:0 lds
    s_waitcnt vmcnt(10)
    v_add_u32 v16, 81920, v16
    ds_read_b64_tr_b16 v[192:193], v16 offset:0
    ds_read_b64_tr_b16 v[194:195], v16 offset:128
    ds_read_b64_tr_b16 v[196:197], v16 offset:1024
    ds_read_b64_tr_b16 v[198:199], v16 offset:1152
    ds_read_b64_tr_b16 v[200:201], v16 offset:2048
    ds_read_b64_tr_b16 v[202:203], v16 offset:2176
    ds_read_b64_tr_b16 v[204:205], v16 offset:3072
    ds_read_b64_tr_b16 v[206:207], v16 offset:3200
    s_add_u32 s57, s57, 6144
    buffer_load_dwordx4 v14, s[12:15], s57 offen offset:1024 lds
    s_add_u32 s57, s57, 6144
    buffer_load_dwordx4 v13, s[12:15], s57 offen offset:2048 lds
    s_add_u32 s57, s57, 6144
    buffer_load_dwordx4 v14, s[12:15], s57 offen offset:3072 lds
    s_add_u32 m0, s52, 147456
    s_mov_b32 s57, 75264
    buffer_load_dwordx4 v13, s[12:15], s57 offen offset:0 lds
    s_waitcnt vmcnt(10)
    ds_read_b64_tr_b16 a[224:225], v2 offset:49152
    ds_read_b64_tr_b16 a[226:227], v2 offset:49664
    ds_read_b64_tr_b16 a[228:229], v3 offset:49152
    ds_read_b64_tr_b16 a[230:231], v3 offset:49664
    s_add_u32 s57, s57, 6144
    buffer_load_dwordx4 v14, s[12:15], s57 offen offset:1024 lds
    ds_read_b64_tr_b16 a[232:233], v2 offset:49408
    ds_read_b64_tr_b16 a[234:235], v2 offset:49920
    ds_read_b64_tr_b16 a[236:237], v3 offset:49408
    ds_read_b64_tr_b16 a[238:239], v3 offset:49920
    s_add_u32 s57, s57, 6144
    buffer_load_dwordx4 v13, s[12:15], s57 offen offset:2048 lds
    s_add_u32 s57, s57, 6144
    buffer_load_dwordx4 v14, s[12:15], s57 offen offset:3072 lds
    s_waitcnt vmcnt(10)
    v_cmp_ne_u32 vcc, s47, v17
    s_nop 0
    s_cbranch_vccz L_ok8
    s_mov_b32 s59, 20000
L_spin7:
    buffer_load_dword v17, v20, s[24:27], 0 offen sc1
    s_waitcnt vmcnt(0)
    v_cmp_ne_u32 vcc, s47, v17
    s_nop 0
    s_cbranch_vccz L_ok8
    s_sub_u32 s59, s59, 1
    s_cbranch_scc0 L_spin7
L_ok8:
    s_mov_b32 s66, s68
    s_add_u32 s58, s66, s76
    buffer_load_dwordx4 v[144:147], v23, s[24:27], s58 offen offset:0 sc1
    buffer_load_dwordx4 v[148:151], v23, s[24:27], s58 offen offset:1024 sc1
    s_waitcnt vmcnt(10)
    ds_read_b64_tr_b16 a[240:241], v4 offset:0
    ds_read_b64_tr_b16 a[242:243], v4 offset:512
    ds_read_b64_tr_b16 a[244:245], v5 offset:0
    ds_read_b64_tr_b16 a[246:247], v5 offset:512
    s_add_u32 s58, s66, s77
    buffer_load_dwordx4 v[152:155], v23, s[24:27], s58 offen offset:0 sc1
    ds_read_b64_tr_b16 a[248:249], v4 offset:256
    ds_read_b64_tr_b16 a[250:251], v4 offset:768
    ds_read_b64_tr_b16 a[252:253], v5 offset:256
    ds_read_b64_tr_b16 a[254:255], v5 offset:768
    buffer_load_dwordx4 v[156:159], v23, s[24:27], s58 offen offset:1024 sc1
    s_add_u32 s58, s66, s78
    buffer_load_dwordx4 v[112:115], v23, s[24:27], s58 offen offset:0 sc1
    buffer_load_dwordx4 v[116:119], v23, s[24:27], s58 offen offset:1024 sc1
    s_add_u32 s58, s66, s79
    buffer_load_dwordx4 v[120:123], v23, s[24:27], s58 offen offset:0 sc1
    buffer_load_dwordx4 v[124:127], v23, s[24:27], s58 offen offset:1024 sc1
    s_add_u32 s58, s66, s80
    buffer_load_dwordx4 v[128:131], v23, s[24:27], s58 offen offset:0 sc1
    buffer_load_dwordx4 v[132:135], v23, s[24:27], s58 offen offset:1024 sc1
    s_waitcnt vmcnt(9)
    v_mfma_f32_16x16x32_bf16 v[96:99], v[144:147], a[0:3], 0
    s_add_u32 s58, s66, s81
    v_mfma_f32_16x16x32_bf16 v[100:103], v[144:147], a[4:7], 0
    buffer_load_dwordx4 v[136:139], v23, s[24:27], s58 offen offset:0 sc1
    v_mfma_f32_16x16x32_bf16 v[104:107], v[144:147], a[8:11], 0
    v_mfma_f32_16x16x32_bf16 v[108:111], v[144:147], a[12:15], 0
    s_waitcnt vmcnt(9)
    v_mfma_f32_16x16x32_bf16 v[96:99], v[148:151], a[16:19], v[96:99]
    buffer_load_dwordx4 v[140:143], v23, s[24:27], s58 offen offset:1024 sc1
    v_mfma_f32_16x16x32_bf16 v[100:103], v[148:151], a[20:23], v[100:103]
    v_mfma_f32_16x16x32_bf16 v[104:107], v[148:151], a[24:27], v[104:107]
    v_mfma_f32_16x16x32_bf16 v[108:111], v[148:151], a[28:31], v[108:111]
    s_waitcnt vmcnt(9)
    v_mfma_f32_16x16x32_bf16 v[96:99], v[152:155], a[32:35], v[96:99]
    s_add_u32 s58, s66, s82
    v_mfma_f32_16x16x32_bf16 v[100:103], v[152:155], a[36:39], v[100:103]
    buffer_load_dwordx4 v[144:147], v23, s[24:27], s58 offen offset:0 sc1
    v_mfma_f32_16x16x32_bf16 v[104:107], v[152:155], a[40:43], v[104:107]
    v_mfma_f32_16x16x32_bf16 v[108:111], v[152:155], a[44:47], v[108:111]
    s_waitcnt vmcnt(9)
    v_mfma_f32_16x16x32_bf16 v[96:99], v[156:159], a[48:51], v[96:99]
    buffer_load_dwordx4 v[148:151], v23, s[24:27], s58 offen offset:1024 sc1
    v_mfma_f32_16x16x32_bf16 v[100:103], v[156:159], a[52:55], v[100:103]
    v_mfma_f32_16x16x32_bf16 v[104:107], v[156:159], a[56:59], v[104:107]
    v_mfma_f32_16x16x32_bf16 v[108:111], v[156:159], a[60:63], v[108:111]
    s_waitcnt vmcnt(9)
    v_mfma_f32_16x16x32_bf16 v[96:99], v[112:115], a[64:67], v[96:99]
    s_xor_b32 s66, s44, 3
    s_lshl2_add_u32 s66, s49, s66
    v_mfma_f32_16x16x32_bf16 v[100:103], v[112:115], a[68:71], v[100:103]
    s_mul_i32 s66, s66, 58624
    s_add_u32 s66, s66, s69
    v_mfma_f32_16x16x32_bf16 v[104:107], v[112:115], a[72:75], v[104:107]
    s_add_u32 s58, s66, s76
    buffer_load_dwordx4 v[152:155], v23, s[24:27], s58 offen offset:0 sc1
    v_mfma_f32_16x16x32_bf16 v[108:111], v[112:115], a[76:79], v[108:111]
    s_waitcnt vmcnt(9)
    v_mfma_f32_16x16x32_bf16 v[96:99], v[116:119], a[80:83], v[96:99]
    buffer_load_dwordx4 v[156:159], v23, s[24:27], s58 offen offset:1024 sc1
    v_mfma_f32_16x16x32_bf16 v[100:103], v[116:119], a[84:87], v[100:103]
    v_mfma_f32_16x16x32_bf16 v[104:107], v[116:119], a[88:91], v[104:107]
    v_mfma_f32_16x16x32_bf16 v[108:111], v[116:119], a[92:95], v[108:111]
    s_waitcnt vmcnt(9)
    v_mfma_f32_16x16x32_bf16 v[96:99], v[120:123], a[96:99], v[96:99]
    s_add_u32 s58, s66, s77
    v_mfma_f32_16x16x32_bf16 v[100:103], v[120:123], a[100:103], v[100:103]
    buffer_load_dwordx4 v[112:115], v23, s[24:27], s58 offen offset:0 sc1
    v_mfma_f32_16x16x32_bf16 v[104:107], v[120:123], a[104:107], v[104:107]
    v_mfma_f32_16x16x32_bf16 v[108:111], v[120:123], a[108:111], v[108:111]
    s_waitcnt vmcnt(9)
    v_mfma_f32_16x16x32_bf16 v[96:99], v[124:127], a[112:115], v[96:99]
    buffer_load_dwordx4 v[116:119], v23, s[24:27], s58 offen offset:1024 sc1
    v_mfma_f32_16x16x32_bf16 v[100:103], v[124:127], a[116:119], v[100:103]
    v_mfma_f32_16x16x32_bf16 v[104:107], v[124:127], a[120:123], v[104:107]
    v_mfma_f32_16x16x32_bf16 v[108:111], v[124:127], a[124:127], v[108:111]
    s_waitcnt vmcnt(9)
    v_mfma_f32_16x16x32_bf16 v[96:99], v[128:131], a[128:131], v[96:99]
    s_add_u32 s58, s66, s78
    v_mfma_f32_16x16x32_bf16 v[100:103], v[128:131], a[132:135], v[100:103]
    buffer_load_dwordx4 v[120:123], v23, s[24:27], s58 offen offset:0 sc1
    v_mfma_f32_16x16x32_bf16 v[104:107], v[128:131], a[136:139], v[104:107]
    v_mfma_f32_16x16x32_bf16 v[108:111], v[128:131], a[140:143], v[108:111]
    s_waitcnt vmcnt(9)
    v_mfma_f32_16x16x32_bf16 v[96:99], v[132:135], a[144:147], v[96:99]
    buffer_load_dwordx4 v[124:127], v23, s[24:27], s58 offen offset:1024 sc1
    v_mfma_f32_16x16x32_bf16 v[100:103], v[132:135], a[148:151], v[100:103]
    v_mfma_f32_16x16x32_bf16 v[104:107], v[132:135], a[152:155], v[104:107]
    v_mfma_f32_16x16x32_bf16 v[108:111], v[132:135], a[156:159], v[108:111]
    s_waitcnt vmcnt(9)
    v_mfma_f32_16x16x32_bf16 v[96:99], v[136:139], a[160:163], v[96:99]
    s_add_u32 s58, s66, s79
    v_mfma_f32_16x16x32_bf16 v[100:103], v[136:139], a[164:167], v[100:103]
    buffer_load_dwordx4 v[128:131], v23, s[24:27], s58 offen offset:0 sc1
    v_mfma_f32_16x16x32_bf16 v[104:107], v[136:139], a[168:171], v[104:107]
    v_mfma_f32_16x16x32_bf16 v[108:111], v[136:139], a[172:175], v[108:111]
    s_waitcnt vmcnt(9)
    v_mfma_f32_16x16x32_bf16 v[96:99], v[140:143], a[176:179], v[96:99]
    buffer_load_dwordx4 v[132:135], v23, s[24:27], s58 offen offset:1024 sc1
    v_mfma_f32_16x16x32_bf16 v[100:103], v[140:143], a[180:183], v[100:103]
    v_mfma_f32_16x16x32_bf16 v[104:107], v[140:143], a[184:187], v[104:107]
    v_mfma_f32_16x16x32_bf16 v[108:111], v[140:143], a[188:191], v[108:111]
    s_waitcnt vmcnt(9)
    s_waitcnt lgkmcnt(15)
    v_mfma_f32_16x16x32_bf16 v[96:99], v[144:147], a[192:195], v[96:99]
    s_add_u32 s58, s66, s80
    v_mfma_f32_16x16x32_bf16 v[100:103], v[144:147], a[196:199], v[100:103]
    buffer_load_dwordx4 v[136:139], v23, s[24:27], s58 offen offset:0 sc1
    v_mfma_f32_16x16x32_bf16 v[104:107], v[144:147], a[200:203], v[104:107]
    v_mfma_f32_16x16x32_bf16 v[108:111], v[144:147], a[204:207], v[108:111]
    s_waitcnt vmcnt(9)
    v_mfma_f32_16x16x32_bf16 v[96:99], v[148:151], a[208:211], v[96:99]
    buffer_load_dwordx4 v[140:143], v23, s[24:27], s58 offen offset:1024 sc1
    v_mfma_f32_16x16x32_bf16 v[100:103], v[148:151], a[212:215], v[100:103]
    v_mfma_f32_16x16x32_bf16 v[104:107], v[148:151], a[216:219], v[104:107]
    v_mfma_f32_16x16x32_bf16 v[108:111], v[148:151], a[220:223], v[108:111]
    s_waitcnt vmcnt(9)
    v_mfma_f32_16x16x32_bf16 v[80:83], v[152:155], a[0:3], 0
    s_add_u32 s58, s66, s81
    v_mfma_f32_16x16x32_bf16 v[84:87], v[152:155], a[4:7], 0
    buffer_load_dwordx4 v[144:147], v23, s[24:27], s58 offen offset:0 sc1
    v_mfma_f32_16x16x32_bf16 v[88:91], v[152:155], a[8:11], 0
    v_mfma_f32_16x16x32_bf16 v[92:95], v[152:155], a[12:15], 0
    s_waitcnt vmcnt(9)
    v_mfma_f32_16x16x32_bf16 v[80:83], v[156:159], a[16:19], v[80:83]
    buffer_load_dwordx4 v[148:151], v23, s[24:27], s58 offen offset:1024 sc1
    v_mfma_f32_16x16x32_bf16 v[84:87], v[156:159], a[20:23], v[84:87]
    v_mfma_f32_16x16x32_bf16 v[88:91], v[156:159], a[24:27], v[88:91]
    v_mfma_f32_16x16x32_bf16 v[92:95], v[156:159], a[28:31], v[92:95]
    s_waitcnt vmcnt(9)
    v_mfma_f32_16x16x32_bf16 v[80:83], v[112:115], a[32:35], v[80:83]
    s_add_u32 s58, s66, s82
    v_mfma_f32_16x16x32_bf16 v[84:87], v[112:115], a[36:39], v[84:87]
    buffer_load_dwordx4 v[152:155], v23, s[24:27], s58 offen offset:0 sc1
    v_mfma_f32_16x16x32_bf16 v[88:91], v[112:115], a[40:43], v[88:91]
    v_mfma_f32_16x16x32_bf16 v[92:95], v[112:115], a[44:47], v[92:95]
    s_waitcnt vmcnt(9)
    v_mfma_f32_16x16x32_bf16 v[80:83], v[116:119], a[48:51], v[80:83]
    buffer_load_dwordx4 v[156:159], v23, s[24:27], s58 offen offset:1024 sc1
    v_mfma_f32_16x16x32_bf16 v[84:87], v[116:119], a[52:55], v[84:87]
    v_mfma_f32_16x16x32_bf16 v[88:91], v[116:119], a[56:59], v[88:91]
    v_mfma_f32_16x16x32_bf16 v[92:95], v[116:119], a[60:63], v[92:95]
    s_waitcnt vmcnt(9)
    v_mfma_f32_16x16x32_bf16 v[80:83], v[120:123], a[64:67], v[80:83]
    s_xor_b32 s66, s44, 2
    s_lshl2_add_u32 s66, s49, s66
    v_mfma_f32_16x16x32_bf16 v[84:87], v[120:123], a[68:71], v[84:87]
    s_mul_i32 s66, s66, 58624
    s_add_u32 s66, s66, s69
    v_mfma_f32_16x16x32_bf16 v[88:91], v[120:123], a[72:75], v[88:91]
    s_add_u32 s58, s66, s76
    buffer_load_dwordx4 v[112:115], v23, s[24:27], s58 offen offset:0 sc1
    v_mfma_f32_16x16x32_bf16 v[92:95], v[120:123], a[76:79], v[92:95]
    s_waitcnt vmcnt(9)
    v_mfma_f32_16x16x32_bf16 v[80:83], v[124:127], a[80:83], v[80:83]
    buffer_load_dwordx4 v[116:119], v23, s[24:27], s58 offen offset:1024 sc1
    v_mfma_f32_16x16x32_bf16 v[84:87], v[124:127], a[84:87], v[84:87]
    v_mfma_f32_16x16x32_bf16 v[88:91], v[124:127], a[88:91], v[88:91]
    v_mfma_f32_16x16x32_bf16 v[92:95], v[124:127], a[92:95], v[92:95]
    s_waitcnt vmcnt(9)
    v_mfma_f32_16x16x32_bf16 v[80:83], v[128:131], a[96:99], v[80:83]
    s_add_u32 s58, s66, s77
    v_mfma_f32_16x16x32_bf16 v[84:87], v[128:131], a[100:103], v[84:87]
    buffer_load_dwordx4 v[120:123], v23, s[24:27], s58 offen offset:0 sc1
    v_mfma_f32_16x16x32_bf16 v[88:91], v[128:131], a[104:107], v[88:91]
    v_mfma_f32_16x16x32_bf16 v[92:95], v[128:131], a[108:111], v[92:95]
    s_waitcnt vmcnt(9)
    v_mfma_f32_16x16x32_bf16 v[80:83], v[132:135], a[112:115], v[80:83]
    buffer_load_dwordx4 v[124:127], v23, s[24:27], s58 offen offset:1024 sc1
    v_mfma_f32_16x16x32_bf16 v[84:87], v[132:135], a[116:119], v[84:87]
    v_mfma_f32_16x16x32_bf16 v[88:91], v[132:135], a[120:123], v[88:91]
    v_mfma_f32_16x16x32_bf16 v[92:95], v[132:135], a[124:127], v[92:95]
    buffer_load_dword v19, v21, s[24:27], 0 offen sc1
    s_waitcnt vmcnt(10)
    v_mfma_f32_16x16x32_bf16 v[80:83], v[136:139], a[128:131], v[80:83]
    v_mfma_f32_16x16x32_bf16 v[84:87], v[136:139], a[132:135], v[84:87]
    v_mfma_f32_16x16x32_bf16 v[88:91], v[136:139], a[136:139], v[88:91]
    v_mfma_f32_16x16x32_bf16 v[92:95], v[136:139], a[140:143], v[92:95]
    s_waitcnt vmcnt(9)
    v_mfma_f32_16x16x32_bf16 v[80:83], v[140:143], a[144:147], v[80:83]
    s_add_u32 s58, s66, s78
    v_mfma_f32_16x16x32_bf16 v[84:87], v[140:143], a[148:151], v[84:87]
    buffer_load_dwordx4 v[128:131], v23, s[24:27], s58 offen offset:0 sc1
    v_mfma_f32_16x16x32_bf16 v[88:91], v[140:143], a[152:155], v[88:91]
    v_mfma_f32_16x16x32_bf16 v[92:95], v[140:143], a[156:159], v[92:95]
    s_waitcnt vmcnt(9)
    v_mfma_f32_16x16x32_bf16 v[80:83], v[144:147], a[160:163], v[80:83]
    buffer_load_dwordx4 v[132:135], v23, s[24:27], s58 offen offset:1024 sc1
    v_mfma_f32_16x16x32_bf16 v[84:87], v[144:147], a[164:167], v[84:87]
    v_mfma_f32_16x16x32_bf16 v[88:91], v[144:147], a[168:171], v[88:91]
    v_mfma_f32_16x16x32_bf16 v[92:95], v[144:147], a[172:175], v[92:95]
    s_waitcnt vmcnt(9)
    v_mfma_f32_16x16x32_bf16 v[80:83], v[148:151], a[176:179], v[80:83]
    s_add_u32 s58, s66, s79
    v_mfma_f32_16x16x32_bf16 v[84:87], v[148:151], a[180:183], v[84:87]
    buffer_load_dwordx4 v[136:139], v23, s[24:27], s58 offen offset:0 sc1
    v_mfma_f32_16x16x32_bf16 v[88:91], v[148:151], a[184:187], v[88:91]
    v_mfma_f32_16x16x32_bf16 v[92:95], v[148:151], a[188:191], v[92:95]
    s_waitcnt vmcnt(9)
    v_mfma_f32_16x16x32_bf16 v[80:83], v[152:155], a[192:195], v[80:83]
    buffer_load_dwordx4 v[140:143], v23, s[24:27], s58 offen offset:1024 sc1
    v_mfma_f32_16x16x32_bf16 v[84:87], v[152:155], a[196:199], v[84:87]
    v_mfma_f32_16x16x32_bf16 v[88:91], v[152:155], a[200:203], v[88:91]
    v_mfma_f32_16x16x32_bf16 v[92:95], v[152:155], a[204:207], v[92:95]
    s_waitcnt vmcnt(9)
    v_mfma_f32_16x16x32_bf16 v[80:83], v[156:159], a[208:211], v[80:83]
    s_add_u32 s58, s66, s80
    v_mfma_f32_16x16x32_bf16 v[84:87], v[156:159], a[212:215], v[84:87]
    buffer_load_dwordx4 v[144:147], v23, s[24:27], s58 offen offset:0 sc1
    v_mfma_f32_16x16x32_bf16 v[88:91], v[156:159], a[216:219], v[88:91]
    v_mfma_f32_16x16x32_bf16 v[92:95], v[156:159], a[220:223], v[92:95]
    s_waitcnt vmcnt(9)
    v_mfma_f32_16x16x32_bf16 v[64:67], v[112:115], a[0:3], 0
    buffer_load_dwordx4 v[148:151], v23, s[24:27], s58 offen offset:1024 sc1
    v_mfma_f32_16x16x32_bf16 v[68:71], v[112:115], a[4:7], 0
    v_mfma_f32_16x16x32_bf16 v[72:75], v[112:115], a[8:11], 0
    v_mfma_f32_16x16x32_bf16 v[76:79], v[112:115], a[12:15], 0
    s_waitcnt vmcnt(9)
    v_mfma_f32_16x16x32_bf16 v[64:67], v[116:119], a[16:19], v[64:67]
    s_add_u32 s58, s66, s81
    v_mfma_f32_16x16x32_bf16 v[68:71], v[116:119], a[20:23], v[68:71]
    buffer_load_dwordx4 v[152:155], v23, s[24:27], s58 offen offset:0 sc1
    v_mfma_f32_16x16x32_bf16 v[72:75], v[116:119], a[24:27], v[72:75]
    v_mfma_f32_16x16x32_bf16 v[76:79], v[116:119], a[28:31], v[76:79]
    s_waitcnt vmcnt(9)
    v_mfma_f32_16x16x32_bf16 v[64:67], v[120:123], a[32:35], v[64:67]
    buffer_load_dwordx4 v[156:159], v23, s[24:27], s58 offen offset:1024 sc1
    v_mfma_f32_16x16x32_bf16 v[68:71], v[120:123], a[36:39], v[68:71]
    v_mfma_f32_16x16x32_bf16 v[72:75], v[120:123], a[40:43], v[72:75]
    v_mfma_f32_16x16x32_bf16 v[76:79], v[120:123], a[44:47], v[76:79]
    s_waitcnt vmcnt(9)
    v_mfma_f32_16x16x32_bf16 v[64:67], v[124:127], a[48:51], v[64:67]
    s_add_u32 s58, s66, s82
    v_mfma_f32_16x16x32_bf16 v[68:71], v[124:127], a[52:55], v[68:71]
    buffer_load_dwordx4 v[112:115], v23, s[24:27], s58 offen offset:0 sc1
    v_mfma_f32_16x16x32_bf16 v[72:75], v[124:127], a[56:59], v[72:75]
    v_mfma_f32_16x16x32_bf16 v[76:79], v[124:127], a[60:63], v[76:79]
    buffer_load_dwordx4 v[116:119], v23, s[24:27], s58 offen offset:1024 sc1
    s_waitcnt vmcnt(10)
    v_cmp_ne_u32 vcc, s47, v19
    s_nop 0
    s_cbranch_vccz L_ok10
    s_mov_b32 s59, 20000
L_spin9:
    buffer_load_dword v19, v21, s[24:27], 0 offen sc1
    s_waitcnt vmcnt(0)
    v_cmp_ne_u32 vcc, s47, v19
    s_nop 0
    s_cbranch_vccz L_ok10
    s_sub_u32 s59, s59, 1
    s_cbranch_scc0 L_spin9
L_ok10:
    s_waitcnt vmcnt(9)
    v_mfma_f32_16x16x32_bf16 v[64:67], v[128:131], a[64:67], v[64:67]
    s_add_u32 s58, s70, 0
    v_mfma_f32_16x16x32_bf16 v[68:71], v[128:131], a[68:71], v[68:71]
    buffer_load_dwordx4 v[120:123], v23, s[24:27], s58 offen offset:0 sc1
    v_mfma_f32_16x16x32_bf16 v[72:75], v[128:131], a[72:75], v[72:75]
    v_mfma_f32_16x16x32_bf16 v[76:79], v[128:131], a[76:79], v[76:79]
    s_waitcnt vmcnt(9)
    v_mfma_f32_16x16x32_bf16 v[64:67], v[132:135], a[80:83], v[64:67]
    s_add_u32 s58, s70, 16384
    v_mfma_f32_16x16x32_bf16 v[68:71], v[132:135], a[84:87], v[68:71]
    buffer_load_dwordx4 v[124:127], v23, s[24:27], s58 offen offset:0 sc1
    v_mfma_f32_16x16x32_bf16 v[72:75], v[132:135], a[88:91], v[72:75]
    v_mfma_f32_16x16x32_bf16 v[76:79], v[132:135], a[92:95], v[76:79]
    s_waitcnt vmcnt(9)
    v_mfma_f32_16x16x32_bf16 v[64:67], v[136:139], a[96:99], v[64:67]
    s_add_u32 s58, s70, 32768
    v_mfma_f32_16x16x32_bf16 v[68:71], v[136:139], a[100:103], v[68:71]
    buffer_load_dwordx4 v[128:131], v23, s[24:27], s58 offen offset:0 sc1
    v_mfma_f32_16x16x32_bf16 v[72:75], v[136:139], a[104:107], v[72:75]
    v_mfma_f32_16x16x32_bf16 v[76:79], v[136:139], a[108:111], v[76:79]
    s_waitcnt vmcnt(9)
    v_mfma_f32_16x16x32_bf16 v[64:67], v[140:143], a[112:115], v[64:67]
    s_add_u32 s58, s70, 49152
    v_mfma_f32_16x16x32_bf16 v[68:71], v[140:143], a[116:119], v[68:71]
    buffer_load_dwordx4 v[132:135], v23, s[24:27], s58 offen offset:0 sc1
    v_mfma_f32_16x16x32_bf16 v[72:75], v[140:143], a[120:123], v[72:75]
    v_mfma_f32_16x16x32_bf16 v[76:79], v[140:143], a[124:127], v[76:79]
    s_waitcnt vmcnt(9)
    v_mfma_f32_16x16x32_bf16 v[64:67], v[144:147], a[128:131], v[64:67]
    s_add_u32 s58, s70, 0
    v_mfma_f32_16x16x32_bf16 v[68:71], v[144:147], a[132:135], v[68:71]
    buffer_load_dwordx4 v[136:139], v23, s[24:27], s58 offen offset:1024 sc1
    v_mfma_f32_16x16x32_bf16 v[72:75], v[144:147], a[136:139], v[72:75]
    v_mfma_f32_16x16x32_bf16 v[76:79], v[144:147], a[140:143], v[76:79]
    s_waitcnt vmcnt(9)
    v_mfma_f32_16x16x32_bf16 v[64:67], v[148:151], a[144:147], v[64:67]
    s_add_u32 s58, s70, 16384
    v_mfma_f32_16x16x32_bf16 v[68:71], v[148:151], a[148:151], v[68:71]
    buffer_load_dwordx4 v[140:143], v23, s[24:27], s58 offen offset:1024 sc1
    v_mfma_f32_16x16x32_bf16 v[72:75], v[148:151], a[152:155], v[72:75]
    v_mfma_f32_16x16x32_bf16 v[76:79], v[148:151], a[156:159], v[76:79]
    s_waitcnt vmcnt(9)
    v_mfma_f32_16x16x32_bf16 v[64:67], v[152:155], a[160:163], v[64:67]
    s_add_u32 s58, s70, 32768
    v_mfma_f32_16x16x32_bf16 v[68:71], v[152:155], a[164:167], v[68:71]
    buffer_load_dwordx4 v[144:147], v23, s[24:27], s58 offen offset:1024 sc1
    v_mfma_f32_16x16x32_bf16 v[72:75], v[152:155], a[168:171], v[72:75]
    v_mfma_f32_16x16x32_bf16 v[76:79], v[152:155], a[172:175], v[76:79]
    s_waitcnt vmcnt(9)
    v_mfma_f32_16x16x32_bf16 v[64:67], v[156:159], a[176:179], v[64:67]
    s_add_u32 s58, s70, 49152
    v_mfma_f32_16x16x32_bf16 v[68:71], v[156:159], a[180:183], v[68:71]
    buffer_load_dwordx4 v[148:151], v23, s[24:27], s58 offen offset:1024 sc1
    v_mfma_f32_16x16x32_bf16 v[72:75], v[156:159], a[184:187], v[72:75]
    v_mfma_f32_16x16x32_bf16 v[76:79], v[156:159], a[188:191], v[76:79]
    s_waitcnt vmcnt(9)
    v_mfma_f32_16x16x32_bf16 v[64:67], v[112:115], a[192:195], v[64:67]
    s_add_u32 s58, s70, 0
    v_mfma_f32_16x16x32_bf16 v[68:71], v[112:115], a[196:199], v[68:71]
    buffer_load_dwordx4 v[152:155], v23, s[24:27], s58 offen offset:2048 sc1
    v_mfma_f32_16x16x32_bf16 v[72:75], v[112:115], a[200:203], v[72:75]
    v_mfma_f32_16x16x32_bf16 v[76:79], v[112:115], a[204:207], v[76:79]
    s_waitcnt vmcnt(9)
    v_mfma_f32_16x16x32_bf16 v[64:67], v[116:119], a[208:211], v[64:67]
    s_add_u32 s58, s70, 16384
    v_mfma_f32_16x16x32_bf16 v[68:71], v[116:119], a[212:215], v[68:71]
    buffer_load_dwordx4 v[156:159], v23, s[24:27], s58 offen offset:2048 sc1
    v_mfma_f32_16x16x32_bf16 v[72:75], v[116:119], a[216:219], v[72:75]
    v_mfma_f32_16x16x32_bf16 v[76:79], v[116:119], a[220:223], v[76:79]
    s_waitcnt vmcnt(9)
    s_waitcnt lgkmcnt(8)
    v_mfma_f32_16x16x32_bf16 v[32:35], a[224:227], v[120:123], 0
    s_add_u32 s58, s70, 32768
    v_mfma_f32_16x16x32_bf16 v[48:51], a[228:231], v[120:123], 0
    buffer_load_dwordx4 v[112:115], v23, s[24:27], s58 offen offset:2048 sc1
    v_mfma_f32_16x16x32_bf16 v[64:67], a[232:235], v[120:123], v[64:67]
    v_mfma_f32_16x16x32_bf16 v[80:83], a[236:239], v[120:123], v[80:83]
    v_mfma_f32_16x16x32_bf16 v[96:99], v[192:195], v[120:123], v[96:99]
    s_waitcnt vmcnt(9)
    v_mfma_f32_16x16x32_bf16 v[36:39], a[224:227], v[124:127], 0
    s_add_u32 s58, s70, 49152
    v_mfma_f32_16x16x32_bf16 v[52:55], a[228:231], v[124:127], 0
    buffer_load_dwordx4 v[116:119], v23, s[24:27], s58 offen offset:2048 sc1
    v_mfma_f32_16x16x32_bf16 v[68:71], a[232:235], v[124:127], v[68:71]
    v_mfma_f32_16x16x32_bf16 v[84:87], a[236:239], v[124:127], v[84:87]
    v_mfma_f32_16x16x32_bf16 v[100:103], v[192:195], v[124:127], v[100:103]
    s_waitcnt vmcnt(9)
    v_mfma_f32_16x16x32_bf16 v[40:43], a[224:227], v[128:131], 0
    s_add_u32 s58, s70, 0
    v_mfma_f32_16x16x32_bf16 v[56:59], a[228:231], v[128:131], 0
    buffer_load_dwordx4 v[120:123], v23, s[24:27], s58 offen offset:3072 sc1
    v_mfma_f32_16x16x32_bf16 v[72:75], a[232:235], v[128:131], v[72:75]
    v_mfma_f32_16x16x32_bf16 v[88:91], a[236:239], v[128:131], v[88:91]
    v_mfma_f32_16x16x32_bf16 v[104:107], v[192:195], v[128:131], v[104:107]
    s_waitcnt vmcnt(9)
    v_mfma_f32_16x16x32_bf16 v[44:47], a[224:227], v[132:135], 0
    s_add_u32 s58, s70, 16384
    v_mfma_f32_16x16x32_bf16 v[60:63], a[228:231], v[132:135], 0
    buffer_load_dwordx4 v[124:127], v23, s[24:27], s58 offen offset:3072 sc1
    v_mfma_f32_16x16x32_bf16 v[76:79], a[232:235], v[132:135], v[76:79]
    v_mfma_f32_16x16x32_bf16 v[92:95], a[236:239], v[132:135], v[92:95]
    v_mfma_f32_16x16x32_bf16 v[108:111], v[192:195], v[132:135], v[108:111]
    ds_read_b64_tr_b16 a[224:225], v4 offset:16384
    ds_read_b64_tr_b16 a[226:227], v4 offset:16896
    ds_read_b64_tr_b16 a[228:229], v5 offset:16384
    ds_read_b64_tr_b16 a[230:231], v5 offset:16896
    s_waitcnt vmcnt(9)
    s_waitcnt lgkmcnt(4)
    v_mfma_f32_16x16x32_bf16 v[32:35], a[240:243], v[136:139], v[32:35]
    s_add_u32 s58, s70, 32768
    v_mfma_f32_16x16x32_bf16 v[48:51], a[244:247], v[136:139], v[48:51]
    buffer_load_dwordx4 v[128:131], v23, s[24:27], s58 offen offset:3072 sc1
    v_mfma_f32_16x16x32_bf16 v[64:67], a[248:251], v[136:139], v[64:67]
    v_mfma_f32_16x16x32_bf16 v[80:83], a[252:255], v[136:139], v[80:83]
    v_mfma_f32_16x16x32_bf16 v[96:99], v[196:199], v[136:139], v[96:99]
    ds_read_b64_tr_b16 a[232:233], v4 offset:16640
    ds_read_b64_tr_b16 a[234:235], v4 offset:17152
    ds_read_b64_tr_b16 a[236:237], v5 offset:16640
    ds_read_b64_tr_b16 a[238:239], v5 offset:17152
    s_waitcnt vmcnt(9)
    v_mfma_f32_16x16x32_bf16 v[36:39], a[240:243], v[140:143], v[36:39]
    s_add_u32 s58, s70, 49152
    v_mfma_f32_16x16x32_bf16 v[52:55], a[244:247], v[140:143], v[52:55]
    buffer_load_dwordx4 v[132:135], v23, s[24:27], s58 offen offset:3072 sc1
    v_mfma_f32_16x16x32_bf16 v[68:71], a[248:251], v[140:143], v[68:71]
    v_mfma_f32_16x16x32_bf16 v[84:87], a[252:255], v[140:143], v[84:87]
    v_mfma_f32_16x16x32_bf16 v[100:103], v[196:199], v[140:143], v[100:103]
    s_waitcnt vmcnt(9)
    v_mfma_f32_16x16x32_bf16 v[40:43], a[240:243], v[144:147], v[40:43]
    s_xor_b32 s66, s44, 1
    s_lshl2_add_u32 s66, s49, s66
    v_mfma_f32_16x16x32_bf16 v[56:59], a[244:247], v[144:147], v[56:59]
    s_mul_i32 s66, s66, 58624
    s_add_u32 s66, s66, s69
    v_mfma_f32_16x16x32_bf16 v[72:75], a[248:251], v[144:147], v[72:75]
    s_add_u32 s58, s66, s76
    buffer_load_dwordx4 v[136:139], v23, s[24:27], s58 offen offset:0 sc1
    v_mfma_f32_16x16x32_bf16 v[88:91], a[252:255], v[144:147], v[88:91]
    v_mfma_f32_16x16x32_bf16 v[104:107], v[196:199], v[144:147], v[104:107]
    s_waitcnt vmcnt(9)
    v_mfma_f32_16x16x32_bf16 v[44:47], a[240:243], v[148:151], v[44:47]
    buffer_load_dwordx4 v[140:143], v23, s[24:27], s58 offen offset:1024 sc1
    v_mfma_f32_16x16x32_bf16 v[60:63], a[244:247], v[148:151], v[60:63]
    v_mfma_f32_16x16x32_bf16 v[76:79], a[248:251], v[148:151], v[76:79]
    v_mfma_f32_16x16x32_bf16 v[92:95], a[252:255], v[148:151], v[92:95]
    v_mfma_f32_16x16x32_bf16 v[108:111], v[196:199], v[148:151], v[108:111]
    ds_read_b64_tr_b16 a[240:241], v4 offset:32768
    ds_read_b64_tr_b16 a[242:243], v4 offset:33280
    ds_read_b64_tr_b16 a[244:245], v5 offset:32768
    ds_read_b64_tr_b16 a[246:247], v5 offset:33280
    s_waitcnt vmcnt(9)
    s_waitcnt lgkmcnt(4)
    v_mfma_f32_16x16x32_bf16 v[32:35], a[224:227], v[152:155], v[32:35]
    s_add_u32 s58, s66, s77
    v_mfma_f32_16x16x32_bf16 v[48:51], a[228:231], v[152:155], v[48:51]
    buffer_load_dwordx4 v[144:147], v23, s[24:27], s58 offen offset:0 sc1
    v_mfma_f32_16x16x32_bf16 v[64:67], a[232:235], v[152:155], v[64:67]
    v_mfma_f32_16x16x32_bf16 v[80:83], a[236:239], v[152:155], v[80:83]
    v_mfma_f32_16x16x32_bf16 v[96:99], v[200:203], v[152:155], v[96:99]
    ds_read_b64_tr_b16 a[248:249], v4 offset:33024
    ds_read_b64_tr_b16 a[250:251], v4 offset:33536
    ds_read_b64_tr_b16 a[252:253], v5 offset:33024
    ds_read_b64_tr_b16 a[254:255], v5 offset:33536
    s_waitcnt vmcnt(9)
    v_mfma_f32_16x16x32_bf16 v[36:39], a[224:227], v[156:159], v[36:39]
    buffer_load_dwordx4 v[148:151], v23, s[24:27], s58 offen offset:1024 sc1
    v_mfma_f32_16x16x32_bf16 v[52:55], a[228:231], v[156:159], v[52:55]
    v_mfma_f32_16x16x32_bf16 v[68:71], a[232:235], v[156:159], v[68:71]
    v_mfma_f32_16x16x32_bf16 v[84:87], a[236:239], v[156:159], v[84:87]
    v_mfma_f32_16x16x32_bf16 v[100:103], v[200:203], v[156:159], v[100:103]
    s_waitcnt vmcnt(9)
    v_mfma_f32_16x16x32_bf16 v[40:43], a[224:227], v[112:115], v[40:43]
    s_add_u32 s58, s66, s78
    v_mfma_f32_16x16x32_bf16 v[56:59], a[228:231], v[112:115], v[56:59]
    buffer_load_dwordx4 v[152:155], v23, s[24:27], s58 offen offset:0 sc1
    v_mfma_f32_16x16x32_bf16 v[72:75], a[232:235], v[112:115], v[72:75]
    v_mfma_f32_16x16x32_bf16 v[88:91], a[236:239], v[112:115], v[88:91]
    v_mfma_f32_16x16x32_bf16 v[104:107], v[200:203], v[112:115], v[104:107]
    s_waitcnt vmcnt(9)
    v_mfma_f32_16x16x32_bf16 v[44:47], a[224:227], v[116:119], v[44:47]
    buffer_load_dwordx4 v[156:159], v23, s[24:27], s58 offen offset:1024 sc1
    v_mfma_f32_16x16x32_bf16 v[60:63], a[228:231], v[116:119], v[60:63]
    v_mfma_f32_16x16x32_bf16 v[76:79], a[232:235], v[116:119], v[76:79]
    v_mfma_f32_16x16x32_bf16 v[92:95], a[236:239], v[116:119], v[92:95]
    v_mfma_f32_16x16x32_bf16 v[108:111], v[200:203], v[116:119], v[108:111]
    s_waitcnt vmcnt(9)
    s_waitcnt lgkmcnt(0)
    v_mfma_f32_16x16x32_bf16 v[32:35], a[240:243], v[120:123], v[32:35]
    s_add_u32 s58, s66, s79
    v_mfma_f32_16x16x32_bf16 v[48:51], a[244:247], v[120:123], v[48:51]
    buffer_load_dwordx4 v[112:115], v23, s[24:27], s58 offen offset:0 sc1
    v_mfma_f32_16x16x32_bf16 v[64:67], a[248:251], v[120:123], v[64:67]
    v_mfma_f32_16x16x32_bf16 v[80:83], a[252:255], v[120:123], v[80:83]
    v_mfma_f32_16x16x32_bf16 v[96:99], v[204:207], v[120:123], v[96:99]
    s_waitcnt vmcnt(9)
    v_mfma_f32_16x16x32_bf16 v[36:39], a[240:243], v[124:127], v[36:39]
    buffer_load_dwordx4 v[116:119], v23, s[24:27], s58 offen offset:1024 sc1
    v_mfma_f32_16x16x32_bf16 v[52:55], a[244:247], v[124:127], v[52:55]
    v_mfma_f32_16x16x32_bf16 v[68:71], a[248:251], v[124:127], v[68:71]
    v_mfma_f32_16x16x32_bf16 v[84:87], a[252:255], v[124:127], v[84:87]
    v_mfma_f32_16x16x32_bf16 v[100:103], v[204:207], v[124:127], v[100:103]
    s_waitcnt vmcnt(9)
    v_mfma_f32_16x16x32_bf16 v[40:43], a[240:243], v[128:131], v[40:43]
    s_add_u32 s58, s66, s80
    v_mfma_f32_16x16x32_bf16 v[56:59], a[244:247], v[128:131], v[56:59]
    buffer_load_dwordx4 v[120:123], v23, s[24:27], s58 offen offset:0 sc1
    v_mfma_f32_16x16x32_bf16 v[72:75], a[248:251], v[128:131], v[72:75]
    v_mfma_f32_16x16x32_bf16 v[88:91], a[252:255], v[128:131], v[88:91]
    v_mfma_f32_16x16x32_bf16 v[104:107], v[204:207], v[128:131], v[104:107]
    s_waitcnt vmcnt(9)
    v_mfma_f32_16x16x32_bf16 v[44:47], a[240:243], v[132:135], v[44:47]
    buffer_load_dwordx4 v[124:127], v23, s[24:27], s58 offen offset:1024 sc1
    v_mfma_f32_16x16x32_bf16 v[60:63], a[244:247], v[132:135], v[60:63]
    v_mfma_f32_16x16x32_bf16 v[76:79], a[248:251], v[132:135], v[76:79]
    v_mfma_f32_16x16x32_bf16 v[92:95], a[252:255], v[132:135], v[92:95]
    v_mfma_f32_16x16x32_bf16 v[108:111], v[204:207], v[132:135], v[108:111]
    s_waitcnt vmcnt(9)
    v_mfma_f32_16x16x32_bf16 v[48:51], v[136:139], a[0:3], v[48:51]
    s_add_u32 s58, s66, s81
    v_mfma_f32_16x16x32_bf16 v[52:55], v[136:139], a[4:7], v[52:55]
    buffer_load_dwordx4 v[128:131], v23, s[24:27], s58 offen offset:0 sc1
    v_mfma_f32_16x16x32_bf16 v[56:59], v[136:139], a[8:11], v[56:59]
    v_mfma_f32_16x16x32_bf16 v[60:63], v[136:139], a[12:15], v[60:63]
    s_waitcnt vmcnt(9)
    v_mfma_f32_16x16x32_bf16 v[48:51], v[140:143], a[16:19], v[48:51]
    buffer_load_dwordx4 v[132:135], v23, s[24:27], s58 offen offset:1024 sc1
    v_mfma_f32_16x16x32_bf16 v[52:55], v[140:143], a[20:23], v[52:55]
    v_mfma_f32_16x16x32_bf16 v[56:59], v[140:143], a[24:27], v[56:59]
    v_mfma_f32_16x16x32_bf16 v[60:63], v[140:143], a[28:31], v[60:63]
    s_waitcnt vmcnt(9)
    v_mfma_f32_16x16x32_bf16 v[48:51], v[144:147], a[32:35], v[48:51]
    s_add_u32 s58, s66, s82
    ds_write_b128 v242, v[96:99] offset:0
    v_mfma_f32_16x16x32_bf16 v[52:55], v[144:147], a[36:39], v[52:55]
    buffer_load_dwordx4 v[136:139], v23, s[24:27], s58 offen offset:0 sc1
    v_mfma_f32_16x16x32_bf16 v[56:59], v[144:147], a[40:43], v[56:59]
    v_mfma_f32_16x16x32_bf16 v[60:63], v[144:147], a[44:47], v[60:63]
    s_waitcnt vmcnt(9)
    v_mfma_f32_16x16x32_bf16 v[48:51], v[148:151], a[48:51], v[48:51]
    buffer_load_dwordx4 v[140:143], v23, s[24:27], s58 offen offset:1024 sc1
    ds_write_b128 v242, v[100:103] offset:1024
    v_mfma_f32_16x16x32_bf16 v[52:55], v[148:151], a[52:55], v[52:55]
    v_mfma_f32_16x16x32_bf16 v[56:59], v[148:151], a[56:59], v[56:59]
    v_mfma_f32_16x16x32_bf16 v[60:63], v[148:151], a[60:63], v[60:63]
    s_waitcnt vmcnt(9)
    v_mfma_f32_16x16x32_bf16 v[48:51], v[152:155], a[64:67], v[48:51]
    s_xor_b32 s66, s44, 0
    s_lshl2_add_u32 s66, s49, s66
    ds_write_b128 v242, v[104:107] offset:2048
    v_mfma_f32_16x16x32_bf16 v[52:55], v[152:155], a[68:71], v[52:55]
    s_mul_i32 s66, s66, 58624
    s_add_u32 s66, s66, s69
    v_mfma_f32_16x16x32_bf16 v[56:59], v[152:155], a[72:75], v[56:59]
    s_add_u32 s58, s66, s76
    buffer_load_dwordx4 v[144:147], v23, s[24:27], s58 offen offset:0 sc1
    v_mfma_f32_16x16x32_bf16 v[60:63], v[152:155], a[76:79], v[60:63]
    s_waitcnt vmcnt(9)
    v_mfma_f32_16x16x32_bf16 v[48:51], v[156:159], a[80:83], v[48:51]
    buffer_load_dwordx4 v[148:151], v23, s[24:27], s58 offen offset:1024 sc1
    ds_write_b128 v242, v[108:111] offset:3072
    v_mfma_f32_16x16x32_bf16 v[52:55], v[156:159], a[84:87], v[52:55]
    v_mfma_f32_16x16x32_bf16 v[56:59], v[156:159], a[88:91], v[56:59]
    v_mfma_f32_16x16x32_bf16 v[60:63], v[156:159], a[92:95], v[60:63]
    s_waitcnt vmcnt(9)
    v_mfma_f32_16x16x32_bf16 v[48:51], v[112:115], a[96:99], v[48:51]
    s_add_u32 s58, s66, s77
    ds_write_b128 v241, v[80:83] offset:0
    v_mfma_f32_16x16x32_bf16 v[52:55], v[112:115], a[100:103], v[52:55]
    buffer_load_dwordx4 v[152:155], v23, s[24:27], s58 offen offset:0 sc1
    v_mfma_f32_16x16x32_bf16 v[56:59], v[112:115], a[104:107], v[56:59]
    v_mfma_f32_16x16x32_bf16 v[60:63], v[112:115], a[108:111], v[60:63]
    s_waitcnt vmcnt(9)
    v_mfma_f32_16x16x32_bf16 v[48:51], v[116:119], a[112:115], v[48:51]
    buffer_load_dwordx4 v[156:159], v23, s[24:27], s58 offen offset:1024 sc1
    ds_write_b128 v241, v[84:87] offset:16384
    v_mfma_f32_16x16x32_bf16 v[52:55], v[116:119], a[116:119], v[52:55]
    v_mfma_f32_16x16x32_bf16 v[56:59], v[116:119], a[120:123], v[56:59]
    v_mfma_f32_16x16x32_bf16 v[60:63], v[116:119], a[124:127], v[60:63]
    s_waitcnt vmcnt(9)
    v_mfma_f32_16x16x32_bf16 v[48:51], v[120:123], a[128:131], v[48:51]
    s_add_u32 s58, s66, s78
    ds_write_b128 v241, v[88:91] offset:32768
    v_mfma_f32_16x16x32_bf16 v[52:55], v[120:123], a[132:135], v[52:55]
    buffer_load_dwordx4 v[112:115], v23, s[24:27], s58 offen offset:0 sc1
    v_mfma_f32_16x16x32_bf16 v[56:59], v[120:123], a[136:139], v[56:59]
    v_mfma_f32_16x16x32_bf16 v[60:63], v[120:123], a[140:143], v[60:63]
    s_waitcnt vmcnt(9)
    v_mfma_f32_16x16x32_bf16 v[48:51], v[124:127], a[144:147], v[48:51]
    buffer_load_dwordx4 v[116:119], v23, s[24:27], s58 offen offset:1024 sc1
    ds_write_b128 v241, v[92:95] offset:49152
    v_mfma_f32_16x16x32_bf16 v[52:55], v[124:127], a[148:151], v[52:55]
    v_mfma_f32_16x16x32_bf16 v[56:59], v[124:127], a[152:155], v[56:59]
    v_mfma_f32_16x16x32_bf16 v[60:63], v[124:127], a[156:159], v[60:63]
    s_waitcnt vmcnt(9)
    v_mfma_f32_16x16x32_bf16 v[48:51], v[128:131], a[160:163], v[48:51]
    s_add_u32 s58, s66, s79
    ds_write_b128 v240, v[64:67] offset:0
    v_mfma_f32_16x16x32_bf16 v[52:55], v[128:131], a[164:167], v[52:55]
    buffer_load_dwordx4 v[120:123], v23, s[24:27], s58 offen offset:0 sc1
    v_mfma_f32_16x16x32_bf16 v[56:59], v[128:131], a[168:171], v[56:59]
    v_mfma_f32_16x16x32_bf16 v[60:63], v[128:131], a[172:175], v[60:63]
    s_waitcnt vmcnt(9)
    v_mfma_f32_16x16x32_bf16 v[48:51], v[132:135], a[176:179], v[48:51]
    buffer_load_dwordx4 v[124:127], v23, s[24:27], s58 offen offset:1024 sc1
    ds_write_b128 v240, v[68:71] offset:16384
    v_mfma_f32_16x16x32_bf16 v[52:55], v[132:135], a[180:183], v[52:55]
    v_mfma_f32_16x16x32_bf16 v[56:59], v[132:135], a[184:187], v[56:59]
    v_mfma_f32_16x16x32_bf16 v[60:63], v[132:135], a[188:191], v[60:63]
    s_waitcnt vmcnt(9)
    v_mfma_f32_16x16x32_bf16 v[48:51], v[136:139], a[192:195], v[48:51]
    s_add_u32 s58, s66, s80
    ds_write_b128 v240, v[72:75] offset:32768
    v_mfma_f32_16x16x32_bf16 v[52:55], v[136:139], a[196:199], v[52:55]
    buffer_load_dwordx4 v[128:131], v23, s[24:27], s58 offen offset:0 sc1
    v_mfma_f32_16x16x32_bf16 v[56:59], v[136:139], a[200:203], v[56:59]
    v_mfma_f32_16x16x32_bf16 v[60:63], v[136:139], a[204:207], v[60:63]
    s_waitcnt vmcnt(9)
    v_mfma_f32_16x16x32_bf16 v[48:51], v[140:143], a[208:211], v[48:51]
    buffer_load_dwordx4 v[132:135], v23, s[24:27], s58 offen offset:1024 sc1
    ds_write_b128 v240, v[76:79] offset:49152
    v_mfma_f32_16x16x32_bf16 v[52:55], v[140:143], a[212:215], v[52:55]
    v_mfma_f32_16x16x32_bf16 v[56:59], v[140:143], a[216:219], v[56:59]
    v_mfma_f32_16x16x32_bf16 v[60:63], v[140:143], a[220:223], v[60:63]
    s_waitcnt vmcnt(9)
    v_mfma_f32_16x16x32_bf16 v[32:35], v[144:147], a[0:3], v[32:35]
    s_add_u32 s58, s66, s81
    v_mfma_f32_16x16x32_bf16 v[36:39], v[144:147], a[4:7], v[36:39]
    buffer_load_dwordx4 v[136:139], v23, s[24:27], s58 offen offset:0 sc1
    v_mfma_f32_16x16x32_bf16 v[40:43], v[144:147], a[8:11], v[40:43]
    v_mfma_f32_16x16x32_bf16 v[44:47], v[144:147], a[12:15], v[44:47]
    s_waitcnt vmcnt(9)
    v_mfma_f32_16x16x32_bf16 v[32:35], v[148:151], a[16:19], v[32:35]
    buffer_load_dwordx4 v[140:143], v23, s[24:27], s58 offen offset:1024 sc1
    ds_write_b128 v239, v[48:51] offset:0
    v_mfma_f32_16x16x32_bf16 v[36:39], v[148:151], a[20:23], v[36:39]
    ds_write_b128 v239, v[52:55] offset:16384
    v_mfma_f32_16x16x32_bf16 v[40:43], v[148:151], a[24:27], v[40:43]
    v_mfma_f32_16x16x32_bf16 v[44:47], v[148:151], a[28:31], v[44:47]
    s_waitcnt vmcnt(9)
    v_mfma_f32_16x16x32_bf16 v[32:35], v[152:155], a[32:35], v[32:35]
    s_add_u32 s58, s66, s82
    ds_write_b128 v239, v[56:59] offset:32768
    v_mfma_f32_16x16x32_bf16 v[36:39], v[152:155], a[36:39], v[36:39]
    buffer_load_dwordx4 v[144:147], v23, s[24:27], s58 offen offset:0 sc1
    ds_write_b128 v239, v[60:63] offset:49152
    v_mfma_f32_16x16x32_bf16 v[40:43], v[152:155], a[40:43], v[40:43]
    v_mfma_f32_16x16x32_bf16 v[44:47], v[152:155], a[44:47], v[44:47]
    s_waitcnt vmcnt(9)
    v_mfma_f32_16x16x32_bf16 v[32:35], v[156:159], a[48:51], v[32:35]
    buffer_load_dwordx4 v[148:151], v23, s[24:27], s58 offen offset:1024 sc1
    v_mfma_f32_16x16x32_bf16 v[36:39], v[156:159], a[52:55], v[36:39]
    v_mfma_f32_16x16x32_bf16 v[40:43], v[156:159], a[56:59], v[40:43]
    v_mfma_f32_16x16x32_bf16 v[44:47], v[156:159], a[60:63], v[44:47]
    s_waitcnt vmcnt(9)
    v_mfma_f32_16x16x32_bf16 v[32:35], v[112:115], a[64:67], v[32:35]
    v_mfma_f32_16x16x32_bf16 v[36:39], v[112:115], a[68:71], v[36:39]
    v_mfma_f32_16x16x32_bf16 v[40:43], v[112:115], a[72:75], v[40:43]
    v_mfma_f32_16x16x32_bf16 v[44:47], v[112:115], a[76:79], v[44:47]
    s_waitcnt vmcnt(8)
    v_mfma_f32_16x16x32_bf16 v[32:35], v[116:119], a[80:83], v[32:35]
    s_waitcnt lgkmcnt(0)
    s_barrier
    v_mfma_f32_16x16x32_bf16 v[36:39], v[116:119], a[84:87], v[36:39]
    v_mfma_f32_16x16x32_bf16 v[40:43], v[116:119], a[88:91], v[40:43]
    v_mfma_f32_16x16x32_bf16 v[44:47], v[116:119], a[92:95], v[44:47]
    s_waitcnt vmcnt(7)
    v_mfma_f32_16x16x32_bf16 v[32:35], v[120:123], a[96:99], v[32:35]
    ds_read_b128 v[160:163], v252 offset:0
    ds_read_b128 v[164:167], v252 offset:4096
    v_mfma_f32_16x16x32_bf16 v[36:39], v[120:123], a[100:103], v[36:39]
    ds_read_b128 v[168:171], v252 offset:8192
    ds_read_b128 v[172:175], v252 offset:12288
    v_mfma_f32_16x16x32_bf16 v[40:43], v[120:123], a[104:107], v[40:43]
    ds_read_b128 v[48:51], v246 offset:0
    ds_read_b128 v[52:55], v248 offset:0
    v_mfma_f32_16x16x32_bf16 v[44:47], v[120:123], a[108:111], v[44:47]
    s_waitcnt vmcnt(6)
    v_mfma_f32_16x16x32_bf16 v[32:35], v[124:127], a[112:115], v[32:35]
    ds_read_b128 v[56:59], v250 offset:0
    ds_read_b128 v[60:63], v247 offset:0
    v_mfma_f32_16x16x32_bf16 v[36:39], v[124:127], a[116:119], v[36:39]
    ds_read_b128 v[64:67], v249 offset:0
    ds_read_b128 v[68:71], v251 offset:0
    v_mfma_f32_16x16x32_bf16 v[40:43], v[124:127], a[120:123], v[40:43]
    ds_read_b128 v[72:75], v246 offset:32768
    ds_read_b128 v[76:79], v248 offset:32768
    v_mfma_f32_16x16x32_bf16 v[44:47], v[124:127], a[124:127], v[44:47]
    s_waitcnt vmcnt(5)
    v_mfma_f32_16x16x32_bf16 v[32:35], v[128:131], a[128:131], v[32:35]
    ds_read_b128 v[80:83], v250 offset:32768
    v_mfma_f32_16x16x32_bf16 v[36:39], v[128:131], a[132:135], v[36:39]
    ds_read_b128 v[84:87], v247 offset:32768
    v_mfma_f32_16x16x32_bf16 v[40:43], v[128:131], a[136:139], v[40:43]
    ds_read_b128 v[88:91], v249 offset:32768
    v_mfma_f32_16x16x32_bf16 v[44:47], v[128:131], a[140:143], v[44:47]
    ds_read_b128 v[92:95], v251 offset:32768
    s_waitcnt vmcnt(4)
    v_mfma_f32_16x16x32_bf16 v[32:35], v[132:135], a[144:147], v[32:35]
    s_waitcnt lgkmcnt(12)
    v_add_f32 v232, v232, v160
    v_mfma_f32_16x16x32_bf16 v[36:39], v[132:135], a[148:151], v[36:39]
    v_add_f32 v233, v233, v161
    v_add_f32 v234, v234, v162
    v_mfma_f32_16x16x32_bf16 v[40:43], v[132:135], a[152:155], v[40:43]
    v_add_f32 v235, v235, v163
    v_add_f32 v232, v232, v164
    v_mfma_f32_16x16x32_bf16 v[44:47], v[132:135], a[156:159], v[44:47]
    v_add_f32 v233, v233, v165
    v_add_f32 v234, v234, v166
    s_waitcnt vmcnt(3)
    v_mfma_f32_16x16x32_bf16 v[32:35], v[136:139], a[160:163], v[32:35]
    v_add_f32 v235, v235, v167
    v_add_f32 v232, v232, v168
    v_mfma_f32_16x16x32_bf16 v[36:39], v[136:139], a[164:167], v[36:39]
    v_add_f32 v233, v233, v169
    v_add_f32 v234, v234, v170
    v_mfma_f32_16x16x32_bf16 v[40:43], v[136:139], a[168:171], v[40:43]
    v_add_f32 v235, v235, v171
    v_add_f32 v232, v232, v172
    v_mfma_f32_16x16x32_bf16 v[44:47], v[136:139], a[172:175], v[44:47]
    v_add_f32 v233, v233, v173
    v_add_f32 v234, v234, v174
    s_waitcnt vmcnt(2)
    v_mfma_f32_16x16x32_bf16 v[32:35], v[140:143], a[176:179], v[32:35]
    v_add_f32 v235, v235, v175
    v_cvt_pk_bf16_f32 v226, v232, v233
    v_cvt_pk_bf16_f32 v227, v234, v235
    v_mfma_f32_16x16x32_bf16 v[36:39], v[140:143], a[180:183], v[36:39]
    s_waitcnt lgkmcnt(9)
    v_add_f32 v176, v176, v48
    v_mfma_f32_16x16x32_bf16 v[40:43], v[140:143], a[184:187], v[40:43]
    v_add_f32 v177, v177, v49
    v_add_f32 v178, v178, v50
    v_mfma_f32_16x16x32_bf16 v[44:47], v[140:143], a[188:191], v[44:47]
    v_add_f32 v179, v179, v51
    v_add_f32 v176, v176, v52
    s_waitcnt vmcnt(1)
    v_mfma_f32_16x16x32_bf16 v[32:35], v[144:147], a[192:195], v[32:35]
    v_add_f32 v177, v177, v53
    v_add_f32 v178, v178, v54
    v_mfma_f32_16x16x32_bf16 v[36:39], v[144:147], a[196:199], v[36:39]
    v_add_f32 v179, v179, v55
    v_add_f32 v176, v176, v56
    v_mfma_f32_16x16x32_bf16 v[40:43], v[144:147], a[200:203], v[40:43]
    v_add_f32 v177, v177, v57
    v_add_f32 v178, v178, v58
    v_mfma_f32_16x16x32_bf16 v[44:47], v[144:147], a[204:207], v[44:47]
    v_add_f32 v179, v179, v59
    s_waitcnt lgkmcnt(6)
    s_waitcnt vmcnt(0)
    v_mfma_f32_16x16x32_bf16 v[32:35], v[148:151], a[208:211], v[32:35]
    v_add_f32 v180, v180, v60
    v_add_f32 v181, v181, v61
    v_mfma_f32_16x16x32_bf16 v[36:39], v[148:151], a[212:215], v[36:39]
    v_add_f32 v182, v182, v62
    v_add_f32 v183, v183, v63
    v_mfma_f32_16x16x32_bf16 v[40:43], v[148:151], a[216:219], v[40:43]
    v_add_f32 v180, v180, v64
    v_add_f32 v181, v181, v65
    v_mfma_f32_16x16x32_bf16 v[44:47], v[148:151], a[220:223], v[44:47]
    v_add_f32 v182, v182, v66
    v_add_f32 v183, v183, v67
    v_add_f32 v180, v180, v68
    v_add_f32 v181, v181, v69
    v_add_f32 v182, v182, v70
    v_add_f32 v183, v183, v71
    s_waitcnt lgkmcnt(3)
    v_add_f32 v184, v184, v72
    v_add_f32 v185, v185, v73
    v_add_f32 v186, v186, v74
    ds_write_b128 v238, v[32:35] offset:0
    ds_write_b128 v238, v[36:39] offset:16384
    ds_write_b128 v238, v[40:43] offset:32768
    ds_write_b128 v238, v[44:47] offset:49152
    buffer_store_dwordx2 v[226:227], v26, s[28:31], s73 offen
    v_add_f32 v187, v187, v75
    v_add_f32 v184, v184, v76
    v_add_f32 v185, v185, v77
    v_add_f32 v186, v186, v78
    v_add_f32 v187, v187, v79
    v_add_f32 v184, v184, v80
    v_add_f32 v185, v185, v81
    v_add_f32 v186, v186, v82
    v_add_f32 v187, v187, v83
    s_waitcnt lgkmcnt(4)
    v_add_f32 v188, v188, v84
    v_add_f32 v189, v189, v85
    v_add_f32 v190, v190, v86
    v_add_f32 v191, v191, v87
    v_add_f32 v188, v188, v88
    v_add_f32 v189, v189, v89
    v_add_f32 v190, v190, v90
    v_add_f32 v191, v191, v91
    v_add_f32 v188, v188, v92
    v_add_f32 v189, v189, v93
    v_add_f32 v190, v190, v94
    v_add_f32 v191, v191, v95
    s_waitcnt lgkmcnt(0)
    s_barrier
    ds_read_b128 v[160:163], v244 offset:0
    ds_read_b128 v[164:167], v245 offset:0
    ds_read_b128 v[168:171], v244 offset:32768
    ds_read_b128 v[172:175], v245 offset:32768
    s_waitcnt lgkmcnt(2)
    v_pk_add_f32 v[176:177], v[176:177], v[160:161]
    v_pk_add_f32 v[178:179], v[178:179], v[162:163]
    v_pk_add_f32 v[180:181], v[180:181], v[164:165]
    v_pk_add_f32 v[182:183], v[182:183], v[166:167]
    v_cvt_pk_bf16_f32 v216, v176, v177
    v_cvt_pk_bf16_f32 v217, v178, v179
    v_cvt_pk_bf16_f32 v218, v180, v181
    v_cvt_pk_bf16_f32 v219, v182, v183
    buffer_store_dwordx4 v[216:219], v22, s[28:31], s71 offen
    s_waitcnt lgkmcnt(0)
    v_pk_add_f32 v[184:185], v[184:185], v[168:169]
    v_pk_add_f32 v[186:187], v[186:187], v[170:171]
    v_pk_add_f32 v[188:189], v[188:189], v[172:173]
    v_pk_add_f32 v[190:191], v[190:191], v[174:175]
    v_cvt_pk_bf16_f32 v220, v184, v185
    v_cvt_pk_bf16_f32 v221, v186, v187
    v_cvt_pk_bf16_f32 v222, v188, v189
    v_cvt_pk_bf16_f32 v223, v190, v191
    buffer_store_dwordx4 v[220:223], v22, s[28:31], s72 offen
L_end:
    s_endpgm
L_help:
    s_sub_u32 s55, s46, 21
    v_lshlrev_b32 v217, 7, v1
    v_lshrrev_b32 v218, 2, v1
    v_lshlrev_b32 v218, 12, v218
    v_lshl_add_u32 v218, v210, 7, v218
    buffer_load_dword v108, v217, s[32:35], 0 offen
    s_mul_i32 s54, s44, 28
    s_add_u32 s54, s54, s55
    s_add_u32 s54, s54, 6
    s_lshl_b32 s54, s54, 16
    s_lshl_b32 s56, s45, 9
    s_add_u32 s54, s54, s56
    buffer_load_dword v108, v218, s[20:23], s54 offen
    s_add_u32 s54, s54, 196608
    buffer_load_dword v108, v218, s[20:23], s54 offen
    s_add_u32 s54, s54, 196608
    buffer_load_dword v108, v218, s[20:23], s54 offen
    s_add_u32 s54, s54, 196608
    buffer_load_dword v108, v218, s[20:23], s54 offen
    s_add_u32 s54, s54, 196608
    buffer_load_dword v108, v218, s[20:23], s54 offen
    s_add_u32 s54, s54, 196608
    buffer_load_dword v108, v218, s[20:23], s54 offen
    s_add_u32 s54, s54, 196608
    buffer_load_dword v108, v218, s[20:23], s54 offen
    s_add_u32 s54, s54, 196608
    s_cmp_eq_u32 s55, 0
    s_cselect_b32 s54, s54, 2130706432
    buffer_load_dword v108, v218, s[20:23], s54 offen
    s_add_u32 s54, s54, 196608
    buffer_load_dword v108, v217, s[36:39], 0 offen
    s_waitcnt vmcnt(0) lgkmcnt(0)
    s_mul_i32 s53, s46, 43
    s_lshr_b32 s53, s53, 8
    s_mul_i32 s54, s53, 6
    s_sub_u32 s49, s46, s54
    s_lshl2_add_u32 s48, s45, s53
    s_mul_i32 s53, s44, 1835008
    s_lshl_b32 s74, s48, 7
    s_add_u32 s53, s53, s74
    v_lshlrev_b32 v217, 5, v212
    v_xor_b32 v217, v217, v214
    v_lshlrev_b32 v12, 12, v213
    v_add3_u32 v12, v12, v217, s53
    s_mul_i32 s53, s44, 100352
    s_lshl_b32 s54, s49, 7
    s_add_u32 s55, s53, s54
    s_lshl_b32 s56, s44, 5
    v_xor_b32 v217, s56, v214
    v_mul_u32_u24 v13, 896, v213
    v_add3_u32 v13, v13, v217, s55
    v_xor_b32 v14, 32, v13
    s_mul_i32 s73, s48, 57344
    s_add_u32 s71, s73, s54
    s_add_u32 s72, s71, 28672
    v_lshrrev_b32 v217, 1, v1
    v_mul_u32_u24 v15, 896, v217
    v_and_b32 v217, 1, v1
    v_lshl_add_u32 v15, v217, 4, v15
    v_add_u32 v15, s53, v15
    s_lshl_b32 s54, s49, 5
    s_add_u32 s54, s54, 768
    s_add_u32 s68, s49, 24
    s_mul_i32 s68, s68, 58624
    s_mul_i32 s69, s44, 14336
    s_add_u32 s69, s69, 2097152
    s_add_u32 s68, s68, s69
    s_add_u32 s73, s73, s54
    s_mov_b32 s76, 0
    s_add_u32 s77, s76, 2048
    s_cmp_eq_u32 s77, 14336
    s_cselect_b32 s77, 0, s77
    s_add_u32 s78, s77, 2048
    s_cmp_eq_u32 s78, 14336
    s_cselect_b32 s78, 0, s78
    s_add_u32 s79, s78, 2048
    s_cmp_eq_u32 s79, 14336
    s_cselect_b32 s79, 0, s79
    s_add_u32 s80, s79, 2048
    s_cmp_eq_u32 s80, 14336
    s_cselect_b32 s80, 0, s80
    s_add_u32 s81, s80, 2048
    s_cmp_eq_u32 s81, 14336
    s_cselect_b32 s81, 0, s81
    s_add_u32 s82, s81, 2048
    s_cmp_eq_u32 s82, 14336
    s_cselect_b32 s82, 0, s82
    s_cmp_lt_u32 s49, 4
    s_cselect_b32 s75, s54, 2130706432
    s_cselect_b32 s68, s68, 2130706432
    s_cselect_b32 s73, s73, 2130706432
    v_lshl_add_u32 v217, v208, 3, v209
    v_lshlrev_b32 v16, 5, v217
    v_lshl_add_u32 v16, v210, 3, v16
    v_add_u32 v16, s52, v16
    v_and_b32 v217, 7, v1
    v_min_u32 v218, 6, v217
    s_lshl_b32 s53, s49, 5
    s_mul_i32 s54, s44, 7
    s_add_u32 s53, s53, s54
    s_lshl_b32 s53, s53, 7
    s_add_u32 s53, s53, 12713984
    v_lshl_add_u32 v20, v218, 7, s53
    s_lshr_b32 s53, s48, 1
    s_lshl4_add_u32 s53, s44, s53
    s_lshl_b32 s53, s53, 7
    s_add_u32 s53, s53, 12779520
    v_mov_b32 v21, s53
    s_lshl_b32 s70, s48, 16
    s_add_u32 s70, s70, s52
    s_add_u32 s70, s70, 4194304
    v_lshrrev_b32 v218, 3, v0
    v_mul_u32_u24 v22, 896, v218
    v_lshl_add_u32 v22, v217, 4, v22
    v_lshlrev_b32 v25, 1, v218
    v_lshrrev_b32 v219, 4, v218
    v_lshlrev_b32 v244, 14, v219
    v_lshrrev_b32 v219, 1, v217
    v_lshl_add_u32 v244, v219, 12, v244
    v_and_b32 v219, 15, v218
    v_lshl_add_u32 v244, v219, 8, v244
    v_bfe_u32 v219, v218, 1, 1
    v_lshl_add_u32 v244, v219, 7, v244
    v_and_b32 v219, 7, v218
    v_xor_b32 v219, v219, v217
    v_lshl_add_u32 v244, v219, 4, v244
    v_xor_b32 v245, 128, v244
    v_xor_b32 v246, 4096, v244
    v_xor_b32 v247, 4224, v244
    v_xor_b32 v248, 8192, v244
    v_xor_b32 v249, 8320, v244
    v_xor_b32 v250, 12288, v244
    v_xor_b32 v251, 12416, v244
    v_lshrrev_b32 v218, 2, v0
    v_mul_u32_u24 v26, 896, v218
    v_lshl_add_u32 v26, v210, 3, v26
    v_lshlrev_b32 v27, 1, v218
    v_bfe_u32 v219, v218, 1, 2
    v_xor_b32 v219, v219, v210
    v_lshlrev_b32 v252, 6, v218
    v_lshl_add_u32 v252, v219, 4, v252
    v_add_u32 v252, 65536, v252
    v_bfe_u32 v219, v1, 1, 2
    v_xor_b32 v219, v219, v208
    v_lshlrev_b32 v242, 6, v211
    v_lshl_add_u32 v242, v219, 4, v242
    s_add_u32 s53, s52, 65536
    v_add_u32 v242, s53, v242
    v_xor_b32 v218, v217, v212
    v_lshlrev_b32 v238, 4, v218
    v_xor_b32 v238, s56, v238
    v_bfe_u32 v219, v1, 1, 1
    v_xor_b32 v219, v219, v215
    v_lshl_add_u32 v238, v219, 7, v238
    v_lshl_add_u32 v238, v211, 8, v238
    v_add_u32 v238, s52, v238
    v_xor_b32 v239, 32, v238
    v_xor_b32 v240, 64, v238
    v_xor_b32 v241, 96, v238
    buffer_load_dwordx4 v[216:219], v22, s[4:7], s71 offen
    buffer_load_dwordx4 v[220:223], v22, s[4:7], s72 offen
    buffer_load_dwordx2 v[226:227], v26, s[4:7], s73 offen
    buffer_load_ushort v224, v25, s[36:39], s74 offen
    buffer_load_ushort v225, v25, s[36:39], s74 offen offset:64
    buffer_load_ushort v228, v27, s[36:39], s74 offen
    s_add_u32 m0, s52, 81920
    s_lshl_b32 s57, s76, 7
    buffer_load_dwordx4 v12, s[20:23], s57 offen offset:0 lds
    s_add_u32 s57, s57, 31744
    buffer_load_dwordx4 v12, s[20:23], s57 offen offset:1024 lds
    s_add_u32 s57, s57, 31744
    buffer_load_dwordx4 v12, s[20:23], s57 offen offset:2048 lds
    s_add_u32 s57, s57, 31744
    buffer_load_dwordx4 v12, s[20:23], s57 offen offset:3072 lds
    s_add_u32 m0, s52, 98304
    s_lshl_b32 s57, s76, 7
    s_add_u32 s57, s57, 131072
    buffer_load_dwordx4 v12, s[20:23], s57 offen offset:0 lds
    s_add_u32 s57, s57, 31744
    buffer_load_dwordx4 v12, s[20:23], s57 offen offset:1024 lds
    s_add_u32 s57, s57, 31744
    buffer_load_dwordx4 v12, s[20:23], s57 offen offset:2048 lds
    s_add_u32 s57, s57, 31744
    buffer_load_dwordx4 v12, s[20:23], s57 offen offset:3072 lds
    s_add_u32 m0, s52, 114688
    s_lshl_b32 s57, s77, 7
    buffer_load_dwordx4 v12, s[20:23], s57 offen offset:0 lds
    s_add_u32 s57, s57, 31744
    buffer_load_dwordx4 v12, s[20:23], s57 offen offset:1024 lds
    s_add_u32 s57, s57, 31744
    buffer_load_dwordx4 v12, s[20:23], s57 offen offset:2048 lds
    s_add_u32 s57, s57, 31744
    buffer_load_dwordx4 v12, s[20:23], s57 offen offset:3072 lds
    s_add_u32 m0, s52, 131072
    s_lshl_b32 s57, s77, 7
    s_add_u32 s57, s57, 131072
    buffer_load_dwordx4 v12, s[20:23], s57 offen offset:0 lds
    s_add_u32 s57, s57, 31744
    buffer_load_dwordx4 v12, s[20:23], s57 offen offset:1024 lds
    s_waitcnt vmcnt(10)
    ds_read_b64_tr_b16 a[0:1], v6 offset:32768
    ds_read_b64_tr_b16 a[2:3], v6 offset:34816
    ds_read_b64_tr_b16 a[4:5], v7 offset:32768
    ds_read_b64_tr_b16 a[6:7], v7 offset:34816
    ds_read_b64_tr_b16 a[8:9], v6 offset:33024
    ds_read_b64_tr_b16 a[10:11], v6 offset:35072
    ds_read_b64_tr_b16 a[12:13], v7 offset:33024
    ds_read_b64_tr_b16 a[14:15], v7 offset:35072
    s_add_u32 s57, s57, 31744
    buffer_load_dwordx4 v12, s[20:23], s57 offen offset:2048 lds
    s_add_u32 s57, s57, 31744
    buffer_load_dwordx4 v12, s[20:23], s57 offen offset:3072 lds
    s_add_u32 m0, s52, 147456
    s_lshl_b32 s57, s78, 7
    buffer_load_dwordx4 v12, s[20:23], s57 offen offset:0 lds
    s_add_u32 s57, s57, 31744
    buffer_load_dwordx4 v12, s[20:23], s57 offen offset:1024 lds
    s_waitcnt vmcnt(10)
    ds_read_b64_tr_b16 a[16:17], v6 offset:49152
    ds_read_b64_tr_b16 a[18:19], v6 offset:51200
    ds_read_b64_tr_b16 a[20:21], v7 offset:49152
    ds_read_b64_tr_b16 a[22:23], v7 offset:51200
    s_add_u32 s57, s57, 31744
    buffer_load_dwordx4 v12, s[20:23], s57 offen offset:2048 lds
    ds_read_b64_tr_b16 a[24:25], v6 offset:49408
    ds_read_b64_tr_b16 a[26:27], v6 offset:51456
    ds_read_b64_tr_b16 a[28:29], v7 offset:49408
    ds_read_b64_tr_b16 a[30:31], v7 offset:51456
    s_add_u32 s57, s57, 31744
    buffer_load_dwordx4 v12, s[20:23], s57 offen offset:3072 lds
    s_add_u32 m0, s52, 49152
    s_lshl_b32 s57, s78, 7
    s_add_u32 s57, s57, 131072
    buffer_load_dwordx4 v12, s[20:23], s57 offen offset:0 lds
    s_add_u32 s57, s57, 31744
    buffer_load_dwordx4 v12, s[20:23], s57 offen offset:1024 lds
    s_waitcnt vmcnt(10)
    ds_read_b64_tr_b16 a[32:33], v8 offset:0
    ds_read_b64_tr_b16 a[34:35], v8 offset:2048
    ds_read_b64_tr_b16 a[36:37], v9 offset:0
    ds_read_b64_tr_b16 a[38:39], v9 offset:2048
    s_add_u32 s57, s57, 31744
    buffer_load_dwordx4 v12, s[20:23], s57 offen offset:2048 lds
    ds_read_b64_tr_b16 a[40:41], v8 offset:256
    ds_read_b64_tr_b16 a[42:43], v8 offset:2304
    ds_read_b64_tr_b16 a[44:45], v9 offset:256
    ds_read_b64_tr_b16 a[46:47], v9 offset:2304
    s_add_u32 s57, s57, 31744
    buffer_load_dwordx4 v12, s[20:23], s57 offen offset:3072 lds
    s_waitcnt vmcnt(0) lgkmcnt(0)
    s_branch L_p3join
L_role_a:
    v_lshrrev_b32 v112, 4, v1
    v_bfe_u32 v113, v1, 2, 2
    v_and_b32 v114, 3, v1
    v_and_b32 v115, 15, v1
    v_lshrrev_b32 v116, 5, v1
    s_lshr_b32 s48, s45, 1
    s_and_b32 s53, s45, 1
    s_lshl3_add_u32 s49, s53, s46
    s_sub_u32 s49, s49, 24
    s_lshl_b32 s90, s44, 11
    s_and_b32 s53, s44, 1
    s_lshl_b32 s53, s53, 1
    v_lshlrev_b32 v117, 2, v112
    v_sub_u32 v117, v115, v117
    v_and_b32 v117, 15, v117
    v_xor_b32 v117, s53, v117
    v_mul_u32_u24 v2, 2688, v112
    v_lshl_add_u32 v2, v117, 4, v2
    s_mul_i32 s53, s44, 21504
    s_mul_i32 s54, s48, 224
    s_andn2_b32 s54, s54, 63
    s_add_u32 s53, s53, s54
    v_add_u32 v2, s53, v2
    s_add_u32 m0, s90, 65536
    s_mov_b32 s57, 896
    buffer_load_dwordx4 v2, s[8:11], s57 offen offset:0 lds
    v_mul_u32_u24 v109, 960, v25
    v_lshl_add_u32 v109, v26, 4, v109
    v_mul_u32_u24 v110, 960, v113
    v_lshl_add_u32 v110, v112, 5, v110
    v_lshl_add_u32 v110, v114, 3, v110
    s_lshl_b32 s53, s44, 7
    v_add_u32 v110, s53, v110
    v_mul_u32_u24 v111, 66816, v112
    v_lshl_add_u32 v111, v115, 4, v111
    s_mul_i32 s63, s44, 267264
    s_lshl_b32 s53, s2, 8
    s_add_u32 s63, s63, s53
    s_add_u32 s64, s63, 1069056
    s_cmp_eq_u32 s44, 3
    s_cselect_b32 s64, 2130706432, s64
    s_mov_b32 s62, 0x3f803f80
    s_mov_b32 s61, 0xffff0000
    s_mov_b32 s66, 6291456
    v_mov_b32 v96, 0
    v_mov_b32 v97, 0
    v_and_b32 v117, 1, v112
    v_lshlrev_b32 v117, 5, v117
    s_mul_i32 s53, s44, 56
    s_and_b32 s54, s48, 1
    s_lshl_b32 s54, s54, 5
    s_add_u32 s53, s53, s54
    v_lshlrev_b32 v118, 11, v112
    v_lshl_add_u32 v118, v113, 8, v118
    v_add_u32 v118, 65536, v118
    v_lshl_add_u32 v119, v114, 3, s53
    v_add_u32 v119, 0, v119
    v_xor_b32 v119, v119, v117
    v_lshl_add_u32 v119, v113, 6, v119
    v_and_b32 v119, 255, v119
    v_add_u32 v6, v118, v119
    v_add_u32 v10, 49152, v6
    v_subrev_u32 v120, 65536, v6
    v_lshl_add_u32 v119, v114, 3, s53
    v_add_u32 v119, 32, v119
    v_xor_b32 v119, v119, v117
    v_lshl_add_u32 v119, v113, 6, v119
    v_and_b32 v119, 255, v119
    v_add_u32 v7, v118, v119
    v_add_u32 v11, 49152, v7
    v_subrev_u32 v121, 65536, v7
    v_lshl_add_u32 v119, v114, 4, s53
    v_add_u32 v119, 0, v119
    v_xor_b32 v119, v119, v117
    v_lshl_add_u32 v119, v113, 6, v119
    v_and_b32 v119, 255, v119
    v_add_u32 v8, v118, v119
    v_add_u32 v12, 49152, v8
    v_subrev_u32 v122, 65536, v8
    v_lshl_add_u32 v119, v114, 4, s53
    v_add_u32 v119, 8, v119
    v_xor_b32 v119, v119, v117
    v_lshl_add_u32 v119, v113, 6, v119
    v_and_b32 v119, 255, v119
    v_add_u32 v9, v118, v119
    v_add_u32 v13, 49152, v9
    v_subrev_u32 v123, 65536, v9
    s_waitcnt vmcnt(4)
    v_dot2c_f32_bf16 v96, s62, v32
    v_dot2c_f32_bf16 v97, v32, v32
    v_lshlrev_b32 v40, 16, v32
    v_and_b32 v41, s61, v32
    v_dot2c_f32_bf16 v96, s62, v33
    v_dot2c_f32_bf16 v97, v33, v33
    v_lshlrev_b32 v42, 16, v33
    v_and_b32 v43, s61, v33
    v_dot2c_f32_bf16 v96, s62, v34
    v_dot2c_f32_bf16 v97, v34, v34
    v_lshlrev_b32 v44, 16, v34
    v_and_b32 v45, s61, v34
    v_dot2c_f32_bf16 v96, s62, v35
    v_dot2c_f32_bf16 v97, v35, v35
    v_lshlrev_b32 v46, 16, v35
    v_and_b32 v47, s61, v35
    s_waitcnt vmcnt(3)
    v_dot2c_f32_bf16 v96, s62, v36
    v_dot2c_f32_bf16 v97, v36, v36
    v_lshlrev_b32 v48, 16, v36
    v_and_b32 v49, s61, v36
    v_dot2c_f32_bf16 v96, s62, v37
    v_dot2c_f32_bf16 v97, v37, v37
    v_lshlrev_b32 v50, 16, v37
    v_and_b32 v51, s61, v37
    v_dot2c_f32_bf16 v96, s62, v38
    v_dot2c_f32_bf16 v97, v38, v38
    v_lshlrev_b32 v52, 16, v38
    v_and_b32 v53, s61, v38
    v_dot2c_f32_bf16 v96, s62, v39
    v_dot2c_f32_bf16 v97, v39, v39
    v_lshlrev_b32 v54, 16, v39
    v_and_b32 v55, s61, v39
    buffer_load_dword v29, off, s[40:43], 0 sc1
    v_add_f32_dpp v96, v96, v96 quad_perm:[1,0,3,2] row_mask:0xf bank_mask:0xf
    v_add_f32_dpp v97, v97, v97 quad_perm:[1,0,3,2] row_mask:0xf bank_mask:0xf
    s_nop 0
    v_add_f32_dpp v96, v96, v96 quad_perm:[2,3,0,1] row_mask:0xf bank_mask:0xf
    v_add_f32_dpp v97, v97, v97 quad_perm:[2,3,0,1] row_mask:0xf bank_mask:0xf
    s_nop 0
    v_add_f32_dpp v96, v96, v96 row_half_mirror row_mask:0xf bank_mask:0xf
    v_add_f32_dpp v97, v97, v97 row_half_mirror row_mask:0xf bank_mask:0xf
    s_nop 0
    v_add_f32_dpp v96, v96, v96 row_mirror row_mask:0xf bank_mask:0xf
    v_add_f32_dpp v97, v97, v97 row_mirror row_mask:0xf bank_mask:0xf
    v_mov_b32 v98, v96
    v_mov_b32 v99, v97
    s_nop 0
    v_permlane16_swap_b32 v96, v98
    v_permlane16_swap_b32 v97, v99
    v_add_f32 v96, v96, v98
    v_add_f32 v97, v97, v99
    v_mul_f32 v98, 0x3b124925, v96
    v_mul_f32 v99, 0x3b124925, v97
    v_fma_f32 v99, -v98, v98, v99
    v_max_f32 v99, 0, v99
    v_cvt_pk_bf16_f32 v100, 0, v99
    v_add_f32 v100, 0x3727c5ac, v100
    v_cvt_pk_bf16_f32 v100, 0, v100
    v_sqrt_f32 v100, v100
    s_nop 0
    v_cvt_pk_bf16_f32 v100, 0, v100
    v_rcp_f32 v100, v100
    s_nop 0
    v_mul_f32 v99, v99, v100
    v_mul_f32 v102, v98, v100
    v_mul_f32 v99, v99, v100
    v_cvt_pk_bf16_f32 v104, 0, v99
    v_add_f32 v104, 0x3727c5ac, v104
    v_cvt_pk_bf16_f32 v104, 0, v104
    v_sqrt_f32 v104, v104
    s_nop 0
    v_cvt_pk_bf16_f32 v104, 0, v104
    v_rcp_f32 v104, v104
    s_nop 0
    v_mul_f32 v104, v104, v100
    v_mul_f32 v106, v98, v104
    v_pk_fma_f32 v[56:57], v[40:41], v[104:105], v[106:107] op_sel_hi:[1,0,0] neg_lo:[0,0,1] neg_hi:[0,0,1]
    v_pk_fma_f32 v[58:59], v[42:43], v[104:105], v[106:107] op_sel_hi:[1,0,0] neg_lo:[0,0,1] neg_hi:[0,0,1]
    v_pk_fma_f32 v[60:61], v[44:45], v[104:105], v[106:107] op_sel_hi:[1,0,0] neg_lo:[0,0,1] neg_hi:[0,0,1]
    v_pk_fma_f32 v[62:63], v[46:47], v[104:105], v[106:107] op_sel_hi:[1,0,0] neg_lo:[0,0,1] neg_hi:[0,0,1]
    v_pk_fma_f32 v[64:65], v[48:49], v[104:105], v[106:107] op_sel_hi:[1,0,0] neg_lo:[0,0,1] neg_hi:[0,0,1]
    v_pk_fma_f32 v[66:67], v[50:51], v[104:105], v[106:107] op_sel_hi:[1,0,0] neg_lo:[0,0,1] neg_hi:[0,0,1]
    v_pk_fma_f32 v[68:69], v[52:53], v[104:105], v[106:107] op_sel_hi:[1,0,0] neg_lo:[0,0,1] neg_hi:[0,0,1]
    v_pk_fma_f32 v[70:71], v[54:55], v[104:105], v[106:107] op_sel_hi:[1,0,0] neg_lo:[0,0,1] neg_hi:[0,0,1]
    v_cvt_pk_bf16_f32 v80, v56, v57
    v_cvt_pk_bf16_f32 v81, v58, v59
    v_cvt_pk_bf16_f32 v82, v60, v61
    v_cvt_pk_bf16_f32 v83, v62, v63
    v_cvt_pk_bf16_f32 v84, v64, v65
    v_cvt_pk_bf16_f32 v85, v66, v67
    v_cvt_pk_bf16_f32 v86, v68, v69
    v_cvt_pk_bf16_f32 v87, v70, v71
    ds_write_b128 v109, v[80:83] offset:49152
    ds_write_b128 v109, v[84:87] offset:49600
    v_pk_fma_f32 v[40:41], v[40:41], v[100:101], v[102:103] op_sel_hi:[1,0,0] neg_lo:[0,0,1] neg_hi:[0,0,1]
    v_pk_fma_f32 v[42:43], v[42:43], v[100:101], v[102:103] op_sel_hi:[1,0,0] neg_lo:[0,0,1] neg_hi:[0,0,1]
    v_pk_fma_f32 v[44:45], v[44:45], v[100:101], v[102:103] op_sel_hi:[1,0,0] neg_lo:[0,0,1] neg_hi:[0,0,1]
    v_pk_fma_f32 v[46:47], v[46:47], v[100:101], v[102:103] op_sel_hi:[1,0,0] neg_lo:[0,0,1] neg_hi:[0,0,1]
    v_pk_fma_f32 v[48:49], v[48:49], v[100:101], v[102:103] op_sel_hi:[1,0,0] neg_lo:[0,0,1] neg_hi:[0,0,1]
    v_pk_fma_f32 v[50:51], v[50:51], v[100:101], v[102:103] op_sel_hi:[1,0,0] neg_lo:[0,0,1] neg_hi:[0,0,1]
    v_pk_fma_f32 v[52:53], v[52:53], v[100:101], v[102:103] op_sel_hi:[1,0,0] neg_lo:[0,0,1] neg_hi:[0,0,1]
    v_pk_fma_f32 v[54:55], v[54:55], v[100:101], v[102:103] op_sel_hi:[1,0,0] neg_lo:[0,0,1] neg_hi:[0,0,1]
    v_cvt_pk_bf16_f32 v72, v40, v41
    v_cvt_pk_bf16_f32 v73, v42, v43
    v_cvt_pk_bf16_f32 v74, v44, v45
    v_cvt_pk_bf16_f32 v75, v46, v47
    v_cvt_pk_bf16_f32 v76, v48, v49
    v_cvt_pk_bf16_f32 v77, v50, v51
    v_cvt_pk_bf16_f32 v78, v52, v53
    v_cvt_pk_bf16_f32 v79, v54, v55
    s_waitcnt lgkmcnt(0)
    s_barrier
    ds_read_b64_tr_b16 v[88:89], v110 offset:49152
    ds_read_b64_tr_b16 v[90:91], v110 offset:52992
    ds_read_b64_tr_b16 v[92:93], v110 offset:49664
    ds_read_b64_tr_b16 v[94:95], v110 offset:53504
    buffer_store_dwordx4 v[72:75], v24, s[24:27], s66 offen offset:0 sc1
    buffer_store_dwordx4 v[76:79], v24, s[24:27], s66 offen offset:448 sc1
    s_waitcnt lgkmcnt(2)
    buffer_store_dwordx4 v[88:91], v111, s[24:27], s63 offen sc1
    s_waitcnt lgkmcnt(0)
    buffer_store_dwordx4 v[92:95], v111, s[24:27], s64 offen sc1
    s_mov_b32 s57, 10624
    buffer_load_dwordx4 v2, s[8:11], s57 offen offset:1024 lds
    v_lshrrev_b32 v119, 3, v1
    v_mul_u32_u24 v3, 896, v119
    v_xor_b32 v118, v119, v1
    v_and_b32 v118, 6, v118
    v_and_or_b32 v118, v1, 1, v118
    v_lshl_add_u32 v3, v118, 4, v3
    v_and_b32 v118, 6, v1
    v_xor_b32 v118, v118, v112
    s_add_u32 m0, s90, 73728
    s_mov_b32 s57, 86912
    buffer_load_dwordx4 v2, s[8:11], s57 offen offset:0 lds
    v_lshlrev_b32 v4, 7, v115
    v_lshl_add_u32 v4, v118, 4, v4
    v_xor_b32 v25, 64, v4
    s_lshl_b32 s53, s49, 4
    s_sub_u32 s53, s53, 2
    v_min_u32 v117, 17, v1
    v_add_u32 v117, s53, v117
    v_max_i32 v117, 0, v117
    v_lshlrev_b32 v19, 5, v117
    v_add_u32 v19, 12582912, v19
    v_and_b32 v117, 1, v115
    v_cmp_eq_u32 s[76:77], 1, v117
    v_lshl_add_u32 v117, v112, 2, v117
    v_cmp_le_u32 s[78:79], v117, v115
    v_add_u32 v117, 2, v117
    v_cmp_le_u32 s[80:81], v117, v115
    s_mov_b32 s57, 96640
    buffer_load_dwordx4 v2, s[8:11], s57 offen offset:1024 lds
    v_cmp_eq_u32 s[82:83], 3, v112
    v_mov_b32 v117, 0xffff
    v_mov_b32 v118, 0xffff0000
    v_cndmask_b32 v117, v117, v118, s[76:77]
    v_cndmask_b32 v14, v117, 0, s[78:79]
    v_cndmask_b32 v15, v117, 0, s[80:81]
    v_cndmask_b32 v16, 0, v117, s[78:79]
    v_cndmask_b32 v17, 0, v117, s[80:81]
    s_mov_b32 s91, 0x3e8b97f6
    v_mov_b32 v18, 0xf149f2ca
    s_lshl_b32 s53, s49, 3
    s_mul_i32 s72, s53, 14336
    s_add_u32 s72, s72, 6291456
    s_lshl_b32 s74, s53, 14
    s_lshl2_add_u32 s54, s48, s44
    s_lshl_b32 s54, s54, 10
    s_add_u32 m0, s90, 81920
    s_mov_b32 s57, 172928
    buffer_load_dwordx4 v2, s[8:11], s57 offen offset:0 lds
    s_add_u32 s74, s74, s54
    s_add_u32 s74, s74, 4177920
    s_lshl2_add_u32 s53, s44, 0
    s_lshl_b32 s54, s44, 8
    s_add_u32 s54, s54, 0
    s_cmp_lt_u32 s53, 14
    s_cselect_b32 s68, s54, 2130706432
    s_lshl2_add_u32 s53, s44, 1
    s_lshl_b32 s54, s44, 8
    s_add_u32 s54, s54, 6144
    s_cmp_lt_u32 s53, 14
    s_cselect_b32 s69, s54, 2130706432
    s_lshl2_add_u32 s53, s44, 2
    s_lshl_b32 s54, s44, 8
    s_add_u32 s54, s54, -1920
    s_cmp_lt_u32 s53, 14
    s_cselect_b32 s70, s54, 2130706432
    s_lshl2_add_u32 s53, s44, 3
    s_lshl_b32 s54, s44, 8
    s_add_u32 s54, s54, 4224
    s_cmp_lt_u32 s53, 14
    s_cselect_b32 s71, s54, 2130706432
    s_cmp_eq_u32 s49, 0
    s_cselect_b64 s[88:89], -1, 0
    s_mov_b32 s57, 182656
    buffer_load_dwordx4 v2, s[8:11], s57 offen offset:1024 lds
    s_add_u32 m0, s90, 90112
    s_mov_b32 s57, 258944
    buffer_load_dwordx4 v2, s[8:11], s57 offen offset:0 lds
    s_mov_b32 s57, 268672
    buffer_load_dwordx4 v2, s[8:11], s57 offen offset:1024 lds
    s_add_u32 m0, s90, 98304
    s_mov_b32 s57, 344960
    buffer_load_dwordx4 v2, s[8:11], s57 offen offset:0 lds
    s_mov_b32 s57, 354688
    buffer_load_dwordx4 v2, s[8:11], s57 offen offset:1024 lds
    s_add_u32 m0, s90, 106496
    s_mov_b32 s57, 430976
    buffer_load_dwordx4 v2, s[8:11], s57 offen offset:0 lds
    s_mov_b32 s57, 440704
    buffer_load_dwordx4 v2, s[8:11], s57 offen offset:1024 lds
    s_add_u32 m0, s90, 114688
    s_mov_b32 s57, 516992
    buffer_load_dwordx4 v2, s[8:11], s57 offen offset:0 lds
    s_mov_b32 s57, 526720
    buffer_load_dwordx4 v2, s[8:11], s57 offen offset:1024 lds
    s_waitcnt vmcnt(13)
    v_cmp_eq_u32 vcc, 0, v29
    s_nop 0
    s_cbranch_vccz L_ok12
    s_mov_b32 s59, 20000
L_spin11:
    buffer_load_dword v29, off, s[40:43], 0 sc1
    s_waitcnt vmcnt(0)
    v_cmp_eq_u32 vcc, 0, v29
    s_nop 0
    s_cbranch_vccz L_ok12
    s_sub_u32 s59, s59, 1
    s_cbranch_scc0 L_spin11
L_ok12:
    v_readfirstlane_b32 s47, v29
    s_barrier
    s_cmp_lg_u32 s44, 0
    s_cbranch_scc1 L_nopub13
    s_lshl_b32 s60, s2, 5
    s_add_u32 s60, s60, 12582912
    v_mov_b32 v30, s47
    s_mov_b64 exec, 1
    buffer_store_dword v30, off, s[24:27], s60 sc1
    s_mov_b64 exec, -1
L_nopub13:
    s_add_u32 m0, s90, 122880
    s_mov_b32 s57, 603008
    buffer_load_dwordx4 v2, s[8:11], s57 offen offset:0 lds
    s_mov_b32 s57, 612736
    buffer_load_dwordx4 v2, s[8:11], s57 offen offset:1024 lds
    s_waitcnt vmcnt(10)
    s_barrier
    s_add_u32 m0, s90, 131072
    s_mov_b32 s57, 689024
    buffer_load_dwordx4 v2, s[8:11], s57 offen offset:0 lds
    s_mov_b32 s57, 698752
    buffer_load_dwordx4 v2, s[8:11], s57 offen offset:1024 lds
    ds_read_b64_tr_b16 a[8:9], v6 offset:0
    ds_read_b64_tr_b16 a[10:11], v6 offset:1024
    ds_read_b64_tr_b16 a[12:13], v7 offset:0
    ds_read_b64_tr_b16 a[14:15], v7 offset:1024
    s_add_u32 m0, s90, 139264
    s_mov_b32 s57, 775040
    buffer_load_dwordx4 v2, s[8:11], s57 offen offset:0 lds
    s_mov_b32 s57, 784768
    buffer_load_dwordx4 v2, s[8:11], s57 offen offset:1024 lds
    ds_read_b64_tr_b16 a[32:33], v6 offset:8192
    ds_read_b64_tr_b16 a[34:35], v6 offset:9216
    ds_read_b64_tr_b16 a[36:37], v7 offset:8192
    ds_read_b64_tr_b16 a[38:39], v7 offset:9216
    s_add_u32 m0, s90, 147456
    s_mov_b32 s57, 861056
    buffer_load_dwordx4 v2, s[8:11], s57 offen offset:0 lds
    s_mov_b32 s57, 870784
    buffer_load_dwordx4 v2, s[8:11], s57 offen offset:1024 lds
    ds_read_b64_tr_b16 a[56:57], v6 offset:16384
    ds_read_b64_tr_b16 a[58:59], v6 offset:17408
    ds_read_b64_tr_b16 a[60:61], v7 offset:16384
    ds_read_b64_tr_b16 a[62:63], v7 offset:17408
    s_waitcnt vmcnt(10)
    s_waitcnt lgkmcnt(0)
    s_barrier
    s_add_u32 m0, s90, 155648
    s_mov_b32 s57, 947072
    buffer_load_dwordx4 v2, s[8:11], s57 offen offset:0 lds
    s_mov_b32 s57, 956800
    buffer_load_dwordx4 v2, s[8:11], s57 offen offset:1024 lds
    ds_read_b64_tr_b16 a[80:81], v6 offset:24576
    ds_read_b64_tr_b16 a[82:83], v6 offset:25600
    ds_read_b64_tr_b16 a[84:85], v7 offset:24576
    ds_read_b64_tr_b16 a[86:87], v7 offset:25600
    s_add_u32 m0, s90, 0
    s_mov_b32 s57, 1033088
    buffer_load_dwordx4 v2, s[8:11], s57 offen offset:0 lds
    s_mov_b32 s57, 1042816
    buffer_load_dwordx4 v2, s[8:11], s57 offen offset:1024 lds
    ds_read_b64_tr_b16 a[104:105], v6 offset:32768
    ds_read_b64_tr_b16 a[106:107], v6 offset:33792
    ds_read_b64_tr_b16 a[108:109], v7 offset:32768
    ds_read_b64_tr_b16 a[110:111], v7 offset:33792
    s_add_u32 m0, s90, 8192
    s_mov_b32 s57, 1119104
    buffer_load_dwordx4 v2, s[8:11], s57 offen offset:0 lds
    s_mov_b32 s57, 1128832
    buffer_load_dwordx4 v2, s[8:11], s57 offen offset:1024 lds
    ds_read_b64_tr_b16 a[128:129], v6 offset:40960
    ds_read_b64_tr_b16 a[130:131], v6 offset:41984
    ds_read_b64_tr_b16 a[132:133], v7 offset:40960
    ds_read_b64_tr_b16 a[134:135], v7 offset:41984
    s_waitcnt vmcnt(10)
    s_waitcnt lgkmcnt(0)
    s_barrier
    s_add_u32 m0, s90, 16384
    s_mov_b32 s57, 1792
    buffer_load_dwordx4 v2, s[8:11], s57 offen offset:0 lds
    s_mov_b32 s57, 11520
    buffer_load_dwordx4 v2, s[8:11], s57 offen offset:1024 lds
    ds_read_b64_tr_b16 a[152:153], v10 offset:0
    ds_read_b64_tr_b16 a[154:155], v10 offset:1024
    ds_read_b64_tr_b16 a[156:157], v11 offset:0
    ds_read_b64_tr_b16 a[158:159], v11 offset:1024
    s_add_u32 m0, s90, 24576
    s_mov_b32 s57, 87808
    buffer_load_dwordx4 v2, s[8:11], s57 offen offset:0 lds
    s_mov_b32 s57, 97536
    buffer_load_dwordx4 v2, s[8:11], s57 offen offset:1024 lds
    ds_read_b64_tr_b16 a[176:177], v10 offset:8192
    ds_read_b64_tr_b16 a[178:179], v10 offset:9216
    ds_read_b64_tr_b16 a[180:181], v11 offset:8192
    ds_read_b64_tr_b16 a[182:183], v11 offset:9216
    s_add_u32 m0, s90, 32768
    s_mov_b32 s57, 173824
    buffer_load_dwordx4 v2, s[8:11], s57 offen offset:0 lds
    s_mov_b32 s57, 183552
    buffer_load_dwordx4 v2, s[8:11], s57 offen offset:1024 lds
    ds_read_b64_tr_b16 a[200:201], v10 offset:16384
    ds_read_b64_tr_b16 a[202:203], v10 offset:17408
    ds_read_b64_tr_b16 a[204:205], v11 offset:16384
    ds_read_b64_tr_b16 a[206:207], v11 offset:17408
    s_waitcnt vmcnt(10)
    s_waitcnt lgkmcnt(0)
    s_barrier
    s_add_u32 m0, s90, 40960
    s_mov_b32 s57, 259840
    buffer_load_dwordx4 v2, s[8:11], s57 offen offset:0 lds
    s_mov_b32 s57, 269568
    buffer_load_dwordx4 v2, s[8:11], s57 offen offset:1024 lds
    ds_read_b64_tr_b16 a[224:225], v10 offset:24576
    ds_read_b64_tr_b16 a[226:227], v10 offset:25600
    ds_read_b64_tr_b16 a[228:229], v11 offset:24576
    ds_read_b64_tr_b16 a[230:231], v11 offset:25600
    s_add_u32 m0, s90, 65536
    s_mov_b32 s57, 345856
    buffer_load_dwordx4 v2, s[8:11], s57 offen offset:0 lds
    s_mov_b32 s57, 355584
    buffer_load_dwordx4 v2, s[8:11], s57 offen offset:1024 lds
    ds_read_b64_tr_b16 a[248:249], v10 offset:32768
    ds_read_b64_tr_b16 a[250:251], v10 offset:33792
    ds_read_b64_tr_b16 a[252:253], v11 offset:32768
    ds_read_b64_tr_b16 a[254:255], v11 offset:33792
    s_add_u32 m0, s90, 73728
    s_mov_b32 s57, 431872
    buffer_load_dwordx4 v2, s[8:11], s57 offen offset:0 lds
    s_mov_b32 s57, 441600
    buffer_load_dwordx4 v2, s[8:11], s57 offen offset:1024 lds
    ds_read_b64_tr_b16 v[192:193], v10 offset:40960
    ds_read_b64_tr_b16 v[194:195], v10 offset:41984
    ds_read_b64_tr_b16 v[196:197], v11 offset:40960
    ds_read_b64_tr_b16 v[198:199], v11 offset:41984
    s_waitcnt vmcnt(10)
    s_waitcnt lgkmcnt(0)
    s_barrier
    ds_read_b64_tr_b16 v[216:217], v120 offset:0
    ds_read_b64_tr_b16 v[218:219], v120 offset:1024
    ds_read_b64_tr_b16 v[220:221], v121 offset:0
    ds_read_b64_tr_b16 v[222:223], v121 offset:1024
    ds_read_b64_tr_b16 v[240:241], v120 offset:8192
    ds_read_b64_tr_b16 v[242:243], v120 offset:9216
    ds_read_b64_tr_b16 v[244:245], v121 offset:8192
    ds_read_b64_tr_b16 v[246:247], v121 offset:9216
    s_add_u32 m0, s90, 81920
    s_mov_b32 s57, 517888
    buffer_load_dwordx4 v2, s[8:11], s57 offen offset:0 lds
    ds_read_b64_tr_b16 a[16:17], v122 offset:16384
    ds_read_b64_tr_b16 a[18:19], v122 offset:17408
    ds_read_b64_tr_b16 a[20:21], v123 offset:16384
    ds_read_b64_tr_b16 a[22:23], v123 offset:17408
    s_mov_b32 s57, 527616
    buffer_load_dwordx4 v2, s[8:11], s57 offen offset:1024 lds
    s_add_u32 m0, s90, 90112
    s_mov_b32 s57, 603904
    buffer_load_dwordx4 v2, s[8:11], s57 offen offset:0 lds
    s_mov_b32 s57, 613632
    buffer_load_dwordx4 v2, s[8:11], s57 offen offset:1024 lds
    s_add_u32 m0, s90, 98304
    s_mov_b32 s57, 689920
    buffer_load_dwordx4 v2, s[8:11], s57 offen offset:0 lds
    s_mov_b32 s57, 699648
    buffer_load_dwordx4 v2, s[8:11], s57 offen offset:1024 lds
    s_waitcnt vmcnt(10)
    s_waitcnt lgkmcnt(0)
    s_barrier
    ds_read_b64_tr_b16 a[40:41], v122 offset:24576
    ds_read_b64_tr_b16 a[42:43], v122 offset:25600
    ds_read_b64_tr_b16 a[44:45], v123 offset:24576
    ds_read_b64_tr_b16 a[46:47], v123 offset:25600
    ds_read_b64_tr_b16 a[64:65], v122 offset:32768
    ds_read_b64_tr_b16 a[66:67], v122 offset:33792
    ds_read_b64_tr_b16 a[68:69], v123 offset:32768
    ds_read_b64_tr_b16 a[70:71], v123 offset:33792
    ds_read_b64_tr_b16 a[88:89], v122 offset:40960
    ds_read_b64_tr_b16 a[90:91], v122 offset:41984
    ds_read_b64_tr_b16 a[92:93], v123 offset:40960
    ds_read_b64_tr_b16 a[94:95], v123 offset:41984
    s_add_u32 m0, s90, 106496
    s_mov_b32 s57, 775936
    buffer_load_dwordx4 v2, s[8:11], s57 offen offset:0 lds
    s_mov_b32 s57, 785664
    buffer_load_dwordx4 v2, s[8:11], s57 offen offset:1024 lds
    buffer_load_dword v21, v19, s[24:27], 0 offen sc1
    s_add_u32 m0, s90, 114688
    s_mov_b32 s57, 861952
    buffer_load_dwordx4 v2, s[8:11], s57 offen offset:0 lds
    s_mov_b32 s57, 871680
    buffer_load_dwordx4 v2, s[8:11], s57 offen offset:1024 lds
    s_add_u32 m0, s90, 122880
    s_mov_b32 s57, 947968
    buffer_load_dwordx4 v2, s[8:11], s57 offen offset:0 lds
    s_waitcnt vmcnt(10)
    s_waitcnt lgkmcnt(0)
    s_barrier
    ds_read_b64_tr_b16 a[112:113], v8 offset:0
    ds_read_b64_tr_b16 a[114:115], v8 offset:1024
    ds_read_b64_tr_b16 a[116:117], v9 offset:0
    ds_read_b64_tr_b16 a[118:119], v9 offset:1024
    ds_read_b64_tr_b16 a[136:137], v8 offset:8192
    ds_read_b64_tr_b16 a[138:139], v8 offset:9216
    ds_read_b64_tr_b16 a[140:141], v9 offset:8192
    ds_read_b64_tr_b16 a[142:143], v9 offset:9216
    ds_read_b64_tr_b16 a[160:161], v8 offset:16384
    ds_read_b64_tr_b16 a[162:163], v8 offset:17408
    ds_read_b64_tr_b16 a[164:165], v9 offset:16384
    ds_read_b64_tr_b16 a[166:167], v9 offset:17408
    s_mov_b32 s57, 957696
    buffer_load_dwordx4 v2, s[8:11], s57 offen offset:1024 lds
    s_add_u32 m0, s90, 131072
    s_mov_b32 s57, 1033984
    buffer_load_dwordx4 v2, s[8:11], s57 offen offset:0 lds
    s_mov_b32 s57, 1043712
    buffer_load_dwordx4 v2, s[8:11], s57 offen offset:1024 lds
    s_waitcnt vmcnt(6)
    v_cmp_ne_u32 vcc, s47, v21
    s_nop 0
    s_cbranch_vccz L_ok15
    s_mov_b32 s59, 20000
L_spin14:
    buffer_load_dword v21, v19, s[24:27], 0 offen sc1
    s_waitcnt vmcnt(0)
    v_cmp_ne_u32 vcc, s47, v21
    s_nop 0
    s_cbranch_vccz L_ok15
    s_sub_u32 s59, s59, 1
    s_cbranch_scc0 L_spin14
L_ok15:
    s_add_u32 m0, s52, 0
    s_sub_u32 s58, s72, 14336
    s_max_u32 s58, s58, 6291456
    s_add_u32 s57, s58, s68
    buffer_load_dwordx4 v3, s[24:27], s57 offen offset:0 sc1 lds
    s_add_u32 s57, s58, s69
    buffer_load_dwordx4 v3, s[24:27], s57 offen offset:1024 sc1 lds
    s_add_u32 s57, s58, s70
    buffer_load_dwordx4 v3, s[24:27], s57 offen offset:2048 sc1 lds
    s_waitcnt lgkmcnt(0)
    s_barrier
    ds_read_b64_tr_b16 a[184:185], v8 offset:24576
    ds_read_b64_tr_b16 a[186:187], v8 offset:25600
    ds_read_b64_tr_b16 a[188:189], v9 offset:24576
    ds_read_b64_tr_b16 a[190:191], v9 offset:25600
    ds_read_b64_tr_b16 a[208:209], v8 offset:32768
    ds_read_b64_tr_b16 a[210:211], v8 offset:33792
    ds_read_b64_tr_b16 a[212:213], v9 offset:32768
    ds_read_b64_tr_b16 a[214:215], v9 offset:33792
    ds_read_b64_tr_b16 a[232:233], v8 offset:40960
    ds_read_b64_tr_b16 a[234:235], v8 offset:41984
    ds_read_b64_tr_b16 a[236:237], v9 offset:40960
    ds_read_b64_tr_b16 a[238:239], v9 offset:41984
    s_add_u32 s57, s58, s71
    buffer_load_dwordx4 v3, s[24:27], s57 offen offset:3072 sc1 lds
    s_add_u32 m0, s52, 16384
    s_add_u32 s58, s72, 0
    s_add_u32 s57, s58, s68
    buffer_load_dwordx4 v3, s[24:27], s57 offen offset:0 sc1 lds
    s_add_u32 s57, s58, s69
    buffer_load_dwordx4 v3, s[24:27], s57 offen offset:1024 sc1 lds
    s_add_u32 s57, s58, s70
    buffer_load_dwordx4 v3, s[24:27], s57 offen offset:2048 sc1 lds
    s_add_u32 s57, s58, s71
    buffer_load_dwordx4 v3, s[24:27], s57 offen offset:3072 sc1 lds
    s_add_u32 m0, s90, 139264
    s_mov_b32 s57, 1120000
    buffer_load_dwordx4 v2, s[8:11], s57 offen offset:0 lds
    s_mov_b32 s57, 1129728
    buffer_load_dwordx4 v2, s[8:11], s57 offen offset:1024 lds
    s_waitcnt vmcnt(10)
    s_waitcnt lgkmcnt(0)
    s_barrier
    ds_read_b64_tr_b16 v[176:177], v12 offset:0
    ds_read_b64_tr_b16 v[178:179], v12 offset:1024
    ds_read_b64_tr_b16 v[180:181], v13 offset:0
    ds_read_b64_tr_b16 v[182:183], v13 offset:1024
    ds_read_b64_tr_b16 v[200:201], v12 offset:8192
    ds_read_b64_tr_b16 v[202:203], v12 offset:9216
    ds_read_b64_tr_b16 v[204:205], v13 offset:8192
    ds_read_b64_tr_b16 v[206:207], v13 offset:9216
    ds_read_b64_tr_b16 v[224:225], v12 offset:16384
    ds_read_b64_tr_b16 v[226:227], v12 offset:17408
    ds_read_b64_tr_b16 v[228:229], v13 offset:16384
    ds_read_b64_tr_b16 v[230:231], v13 offset:17408
    s_add_u32 m0, s90, 147456
    s_mov_b32 s57, 0
    buffer_load_dwordx4 v2, s[8:11], s57 offen offset:0 lds
    s_mov_b32 s57, 9728
    buffer_load_dwordx4 v2, s[8:11], s57 offen offset:1024 lds
    s_add_u32 m0, s90, 155648
    s_mov_b32 s57, 86016
    buffer_load_dwordx4 v2, s[8:11], s57 offen offset:0 lds
    s_mov_b32 s57, 95744
    buffer_load_dwordx4 v2, s[8:11], s57 offen offset:1024 lds
    s_add_u32 m0, s90, 65536
    s_mov_b32 s57, 172032
    buffer_load_dwordx4 v2, s[8:11], s57 offen offset:0 lds
    s_mov_b32 s57, 181760
    buffer_load_dwordx4 v2, s[8:11], s57 offen offset:1024 lds
    s_add_u32 m0, s90, 73728
    s_mov_b32 s57, 258048
    buffer_load_dwordx4 v2, s[8:11], s57 offen offset:0 lds
    s_mov_b32 s57, 267776
    buffer_load_dwordx4 v2, s[8:11], s57 offen offset:1024 lds
    s_add_u32 m0, s90, 81920
    s_mov_b32 s57, 344064
    buffer_load_dwordx4 v2, s[8:11], s57 offen offset:0 lds
    s_mov_b32 s57, 353792
    buffer_load_dwordx4 v2, s[8:11], s57 offen offset:1024 lds
    s_add_u32 m0, s90, 90112
    s_mov_b32 s57, 430080
    buffer_load_dwordx4 v2, s[8:11], s57 offen offset:0 lds
    s_mov_b32 s57, 439808
    buffer_load_dwordx4 v2, s[8:11], s57 offen offset:1024 lds
    s_add_u32 m0, s90, 98304
    s_mov_b32 s57, 516096
    buffer_load_dwordx4 v2, s[8:11], s57 offen offset:0 lds
    s_mov_b32 s57, 525824
    buffer_load_dwordx4 v2, s[8:11], s57 offen offset:1024 lds
    s_waitcnt vmcnt(10)
    s_waitcnt lgkmcnt(0)
    s_barrier
    ds_read_b64_tr_b16 v[248:249], v12 offset:24576
    ds_read_b64_tr_b16 v[250:251], v12 offset:25600
    ds_read_b64_tr_b16 v[252:253], v13 offset:24576
    ds_read_b64_tr_b16 v[254:255], v13 offset:25600
    ds_read_b64_tr_b16 a[0:1], v10 offset:32768
    ds_read_b64_tr_b16 a[2:3], v10 offset:33792
    ds_read_b64_tr_b16 a[4:5], v11 offset:32768
    ds_read_b64_tr_b16 a[6:7], v11 offset:33792
    ds_read_b64_tr_b16 a[24:25], v10 offset:40960
    ds_read_b64_tr_b16 a[26:27], v10 offset:41984
    ds_read_b64_tr_b16 a[28:29], v11 offset:40960
    ds_read_b64_tr_b16 a[30:31], v11 offset:41984
    s_add_u32 m0, s90, 106496
    s_mov_b32 s57, 602112
    buffer_load_dwordx4 v2, s[8:11], s57 offen offset:0 lds
    ds_read_b128 v[120:123], v4 offset:0
    ds_read_b128 v[124:127], v25 offset:0
    ds_read_b128 v[128:131], v4 offset:2048
    ds_read_b128 v[132:135], v25 offset:2048
    ds_read_b128 v[136:139], v4 offset:4096
    ds_read_b128 v[140:143], v25 offset:4096
    ds_read_b128 v[144:147], v4 offset:6144
    ds_read_b128 v[148:151], v25 offset:6144
    ds_read_b128 v[152:155], v4 offset:8192
    ds_read_b128 v[156:159], v25 offset:8192
    ds_read_b128 v[160:163], v4 offset:10240
    ds_read_b128 v[164:167], v25 offset:10240
    ds_read_b128 v[168:171], v4 offset:12288
    ds_read_b128 v[172:175], v25 offset:12288
    s_waitcnt lgkmcnt(13)
    v_mfma_f32_16x16x32_bf16 v[104:107], a[8:11], v[120:123], 0
    s_mov_b32 s57, 611840
    buffer_load_dwordx4 v2, s[8:11], s57 offen offset:1024 lds
    s_waitcnt lgkmcnt(12)
    v_mfma_f32_16x16x32_bf16 v[104:107], a[32:35], v[124:127], v[104:107]
    s_waitcnt lgkmcnt(11)
    v_mfma_f32_16x16x32_bf16 v[104:107], a[56:59], v[128:131], v[104:107]
    s_waitcnt lgkmcnt(10)
    v_mfma_f32_16x16x32_bf16 v[104:107], a[80:83], v[132:135], v[104:107]
    s_waitcnt lgkmcnt(9)
    v_mfma_f32_16x16x32_bf16 v[104:107], a[104:107], v[136:139], v[104:107]
    s_add_u32 m0, s90, 114688
    s_mov_b32 s57, 688128
    buffer_load_dwordx4 v2, s[8:11], s57 offen offset:0 lds
    s_waitcnt lgkmcnt(8)
    v_mfma_f32_16x16x32_bf16 v[104:107], a[128:131], v[140:143], v[104:107]
    s_waitcnt lgkmcnt(7)
    v_mfma_f32_16x16x32_bf16 v[104:107], a[152:155], v[144:147], v[104:107]
    s_waitcnt lgkmcnt(6)
    v_mfma_f32_16x16x32_bf16 v[104:107], a[176:179], v[148:151], v[104:107]
    s_waitcnt lgkmcnt(5)
    v_mfma_f32_16x16x32_bf16 v[104:107], a[200:203], v[152:155], v[104:107]
    s_mov_b32 s57, 697856
    buffer_load_dwordx4 v2, s[8:11], s57 offen offset:1024 lds
    s_waitcnt lgkmcnt(4)
    v_mfma_f32_16x16x32_bf16 v[104:107], a[224:227], v[156:159], v[104:107]
    s_waitcnt lgkmcnt(3)
    v_mfma_f32_16x16x32_bf16 v[104:107], a[248:251], v[160:163], v[104:107]
    s_waitcnt lgkmcnt(2)
    v_mfma_f32_16x16x32_bf16 v[104:107], v[192:195], v[164:167], v[104:107]
    s_waitcnt lgkmcnt(1)
    v_mfma_f32_16x16x32_bf16 v[104:107], v[216:219], v[168:171], v[104:107]
    s_add_u32 m0, s90, 122880
    s_mov_b32 s57, 774144
    buffer_load_dwordx4 v2, s[8:11], s57 offen offset:0 lds
    s_waitcnt lgkmcnt(0)
    v_mfma_f32_16x16x32_bf16 v[104:107], v[240:243], v[172:175], v[104:107]
    v_mfma_f32_16x16x32_bf16 v[108:111], a[12:15], v[120:123], 0
    v_mfma_f32_16x16x32_bf16 v[108:111], a[36:39], v[124:127], v[108:111]
    s_mov_b32 s57, 783872
    buffer_load_dwordx4 v2, s[8:11], s57 offen offset:1024 lds
    s_waitcnt vmcnt(10)
    s_barrier
    ds_read_b64_tr_b16 a[48:49], v6 offset:0
    ds_read_b64_tr_b16 a[50:51], v6 offset:1024
    ds_read_b64_tr_b16 a[52:53], v7 offset:0
    ds_read_b64_tr_b16 a[54:55], v7 offset:1024
    v_mfma_f32_16x16x32_bf16 v[108:111], a[60:63], v[128:131], v[108:111]
    v_mfma_f32_16x16x32_bf16 v[108:111], a[84:87], v[132:135], v[108:111]
    s_add_u32 m0, s90, 131072
    s_mov_b32 s57, 860160
    buffer_load_dwordx4 v2, s[8:11], s57 offen offset:0 lds
    v_mfma_f32_16x16x32_bf16 v[108:111], a[108:111], v[136:139], v[108:111]
    v_mfma_f32_16x16x32_bf16 v[108:111], a[132:135], v[140:143], v[108:111]
    v_mfma_f32_16x16x32_bf16 v[108:111], a[156:159], v[144:147], v[108:111]
    v_mfma_f32_16x16x32_bf16 v[108:111], a[180:183], v[148:151], v[108:111]
    s_mov_b32 s57, 869888
    buffer_load_dwordx4 v2, s[8:11], s57 offen offset:1024 lds
    v_mfma_f32_16x16x32_bf16 v[108:111], a[204:207], v[152:155], v[108:111]
    v_cvt_pk_bf16_f32 v36, v104, v105
    v_cvt_pk_bf16_f32 v37, v106, v107
    v_mfma_f32_16x16x32_bf16 v[108:111], a[228:231], v[156:159], v[108:111]
    ds_read_b64_tr_b16 a[72:73], v6 offset:8192
    ds_read_b64_tr_b16 a[74:75], v6 offset:9216
    ds_read_b64_tr_b16 a[76:77], v7 offset:8192
    ds_read_b64_tr_b16 a[78:79], v7 offset:9216
    v_mfma_f32_16x16x32_bf16 v[108:111], a[252:255], v[160:163], v[108:111]
    s_add_u32 m0, s90, 139264
    s_mov_b32 s57, 946176
    buffer_load_dwordx4 v2, s[8:11], s57 offen offset:0 lds
    v_mfma_f32_16x16x32_bf16 v[108:111], v[196:199], v[164:167], v[108:111]
    v_mfma_f32_16x16x32_bf16 v[108:111], v[220:223], v[168:171], v[108:111]
    v_mfma_f32_16x16x32_bf16 v[108:111], v[244:247], v[172:175], v[108:111]
    v_mfma_f32_16x16x32_bf16 v[112:115], v[120:123], a[16:19], 0
    s_mov_b32 s57, 955904
    buffer_load_dwordx4 v2, s[8:11], s57 offen offset:1024 lds
    v_mfma_f32_16x16x32_bf16 v[112:115], v[124:127], a[40:43], v[112:115]
    v_mfma_f32_16x16x32_bf16 v[112:115], v[128:131], a[64:67], v[112:115]
    v_mfma_f32_16x16x32_bf16 v[112:115], v[132:135], a[88:91], v[112:115]
    ds_read_b64_tr_b16 a[96:97], v6 offset:16384
    ds_read_b64_tr_b16 a[98:99], v6 offset:17408
    ds_read_b64_tr_b16 a[100:101], v7 offset:16384
    ds_read_b64_tr_b16 a[102:103], v7 offset:17408
    s_add_u32 m0, s90, 147456
    s_mov_b32 s57, 1032192
    buffer_load_dwordx4 v2, s[8:11], s57 offen offset:0 lds
    v_mfma_f32_16x16x32_bf16 v[112:115], v[136:139], a[112:115], v[112:115]
    v_mfma_f32_16x16x32_bf16 v[112:115], v[140:143], a[136:139], v[112:115]
    v_mfma_f32_16x16x32_bf16 v[112:115], v[144:147], a[160:163], v[112:115]
    v_mfma_f32_16x16x32_bf16 v[112:115], v[148:151], a[184:187], v[112:115]
    s_mov_b32 s57, 1041920
    buffer_load_dwordx4 v2, s[8:11], s57 offen offset:1024 lds
    v_mfma_f32_16x16x32_bf16 v[112:115], v[152:155], a[208:211], v[112:115]
    v_cvt_pk_bf16_f32 v38, v108, v109
    v_cvt_pk_bf16_f32 v39, v110, v111
    v_mfma_f32_16x16x32_bf16 v[112:115], v[156:159], a[232:235], v[112:115]
    v_cndmask_b32 v38, v38, 0, s[82:83]
    v_cndmask_b32 v39, v39, 0, s[82:83]
    v_mfma_f32_16x16x32_bf16 v[112:115], v[160:163], v[176:179], v[112:115]
    v_mfma_f32_16x16x32_bf16 v[112:115], v[164:167], v[200:203], v[112:115]
    s_add_u32 m0, s90, 155648
    s_mov_b32 s57, 1118208
    buffer_load_dwordx4 v2, s[8:11], s57 offen offset:0 lds
    s_waitcnt vmcnt(11)
    s_waitcnt lgkmcnt(0)
    s_barrier
    ds_read_b64_tr_b16 a[120:121], v6 offset:24576
    ds_read_b64_tr_b16 a[122:123], v6 offset:25600
    ds_read_b64_tr_b16 a[124:125], v7 offset:24576
    ds_read_b64_tr_b16 a[126:127], v7 offset:25600
    v_mfma_f32_16x16x32_bf16 v[112:115], v[168:171], v[224:227], v[112:115]
    v_mfma_f32_16x16x32_bf16 v[112:115], v[172:175], v[248:251], v[112:115]
    s_mov_b32 s57, 1127936
    buffer_load_dwordx4 v2, s[8:11], s57 offen offset:1024 lds
    v_mfma_f32_16x16x32_bf16 v[116:119], v[120:123], a[20:23], 0
    ds_read_b128 v[120:123], v4 offset:16384
    v_mfma_f32_16x16x32_bf16 v[116:119], v[124:127], a[44:47], v[116:119]
    ds_read_b128 v[124:127], v25 offset:16384
    v_mfma_f32_16x16x32_bf16 v[116:119], v[128:131], a[68:71], v[116:119]
    ds_read_b128 v[128:131], v4 offset:18432
    v_mfma_f32_16x16x32_bf16 v[116:119], v[132:135], a[92:95], v[116:119]
    ds_read_b128 v[132:135], v25 offset:18432
    s_add_u32 m0, s52, 32768
    s_add_u32 s58, s72, 14336
    s_add_u32 s57, s58, s68
    buffer_load_dwordx4 v3, s[24:27], s57 offen offset:0 sc1 lds
    v_mfma_f32_16x16x32_bf16 v[116:119], v[136:139], a[116:119], v[116:119]
    ds_read_b128 v[136:139], v4 offset:20480
    v_mfma_f32_16x16x32_bf16 v[116:119], v[140:143], a[140:143], v[116:119]
    ds_read_b128 v[140:143], v25 offset:20480
    ds_read_b64_tr_b16 a[144:145], v6 offset:32768
    ds_read_b64_tr_b16 a[146:147], v6 offset:33792
    ds_read_b64_tr_b16 a[148:149], v7 offset:32768
    ds_read_b64_tr_b16 a[150:151], v7 offset:33792
    v_mfma_f32_16x16x32_bf16 v[116:119], v[144:147], a[164:167], v[116:119]
    ds_read_b128 v[144:147], v4 offset:22528
    s_add_u32 s57, s58, s69
    buffer_load_dwordx4 v3, s[24:27], s57 offen offset:1024 sc1 lds
    v_mfma_f32_16x16x32_bf16 v[116:119], v[148:151], a[188:191], v[116:119]
    ds_read_b128 v[148:151], v25 offset:22528
    v_mfma_f32_16x16x32_bf16 v[116:119], v[152:155], a[212:215], v[116:119]
    v_cvt_pk_bf16_f32 v44, v112, v113
    v_cvt_pk_bf16_f32 v45, v114, v115
    ds_read_b128 v[152:155], v4 offset:24576
    v_mfma_f32_16x16x32_bf16 v[116:119], v[156:159], a[236:239], v[116:119]
    ds_read_b128 v[156:159], v25 offset:24576
    v_mfma_f32_16x16x32_bf16 v[116:119], v[160:163], v[180:183], v[116:119]
    ds_read_b128 v[160:163], v4 offset:26624
    s_add_u32 s57, s58, s70
    buffer_load_dwordx4 v3, s[24:27], s57 offen offset:2048 sc1 lds
    v_mfma_f32_16x16x32_bf16 v[116:119], v[164:167], v[204:207], v[116:119]
    ds_read_b128 v[164:167], v25 offset:26624
    v_mfma_f32_16x16x32_bf16 v[116:119], v[168:171], v[228:231], v[116:119]
    ds_read_b128 v[168:171], v4 offset:28672
    v_mfma_f32_16x16x32_bf16 v[116:119], v[172:175], v[252:255], v[116:119]
    ds_read_b128 v[172:175], v25 offset:28672
    ds_read_b64_tr_b16 a[168:169], v6 offset:40960
    ds_read_b64_tr_b16 a[170:171], v6 offset:41984
    ds_read_b64_tr_b16 a[172:173], v7 offset:40960
    ds_read_b64_tr_b16 a[174:175], v7 offset:41984
    s_add_u32 s57, s58, s71
    buffer_load_dwordx4 v3, s[24:27], s57 offen offset:3072 sc1 lds
    s_waitcnt lgkmcnt(15)
    v_mfma_f32_16x16x32_bf16 v[104:107], a[8:11], v[120:123], 0
    v_mfma_f32_16x16x32_bf16 v[104:107], a[32:35], v[124:127], v[104:107]
    v_mfma_f32_16x16x32_bf16 v[104:107], a[56:59], v[128:131], v[104:107]
    v_mfma_f32_16x16x32_bf16 v[104:107], a[80:83], v[132:135], v[104:107]
    s_add_u32 m0, s52, 49152
    s_add_u32 s58, s72, 28672
    s_add_u32 s57, s58, s68
    buffer_load_dwordx4 v3, s[24:27], s57 offen offset:0 sc1 lds
    v_mfma_f32_16x16x32_bf16 v[104:107], a[104:107], v[136:139], v[104:107]
    v_mfma_f32_16x16x32_bf16 v[104:107], a[128:131], v[140:143], v[104:107]
    s_waitcnt lgkmcnt(11)
    v_mfma_f32_16x16x32_bf16 v[104:107], a[152:155], v[144:147], v[104:107]
    s_waitcnt lgkmcnt(10)
    v_mfma_f32_16x16x32_bf16 v[104:107], a[176:179], v[148:151], v[104:107]
    s_add_u32 s57, s58, s69
    buffer_load_dwordx4 v3, s[24:27], s57 offen offset:1024 sc1 lds
    s_waitcnt vmcnt(12)
    s_waitcnt lgkmcnt(0)
    s_barrier
    ds_read_b64_tr_b16 a[192:193], v10 offset:0
    ds_read_b64_tr_b16 a[194:195], v10 offset:1024
    ds_read_b64_tr_b16 a[196:197], v11 offset:0
    ds_read_b64_tr_b16 a[198:199], v11 offset:1024
    v_mfma_f32_16x16x32_bf16 v[104:107], a[200:203], v[152:155], v[104:107]
    v_cvt_pk_bf16_f32 v48, v116, v117
    v_cvt_pk_bf16_f32 v49, v118, v119
    v_mfma_f32_16x16x32_bf16 v[104:107], a[224:227], v[156:159], v[104:107]
    s_add_u32 s57, s58, s70
    buffer_load_dwordx4 v3, s[24:27], s57 offen offset:2048 sc1 lds
    v_mfma_f32_16x16x32_bf16 v[104:107], a[248:251], v[160:163], v[104:107]
    v_mfma_f32_16x16x32_bf16 v[104:107], v[192:195], v[164:167], v[104:107]
    v_mfma_f32_16x16x32_bf16 v[104:107], v[216:219], v[168:171], v[104:107]
    v_mfma_f32_16x16x32_bf16 v[104:107], v[240:243], v[172:175], v[104:107]
    s_add_u32 s57, s58, s71
    buffer_load_dwordx4 v3, s[24:27], s57 offen offset:3072 sc1 lds
    v_mfma_f32_16x16x32_bf16 v[108:111], a[12:15], v[120:123], 0
    v_mfma_f32_16x16x32_bf16 v[108:111], a[36:39], v[124:127], v[108:111]
    ds_read_b64_tr_b16 a[216:217], v10 offset:8192
    ds_read_b64_tr_b16 a[218:219], v10 offset:9216
    ds_read_b64_tr_b16 a[220:221], v11 offset:8192
    ds_read_b64_tr_b16 a[222:223], v11 offset:9216
    v_mfma_f32_16x16x32_bf16 v[108:111], a[60:63], v[128:131], v[108:111]
    v_mfma_f32_16x16x32_bf16 v[108:111], a[84:87], v[132:135], v[108:111]
    v_mfma_f32_16x16x32_bf16 v[108:111], a[108:111], v[136:139], v[108:111]
    v_mfma_f32_16x16x32_bf16 v[108:111], a[132:135], v[140:143], v[108:111]
    v_mfma_f32_16x16x32_bf16 v[108:111], a[156:159], v[144:147], v[108:111]
    v_mfma_f32_16x16x32_bf16 v[108:111], a[180:183], v[148:151], v[108:111]
    v_mfma_f32_16x16x32_bf16 v[108:111], a[204:207], v[152:155], v[108:111]
    v_cvt_pk_bf16_f32 v40, v104, v105
    v_cvt_pk_bf16_f32 v41, v106, v107
    v_mfma_f32_16x16x32_bf16 v[108:111], a[228:231], v[156:159], v[108:111]
    ds_read_b64_tr_b16 a[240:241], v10 offset:16384
    ds_read_b64_tr_b16 a[242:243], v10 offset:17408
    ds_read_b64_tr_b16 a[244:245], v11 offset:16384
    ds_read_b64_tr_b16 a[246:247], v11 offset:17408
    v_mfma_f32_16x16x32_bf16 v[108:111], a[252:255], v[160:163], v[108:111]
    v_mfma_f32_16x16x32_bf16 v[108:111], v[196:199], v[164:167], v[108:111]
    v_mfma_f32_16x16x32_bf16 v[108:111], v[220:223], v[168:171], v[108:111]
    v_mfma_f32_16x16x32_bf16 v[108:111], v[244:247], v[172:175], v[108:111]
    v_mfma_f32_16x16x32_bf16 v[112:115], v[120:123], a[16:19], 0
    v_mfma_f32_16x16x32_bf16 v[112:115], v[124:127], a[40:43], v[112:115]
    v_mfma_f32_16x16x32_bf16 v[112:115], v[128:131], a[64:67], v[112:115]
    v_mfma_f32_16x16x32_bf16 v[112:115], v[132:135], a[88:91], v[112:115]
    s_waitcnt vmcnt(8)
    s_waitcnt lgkmcnt(0)
    s_barrier
    ds_read_b64_tr_b16 v[184:185], v10 offset:24576
    ds_read_b64_tr_b16 v[186:187], v10 offset:25600
    ds_read_b64_tr_b16 v[188:189], v11 offset:24576
    ds_read_b64_tr_b16 v[190:191], v11 offset:25600
    v_mfma_f32_16x16x32_bf16 v[112:115], v[136:139], a[112:115], v[112:115]
    v_mfma_f32_16x16x32_bf16 v[112:115], v[140:143], a[136:139], v[112:115]
    v_mfma_f32_16x16x32_bf16 v[112:115], v[144:147], a[160:163], v[112:115]
    v_mfma_f32_16x16x32_bf16 v[112:115], v[148:151], a[184:187], v[112:115]
    v_mfma_f32_16x16x32_bf16 v[112:115], v[152:155], a[208:211], v[112:115]
    v_cvt_pk_bf16_f32 v42, v108, v109
    v_cvt_pk_bf16_f32 v43, v110, v111
    v_mfma_f32_16x16x32_bf16 v[112:115], v[156:159], a[232:235], v[112:115]
    v_cndmask_b32 v42, v42, 0, s[82:83]
    v_cndmask_b32 v43, v43, 0, s[82:83]
    v_mfma_f32_16x16x32_bf16 v[112:115], v[160:163], v[176:179], v[112:115]
    v_mfma_f32_16x16x32_bf16 v[112:115], v[164:167], v[200:203], v[112:115]
    ds_read_b64_tr_b16 v[208:209], v10 offset:32768
    ds_read_b64_tr_b16 v[210:211], v10 offset:33792
    ds_read_b64_tr_b16 v[212:213], v11 offset:32768
    ds_read_b64_tr_b16 v[214:215], v11 offset:33792
    v_mfma_f32_16x16x32_bf16 v[112:115], v[168:171], v[224:227], v[112:115]
    v_mfma_f32_16x16x32_bf16 v[112:115], v[172:175], v[248:251], v[112:115]
    v_mfma_f32_16x16x32_bf16 v[116:119], v[120:123], a[20:23], 0
    v_mfma_f32_16x16x32_bf16 v[116:119], v[124:127], a[44:47], v[116:119]
    v_mfma_f32_16x16x32_bf16 v[116:119], v[128:131], a[68:71], v[116:119]
    v_mfma_f32_16x16x32_bf16 v[116:119], v[132:135], a[92:95], v[116:119]
    v_mfma_f32_16x16x32_bf16 v[116:119], v[136:139], a[116:119], v[116:119]
    v_mfma_f32_16x16x32_bf16 v[116:119], v[140:143], a[140:143], v[116:119]
    ds_read_b64_tr_b16 v[232:233], v10 offset:40960
    ds_read_b64_tr_b16 v[234:235], v10 offset:41984
    ds_read_b64_tr_b16 v[236:237], v11 offset:40960
    ds_read_b64_tr_b16 v[238:239], v11 offset:41984
    v_mfma_f32_16x16x32_bf16 v[116:119], v[144:147], a[164:167], v[116:119]
    v_mfma_f32_16x16x32_bf16 v[116:119], v[148:151], a[188:191], v[116:119]
    v_mfma_f32_16x16x32_bf16 v[116:119], v[152:155], a[212:215], v[116:119]
    v_mfma_f32_16x16x32_bf16 v[116:119], v[156:159], a[236:239], v[116:119]
    v_mfma_f32_16x16x32_bf16 v[116:119], v[160:163], v[180:183], v[116:119]
    v_mfma_f32_16x16x32_bf16 v[116:119], v[164:167], v[204:207], v[116:119]
    v_mfma_f32_16x16x32_bf16 v[116:119], v[168:171], v[228:231], v[116:119]
    v_mfma_f32_16x16x32_bf16 v[116:119], v[172:175], v[252:255], v[116:119]
    s_mov_b32 s65, 1
    s_mov_b32 s73, s52
    s_add_u32 s72, s72, 43008
    v_add_u32 v4, 16384, v4
    s_waitcnt vmcnt(4) lgkmcnt(0)
    s_branch L_a_entry
L_a_loop:
    s_waitcnt lgkmcnt(11)
    v_mfma_f32_16x16x32_bf16 v[104:107], a[8:11], v[120:123], 0
    s_cmp_eq_u32 s65, 2
    s_cselect_b64 s[84:85], s[88:89], 0
    v_mfma_f32_16x16x32_bf16 v[104:107], a[32:35], v[124:127], v[104:107]
    s_andn2_b64 s[86:87], s[84:85], s[80:81]
    s_andn2_b64 s[84:85], s[84:85], s[78:79]
    v_mfma_f32_16x16x32_bf16 v[104:107], a[56:59], v[128:131], v[104:107]
    s_mov_b32 m0, s73
    s_add_u32 s57, s72, s68
    s_waitcnt lgkmcnt(8)
    v_mfma_f32_16x16x32_bf16 v[104:107], a[80:83], v[132:135], v[104:107]
    buffer_load_dwordx4 v3, s[24:27], s57 offen offset:0 sc1 lds
    v_mfma_f32_16x16x32_bf16 v[104:107], a[104:107], v[136:139], v[104:107]
    v_cvt_pk_bf16_f32 v34, v100, v101
    v_cvt_pk_bf16_f32 v35, v102, v103
    v_mfma_f32_16x16x32_bf16 v[104:107], a[128:131], v[140:143], v[104:107]
    v_cndmask_b32 v34, v34, 0, s[82:83]
    v_cndmask_b32 v35, v35, 0, s[82:83]
    s_waitcnt lgkmcnt(5)
    v_mfma_f32_16x16x32_bf16 v[104:107], a[152:155], v[144:147], v[104:107]
    v_mfma_f32_16x16x32_bf16 v[104:107], a[176:179], v[148:151], v[104:107]
    v_mfma_f32_16x16x32_bf16 v[52:55], v[36:39], v[32:35], 0
    v_mfma_f32_16x16x32_bf16 v[104:107], a[200:203], v[152:155], v[104:107]
    v_mfma_f32_16x16x32_bf16 v[56:59], v[40:43], v[32:35], 0
    s_waitcnt lgkmcnt(2)
    v_mfma_f32_16x16x32_bf16 v[104:107], a[224:227], v[156:159], v[104:107]
    v_mov_b32 v36, v40
    v_mfma_f32_16x16x32_bf16 v[104:107], a[248:251], v[160:163], v[104:107]
    v_mov_b32 v37, v41
    v_mfma_f32_16x16x32_bf16 v[104:107], v[192:195], v[164:167], v[104:107]
    v_mov_b32 v38, v42
    s_waitcnt lgkmcnt(0)
    v_mfma_f32_16x16x32_bf16 v[104:107], v[216:219], v[168:171], v[104:107]
    v_mov_b32 v39, v43
    v_mfma_f32_16x16x32_bf16 v[104:107], v[240:243], v[172:175], v[104:107]
    v_cndmask_b32 v76, v52, v53, s[76:77]
    v_mfma_f32_16x16x32_bf16 v[108:111], a[12:15], v[120:123], 0
    v_cndmask_b32 v77, v54, v55, s[76:77]
    v_mfma_f32_16x16x32_bf16 v[108:111], a[36:39], v[124:127], v[108:111]
    v_cndmask_b32 v78, v56, v57, s[76:77]
    v_mfma_f32_16x16x32_bf16 v[108:111], a[60:63], v[128:131], v[108:111]
    v_cndmask_b32 v79, v58, v59, s[76:77]
    v_mfma_f32_16x16x32_bf16 v[108:111], a[84:87], v[132:135], v[108:111]
    v_cndmask_b32 v76, v76, v78, s[78:79]
    v_mfma_f32_16x16x32_bf16 v[108:111], a[108:111], v[136:139], v[108:111]
    v_cndmask_b32 v77, v77, v79, s[80:81]
    v_mfma_f32_16x16x32_bf16 v[108:111], a[132:135], v[140:143], v[108:111]
    v_cndmask_b32 v76, v76, v18, s[84:85]
    v_cvt_pk_bf16_f32 v40, v104, v105
    v_mfma_f32_16x16x32_bf16 v[108:111], a[156:159], v[144:147], v[108:111]
    v_cndmask_b32 v77, v77, v18, s[86:87]
    v_cvt_pk_bf16_f32 v41, v106, v107
    v_mfma_f32_16x16x32_bf16 v[108:111], a[180:183], v[148:151], v[108:111]
    v_max_f32 v78, v76, v77
    v_mfma_f32_16x16x32_bf16 v[108:111], a[204:207], v[152:155], v[108:111]
    v_mov_b32 v79, v78
    s_add_u32 s57, s72, s69
    v_mfma_f32_16x16x32_bf16 v[108:111], a[228:231], v[156:159], v[108:111]
    buffer_load_dwordx4 v3, s[24:27], s57 offen offset:1024 sc1 lds
    v_mfma_f32_16x16x32_bf16 v[108:111], a[252:255], v[160:163], v[108:111]
    v_permlane16_swap_b32 v78, v79
    v_mfma_f32_16x16x32_bf16 v[108:111], v[196:199], v[164:167], v[108:111]
    v_max_f32 v78, v78, v79
    v_mfma_f32_16x16x32_bf16 v[108:111], v[220:223], v[168:171], v[108:111]
    v_mov_b32 v79, v78
    s_add_u32 s57, s72, s70
    v_mfma_f32_16x16x32_bf16 v[108:111], v[244:247], v[172:175], v[108:111]
    buffer_load_dwordx4 v3, s[24:27], s57 offen offset:2048 sc1 lds
    v_mfma_f32_16x16x32_bf16 v[112:115], v[120:123], a[16:19], 0
    v_permlane32_swap_b32 v78, v79
    v_mfma_f32_16x16x32_bf16 v[112:115], v[124:127], a[40:43], v[112:115]
    v_max_f32 v78, v78, v79
    v_mfma_f32_16x16x32_bf16 v[112:115], v[128:131], a[64:67], v[112:115]
    v_sub_f32 v76, v76, v78
    v_sub_f32 v77, v77, v78
    v_mfma_f32_16x16x32_bf16 v[112:115], v[132:135], a[88:91], v[112:115]
    v_mul_f32 v76, s91, v76
    v_mul_f32 v77, s91, v77
    v_mfma_f32_16x16x32_bf16 v[112:115], v[136:139], a[112:115], v[112:115]
    v_exp_f32 v76, v76
    v_mfma_f32_16x16x32_bf16 v[112:115], v[140:143], a[136:139], v[112:115]
    v_exp_f32 v77, v77
    v_mfma_f32_16x16x32_bf16 v[112:115], v[144:147], a[160:163], v[112:115]
    v_add_f32 v78, v76, v77
    v_mfma_f32_16x16x32_bf16 v[112:115], v[148:151], a[184:187], v[112:115]
    v_mov_b32 v79, v78
    v_mfma_f32_16x16x32_bf16 v[112:115], v[152:155], a[208:211], v[112:115]
    v_cvt_pk_bf16_f32 v42, v108, v109
    v_mfma_f32_16x16x32_bf16 v[112:115], v[156:159], a[232:235], v[112:115]
    v_permlane16_swap_b32 v78, v79
    v_cvt_pk_bf16_f32 v43, v110, v111
    v_mfma_f32_16x16x32_bf16 v[112:115], v[160:163], v[176:179], v[112:115]
    v_add_f32 v78, v78, v79
    v_cndmask_b32 v42, v42, 0, s[82:83]
    v_mfma_f32_16x16x32_bf16 v[112:115], v[164:167], v[200:203], v[112:115]
    v_mov_b32 v79, v78
    v_cndmask_b32 v43, v43, 0, s[82:83]
    v_mfma_f32_16x16x32_bf16 v[112:115], v[168:171], v[224:227], v[112:115]
    v_mfma_f32_16x16x32_bf16 v[112:115], v[172:175], v[248:251], v[112:115]
    v_permlane32_swap_b32 v78, v79
    v_mfma_f32_16x16x32_bf16 v[116:119], v[120:123], a[20:23], 0
    v_add_f32 v78, v78, v79
    v_mfma_f32_16x16x32_bf16 v[116:119], v[124:127], a[44:47], v[116:119]
    v_rcp_f32 v78, v78
    v_mfma_f32_16x16x32_bf16 v[116:119], v[128:131], a[68:71], v[116:119]
    v_mul_f32 v76, v76, v78
    v_mul_f32 v77, v77, v78
    v_mfma_f32_16x16x32_bf16 v[116:119], v[132:135], a[92:95], v[116:119]
    v_cvt_pk_bf16_f32 v76, v76, v76
    v_cvt_pk_bf16_f32 v77, v77, v77
    v_mfma_f32_16x16x32_bf16 v[116:119], v[136:139], a[116:119], v[116:119]
    v_and_b32 v60, v76, v14
    v_and_b32 v61, v77, v15
    v_mfma_f32_16x16x32_bf16 v[116:119], v[140:143], a[140:143], v[116:119]
    v_and_b32 v62, v76, v16
    v_and_b32 v63, v77, v17
    s_add_u32 s57, s72, s71
    v_mfma_f32_16x16x32_bf16 v[116:119], v[144:147], a[164:167], v[116:119]
    buffer_load_dwordx4 v3, s[24:27], s57 offen offset:3072 sc1 lds
    v_mfma_f32_16x16x32_bf16 v[116:119], v[148:151], a[188:191], v[116:119]
    v_mfma_f32_16x16x32_bf16 v[64:67], v[44:47], v[60:63], 0
    v_mfma_f32_16x16x32_bf16 v[116:119], v[152:155], a[212:215], v[116:119]
    v_mfma_f32_16x16x32_bf16 v[68:71], v[48:51], v[60:63], 0
    v_mfma_f32_16x16x32_bf16 v[116:119], v[156:159], a[236:239], v[116:119]
    v_mov_b32 v44, v46
    s_add_u32 s72, s72, 14336
    v_mfma_f32_16x16x32_bf16 v[116:119], v[160:163], v[180:183], v[116:119]
    v_mov_b32 v45, v47
    s_add_u32 s73, s73, 16384
    v_mfma_f32_16x16x32_bf16 v[116:119], v[164:167], v[204:207], v[116:119]
    v_mov_b32 v48, v50
    s_and_b32 s73, s73, 0xffff
    v_mfma_f32_16x16x32_bf16 v[116:119], v[168:171], v[228:231], v[116:119]
    v_mov_b32 v49, v51
    v_mfma_f32_16x16x32_bf16 v[116:119], v[172:175], v[252:255], v[116:119]
L_a_entry:
    v_mfma_f32_16x16x32_bf16 v[96:99], a[0:3], v[120:123], 0
    s_cmp_lt_u32 s65, 2
    s_cselect_b32 s53, 2130706432, s74
    v_mfma_f32_16x16x32_bf16 v[96:99], a[24:27], v[124:127], v[96:99]
    v_cvt_pk_bf16_f32 v72, v64, v65
    s_add_u32 s74, s74, 16384
    v_mfma_f32_16x16x32_bf16 v[96:99], a[48:51], v[128:131], v[96:99]
    v_cvt_pk_bf16_f32 v73, v66, v67
    v_add_u32 v4, 16384, v4
    v_mfma_f32_16x16x32_bf16 v[96:99], a[72:75], v[132:135], v[96:99]
    v_cvt_pk_bf16_f32 v74, v68, v69
    v_and_b32 v4, 0xffff, v4
    v_mfma_f32_16x16x32_bf16 v[96:99], a[96:99], v[136:139], v[96:99]
    v_cvt_pk_bf16_f32 v75, v70, v71
    v_xor_b32 v25, 64, v4
    v_mfma_f32_16x16x32_bf16 v[96:99], a[120:123], v[140:143], v[96:99]
    v_cndmask_b32 v74, v74, 0, s[82:83]
    v_mfma_f32_16x16x32_bf16 v[96:99], a[144:147], v[144:147], v[96:99]
    v_cndmask_b32 v75, v75, 0, s[82:83]
    v_mfma_f32_16x16x32_bf16 v[96:99], a[168:171], v[148:151], v[96:99]
    buffer_store_dwordx4 v[72:75], v23, s[24:27], s53 offen sc1
    v_mfma_f32_16x16x32_bf16 v[96:99], a[192:195], v[152:155], v[96:99]
    v_cvt_pk_bf16_f32 v46, v112, v113
    v_mfma_f32_16x16x32_bf16 v[96:99], a[216:219], v[156:159], v[96:99]
    v_cvt_pk_bf16_f32 v47, v114, v115
    v_mfma_f32_16x16x32_bf16 v[96:99], a[240:243], v[160:163], v[96:99]
    v_cvt_pk_bf16_f32 v50, v116, v117
    v_mfma_f32_16x16x32_bf16 v[96:99], v[184:187], v[164:167], v[96:99]
    v_cvt_pk_bf16_f32 v51, v118, v119
    v_mfma_f32_16x16x32_bf16 v[96:99], v[208:211], v[168:171], v[96:99]
    v_mfma_f32_16x16x32_bf16 v[96:99], v[232:235], v[172:175], v[96:99]
    s_waitcnt vmcnt(6)
    s_barrier
    v_mfma_f32_16x16x32_bf16 v[100:103], a[4:7], v[120:123], 0
    ds_read_b128 v[120:123], v4 offset:0
    v_mfma_f32_16x16x32_bf16 v[100:103], a[28:31], v[124:127], v[100:103]
    ds_read_b128 v[124:127], v25 offset:0
    v_mfma_f32_16x16x32_bf16 v[100:103], a[52:55], v[128:131], v[100:103]
    ds_read_b128 v[128:131], v4 offset:2048
    v_mfma_f32_16x16x32_bf16 v[100:103], a[76:79], v[132:135], v[100:103]
    ds_read_b128 v[132:135], v25 offset:2048
    v_mfma_f32_16x16x32_bf16 v[100:103], a[100:103], v[136:139], v[100:103]
    ds_read_b128 v[136:139], v4 offset:4096
    v_mfma_f32_16x16x32_bf16 v[100:103], a[124:127], v[140:143], v[100:103]
    ds_read_b128 v[140:143], v25 offset:4096
    v_cvt_pk_bf16_f32 v32, v96, v97
    v_mfma_f32_16x16x32_bf16 v[100:103], a[148:151], v[144:147], v[100:103]
    ds_read_b128 v[144:147], v4 offset:6144
    v_cvt_pk_bf16_f32 v33, v98, v99
    v_mfma_f32_16x16x32_bf16 v[100:103], a[172:175], v[148:151], v[100:103]
    ds_read_b128 v[148:151], v25 offset:6144
    v_mfma_f32_16x16x32_bf16 v[100:103], a[196:199], v[152:155], v[100:103]
    ds_read_b128 v[152:155], v4 offset:8192
    v_mfma_f32_16x16x32_bf16 v[100:103], a[220:223], v[156:159], v[100:103]
    ds_read_b128 v[156:159], v25 offset:8192
    v_mfma_f32_16x16x32_bf16 v[100:103], a[244:247], v[160:163], v[100:103]
    ds_read_b128 v[160:163], v4 offset:10240
    v_mfma_f32_16x16x32_bf16 v[100:103], v[188:191], v[164:167], v[100:103]
    ds_read_b128 v[164:167], v25 offset:10240
    v_mfma_f32_16x16x32_bf16 v[100:103], v[212:215], v[168:171], v[100:103]
    ds_read_b128 v[168:171], v4 offset:12288
    v_mfma_f32_16x16x32_bf16 v[100:103], v[236:239], v[172:175], v[100:103]
    ds_read_b128 v[172:175], v25 offset:12288
    s_add_u32 s65, s65, 1
    s_cmp_lt_u32 s65, 9
    s_cbranch_scc1 L_a_loop
    s_cmp_eq_u32 s65, 2
    s_cselect_b64 s[84:85], s[88:89], 0
    s_andn2_b64 s[86:87], s[84:85], s[80:81]
    s_andn2_b64 s[84:85], s[84:85], s[78:79]
    v_cvt_pk_bf16_f32 v34, v100, v101
    v_cvt_pk_bf16_f32 v35, v102, v103
    v_cndmask_b32 v34, v34, 0, s[82:83]
    v_cndmask_b32 v35, v35, 0, s[82:83]
    s_nop 1
    v_mfma_f32_16x16x32_bf16 v[52:55], v[36:39], v[32:35], 0
    v_mfma_f32_16x16x32_bf16 v[56:59], v[40:43], v[32:35], 0
    s_nop 6
    v_cndmask_b32 v76, v52, v53, s[76:77]
    v_cndmask_b32 v77, v54, v55, s[76:77]
    v_cndmask_b32 v78, v56, v57, s[76:77]
    v_cndmask_b32 v79, v58, v59, s[76:77]
    v_cndmask_b32 v76, v76, v78, s[78:79]
    v_cndmask_b32 v77, v77, v79, s[80:81]
    v_cndmask_b32 v76, v76, v18, s[84:85]
    v_cndmask_b32 v77, v77, v18, s[86:87]
    v_max_f32 v78, v76, v77
    v_mov_b32 v79, v78
    s_nop 1
    v_permlane16_swap_b32 v78, v79
    v_max_f32 v78, v78, v79
    v_mov_b32 v79, v78
    s_nop 1
    v_permlane32_swap_b32 v78, v79
    v_max_f32 v78, v78, v79
    v_sub_f32 v76, v76, v78
    v_sub_f32 v77, v77, v78
    v_mul_f32 v76, s91, v76
    v_mul_f32 v77, s91, v77
    v_exp_f32 v76, v76
    v_exp_f32 v77, v77
    s_nop 0
    v_add_f32 v78, v76, v77
    v_mov_b32 v79, v78
    s_nop 1
    v_permlane16_swap_b32 v78, v79
    v_add_f32 v78, v78, v79
    v_mov_b32 v79, v78
    s_nop 1
    v_permlane32_swap_b32 v78, v79
    v_add_f32 v78, v78, v79
    v_rcp_f32 v78, v78
    s_nop 0
    v_mul_f32 v76, v76, v78
    v_mul_f32 v77, v77, v78
    v_cvt_pk_bf16_f32 v76, v76, v76
    v_cvt_pk_bf16_f32 v77, v77, v77
    v_and_b32 v60, v76, v14
    v_and_b32 v61, v77, v15
    v_and_b32 v62, v76, v16
    v_and_b32 v63, v77, v17
    s_nop 1
    v_mfma_f32_16x16x32_bf16 v[64:67], v[44:47], v[60:63], 0
    v_mfma_f32_16x16x32_bf16 v[68:71], v[48:51], v[60:63], 0
    s_cmp_lt_u32 s65, 2
    s_cselect_b32 s53, 2130706432, s74
    s_nop 4
    v_cvt_pk_bf16_f32 v72, v64, v65
    v_cvt_pk_bf16_f32 v73, v66, v67
    v_cvt_pk_bf16_f32 v74, v68, v69
    v_cvt_pk_bf16_f32 v75, v70, v71
    v_cndmask_b32 v74, v74, 0, s[82:83]
    v_cndmask_b32 v75, v75, 0, s[82:83]
    buffer_store_dwordx4 v[72:75], v23, s[24:27], s53 offen sc1
    s_waitcnt vmcnt(0) lgkmcnt(0)
    s_barrier
    s_cmp_lg_u32 s44, 0
    s_cbranch_scc1 L_nopub16
    s_lshl_b32 s60, s48, 4
    s_add_u32 s60, s60, s49
    s_lshl_b32 s60, s60, 7
    s_add_u32 s60, s60, 12779520
    v_mov_b32 v30, s47
    s_mov_b64 exec, 1
    buffer_store_dword v30, off, s[24:27], s60 sc1
    s_mov_b64 exec, -1
L_nopub16:
    s_endpgm
L_codeend:
.section .rodata,"a"
.p2align 6
.amdhsa_kernel parallel_sum__sliding_local_dilated__mixer_token_mlp__prompt_kernel
  .amdhsa_next_free_vgpr 512
  .amdhsa_next_free_sgpr 102
  .amdhsa_accum_offset 256
  .amdhsa_group_segment_fixed_size 0
  .amdhsa_kernarg_size 88
  .amdhsa_user_sgpr_count 2
  .amdhsa_user_sgpr_kernarg_segment_ptr 1
  .amdhsa_system_sgpr_workgroup_id_x 1
  .amdhsa_float_denorm_mode_32 3
.end_amdhsa_kernel
```

```asm
; @launch grid=(256,1,1) block=(256,1,1) lds=163840
.amdgcn_target "amdgcn-amd-amdhsa--gfx950"
.text
.globl parallel_sum__sliding_local_dilated__mixer_token_mlp__prompt_kernel
.p2align 8
.type parallel_sum__sliding_local_dilated__mixer_token_mlp__prompt_kernel,@function
parallel_sum__sliding_local_dilated__mixer_token_mlp__prompt_kernel:
    s_cmp_ge_u32 s2, 256
    s_cbranch_scc1 L_end
    s_load_dwordx2 s[4:5], s[0:1], 0
    s_load_dwordx16 s[76:91], s[0:1], 0
    s_load_dwordx4 s[92:95], s[0:1], 64
    s_load_dwordx2 s[24:25], s[0:1], 80
    s_lshr_b32 s46, s2, 3
    s_getpc_b64 s[98:99]
L_pc:
    s_lshl_b32 s53, s46, 10
    v_lshrrev_b32 v25, 5, v0
    v_lshl_add_u32 v26, v25, 7, s53
    v_min_u32 v26, L_codeend-L_pc-4, v26
    v_mov_b32 v29, s99
    v_add_co_u32 v28, vcc, s98, v26
    s_nop 1
    v_addc_co_u32 v29, vcc, 0, v29, vcc
    global_load_dword v108, v[28:29], off
    v_and_b32 v26, 31, v0
    v_mul_u32_u24 v24, 896, v25
    v_lshl_add_u32 v24, v26, 4, v24
    s_mul_i32 s53, s2, 7168
    v_add_u32 v24, s53, v24
    v_cmp_gt_u32 vcc, 28, v26
    v_mov_b32 v27, 2130706432
    s_mov_b32 s6, 1835008
    s_mov_b32 s7, 0x20000
    v_cndmask_b32 v24, v27, v24, vcc
    v_lshrrev_b32 v27, 6, v0
    v_and_b32 v1, 63, v0
    s_waitcnt lgkmcnt(0)
    buffer_load_dwordx4 v[32:35], v24, s[4:7], 0 offen
    buffer_load_dwordx4 v[36:39], v24, s[4:7], 0 offen offset:448
    v_readfirstlane_b32 s44, v27
    s_and_b32 s45, s2, 7
    s_mov_b64 s[8:9], s[78:79]
    s_mov_b32 s10, 1204224
    s_mov_b32 s11, s7
    s_lshr_b32 s53, s45, 1
    s_add_u32 s54, s53, 1
    s_bfe_u32 s54, s54, 0x10001
    s_add_u32 s54, s54, 1
    s_mul_i32 s53, s53, 224
    s_andn2_b32 s53, s53, 127
    s_mul_i32 s55, s46, 43008
    s_add_u32 s53, s53, s55
    v_and_b32 v27, 3, v0
    v_min_u32 v27, s54, v27
    v_bfe_u32 v28, v0, 2, 2
    v_min_u32 v28, 2, v28
    v_mul_u32_u24 v28, 7, v28
    v_add_u32 v27, v27, v28
    v_lshrrev_b32 v28, 4, v0
    v_mul_u32_u24 v28, 21, v28
    v_add_lshl_u32 v27, v27, v28, 7
    buffer_load_dword v108, v27, s[8:11], s53 offen
    s_mov_b64 s[40:41], s[94:95]
    s_mov_b32 s42, 256
    s_mov_b32 s43, s7
    s_or_b32 s53, s2, s44
    s_cbranch_scc1 L_nononce
    s_memrealtime s[98:99]
    s_waitcnt lgkmcnt(0)
    s_or_b32 s98, s98, 1
    v_mov_b32 v28, s98
    s_mov_b64 exec, 1
    buffer_store_dword v28, off, s[40:43], 0 sc1
    s_mov_b64 exec, -1
L_nononce:
    s_mov_b64 s[16:17], s[84:85]
    s_mov_b32 s18, 7340032
    s_mov_b32 s19, s7
    s_mov_b32 s26, 16777216
    s_mov_b32 s27, s7
    s_mov_b64 s[20:21], s[88:89]
    s_mov_b32 s22, 7340032
    s_mov_b32 s23, s7
    s_mov_b64 s[12:13], s[80:81]
    s_mov_b32 s14, 401408
    s_mov_b32 s15, s7
    v_lshrrev_b32 v27, 4, v0
    v_min_u32 v27, 12, v27
    v_lshlrev_b32 v27, 7, v27
    s_mul_i32 s53, s2, 1664
    buffer_load_dword v108, v27, s[12:15], s53 offen
    s_mov_b64 s[28:29], s[92:93]
    s_mov_b32 s30, 1835008
    s_mov_b32 s31, s7
    s_mov_b64 s[32:33], s[86:87]
    s_mov_b32 s34, 3584
    s_mov_b32 s35, s7
    s_mov_b64 s[36:37], s[90:91]
    s_mov_b32 s38, 4096
    s_mov_b32 s39, s7
    s_lshl_b32 s52, s44, 12
    v_lshlrev_b32 v23, 4, v1
    s_cmp_ge_u32 s46, 24
    s_cbranch_scc1 L_role_a
    v_lshrrev_b32 v208, 4, v1
    v_bfe_u32 v209, v1, 2, 2
    v_and_b32 v210, 3, v1
    v_and_b32 v211, 15, v1
    v_lshrrev_b32 v212, 5, v1
    s_and_b32 s54, s45, 1
    s_mul_i32 s54, s54, 24
    s_cmp_ge_u32 s46, 21
    s_cselect_b32 s54, s54, 0
    s_mul_i32 s53, s45, 21
    s_add_u32 s53, s53, s46
    s_sub_u32 s53, s53, s54
    s_mul_i32 s50, s53, 171
    s_lshr_b32 s50, s50, 10
    s_mul_i32 s54, s50, 6
    s_sub_u32 s51, s53, s54
    s_lshl3_add_u32 s65, s51, 1
    s_mul_i32 s65, s65, 43
    s_lshr_b32 s65, s65, 7
    v_lshl_add_u32 v213, v212, 2, v209
    v_and_b32 v215, 1, v208
    v_lshlrev_b32 v214, 4, v210
    v_lshl_add_u32 v214, v215, 6, v214
    s_mul_i32 s53, s44, 1835008
    s_lshl_b32 s54, s50, 7
    s_add_u32 s53, s53, s54
    v_mul_u32_u24 v10, 3584, v213
    v_add3_u32 v10, v10, v214, s53
    v_xor_b32 v11, 32, v10
    s_add_u32 m0, s52, 49152
    s_add_u32 s57, s65, 0
    s_and_b32 s57, s57, 15
    s_mul_i32 s57, s57, 114688
    buffer_load_dwordx4 v10, s[16:19], s57 offen offset:0 lds
    s_add_u32 s57, s57, 27648
    buffer_load_dwordx4 v11, s[16:19], s57 offen offset:1024 lds
    v_mul_u32_u24 v109, 960, v25
    v_lshl_add_u32 v109, v26, 4, v109
    v_mul_u32_u24 v110, 960, v209
    v_lshl_add_u32 v110, v208, 5, v110
    v_lshl_add_u32 v110, v210, 3, v110
    s_lshl_b32 s53, s44, 7
    v_add_u32 v110, s53, v110
    v_mul_u32_u24 v111, 66816, v208
    v_lshl_add_u32 v111, v211, 4, v111
    s_mul_i32 s63, s44, 267264
    s_lshl_b32 s53, s2, 8
    s_add_u32 s63, s63, s53
    s_add_u32 s64, s63, 1069056
    s_cmp_eq_u32 s44, 3
    s_cselect_b32 s64, 2130706432, s64
    s_mov_b32 s62, 0x3f803f80
    s_mov_b32 s61, 0xffff0000
    s_mov_b32 s66, 6291456
    v_mov_b32 v96, 0
    v_mov_b32 v97, 0
    v_lshlrev_b32 v216, 6, v209
    v_lshl_add_u32 v216, v210, 3, v216
    v_lshl_add_u32 v216, v215, 5, v216
    s_add_u32 s53, s52, 49152
    v_lshl_add_u32 v2, v208, 10, v216
    v_add_u32 v2, s53, v2
    v_xor_b32 v3, 32, v2
    v_add_u32 v4, 65536, v2
    v_add_u32 v5, 65536, v3
    v_lshl_add_u32 v6, v208, 9, v216
    v_add_u32 v6, s53, v6
    v_xor_b32 v7, 32, v6
    v_add_u32 v8, 65536, v6
    v_add_u32 v9, 65536, v7
    s_waitcnt vmcnt(5)
    v_dot2c_f32_bf16 v96, s62, v32
    v_dot2c_f32_bf16 v97, v32, v32
    v_lshlrev_b32 v40, 16, v32
    v_and_b32 v41, s61, v32
    v_dot2c_f32_bf16 v96, s62, v33
    v_dot2c_f32_bf16 v97, v33, v33
    v_lshlrev_b32 v42, 16, v33
    v_and_b32 v43, s61, v33
    v_dot2c_f32_bf16 v96, s62, v34
    v_dot2c_f32_bf16 v97, v34, v34
    v_lshlrev_b32 v44, 16, v34
    v_and_b32 v45, s61, v34
    v_dot2c_f32_bf16 v96, s62, v35
    v_dot2c_f32_bf16 v97, v35, v35
    v_lshlrev_b32 v46, 16, v35
    v_and_b32 v47, s61, v35
    s_waitcnt vmcnt(4)
    v_dot2c_f32_bf16 v96, s62, v36
    v_dot2c_f32_bf16 v97, v36, v36
    v_lshlrev_b32 v48, 16, v36
    v_and_b32 v49, s61, v36
    v_dot2c_f32_bf16 v96, s62, v37
    v_dot2c_f32_bf16 v97, v37, v37
    v_lshlrev_b32 v50, 16, v37
    v_and_b32 v51, s61, v37
    v_dot2c_f32_bf16 v96, s62, v38
    v_dot2c_f32_bf16 v97, v38, v38
    v_lshlrev_b32 v52, 16, v38
    v_and_b32 v53, s61, v38
    v_dot2c_f32_bf16 v96, s62, v39
    v_dot2c_f32_bf16 v97, v39, v39
    v_lshlrev_b32 v54, 16, v39
    v_and_b32 v55, s61, v39
    buffer_load_dword v29, off, s[40:43], 0 sc1
    v_add_f32_dpp v96, v96, v96 quad_perm:[1,0,3,2] row_mask:0xf bank_mask:0xf
    v_add_f32_dpp v97, v97, v97 quad_perm:[1,0,3,2] row_mask:0xf bank_mask:0xf
    s_nop 0
    v_add_f32_dpp v96, v96, v96 quad_perm:[2,3,0,1] row_mask:0xf bank_mask:0xf
    v_add_f32_dpp v97, v97, v97 quad_perm:[2,3,0,1] row_mask:0xf bank_mask:0xf
    s_nop 0
    v_add_f32_dpp v96, v96, v96 row_half_mirror row_mask:0xf bank_mask:0xf
    v_add_f32_dpp v97, v97, v97 row_half_mirror row_mask:0xf bank_mask:0xf
    s_nop 0
    v_add_f32_dpp v96, v96, v96 row_mirror row_mask:0xf bank_mask:0xf
    v_add_f32_dpp v97, v97, v97 row_mirror row_mask:0xf bank_mask:0xf
    v_mov_b32 v98, v96
    v_mov_b32 v99, v97
    s_nop 0
    v_permlane16_swap_b32 v96, v98
    v_permlane16_swap_b32 v97, v99
    v_add_f32 v96, v96, v98
    v_add_f32 v97, v97, v99
    v_mul_f32 v98, 0x3b124925, v96
    v_mul_f32 v99, 0x3b124925, v97
    v_fma_f32 v99, -v98, v98, v99
    v_max_f32 v99, 0, v99
    v_cvt_pk_bf16_f32 v100, 0, v99
    v_add_f32 v100, 0x3727c5ac, v100
    v_cvt_pk_bf16_f32 v100, 0, v100
    v_sqrt_f32 v100, v100
    s_nop 0
    v_cvt_pk_bf16_f32 v100, 0, v100
    v_rcp_f32 v100, v100
    s_nop 0
    v_mul_f32 v99, v99, v100
    v_mul_f32 v102, v98, v100
    v_mul_f32 v99, v99, v100
    v_cvt_pk_bf16_f32 v104, 0, v99
    v_add_f32 v104, 0x3727c5ac, v104
    v_cvt_pk_bf16_f32 v104, 0, v104
    v_sqrt_f32 v104, v104
    s_nop 0
    v_cvt_pk_bf16_f32 v104, 0, v104
    v_rcp_f32 v104, v104
    s_nop 0
    v_mul_f32 v104, v104, v100
    v_mul_f32 v106, v98, v104
    v_pk_fma_f32 v[56:57], v[40:41], v[104:105], v[106:107] op_sel_hi:[1,0,0] neg_lo:[0,0,1] neg_hi:[0,0,1]
    v_pk_fma_f32 v[58:59], v[42:43], v[104:105], v[106:107] op_sel_hi:[1,0,0] neg_lo:[0,0,1] neg_hi:[0,0,1]
    v_pk_fma_f32 v[60:61], v[44:45], v[104:105], v[106:107] op_sel_hi:[1,0,0] neg_lo:[0,0,1] neg_hi:[0,0,1]
    v_pk_fma_f32 v[62:63], v[46:47], v[104:105], v[106:107] op_sel_hi:[1,0,0] neg_lo:[0,0,1] neg_hi:[0,0,1]
    v_pk_fma_f32 v[64:65], v[48:49], v[104:105], v[106:107] op_sel_hi:[1,0,0] neg_lo:[0,0,1] neg_hi:[0,0,1]
    v_pk_fma_f32 v[66:67], v[50:51], v[104:105], v[106:107] op_sel_hi:[1,0,0] neg_lo:[0,0,1] neg_hi:[0,0,1]
    v_pk_fma_f32 v[68:69], v[52:53], v[104:105], v[106:107] op_sel_hi:[1,0,0] neg_lo:[0,0,1] neg_hi:[0,0,1]
    v_pk_fma_f32 v[70:71], v[54:55], v[104:105], v[106:107] op_sel_hi:[1,0,0] neg_lo:[0,0,1] neg_hi:[0,0,1]
    v_cvt_pk_bf16_f32 v80, v56, v57
    v_cvt_pk_bf16_f32 v81, v58, v59
    v_cvt_pk_bf16_f32 v82, v60, v61
    v_cvt_pk_bf16_f32 v83, v62, v63
    v_cvt_pk_bf16_f32 v84, v64, v65
    v_cvt_pk_bf16_f32 v85, v66, v67
    v_cvt_pk_bf16_f32 v86, v68, v69
    v_cvt_pk_bf16_f32 v87, v70, v71
    ds_write_b128 v109, v[80:83] offset:0
    ds_write_b128 v109, v[84:87] offset:448
    v_pk_fma_f32 v[40:41], v[40:41], v[100:101], v[102:103] op_sel_hi:[1,0,0] neg_lo:[0,0,1] neg_hi:[0,0,1]
    v_pk_fma_f32 v[42:43], v[42:43], v[100:101], v[102:103] op_sel_hi:[1,0,0] neg_lo:[0,0,1] neg_hi:[0,0,1]
    v_pk_fma_f32 v[44:45], v[44:45], v[100:101], v[102:103] op_sel_hi:[1,0,0] neg_lo:[0,0,1] neg_hi:[0,0,1]
    v_pk_fma_f32 v[46:47], v[46:47], v[100:101], v[102:103] op_sel_hi:[1,0,0] neg_lo:[0,0,1] neg_hi:[0,0,1]
    v_pk_fma_f32 v[48:49], v[48:49], v[100:101], v[102:103] op_sel_hi:[1,0,0] neg_lo:[0,0,1] neg_hi:[0,0,1]
    v_pk_fma_f32 v[50:51], v[50:51], v[100:101], v[102:103] op_sel_hi:[1,0,0] neg_lo:[0,0,1] neg_hi:[0,0,1]
    v_pk_fma_f32 v[52:53], v[52:53], v[100:101], v[102:103] op_sel_hi:[1,0,0] neg_lo:[0,0,1] neg_hi:[0,0,1]
    v_pk_fma_f32 v[54:55], v[54:55], v[100:101], v[102:103] op_sel_hi:[1,0,0] neg_lo:[0,0,1] neg_hi:[0,0,1]
    v_cvt_pk_bf16_f32 v72, v40, v41
    v_cvt_pk_bf16_f32 v73, v42, v43
    v_cvt_pk_bf16_f32 v74, v44, v45
    v_cvt_pk_bf16_f32 v75, v46, v47
    v_cvt_pk_bf16_f32 v76, v48, v49
    v_cvt_pk_bf16_f32 v77, v50, v51
    v_cvt_pk_bf16_f32 v78, v52, v53
    v_cvt_pk_bf16_f32 v79, v54, v55
    s_waitcnt lgkmcnt(0)
    s_barrier
    ds_read_b64_tr_b16 v[88:89], v110 offset:0
    ds_read_b64_tr_b16 v[90:91], v110 offset:3840
    ds_read_b64_tr_b16 v[92:93], v110 offset:512
    ds_read_b64_tr_b16 v[94:95], v110 offset:4352
    buffer_store_dwordx4 v[72:75], v24, s[24:27], s66 offen offset:0 sc1
    buffer_store_dwordx4 v[76:79], v24, s[24:27], s66 offen offset:448 sc1
    s_waitcnt lgkmcnt(2)
    buffer_store_dwordx4 v[88:91], v111, s[24:27], s63 offen sc1
    s_waitcnt lgkmcnt(0)
    buffer_store_dwordx4 v[92:95], v111, s[24:27], s64 offen sc1
    s_add_u32 s57, s57, 27648
    buffer_load_dwordx4 v10, s[16:19], s57 offen offset:2048 lds
    s_add_u32 s57, s57, 27648
    buffer_load_dwordx4 v11, s[16:19], s57 offen offset:3072 lds
    s_add_u32 m0, s52, 65536
    s_add_u32 s57, s65, 1
    s_and_b32 s57, s57, 15
    s_mul_i32 s57, s57, 114688
    buffer_load_dwordx4 v10, s[16:19], s57 offen offset:0 lds
    s_add_u32 s57, s57, 27648
    buffer_load_dwordx4 v11, s[16:19], s57 offen offset:1024 lds
    s_add_u32 s57, s57, 27648
    buffer_load_dwordx4 v10, s[16:19], s57 offen offset:2048 lds
    s_add_u32 s57, s57, 27648
    buffer_load_dwordx4 v11, s[16:19], s57 offen offset:3072 lds
    s_add_u32 m0, s52, 81920
    s_add_u32 s57, s65, 2
    s_and_b32 s57, s57, 15
    s_mul_i32 s57, s57, 114688
    buffer_load_dwordx4 v10, s[16:19], s57 offen offset:0 lds
    s_add_u32 s57, s57, 27648
    buffer_load_dwordx4 v11, s[16:19], s57 offen offset:1024 lds
    s_add_u32 s57, s57, 27648
    buffer_load_dwordx4 v10, s[16:19], s57 offen offset:2048 lds
    s_add_u32 s57, s57, 27648
    buffer_load_dwordx4 v11, s[16:19], s57 offen offset:3072 lds
    s_waitcnt vmcnt(10)
    v_cmp_eq_u32 vcc, 0, v29
    s_nop 0
    s_cbranch_vccz L_ok2
    s_mov_b32 s59, 20000
L_spin1:
    buffer_load_dword v29, off, s[40:43], 0 sc1
    s_waitcnt vmcnt(0)
    v_cmp_eq_u32 vcc, 0, v29
    s_nop 0
    s_cbranch_vccz L_ok2
    s_sub_u32 s59, s59, 1
    s_cbranch_scc0 L_spin1
L_ok2:
    v_readfirstlane_b32 s47, v29
    s_barrier
    s_cmp_lg_u32 s44, 0
    s_cbranch_scc1 L_nopub3
    s_lshl_b32 s60, s2, 5
    s_add_u32 s60, s60, 12582912
    v_mov_b32 v30, s47
    s_mov_b64 exec, 1
    buffer_store_dword v30, off, s[24:27], s60 sc1
    s_mov_b64 exec, -1
L_nopub3:
    s_cmp_ge_u32 s46, 21
    s_cbranch_scc1 L_help
    s_lshl_b32 s53, s44, 11
    s_add_u32 s53, s53, 12582912
    v_lshl_add_u32 v18, v1, 5, s53
    s_lshl_b32 s53, s50, 7
    s_add_u32 m0, s52, 98304
    s_add_u32 s57, s65, 3
    s_and_b32 s57, s57, 15
    s_mul_i32 s57, s57, 114688
    buffer_load_dwordx4 v10, s[16:19], s57 offen offset:0 lds
    v_lshl_add_u32 v19, v208, 3, s53
    s_lshl2_add_u32 s67, s51, s44
    s_mul_i32 s67, s67, 58624
    s_lshl_b32 s53, s50, 11
    s_add_u32 s57, s57, 27648
    buffer_load_dwordx4 v11, s[16:19], s57 offen offset:1024 lds
    s_waitcnt vmcnt(10)
    ds_read_b64_tr_b16 a[0:1], v2 offset:0
    ds_read_b64_tr_b16 a[2:3], v2 offset:512
    ds_read_b64_tr_b16 a[4:5], v3 offset:0
    ds_read_b64_tr_b16 a[6:7], v3 offset:512
    s_add_u32 s57, s57, 27648
    buffer_load_dwordx4 v10, s[16:19], s57 offen offset:2048 lds
    ds_read_b64_tr_b16 a[8:9], v2 offset:256
    ds_read_b64_tr_b16 a[10:11], v2 offset:768
    ds_read_b64_tr_b16 a[12:13], v3 offset:256
    ds_read_b64_tr_b16 a[14:15], v3 offset:768
    s_add_u32 s67, s67, s53
    s_add_u32 s67, s67, 2097152
    v_add_u32 v232, s52, v23
    v_xor_b32 v233, 4096, v232
    s_add_u32 s57, s57, 27648
    buffer_load_dwordx4 v11, s[16:19], s57 offen offset:3072 lds
    v_xor_b32 v234, 8192, v232
    v_xor_b32 v235, 12288, v232
    v_mov_b32 v236, 0xbdd2d3e8
    v_mov_b32 v237, 0xc0135761
    s_add_u32 m0, s52, 114688
    s_add_u32 s57, s65, 4
    s_and_b32 s57, s57, 15
    s_mul_i32 s57, s57, 114688
    buffer_load_dwordx4 v10, s[16:19], s57 offen offset:0 lds
    s_add_u32 s54, s51, 24
    s_mul_i32 s84, s54, 66816
    s_lshl2_add_u32 s84, s52, s84
    s_mul_i32 s83, s54, 58624
    s_add_u32 s57, s57, 27648
    buffer_load_dwordx4 v11, s[16:19], s57 offen offset:1024 lds
    s_waitcnt vmcnt(10)
    ds_read_b64_tr_b16 a[16:17], v2 offset:16384
    ds_read_b64_tr_b16 a[18:19], v2 offset:16896
    ds_read_b64_tr_b16 a[20:21], v3 offset:16384
    ds_read_b64_tr_b16 a[22:23], v3 offset:16896
    s_add_u32 s83, s83, s53
    s_and_b32 s54, s44, 1
    s_lshl_b32 s54, s54, 10
    s_add_u32 s83, s83, s54
    ds_read_b64_tr_b16 a[24:25], v2 offset:16640
    ds_read_b64_tr_b16 a[26:27], v2 offset:17152
    ds_read_b64_tr_b16 a[28:29], v3 offset:16640
    ds_read_b64_tr_b16 a[30:31], v3 offset:17152
    s_add_u32 s57, s57, 27648
    buffer_load_dwordx4 v10, s[16:19], s57 offen offset:2048 lds
    s_add_u32 s83, s83, 2097152
    s_lshl1_add_u32 s54, s54, 49152
    v_add_u32 v243, s54, v23
    s_add_u32 s57, s57, 27648
    buffer_load_dwordx4 v11, s[16:19], s57 offen offset:3072 lds
    s_cmp_lt_u32 s51, 4
    s_cselect_b32 s84, s84, 2130706432
    s_cselect_b32 s83, s83, 2130706432
    s_cmp_lt_u32 s44, 2
    s_cselect_b32 s83, s83, 2130706432
    s_cmp_eq_u32 s44, 0
    s_cselect_b32 s85, 1.0, 0
    s_mul_i32 s53, s45, 7
    s_lshr_b32 s53, s53, 1
    s_sub_u32 s53, s50, s53
    s_lshl1_add_u32 s53, s53, s51
    s_sub_u32 s53, s53, 4
    s_mul_i32 s54, s44, 28
    s_add_u32 s54, s54, s53
    s_lshl_b32 s87, s54, 16
    s_lshl_b32 s54, s45, 9
    s_add_u32 s87, s87, s54
    s_cmp_ge_u32 s51, 4
    s_cselect_b32 s87, s87, 2130706432
    v_lshrrev_b32 v254, 2, v1
    v_lshlrev_b32 v254, 12, v254
    v_lshl_add_u32 v254, v210, 7, v254
    s_add_u32 m0, s52, 131072
    s_add_u32 s57, s65, 5
    s_and_b32 s57, s57, 15
    s_mul_i32 s57, s57, 114688
    buffer_load_dwordx4 v10, s[16:19], s57 offen offset:0 lds
    s_lshr_b32 s53, s46, 2
    s_and_b32 s49, s46, 3
    s_bfe_u32 s54, s46, 0x20001
    s_and_b32 s55, s46, 1
    s_add_u32 s55, s55, 4
    s_cmp_lt_u32 s46, 16
    s_cselect_b32 s53, s53, s54
    s_cselect_b32 s49, s49, s55
    s_add_u32 s57, s57, 27648
    buffer_load_dwordx4 v11, s[16:19], s57 offen offset:1024 lds
    s_waitcnt vmcnt(10)
    ds_read_b64_tr_b16 a[32:33], v2 offset:32768
    ds_read_b64_tr_b16 a[34:35], v2 offset:33280
    ds_read_b64_tr_b16 a[36:37], v3 offset:32768
    ds_read_b64_tr_b16 a[38:39], v3 offset:33280
    s_add_u32 s57, s57, 27648
    buffer_load_dwordx4 v10, s[16:19], s57 offen offset:2048 lds
    ds_read_b64_tr_b16 a[40:41], v2 offset:33024
    ds_read_b64_tr_b16 a[42:43], v2 offset:33536
    ds_read_b64_tr_b16 a[44:45], v3 offset:33024
    ds_read_b64_tr_b16 a[46:47], v3 offset:33536
    s_add_u32 s57, s57, 27648
    buffer_load_dwordx4 v11, s[16:19], s57 offen offset:3072 lds
    s_lshl2_add_u32 s48, s45, s53
    s_mul_i32 s53, s44, 1835008
    s_lshl_b32 s74, s48, 7
    s_add_u32 s53, s53, s74
    v_lshlrev_b32 v217, 5, v212
    v_xor_b32 v217, v217, v214
    v_lshlrev_b32 v12, 12, v213
    v_add3_u32 v12, v12, v217, s53
    s_add_u32 m0, s52, 147456
    s_add_u32 s57, s65, 6
    s_and_b32 s57, s57, 15
    s_mul_i32 s57, s57, 114688
    buffer_load_dwordx4 v10, s[16:19], s57 offen offset:0 lds
    s_mul_i32 s53, s44, 100352
    s_lshl_b32 s54, s49, 7
    s_add_u32 s55, s53, s54
    s_lshl_b32 s56, s44, 5
    s_add_u32 s57, s57, 27648
    buffer_load_dwordx4 v11, s[16:19], s57 offen offset:1024 lds
    s_waitcnt vmcnt(10)
    ds_read_b64_tr_b16 a[48:49], v2 offset:49152
    ds_read_b64_tr_b16 a[50:51], v2 offset:49664
    ds_read_b64_tr_b16 a[52:53], v3 offset:49152
    ds_read_b64_tr_b16 a[54:55], v3 offset:49664
    s_add_u32 s57, s57, 27648
    buffer_load_dwordx4 v10, s[16:19], s57 offen offset:2048 lds
    ds_read_b64_tr_b16 a[56:57], v2 offset:49408
    ds_read_b64_tr_b16 a[58:59], v2 offset:49920
    ds_read_b64_tr_b16 a[60:61], v3 offset:49408
    ds_read_b64_tr_b16 a[62:63], v3 offset:49920
    v_xor_b32 v217, s56, v214
    v_mul_u32_u24 v13, 896, v213
    v_add3_u32 v13, v13, v217, s55
    v_xor_b32 v14, 32, v13
    s_add_u32 s57, s57, 27648
    buffer_load_dwordx4 v11, s[16:19], s57 offen offset:3072 lds
    s_mul_i32 s73, s48, 57344
    s_add_u32 s71, s73, s54
    s_add_u32 s72, s71, 28672
    v_lshrrev_b32 v217, 1, v1
    s_waitcnt lgkmcnt(15)
    s_add_u32 m0, s52, 49152
    s_add_u32 s57, s65, 7
    s_and_b32 s57, s57, 15
    s_mul_i32 s57, s57, 114688
    buffer_load_dwordx4 v10, s[16:19], s57 offen offset:0 lds
    v_mul_u32_u24 v15, 896, v217
    v_and_b32 v217, 1, v1
    v_lshl_add_u32 v15, v217, 4, v15
    v_add_u32 v15, s53, v15
    s_add_u32 s57, s57, 27648
    buffer_load_dwordx4 v11, s[16:19], s57 offen offset:1024 lds
    s_waitcnt vmcnt(10)
    ds_read_b64_tr_b16 a[64:65], v4 offset:0
    ds_read_b64_tr_b16 a[66:67], v4 offset:512
    ds_read_b64_tr_b16 a[68:69], v5 offset:0
    ds_read_b64_tr_b16 a[70:71], v5 offset:512
    s_lshl_b32 s54, s49, 5
    s_add_u32 s54, s54, 768
    s_add_u32 s68, s49, 24
    s_mul_i32 s68, s68, 58624
    ds_read_b64_tr_b16 a[72:73], v4 offset:256
    ds_read_b64_tr_b16 a[74:75], v4 offset:768
    ds_read_b64_tr_b16 a[76:77], v5 offset:256
    ds_read_b64_tr_b16 a[78:79], v5 offset:768
    s_add_u32 s57, s57, 27648
    buffer_load_dwordx4 v10, s[16:19], s57 offen offset:2048 lds
    s_mul_i32 s69, s44, 14336
    s_add_u32 s69, s69, 2097152
    s_add_u32 s68, s68, s69
    s_add_u32 s73, s73, s54
    s_add_u32 s57, s57, 27648
    buffer_load_dwordx4 v11, s[16:19], s57 offen offset:3072 lds
    s_mov_b32 s76, 0
    s_add_u32 s77, s76, 2048
    s_cmp_eq_u32 s77, 14336
    s_cselect_b32 s77, 0, s77
    s_add_u32 s78, s77, 2048
    s_cmp_eq_u32 s78, 14336
    s_cselect_b32 s78, 0, s78
    s_add_u32 s79, s78, 2048
    s_cmp_eq_u32 s79, 14336
    s_cselect_b32 s79, 0, s79
    s_add_u32 s80, s79, 2048
    s_cmp_eq_u32 s80, 14336
    s_cselect_b32 s80, 0, s80
    s_add_u32 s81, s80, 2048
    s_cmp_eq_u32 s81, 14336
    s_cselect_b32 s81, 0, s81
    s_add_u32 s82, s81, 2048
    s_cmp_eq_u32 s82, 14336
    s_cselect_b32 s82, 0, s82
    s_add_u32 m0, s52, 65536
    s_add_u32 s57, s65, 8
    s_and_b32 s57, s57, 15
    s_mul_i32 s57, s57, 114688
    buffer_load_dwordx4 v10, s[16:19], s57 offen offset:0 lds
    s_cmp_lt_u32 s49, 4
    s_cselect_b32 s75, s54, 2130706432
    s_cselect_b32 s68, s68, 2130706432
    s_cselect_b32 s73, s73, 2130706432
    s_add_u32 s57, s57, 27648
    buffer_load_dwordx4 v11, s[16:19], s57 offen offset:1024 lds
    s_waitcnt vmcnt(10)
    ds_read_b64_tr_b16 a[80:81], v4 offset:16384
    ds_read_b64_tr_b16 a[82:83], v4 offset:16896
    ds_read_b64_tr_b16 a[84:85], v5 offset:16384
    ds_read_b64_tr_b16 a[86:87], v5 offset:16896
    s_add_u32 s57, s57, 27648
    buffer_load_dwordx4 v10, s[16:19], s57 offen offset:2048 lds
    ds_read_b64_tr_b16 a[88:89], v4 offset:16640
    ds_read_b64_tr_b16 a[90:91], v4 offset:17152
    ds_read_b64_tr_b16 a[92:93], v5 offset:16640
    ds_read_b64_tr_b16 a[94:95], v5 offset:17152
    v_lshl_add_u32 v217, v208, 3, v209
    v_lshlrev_b32 v16, 5, v217
    v_lshl_add_u32 v16, v210, 3, v16
    v_add_u32 v16, s52, v16
    s_add_u32 s57, s57, 27648
    buffer_load_dwordx4 v11, s[16:19], s57 offen offset:3072 lds
    v_and_b32 v217, 7, v1
    v_min_u32 v218, 6, v217
    s_lshl_b32 s53, s49, 5
    s_mul_i32 s54, s44, 7
    s_waitcnt lgkmcnt(15)
    s_add_u32 m0, s52, 81920
    s_add_u32 s57, s65, 9
    s_and_b32 s57, s57, 15
    s_mul_i32 s57, s57, 114688
    buffer_load_dwordx4 v10, s[16:19], s57 offen offset:0 lds
    s_add_u32 s53, s53, s54
    s_lshl_b32 s53, s53, 7
    s_add_u32 s53, s53, 12713984
    v_lshl_add_u32 v20, v218, 7, s53
    s_add_u32 s57, s57, 27648
    buffer_load_dwordx4 v11, s[16:19], s57 offen offset:1024 lds
    s_waitcnt vmcnt(10)
    ds_read_b64_tr_b16 a[96:97], v4 offset:32768
    ds_read_b64_tr_b16 a[98:99], v4 offset:33280
    ds_read_b64_tr_b16 a[100:101], v5 offset:32768
    ds_read_b64_tr_b16 a[102:103], v5 offset:33280
    s_lshr_b32 s53, s48, 1
    s_lshl4_add_u32 s53, s44, s53
    s_lshl_b32 s53, s53, 7
    s_add_u32 s53, s53, 12779520
    ds_read_b64_tr_b16 a[104:105], v4 offset:33024
    ds_read_b64_tr_b16 a[106:107], v4 offset:33536
    ds_read_b64_tr_b16 a[108:109], v5 offset:33024
    ds_read_b64_tr_b16 a[110:111], v5 offset:33536
    s_add_u32 s57, s57, 27648
    buffer_load_dwordx4 v10, s[16:19], s57 offen offset:2048 lds
    v_mov_b32 v21, s53
    s_lshl_b32 s70, s48, 16
    s_add_u32 s70, s70, s52
    s_add_u32 s70, s70, 4194304
    s_add_u32 s57, s57, 27648
    buffer_load_dwordx4 v11, s[16:19], s57 offen offset:3072 lds
    v_lshrrev_b32 v218, 3, v0
    v_mul_u32_u24 v22, 896, v218
    v_lshl_add_u32 v22, v217, 4, v22
    v_lshlrev_b32 v25, 1, v218
    buffer_load_dwordx2 v[224:225], v19, s[32:35], 0 offen offset:0
    v_lshrrev_b32 v219, 4, v218
    v_lshlrev_b32 v244, 14, v219
    v_lshrrev_b32 v219, 1, v217
    v_lshl_add_u32 v244, v219, 12, v244
    buffer_load_dwordx2 v[226:227], v19, s[32:35], 0 offen offset:32
    s_waitcnt vmcnt(10)
    ds_read_b64_tr_b16 a[112:113], v2 offset:0
    ds_read_b64_tr_b16 a[114:115], v2 offset:512
    ds_read_b64_tr_b16 a[116:117], v3 offset:0
    ds_read_b64_tr_b16 a[118:119], v3 offset:512
    buffer_load_dwordx2 v[228:229], v19, s[32:35], 0 offen offset:64
    ds_read_b64_tr_b16 a[120:121], v2 offset:256
    ds_read_b64_tr_b16 a[122:123], v2 offset:768
    ds_read_b64_tr_b16 a[124:125], v3 offset:256
    ds_read_b64_tr_b16 a[126:127], v3 offset:768
    buffer_load_dwordx2 v[230:231], v19, s[32:35], 0 offen offset:96
    v_and_b32 v219, 15, v218
    v_lshl_add_u32 v244, v219, 8, v244
    v_bfe_u32 v219, v218, 1, 1
    v_lshl_add_u32 v244, v219, 7, v244
    s_add_u32 m0, s52, 98304
    s_add_u32 s57, s65, 10
    s_and_b32 s57, s57, 15
    s_mul_i32 s57, s57, 114688
    buffer_load_dwordx4 v10, s[16:19], s57 offen offset:0 lds
    v_and_b32 v219, 7, v218
    v_xor_b32 v219, v219, v217
    v_lshl_add_u32 v244, v219, 4, v244
    v_xor_b32 v245, 128, v244
    v_xor_b32 v246, 4096, v244
    v_xor_b32 v247, 4224, v244
    v_xor_b32 v248, 8192, v244
    v_xor_b32 v249, 8320, v244
    s_add_u32 s57, s57, 27648
    buffer_load_dwordx4 v11, s[16:19], s57 offen offset:1024 lds
    s_waitcnt vmcnt(10)
    ds_read_b64_tr_b16 a[128:129], v2 offset:16384
    ds_read_b64_tr_b16 a[130:131], v2 offset:16896
    ds_read_b64_tr_b16 a[132:133], v3 offset:16384
    ds_read_b64_tr_b16 a[134:135], v3 offset:16896
    s_add_u32 s57, s57, 27648
    buffer_load_dwordx4 v10, s[16:19], s57 offen offset:2048 lds
    ds_read_b64_tr_b16 a[136:137], v2 offset:16640
    ds_read_b64_tr_b16 a[138:139], v2 offset:17152
    ds_read_b64_tr_b16 a[140:141], v3 offset:16640
    ds_read_b64_tr_b16 a[142:143], v3 offset:17152
    s_add_u32 s57, s57, 27648
    buffer_load_dwordx4 v11, s[16:19], s57 offen offset:3072 lds
    v_xor_b32 v250, 12288, v244
    v_xor_b32 v251, 12416, v244
    v_lshrrev_b32 v218, 2, v0
    v_mul_u32_u24 v26, 896, v218
    v_lshl_add_u32 v26, v210, 3, v26
    v_lshlrev_b32 v27, 1, v218
    v_bfe_u32 v219, v218, 1, 2
    v_xor_b32 v219, v219, v210
    s_waitcnt lgkmcnt(15)
    s_add_u32 m0, s52, 114688
    s_add_u32 s57, s65, 11
    s_and_b32 s57, s57, 15
    s_mul_i32 s57, s57, 114688
    buffer_load_dwordx4 v10, s[16:19], s57 offen offset:0 lds
    v_lshlrev_b32 v252, 6, v218
    v_lshl_add_u32 v252, v219, 4, v252
    v_add_u32 v252, 65536, v252
    v_bfe_u32 v219, v1, 1, 2
    s_add_u32 s57, s57, 27648
    buffer_load_dwordx4 v11, s[16:19], s57 offen offset:1024 lds
    s_waitcnt vmcnt(10)
    ds_read_b64_tr_b16 a[144:145], v2 offset:32768
    ds_read_b64_tr_b16 a[146:147], v2 offset:33280
    ds_read_b64_tr_b16 a[148:149], v3 offset:32768
    ds_read_b64_tr_b16 a[150:151], v3 offset:33280
    s_add_u32 s57, s57, 27648
    buffer_load_dwordx4 v10, s[16:19], s57 offen offset:2048 lds
    ds_read_b64_tr_b16 a[152:153], v2 offset:33024
    ds_read_b64_tr_b16 a[154:155], v2 offset:33536
    ds_read_b64_tr_b16 a[156:157], v3 offset:33024
    ds_read_b64_tr_b16 a[158:159], v3 offset:33536
    v_xor_b32 v219, v219, v208
    v_lshlrev_b32 v242, 6, v211
    v_lshl_add_u32 v242, v219, 4, v242
    s_add_u32 s53, s52, 65536
    s_add_u32 s57, s57, 27648
    buffer_load_dwordx4 v11, s[16:19], s57 offen offset:3072 lds
    v_add_u32 v242, s53, v242
    v_xor_b32 v218, v217, v212
    v_lshlrev_b32 v238, 4, v218
    v_xor_b32 v238, s56, v238
    s_add_u32 m0, s52, 131072
    s_add_u32 s57, s65, 12
    s_and_b32 s57, s57, 15
    s_mul_i32 s57, s57, 114688
    buffer_load_dwordx4 v10, s[16:19], s57 offen offset:0 lds
    v_bfe_u32 v219, v1, 1, 1
    v_xor_b32 v219, v219, v215
    v_lshl_add_u32 v238, v219, 7, v238
    v_lshl_add_u32 v238, v211, 8, v238
    s_add_u32 s57, s57, 27648
    buffer_load_dwordx4 v11, s[16:19], s57 offen offset:1024 lds
    v_add_u32 v238, s52, v238
    v_xor_b32 v239, 32, v238
    v_xor_b32 v240, 64, v238
    v_xor_b32 v241, 96, v238
    s_waitcnt vmcnt(10)
    v_lshlrev_b32 v32, 16, v224
    v_and_b32 v33, s61, v224
    v_lshlrev_b32 v34, 16, v225
    v_and_b32 v35, s61, v225
    s_add_u32 s57, s57, 27648
    buffer_load_dwordx4 v10, s[16:19], s57 offen offset:2048 lds
    v_lshlrev_b32 v36, 16, v226
    v_and_b32 v37, s61, v226
    v_lshlrev_b32 v38, 16, v227
    v_and_b32 v39, s61, v227
    s_add_u32 s57, s57, 27648
    buffer_load_dwordx4 v11, s[16:19], s57 offen offset:3072 lds
    v_lshlrev_b32 v40, 16, v228
    v_and_b32 v41, s61, v228
    v_lshlrev_b32 v42, 16, v229
    v_and_b32 v43, s61, v229
    buffer_load_dword v17, v18, s[24:27], 0 offen sc1
    v_lshlrev_b32 v44, 16, v230
    v_and_b32 v45, s61, v230
    v_lshlrev_b32 v46, 16, v231
    v_and_b32 v47, s61, v231
    v_mul_f32 v96, s85, v32
    v_mul_f32 v97, s85, v33
    v_mul_f32 v98, s85, v34
    v_mul_f32 v99, s85, v35
    s_add_u32 m0, s52, 147456
    s_add_u32 s57, s65, 13
    s_and_b32 s57, s57, 15
    s_mul_i32 s57, s57, 114688
    buffer_load_dwordx4 v10, s[16:19], s57 offen offset:0 lds
    s_waitcnt vmcnt(10)
    ds_read_b64_tr_b16 a[160:161], v2 offset:49152
    ds_read_b64_tr_b16 a[162:163], v2 offset:49664
    ds_read_b64_tr_b16 a[164:165], v3 offset:49152
    ds_read_b64_tr_b16 a[166:167], v3 offset:49664
    v_mul_f32 v100, s85, v36
    v_mul_f32 v101, s85, v37
    v_mul_f32 v102, s85, v38
    v_mul_f32 v103, s85, v39
    ds_read_b64_tr_b16 a[168:169], v2 offset:49408
    ds_read_b64_tr_b16 a[170:171], v2 offset:49920
    ds_read_b64_tr_b16 a[172:173], v3 offset:49408
    ds_read_b64_tr_b16 a[174:175], v3 offset:49920
    s_add_u32 s57, s57, 27648
    buffer_load_dwordx4 v11, s[16:19], s57 offen offset:1024 lds
    v_mul_f32 v104, s85, v40
    v_mul_f32 v105, s85, v41
    v_mul_f32 v106, s85, v42
    v_mul_f32 v107, s85, v43
    s_add_u32 s57, s57, 27648
    buffer_load_dwordx4 v10, s[16:19], s57 offen offset:2048 lds
    v_mul_f32 v108, s85, v44
    v_mul_f32 v109, s85, v45
    v_mul_f32 v110, s85, v46
    v_mul_f32 v111, s85, v47
    s_add_u32 s57, s57, 27648
    buffer_load_dwordx4 v11, s[16:19], s57 offen offset:3072 lds
    s_waitcnt lgkmcnt(15)
    s_add_u32 m0, s52, 49152
    s_add_u32 s57, s65, 14
    s_and_b32 s57, s57, 15
    s_mul_i32 s57, s57, 114688
    buffer_load_dwordx4 v10, s[16:19], s57 offen offset:0 lds
    s_waitcnt vmcnt(10)
    ds_read_b64_tr_b16 a[176:177], v4 offset:0
    ds_read_b64_tr_b16 a[178:179], v4 offset:512
    ds_read_b64_tr_b16 a[180:181], v5 offset:0
    ds_read_b64_tr_b16 a[182:183], v5 offset:512
    s_add_u32 s57, s57, 27648
    buffer_load_dwordx4 v11, s[16:19], s57 offen offset:1024 lds
    ds_read_b64_tr_b16 a[184:185], v4 offset:256
    ds_read_b64_tr_b16 a[186:187], v4 offset:768
    ds_read_b64_tr_b16 a[188:189], v5 offset:256
    ds_read_b64_tr_b16 a[190:191], v5 offset:768
    s_add_u32 s57, s57, 27648
    buffer_load_dwordx4 v10, s[16:19], s57 offen offset:2048 lds
    s_add_u32 s57, s57, 27648
    buffer_load_dwordx4 v11, s[16:19], s57 offen offset:3072 lds
    s_add_u32 m0, s52, 65536
    s_add_u32 s57, s65, 15
    s_and_b32 s57, s57, 15
    s_mul_i32 s57, s57, 114688
    buffer_load_dwordx4 v10, s[16:19], s57 offen offset:0 lds
    s_waitcnt vmcnt(10)
    ds_read_b64_tr_b16 a[192:193], v4 offset:16384
    ds_read_b64_tr_b16 a[194:195], v4 offset:16896
    ds_read_b64_tr_b16 a[196:197], v5 offset:16384
    ds_read_b64_tr_b16 a[198:199], v5 offset:16896
    s_add_u32 s57, s57, 27648
    buffer_load_dwordx4 v11, s[16:19], s57 offen offset:1024 lds
    ds_read_b64_tr_b16 a[200:201], v4 offset:16640
    ds_read_b64_tr_b16 a[202:203], v4 offset:17152
    ds_read_b64_tr_b16 a[204:205], v5 offset:16640
    ds_read_b64_tr_b16 a[206:207], v5 offset:17152
    s_waitcnt vmcnt(10)
    v_cmp_ne_u32 vcc, s47, v17
    s_nop 0
    s_cbranch_vccz L_ok5
    s_mov_b32 s59, 20000
L_spin4:
    buffer_load_dword v17, v18, s[24:27], 0 offen sc1
    s_waitcnt vmcnt(0)
    v_cmp_ne_u32 vcc, s47, v17
    s_nop 0
    s_cbranch_vccz L_ok5
    s_sub_u32 s59, s59, 1
    s_cbranch_scc0 L_spin4
L_ok5:
    s_add_u32 s57, s57, 27648
    buffer_load_dwordx4 v10, s[16:19], s57 offen offset:2048 lds
    s_add_u32 s57, s57, 27648
    buffer_load_dwordx4 v11, s[16:19], s57 offen offset:3072 lds
    buffer_load_dword v253, v254, s[20:23], s87 offen
    s_mov_b32 s66, s84
    s_lshl_b32 s86, s65, 10
    s_add_u32 s58, s86, s66
    buffer_load_dwordx4 v[112:115], v23, s[24:27], s58 offen offset:0 sc1
    s_waitcnt vmcnt(10)
    ds_read_b64_tr_b16 a[208:209], v4 offset:32768
    ds_read_b64_tr_b16 a[210:211], v4 offset:33280
    ds_read_b64_tr_b16 a[212:213], v5 offset:32768
    ds_read_b64_tr_b16 a[214:215], v5 offset:33280
    s_add_u32 s86, s86, 1024
    s_and_b32 s86, s86, 16383
    s_add_u32 s58, s86, s66
    buffer_load_dwordx4 v[116:119], v23, s[24:27], s58 offen offset:0 sc1
    ds_read_b64_tr_b16 a[216:217], v4 offset:33024
    ds_read_b64_tr_b16 a[218:219], v4 offset:33536
    ds_read_b64_tr_b16 a[220:221], v5 offset:33024
    ds_read_b64_tr_b16 a[222:223], v5 offset:33536
    s_add_u32 s86, s86, 1024
    s_and_b32 s86, s86, 16383
    s_add_u32 s58, s86, s66
    buffer_load_dwordx4 v[120:123], v23, s[24:27], s58 offen offset:0 sc1
    s_add_u32 s86, s86, 1024
    s_and_b32 s86, s86, 16383
    s_add_u32 s58, s86, s66
    buffer_load_dwordx4 v[124:127], v23, s[24:27], s58 offen offset:0 sc1
    s_add_u32 s86, s86, 1024
    s_and_b32 s86, s86, 16383
    s_add_u32 s58, s86, s66
    buffer_load_dwordx4 v[128:131], v23, s[24:27], s58 offen offset:0 sc1
    s_waitcnt vmcnt(10)
    ds_read_b64_tr_b16 a[224:225], v2 offset:0
    ds_read_b64_tr_b16 a[226:227], v2 offset:512
    ds_read_b64_tr_b16 a[228:229], v3 offset:0
    ds_read_b64_tr_b16 a[230:231], v3 offset:512
    s_add_u32 s86, s86, 1024
    s_and_b32 s86, s86, 16383
    s_add_u32 s58, s86, s66
    buffer_load_dwordx4 v[132:135], v23, s[24:27], s58 offen offset:0 sc1
    ds_read_b64_tr_b16 a[232:233], v2 offset:256
    ds_read_b64_tr_b16 a[234:235], v2 offset:768
    ds_read_b64_tr_b16 a[236:237], v3 offset:256
    ds_read_b64_tr_b16 a[238:239], v3 offset:768
    s_add_u32 s86, s86, 1024
    s_and_b32 s86, s86, 16383
    s_add_u32 s58, s86, s66
    buffer_load_dwordx4 v[136:139], v23, s[24:27], s58 offen offset:0 sc1
    s_add_u32 s86, s86, 1024
    s_and_b32 s86, s86, 16383
    s_add_u32 s58, s86, s66
    buffer_load_dwordx4 v[140:143], v23, s[24:27], s58 offen offset:0 sc1
    s_add_u32 s86, s86, 1024
    s_and_b32 s86, s86, 16383
    s_add_u32 s58, s86, s66
    buffer_load_dwordx4 v[144:147], v23, s[24:27], s58 offen offset:0 sc1
    s_waitcnt vmcnt(10)
    ds_read_b64_tr_b16 a[240:241], v2 offset:16384
    ds_read_b64_tr_b16 a[242:243], v2 offset:16896
    ds_read_b64_tr_b16 a[244:245], v3 offset:16384
    ds_read_b64_tr_b16 a[246:247], v3 offset:16896
    s_add_u32 s86, s86, 1024
    s_and_b32 s86, s86, 16383
    s_add_u32 s58, s86, s66
    buffer_load_dwordx4 v[148:151], v23, s[24:27], s58 offen offset:0 sc1
    ds_read_b64_tr_b16 a[248:249], v2 offset:16640
    ds_read_b64_tr_b16 a[250:251], v2 offset:17152
    ds_read_b64_tr_b16 a[252:253], v3 offset:16640
    ds_read_b64_tr_b16 a[254:255], v3 offset:17152
    s_waitcnt vmcnt(9)
    v_mfma_f32_16x16x32_bf16 v[96:99], a[0:3], v[112:115], v[96:99]
    s_add_u32 s86, s86, 1024
    s_and_b32 s86, s86, 16383
    s_add_u32 s58, s86, s66
    v_mfma_f32_16x16x32_bf16 v[100:103], a[4:7], v[112:115], v[100:103]
    buffer_load_dwordx4 v[152:155], v23, s[24:27], s58 offen offset:0 sc1
    v_mfma_f32_16x16x32_bf16 v[104:107], a[8:11], v[112:115], v[104:107]
    v_mfma_f32_16x16x32_bf16 v[108:111], a[12:15], v[112:115], v[108:111]
    s_waitcnt vmcnt(9)
    v_mfma_f32_16x16x32_bf16 v[96:99], a[16:19], v[116:119], v[96:99]
    s_add_u32 s86, s86, 1024
    s_and_b32 s86, s86, 16383
    s_add_u32 s58, s86, s66
    v_mfma_f32_16x16x32_bf16 v[100:103], a[20:23], v[116:119], v[100:103]
    buffer_load_dwordx4 v[156:159], v23, s[24:27], s58 offen offset:0 sc1
    v_mfma_f32_16x16x32_bf16 v[104:107], a[24:27], v[116:119], v[104:107]
    v_mfma_f32_16x16x32_bf16 v[108:111], a[28:31], v[116:119], v[108:111]
    s_waitcnt vmcnt(9)
    v_mfma_f32_16x16x32_bf16 v[96:99], a[32:35], v[120:123], v[96:99]
    s_add_u32 s86, s86, 1024
    s_and_b32 s86, s86, 16383
    s_add_u32 s58, s86, s66
    v_mfma_f32_16x16x32_bf16 v[100:103], a[36:39], v[120:123], v[100:103]
    buffer_load_dwordx4 v[112:115], v23, s[24:27], s58 offen offset:0 sc1
    v_mfma_f32_16x16x32_bf16 v[104:107], a[40:43], v[120:123], v[104:107]
    v_mfma_f32_16x16x32_bf16 v[108:111], a[44:47], v[120:123], v[108:111]
    s_waitcnt vmcnt(9)
    v_mfma_f32_16x16x32_bf16 v[96:99], a[48:51], v[124:127], v[96:99]
    s_add_u32 s86, s86, 1024
    s_and_b32 s86, s86, 16383
    s_add_u32 s58, s86, s66
    v_mfma_f32_16x16x32_bf16 v[100:103], a[52:55], v[124:127], v[100:103]
    buffer_load_dwordx4 v[116:119], v23, s[24:27], s58 offen offset:0 sc1
    v_mfma_f32_16x16x32_bf16 v[104:107], a[56:59], v[124:127], v[104:107]
    v_mfma_f32_16x16x32_bf16 v[108:111], a[60:63], v[124:127], v[108:111]
    s_waitcnt vmcnt(9)
    v_mfma_f32_16x16x32_bf16 v[96:99], a[64:67], v[128:131], v[96:99]
    s_add_u32 s86, s86, 1024
    s_and_b32 s86, s86, 16383
    s_add_u32 s58, s86, s66
    v_mfma_f32_16x16x32_bf16 v[100:103], a[68:71], v[128:131], v[100:103]
    buffer_load_dwordx4 v[120:123], v23, s[24:27], s58 offen offset:0 sc1
    v_mfma_f32_16x16x32_bf16 v[104:107], a[72:75], v[128:131], v[104:107]
    v_mfma_f32_16x16x32_bf16 v[108:111], a[76:79], v[128:131], v[108:111]
    s_waitcnt vmcnt(9)
    v_mfma_f32_16x16x32_bf16 v[96:99], a[80:83], v[132:135], v[96:99]
    s_add_u32 s86, s86, 1024
    s_and_b32 s86, s86, 16383
    s_add_u32 s58, s86, s66
    v_mfma_f32_16x16x32_bf16 v[100:103], a[84:87], v[132:135], v[100:103]
    buffer_load_dwordx4 v[124:127], v23, s[24:27], s58 offen offset:0 sc1
    v_mfma_f32_16x16x32_bf16 v[104:107], a[88:91], v[132:135], v[104:107]
    v_mfma_f32_16x16x32_bf16 v[108:111], a[92:95], v[132:135], v[108:111]
    s_waitcnt vmcnt(9)
    v_mfma_f32_16x16x32_bf16 v[96:99], a[96:99], v[136:139], v[96:99]
    s_xor_b32 s66, s44, 3
    s_lshl2_add_u32 s66, s51, s66
    s_mul_i32 s66, s66, 66816
    s_lshl2_add_u32 s66, s52, s66
    s_lshl_b32 s86, s65, 10
    s_add_u32 s58, s86, s66
    v_mfma_f32_16x16x32_bf16 v[100:103], a[100:103], v[136:139], v[100:103]
    buffer_load_dwordx4 v[128:131], v23, s[24:27], s58 offen offset:0 sc1
    v_mfma_f32_16x16x32_bf16 v[104:107], a[104:107], v[136:139], v[104:107]
    v_mfma_f32_16x16x32_bf16 v[108:111], a[108:111], v[136:139], v[108:111]
    s_waitcnt vmcnt(9)
    v_mfma_f32_16x16x32_bf16 v[96:99], a[112:115], v[140:143], v[96:99]
    s_add_u32 s86, s86, 1024
    s_and_b32 s86, s86, 16383
    s_add_u32 s58, s86, s66
    v_mfma_f32_16x16x32_bf16 v[100:103], a[116:119], v[140:143], v[100:103]
    buffer_load_dwordx4 v[132:135], v23, s[24:27], s58 offen offset:0 sc1
    v_mfma_f32_16x16x32_bf16 v[104:107], a[120:123], v[140:143], v[104:107]
    v_mfma_f32_16x16x32_bf16 v[108:111], a[124:127], v[140:143], v[108:111]
    s_waitcnt vmcnt(9)
    v_mfma_f32_16x16x32_bf16 v[96:99], a[128:131], v[144:147], v[96:99]
    s_add_u32 s86, s86, 1024
    s_and_b32 s86, s86, 16383
    s_add_u32 s58, s86, s66
    v_mfma_f32_16x16x32_bf16 v[100:103], a[132:135], v[144:147], v[100:103]
    buffer_load_dwordx4 v[136:139], v23, s[24:27], s58 offen offset:0 sc1
    v_mfma_f32_16x16x32_bf16 v[104:107], a[136:139], v[144:147], v[104:107]
    v_mfma_f32_16x16x32_bf16 v[108:111], a[140:143], v[144:147], v[108:111]
    s_waitcnt vmcnt(9)
    s_waitcnt lgkmcnt(15)
    v_mfma_f32_16x16x32_bf16 v[96:99], a[144:147], v[148:151], v[96:99]
    s_add_u32 s86, s86, 1024
    s_and_b32 s86, s86, 16383
    s_add_u32 s58, s86, s66
    v_mfma_f32_16x16x32_bf16 v[100:103], a[148:151], v[148:151], v[100:103]
    buffer_load_dwordx4 v[140:143], v23, s[24:27], s58 offen offset:0 sc1
    v_mfma_f32_16x16x32_bf16 v[104:107], a[152:155], v[148:151], v[104:107]
    v_mfma_f32_16x16x32_bf16 v[108:111], a[156:159], v[148:151], v[108:111]
    s_waitcnt vmcnt(9)
    v_mfma_f32_16x16x32_bf16 v[96:99], a[160:163], v[152:155], v[96:99]
    s_add_u32 s86, s86, 1024
    s_and_b32 s86, s86, 16383
    s_add_u32 s58, s86, s66
    v_mfma_f32_16x16x32_bf16 v[100:103], a[164:167], v[152:155], v[100:103]
    buffer_load_dwordx4 v[144:147], v23, s[24:27], s58 offen offset:0 sc1
    v_mfma_f32_16x16x32_bf16 v[104:107], a[168:171], v[152:155], v[104:107]
    v_mfma_f32_16x16x32_bf16 v[108:111], a[172:175], v[152:155], v[108:111]
    s_waitcnt vmcnt(9)
    v_mfma_f32_16x16x32_bf16 v[96:99], a[176:179], v[156:159], v[96:99]
    s_add_u32 s86, s86, 1024
    s_and_b32 s86, s86, 16383
    s_add_u32 s58, s86, s66
    v_mfma_f32_16x16x32_bf16 v[100:103], a[180:183], v[156:159], v[100:103]
    buffer_load_dwordx4 v[148:151], v23, s[24:27], s58 offen offset:0 sc1
    v_mfma_f32_16x16x32_bf16 v[104:107], a[184:187], v[156:159], v[104:107]
    v_mfma_f32_16x16x32_bf16 v[108:111], a[188:191], v[156:159], v[108:111]
    s_waitcnt vmcnt(9)
    v_mfma_f32_16x16x32_bf16 v[96:99], a[192:195], v[112:115], v[96:99]
    s_add_u32 s86, s86, 1024
    s_and_b32 s86, s86, 16383
    s_add_u32 s58, s86, s66
    v_mfma_f32_16x16x32_bf16 v[100:103], a[196:199], v[112:115], v[100:103]
    buffer_load_dwordx4 v[152:155], v23, s[24:27], s58 offen offset:0 sc1
    v_mfma_f32_16x16x32_bf16 v[104:107], a[200:203], v[112:115], v[104:107]
    v_mfma_f32_16x16x32_bf16 v[108:111], a[204:207], v[112:115], v[108:111]
    s_waitcnt vmcnt(9)
    v_mfma_f32_16x16x32_bf16 v[96:99], a[208:211], v[116:119], v[96:99]
    s_add_u32 s86, s86, 1024
    s_and_b32 s86, s86, 16383
    s_add_u32 s58, s86, s66
    v_mfma_f32_16x16x32_bf16 v[100:103], a[212:215], v[116:119], v[100:103]
    buffer_load_dwordx4 v[156:159], v23, s[24:27], s58 offen offset:0 sc1
    v_mfma_f32_16x16x32_bf16 v[104:107], a[216:219], v[116:119], v[104:107]
    v_mfma_f32_16x16x32_bf16 v[108:111], a[220:223], v[116:119], v[108:111]
    s_waitcnt vmcnt(9)
    s_waitcnt lgkmcnt(8)
    v_mfma_f32_16x16x32_bf16 v[96:99], a[224:227], v[120:123], v[96:99]
    s_add_u32 s86, s86, 1024
    s_and_b32 s86, s86, 16383
    s_add_u32 s58, s86, s66
    v_mfma_f32_16x16x32_bf16 v[100:103], a[228:231], v[120:123], v[100:103]
    buffer_load_dwordx4 v[112:115], v23, s[24:27], s58 offen offset:0 sc1
    v_mfma_f32_16x16x32_bf16 v[104:107], a[232:235], v[120:123], v[104:107]
    v_mfma_f32_16x16x32_bf16 v[108:111], a[236:239], v[120:123], v[108:111]
    s_waitcnt vmcnt(9)
    s_waitcnt lgkmcnt(0)
    v_mfma_f32_16x16x32_bf16 v[96:99], a[240:243], v[124:127], v[96:99]
    s_add_u32 s86, s86, 1024
    s_and_b32 s86, s86, 16383
    s_add_u32 s58, s86, s66
    v_mfma_f32_16x16x32_bf16 v[100:103], a[244:247], v[124:127], v[100:103]
    buffer_load_dwordx4 v[116:119], v23, s[24:27], s58 offen offset:0 sc1
    v_mfma_f32_16x16x32_bf16 v[104:107], a[248:251], v[124:127], v[104:107]
    v_mfma_f32_16x16x32_bf16 v[108:111], a[252:255], v[124:127], v[108:111]
    s_waitcnt vmcnt(9)
    v_mfma_f32_16x16x32_bf16 v[80:83], a[0:3], v[128:131], 0
    s_add_u32 s86, s86, 1024
    s_and_b32 s86, s86, 16383
    s_add_u32 s58, s86, s66
    v_mfma_f32_16x16x32_bf16 v[84:87], a[4:7], v[128:131], 0
    buffer_load_dwordx4 v[120:123], v23, s[24:27], s58 offen offset:0 sc1
    v_mfma_f32_16x16x32_bf16 v[88:91], a[8:11], v[128:131], 0
    v_mfma_f32_16x16x32_bf16 v[92:95], a[12:15], v[128:131], 0
    s_waitcnt vmcnt(9)
    v_mfma_f32_16x16x32_bf16 v[80:83], a[16:19], v[132:135], v[80:83]
    s_add_u32 s86, s86, 1024
    s_and_b32 s86, s86, 16383
    s_add_u32 s58, s86, s66
    v_mfma_f32_16x16x32_bf16 v[84:87], a[20:23], v[132:135], v[84:87]
    buffer_load_dwordx4 v[124:127], v23, s[24:27], s58 offen offset:0 sc1
    v_mfma_f32_16x16x32_bf16 v[88:91], a[24:27], v[132:135], v[88:91]
    ds_write_b128 v232, v[96:99] offset:49152
    v_mfma_f32_16x16x32_bf16 v[92:95], a[28:31], v[132:135], v[92:95]
    s_waitcnt vmcnt(9)
    v_mfma_f32_16x16x32_bf16 v[80:83], a[32:35], v[136:139], v[80:83]
    s_add_u32 s86, s86, 1024
    s_and_b32 s86, s86, 16383
    s_add_u32 s58, s86, s66
    v_mfma_f32_16x16x32_bf16 v[84:87], a[36:39], v[136:139], v[84:87]
    buffer_load_dwordx4 v[128:131], v23, s[24:27], s58 offen offset:0 sc1
    v_mfma_f32_16x16x32_bf16 v[88:91], a[40:43], v[136:139], v[88:91]
    ds_write_b128 v232, v[100:103] offset:50176
    v_mfma_f32_16x16x32_bf16 v[92:95], a[44:47], v[136:139], v[92:95]
    s_waitcnt vmcnt(9)
    v_mfma_f32_16x16x32_bf16 v[80:83], a[48:51], v[140:143], v[80:83]
    s_add_u32 s86, s86, 1024
    s_and_b32 s86, s86, 16383
    s_add_u32 s58, s86, s66
    v_mfma_f32_16x16x32_bf16 v[84:87], a[52:55], v[140:143], v[84:87]
    buffer_load_dwordx4 v[132:135], v23, s[24:27], s58 offen offset:0 sc1
    v_mfma_f32_16x16x32_bf16 v[88:91], a[56:59], v[140:143], v[88:91]
    ds_write_b128 v232, v[104:107] offset:51200
    v_mfma_f32_16x16x32_bf16 v[92:95], a[60:63], v[140:143], v[92:95]
    s_waitcnt vmcnt(9)
    v_mfma_f32_16x16x32_bf16 v[80:83], a[64:67], v[144:147], v[80:83]
    s_add_u32 s86, s86, 1024
    s_and_b32 s86, s86, 16383
    s_add_u32 s58, s86, s66
    v_mfma_f32_16x16x32_bf16 v[84:87], a[68:71], v[144:147], v[84:87]
    buffer_load_dwordx4 v[136:139], v23, s[24:27], s58 offen offset:0 sc1
    v_mfma_f32_16x16x32_bf16 v[88:91], a[72:75], v[144:147], v[88:91]
    ds_write_b128 v232, v[108:111] offset:52224
    v_mfma_f32_16x16x32_bf16 v[92:95], a[76:79], v[144:147], v[92:95]
    s_waitcnt vmcnt(9)
    v_mfma_f32_16x16x32_bf16 v[80:83], a[80:83], v[148:151], v[80:83]
    s_add_u32 s86, s86, 1024
    s_and_b32 s86, s86, 16383
    s_add_u32 s58, s86, s66
    v_mfma_f32_16x16x32_bf16 v[84:87], a[84:87], v[148:151], v[84:87]
    buffer_load_dwordx4 v[140:143], v23, s[24:27], s58 offen offset:0 sc1
    v_mfma_f32_16x16x32_bf16 v[88:91], a[88:91], v[148:151], v[88:91]
    v_mfma_f32_16x16x32_bf16 v[92:95], a[92:95], v[148:151], v[92:95]
    s_waitcnt vmcnt(9)
    v_mfma_f32_16x16x32_bf16 v[80:83], a[96:99], v[152:155], v[80:83]
    s_xor_b32 s66, s44, 2
    s_lshl2_add_u32 s66, s51, s66
    s_mul_i32 s66, s66, 66816
    s_lshl2_add_u32 s66, s52, s66
    s_lshl_b32 s86, s65, 10
    s_add_u32 s58, s86, s66
    v_mfma_f32_16x16x32_bf16 v[84:87], a[100:103], v[152:155], v[84:87]
    buffer_load_dwordx4 v[144:147], v23, s[24:27], s58 offen offset:0 sc1
    v_mfma_f32_16x16x32_bf16 v[88:91], a[104:107], v[152:155], v[88:91]
    v_mfma_f32_16x16x32_bf16 v[92:95], a[108:111], v[152:155], v[92:95]
    s_waitcnt vmcnt(9)
    v_mfma_f32_16x16x32_bf16 v[80:83], a[112:115], v[156:159], v[80:83]
    s_add_u32 s86, s86, 1024
    s_and_b32 s86, s86, 16383
    s_add_u32 s58, s86, s66
    v_mfma_f32_16x16x32_bf16 v[84:87], a[116:119], v[156:159], v[84:87]
    buffer_load_dwordx4 v[148:151], v23, s[24:27], s58 offen offset:0 sc1
    v_mfma_f32_16x16x32_bf16 v[88:91], a[120:123], v[156:159], v[88:91]
    s_waitcnt lgkmcnt(0)
    s_barrier
    v_mfma_f32_16x16x32_bf16 v[92:95], a[124:127], v[156:159], v[92:95]
    s_waitcnt vmcnt(9)
    v_mfma_f32_16x16x32_bf16 v[80:83], a[128:131], v[112:115], v[80:83]
    s_add_u32 s86, s86, 1024
    s_and_b32 s86, s86, 16383
    s_add_u32 s58, s86, s66
    v_mfma_f32_16x16x32_bf16 v[84:87], a[132:135], v[112:115], v[84:87]
    buffer_load_dwordx4 v[152:155], v23, s[24:27], s58 offen offset:0 sc1
    v_mfma_f32_16x16x32_bf16 v[88:91], a[136:139], v[112:115], v[88:91]
    ds_read_b128 v[160:163], v243 offset:0
    ds_read_b128 v[164:167], v243 offset:1024
    v_mfma_f32_16x16x32_bf16 v[92:95], a[140:143], v[112:115], v[92:95]
    ds_read_b128 v[168:171], v243 offset:4096
    s_waitcnt vmcnt(9)
    v_mfma_f32_16x16x32_bf16 v[80:83], a[144:147], v[116:119], v[80:83]
    s_add_u32 s86, s86, 1024
    s_and_b32 s86, s86, 16383
    s_add_u32 s58, s86, s66
    v_mfma_f32_16x16x32_bf16 v[84:87], a[148:151], v[116:119], v[84:87]
    buffer_load_dwordx4 v[156:159], v23, s[24:27], s58 offen offset:0 sc1
    v_mfma_f32_16x16x32_bf16 v[88:91], a[152:155], v[116:119], v[88:91]
    ds_read_b128 v[172:175], v243 offset:5120
    ds_read_b128 v[176:179], v243 offset:8192
    v_mfma_f32_16x16x32_bf16 v[92:95], a[156:159], v[116:119], v[92:95]
    ds_read_b128 v[180:183], v243 offset:9216
    s_waitcnt vmcnt(9)
    v_mfma_f32_16x16x32_bf16 v[80:83], a[160:163], v[120:123], v[80:83]
    s_add_u32 s86, s86, 1024
    s_and_b32 s86, s86, 16383
    s_add_u32 s58, s86, s66
    v_mfma_f32_16x16x32_bf16 v[84:87], a[164:167], v[120:123], v[84:87]
    buffer_load_dwordx4 v[112:115], v23, s[24:27], s58 offen offset:0 sc1
    v_mfma_f32_16x16x32_bf16 v[88:91], a[168:171], v[120:123], v[88:91]
    ds_read_b128 v[184:187], v243 offset:12288
    v_mfma_f32_16x16x32_bf16 v[92:95], a[172:175], v[120:123], v[92:95]
    ds_read_b128 v[188:191], v243 offset:13312
    s_waitcnt vmcnt(9)
    v_mfma_f32_16x16x32_bf16 v[80:83], a[176:179], v[124:127], v[80:83]
    s_add_u32 s86, s86, 1024
    s_and_b32 s86, s86, 16383
    s_add_u32 s58, s86, s66
    v_mfma_f32_16x16x32_bf16 v[84:87], a[180:183], v[124:127], v[84:87]
    buffer_load_dwordx4 v[116:119], v23, s[24:27], s58 offen offset:0 sc1
    v_mfma_f32_16x16x32_bf16 v[88:91], a[184:187], v[124:127], v[88:91]
    v_mfma_f32_16x16x32_bf16 v[92:95], a[188:191], v[124:127], v[92:95]
    s_waitcnt vmcnt(9)
    v_mfma_f32_16x16x32_bf16 v[80:83], a[192:195], v[128:131], v[80:83]
    s_add_u32 s86, s86, 1024
    s_and_b32 s86, s86, 16383
    s_add_u32 s58, s86, s66
    v_mfma_f32_16x16x32_bf16 v[84:87], a[196:199], v[128:131], v[84:87]
    buffer_load_dwordx4 v[120:123], v23, s[24:27], s58 offen offset:0 sc1
    v_mfma_f32_16x16x32_bf16 v[88:91], a[200:203], v[128:131], v[88:91]
    s_waitcnt lgkmcnt(0)
    v_add_f32 v160, v160, v168
    v_mfma_f32_16x16x32_bf16 v[92:95], a[204:207], v[128:131], v[92:95]
    v_add_f32 v161, v161, v169
    s_waitcnt vmcnt(9)
    v_mfma_f32_16x16x32_bf16 v[80:83], a[208:211], v[132:135], v[80:83]
    s_add_u32 s86, s86, 1024
    s_and_b32 s86, s86, 16383
    s_add_u32 s58, s86, s66
    v_mfma_f32_16x16x32_bf16 v[84:87], a[212:215], v[132:135], v[84:87]
    buffer_load_dwordx4 v[124:127], v23, s[24:27], s58 offen offset:0 sc1
    v_mfma_f32_16x16x32_bf16 v[88:91], a[216:219], v[132:135], v[88:91]
    v_add_f32 v162, v162, v170
    v_add_f32 v163, v163, v171
    v_mfma_f32_16x16x32_bf16 v[92:95], a[220:223], v[132:135], v[92:95]
    v_add_f32 v164, v164, v172
    s_waitcnt vmcnt(9)
    v_mfma_f32_16x16x32_bf16 v[80:83], a[224:227], v[136:139], v[80:83]
    s_add_u32 s86, s86, 1024
    s_and_b32 s86, s86, 16383
    s_add_u32 s58, s86, s66
    v_mfma_f32_16x16x32_bf16 v[84:87], a[228:231], v[136:139], v[84:87]
    buffer_load_dwordx4 v[128:131], v23, s[24:27], s58 offen offset:0 sc1
    v_mfma_f32_16x16x32_bf16 v[88:91], a[232:235], v[136:139], v[88:91]
    v_add_f32 v165, v165, v173
    v_add_f32 v166, v166, v174
    v_mfma_f32_16x16x32_bf16 v[92:95], a[236:239], v[136:139], v[92:95]
    v_add_f32 v167, v167, v175
    s_waitcnt vmcnt(9)
    v_mfma_f32_16x16x32_bf16 v[80:83], a[240:243], v[140:143], v[80:83]
    s_add_u32 s86, s86, 1024
    s_and_b32 s86, s86, 16383
    s_add_u32 s58, s86, s66
    v_mfma_f32_16x16x32_bf16 v[84:87], a[244:247], v[140:143], v[84:87]
    buffer_load_dwordx4 v[132:135], v23, s[24:27], s58 offen offset:0 sc1
    v_mfma_f32_16x16x32_bf16 v[88:91], a[248:251], v[140:143], v[88:91]
    v_add_f32 v160, v160, v176
    v_add_f32 v161, v161, v177
    v_mfma_f32_16x16x32_bf16 v[92:95], a[252:255], v[140:143], v[92:95]
    v_add_f32 v162, v162, v178
    s_waitcnt vmcnt(9)
    v_mfma_f32_16x16x32_bf16 v[64:67], a[0:3], v[144:147], 0
    s_add_u32 s86, s86, 1024
    s_and_b32 s86, s86, 16383
    s_add_u32 s58, s86, s66
    v_mfma_f32_16x16x32_bf16 v[68:71], a[4:7], v[144:147], 0
    buffer_load_dwordx4 v[136:139], v23, s[24:27], s58 offen offset:0 sc1
    v_mfma_f32_16x16x32_bf16 v[72:75], a[8:11], v[144:147], 0
    v_mfma_f32_16x16x32_bf16 v[76:79], a[12:15], v[144:147], 0
    s_waitcnt vmcnt(9)
    v_mfma_f32_16x16x32_bf16 v[64:67], a[16:19], v[148:151], v[64:67]
    s_add_u32 s86, s86, 1024
    s_and_b32 s86, s86, 16383
    s_add_u32 s58, s86, s66
    v_mfma_f32_16x16x32_bf16 v[68:71], a[20:23], v[148:151], v[68:71]
    buffer_load_dwordx4 v[140:143], v23, s[24:27], s58 offen offset:0 sc1
    v_mfma_f32_16x16x32_bf16 v[72:75], a[24:27], v[148:151], v[72:75]
    ds_write_b128 v232, v[80:83] offset:32768
    v_mfma_f32_16x16x32_bf16 v[76:79], a[28:31], v[148:151], v[76:79]
    s_waitcnt vmcnt(9)
    v_mfma_f32_16x16x32_bf16 v[64:67], a[32:35], v[152:155], v[64:67]
    s_add_u32 s86, s86, 1024
    s_and_b32 s86, s86, 16383
    s_add_u32 s58, s86, s66
    v_mfma_f32_16x16x32_bf16 v[68:71], a[36:39], v[152:155], v[68:71]
    buffer_load_dwordx4 v[144:147], v23, s[24:27], s58 offen offset:0 sc1
    v_mfma_f32_16x16x32_bf16 v[72:75], a[40:43], v[152:155], v[72:75]
    ds_write_b128 v232, v[84:87] offset:33792
    v_mfma_f32_16x16x32_bf16 v[76:79], a[44:47], v[152:155], v[76:79]
    s_waitcnt vmcnt(9)
    v_mfma_f32_16x16x32_bf16 v[64:67], a[48:51], v[156:159], v[64:67]
    s_add_u32 s86, s86, 1024
    s_and_b32 s86, s86, 16383
    s_add_u32 s58, s86, s66
    ds_write_b128 v232, v[88:91] offset:34816
    v_mfma_f32_16x16x32_bf16 v[68:71], a[52:55], v[156:159], v[68:71]
    buffer_load_dwordx4 v[148:151], v23, s[24:27], s58 offen offset:0 sc1
    v_mfma_f32_16x16x32_bf16 v[72:75], a[56:59], v[156:159], v[72:75]
    v_add_f32 v163, v163, v179
    v_add_f32 v164, v164, v180
    v_mfma_f32_16x16x32_bf16 v[76:79], a[60:63], v[156:159], v[76:79]
    v_add_f32 v165, v165, v181
    s_waitcnt vmcnt(9)
    v_mfma_f32_16x16x32_bf16 v[64:67], a[64:67], v[112:115], v[64:67]
    s_add_u32 s86, s86, 1024
    s_and_b32 s86, s86, 16383
    s_add_u32 s58, s86, s66
    ds_write_b128 v232, v[92:95] offset:35840
    v_mfma_f32_16x16x32_bf16 v[68:71], a[68:71], v[112:115], v[68:71]
    buffer_load_dwordx4 v[152:155], v23, s[24:27], s58 offen offset:0 sc1
    v_mfma_f32_16x16x32_bf16 v[72:75], a[72:75], v[112:115], v[72:75]
    v_add_f32 v166, v166, v182
    v_add_f32 v167, v167, v183
    v_mfma_f32_16x16x32_bf16 v[76:79], a[76:79], v[112:115], v[76:79]
    v_add_f32 v160, v160, v184
    s_waitcnt vmcnt(9)
    v_mfma_f32_16x16x32_bf16 v[64:67], a[80:83], v[116:119], v[64:67]
    s_add_u32 s86, s86, 1024
    s_and_b32 s86, s86, 16383
    s_add_u32 s58, s86, s66
    v_mfma_f32_16x16x32_bf16 v[68:71], a[84:87], v[116:119], v[68:71]
    buffer_load_dwordx4 v[156:159], v23, s[24:27], s58 offen offset:0 sc1
    v_mfma_f32_16x16x32_bf16 v[72:75], a[88:91], v[116:119], v[72:75]
    v_add_f32 v161, v161, v185
    v_add_f32 v162, v162, v186
    v_mfma_f32_16x16x32_bf16 v[76:79], a[92:95], v[116:119], v[76:79]
    v_add_f32 v163, v163, v187
    s_waitcnt vmcnt(9)
    v_mfma_f32_16x16x32_bf16 v[64:67], a[96:99], v[120:123], v[64:67]
    s_xor_b32 s66, s44, 1
    s_lshl2_add_u32 s66, s51, s66
    s_mul_i32 s66, s66, 66816
    s_lshl2_add_u32 s66, s52, s66
    s_lshl_b32 s86, s65, 10
    s_add_u32 s58, s86, s66
    v_mfma_f32_16x16x32_bf16 v[68:71], a[100:103], v[120:123], v[68:71]
    buffer_load_dwordx4 v[112:115], v23, s[24:27], s58 offen offset:0 sc1
    v_mfma_f32_16x16x32_bf16 v[72:75], a[104:107], v[120:123], v[72:75]
    v_add_f32 v164, v164, v188
    v_add_f32 v165, v165, v189
    v_mfma_f32_16x16x32_bf16 v[76:79], a[108:111], v[120:123], v[76:79]
    v_add_f32 v166, v166, v190
    s_waitcnt vmcnt(9)
    v_mfma_f32_16x16x32_bf16 v[64:67], a[112:115], v[124:127], v[64:67]
    s_add_u32 s86, s86, 1024
    s_and_b32 s86, s86, 16383
    s_add_u32 s58, s86, s66
    v_mfma_f32_16x16x32_bf16 v[68:71], a[116:119], v[124:127], v[68:71]
    buffer_load_dwordx4 v[116:119], v23, s[24:27], s58 offen offset:0 sc1
    v_mfma_f32_16x16x32_bf16 v[72:75], a[120:123], v[124:127], v[72:75]
    v_add_f32 v167, v167, v191
    v_mul_f32 v192, v160, v160
    v_mfma_f32_16x16x32_bf16 v[76:79], a[124:127], v[124:127], v[76:79]
    v_mul_f32 v193, v161, v161
    s_waitcnt vmcnt(9)
    v_mfma_f32_16x16x32_bf16 v[64:67], a[128:131], v[128:131], v[64:67]
    s_add_u32 s86, s86, 1024
    s_and_b32 s86, s86, 16383
    s_add_u32 s58, s86, s66
    v_mfma_f32_16x16x32_bf16 v[68:71], a[132:135], v[128:131], v[68:71]
    buffer_load_dwordx4 v[120:123], v23, s[24:27], s58 offen offset:0 sc1
    v_mfma_f32_16x16x32_bf16 v[72:75], a[136:139], v[128:131], v[72:75]
    v_mul_f32 v194, v162, v162
    v_mul_f32 v195, v163, v163
    v_mfma_f32_16x16x32_bf16 v[76:79], a[140:143], v[128:131], v[76:79]
    v_mul_f32 v196, v164, v164
    s_waitcnt vmcnt(9)
    v_mfma_f32_16x16x32_bf16 v[64:67], a[144:147], v[132:135], v[64:67]
    s_add_u32 s86, s86, 1024
    s_and_b32 s86, s86, 16383
    s_add_u32 s58, s86, s66
    v_mfma_f32_16x16x32_bf16 v[68:71], a[148:151], v[132:135], v[68:71]
    buffer_load_dwordx4 v[124:127], v23, s[24:27], s58 offen offset:0 sc1
    v_mfma_f32_16x16x32_bf16 v[72:75], a[152:155], v[132:135], v[72:75]
    v_mul_f32 v197, v165, v165
    v_mul_f32 v198, v166, v166
    v_mfma_f32_16x16x32_bf16 v[76:79], a[156:159], v[132:135], v[76:79]
    v_mul_f32 v199, v167, v167
    s_waitcnt vmcnt(9)
    v_mfma_f32_16x16x32_bf16 v[64:67], a[160:163], v[136:139], v[64:67]
    s_add_u32 s86, s86, 1024
    s_and_b32 s86, s86, 16383
    s_add_u32 s58, s86, s66
    v_mfma_f32_16x16x32_bf16 v[68:71], a[164:167], v[136:139], v[68:71]
    buffer_load_dwordx4 v[128:131], v23, s[24:27], s58 offen offset:0 sc1
    v_mfma_f32_16x16x32_bf16 v[72:75], a[168:171], v[136:139], v[72:75]
    v_fma_f32 v192, v192, v236, v237
    v_fma_f32 v193, v193, v236, v237
    v_mfma_f32_16x16x32_bf16 v[76:79], a[172:175], v[136:139], v[76:79]
    v_fma_f32 v194, v194, v236, v237
    s_waitcnt vmcnt(9)
    v_mfma_f32_16x16x32_bf16 v[64:67], a[176:179], v[140:143], v[64:67]
    s_add_u32 s86, s86, 1024
    s_and_b32 s86, s86, 16383
    s_add_u32 s58, s86, s66
    v_mfma_f32_16x16x32_bf16 v[68:71], a[180:183], v[140:143], v[68:71]
    buffer_load_dwordx4 v[132:135], v23, s[24:27], s58 offen offset:0 sc1
    v_mfma_f32_16x16x32_bf16 v[72:75], a[184:187], v[140:143], v[72:75]
    v_fma_f32 v195, v195, v236, v237
    v_fma_f32 v196, v196, v236, v237
    v_mfma_f32_16x16x32_bf16 v[76:79], a[188:191], v[140:143], v[76:79]
    v_fma_f32 v197, v197, v236, v237
    s_waitcnt vmcnt(9)
    v_mfma_f32_16x16x32_bf16 v[64:67], a[192:195], v[144:147], v[64:67]
    s_add_u32 s86, s86, 1024
    s_and_b32 s86, s86, 16383
    s_add_u32 s58, s86, s66
    v_mfma_f32_16x16x32_bf16 v[68:71], a[196:199], v[144:147], v[68:71]
    buffer_load_dwordx4 v[136:139], v23, s[24:27], s58 offen offset:0 sc1
    v_mfma_f32_16x16x32_bf16 v[72:75], a[200:203], v[144:147], v[72:75]
    v_fma_f32 v198, v198, v236, v237
    v_fma_f32 v199, v199, v236, v237
    v_mfma_f32_16x16x32_bf16 v[76:79], a[204:207], v[144:147], v[76:79]
    v_mul_f32 v192, v192, v160
    s_waitcnt vmcnt(9)
    v_mfma_f32_16x16x32_bf16 v[64:67], a[208:211], v[148:151], v[64:67]
    s_add_u32 s86, s86, 1024
    s_and_b32 s86, s86, 16383
    s_add_u32 s58, s86, s66
    v_mfma_f32_16x16x32_bf16 v[68:71], a[212:215], v[148:151], v[68:71]
    buffer_load_dwordx4 v[140:143], v23, s[24:27], s58 offen offset:0 sc1
    v_mfma_f32_16x16x32_bf16 v[72:75], a[216:219], v[148:151], v[72:75]
    v_mul_f32 v193, v193, v161
    v_mul_f32 v194, v194, v162
    v_mfma_f32_16x16x32_bf16 v[76:79], a[220:223], v[148:151], v[76:79]
    v_mul_f32 v195, v195, v163
    s_waitcnt vmcnt(9)
    v_mfma_f32_16x16x32_bf16 v[64:67], a[224:227], v[152:155], v[64:67]
    s_add_u32 s86, s86, 1024
    s_and_b32 s86, s86, 16383
    s_add_u32 s58, s86, s66
    v_mfma_f32_16x16x32_bf16 v[68:71], a[228:231], v[152:155], v[68:71]
    buffer_load_dwordx4 v[144:147], v23, s[24:27], s58 offen offset:0 sc1
    v_mfma_f32_16x16x32_bf16 v[72:75], a[232:235], v[152:155], v[72:75]
    v_mul_f32 v196, v196, v164
    v_mul_f32 v197, v197, v165
    v_mfma_f32_16x16x32_bf16 v[76:79], a[236:239], v[152:155], v[76:79]
    v_mul_f32 v198, v198, v166
    s_waitcnt vmcnt(9)
    v_mfma_f32_16x16x32_bf16 v[64:67], a[240:243], v[156:159], v[64:67]
    s_add_u32 s86, s86, 1024
    s_and_b32 s86, s86, 16383
    s_add_u32 s58, s86, s66
    v_mfma_f32_16x16x32_bf16 v[68:71], a[244:247], v[156:159], v[68:71]
    buffer_load_dwordx4 v[148:151], v23, s[24:27], s58 offen offset:0 sc1
    v_mfma_f32_16x16x32_bf16 v[72:75], a[248:251], v[156:159], v[72:75]
    v_mul_f32 v199, v199, v167
    v_mfma_f32_16x16x32_bf16 v[76:79], a[252:255], v[156:159], v[76:79]
    s_waitcnt vmcnt(9)
    v_mfma_f32_16x16x32_bf16 v[48:51], a[0:3], v[112:115], 0
    s_add_u32 s86, s86, 1024
    s_and_b32 s86, s86, 16383
    s_add_u32 s58, s86, s66
    v_mfma_f32_16x16x32_bf16 v[52:55], a[4:7], v[112:115], 0
    buffer_load_dwordx4 v[152:155], v23, s[24:27], s58 offen offset:0 sc1
    v_mfma_f32_16x16x32_bf16 v[56:59], a[8:11], v[112:115], 0
    v_mfma_f32_16x16x32_bf16 v[60:63], a[12:15], v[112:115], 0
    s_waitcnt vmcnt(9)
    v_mfma_f32_16x16x32_bf16 v[48:51], a[16:19], v[116:119], v[48:51]
    s_add_u32 s86, s86, 1024
    s_and_b32 s86, s86, 16383
    s_add_u32 s58, s86, s66
    v_mfma_f32_16x16x32_bf16 v[52:55], a[20:23], v[116:119], v[52:55]
    buffer_load_dwordx4 v[156:159], v23, s[24:27], s58 offen offset:0 sc1
    v_mfma_f32_16x16x32_bf16 v[56:59], a[24:27], v[116:119], v[56:59]
    ds_write_b128 v232, v[64:67] offset:16384
    v_mfma_f32_16x16x32_bf16 v[60:63], a[28:31], v[116:119], v[60:63]
    s_waitcnt vmcnt(9)
    v_mfma_f32_16x16x32_bf16 v[48:51], a[32:35], v[120:123], v[48:51]
    s_add_u32 s86, s86, 1024
    s_and_b32 s86, s86, 16383
    s_add_u32 s58, s86, s66
    v_mfma_f32_16x16x32_bf16 v[52:55], a[36:39], v[120:123], v[52:55]
    buffer_load_dwordx4 v[112:115], v23, s[24:27], s58 offen offset:0 sc1
    v_mfma_f32_16x16x32_bf16 v[56:59], a[40:43], v[120:123], v[56:59]
    ds_write_b128 v232, v[68:71] offset:17408
    v_mfma_f32_16x16x32_bf16 v[60:63], a[44:47], v[120:123], v[60:63]
    s_waitcnt vmcnt(9)
    v_mfma_f32_16x16x32_bf16 v[48:51], a[48:51], v[124:127], v[48:51]
    s_add_u32 s86, s86, 1024
    s_and_b32 s86, s86, 16383
    s_add_u32 s58, s86, s66
    ds_write_b128 v232, v[72:75] offset:18432
    v_mfma_f32_16x16x32_bf16 v[52:55], a[52:55], v[124:127], v[52:55]
    buffer_load_dwordx4 v[116:119], v23, s[24:27], s58 offen offset:0 sc1
    v_mfma_f32_16x16x32_bf16 v[56:59], a[56:59], v[124:127], v[56:59]
    v_exp_f32 v192, v192
    v_exp_f32 v193, v193
    v_mfma_f32_16x16x32_bf16 v[60:63], a[60:63], v[124:127], v[60:63]
    v_exp_f32 v194, v194
    s_waitcnt vmcnt(9)
    v_mfma_f32_16x16x32_bf16 v[48:51], a[64:67], v[128:131], v[48:51]
    s_add_u32 s86, s86, 1024
    s_and_b32 s86, s86, 16383
    s_add_u32 s58, s86, s66
    ds_write_b128 v232, v[76:79] offset:19456
    v_mfma_f32_16x16x32_bf16 v[52:55], a[68:71], v[128:131], v[52:55]
    buffer_load_dwordx4 v[120:123], v23, s[24:27], s58 offen offset:0 sc1
    v_mfma_f32_16x16x32_bf16 v[56:59], a[72:75], v[128:131], v[56:59]
    v_exp_f32 v195, v195
    v_exp_f32 v196, v196
    v_mfma_f32_16x16x32_bf16 v[60:63], a[76:79], v[128:131], v[60:63]
    v_exp_f32 v197, v197
    s_waitcnt vmcnt(9)
    v_mfma_f32_16x16x32_bf16 v[48:51], a[80:83], v[132:135], v[48:51]
    s_add_u32 s86, s86, 1024
    s_and_b32 s86, s86, 16383
    s_add_u32 s58, s86, s66
    v_mfma_f32_16x16x32_bf16 v[52:55], a[84:87], v[132:135], v[52:55]
    buffer_load_dwordx4 v[124:127], v23, s[24:27], s58 offen offset:0 sc1
    v_mfma_f32_16x16x32_bf16 v[56:59], a[88:91], v[132:135], v[56:59]
    v_exp_f32 v198, v198
    v_exp_f32 v199, v199
    v_mfma_f32_16x16x32_bf16 v[60:63], a[92:95], v[132:135], v[60:63]
    v_add_f32 v192, 1.0, v192
    s_waitcnt vmcnt(9)
    v_mfma_f32_16x16x32_bf16 v[48:51], a[96:99], v[136:139], v[48:51]
    s_xor_b32 s66, s44, 0
    s_lshl2_add_u32 s66, s51, s66
    s_mul_i32 s66, s66, 66816
    s_lshl2_add_u32 s66, s52, s66
    s_lshl_b32 s86, s65, 10
    s_add_u32 s58, s86, s66
    v_mfma_f32_16x16x32_bf16 v[52:55], a[100:103], v[136:139], v[52:55]
    buffer_load_dwordx4 v[128:131], v23, s[24:27], s58 offen offset:0 sc1
    v_mfma_f32_16x16x32_bf16 v[56:59], a[104:107], v[136:139], v[56:59]
    v_add_f32 v193, 1.0, v193
    v_add_f32 v194, 1.0, v194
    v_mfma_f32_16x16x32_bf16 v[60:63], a[108:111], v[136:139], v[60:63]
    v_add_f32 v195, 1.0, v195
    s_waitcnt vmcnt(9)
    v_mfma_f32_16x16x32_bf16 v[48:51], a[112:115], v[140:143], v[48:51]
    s_add_u32 s86, s86, 1024
    s_and_b32 s86, s86, 16383
    s_add_u32 s58, s86, s66
    v_mfma_f32_16x16x32_bf16 v[52:55], a[116:119], v[140:143], v[52:55]
    buffer_load_dwordx4 v[132:135], v23, s[24:27], s58 offen offset:0 sc1
    v_mfma_f32_16x16x32_bf16 v[56:59], a[120:123], v[140:143], v[56:59]
    v_add_f32 v196, 1.0, v196
    v_add_f32 v197, 1.0, v197
    v_mfma_f32_16x16x32_bf16 v[60:63], a[124:127], v[140:143], v[60:63]
    v_add_f32 v198, 1.0, v198
    s_waitcnt vmcnt(9)
    v_mfma_f32_16x16x32_bf16 v[48:51], a[128:131], v[144:147], v[48:51]
    s_add_u32 s86, s86, 1024
    s_and_b32 s86, s86, 16383
    s_add_u32 s58, s86, s66
    v_mfma_f32_16x16x32_bf16 v[52:55], a[132:135], v[144:147], v[52:55]
    buffer_load_dwordx4 v[136:139], v23, s[24:27], s58 offen offset:0 sc1
    v_mfma_f32_16x16x32_bf16 v[56:59], a[136:139], v[144:147], v[56:59]
    v_add_f32 v199, 1.0, v199
    v_rcp_f32 v192, v192
    v_mfma_f32_16x16x32_bf16 v[60:63], a[140:143], v[144:147], v[60:63]
    v_rcp_f32 v193, v193
    s_waitcnt vmcnt(9)
    v_mfma_f32_16x16x32_bf16 v[48:51], a[144:147], v[148:151], v[48:51]
    s_add_u32 s86, s86, 1024
    s_and_b32 s86, s86, 16383
    s_add_u32 s58, s86, s66
    v_mfma_f32_16x16x32_bf16 v[52:55], a[148:151], v[148:151], v[52:55]
    buffer_load_dwordx4 v[140:143], v23, s[24:27], s58 offen offset:0 sc1
    v_mfma_f32_16x16x32_bf16 v[56:59], a[152:155], v[148:151], v[56:59]
    v_rcp_f32 v194, v194
    v_rcp_f32 v195, v195
    v_mfma_f32_16x16x32_bf16 v[60:63], a[156:159], v[148:151], v[60:63]
    v_rcp_f32 v196, v196
    s_waitcnt vmcnt(9)
    v_mfma_f32_16x16x32_bf16 v[48:51], a[160:163], v[152:155], v[48:51]
    s_add_u32 s86, s86, 1024
    s_and_b32 s86, s86, 16383
    s_add_u32 s58, s86, s66
    v_mfma_f32_16x16x32_bf16 v[52:55], a[164:167], v[152:155], v[52:55]
    buffer_load_dwordx4 v[144:147], v23, s[24:27], s58 offen offset:0 sc1
    v_mfma_f32_16x16x32_bf16 v[56:59], a[168:171], v[152:155], v[56:59]
    v_rcp_f32 v197, v197
    v_rcp_f32 v198, v198
    v_mfma_f32_16x16x32_bf16 v[60:63], a[172:175], v[152:155], v[60:63]
    v_rcp_f32 v199, v199
    s_waitcnt vmcnt(9)
    v_mfma_f32_16x16x32_bf16 v[48:51], a[176:179], v[156:159], v[48:51]
    s_add_u32 s86, s86, 1024
    s_and_b32 s86, s86, 16383
    s_add_u32 s58, s86, s66
    v_mfma_f32_16x16x32_bf16 v[52:55], a[180:183], v[156:159], v[52:55]
    buffer_load_dwordx4 v[148:151], v23, s[24:27], s58 offen offset:0 sc1
    v_mfma_f32_16x16x32_bf16 v[56:59], a[184:187], v[156:159], v[56:59]
    v_mul_f32 v192, v192, v160
    v_mul_f32 v193, v193, v161
    v_mfma_f32_16x16x32_bf16 v[60:63], a[188:191], v[156:159], v[60:63]
    v_mul_f32 v194, v194, v162
    s_waitcnt vmcnt(9)
    v_mfma_f32_16x16x32_bf16 v[48:51], a[192:195], v[112:115], v[48:51]
    s_add_u32 s86, s86, 1024
    s_and_b32 s86, s86, 16383
    s_add_u32 s58, s86, s66
    v_mfma_f32_16x16x32_bf16 v[52:55], a[196:199], v[112:115], v[52:55]
    buffer_load_dwordx4 v[152:155], v23, s[24:27], s58 offen offset:0 sc1
    v_mfma_f32_16x16x32_bf16 v[56:59], a[200:203], v[112:115], v[56:59]
    v_mul_f32 v195, v195, v163
    v_mul_f32 v196, v196, v164
    v_mfma_f32_16x16x32_bf16 v[60:63], a[204:207], v[112:115], v[60:63]
    v_mul_f32 v197, v197, v165
    s_waitcnt vmcnt(9)
    v_mfma_f32_16x16x32_bf16 v[48:51], a[208:211], v[116:119], v[48:51]
    s_add_u32 s86, s86, 1024
    s_and_b32 s86, s86, 16383
    s_add_u32 s58, s86, s66
    v_mfma_f32_16x16x32_bf16 v[52:55], a[212:215], v[116:119], v[52:55]
    buffer_load_dwordx4 v[156:159], v23, s[24:27], s58 offen offset:0 sc1
    v_mfma_f32_16x16x32_bf16 v[56:59], a[216:219], v[116:119], v[56:59]
    v_mul_f32 v198, v198, v166
    v_mul_f32 v199, v199, v167
    v_mfma_f32_16x16x32_bf16 v[60:63], a[220:223], v[116:119], v[60:63]
    v_cvt_pk_bf16_f32 v96, v192, v193
    s_waitcnt vmcnt(9)
    v_mfma_f32_16x16x32_bf16 v[48:51], a[224:227], v[120:123], v[48:51]
    s_add_u32 s86, s86, 1024
    s_and_b32 s86, s86, 16383
    s_add_u32 s58, s86, s66
    v_mfma_f32_16x16x32_bf16 v[52:55], a[228:231], v[120:123], v[52:55]
    buffer_load_dwordx4 v[112:115], v23, s[24:27], s58 offen offset:0 sc1
    v_mfma_f32_16x16x32_bf16 v[56:59], a[232:235], v[120:123], v[56:59]
    v_cvt_pk_bf16_f32 v97, v194, v195
    v_cvt_pk_bf16_f32 v98, v196, v197
    v_mfma_f32_16x16x32_bf16 v[60:63], a[236:239], v[120:123], v[60:63]
    v_cvt_pk_bf16_f32 v99, v198, v199
    s_waitcnt vmcnt(9)
    v_mfma_f32_16x16x32_bf16 v[48:51], a[240:243], v[124:127], v[48:51]
    s_add_u32 s86, s86, 1024
    s_and_b32 s86, s86, 16383
    s_add_u32 s58, s86, s66
    v_mfma_f32_16x16x32_bf16 v[52:55], a[244:247], v[124:127], v[52:55]
    buffer_load_dwordx4 v[116:119], v23, s[24:27], s58 offen offset:0 sc1
    v_mfma_f32_16x16x32_bf16 v[56:59], a[248:251], v[124:127], v[56:59]
    v_mfma_f32_16x16x32_bf16 v[60:63], a[252:255], v[124:127], v[60:63]
    s_waitcnt vmcnt(9)
    v_mfma_f32_16x16x32_bf16 v[32:35], a[0:3], v[128:131], v[32:35]
    s_add_u32 s86, s86, 1024
    s_and_b32 s86, s86, 16383
    s_add_u32 s58, s86, s66
    v_mfma_f32_16x16x32_bf16 v[36:39], a[4:7], v[128:131], v[36:39]
    buffer_load_dwordx4 v[120:123], v23, s[24:27], s58 offen offset:0 sc1
    v_mfma_f32_16x16x32_bf16 v[40:43], a[8:11], v[128:131], v[40:43]
    v_mfma_f32_16x16x32_bf16 v[44:47], a[12:15], v[128:131], v[44:47]
    s_waitcnt vmcnt(9)
    v_mfma_f32_16x16x32_bf16 v[32:35], a[16:19], v[132:135], v[32:35]
    s_add_u32 s86, s86, 1024
    s_and_b32 s86, s86, 16383
    s_add_u32 s58, s86, s66
    v_mfma_f32_16x16x32_bf16 v[36:39], a[20:23], v[132:135], v[36:39]
    buffer_load_dwordx4 v[124:127], v23, s[24:27], s58 offen offset:0 sc1
    v_mfma_f32_16x16x32_bf16 v[40:43], a[24:27], v[132:135], v[40:43]
    ds_write_b128 v232, v[48:51] offset:0
    v_mfma_f32_16x16x32_bf16 v[44:47], a[28:31], v[132:135], v[44:47]
    ds_write_b128 v232, v[52:55] offset:1024
    s_waitcnt vmcnt(9)
    v_mfma_f32_16x16x32_bf16 v[32:35], a[32:35], v[136:139], v[32:35]
    s_add_u32 s86, s86, 1024
    s_and_b32 s86, s86, 16383
    s_add_u32 s58, s86, s66
    v_mfma_f32_16x16x32_bf16 v[36:39], a[36:39], v[136:139], v[36:39]
    buffer_load_dwordx4 v[128:131], v23, s[24:27], s58 offen offset:0 sc1
    v_mfma_f32_16x16x32_bf16 v[40:43], a[40:43], v[136:139], v[40:43]
    ds_write_b128 v232, v[56:59] offset:2048
    v_mfma_f32_16x16x32_bf16 v[44:47], a[44:47], v[136:139], v[44:47]
    ds_write_b128 v232, v[60:63] offset:3072
    s_waitcnt vmcnt(9)
    v_mfma_f32_16x16x32_bf16 v[32:35], a[48:51], v[140:143], v[32:35]
    s_add_u32 s86, s86, 1024
    s_and_b32 s86, s86, 16383
    s_add_u32 s58, s86, s66
    v_mfma_f32_16x16x32_bf16 v[36:39], a[52:55], v[140:143], v[36:39]
    buffer_load_dwordx4 v[132:135], v23, s[24:27], s58 offen offset:0 sc1
    v_mfma_f32_16x16x32_bf16 v[40:43], a[56:59], v[140:143], v[40:43]
    v_mfma_f32_16x16x32_bf16 v[44:47], a[60:63], v[140:143], v[44:47]
    s_waitcnt vmcnt(9)
    v_mfma_f32_16x16x32_bf16 v[32:35], a[64:67], v[144:147], v[32:35]
    s_add_u32 s86, s86, 1024
    s_and_b32 s86, s86, 16383
    s_add_u32 s58, s86, s66
    v_mfma_f32_16x16x32_bf16 v[36:39], a[68:71], v[144:147], v[36:39]
    buffer_load_dwordx4 v[136:139], v23, s[24:27], s58 offen offset:0 sc1
    v_mfma_f32_16x16x32_bf16 v[40:43], a[72:75], v[144:147], v[40:43]
    v_mfma_f32_16x16x32_bf16 v[44:47], a[76:79], v[144:147], v[44:47]
    s_waitcnt vmcnt(9)
    v_mfma_f32_16x16x32_bf16 v[32:35], a[80:83], v[148:151], v[32:35]
    s_add_u32 s86, s86, 1024
    s_and_b32 s86, s86, 16383
    s_add_u32 s58, s86, s66
    v_mfma_f32_16x16x32_bf16 v[36:39], a[84:87], v[148:151], v[36:39]
    buffer_load_dwordx4 v[140:143], v23, s[24:27], s58 offen offset:0 sc1
    v_mfma_f32_16x16x32_bf16 v[40:43], a[88:91], v[148:151], v[40:43]
    s_waitcnt lgkmcnt(0)
    s_barrier
    v_mfma_f32_16x16x32_bf16 v[44:47], a[92:95], v[148:151], v[44:47]
    buffer_load_dwordx4 v[216:219], v22, s[4:7], s71 offen
    s_waitcnt vmcnt(10)
    v_mfma_f32_16x16x32_bf16 v[32:35], a[96:99], v[152:155], v[32:35]
    ds_read_b128 v[160:163], v233 offset:0
    v_mfma_f32_16x16x32_bf16 v[36:39], a[100:103], v[152:155], v[36:39]
    ds_read_b128 v[176:179], v234 offset:16384
    v_mfma_f32_16x16x32_bf16 v[40:43], a[104:107], v[152:155], v[40:43]
    ds_read_b128 v[192:195], v235 offset:32768
    v_mfma_f32_16x16x32_bf16 v[44:47], a[108:111], v[152:155], v[44:47]
    buffer_load_dwordx4 v[220:223], v22, s[4:7], s72 offen
    s_waitcnt vmcnt(10)
    v_mfma_f32_16x16x32_bf16 v[32:35], a[112:115], v[156:159], v[32:35]
    ds_read_b128 v[164:167], v233 offset:1024
    v_mfma_f32_16x16x32_bf16 v[36:39], a[116:119], v[156:159], v[36:39]
    ds_read_b128 v[180:183], v234 offset:17408
    v_mfma_f32_16x16x32_bf16 v[40:43], a[120:123], v[156:159], v[40:43]
    ds_read_b128 v[196:199], v235 offset:33792
    v_mfma_f32_16x16x32_bf16 v[44:47], a[124:127], v[156:159], v[44:47]
    buffer_load_dwordx2 v[226:227], v26, s[4:7], s73 offen
    s_waitcnt vmcnt(10)
    v_mfma_f32_16x16x32_bf16 v[32:35], a[128:131], v[112:115], v[32:35]
    ds_read_b128 v[168:171], v233 offset:2048
    v_mfma_f32_16x16x32_bf16 v[36:39], a[132:135], v[112:115], v[36:39]
    ds_read_b128 v[184:187], v234 offset:18432
    v_mfma_f32_16x16x32_bf16 v[40:43], a[136:139], v[112:115], v[40:43]
    ds_read_b128 v[200:203], v235 offset:34816
    v_mfma_f32_16x16x32_bf16 v[44:47], a[140:143], v[112:115], v[44:47]
    buffer_load_ushort v224, v25, s[36:39], s74 offen
    s_waitcnt vmcnt(10)
    v_mfma_f32_16x16x32_bf16 v[32:35], a[144:147], v[116:119], v[32:35]
    ds_read_b128 v[172:175], v233 offset:3072
    v_mfma_f32_16x16x32_bf16 v[36:39], a[148:151], v[116:119], v[36:39]
    ds_read_b128 v[188:191], v234 offset:19456
    v_mfma_f32_16x16x32_bf16 v[40:43], a[152:155], v[116:119], v[40:43]
    ds_read_b128 v[204:207], v235 offset:35840
    v_mfma_f32_16x16x32_bf16 v[44:47], a[156:159], v[116:119], v[44:47]
    buffer_load_ushort v225, v25, s[36:39], s74 offen offset:64
    s_waitcnt vmcnt(10)
    v_mfma_f32_16x16x32_bf16 v[32:35], a[160:163], v[120:123], v[32:35]
    v_mfma_f32_16x16x32_bf16 v[36:39], a[164:167], v[120:123], v[36:39]
    v_mfma_f32_16x16x32_bf16 v[40:43], a[168:171], v[120:123], v[40:43]
    v_mfma_f32_16x16x32_bf16 v[44:47], a[172:175], v[120:123], v[44:47]
    buffer_load_ushort v228, v27, s[36:39], s74 offen
    s_waitcnt vmcnt(10)
    v_mfma_f32_16x16x32_bf16 v[32:35], a[176:179], v[124:127], v[32:35]
    s_waitcnt lgkmcnt(9)
    v_mfma_f32_16x16x32_bf16 v[36:39], a[180:183], v[124:127], v[36:39]
    v_add_f32 v160, v160, v176
    v_mfma_f32_16x16x32_bf16 v[40:43], a[184:187], v[124:127], v[40:43]
    v_add_f32 v161, v161, v177
    v_mfma_f32_16x16x32_bf16 v[44:47], a[188:191], v[124:127], v[44:47]
    v_add_f32 v162, v162, v178
    s_add_u32 m0, s52, 81920
    s_lshl_b32 s57, s76, 7
    buffer_load_dwordx4 v12, s[20:23], s57 offen offset:0 lds
    s_waitcnt vmcnt(10)
    v_mfma_f32_16x16x32_bf16 v[32:35], a[192:195], v[128:131], v[32:35]
    v_add_f32 v163, v163, v179
    v_mfma_f32_16x16x32_bf16 v[36:39], a[196:199], v[128:131], v[36:39]
    s_waitcnt lgkmcnt(6)
    v_mfma_f32_16x16x32_bf16 v[40:43], a[200:203], v[128:131], v[40:43]
    v_add_f32 v164, v164, v180
    v_mfma_f32_16x16x32_bf16 v[44:47], a[204:207], v[128:131], v[44:47]
    v_add_f32 v165, v165, v181
    s_add_u32 s57, s57, 31744
    buffer_load_dwordx4 v12, s[20:23], s57 offen offset:1024 lds
    s_waitcnt vmcnt(10)
    v_mfma_f32_16x16x32_bf16 v[32:35], a[208:211], v[132:135], v[32:35]
    v_add_f32 v166, v166, v182
    v_mfma_f32_16x16x32_bf16 v[36:39], a[212:215], v[132:135], v[36:39]
    v_add_f32 v167, v167, v183
    v_mfma_f32_16x16x32_bf16 v[40:43], a[216:219], v[132:135], v[40:43]
    s_waitcnt lgkmcnt(3)
    v_mfma_f32_16x16x32_bf16 v[44:47], a[220:223], v[132:135], v[44:47]
    v_add_f32 v168, v168, v184
    s_add_u32 s57, s57, 31744
    buffer_load_dwordx4 v12, s[20:23], s57 offen offset:2048 lds
    s_waitcnt vmcnt(10)
    v_mfma_f32_16x16x32_bf16 v[32:35], a[224:227], v[136:139], v[32:35]
    v_add_f32 v169, v169, v185
    v_mfma_f32_16x16x32_bf16 v[36:39], a[228:231], v[136:139], v[36:39]
    v_add_f32 v170, v170, v186
    v_mfma_f32_16x16x32_bf16 v[40:43], a[232:235], v[136:139], v[40:43]
    v_add_f32 v171, v171, v187
    v_mfma_f32_16x16x32_bf16 v[44:47], a[236:239], v[136:139], v[44:47]
    s_waitcnt lgkmcnt(0)
    s_add_u32 s57, s57, 31744
    buffer_load_dwordx4 v12, s[20:23], s57 offen offset:3072 lds
    s_waitcnt vmcnt(10)
    v_mfma_f32_16x16x32_bf16 v[32:35], a[240:243], v[140:143], v[32:35]
    v_add_f32 v172, v172, v188
    v_mfma_f32_16x16x32_bf16 v[36:39], a[244:247], v[140:143], v[36:39]
    v_add_f32 v173, v173, v189
    v_mfma_f32_16x16x32_bf16 v[40:43], a[248:251], v[140:143], v[40:43]
    v_add_f32 v174, v174, v190
    v_mfma_f32_16x16x32_bf16 v[44:47], a[252:255], v[140:143], v[44:47]
    v_add_f32 v175, v175, v191
    v_pk_add_f32 v[160:161], v[160:161], v[192:193]
    v_pk_add_f32 v[162:163], v[162:163], v[194:195]
    v_pk_add_f32 v[164:165], v[164:165], v[196:197]
    v_pk_add_f32 v[166:167], v[166:167], v[198:199]
    v_pk_add_f32 v[168:169], v[168:169], v[200:201]
    v_pk_add_f32 v[170:171], v[170:171], v[202:203]
    v_pk_add_f32 v[172:173], v[172:173], v[204:205]
    v_pk_add_f32 v[174:175], v[174:175], v[206:207]
    buffer_store_dwordx4 v[96:99], v23, s[24:27], s83 offen sc1
    s_add_u32 m0, s52, 98304
    s_lshl_b32 s57, s76, 7
    s_add_u32 s57, s57, 131072
    buffer_load_dwordx4 v12, s[20:23], s57 offen offset:0 lds
    v_pk_add_f32 v[32:33], v[32:33], v[160:161]
    v_pk_add_f32 v[34:35], v[34:35], v[162:163]
    v_pk_add_f32 v[36:37], v[36:37], v[164:165]
    v_pk_add_f32 v[38:39], v[38:39], v[166:167]
    v_pk_mul_f32 v[48:49], v[32:33], v[32:33]
    v_pk_mul_f32 v[50:51], v[34:35], v[34:35]
    v_pk_mul_f32 v[52:53], v[36:37], v[36:37]
    v_pk_mul_f32 v[54:55], v[38:39], v[38:39]
    s_add_u32 s57, s57, 31744
    buffer_load_dwordx4 v12, s[20:23], s57 offen offset:1024 lds
    v_pk_fma_f32 v[48:49], v[48:49], v[236:237], v[236:237] op_sel:[0,0,1] op_sel_hi:[1,0,1]
    v_pk_fma_f32 v[50:51], v[50:51], v[236:237], v[236:237] op_sel:[0,0,1] op_sel_hi:[1,0,1]
    v_pk_fma_f32 v[52:53], v[52:53], v[236:237], v[236:237] op_sel:[0,0,1] op_sel_hi:[1,0,1]
    v_pk_fma_f32 v[54:55], v[54:55], v[236:237], v[236:237] op_sel:[0,0,1] op_sel_hi:[1,0,1]
    v_pk_mul_f32 v[48:49], v[48:49], v[32:33]
    v_pk_mul_f32 v[50:51], v[50:51], v[34:35]
    v_pk_mul_f32 v[52:53], v[52:53], v[36:37]
    v_pk_mul_f32 v[54:55], v[54:55], v[38:39]
    s_add_u32 s57, s57, 31744
    buffer_load_dwordx4 v12, s[20:23], s57 offen offset:2048 lds
    v_exp_f32 v48, v48
    v_exp_f32 v49, v49
    v_exp_f32 v50, v50
    v_exp_f32 v51, v51
    v_exp_f32 v52, v52
    v_exp_f32 v53, v53
    v_exp_f32 v54, v54
    v_exp_f32 v55, v55
    v_pk_add_f32 v[48:49], v[48:49], 1.0 op_sel_hi:[1,0]
    v_pk_add_f32 v[50:51], v[50:51], 1.0 op_sel_hi:[1,0]
    v_pk_add_f32 v[52:53], v[52:53], 1.0 op_sel_hi:[1,0]
    v_pk_add_f32 v[54:55], v[54:55], 1.0 op_sel_hi:[1,0]
    s_add_u32 s57, s57, 31744
    buffer_load_dwordx4 v12, s[20:23], s57 offen offset:3072 lds
    v_rcp_f32 v48, v48
    v_rcp_f32 v49, v49
    v_rcp_f32 v50, v50
    v_rcp_f32 v51, v51
    v_rcp_f32 v52, v52
    v_rcp_f32 v53, v53
    v_rcp_f32 v54, v54
    v_rcp_f32 v55, v55
    s_add_u32 m0, s52, 114688
    s_lshl_b32 s57, s77, 7
    buffer_load_dwordx4 v12, s[20:23], s57 offen offset:0 lds
    v_pk_mul_f32 v[48:49], v[48:49], v[32:33]
    v_pk_mul_f32 v[50:51], v[50:51], v[34:35]
    v_pk_mul_f32 v[52:53], v[52:53], v[36:37]
    v_pk_mul_f32 v[54:55], v[54:55], v[38:39]
    v_cvt_pk_bf16_f32 v56, v48, v49
    v_cvt_pk_bf16_f32 v57, v50, v51
    v_cvt_pk_bf16_f32 v58, v52, v53
    v_cvt_pk_bf16_f32 v59, v54, v55
    buffer_store_dwordx4 v[56:59], v23, s[24:27], s67 offen offset:0 sc1
    v_pk_add_f32 v[40:41], v[40:41], v[168:169]
    v_pk_add_f32 v[42:43], v[42:43], v[170:171]
    v_pk_add_f32 v[44:45], v[44:45], v[172:173]
    v_pk_add_f32 v[46:47], v[46:47], v[174:175]
    s_add_u32 s57, s57, 31744
    buffer_load_dwordx4 v12, s[20:23], s57 offen offset:1024 lds
    v_pk_mul_f32 v[48:49], v[40:41], v[40:41]
    v_pk_mul_f32 v[50:51], v[42:43], v[42:43]
    v_pk_mul_f32 v[52:53], v[44:45], v[44:45]
    v_pk_mul_f32 v[54:55], v[46:47], v[46:47]
    v_pk_fma_f32 v[48:49], v[48:49], v[236:237], v[236:237] op_sel:[0,0,1] op_sel_hi:[1,0,1]
    v_pk_fma_f32 v[50:51], v[50:51], v[236:237], v[236:237] op_sel:[0,0,1] op_sel_hi:[1,0,1]
    v_pk_fma_f32 v[52:53], v[52:53], v[236:237], v[236:237] op_sel:[0,0,1] op_sel_hi:[1,0,1]
    v_pk_fma_f32 v[54:55], v[54:55], v[236:237], v[236:237] op_sel:[0,0,1] op_sel_hi:[1,0,1]
    s_add_u32 s57, s57, 31744
    buffer_load_dwordx4 v12, s[20:23], s57 offen offset:2048 lds
    v_pk_mul_f32 v[48:49], v[48:49], v[40:41]
    v_pk_mul_f32 v[50:51], v[50:51], v[42:43]
    v_pk_mul_f32 v[52:53], v[52:53], v[44:45]
    v_pk_mul_f32 v[54:55], v[54:55], v[46:47]
    v_exp_f32 v48, v48
    v_exp_f32 v49, v49
    v_exp_f32 v50, v50
    v_exp_f32 v51, v51
    v_exp_f32 v52, v52
    v_exp_f32 v53, v53
    v_exp_f32 v54, v54
    v_exp_f32 v55, v55
    s_add_u32 s57, s57, 31744
    buffer_load_dwordx4 v12, s[20:23], s57 offen offset:3072 lds
    v_pk_add_f32 v[48:49], v[48:49], 1.0 op_sel_hi:[1,0]
    v_pk_add_f32 v[50:51], v[50:51], 1.0 op_sel_hi:[1,0]
    v_pk_add_f32 v[52:53], v[52:53], 1.0 op_sel_hi:[1,0]
    v_pk_add_f32 v[54:55], v[54:55], 1.0 op_sel_hi:[1,0]
    v_rcp_f32 v48, v48
    v_rcp_f32 v49, v49
    v_rcp_f32 v50, v50
    v_rcp_f32 v51, v51
    s_add_u32 m0, s52, 131072
    s_lshl_b32 s57, s77, 7
    s_add_u32 s57, s57, 131072
    buffer_load_dwordx4 v12, s[20:23], s57 offen offset:0 lds
    v_rcp_f32 v52, v52
    v_rcp_f32 v53, v53
    v_rcp_f32 v54, v54
    v_rcp_f32 v55, v55
    v_pk_mul_f32 v[48:49], v[48:49], v[40:41]
    v_pk_mul_f32 v[50:51], v[50:51], v[42:43]
    v_pk_mul_f32 v[52:53], v[52:53], v[44:45]
    v_pk_mul_f32 v[54:55], v[54:55], v[46:47]
    v_cvt_pk_bf16_f32 v60, v48, v49
    v_cvt_pk_bf16_f32 v61, v50, v51
    v_cvt_pk_bf16_f32 v62, v52, v53
    v_cvt_pk_bf16_f32 v63, v54, v55
    buffer_store_dwordx4 v[60:63], v23, s[24:27], s67 offen offset:1024 sc1
    s_add_u32 s57, s57, 31744
    buffer_load_dwordx4 v12, s[20:23], s57 offen offset:1024 lds
    s_waitcnt vmcnt(13)
    ds_read_b64_tr_b16 a[0:1], v6 offset:32768
    ds_read_b64_tr_b16 a[2:3], v6 offset:34816
    ds_read_b64_tr_b16 a[4:5], v7 offset:32768
    ds_read_b64_tr_b16 a[6:7], v7 offset:34816
    ds_read_b64_tr_b16 a[8:9], v6 offset:33024
    ds_read_b64_tr_b16 a[10:11], v6 offset:35072
    ds_read_b64_tr_b16 a[12:13], v7 offset:33024
    ds_read_b64_tr_b16 a[14:15], v7 offset:35072
    s_add_u32 s57, s57, 31744
    buffer_load_dwordx4 v12, s[20:23], s57 offen offset:2048 lds
    s_add_u32 s57, s57, 31744
    buffer_load_dwordx4 v12, s[20:23], s57 offen offset:3072 lds
    s_add_u32 m0, s52, 147456
    s_lshl_b32 s57, s78, 7
    buffer_load_dwordx4 v12, s[20:23], s57 offen offset:0 lds
    s_add_u32 s57, s57, 31744
    buffer_load_dwordx4 v12, s[20:23], s57 offen offset:1024 lds
    s_waitcnt vmcnt(12)
    ds_read_b64_tr_b16 a[16:17], v6 offset:49152
    ds_read_b64_tr_b16 a[18:19], v6 offset:51200
    ds_read_b64_tr_b16 a[20:21], v7 offset:49152
    ds_read_b64_tr_b16 a[22:23], v7 offset:51200
    s_add_u32 s57, s57, 31744
    buffer_load_dwordx4 v12, s[20:23], s57 offen offset:2048 lds
    ds_read_b64_tr_b16 a[24:25], v6 offset:49408
    ds_read_b64_tr_b16 a[26:27], v6 offset:51456
    ds_read_b64_tr_b16 a[28:29], v7 offset:49408
    ds_read_b64_tr_b16 a[30:31], v7 offset:51456
    s_add_u32 s57, s57, 31744
    buffer_load_dwordx4 v12, s[20:23], s57 offen offset:3072 lds
    s_add_u32 m0, s52, 49152
    s_lshl_b32 s57, s78, 7
    s_add_u32 s57, s57, 131072
    buffer_load_dwordx4 v12, s[20:23], s57 offen offset:0 lds
    s_add_u32 s57, s57, 31744
    buffer_load_dwordx4 v12, s[20:23], s57 offen offset:1024 lds
    s_waitcnt vmcnt(11)
    ds_read_b64_tr_b16 a[32:33], v8 offset:0
    ds_read_b64_tr_b16 a[34:35], v8 offset:2048
    ds_read_b64_tr_b16 a[36:37], v9 offset:0
    ds_read_b64_tr_b16 a[38:39], v9 offset:2048
    s_add_u32 s57, s57, 31744
    buffer_load_dwordx4 v12, s[20:23], s57 offen offset:2048 lds
    ds_read_b64_tr_b16 a[40:41], v8 offset:256
    ds_read_b64_tr_b16 a[42:43], v8 offset:2304
    ds_read_b64_tr_b16 a[44:45], v9 offset:256
    ds_read_b64_tr_b16 a[46:47], v9 offset:2304
    s_add_u32 s57, s57, 31744
    buffer_load_dwordx4 v12, s[20:23], s57 offen offset:3072 lds
    s_waitcnt vmcnt(11)
    s_barrier
    s_cmp_lg_u32 s44, 0
    s_cbranch_scc1 L_nopub6
    s_lshl_b32 s60, s51, 5
    s_add_u32 s60, s60, s50
    s_lshl_b32 s60, s60, 7
    s_add_u32 s60, s60, 12713984
    v_mov_b32 v30, s47
    s_mov_b64 exec, 1
    buffer_store_dword v30, off, s[24:27], s60 sc1
    s_mov_b64 exec, -1
L_nopub6:
L_p3join:
    v_lshlrev_b32 v224, 16, v224
    v_lshlrev_b32 v176, 16, v216
    v_and_b32 v177, s61, v216
    v_lshlrev_b32 v178, 16, v217
    s_add_u32 m0, s52, 65536
    s_lshl_b32 s57, s79, 7
    buffer_load_dwordx4 v12, s[20:23], s57 offen offset:0 lds
    v_and_b32 v179, s61, v217
    v_lshlrev_b32 v180, 16, v218
    v_and_b32 v181, s61, v218
    v_lshlrev_b32 v182, 16, v219
    s_add_u32 s57, s57, 31744
    buffer_load_dwordx4 v12, s[20:23], s57 offen offset:1024 lds
    s_waitcnt vmcnt(10)
    ds_read_b64_tr_b16 a[48:49], v8 offset:16384
    ds_read_b64_tr_b16 a[50:51], v8 offset:18432
    ds_read_b64_tr_b16 a[52:53], v9 offset:16384
    ds_read_b64_tr_b16 a[54:55], v9 offset:18432
    s_add_u32 s57, s57, 31744
    buffer_load_dwordx4 v12, s[20:23], s57 offen offset:2048 lds
    ds_read_b64_tr_b16 a[56:57], v8 offset:16640
    ds_read_b64_tr_b16 a[58:59], v8 offset:18688
    ds_read_b64_tr_b16 a[60:61], v9 offset:16640
    ds_read_b64_tr_b16 a[62:63], v9 offset:18688
    v_and_b32 v183, s61, v219
    v_add_f32 v176, v176, v224
    v_add_f32 v177, v177, v224
    v_add_f32 v178, v178, v224
    s_add_u32 s57, s57, 31744
    buffer_load_dwordx4 v12, s[20:23], s57 offen offset:3072 lds
    v_add_f32 v179, v179, v224
    v_add_f32 v180, v180, v224
    v_add_f32 v181, v181, v224
    v_add_f32 v182, v182, v224
    s_waitcnt lgkmcnt(15)
    s_add_u32 m0, s52, 81920
    s_lshl_b32 s57, s79, 7
    s_add_u32 s57, s57, 131072
    buffer_load_dwordx4 v12, s[20:23], s57 offen offset:0 lds
    v_add_f32 v183, v183, v224
    v_lshlrev_b32 v225, 16, v225
    v_lshlrev_b32 v184, 16, v220
    v_and_b32 v185, s61, v220
    s_add_u32 s57, s57, 31744
    buffer_load_dwordx4 v12, s[20:23], s57 offen offset:1024 lds
    s_waitcnt vmcnt(10)
    ds_read_b64_tr_b16 a[64:65], v8 offset:32768
    ds_read_b64_tr_b16 a[66:67], v8 offset:34816
    ds_read_b64_tr_b16 a[68:69], v9 offset:32768
    ds_read_b64_tr_b16 a[70:71], v9 offset:34816
    v_lshlrev_b32 v186, 16, v221
    v_and_b32 v187, s61, v221
    v_lshlrev_b32 v188, 16, v222
    v_and_b32 v189, s61, v222
    ds_read_b64_tr_b16 a[72:73], v8 offset:33024
    ds_read_b64_tr_b16 a[74:75], v8 offset:35072
    ds_read_b64_tr_b16 a[76:77], v9 offset:33024
    ds_read_b64_tr_b16 a[78:79], v9 offset:35072
    s_add_u32 s57, s57, 31744
    buffer_load_dwordx4 v12, s[20:23], s57 offen offset:2048 lds
    v_lshlrev_b32 v190, 16, v223
    v_and_b32 v191, s61, v223
    v_add_f32 v184, v184, v225
    v_add_f32 v185, v185, v225
    s_add_u32 s57, s57, 31744
    buffer_load_dwordx4 v12, s[20:23], s57 offen offset:3072 lds
    v_add_f32 v186, v186, v225
    v_add_f32 v187, v187, v225
    v_add_f32 v188, v188, v225
    v_add_f32 v189, v189, v225
    s_add_u32 m0, s52, 98304
    s_lshl_b32 s57, s80, 7
    buffer_load_dwordx4 v12, s[20:23], s57 offen offset:0 lds
    v_add_f32 v190, v190, v225
    v_add_f32 v191, v191, v225
    v_lshlrev_b32 v228, 16, v228
    v_lshlrev_b32 v232, 16, v226
    v_and_b32 v233, s61, v226
    v_lshlrev_b32 v234, 16, v227
    v_and_b32 v235, s61, v227
    v_add_f32 v232, v232, v228
    s_add_u32 s57, s57, 31744
    buffer_load_dwordx4 v12, s[20:23], s57 offen offset:1024 lds
    s_waitcnt vmcnt(10)
    ds_read_b64_tr_b16 a[80:81], v6 offset:0
    ds_read_b64_tr_b16 a[82:83], v6 offset:2048
    ds_read_b64_tr_b16 a[84:85], v7 offset:0
    ds_read_b64_tr_b16 a[86:87], v7 offset:2048
    s_add_u32 s57, s57, 31744
    buffer_load_dwordx4 v12, s[20:23], s57 offen offset:2048 lds
    ds_read_b64_tr_b16 a[88:89], v6 offset:256
    ds_read_b64_tr_b16 a[90:91], v6 offset:2304
    ds_read_b64_tr_b16 a[92:93], v7 offset:256
    ds_read_b64_tr_b16 a[94:95], v7 offset:2304
    s_add_u32 s57, s57, 31744
    buffer_load_dwordx4 v12, s[20:23], s57 offen offset:3072 lds
    v_add_f32 v233, v233, v228
    v_add_f32 v234, v234, v228
    v_add_f32 v235, v235, v228
    s_waitcnt lgkmcnt(15)
    s_add_u32 m0, s52, 114688
    s_lshl_b32 s57, s80, 7
    s_add_u32 s57, s57, 131072
    buffer_load_dwordx4 v12, s[20:23], s57 offen offset:0 lds
    s_add_u32 s57, s57, 31744
    buffer_load_dwordx4 v12, s[20:23], s57 offen offset:1024 lds
    s_waitcnt vmcnt(10)
    ds_read_b64_tr_b16 a[96:97], v6 offset:16384
    ds_read_b64_tr_b16 a[98:99], v6 offset:18432
    ds_read_b64_tr_b16 a[100:101], v7 offset:16384
    ds_read_b64_tr_b16 a[102:103], v7 offset:18432
    s_add_u32 s57, s57, 31744
    buffer_load_dwordx4 v12, s[20:23], s57 offen offset:2048 lds
    ds_read_b64_tr_b16 a[104:105], v6 offset:16640
    ds_read_b64_tr_b16 a[106:107], v6 offset:18688
    ds_read_b64_tr_b16 a[108:109], v7 offset:16640
    ds_read_b64_tr_b16 a[110:111], v7 offset:18688
    s_add_u32 s57, s57, 31744
    buffer_load_dwordx4 v12, s[20:23], s57 offen offset:3072 lds
    s_add_u32 m0, s52, 131072
    s_lshl_b32 s57, s81, 7
    buffer_load_dwordx4 v12, s[20:23], s57 offen offset:0 lds
    s_add_u32 s57, s57, 31744
    buffer_load_dwordx4 v12, s[20:23], s57 offen offset:1024 lds
    s_waitcnt vmcnt(10)
    ds_read_b64_tr_b16 a[112:113], v6 offset:32768
    ds_read_b64_tr_b16 a[114:115], v6 offset:34816
    ds_read_b64_tr_b16 a[116:117], v7 offset:32768
    ds_read_b64_tr_b16 a[118:119], v7 offset:34816
    s_add_u32 s57, s57, 31744
    buffer_load_dwordx4 v12, s[20:23], s57 offen offset:2048 lds
    ds_read_b64_tr_b16 a[120:121], v6 offset:33024
    ds_read_b64_tr_b16 a[122:123], v6 offset:35072
    ds_read_b64_tr_b16 a[124:125], v7 offset:33024
    ds_read_b64_tr_b16 a[126:127], v7 offset:35072
    s_add_u32 s57, s57, 31744
    buffer_load_dwordx4 v12, s[20:23], s57 offen offset:3072 lds
    s_waitcnt lgkmcnt(15)
    s_add_u32 m0, s52, 147456
    s_lshl_b32 s57, s81, 7
    s_add_u32 s57, s57, 131072
    buffer_load_dwordx4 v12, s[20:23], s57 offen offset:0 lds
    s_add_u32 s57, s57, 31744
    buffer_load_dwordx4 v12, s[20:23], s57 offen offset:1024 lds
    s_waitcnt vmcnt(10)
    ds_read_b64_tr_b16 a[128:129], v6 offset:49152
    ds_read_b64_tr_b16 a[130:131], v6 offset:51200
    ds_read_b64_tr_b16 a[132:133], v7 offset:49152
    ds_read_b64_tr_b16 a[134:135], v7 offset:51200
    s_add_u32 s57, s57, 31744
    buffer_load_dwordx4 v12, s[20:23], s57 offen offset:2048 lds
    ds_read_b64_tr_b16 a[136:137], v6 offset:49408
    ds_read_b64_tr_b16 a[138:139], v6 offset:51456
    ds_read_b64_tr_b16 a[140:141], v7 offset:49408
    ds_read_b64_tr_b16 a[142:143], v7 offset:51456
    s_add_u32 s57, s57, 31744
    buffer_load_dwordx4 v12, s[20:23], s57 offen offset:3072 lds
    s_add_u32 m0, s52, 49152
    s_lshl_b32 s57, s82, 7
    buffer_load_dwordx4 v12, s[20:23], s57 offen offset:0 lds
    s_add_u32 s57, s57, 31744
    buffer_load_dwordx4 v12, s[20:23], s57 offen offset:1024 lds
    s_waitcnt vmcnt(10)
    ds_read_b64_tr_b16 a[144:145], v8 offset:0
    ds_read_b64_tr_b16 a[146:147], v8 offset:2048
    ds_read_b64_tr_b16 a[148:149], v9 offset:0
    ds_read_b64_tr_b16 a[150:151], v9 offset:2048
    s_add_u32 s57, s57, 31744
    buffer_load_dwordx4 v12, s[20:23], s57 offen offset:2048 lds
    ds_read_b64_tr_b16 a[152:153], v8 offset:256
    ds_read_b64_tr_b16 a[154:155], v8 offset:2304
    ds_read_b64_tr_b16 a[156:157], v9 offset:256
    ds_read_b64_tr_b16 a[158:159], v9 offset:2304
    s_add_u32 s57, s57, 31744
    buffer_load_dwordx4 v12, s[20:23], s57 offen offset:3072 lds
    s_waitcnt lgkmcnt(15)
    s_add_u32 m0, s52, 65536
    s_lshl_b32 s57, s82, 7
    s_add_u32 s57, s57, 131072
    buffer_load_dwordx4 v12, s[20:23], s57 offen offset:0 lds
    s_add_u32 s57, s57, 31744
    buffer_load_dwordx4 v12, s[20:23], s57 offen offset:1024 lds
    s_waitcnt vmcnt(10)
    ds_read_b64_tr_b16 a[160:161], v8 offset:16384
    ds_read_b64_tr_b16 a[162:163], v8 offset:18432
    ds_read_b64_tr_b16 a[164:165], v9 offset:16384
    ds_read_b64_tr_b16 a[166:167], v9 offset:18432
    s_add_u32 s57, s57, 31744
    buffer_load_dwordx4 v12, s[20:23], s57 offen offset:2048 lds
    ds_read_b64_tr_b16 a[168:169], v8 offset:16640
    ds_read_b64_tr_b16 a[170:171], v8 offset:18688
    ds_read_b64_tr_b16 a[172:173], v9 offset:16640
    ds_read_b64_tr_b16 a[174:175], v9 offset:18688
    s_add_u32 s57, s57, 31744
    buffer_load_dwordx4 v12, s[20:23], s57 offen offset:3072 lds
    s_add_u32 m0, s52, 81920
    s_mov_b32 s57, s75
    buffer_load_dwordx4 v15, s[12:15], s57 offen offset:0 lds
    s_add_u32 s57, s57, 24064
    buffer_load_dwordx4 v15, s[12:15], s57 offen offset:1024 lds
    s_waitcnt vmcnt(10)
    ds_read_b64_tr_b16 a[176:177], v8 offset:32768
    ds_read_b64_tr_b16 a[178:179], v8 offset:34816
    ds_read_b64_tr_b16 a[180:181], v9 offset:32768
    ds_read_b64_tr_b16 a[182:183], v9 offset:34816
    s_add_u32 s57, s57, 24064
    buffer_load_dwordx4 v15, s[12:15], s57 offen offset:2048 lds
    ds_read_b64_tr_b16 a[184:185], v8 offset:33024
    ds_read_b64_tr_b16 a[186:187], v8 offset:35072
    ds_read_b64_tr_b16 a[188:189], v9 offset:33024
    ds_read_b64_tr_b16 a[190:191], v9 offset:35072
    s_add_u32 s57, s57, 24064
    buffer_load_dwordx4 v15, s[12:15], s57 offen offset:3072 lds
    s_waitcnt lgkmcnt(15)
    s_add_u32 m0, s52, 98304
    s_mov_b32 s57, 0
    buffer_load_dwordx4 v13, s[12:15], s57 offen offset:0 lds
    s_add_u32 s57, s57, 6144
    buffer_load_dwordx4 v14, s[12:15], s57 offen offset:1024 lds
    s_waitcnt vmcnt(10)
    ds_read_b64_tr_b16 a[192:193], v6 offset:0
    ds_read_b64_tr_b16 a[194:195], v6 offset:2048
    ds_read_b64_tr_b16 a[196:197], v7 offset:0
    ds_read_b64_tr_b16 a[198:199], v7 offset:2048
    s_add_u32 s57, s57, 6144
    buffer_load_dwordx4 v13, s[12:15], s57 offen offset:2048 lds
    ds_read_b64_tr_b16 a[200:201], v6 offset:256
    ds_read_b64_tr_b16 a[202:203], v6 offset:2304
    ds_read_b64_tr_b16 a[204:205], v7 offset:256
    ds_read_b64_tr_b16 a[206:207], v7 offset:2304
    s_add_u32 s57, s57, 6144
    buffer_load_dwordx4 v14, s[12:15], s57 offen offset:3072 lds
    s_add_u32 m0, s52, 114688
    s_mov_b32 s57, 25088
    buffer_load_dwordx4 v13, s[12:15], s57 offen offset:0 lds
    s_add_u32 s57, s57, 6144
    buffer_load_dwordx4 v14, s[12:15], s57 offen offset:1024 lds
    s_waitcnt vmcnt(10)
    ds_read_b64_tr_b16 a[208:209], v6 offset:16384
    ds_read_b64_tr_b16 a[210:211], v6 offset:18432
    ds_read_b64_tr_b16 a[212:213], v7 offset:16384
    ds_read_b64_tr_b16 a[214:215], v7 offset:18432
    buffer_load_dword v17, v20, s[24:27], 0 offen sc1
    ds_read_b64_tr_b16 a[216:217], v6 offset:16640
    ds_read_b64_tr_b16 a[218:219], v6 offset:18688
    ds_read_b64_tr_b16 a[220:221], v7 offset:16640
    ds_read_b64_tr_b16 a[222:223], v7 offset:18688
    s_add_u32 s57, s57, 6144
    buffer_load_dwordx4 v13, s[12:15], s57 offen offset:2048 lds
    s_add_u32 s57, s57, 6144
    buffer_load_dwordx4 v14, s[12:15], s57 offen offset:3072 lds
    s_waitcnt lgkmcnt(15)
    s_add_u32 m0, s52, 131072
    s_mov_b32 s57, 50176
    buffer_load_dwordx4 v13, s[12:15], s57 offen offset:0 lds
    s_waitcnt vmcnt(10)
    v_add_u32 v16, 81920, v16
    ds_read_b64_tr_b16 v[192:193], v16 offset:0
    ds_read_b64_tr_b16 v[194:195], v16 offset:128
    ds_read_b64_tr_b16 v[196:197], v16 offset:1024
    ds_read_b64_tr_b16 v[198:199], v16 offset:1152
    ds_read_b64_tr_b16 v[200:201], v16 offset:2048
    ds_read_b64_tr_b16 v[202:203], v16 offset:2176
    ds_read_b64_tr_b16 v[204:205], v16 offset:3072
    ds_read_b64_tr_b16 v[206:207], v16 offset:3200
    s_add_u32 s57, s57, 6144
    buffer_load_dwordx4 v14, s[12:15], s57 offen offset:1024 lds
    s_add_u32 s57, s57, 6144
    buffer_load_dwordx4 v13, s[12:15], s57 offen offset:2048 lds
    s_add_u32 s57, s57, 6144
    buffer_load_dwordx4 v14, s[12:15], s57 offen offset:3072 lds
    s_add_u32 m0, s52, 147456
    s_mov_b32 s57, 75264
    buffer_load_dwordx4 v13, s[12:15], s57 offen offset:0 lds
    s_waitcnt vmcnt(10)
    ds_read_b64_tr_b16 a[224:225], v2 offset:49152
    ds_read_b64_tr_b16 a[226:227], v2 offset:49664
    ds_read_b64_tr_b16 a[228:229], v3 offset:49152
    ds_read_b64_tr_b16 a[230:231], v3 offset:49664
    s_add_u32 s57, s57, 6144
    buffer_load_dwordx4 v14, s[12:15], s57 offen offset:1024 lds
    ds_read_b64_tr_b16 a[232:233], v2 offset:49408
    ds_read_b64_tr_b16 a[234:235], v2 offset:49920
    ds_read_b64_tr_b16 a[236:237], v3 offset:49408
    ds_read_b64_tr_b16 a[238:239], v3 offset:49920
    s_add_u32 s57, s57, 6144
    buffer_load_dwordx4 v13, s[12:15], s57 offen offset:2048 lds
    s_add_u32 s57, s57, 6144
    buffer_load_dwordx4 v14, s[12:15], s57 offen offset:3072 lds
    s_waitcnt vmcnt(10)
    v_cmp_ne_u32 vcc, s47, v17
    s_nop 0
    s_cbranch_vccz L_ok8
    s_mov_b32 s59, 20000
L_spin7:
    buffer_load_dword v17, v20, s[24:27], 0 offen sc1
    s_waitcnt vmcnt(0)
    v_cmp_ne_u32 vcc, s47, v17
    s_nop 0
    s_cbranch_vccz L_ok8
    s_sub_u32 s59, s59, 1
    s_cbranch_scc0 L_spin7
L_ok8:
    s_mov_b32 s66, s68
    s_add_u32 s58, s66, s76
    buffer_load_dwordx4 v[144:147], v23, s[24:27], s58 offen offset:0 sc1
    buffer_load_dwordx4 v[148:151], v23, s[24:27], s58 offen offset:1024 sc1
    s_waitcnt vmcnt(10)
    ds_read_b64_tr_b16 a[240:241], v4 offset:0
    ds_read_b64_tr_b16 a[242:243], v4 offset:512
    ds_read_b64_tr_b16 a[244:245], v5 offset:0
    ds_read_b64_tr_b16 a[246:247], v5 offset:512
    s_add_u32 s58, s66, s77
    buffer_load_dwordx4 v[152:155], v23, s[24:27], s58 offen offset:0 sc1
    ds_read_b64_tr_b16 a[248:249], v4 offset:256
    ds_read_b64_tr_b16 a[250:251], v4 offset:768
    ds_read_b64_tr_b16 a[252:253], v5 offset:256
    ds_read_b64_tr_b16 a[254:255], v5 offset:768
    buffer_load_dwordx4 v[156:159], v23, s[24:27], s58 offen offset:1024 sc1
    s_add_u32 s58, s66, s78
    buffer_load_dwordx4 v[112:115], v23, s[24:27], s58 offen offset:0 sc1
    buffer_load_dwordx4 v[116:119], v23, s[24:27], s58 offen offset:1024 sc1
    s_add_u32 s58, s66, s79
    buffer_load_dwordx4 v[120:123], v23, s[24:27], s58 offen offset:0 sc1
    buffer_load_dwordx4 v[124:127], v23, s[24:27], s58 offen offset:1024 sc1
    s_add_u32 s58, s66, s80
    buffer_load_dwordx4 v[128:131], v23, s[24:27], s58 offen offset:0 sc1
    buffer_load_dwordx4 v[132:135], v23, s[24:27], s58 offen offset:1024 sc1
    s_waitcnt vmcnt(9)
    v_mfma_f32_16x16x32_bf16 v[96:99], v[144:147], a[0:3], 0
    s_add_u32 s58, s66, s81
    v_mfma_f32_16x16x32_bf16 v[100:103], v[144:147], a[4:7], 0
    buffer_load_dwordx4 v[136:139], v23, s[24:27], s58 offen offset:0 sc1
    v_mfma_f32_16x16x32_bf16 v[104:107], v[144:147], a[8:11], 0
    v_mfma_f32_16x16x32_bf16 v[108:111], v[144:147], a[12:15], 0
    s_waitcnt vmcnt(9)
    v_mfma_f32_16x16x32_bf16 v[96:99], v[148:151], a[16:19], v[96:99]
    v_mfma_f32_16x16x32_bf16 v[100:103], v[148:151], a[20:23], v[100:103]
    buffer_load_dwordx4 v[140:143], v23, s[24:27], s58 offen offset:1024 sc1
    v_mfma_f32_16x16x32_bf16 v[104:107], v[148:151], a[24:27], v[104:107]
    v_mfma_f32_16x16x32_bf16 v[108:111], v[148:151], a[28:31], v[108:111]
    s_waitcnt vmcnt(9)
    v_mfma_f32_16x16x32_bf16 v[96:99], v[152:155], a[32:35], v[96:99]
    s_add_u32 s58, s66, s82
    v_mfma_f32_16x16x32_bf16 v[100:103], v[152:155], a[36:39], v[100:103]
    buffer_load_dwordx4 v[144:147], v23, s[24:27], s58 offen offset:0 sc1
    v_mfma_f32_16x16x32_bf16 v[104:107], v[152:155], a[40:43], v[104:107]
    v_mfma_f32_16x16x32_bf16 v[108:111], v[152:155], a[44:47], v[108:111]
    s_waitcnt vmcnt(9)
    v_mfma_f32_16x16x32_bf16 v[96:99], v[156:159], a[48:51], v[96:99]
    v_mfma_f32_16x16x32_bf16 v[100:103], v[156:159], a[52:55], v[100:103]
    buffer_load_dwordx4 v[148:151], v23, s[24:27], s58 offen offset:1024 sc1
    v_mfma_f32_16x16x32_bf16 v[104:107], v[156:159], a[56:59], v[104:107]
    v_mfma_f32_16x16x32_bf16 v[108:111], v[156:159], a[60:63], v[108:111]
    s_waitcnt vmcnt(9)
    v_mfma_f32_16x16x32_bf16 v[96:99], v[112:115], a[64:67], v[96:99]
    s_xor_b32 s66, s44, 3
    s_lshl2_add_u32 s66, s49, s66
    s_mul_i32 s66, s66, 58624
    s_add_u32 s66, s66, s69
    s_add_u32 s58, s66, s76
    v_mfma_f32_16x16x32_bf16 v[100:103], v[112:115], a[68:71], v[100:103]
    buffer_load_dwordx4 v[152:155], v23, s[24:27], s58 offen offset:0 sc1
    v_mfma_f32_16x16x32_bf16 v[104:107], v[112:115], a[72:75], v[104:107]
    v_mfma_f32_16x16x32_bf16 v[108:111], v[112:115], a[76:79], v[108:111]
    s_waitcnt vmcnt(9)
    v_mfma_f32_16x16x32_bf16 v[96:99], v[116:119], a[80:83], v[96:99]
    v_mfma_f32_16x16x32_bf16 v[100:103], v[116:119], a[84:87], v[100:103]
    buffer_load_dwordx4 v[156:159], v23, s[24:27], s58 offen offset:1024 sc1
    v_mfma_f32_16x16x32_bf16 v[104:107], v[116:119], a[88:91], v[104:107]
    v_mfma_f32_16x16x32_bf16 v[108:111], v[116:119], a[92:95], v[108:111]
    s_waitcnt vmcnt(9)
    v_mfma_f32_16x16x32_bf16 v[96:99], v[120:123], a[96:99], v[96:99]
    s_add_u32 s58, s66, s77
    v_mfma_f32_16x16x32_bf16 v[100:103], v[120:123], a[100:103], v[100:103]
    buffer_load_dwordx4 v[112:115], v23, s[24:27], s58 offen offset:0 sc1
    v_mfma_f32_16x16x32_bf16 v[104:107], v[120:123], a[104:107], v[104:107]
    v_mfma_f32_16x16x32_bf16 v[108:111], v[120:123], a[108:111], v[108:111]
    s_waitcnt vmcnt(9)
    v_mfma_f32_16x16x32_bf16 v[96:99], v[124:127], a[112:115], v[96:99]
    v_mfma_f32_16x16x32_bf16 v[100:103], v[124:127], a[116:119], v[100:103]
    buffer_load_dwordx4 v[116:119], v23, s[24:27], s58 offen offset:1024 sc1
    v_mfma_f32_16x16x32_bf16 v[104:107], v[124:127], a[120:123], v[104:107]
    v_mfma_f32_16x16x32_bf16 v[108:111], v[124:127], a[124:127], v[108:111]
    s_waitcnt vmcnt(9)
    v_mfma_f32_16x16x32_bf16 v[96:99], v[128:131], a[128:131], v[96:99]
    s_add_u32 s58, s66, s78
    v_mfma_f32_16x16x32_bf16 v[100:103], v[128:131], a[132:135], v[100:103]
    buffer_load_dwordx4 v[120:123], v23, s[24:27], s58 offen offset:0 sc1
    v_mfma_f32_16x16x32_bf16 v[104:107], v[128:131], a[136:139], v[104:107]
    v_mfma_f32_16x16x32_bf16 v[108:111], v[128:131], a[140:143], v[108:111]
    s_waitcnt vmcnt(9)
    v_mfma_f32_16x16x32_bf16 v[96:99], v[132:135], a[144:147], v[96:99]
    v_mfma_f32_16x16x32_bf16 v[100:103], v[132:135], a[148:151], v[100:103]
    buffer_load_dwordx4 v[124:127], v23, s[24:27], s58 offen offset:1024 sc1
    v_mfma_f32_16x16x32_bf16 v[104:107], v[132:135], a[152:155], v[104:107]
    v_mfma_f32_16x16x32_bf16 v[108:111], v[132:135], a[156:159], v[108:111]
    s_waitcnt vmcnt(9)
    v_mfma_f32_16x16x32_bf16 v[96:99], v[136:139], a[160:163], v[96:99]
    s_add_u32 s58, s66, s79
    v_mfma_f32_16x16x32_bf16 v[100:103], v[136:139], a[164:167], v[100:103]
    buffer_load_dwordx4 v[128:131], v23, s[24:27], s58 offen offset:0 sc1
    v_mfma_f32_16x16x32_bf16 v[104:107], v[136:139], a[168:171], v[104:107]
    v_mfma_f32_16x16x32_bf16 v[108:111], v[136:139], a[172:175], v[108:111]
    s_waitcnt vmcnt(9)
    v_mfma_f32_16x16x32_bf16 v[96:99], v[140:143], a[176:179], v[96:99]
    v_mfma_f32_16x16x32_bf16 v[100:103], v[140:143], a[180:183], v[100:103]
    buffer_load_dwordx4 v[132:135], v23, s[24:27], s58 offen offset:1024 sc1
    v_mfma_f32_16x16x32_bf16 v[104:107], v[140:143], a[184:187], v[104:107]
    v_mfma_f32_16x16x32_bf16 v[108:111], v[140:143], a[188:191], v[108:111]
    s_waitcnt vmcnt(9)
    s_waitcnt lgkmcnt(15)
    v_mfma_f32_16x16x32_bf16 v[96:99], v[144:147], a[192:195], v[96:99]
    s_add_u32 s58, s66, s80
    v_mfma_f32_16x16x32_bf16 v[100:103], v[144:147], a[196:199], v[100:103]
    buffer_load_dwordx4 v[136:139], v23, s[24:27], s58 offen offset:0 sc1
    v_mfma_f32_16x16x32_bf16 v[104:107], v[144:147], a[200:203], v[104:107]
    v_mfma_f32_16x16x32_bf16 v[108:111], v[144:147], a[204:207], v[108:111]
    s_waitcnt vmcnt(9)
    v_mfma_f32_16x16x32_bf16 v[96:99], v[148:151], a[208:211], v[96:99]
    v_mfma_f32_16x16x32_bf16 v[100:103], v[148:151], a[212:215], v[100:103]
    buffer_load_dwordx4 v[140:143], v23, s[24:27], s58 offen offset:1024 sc1
    v_mfma_f32_16x16x32_bf16 v[104:107], v[148:151], a[216:219], v[104:107]
    v_mfma_f32_16x16x32_bf16 v[108:111], v[148:151], a[220:223], v[108:111]
    s_waitcnt vmcnt(9)
    v_mfma_f32_16x16x32_bf16 v[80:83], v[152:155], a[0:3], 0
    s_add_u32 s58, s66, s81
    v_mfma_f32_16x16x32_bf16 v[84:87], v[152:155], a[4:7], 0
    buffer_load_dwordx4 v[144:147], v23, s[24:27], s58 offen offset:0 sc1
    v_mfma_f32_16x16x32_bf16 v[88:91], v[152:155], a[8:11], 0
    v_mfma_f32_16x16x32_bf16 v[92:95], v[152:155], a[12:15], 0
    s_waitcnt vmcnt(9)
    v_mfma_f32_16x16x32_bf16 v[80:83], v[156:159], a[16:19], v[80:83]
    v_mfma_f32_16x16x32_bf16 v[84:87], v[156:159], a[20:23], v[84:87]
    buffer_load_dwordx4 v[148:151], v23, s[24:27], s58 offen offset:1024 sc1
    v_mfma_f32_16x16x32_bf16 v[88:91], v[156:159], a[24:27], v[88:91]
    v_mfma_f32_16x16x32_bf16 v[92:95], v[156:159], a[28:31], v[92:95]
    s_waitcnt vmcnt(9)
    v_mfma_f32_16x16x32_bf16 v[80:83], v[112:115], a[32:35], v[80:83]
    s_add_u32 s58, s66, s82
    v_mfma_f32_16x16x32_bf16 v[84:87], v[112:115], a[36:39], v[84:87]
    buffer_load_dwordx4 v[152:155], v23, s[24:27], s58 offen offset:0 sc1
    v_mfma_f32_16x16x32_bf16 v[88:91], v[112:115], a[40:43], v[88:91]
    v_mfma_f32_16x16x32_bf16 v[92:95], v[112:115], a[44:47], v[92:95]
    s_waitcnt vmcnt(9)
    v_mfma_f32_16x16x32_bf16 v[80:83], v[116:119], a[48:51], v[80:83]
    v_mfma_f32_16x16x32_bf16 v[84:87], v[116:119], a[52:55], v[84:87]
    buffer_load_dwordx4 v[156:159], v23, s[24:27], s58 offen offset:1024 sc1
    v_mfma_f32_16x16x32_bf16 v[88:91], v[116:119], a[56:59], v[88:91]
    v_mfma_f32_16x16x32_bf16 v[92:95], v[116:119], a[60:63], v[92:95]
    s_waitcnt vmcnt(9)
    v_mfma_f32_16x16x32_bf16 v[80:83], v[120:123], a[64:67], v[80:83]
    s_xor_b32 s66, s44, 2
    s_lshl2_add_u32 s66, s49, s66
    s_mul_i32 s66, s66, 58624
    s_add_u32 s66, s66, s69
    s_add_u32 s58, s66, s76
    v_mfma_f32_16x16x32_bf16 v[84:87], v[120:123], a[68:71], v[84:87]
    buffer_load_dwordx4 v[112:115], v23, s[24:27], s58 offen offset:0 sc1
    v_mfma_f32_16x16x32_bf16 v[88:91], v[120:123], a[72:75], v[88:91]
    v_mfma_f32_16x16x32_bf16 v[92:95], v[120:123], a[76:79], v[92:95]
    s_waitcnt vmcnt(9)
    v_mfma_f32_16x16x32_bf16 v[80:83], v[124:127], a[80:83], v[80:83]
    v_mfma_f32_16x16x32_bf16 v[84:87], v[124:127], a[84:87], v[84:87]
    buffer_load_dwordx4 v[116:119], v23, s[24:27], s58 offen offset:1024 sc1
    v_mfma_f32_16x16x32_bf16 v[88:91], v[124:127], a[88:91], v[88:91]
    v_mfma_f32_16x16x32_bf16 v[92:95], v[124:127], a[92:95], v[92:95]
    s_waitcnt vmcnt(9)
    v_mfma_f32_16x16x32_bf16 v[80:83], v[128:131], a[96:99], v[80:83]
    s_add_u32 s58, s66, s77
    v_mfma_f32_16x16x32_bf16 v[84:87], v[128:131], a[100:103], v[84:87]
    buffer_load_dwordx4 v[120:123], v23, s[24:27], s58 offen offset:0 sc1
    v_mfma_f32_16x16x32_bf16 v[88:91], v[128:131], a[104:107], v[88:91]
    v_mfma_f32_16x16x32_bf16 v[92:95], v[128:131], a[108:111], v[92:95]
    s_waitcnt vmcnt(9)
    v_mfma_f32_16x16x32_bf16 v[80:83], v[132:135], a[112:115], v[80:83]
    v_mfma_f32_16x16x32_bf16 v[84:87], v[132:135], a[116:119], v[84:87]
    buffer_load_dwordx4 v[124:127], v23, s[24:27], s58 offen offset:1024 sc1
    v_mfma_f32_16x16x32_bf16 v[88:91], v[132:135], a[120:123], v[88:91]
    v_mfma_f32_16x16x32_bf16 v[92:95], v[132:135], a[124:127], v[92:95]
    buffer_load_dword v19, v21, s[24:27], 0 offen sc1
    s_waitcnt vmcnt(10)
    v_mfma_f32_16x16x32_bf16 v[80:83], v[136:139], a[128:131], v[80:83]
    v_mfma_f32_16x16x32_bf16 v[84:87], v[136:139], a[132:135], v[84:87]
    v_mfma_f32_16x16x32_bf16 v[88:91], v[136:139], a[136:139], v[88:91]
    v_mfma_f32_16x16x32_bf16 v[92:95], v[136:139], a[140:143], v[92:95]
    s_waitcnt vmcnt(9)
    v_mfma_f32_16x16x32_bf16 v[80:83], v[140:143], a[144:147], v[80:83]
    s_add_u32 s58, s66, s78
    v_mfma_f32_16x16x32_bf16 v[84:87], v[140:143], a[148:151], v[84:87]
    buffer_load_dwordx4 v[128:131], v23, s[24:27], s58 offen offset:0 sc1
    v_mfma_f32_16x16x32_bf16 v[88:91], v[140:143], a[152:155], v[88:91]
    v_mfma_f32_16x16x32_bf16 v[92:95], v[140:143], a[156:159], v[92:95]
    s_waitcnt vmcnt(9)
    v_mfma_f32_16x16x32_bf16 v[80:83], v[144:147], a[160:163], v[80:83]
    v_mfma_f32_16x16x32_bf16 v[84:87], v[144:147], a[164:167], v[84:87]
    buffer_load_dwordx4 v[132:135], v23, s[24:27], s58 offen offset:1024 sc1
    v_mfma_f32_16x16x32_bf16 v[88:91], v[144:147], a[168:171], v[88:91]
    v_mfma_f32_16x16x32_bf16 v[92:95], v[144:147], a[172:175], v[92:95]
    s_waitcnt vmcnt(9)
    v_mfma_f32_16x16x32_bf16 v[80:83], v[148:151], a[176:179], v[80:83]
    s_add_u32 s58, s66, s79
    v_mfma_f32_16x16x32_bf16 v[84:87], v[148:151], a[180:183], v[84:87]
    buffer_load_dwordx4 v[136:139], v23, s[24:27], s58 offen offset:0 sc1
    v_mfma_f32_16x16x32_bf16 v[88:91], v[148:151], a[184:187], v[88:91]
    v_mfma_f32_16x16x32_bf16 v[92:95], v[148:151], a[188:191], v[92:95]
    s_waitcnt vmcnt(9)
    v_mfma_f32_16x16x32_bf16 v[80:83], v[152:155], a[192:195], v[80:83]
    v_mfma_f32_16x16x32_bf16 v[84:87], v[152:155], a[196:199], v[84:87]
    buffer_load_dwordx4 v[140:143], v23, s[24:27], s58 offen offset:1024 sc1
    v_mfma_f32_16x16x32_bf16 v[88:91], v[152:155], a[200:203], v[88:91]
    v_mfma_f32_16x16x32_bf16 v[92:95], v[152:155], a[204:207], v[92:95]
    s_waitcnt vmcnt(9)
    v_mfma_f32_16x16x32_bf16 v[80:83], v[156:159], a[208:211], v[80:83]
    s_add_u32 s58, s66, s80
    v_mfma_f32_16x16x32_bf16 v[84:87], v[156:159], a[212:215], v[84:87]
    buffer_load_dwordx4 v[144:147], v23, s[24:27], s58 offen offset:0 sc1
    v_mfma_f32_16x16x32_bf16 v[88:91], v[156:159], a[216:219], v[88:91]
    v_mfma_f32_16x16x32_bf16 v[92:95], v[156:159], a[220:223], v[92:95]
    s_waitcnt vmcnt(9)
    v_mfma_f32_16x16x32_bf16 v[64:67], v[112:115], a[0:3], 0
    v_mfma_f32_16x16x32_bf16 v[68:71], v[112:115], a[4:7], 0
    buffer_load_dwordx4 v[148:151], v23, s[24:27], s58 offen offset:1024 sc1
    v_mfma_f32_16x16x32_bf16 v[72:75], v[112:115], a[8:11], 0
    v_mfma_f32_16x16x32_bf16 v[76:79], v[112:115], a[12:15], 0
    s_waitcnt vmcnt(9)
    v_mfma_f32_16x16x32_bf16 v[64:67], v[116:119], a[16:19], v[64:67]
    s_add_u32 s58, s66, s81
    v_mfma_f32_16x16x32_bf16 v[68:71], v[116:119], a[20:23], v[68:71]
    buffer_load_dwordx4 v[152:155], v23, s[24:27], s58 offen offset:0 sc1
    v_mfma_f32_16x16x32_bf16 v[72:75], v[116:119], a[24:27], v[72:75]
    v_mfma_f32_16x16x32_bf16 v[76:79], v[116:119], a[28:31], v[76:79]
    s_waitcnt vmcnt(9)
    v_mfma_f32_16x16x32_bf16 v[64:67], v[120:123], a[32:35], v[64:67]
    v_mfma_f32_16x16x32_bf16 v[68:71], v[120:123], a[36:39], v[68:71]
    buffer_load_dwordx4 v[156:159], v23, s[24:27], s58 offen offset:1024 sc1
    v_mfma_f32_16x16x32_bf16 v[72:75], v[120:123], a[40:43], v[72:75]
    v_mfma_f32_16x16x32_bf16 v[76:79], v[120:123], a[44:47], v[76:79]
    s_waitcnt vmcnt(9)
    v_mfma_f32_16x16x32_bf16 v[64:67], v[124:127], a[48:51], v[64:67]
    s_add_u32 s58, s66, s82
    v_mfma_f32_16x16x32_bf16 v[68:71], v[124:127], a[52:55], v[68:71]
    buffer_load_dwordx4 v[112:115], v23, s[24:27], s58 offen offset:0 sc1
    v_mfma_f32_16x16x32_bf16 v[72:75], v[124:127], a[56:59], v[72:75]
    v_mfma_f32_16x16x32_bf16 v[76:79], v[124:127], a[60:63], v[76:79]
    buffer_load_dwordx4 v[116:119], v23, s[24:27], s58 offen offset:1024 sc1
    s_waitcnt vmcnt(10)
    v_cmp_ne_u32 vcc, s47, v19
    s_nop 0
    s_cbranch_vccz L_ok10
    s_mov_b32 s59, 20000
L_spin9:
    buffer_load_dword v19, v21, s[24:27], 0 offen sc1
    s_waitcnt vmcnt(0)
    v_cmp_ne_u32 vcc, s47, v19
    s_nop 0
    s_cbranch_vccz L_ok10
    s_sub_u32 s59, s59, 1
    s_cbranch_scc0 L_spin9
L_ok10:
    s_waitcnt vmcnt(9)
    v_mfma_f32_16x16x32_bf16 v[64:67], v[128:131], a[64:67], v[64:67]
    s_add_u32 s58, s70, 0
    v_mfma_f32_16x16x32_bf16 v[68:71], v[128:131], a[68:71], v[68:71]
    buffer_load_dwordx4 v[120:123], v23, s[24:27], s58 offen offset:0 sc1
    v_mfma_f32_16x16x32_bf16 v[72:75], v[128:131], a[72:75], v[72:75]
    v_mfma_f32_16x16x32_bf16 v[76:79], v[128:131], a[76:79], v[76:79]
    s_waitcnt vmcnt(9)
    v_mfma_f32_16x16x32_bf16 v[64:67], v[132:135], a[80:83], v[64:67]
    s_add_u32 s58, s70, 16384
    v_mfma_f32_16x16x32_bf16 v[68:71], v[132:135], a[84:87], v[68:71]
    buffer_load_dwordx4 v[124:127], v23, s[24:27], s58 offen offset:0 sc1
    v_mfma_f32_16x16x32_bf16 v[72:75], v[132:135], a[88:91], v[72:75]
    v_mfma_f32_16x16x32_bf16 v[76:79], v[132:135], a[92:95], v[76:79]
    s_waitcnt vmcnt(9)
    v_mfma_f32_16x16x32_bf16 v[64:67], v[136:139], a[96:99], v[64:67]
    s_add_u32 s58, s70, 32768
    v_mfma_f32_16x16x32_bf16 v[68:71], v[136:139], a[100:103], v[68:71]
    buffer_load_dwordx4 v[128:131], v23, s[24:27], s58 offen offset:0 sc1
    v_mfma_f32_16x16x32_bf16 v[72:75], v[136:139], a[104:107], v[72:75]
    v_mfma_f32_16x16x32_bf16 v[76:79], v[136:139], a[108:111], v[76:79]
    s_waitcnt vmcnt(9)
    v_mfma_f32_16x16x32_bf16 v[64:67], v[140:143], a[112:115], v[64:67]
    s_add_u32 s58, s70, 49152
    v_mfma_f32_16x16x32_bf16 v[68:71], v[140:143], a[116:119], v[68:71]
    buffer_load_dwordx4 v[132:135], v23, s[24:27], s58 offen offset:0 sc1
    v_mfma_f32_16x16x32_bf16 v[72:75], v[140:143], a[120:123], v[72:75]
    v_mfma_f32_16x16x32_bf16 v[76:79], v[140:143], a[124:127], v[76:79]
    s_waitcnt vmcnt(9)
    v_mfma_f32_16x16x32_bf16 v[64:67], v[144:147], a[128:131], v[64:67]
    s_add_u32 s58, s70, 0
    v_mfma_f32_16x16x32_bf16 v[68:71], v[144:147], a[132:135], v[68:71]
    buffer_load_dwordx4 v[136:139], v23, s[24:27], s58 offen offset:1024 sc1
    v_mfma_f32_16x16x32_bf16 v[72:75], v[144:147], a[136:139], v[72:75]
    v_mfma_f32_16x16x32_bf16 v[76:79], v[144:147], a[140:143], v[76:79]
    s_waitcnt vmcnt(9)
    v_mfma_f32_16x16x32_bf16 v[64:67], v[148:151], a[144:147], v[64:67]
    s_add_u32 s58, s70, 16384
    v_mfma_f32_16x16x32_bf16 v[68:71], v[148:151], a[148:151], v[68:71]
    buffer_load_dwordx4 v[140:143], v23, s[24:27], s58 offen offset:1024 sc1
    v_mfma_f32_16x16x32_bf16 v[72:75], v[148:151], a[152:155], v[72:75]
    v_mfma_f32_16x16x32_bf16 v[76:79], v[148:151], a[156:159], v[76:79]
    s_waitcnt vmcnt(9)
    v_mfma_f32_16x16x32_bf16 v[64:67], v[152:155], a[160:163], v[64:67]
    s_add_u32 s58, s70, 32768
    v_mfma_f32_16x16x32_bf16 v[68:71], v[152:155], a[164:167], v[68:71]
    buffer_load_dwordx4 v[144:147], v23, s[24:27], s58 offen offset:1024 sc1
    v_mfma_f32_16x16x32_bf16 v[72:75], v[152:155], a[168:171], v[72:75]
    v_mfma_f32_16x16x32_bf16 v[76:79], v[152:155], a[172:175], v[76:79]
    s_waitcnt vmcnt(9)
    v_mfma_f32_16x16x32_bf16 v[64:67], v[156:159], a[176:179], v[64:67]
    s_add_u32 s58, s70, 49152
    v_mfma_f32_16x16x32_bf16 v[68:71], v[156:159], a[180:183], v[68:71]
    buffer_load_dwordx4 v[148:151], v23, s[24:27], s58 offen offset:1024 sc1
    v_mfma_f32_16x16x32_bf16 v[72:75], v[156:159], a[184:187], v[72:75]
    v_mfma_f32_16x16x32_bf16 v[76:79], v[156:159], a[188:191], v[76:79]
    s_waitcnt vmcnt(9)
    v_mfma_f32_16x16x32_bf16 v[64:67], v[112:115], a[192:195], v[64:67]
    s_add_u32 s58, s70, 0
    v_mfma_f32_16x16x32_bf16 v[68:71], v[112:115], a[196:199], v[68:71]
    buffer_load_dwordx4 v[152:155], v23, s[24:27], s58 offen offset:2048 sc1
    v_mfma_f32_16x16x32_bf16 v[72:75], v[112:115], a[200:203], v[72:75]
    v_mfma_f32_16x16x32_bf16 v[76:79], v[112:115], a[204:207], v[76:79]
    s_waitcnt vmcnt(9)
    v_mfma_f32_16x16x32_bf16 v[64:67], v[116:119], a[208:211], v[64:67]
    s_add_u32 s58, s70, 16384
    v_mfma_f32_16x16x32_bf16 v[68:71], v[116:119], a[212:215], v[68:71]
    buffer_load_dwordx4 v[156:159], v23, s[24:27], s58 offen offset:2048 sc1
    v_mfma_f32_16x16x32_bf16 v[72:75], v[116:119], a[216:219], v[72:75]
    v_mfma_f32_16x16x32_bf16 v[76:79], v[116:119], a[220:223], v[76:79]
    s_waitcnt vmcnt(9)
    s_waitcnt lgkmcnt(8)
    v_mfma_f32_16x16x32_bf16 v[32:35], a[224:227], v[120:123], 0
    s_add_u32 s58, s70, 32768
    v_mfma_f32_16x16x32_bf16 v[48:51], a[228:231], v[120:123], 0
    buffer_load_dwordx4 v[112:115], v23, s[24:27], s58 offen offset:2048 sc1
    v_mfma_f32_16x16x32_bf16 v[64:67], a[232:235], v[120:123], v[64:67]
    v_mfma_f32_16x16x32_bf16 v[80:83], a[236:239], v[120:123], v[80:83]
    v_mfma_f32_16x16x32_bf16 v[96:99], v[192:195], v[120:123], v[96:99]
    s_waitcnt vmcnt(9)
    v_mfma_f32_16x16x32_bf16 v[36:39], a[224:227], v[124:127], 0
    s_add_u32 s58, s70, 49152
    v_mfma_f32_16x16x32_bf16 v[52:55], a[228:231], v[124:127], 0
    buffer_load_dwordx4 v[116:119], v23, s[24:27], s58 offen offset:2048 sc1
    v_mfma_f32_16x16x32_bf16 v[68:71], a[232:235], v[124:127], v[68:71]
    v_mfma_f32_16x16x32_bf16 v[84:87], a[236:239], v[124:127], v[84:87]
    v_mfma_f32_16x16x32_bf16 v[100:103], v[192:195], v[124:127], v[100:103]
    s_waitcnt vmcnt(9)
    v_mfma_f32_16x16x32_bf16 v[40:43], a[224:227], v[128:131], 0
    s_add_u32 s58, s70, 0
    v_mfma_f32_16x16x32_bf16 v[56:59], a[228:231], v[128:131], 0
    buffer_load_dwordx4 v[120:123], v23, s[24:27], s58 offen offset:3072 sc1
    v_mfma_f32_16x16x32_bf16 v[72:75], a[232:235], v[128:131], v[72:75]
    v_mfma_f32_16x16x32_bf16 v[88:91], a[236:239], v[128:131], v[88:91]
    v_mfma_f32_16x16x32_bf16 v[104:107], v[192:195], v[128:131], v[104:107]
    s_waitcnt vmcnt(9)
    v_mfma_f32_16x16x32_bf16 v[44:47], a[224:227], v[132:135], 0
    s_add_u32 s58, s70, 16384
    v_mfma_f32_16x16x32_bf16 v[60:63], a[228:231], v[132:135], 0
    buffer_load_dwordx4 v[124:127], v23, s[24:27], s58 offen offset:3072 sc1
    v_mfma_f32_16x16x32_bf16 v[76:79], a[232:235], v[132:135], v[76:79]
    v_mfma_f32_16x16x32_bf16 v[92:95], a[236:239], v[132:135], v[92:95]
    v_mfma_f32_16x16x32_bf16 v[108:111], v[192:195], v[132:135], v[108:111]
    ds_read_b64_tr_b16 a[224:225], v4 offset:16384
    ds_read_b64_tr_b16 a[226:227], v4 offset:16896
    ds_read_b64_tr_b16 a[228:229], v5 offset:16384
    ds_read_b64_tr_b16 a[230:231], v5 offset:16896
    s_waitcnt vmcnt(9)
    s_waitcnt lgkmcnt(4)
    v_mfma_f32_16x16x32_bf16 v[32:35], a[240:243], v[136:139], v[32:35]
    s_add_u32 s58, s70, 32768
    v_mfma_f32_16x16x32_bf16 v[48:51], a[244:247], v[136:139], v[48:51]
    buffer_load_dwordx4 v[128:131], v23, s[24:27], s58 offen offset:3072 sc1
    v_mfma_f32_16x16x32_bf16 v[64:67], a[248:251], v[136:139], v[64:67]
    v_mfma_f32_16x16x32_bf16 v[80:83], a[252:255], v[136:139], v[80:83]
    v_mfma_f32_16x16x32_bf16 v[96:99], v[196:199], v[136:139], v[96:99]
    ds_read_b64_tr_b16 a[232:233], v4 offset:16640
    ds_read_b64_tr_b16 a[234:235], v4 offset:17152
    ds_read_b64_tr_b16 a[236:237], v5 offset:16640
    ds_read_b64_tr_b16 a[238:239], v5 offset:17152
    s_waitcnt vmcnt(9)
    v_mfma_f32_16x16x32_bf16 v[36:39], a[240:243], v[140:143], v[36:39]
    s_add_u32 s58, s70, 49152
    v_mfma_f32_16x16x32_bf16 v[52:55], a[244:247], v[140:143], v[52:55]
    buffer_load_dwordx4 v[132:135], v23, s[24:27], s58 offen offset:3072 sc1
    v_mfma_f32_16x16x32_bf16 v[68:71], a[248:251], v[140:143], v[68:71]
    v_mfma_f32_16x16x32_bf16 v[84:87], a[252:255], v[140:143], v[84:87]
    v_mfma_f32_16x16x32_bf16 v[100:103], v[196:199], v[140:143], v[100:103]
    s_waitcnt vmcnt(9)
    v_mfma_f32_16x16x32_bf16 v[40:43], a[240:243], v[144:147], v[40:43]
    s_xor_b32 s66, s44, 1
    s_lshl2_add_u32 s66, s49, s66
    s_mul_i32 s66, s66, 58624
    s_add_u32 s66, s66, s69
    s_add_u32 s58, s66, s76
    v_mfma_f32_16x16x32_bf16 v[56:59], a[244:247], v[144:147], v[56:59]
    buffer_load_dwordx4 v[136:139], v23, s[24:27], s58 offen offset:0 sc1
    v_mfma_f32_16x16x32_bf16 v[72:75], a[248:251], v[144:147], v[72:75]
    v_mfma_f32_16x16x32_bf16 v[88:91], a[252:255], v[144:147], v[88:91]
    v_mfma_f32_16x16x32_bf16 v[104:107], v[196:199], v[144:147], v[104:107]
    s_waitcnt vmcnt(9)
    v_mfma_f32_16x16x32_bf16 v[44:47], a[240:243], v[148:151], v[44:47]
    v_mfma_f32_16x16x32_bf16 v[60:63], a[244:247], v[148:151], v[60:63]
    buffer_load_dwordx4 v[140:143], v23, s[24:27], s58 offen offset:1024 sc1
    v_mfma_f32_16x16x32_bf16 v[76:79], a[248:251], v[148:151], v[76:79]
    v_mfma_f32_16x16x32_bf16 v[92:95], a[252:255], v[148:151], v[92:95]
    v_mfma_f32_16x16x32_bf16 v[108:111], v[196:199], v[148:151], v[108:111]
    ds_read_b64_tr_b16 a[240:241], v4 offset:32768
    ds_read_b64_tr_b16 a[242:243], v4 offset:33280
    ds_read_b64_tr_b16 a[244:245], v5 offset:32768
    ds_read_b64_tr_b16 a[246:247], v5 offset:33280
    s_waitcnt vmcnt(9)
    s_waitcnt lgkmcnt(4)
    v_mfma_f32_16x16x32_bf16 v[32:35], a[224:227], v[152:155], v[32:35]
    s_add_u32 s58, s66, s77
    v_mfma_f32_16x16x32_bf16 v[48:51], a[228:231], v[152:155], v[48:51]
    buffer_load_dwordx4 v[144:147], v23, s[24:27], s58 offen offset:0 sc1
    v_mfma_f32_16x16x32_bf16 v[64:67], a[232:235], v[152:155], v[64:67]
    v_mfma_f32_16x16x32_bf16 v[80:83], a[236:239], v[152:155], v[80:83]
    v_mfma_f32_16x16x32_bf16 v[96:99], v[200:203], v[152:155], v[96:99]
    ds_read_b64_tr_b16 a[248:249], v4 offset:33024
    ds_read_b64_tr_b16 a[250:251], v4 offset:33536
    ds_read_b64_tr_b16 a[252:253], v5 offset:33024
    ds_read_b64_tr_b16 a[254:255], v5 offset:33536
    s_waitcnt vmcnt(9)
    v_mfma_f32_16x16x32_bf16 v[36:39], a[224:227], v[156:159], v[36:39]
    v_mfma_f32_16x16x32_bf16 v[52:55], a[228:231], v[156:159], v[52:55]
    buffer_load_dwordx4 v[148:151], v23, s[24:27], s58 offen offset:1024 sc1
    v_mfma_f32_16x16x32_bf16 v[68:71], a[232:235], v[156:159], v[68:71]
    v_mfma_f32_16x16x32_bf16 v[84:87], a[236:239], v[156:159], v[84:87]
    v_mfma_f32_16x16x32_bf16 v[100:103], v[200:203], v[156:159], v[100:103]
    s_waitcnt vmcnt(9)
    v_mfma_f32_16x16x32_bf16 v[40:43], a[224:227], v[112:115], v[40:43]
    s_add_u32 s58, s66, s78
    v_mfma_f32_16x16x32_bf16 v[56:59], a[228:231], v[112:115], v[56:59]
    buffer_load_dwordx4 v[152:155], v23, s[24:27], s58 offen offset:0 sc1
    v_mfma_f32_16x16x32_bf16 v[72:75], a[232:235], v[112:115], v[72:75]
    v_mfma_f32_16x16x32_bf16 v[88:91], a[236:239], v[112:115], v[88:91]
    v_mfma_f32_16x16x32_bf16 v[104:107], v[200:203], v[112:115], v[104:107]
    s_waitcnt vmcnt(9)
    v_mfma_f32_16x16x32_bf16 v[44:47], a[224:227], v[116:119], v[44:47]
    v_mfma_f32_16x16x32_bf16 v[60:63], a[228:231], v[116:119], v[60:63]
    buffer_load_dwordx4 v[156:159], v23, s[24:27], s58 offen offset:1024 sc1
    v_mfma_f32_16x16x32_bf16 v[76:79], a[232:235], v[116:119], v[76:79]
    v_mfma_f32_16x16x32_bf16 v[92:95], a[236:239], v[116:119], v[92:95]
    v_mfma_f32_16x16x32_bf16 v[108:111], v[200:203], v[116:119], v[108:111]
    s_waitcnt vmcnt(9)
    s_waitcnt lgkmcnt(0)
    v_mfma_f32_16x16x32_bf16 v[32:35], a[240:243], v[120:123], v[32:35]
    s_add_u32 s58, s66, s79
    v_mfma_f32_16x16x32_bf16 v[48:51], a[244:247], v[120:123], v[48:51]
    buffer_load_dwordx4 v[112:115], v23, s[24:27], s58 offen offset:0 sc1
    v_mfma_f32_16x16x32_bf16 v[64:67], a[248:251], v[120:123], v[64:67]
    v_mfma_f32_16x16x32_bf16 v[80:83], a[252:255], v[120:123], v[80:83]
    v_mfma_f32_16x16x32_bf16 v[96:99], v[204:207], v[120:123], v[96:99]
    s_waitcnt vmcnt(9)
    v_mfma_f32_16x16x32_bf16 v[36:39], a[240:243], v[124:127], v[36:39]
    v_mfma_f32_16x16x32_bf16 v[52:55], a[244:247], v[124:127], v[52:55]
    buffer_load_dwordx4 v[116:119], v23, s[24:27], s58 offen offset:1024 sc1
    v_mfma_f32_16x16x32_bf16 v[68:71], a[248:251], v[124:127], v[68:71]
    v_mfma_f32_16x16x32_bf16 v[84:87], a[252:255], v[124:127], v[84:87]
    v_mfma_f32_16x16x32_bf16 v[100:103], v[204:207], v[124:127], v[100:103]
    s_waitcnt vmcnt(9)
    v_mfma_f32_16x16x32_bf16 v[40:43], a[240:243], v[128:131], v[40:43]
    s_add_u32 s58, s66, s80
    v_mfma_f32_16x16x32_bf16 v[56:59], a[244:247], v[128:131], v[56:59]
    buffer_load_dwordx4 v[120:123], v23, s[24:27], s58 offen offset:0 sc1
    v_mfma_f32_16x16x32_bf16 v[72:75], a[248:251], v[128:131], v[72:75]
    v_mfma_f32_16x16x32_bf16 v[88:91], a[252:255], v[128:131], v[88:91]
    v_mfma_f32_16x16x32_bf16 v[104:107], v[204:207], v[128:131], v[104:107]
    s_waitcnt vmcnt(9)
    v_mfma_f32_16x16x32_bf16 v[44:47], a[240:243], v[132:135], v[44:47]
    v_mfma_f32_16x16x32_bf16 v[60:63], a[244:247], v[132:135], v[60:63]
    buffer_load_dwordx4 v[124:127], v23, s[24:27], s58 offen offset:1024 sc1
    v_mfma_f32_16x16x32_bf16 v[76:79], a[248:251], v[132:135], v[76:79]
    v_mfma_f32_16x16x32_bf16 v[92:95], a[252:255], v[132:135], v[92:95]
    v_mfma_f32_16x16x32_bf16 v[108:111], v[204:207], v[132:135], v[108:111]
    s_waitcnt vmcnt(9)
    v_mfma_f32_16x16x32_bf16 v[48:51], v[136:139], a[0:3], v[48:51]
    s_add_u32 s58, s66, s81
    v_mfma_f32_16x16x32_bf16 v[52:55], v[136:139], a[4:7], v[52:55]
    buffer_load_dwordx4 v[128:131], v23, s[24:27], s58 offen offset:0 sc1
    v_mfma_f32_16x16x32_bf16 v[56:59], v[136:139], a[8:11], v[56:59]
    v_mfma_f32_16x16x32_bf16 v[60:63], v[136:139], a[12:15], v[60:63]
    s_waitcnt vmcnt(9)
    v_mfma_f32_16x16x32_bf16 v[48:51], v[140:143], a[16:19], v[48:51]
    v_mfma_f32_16x16x32_bf16 v[52:55], v[140:143], a[20:23], v[52:55]
    buffer_load_dwordx4 v[132:135], v23, s[24:27], s58 offen offset:1024 sc1
    v_mfma_f32_16x16x32_bf16 v[56:59], v[140:143], a[24:27], v[56:59]
    v_mfma_f32_16x16x32_bf16 v[60:63], v[140:143], a[28:31], v[60:63]
    s_waitcnt vmcnt(9)
    v_mfma_f32_16x16x32_bf16 v[48:51], v[144:147], a[32:35], v[48:51]
    s_add_u32 s58, s66, s82
    v_mfma_f32_16x16x32_bf16 v[52:55], v[144:147], a[36:39], v[52:55]
    buffer_load_dwordx4 v[136:139], v23, s[24:27], s58 offen offset:0 sc1
    v_mfma_f32_16x16x32_bf16 v[56:59], v[144:147], a[40:43], v[56:59]
    ds_write_b128 v242, v[96:99] offset:0
    v_mfma_f32_16x16x32_bf16 v[60:63], v[144:147], a[44:47], v[60:63]
    s_waitcnt vmcnt(9)
    v_mfma_f32_16x16x32_bf16 v[48:51], v[148:151], a[48:51], v[48:51]
    v_mfma_f32_16x16x32_bf16 v[52:55], v[148:151], a[52:55], v[52:55]
    buffer_load_dwordx4 v[140:143], v23, s[24:27], s58 offen offset:1024 sc1
    v_mfma_f32_16x16x32_bf16 v[56:59], v[148:151], a[56:59], v[56:59]
    ds_write_b128 v242, v[100:103] offset:1024
    v_mfma_f32_16x16x32_bf16 v[60:63], v[148:151], a[60:63], v[60:63]
    s_waitcnt vmcnt(9)
    v_mfma_f32_16x16x32_bf16 v[48:51], v[152:155], a[64:67], v[48:51]
    s_xor_b32 s66, s44, 0
    s_lshl2_add_u32 s66, s49, s66
    s_mul_i32 s66, s66, 58624
    s_add_u32 s66, s66, s69
    s_add_u32 s58, s66, s76
    v_mfma_f32_16x16x32_bf16 v[52:55], v[152:155], a[68:71], v[52:55]
    buffer_load_dwordx4 v[144:147], v23, s[24:27], s58 offen offset:0 sc1
    v_mfma_f32_16x16x32_bf16 v[56:59], v[152:155], a[72:75], v[56:59]
    ds_write_b128 v242, v[104:107] offset:2048
    v_mfma_f32_16x16x32_bf16 v[60:63], v[152:155], a[76:79], v[60:63]
    s_waitcnt vmcnt(9)
    v_mfma_f32_16x16x32_bf16 v[48:51], v[156:159], a[80:83], v[48:51]
    v_mfma_f32_16x16x32_bf16 v[52:55], v[156:159], a[84:87], v[52:55]
    buffer_load_dwordx4 v[148:151], v23, s[24:27], s58 offen offset:1024 sc1
    v_mfma_f32_16x16x32_bf16 v[56:59], v[156:159], a[88:91], v[56:59]
    ds_write_b128 v242, v[108:111] offset:3072
    v_mfma_f32_16x16x32_bf16 v[60:63], v[156:159], a[92:95], v[60:63]
    s_waitcnt vmcnt(9)
    v_mfma_f32_16x16x32_bf16 v[48:51], v[112:115], a[96:99], v[48:51]
    s_add_u32 s58, s66, s77
    v_mfma_f32_16x16x32_bf16 v[52:55], v[112:115], a[100:103], v[52:55]
    buffer_load_dwordx4 v[152:155], v23, s[24:27], s58 offen offset:0 sc1
    v_mfma_f32_16x16x32_bf16 v[56:59], v[112:115], a[104:107], v[56:59]
    ds_write_b128 v241, v[80:83] offset:0
    v_mfma_f32_16x16x32_bf16 v[60:63], v[112:115], a[108:111], v[60:63]
    s_waitcnt vmcnt(9)
    v_mfma_f32_16x16x32_bf16 v[48:51], v[116:119], a[112:115], v[48:51]
    v_mfma_f32_16x16x32_bf16 v[52:55], v[116:119], a[116:119], v[52:55]
    buffer_load_dwordx4 v[156:159], v23, s[24:27], s58 offen offset:1024 sc1
    v_mfma_f32_16x16x32_bf16 v[56:59], v[116:119], a[120:123], v[56:59]
    ds_write_b128 v241, v[84:87] offset:16384
    v_mfma_f32_16x16x32_bf16 v[60:63], v[116:119], a[124:127], v[60:63]
    s_waitcnt vmcnt(9)
    v_mfma_f32_16x16x32_bf16 v[48:51], v[120:123], a[128:131], v[48:51]
    s_add_u32 s58, s66, s78
    v_mfma_f32_16x16x32_bf16 v[52:55], v[120:123], a[132:135], v[52:55]
    buffer_load_dwordx4 v[112:115], v23, s[24:27], s58 offen offset:0 sc1
    v_mfma_f32_16x16x32_bf16 v[56:59], v[120:123], a[136:139], v[56:59]
    ds_write_b128 v241, v[88:91] offset:32768
    v_mfma_f32_16x16x32_bf16 v[60:63], v[120:123], a[140:143], v[60:63]
    s_waitcnt vmcnt(9)
    v_mfma_f32_16x16x32_bf16 v[48:51], v[124:127], a[144:147], v[48:51]
    v_mfma_f32_16x16x32_bf16 v[52:55], v[124:127], a[148:151], v[52:55]
    buffer_load_dwordx4 v[116:119], v23, s[24:27], s58 offen offset:1024 sc1
    v_mfma_f32_16x16x32_bf16 v[56:59], v[124:127], a[152:155], v[56:59]
    ds_write_b128 v241, v[92:95] offset:49152
    v_mfma_f32_16x16x32_bf16 v[60:63], v[124:127], a[156:159], v[60:63]
    s_waitcnt vmcnt(9)
    v_mfma_f32_16x16x32_bf16 v[48:51], v[128:131], a[160:163], v[48:51]
    s_add_u32 s58, s66, s79
    v_mfma_f32_16x16x32_bf16 v[52:55], v[128:131], a[164:167], v[52:55]
    buffer_load_dwordx4 v[120:123], v23, s[24:27], s58 offen offset:0 sc1
    v_mfma_f32_16x16x32_bf16 v[56:59], v[128:131], a[168:171], v[56:59]
    ds_write_b128 v240, v[64:67] offset:0
    v_mfma_f32_16x16x32_bf16 v[60:63], v[128:131], a[172:175], v[60:63]
    s_waitcnt vmcnt(9)
    v_mfma_f32_16x16x32_bf16 v[48:51], v[132:135], a[176:179], v[48:51]
    v_mfma_f32_16x16x32_bf16 v[52:55], v[132:135], a[180:183], v[52:55]
    buffer_load_dwordx4 v[124:127], v23, s[24:27], s58 offen offset:1024 sc1
    v_mfma_f32_16x16x32_bf16 v[56:59], v[132:135], a[184:187], v[56:59]
    ds_write_b128 v240, v[68:71] offset:16384
    v_mfma_f32_16x16x32_bf16 v[60:63], v[132:135], a[188:191], v[60:63]
    s_waitcnt vmcnt(9)
    v_mfma_f32_16x16x32_bf16 v[48:51], v[136:139], a[192:195], v[48:51]
    s_add_u32 s58, s66, s80
    v_mfma_f32_16x16x32_bf16 v[52:55], v[136:139], a[196:199], v[52:55]
    buffer_load_dwordx4 v[128:131], v23, s[24:27], s58 offen offset:0 sc1
    v_mfma_f32_16x16x32_bf16 v[56:59], v[136:139], a[200:203], v[56:59]
    ds_write_b128 v240, v[72:75] offset:32768
    v_mfma_f32_16x16x32_bf16 v[60:63], v[136:139], a[204:207], v[60:63]
    s_waitcnt vmcnt(9)
    v_mfma_f32_16x16x32_bf16 v[48:51], v[140:143], a[208:211], v[48:51]
    v_mfma_f32_16x16x32_bf16 v[52:55], v[140:143], a[212:215], v[52:55]
    buffer_load_dwordx4 v[132:135], v23, s[24:27], s58 offen offset:1024 sc1
    v_mfma_f32_16x16x32_bf16 v[56:59], v[140:143], a[216:219], v[56:59]
    ds_write_b128 v240, v[76:79] offset:49152
    v_mfma_f32_16x16x32_bf16 v[60:63], v[140:143], a[220:223], v[60:63]
    s_waitcnt vmcnt(9)
    v_mfma_f32_16x16x32_bf16 v[32:35], v[144:147], a[0:3], v[32:35]
    s_add_u32 s58, s66, s81
    v_mfma_f32_16x16x32_bf16 v[36:39], v[144:147], a[4:7], v[36:39]
    buffer_load_dwordx4 v[136:139], v23, s[24:27], s58 offen offset:0 sc1
    v_mfma_f32_16x16x32_bf16 v[40:43], v[144:147], a[8:11], v[40:43]
    v_mfma_f32_16x16x32_bf16 v[44:47], v[144:147], a[12:15], v[44:47]
    s_waitcnt vmcnt(9)
    v_mfma_f32_16x16x32_bf16 v[32:35], v[148:151], a[16:19], v[32:35]
    v_mfma_f32_16x16x32_bf16 v[36:39], v[148:151], a[20:23], v[36:39]
    buffer_load_dwordx4 v[140:143], v23, s[24:27], s58 offen offset:1024 sc1
    v_mfma_f32_16x16x32_bf16 v[40:43], v[148:151], a[24:27], v[40:43]
    ds_write_b128 v239, v[48:51] offset:0
    v_mfma_f32_16x16x32_bf16 v[44:47], v[148:151], a[28:31], v[44:47]
    ds_write_b128 v239, v[52:55] offset:16384
    s_waitcnt vmcnt(9)
    v_mfma_f32_16x16x32_bf16 v[32:35], v[152:155], a[32:35], v[32:35]
    s_add_u32 s58, s66, s82
    v_mfma_f32_16x16x32_bf16 v[36:39], v[152:155], a[36:39], v[36:39]
    buffer_load_dwordx4 v[144:147], v23, s[24:27], s58 offen offset:0 sc1
    v_mfma_f32_16x16x32_bf16 v[40:43], v[152:155], a[40:43], v[40:43]
    ds_write_b128 v239, v[56:59] offset:32768
    v_mfma_f32_16x16x32_bf16 v[44:47], v[152:155], a[44:47], v[44:47]
    ds_write_b128 v239, v[60:63] offset:49152
    s_waitcnt vmcnt(9)
    v_mfma_f32_16x16x32_bf16 v[32:35], v[156:159], a[48:51], v[32:35]
    v_mfma_f32_16x16x32_bf16 v[36:39], v[156:159], a[52:55], v[36:39]
    buffer_load_dwordx4 v[148:151], v23, s[24:27], s58 offen offset:1024 sc1
    v_mfma_f32_16x16x32_bf16 v[40:43], v[156:159], a[56:59], v[40:43]
    v_mfma_f32_16x16x32_bf16 v[44:47], v[156:159], a[60:63], v[44:47]
    s_waitcnt vmcnt(9)
    v_mfma_f32_16x16x32_bf16 v[32:35], v[112:115], a[64:67], v[32:35]
    v_mfma_f32_16x16x32_bf16 v[36:39], v[112:115], a[68:71], v[36:39]
    v_mfma_f32_16x16x32_bf16 v[40:43], v[112:115], a[72:75], v[40:43]
    v_mfma_f32_16x16x32_bf16 v[44:47], v[112:115], a[76:79], v[44:47]
    s_waitcnt vmcnt(8)
    v_mfma_f32_16x16x32_bf16 v[32:35], v[116:119], a[80:83], v[32:35]
    s_waitcnt lgkmcnt(0)
    s_barrier
    v_mfma_f32_16x16x32_bf16 v[36:39], v[116:119], a[84:87], v[36:39]
    v_mfma_f32_16x16x32_bf16 v[40:43], v[116:119], a[88:91], v[40:43]
    v_mfma_f32_16x16x32_bf16 v[44:47], v[116:119], a[92:95], v[44:47]
    s_waitcnt vmcnt(7)
    v_mfma_f32_16x16x32_bf16 v[32:35], v[120:123], a[96:99], v[32:35]
    ds_read_b128 v[160:163], v252 offset:0
    v_mfma_f32_16x16x32_bf16 v[36:39], v[120:123], a[100:103], v[36:39]
    ds_read_b128 v[164:167], v252 offset:4096
    v_mfma_f32_16x16x32_bf16 v[40:43], v[120:123], a[104:107], v[40:43]
    ds_read_b128 v[168:171], v252 offset:8192
    v_mfma_f32_16x16x32_bf16 v[44:47], v[120:123], a[108:111], v[44:47]
    ds_read_b128 v[172:175], v252 offset:12288
    s_waitcnt vmcnt(6)
    v_mfma_f32_16x16x32_bf16 v[32:35], v[124:127], a[112:115], v[32:35]
    ds_read_b128 v[48:51], v246 offset:0
    v_mfma_f32_16x16x32_bf16 v[36:39], v[124:127], a[116:119], v[36:39]
    ds_read_b128 v[64:67], v248 offset:0
    v_mfma_f32_16x16x32_bf16 v[40:43], v[124:127], a[120:123], v[40:43]
    ds_read_b128 v[80:83], v250 offset:0
    v_mfma_f32_16x16x32_bf16 v[44:47], v[124:127], a[124:127], v[44:47]
    ds_read_b128 v[52:55], v247 offset:0
    s_waitcnt vmcnt(5)
    v_mfma_f32_16x16x32_bf16 v[32:35], v[128:131], a[128:131], v[32:35]
    ds_read_b128 v[68:71], v249 offset:0
    v_mfma_f32_16x16x32_bf16 v[36:39], v[128:131], a[132:135], v[36:39]
    ds_read_b128 v[84:87], v251 offset:0
    v_mfma_f32_16x16x32_bf16 v[40:43], v[128:131], a[136:139], v[40:43]
    ds_read_b128 v[56:59], v246 offset:32768
    v_mfma_f32_16x16x32_bf16 v[44:47], v[128:131], a[140:143], v[44:47]
    ds_read_b128 v[72:75], v248 offset:32768
    s_waitcnt vmcnt(4)
    v_mfma_f32_16x16x32_bf16 v[32:35], v[132:135], a[144:147], v[32:35]
    ds_read_b128 v[88:91], v250 offset:32768
    v_mfma_f32_16x16x32_bf16 v[36:39], v[132:135], a[148:151], v[36:39]
    ds_read_b128 v[60:63], v247 offset:32768
    v_mfma_f32_16x16x32_bf16 v[40:43], v[132:135], a[152:155], v[40:43]
    ds_read_b128 v[76:79], v249 offset:32768
    v_mfma_f32_16x16x32_bf16 v[44:47], v[132:135], a[156:159], v[44:47]
    ds_read_b128 v[92:95], v251 offset:32768
    s_waitcnt vmcnt(3)
    v_mfma_f32_16x16x32_bf16 v[32:35], v[136:139], a[160:163], v[32:35]
    s_waitcnt lgkmcnt(12)
    v_add_f32 v232, v232, v160
    v_mfma_f32_16x16x32_bf16 v[36:39], v[136:139], a[164:167], v[36:39]
    v_add_f32 v233, v233, v161
    v_mfma_f32_16x16x32_bf16 v[40:43], v[136:139], a[168:171], v[40:43]
    v_add_f32 v234, v234, v162
    v_mfma_f32_16x16x32_bf16 v[44:47], v[136:139], a[172:175], v[44:47]
    v_add_f32 v235, v235, v163
    s_waitcnt vmcnt(2)
    v_mfma_f32_16x16x32_bf16 v[32:35], v[140:143], a[176:179], v[32:35]
    v_add_f32 v232, v232, v164
    v_add_f32 v233, v233, v165
    v_mfma_f32_16x16x32_bf16 v[36:39], v[140:143], a[180:183], v[36:39]
    v_add_f32 v234, v234, v166
    v_mfma_f32_16x16x32_bf16 v[40:43], v[140:143], a[184:187], v[40:43]
    v_add_f32 v235, v235, v167
    v_mfma_f32_16x16x32_bf16 v[44:47], v[140:143], a[188:191], v[44:47]
    v_add_f32 v232, v232, v168
    s_waitcnt vmcnt(1)
    v_mfma_f32_16x16x32_bf16 v[32:35], v[144:147], a[192:195], v[32:35]
    v_add_f32 v233, v233, v169
    v_add_f32 v234, v234, v170
    v_mfma_f32_16x16x32_bf16 v[36:39], v[144:147], a[196:199], v[36:39]
    v_add_f32 v235, v235, v171
    v_mfma_f32_16x16x32_bf16 v[40:43], v[144:147], a[200:203], v[40:43]
    v_add_f32 v232, v232, v172
    v_mfma_f32_16x16x32_bf16 v[44:47], v[144:147], a[204:207], v[44:47]
    v_add_f32 v233, v233, v173
    s_waitcnt vmcnt(0)
    v_mfma_f32_16x16x32_bf16 v[32:35], v[148:151], a[208:211], v[32:35]
    v_add_f32 v234, v234, v174
    v_mfma_f32_16x16x32_bf16 v[36:39], v[148:151], a[212:215], v[36:39]
    v_add_f32 v235, v235, v175
    v_mfma_f32_16x16x32_bf16 v[40:43], v[148:151], a[216:219], v[40:43]
    v_cvt_pk_bf16_f32 v226, v232, v233
    v_cvt_pk_bf16_f32 v227, v234, v235
    v_mfma_f32_16x16x32_bf16 v[44:47], v[148:151], a[220:223], v[44:47]
    s_waitcnt lgkmcnt(0)
    buffer_store_dwordx2 v[226:227], v26, s[28:31], s73 offen
    v_pk_add_f32 v[176:177], v[176:177], v[48:49]
    v_pk_add_f32 v[178:179], v[178:179], v[50:51]
    v_pk_add_f32 v[180:181], v[180:181], v[52:53]
    v_pk_add_f32 v[182:183], v[182:183], v[54:55]
    v_pk_add_f32 v[184:185], v[184:185], v[56:57]
    v_pk_add_f32 v[186:187], v[186:187], v[58:59]
    ds_write_b128 v238, v[32:35] offset:0
    ds_write_b128 v238, v[36:39] offset:16384
    ds_write_b128 v238, v[40:43] offset:32768
    ds_write_b128 v238, v[44:47] offset:49152
    v_pk_add_f32 v[188:189], v[188:189], v[60:61]
    v_pk_add_f32 v[190:191], v[190:191], v[62:63]
    v_pk_add_f32 v[176:177], v[176:177], v[64:65]
    v_pk_add_f32 v[178:179], v[178:179], v[66:67]
    v_pk_add_f32 v[180:181], v[180:181], v[68:69]
    v_pk_add_f32 v[182:183], v[182:183], v[70:71]
    v_pk_add_f32 v[184:185], v[184:185], v[72:73]
    v_pk_add_f32 v[186:187], v[186:187], v[74:75]
    v_pk_add_f32 v[188:189], v[188:189], v[76:77]
    v_pk_add_f32 v[190:191], v[190:191], v[78:79]
    v_pk_add_f32 v[176:177], v[176:177], v[80:81]
    v_pk_add_f32 v[178:179], v[178:179], v[82:83]
    v_pk_add_f32 v[180:181], v[180:181], v[84:85]
    v_pk_add_f32 v[182:183], v[182:183], v[86:87]
    v_pk_add_f32 v[184:185], v[184:185], v[88:89]
    v_pk_add_f32 v[186:187], v[186:187], v[90:91]
    v_pk_add_f32 v[188:189], v[188:189], v[92:93]
    v_pk_add_f32 v[190:191], v[190:191], v[94:95]
    s_waitcnt lgkmcnt(0)
    s_barrier
    ds_read_b128 v[160:163], v244 offset:0
    ds_read_b128 v[164:167], v245 offset:0
    ds_read_b128 v[168:171], v244 offset:32768
    ds_read_b128 v[172:175], v245 offset:32768
    s_waitcnt lgkmcnt(2)
    v_pk_add_f32 v[176:177], v[176:177], v[160:161]
    v_pk_add_f32 v[178:179], v[178:179], v[162:163]
    v_pk_add_f32 v[180:181], v[180:181], v[164:165]
    v_pk_add_f32 v[182:183], v[182:183], v[166:167]
    v_cvt_pk_bf16_f32 v216, v176, v177
    v_cvt_pk_bf16_f32 v217, v178, v179
    v_cvt_pk_bf16_f32 v218, v180, v181
    v_cvt_pk_bf16_f32 v219, v182, v183
    buffer_store_dwordx4 v[216:219], v22, s[28:31], s71 offen
    s_waitcnt lgkmcnt(0)
    v_pk_add_f32 v[184:185], v[184:185], v[168:169]
    v_pk_add_f32 v[186:187], v[186:187], v[170:171]
    v_pk_add_f32 v[188:189], v[188:189], v[172:173]
    v_pk_add_f32 v[190:191], v[190:191], v[174:175]
    v_cvt_pk_bf16_f32 v220, v184, v185
    v_cvt_pk_bf16_f32 v221, v186, v187
    v_cvt_pk_bf16_f32 v222, v188, v189
    v_cvt_pk_bf16_f32 v223, v190, v191
    buffer_store_dwordx4 v[220:223], v22, s[28:31], s72 offen
L_end:
    s_endpgm
L_help:
    s_sub_u32 s55, s46, 21
    v_lshlrev_b32 v217, 7, v1
    v_lshrrev_b32 v218, 2, v1
    v_lshlrev_b32 v218, 12, v218
    v_lshl_add_u32 v218, v210, 7, v218
    buffer_load_dword v108, v217, s[32:35], 0 offen
    s_mul_i32 s54, s44, 28
    s_add_u32 s54, s54, s55
    s_add_u32 s54, s54, 6
    s_lshl_b32 s54, s54, 16
    s_lshl_b32 s56, s45, 9
    s_add_u32 s54, s54, s56
    buffer_load_dword v108, v218, s[20:23], s54 offen
    s_add_u32 s54, s54, 196608
    buffer_load_dword v108, v218, s[20:23], s54 offen
    s_add_u32 s54, s54, 196608
    buffer_load_dword v108, v218, s[20:23], s54 offen
    s_add_u32 s54, s54, 196608
    buffer_load_dword v108, v218, s[20:23], s54 offen
    s_add_u32 s54, s54, 196608
    buffer_load_dword v108, v218, s[20:23], s54 offen
    s_add_u32 s54, s54, 196608
    buffer_load_dword v108, v218, s[20:23], s54 offen
    s_add_u32 s54, s54, 196608
    buffer_load_dword v108, v218, s[20:23], s54 offen
    s_add_u32 s54, s54, 196608
    s_cmp_eq_u32 s55, 0
    s_cselect_b32 s54, s54, 2130706432
    buffer_load_dword v108, v218, s[20:23], s54 offen
    s_add_u32 s54, s54, 196608
    buffer_load_dword v108, v217, s[36:39], 0 offen
    s_waitcnt vmcnt(0) lgkmcnt(0)
    s_lshr_b32 s53, s46, 2
    s_and_b32 s49, s46, 3
    s_bfe_u32 s54, s46, 0x20001
    s_and_b32 s55, s46, 1
    s_add_u32 s55, s55, 4
    s_cmp_lt_u32 s46, 16
    s_cselect_b32 s53, s53, s54
    s_cselect_b32 s49, s49, s55
    s_lshl2_add_u32 s48, s45, s53
    s_mul_i32 s53, s44, 1835008
    s_lshl_b32 s74, s48, 7
    s_add_u32 s53, s53, s74
    v_lshlrev_b32 v217, 5, v212
    v_xor_b32 v217, v217, v214
    v_lshlrev_b32 v12, 12, v213
    v_add3_u32 v12, v12, v217, s53
    s_mul_i32 s53, s44, 100352
    s_lshl_b32 s54, s49, 7
    s_add_u32 s55, s53, s54
    s_lshl_b32 s56, s44, 5
    v_xor_b32 v217, s56, v214
    v_mul_u32_u24 v13, 896, v213
    v_add3_u32 v13, v13, v217, s55
    v_xor_b32 v14, 32, v13
    s_mul_i32 s73, s48, 57344
    s_add_u32 s71, s73, s54
    s_add_u32 s72, s71, 28672
    v_lshrrev_b32 v217, 1, v1
    v_mul_u32_u24 v15, 896, v217
    v_and_b32 v217, 1, v1
    v_lshl_add_u32 v15, v217, 4, v15
    v_add_u32 v15, s53, v15
    s_lshl_b32 s54, s49, 5
    s_add_u32 s54, s54, 768
    s_add_u32 s68, s49, 24
    s_mul_i32 s68, s68, 58624
    s_mul_i32 s69, s44, 14336
    s_add_u32 s69, s69, 2097152
    s_add_u32 s68, s68, s69
    s_add_u32 s73, s73, s54
    s_mov_b32 s76, 0
    s_add_u32 s77, s76, 2048
    s_cmp_eq_u32 s77, 14336
    s_cselect_b32 s77, 0, s77
    s_add_u32 s78, s77, 2048
    s_cmp_eq_u32 s78, 14336
    s_cselect_b32 s78, 0, s78
    s_add_u32 s79, s78, 2048
    s_cmp_eq_u32 s79, 14336
    s_cselect_b32 s79, 0, s79
    s_add_u32 s80, s79, 2048
    s_cmp_eq_u32 s80, 14336
    s_cselect_b32 s80, 0, s80
    s_add_u32 s81, s80, 2048
    s_cmp_eq_u32 s81, 14336
    s_cselect_b32 s81, 0, s81
    s_add_u32 s82, s81, 2048
    s_cmp_eq_u32 s82, 14336
    s_cselect_b32 s82, 0, s82
    s_cmp_lt_u32 s49, 4
    s_cselect_b32 s75, s54, 2130706432
    s_cselect_b32 s68, s68, 2130706432
    s_cselect_b32 s73, s73, 2130706432
    v_lshl_add_u32 v217, v208, 3, v209
    v_lshlrev_b32 v16, 5, v217
    v_lshl_add_u32 v16, v210, 3, v16
    v_add_u32 v16, s52, v16
    v_and_b32 v217, 7, v1
    v_min_u32 v218, 6, v217
    s_lshl_b32 s53, s49, 5
    s_mul_i32 s54, s44, 7
    s_add_u32 s53, s53, s54
    s_lshl_b32 s53, s53, 7
    s_add_u32 s53, s53, 12713984
    v_lshl_add_u32 v20, v218, 7, s53
    s_lshr_b32 s53, s48, 1
    s_lshl4_add_u32 s53, s44, s53
    s_lshl_b32 s53, s53, 7
    s_add_u32 s53, s53, 12779520
    v_mov_b32 v21, s53
    s_lshl_b32 s70, s48, 16
    s_add_u32 s70, s70, s52
    s_add_u32 s70, s70, 4194304
    v_lshrrev_b32 v218, 3, v0
    v_mul_u32_u24 v22, 896, v218
    v_lshl_add_u32 v22, v217, 4, v22
    v_lshlrev_b32 v25, 1, v218
    v_lshrrev_b32 v219, 4, v218
    v_lshlrev_b32 v244, 14, v219
    v_lshrrev_b32 v219, 1, v217
    v_lshl_add_u32 v244, v219, 12, v244
    v_and_b32 v219, 15, v218
    v_lshl_add_u32 v244, v219, 8, v244
    v_bfe_u32 v219, v218, 1, 1
    v_lshl_add_u32 v244, v219, 7, v244
    v_and_b32 v219, 7, v218
    v_xor_b32 v219, v219, v217
    v_lshl_add_u32 v244, v219, 4, v244
    v_xor_b32 v245, 128, v244
    v_xor_b32 v246, 4096, v244
    v_xor_b32 v247, 4224, v244
    v_xor_b32 v248, 8192, v244
    v_xor_b32 v249, 8320, v244
    v_xor_b32 v250, 12288, v244
    v_xor_b32 v251, 12416, v244
    v_lshrrev_b32 v218, 2, v0
    v_mul_u32_u24 v26, 896, v218
    v_lshl_add_u32 v26, v210, 3, v26
    v_lshlrev_b32 v27, 1, v218
    v_bfe_u32 v219, v218, 1, 2
    v_xor_b32 v219, v219, v210
    v_lshlrev_b32 v252, 6, v218
    v_lshl_add_u32 v252, v219, 4, v252
    v_add_u32 v252, 65536, v252
    v_bfe_u32 v219, v1, 1, 2
    v_xor_b32 v219, v219, v208
    v_lshlrev_b32 v242, 6, v211
    v_lshl_add_u32 v242, v219, 4, v242
    s_add_u32 s53, s52, 65536
    v_add_u32 v242, s53, v242
    v_xor_b32 v218, v217, v212
    v_lshlrev_b32 v238, 4, v218
    v_xor_b32 v238, s56, v238
    v_bfe_u32 v219, v1, 1, 1
    v_xor_b32 v219, v219, v215
    v_lshl_add_u32 v238, v219, 7, v238
    v_lshl_add_u32 v238, v211, 8, v238
    v_add_u32 v238, s52, v238
    v_xor_b32 v239, 32, v238
    v_xor_b32 v240, 64, v238
    v_xor_b32 v241, 96, v238
    buffer_load_dwordx4 v[216:219], v22, s[4:7], s71 offen
    buffer_load_dwordx4 v[220:223], v22, s[4:7], s72 offen
    buffer_load_dwordx2 v[226:227], v26, s[4:7], s73 offen
    buffer_load_ushort v224, v25, s[36:39], s74 offen
    buffer_load_ushort v225, v25, s[36:39], s74 offen offset:64
    buffer_load_ushort v228, v27, s[36:39], s74 offen
    s_add_u32 m0, s52, 81920
    s_lshl_b32 s57, s76, 7
    buffer_load_dwordx4 v12, s[20:23], s57 offen offset:0 lds
    s_add_u32 s57, s57, 31744
    buffer_load_dwordx4 v12, s[20:23], s57 offen offset:1024 lds
    s_add_u32 s57, s57, 31744
    buffer_load_dwordx4 v12, s[20:23], s57 offen offset:2048 lds
    s_add_u32 s57, s57, 31744
    buffer_load_dwordx4 v12, s[20:23], s57 offen offset:3072 lds
    s_add_u32 m0, s52, 98304
    s_lshl_b32 s57, s76, 7
    s_add_u32 s57, s57, 131072
    buffer_load_dwordx4 v12, s[20:23], s57 offen offset:0 lds
    s_add_u32 s57, s57, 31744
    buffer_load_dwordx4 v12, s[20:23], s57 offen offset:1024 lds
    s_add_u32 s57, s57, 31744
    buffer_load_dwordx4 v12, s[20:23], s57 offen offset:2048 lds
    s_add_u32 s57, s57, 31744
    buffer_load_dwordx4 v12, s[20:23], s57 offen offset:3072 lds
    s_add_u32 m0, s52, 114688
    s_lshl_b32 s57, s77, 7
    buffer_load_dwordx4 v12, s[20:23], s57 offen offset:0 lds
    s_add_u32 s57, s57, 31744
    buffer_load_dwordx4 v12, s[20:23], s57 offen offset:1024 lds
    s_add_u32 s57, s57, 31744
    buffer_load_dwordx4 v12, s[20:23], s57 offen offset:2048 lds
    s_add_u32 s57, s57, 31744
    buffer_load_dwordx4 v12, s[20:23], s57 offen offset:3072 lds
    s_add_u32 m0, s52, 131072
    s_lshl_b32 s57, s77, 7
    s_add_u32 s57, s57, 131072
    buffer_load_dwordx4 v12, s[20:23], s57 offen offset:0 lds
    s_add_u32 s57, s57, 31744
    buffer_load_dwordx4 v12, s[20:23], s57 offen offset:1024 lds
    s_waitcnt vmcnt(10)
    ds_read_b64_tr_b16 a[0:1], v6 offset:32768
    ds_read_b64_tr_b16 a[2:3], v6 offset:34816
    ds_read_b64_tr_b16 a[4:5], v7 offset:32768
    ds_read_b64_tr_b16 a[6:7], v7 offset:34816
    ds_read_b64_tr_b16 a[8:9], v6 offset:33024
    ds_read_b64_tr_b16 a[10:11], v6 offset:35072
    ds_read_b64_tr_b16 a[12:13], v7 offset:33024
    ds_read_b64_tr_b16 a[14:15], v7 offset:35072
    s_add_u32 s57, s57, 31744
    buffer_load_dwordx4 v12, s[20:23], s57 offen offset:2048 lds
    s_add_u32 s57, s57, 31744
    buffer_load_dwordx4 v12, s[20:23], s57 offen offset:3072 lds
    s_add_u32 m0, s52, 147456
    s_lshl_b32 s57, s78, 7
    buffer_load_dwordx4 v12, s[20:23], s57 offen offset:0 lds
    s_add_u32 s57, s57, 31744
    buffer_load_dwordx4 v12, s[20:23], s57 offen offset:1024 lds
    s_waitcnt vmcnt(10)
    ds_read_b64_tr_b16 a[16:17], v6 offset:49152
    ds_read_b64_tr_b16 a[18:19], v6 offset:51200
    ds_read_b64_tr_b16 a[20:21], v7 offset:49152
    ds_read_b64_tr_b16 a[22:23], v7 offset:51200
    s_add_u32 s57, s57, 31744
    buffer_load_dwordx4 v12, s[20:23], s57 offen offset:2048 lds
    ds_read_b64_tr_b16 a[24:25], v6 offset:49408
    ds_read_b64_tr_b16 a[26:27], v6 offset:51456
    ds_read_b64_tr_b16 a[28:29], v7 offset:49408
    ds_read_b64_tr_b16 a[30:31], v7 offset:51456
    s_add_u32 s57, s57, 31744
    buffer_load_dwordx4 v12, s[20:23], s57 offen offset:3072 lds
    s_add_u32 m0, s52, 49152
    s_lshl_b32 s57, s78, 7
    s_add_u32 s57, s57, 131072
    buffer_load_dwordx4 v12, s[20:23], s57 offen offset:0 lds
    s_add_u32 s57, s57, 31744
    buffer_load_dwordx4 v12, s[20:23], s57 offen offset:1024 lds
    s_waitcnt vmcnt(10)
    ds_read_b64_tr_b16 a[32:33], v8 offset:0
    ds_read_b64_tr_b16 a[34:35], v8 offset:2048
    ds_read_b64_tr_b16 a[36:37], v9 offset:0
    ds_read_b64_tr_b16 a[38:39], v9 offset:2048
    s_add_u32 s57, s57, 31744
    buffer_load_dwordx4 v12, s[20:23], s57 offen offset:2048 lds
    ds_read_b64_tr_b16 a[40:41], v8 offset:256
    ds_read_b64_tr_b16 a[42:43], v8 offset:2304
    ds_read_b64_tr_b16 a[44:45], v9 offset:256
    ds_read_b64_tr_b16 a[46:47], v9 offset:2304
    s_add_u32 s57, s57, 31744
    buffer_load_dwordx4 v12, s[20:23], s57 offen offset:3072 lds
    s_waitcnt vmcnt(0) lgkmcnt(0)
    s_branch L_p3join
L_role_a:
    v_lshrrev_b32 v112, 4, v1
    v_bfe_u32 v113, v1, 2, 2
    v_and_b32 v114, 3, v1
    v_and_b32 v115, 15, v1
    v_lshrrev_b32 v116, 5, v1
    s_lshr_b32 s48, s45, 1
    s_and_b32 s53, s45, 1
    s_lshl3_add_u32 s49, s53, s46
    s_sub_u32 s49, s49, 24
    s_lshl_b32 s90, s44, 11
    s_and_b32 s53, s44, 1
    s_lshl_b32 s53, s53, 1
    v_lshlrev_b32 v117, 2, v112
    v_sub_u32 v117, v115, v117
    v_and_b32 v117, 15, v117
    v_xor_b32 v117, s53, v117
    v_mul_u32_u24 v2, 2688, v112
    v_lshl_add_u32 v2, v117, 4, v2
    s_mul_i32 s53, s44, 21504
    s_mul_i32 s54, s48, 224
    s_andn2_b32 s54, s54, 63
    s_add_u32 s53, s53, s54
    v_add_u32 v2, s53, v2
    s_add_u32 m0, s90, 65536
    s_mov_b32 s57, 896
    buffer_load_dwordx4 v2, s[8:11], s57 offen offset:0 lds
    s_mov_b32 s57, 10624
    buffer_load_dwordx4 v2, s[8:11], s57 offen offset:1024 lds
    s_add_u32 m0, s90, 73728
    s_mov_b32 s57, 86912
    buffer_load_dwordx4 v2, s[8:11], s57 offen offset:0 lds
    s_mov_b32 s57, 96640
    buffer_load_dwordx4 v2, s[8:11], s57 offen offset:1024 lds
    v_mul_u32_u24 v109, 960, v25
    v_lshl_add_u32 v109, v26, 4, v109
    v_mul_u32_u24 v110, 960, v113
    v_lshl_add_u32 v110, v112, 5, v110
    v_lshl_add_u32 v110, v114, 3, v110
    s_lshl_b32 s53, s44, 7
    v_add_u32 v110, s53, v110
    v_mul_u32_u24 v111, 66816, v112
    v_lshl_add_u32 v111, v115, 4, v111
    s_mul_i32 s63, s44, 267264
    s_lshl_b32 s53, s2, 8
    s_add_u32 s63, s63, s53
    s_add_u32 s64, s63, 1069056
    s_cmp_eq_u32 s44, 3
    s_cselect_b32 s64, 2130706432, s64
    s_mov_b32 s62, 0x3f803f80
    s_mov_b32 s61, 0xffff0000
    s_mov_b32 s66, 6291456
    v_mov_b32 v96, 0
    v_mov_b32 v97, 0
    v_and_b32 v117, 1, v112
    v_lshlrev_b32 v117, 5, v117
    s_mul_i32 s53, s44, 56
    s_and_b32 s54, s48, 1
    s_lshl_b32 s54, s54, 5
    s_add_u32 s53, s53, s54
    v_lshlrev_b32 v118, 11, v112
    v_lshl_add_u32 v118, v113, 8, v118
    v_add_u32 v118, 65536, v118
    v_lshl_add_u32 v119, v114, 3, s53
    v_add_u32 v119, 0, v119
    v_xor_b32 v119, v119, v117
    v_lshl_add_u32 v119, v113, 6, v119
    v_and_b32 v119, 255, v119
    v_add_u32 v6, v118, v119
    v_add_u32 v10, 49152, v6
    v_subrev_u32 v120, 65536, v6
    v_lshl_add_u32 v119, v114, 3, s53
    v_add_u32 v119, 32, v119
    v_xor_b32 v119, v119, v117
    v_lshl_add_u32 v119, v113, 6, v119
    v_and_b32 v119, 255, v119
    v_add_u32 v7, v118, v119
    v_add_u32 v11, 49152, v7
    v_subrev_u32 v121, 65536, v7
    v_lshl_add_u32 v119, v114, 4, s53
    v_add_u32 v119, 0, v119
    v_xor_b32 v119, v119, v117
    v_lshl_add_u32 v119, v113, 6, v119
    v_and_b32 v119, 255, v119
    v_add_u32 v8, v118, v119
    v_add_u32 v12, 49152, v8
    v_subrev_u32 v122, 65536, v8
    v_lshl_add_u32 v119, v114, 4, s53
    v_add_u32 v119, 8, v119
    v_xor_b32 v119, v119, v117
    v_lshl_add_u32 v119, v113, 6, v119
    v_and_b32 v119, 255, v119
    v_add_u32 v9, v118, v119
    v_add_u32 v13, 49152, v9
    v_subrev_u32 v123, 65536, v9
    s_waitcnt vmcnt(7)
    v_dot2c_f32_bf16 v96, s62, v32
    v_dot2c_f32_bf16 v97, v32, v32
    v_lshlrev_b32 v40, 16, v32
    v_and_b32 v41, s61, v32
    v_dot2c_f32_bf16 v96, s62, v33
    v_dot2c_f32_bf16 v97, v33, v33
    v_lshlrev_b32 v42, 16, v33
    v_and_b32 v43, s61, v33
    v_dot2c_f32_bf16 v96, s62, v34
    v_dot2c_f32_bf16 v97, v34, v34
    v_lshlrev_b32 v44, 16, v34
    v_and_b32 v45, s61, v34
    v_dot2c_f32_bf16 v96, s62, v35
    v_dot2c_f32_bf16 v97, v35, v35
    v_lshlrev_b32 v46, 16, v35
    v_and_b32 v47, s61, v35
    s_waitcnt vmcnt(6)
    v_dot2c_f32_bf16 v96, s62, v36
    v_dot2c_f32_bf16 v97, v36, v36
    v_lshlrev_b32 v48, 16, v36
    v_and_b32 v49, s61, v36
    v_dot2c_f32_bf16 v96, s62, v37
    v_dot2c_f32_bf16 v97, v37, v37
    v_lshlrev_b32 v50, 16, v37
    v_and_b32 v51, s61, v37
    v_dot2c_f32_bf16 v96, s62, v38
    v_dot2c_f32_bf16 v97, v38, v38
    v_lshlrev_b32 v52, 16, v38
    v_and_b32 v53, s61, v38
    v_dot2c_f32_bf16 v96, s62, v39
    v_dot2c_f32_bf16 v97, v39, v39
    v_lshlrev_b32 v54, 16, v39
    v_and_b32 v55, s61, v39
    buffer_load_dword v29, off, s[40:43], 0 sc1
    v_add_f32_dpp v96, v96, v96 quad_perm:[1,0,3,2] row_mask:0xf bank_mask:0xf
    v_add_f32_dpp v97, v97, v97 quad_perm:[1,0,3,2] row_mask:0xf bank_mask:0xf
    s_nop 0
    v_add_f32_dpp v96, v96, v96 quad_perm:[2,3,0,1] row_mask:0xf bank_mask:0xf
    v_add_f32_dpp v97, v97, v97 quad_perm:[2,3,0,1] row_mask:0xf bank_mask:0xf
    s_nop 0
    v_add_f32_dpp v96, v96, v96 row_half_mirror row_mask:0xf bank_mask:0xf
    v_add_f32_dpp v97, v97, v97 row_half_mirror row_mask:0xf bank_mask:0xf
    s_nop 0
    v_add_f32_dpp v96, v96, v96 row_mirror row_mask:0xf bank_mask:0xf
    v_add_f32_dpp v97, v97, v97 row_mirror row_mask:0xf bank_mask:0xf
    v_mov_b32 v98, v96
    v_mov_b32 v99, v97
    s_nop 0
    v_permlane16_swap_b32 v96, v98
    v_permlane16_swap_b32 v97, v99
    v_add_f32 v96, v96, v98
    v_add_f32 v97, v97, v99
    v_mul_f32 v98, 0x3b124925, v96
    v_mul_f32 v99, 0x3b124925, v97
    v_fma_f32 v99, -v98, v98, v99
    v_max_f32 v99, 0, v99
    v_cvt_pk_bf16_f32 v100, 0, v99
    v_add_f32 v100, 0x3727c5ac, v100
    v_cvt_pk_bf16_f32 v100, 0, v100
    v_sqrt_f32 v100, v100
    s_nop 0
    v_cvt_pk_bf16_f32 v100, 0, v100
    v_rcp_f32 v100, v100
    s_nop 0
    v_mul_f32 v99, v99, v100
    v_mul_f32 v102, v98, v100
    v_mul_f32 v99, v99, v100
    v_cvt_pk_bf16_f32 v104, 0, v99
    v_add_f32 v104, 0x3727c5ac, v104
    v_cvt_pk_bf16_f32 v104, 0, v104
    v_sqrt_f32 v104, v104
    s_nop 0
    v_cvt_pk_bf16_f32 v104, 0, v104
    v_rcp_f32 v104, v104
    s_nop 0
    v_mul_f32 v104, v104, v100
    v_mul_f32 v106, v98, v104
    v_pk_fma_f32 v[56:57], v[40:41], v[104:105], v[106:107] op_sel_hi:[1,0,0] neg_lo:[0,0,1] neg_hi:[0,0,1]
    v_pk_fma_f32 v[58:59], v[42:43], v[104:105], v[106:107] op_sel_hi:[1,0,0] neg_lo:[0,0,1] neg_hi:[0,0,1]
    v_pk_fma_f32 v[60:61], v[44:45], v[104:105], v[106:107] op_sel_hi:[1,0,0] neg_lo:[0,0,1] neg_hi:[0,0,1]
    v_pk_fma_f32 v[62:63], v[46:47], v[104:105], v[106:107] op_sel_hi:[1,0,0] neg_lo:[0,0,1] neg_hi:[0,0,1]
    v_pk_fma_f32 v[64:65], v[48:49], v[104:105], v[106:107] op_sel_hi:[1,0,0] neg_lo:[0,0,1] neg_hi:[0,0,1]
    v_pk_fma_f32 v[66:67], v[50:51], v[104:105], v[106:107] op_sel_hi:[1,0,0] neg_lo:[0,0,1] neg_hi:[0,0,1]
    v_pk_fma_f32 v[68:69], v[52:53], v[104:105], v[106:107] op_sel_hi:[1,0,0] neg_lo:[0,0,1] neg_hi:[0,0,1]
    v_pk_fma_f32 v[70:71], v[54:55], v[104:105], v[106:107] op_sel_hi:[1,0,0] neg_lo:[0,0,1] neg_hi:[0,0,1]
    v_cvt_pk_bf16_f32 v80, v56, v57
    v_cvt_pk_bf16_f32 v81, v58, v59
    v_cvt_pk_bf16_f32 v82, v60, v61
    v_cvt_pk_bf16_f32 v83, v62, v63
    v_cvt_pk_bf16_f32 v84, v64, v65
    v_cvt_pk_bf16_f32 v85, v66, v67
    v_cvt_pk_bf16_f32 v86, v68, v69
    v_cvt_pk_bf16_f32 v87, v70, v71
    ds_write_b128 v109, v[80:83] offset:49152
    ds_write_b128 v109, v[84:87] offset:49600
    v_pk_fma_f32 v[40:41], v[40:41], v[100:101], v[102:103] op_sel_hi:[1,0,0] neg_lo:[0,0,1] neg_hi:[0,0,1]
    v_pk_fma_f32 v[42:43], v[42:43], v[100:101], v[102:103] op_sel_hi:[1,0,0] neg_lo:[0,0,1] neg_hi:[0,0,1]
    v_pk_fma_f32 v[44:45], v[44:45], v[100:101], v[102:103] op_sel_hi:[1,0,0] neg_lo:[0,0,1] neg_hi:[0,0,1]
    v_pk_fma_f32 v[46:47], v[46:47], v[100:101], v[102:103] op_sel_hi:[1,0,0] neg_lo:[0,0,1] neg_hi:[0,0,1]
    v_pk_fma_f32 v[48:49], v[48:49], v[100:101], v[102:103] op_sel_hi:[1,0,0] neg_lo:[0,0,1] neg_hi:[0,0,1]
    v_pk_fma_f32 v[50:51], v[50:51], v[100:101], v[102:103] op_sel_hi:[1,0,0] neg_lo:[0,0,1] neg_hi:[0,0,1]
    v_pk_fma_f32 v[52:53], v[52:53], v[100:101], v[102:103] op_sel_hi:[1,0,0] neg_lo:[0,0,1] neg_hi:[0,0,1]
    v_pk_fma_f32 v[54:55], v[54:55], v[100:101], v[102:103] op_sel_hi:[1,0,0] neg_lo:[0,0,1] neg_hi:[0,0,1]
    v_cvt_pk_bf16_f32 v72, v40, v41
    v_cvt_pk_bf16_f32 v73, v42, v43
    v_cvt_pk_bf16_f32 v74, v44, v45
    v_cvt_pk_bf16_f32 v75, v46, v47
    v_cvt_pk_bf16_f32 v76, v48, v49
    v_cvt_pk_bf16_f32 v77, v50, v51
    v_cvt_pk_bf16_f32 v78, v52, v53
    v_cvt_pk_bf16_f32 v79, v54, v55
    s_waitcnt lgkmcnt(0)
    s_barrier
    ds_read_b64_tr_b16 v[88:89], v110 offset:49152
    ds_read_b64_tr_b16 v[90:91], v110 offset:52992
    ds_read_b64_tr_b16 v[92:93], v110 offset:49664
    ds_read_b64_tr_b16 v[94:95], v110 offset:53504
    buffer_store_dwordx4 v[72:75], v24, s[24:27], s66 offen offset:0 sc1
    buffer_store_dwordx4 v[76:79], v24, s[24:27], s66 offen offset:448 sc1
    s_waitcnt lgkmcnt(2)
    buffer_store_dwordx4 v[88:91], v111, s[24:27], s63 offen sc1
    s_waitcnt lgkmcnt(0)
    buffer_store_dwordx4 v[92:95], v111, s[24:27], s64 offen sc1
    s_add_u32 m0, s90, 81920
    s_mov_b32 s57, 172928
    buffer_load_dwordx4 v2, s[8:11], s57 offen offset:0 lds
    v_lshrrev_b32 v119, 3, v1
    v_mul_u32_u24 v3, 896, v119
    v_xor_b32 v118, v119, v1
    v_and_b32 v118, 6, v118
    v_and_or_b32 v118, v1, 1, v118
    v_lshl_add_u32 v3, v118, 4, v3
    v_and_b32 v118, 6, v1
    v_xor_b32 v118, v118, v112
    s_mov_b32 s57, 182656
    buffer_load_dwordx4 v2, s[8:11], s57 offen offset:1024 lds
    v_lshlrev_b32 v4, 7, v115
    v_lshl_add_u32 v4, v118, 4, v4
    v_xor_b32 v25, 64, v4
    s_lshl_b32 s53, s49, 4
    s_sub_u32 s53, s53, 2
    v_min_u32 v117, 17, v1
    v_add_u32 v117, s53, v117
    v_max_i32 v117, 0, v117
    v_lshlrev_b32 v19, 5, v117
    v_add_u32 v19, 12582912, v19
    v_and_b32 v117, 1, v115
    v_cmp_eq_u32 s[76:77], 1, v117
    v_lshl_add_u32 v117, v112, 2, v117
    v_cmp_le_u32 s[78:79], v117, v115
    v_add_u32 v117, 2, v117
    v_cmp_le_u32 s[80:81], v117, v115
    s_add_u32 m0, s90, 90112
    s_mov_b32 s57, 258944
    buffer_load_dwordx4 v2, s[8:11], s57 offen offset:0 lds
    v_cmp_eq_u32 s[82:83], 3, v112
    v_mov_b32 v117, 0xffff
    v_mov_b32 v118, 0xffff0000
    v_cndmask_b32 v117, v117, v118, s[76:77]
    v_cndmask_b32 v14, v117, 0, s[78:79]
    v_cndmask_b32 v15, v117, 0, s[80:81]
    v_cndmask_b32 v16, 0, v117, s[78:79]
    v_cndmask_b32 v17, 0, v117, s[80:81]
    s_mov_b32 s91, 0x3e8b97f6
    v_mov_b32 v18, 0xf149f2ca
    s_lshl_b32 s53, s49, 3
    s_mul_i32 s72, s53, 14336
    s_add_u32 s72, s72, 6291456
    s_lshl_b32 s74, s53, 14
    s_lshl2_add_u32 s54, s48, s44
    s_lshl_b32 s54, s54, 10
    s_mov_b32 s57, 268672
    buffer_load_dwordx4 v2, s[8:11], s57 offen offset:1024 lds
    s_add_u32 s74, s74, s54
    s_add_u32 s74, s74, 4177920
    s_lshl2_add_u32 s53, s44, 0
    s_lshl_b32 s54, s44, 8
    s_add_u32 s54, s54, 0
    s_cmp_lt_u32 s53, 14
    s_cselect_b32 s68, s54, 2130706432
    s_lshl2_add_u32 s53, s44, 1
    s_lshl_b32 s54, s44, 8
    s_add_u32 s54, s54, 6144
    s_cmp_lt_u32 s53, 14
    s_cselect_b32 s69, s54, 2130706432
    s_lshl2_add_u32 s53, s44, 2
    s_lshl_b32 s54, s44, 8
    s_add_u32 s54, s54, -1920
    s_cmp_lt_u32 s53, 14
    s_cselect_b32 s70, s54, 2130706432
    s_lshl2_add_u32 s53, s44, 3
    s_lshl_b32 s54, s44, 8
    s_add_u32 s54, s54, 4224
    s_cmp_lt_u32 s53, 14
    s_cselect_b32 s71, s54, 2130706432
    s_cmp_eq_u32 s49, 0
    s_cselect_b64 s[88:89], -1, 0
    s_add_u32 m0, s90, 98304
    s_mov_b32 s57, 344960
    buffer_load_dwordx4 v2, s[8:11], s57 offen offset:0 lds
    s_mov_b32 s57, 354688
    buffer_load_dwordx4 v2, s[8:11], s57 offen offset:1024 lds
    s_add_u32 m0, s90, 106496
    s_mov_b32 s57, 430976
    buffer_load_dwordx4 v2, s[8:11], s57 offen offset:0 lds
    s_mov_b32 s57, 440704
    buffer_load_dwordx4 v2, s[8:11], s57 offen offset:1024 lds
    s_add_u32 m0, s90, 114688
    s_mov_b32 s57, 516992
    buffer_load_dwordx4 v2, s[8:11], s57 offen offset:0 lds
    s_mov_b32 s57, 526720
    buffer_load_dwordx4 v2, s[8:11], s57 offen offset:1024 lds
    s_add_u32 m0, s90, 122880
    s_mov_b32 s57, 603008
    buffer_load_dwordx4 v2, s[8:11], s57 offen offset:0 lds
    s_mov_b32 s57, 612736
    buffer_load_dwordx4 v2, s[8:11], s57 offen offset:1024 lds
    s_add_u32 m0, s90, 131072
    s_mov_b32 s57, 689024
    buffer_load_dwordx4 v2, s[8:11], s57 offen offset:0 lds
    s_mov_b32 s57, 698752
    buffer_load_dwordx4 v2, s[8:11], s57 offen offset:1024 lds
    s_add_u32 m0, s90, 139264
    s_mov_b32 s57, 775040
    buffer_load_dwordx4 v2, s[8:11], s57 offen offset:0 lds
    s_mov_b32 s57, 784768
    buffer_load_dwordx4 v2, s[8:11], s57 offen offset:1024 lds
    s_add_u32 m0, s90, 147456
    s_mov_b32 s57, 861056
    buffer_load_dwordx4 v2, s[8:11], s57 offen offset:0 lds
    s_mov_b32 s57, 870784
    buffer_load_dwordx4 v2, s[8:11], s57 offen offset:1024 lds
    s_add_u32 m0, s90, 155648
    s_mov_b32 s57, 947072
    buffer_load_dwordx4 v2, s[8:11], s57 offen offset:0 lds
    s_mov_b32 s57, 956800
    buffer_load_dwordx4 v2, s[8:11], s57 offen offset:1024 lds
    s_waitcnt vmcnt(20)
    v_cmp_eq_u32 vcc, 0, v29
    s_nop 0
    s_cbranch_vccz L_ok12
    s_mov_b32 s59, 20000
L_spin11:
    buffer_load_dword v29, off, s[40:43], 0 sc1
    s_waitcnt vmcnt(0)
    v_cmp_eq_u32 vcc, 0, v29
    s_nop 0
    s_cbranch_vccz L_ok12
    s_sub_u32 s59, s59, 1
    s_cbranch_scc0 L_spin11
L_ok12:
    v_readfirstlane_b32 s47, v29
    s_barrier
    s_cmp_lg_u32 s44, 0
    s_cbranch_scc1 L_nopub13
    s_lshl_b32 s60, s2, 5
    s_add_u32 s60, s60, 12582912
    v_mov_b32 v30, s47
    s_mov_b64 exec, 1
    buffer_store_dword v30, off, s[24:27], s60 sc1
    s_mov_b64 exec, -1
L_nopub13:
    s_waitcnt vmcnt(18)
    s_barrier
    s_add_u32 m0, s90, 0
    s_mov_b32 s57, 1033088
    buffer_load_dwordx4 v2, s[8:11], s57 offen offset:0 lds
    s_mov_b32 s57, 1042816
    buffer_load_dwordx4 v2, s[8:11], s57 offen offset:1024 lds
    ds_read_b64_tr_b16 a[8:9], v6 offset:0
    ds_read_b64_tr_b16 a[10:11], v6 offset:1024
    ds_read_b64_tr_b16 a[12:13], v7 offset:0
    ds_read_b64_tr_b16 a[14:15], v7 offset:1024
    s_add_u32 m0, s90, 8192
    s_mov_b32 s57, 1119104
    buffer_load_dwordx4 v2, s[8:11], s57 offen offset:0 lds
    s_mov_b32 s57, 1128832
    buffer_load_dwordx4 v2, s[8:11], s57 offen offset:1024 lds
    ds_read_b64_tr_b16 a[32:33], v6 offset:8192
    ds_read_b64_tr_b16 a[34:35], v6 offset:9216
    ds_read_b64_tr_b16 a[36:37], v7 offset:8192
    ds_read_b64_tr_b16 a[38:39], v7 offset:9216
    s_add_u32 m0, s90, 16384
    s_mov_b32 s57, 1792
    buffer_load_dwordx4 v2, s[8:11], s57 offen offset:0 lds
    s_mov_b32 s57, 11520
    buffer_load_dwordx4 v2, s[8:11], s57 offen offset:1024 lds
    ds_read_b64_tr_b16 a[56:57], v6 offset:16384
    ds_read_b64_tr_b16 a[58:59], v6 offset:17408
    ds_read_b64_tr_b16 a[60:61], v7 offset:16384
    ds_read_b64_tr_b16 a[62:63], v7 offset:17408
    s_waitcnt vmcnt(18)
    s_waitcnt lgkmcnt(0)
    s_barrier
    s_add_u32 m0, s90, 24576
    s_mov_b32 s57, 87808
    buffer_load_dwordx4 v2, s[8:11], s57 offen offset:0 lds
    s_mov_b32 s57, 97536
    buffer_load_dwordx4 v2, s[8:11], s57 offen offset:1024 lds
    ds_read_b64_tr_b16 a[80:81], v6 offset:24576
    ds_read_b64_tr_b16 a[82:83], v6 offset:25600
    ds_read_b64_tr_b16 a[84:85], v7 offset:24576
    ds_read_b64_tr_b16 a[86:87], v7 offset:25600
    s_add_u32 m0, s90, 32768
    s_mov_b32 s57, 173824
    buffer_load_dwordx4 v2, s[8:11], s57 offen offset:0 lds
    s_mov_b32 s57, 183552
    buffer_load_dwordx4 v2, s[8:11], s57 offen offset:1024 lds
    ds_read_b64_tr_b16 a[104:105], v6 offset:32768
    ds_read_b64_tr_b16 a[106:107], v6 offset:33792
    ds_read_b64_tr_b16 a[108:109], v7 offset:32768
    ds_read_b64_tr_b16 a[110:111], v7 offset:33792
    s_add_u32 m0, s90, 40960
    s_mov_b32 s57, 259840
    buffer_load_dwordx4 v2, s[8:11], s57 offen offset:0 lds
    s_mov_b32 s57, 269568
    buffer_load_dwordx4 v2, s[8:11], s57 offen offset:1024 lds
    ds_read_b64_tr_b16 a[128:129], v6 offset:40960
    ds_read_b64_tr_b16 a[130:131], v6 offset:41984
    ds_read_b64_tr_b16 a[132:133], v7 offset:40960
    ds_read_b64_tr_b16 a[134:135], v7 offset:41984
    s_waitcnt vmcnt(18)
    s_waitcnt lgkmcnt(0)
    s_barrier
    s_add_u32 m0, s90, 65536
    s_mov_b32 s57, 345856
    buffer_load_dwordx4 v2, s[8:11], s57 offen offset:0 lds
    s_mov_b32 s57, 355584
    buffer_load_dwordx4 v2, s[8:11], s57 offen offset:1024 lds
    ds_read_b64_tr_b16 a[152:153], v10 offset:0
    ds_read_b64_tr_b16 a[154:155], v10 offset:1024
    ds_read_b64_tr_b16 a[156:157], v11 offset:0
    ds_read_b64_tr_b16 a[158:159], v11 offset:1024
    s_add_u32 m0, s90, 73728
    s_mov_b32 s57, 431872
    buffer_load_dwordx4 v2, s[8:11], s57 offen offset:0 lds
    s_mov_b32 s57, 441600
    buffer_load_dwordx4 v2, s[8:11], s57 offen offset:1024 lds
    ds_read_b64_tr_b16 a[176:177], v10 offset:8192
    ds_read_b64_tr_b16 a[178:179], v10 offset:9216
    ds_read_b64_tr_b16 a[180:181], v11 offset:8192
    ds_read_b64_tr_b16 a[182:183], v11 offset:9216
    s_add_u32 m0, s90, 81920
    s_mov_b32 s57, 517888
    buffer_load_dwordx4 v2, s[8:11], s57 offen offset:0 lds
    s_mov_b32 s57, 527616
    buffer_load_dwordx4 v2, s[8:11], s57 offen offset:1024 lds
    ds_read_b64_tr_b16 a[200:201], v10 offset:16384
    ds_read_b64_tr_b16 a[202:203], v10 offset:17408
    ds_read_b64_tr_b16 a[204:205], v11 offset:16384
    ds_read_b64_tr_b16 a[206:207], v11 offset:17408
    s_waitcnt vmcnt(18)
    s_waitcnt lgkmcnt(0)
    s_barrier
    s_add_u32 m0, s90, 90112
    s_mov_b32 s57, 603904
    buffer_load_dwordx4 v2, s[8:11], s57 offen offset:0 lds
    s_mov_b32 s57, 613632
    buffer_load_dwordx4 v2, s[8:11], s57 offen offset:1024 lds
    ds_read_b64_tr_b16 a[224:225], v10 offset:24576
    ds_read_b64_tr_b16 a[226:227], v10 offset:25600
    ds_read_b64_tr_b16 a[228:229], v11 offset:24576
    ds_read_b64_tr_b16 a[230:231], v11 offset:25600
    s_add_u32 m0, s90, 98304
    s_mov_b32 s57, 689920
    buffer_load_dwordx4 v2, s[8:11], s57 offen offset:0 lds
    s_mov_b32 s57, 699648
    buffer_load_dwordx4 v2, s[8:11], s57 offen offset:1024 lds
    ds_read_b64_tr_b16 a[248:249], v10 offset:32768
    ds_read_b64_tr_b16 a[250:251], v10 offset:33792
    ds_read_b64_tr_b16 a[252:253], v11 offset:32768
    ds_read_b64_tr_b16 a[254:255], v11 offset:33792
    s_add_u32 m0, s90, 106496
    s_mov_b32 s57, 775936
    buffer_load_dwordx4 v2, s[8:11], s57 offen offset:0 lds
    s_mov_b32 s57, 785664
    buffer_load_dwordx4 v2, s[8:11], s57 offen offset:1024 lds
    ds_read_b64_tr_b16 v[192:193], v10 offset:40960
    ds_read_b64_tr_b16 v[194:195], v10 offset:41984
    ds_read_b64_tr_b16 v[196:197], v11 offset:40960
    ds_read_b64_tr_b16 v[198:199], v11 offset:41984
    s_waitcnt vmcnt(18)
    s_waitcnt lgkmcnt(0)
    s_barrier
    s_add_u32 m0, s90, 114688
    s_mov_b32 s57, 861952
    buffer_load_dwordx4 v2, s[8:11], s57 offen offset:0 lds
    s_mov_b32 s57, 871680
    buffer_load_dwordx4 v2, s[8:11], s57 offen offset:1024 lds
    ds_read_b64_tr_b16 v[216:217], v120 offset:0
    ds_read_b64_tr_b16 v[218:219], v120 offset:1024
    ds_read_b64_tr_b16 v[220:221], v121 offset:0
    ds_read_b64_tr_b16 v[222:223], v121 offset:1024
    s_add_u32 m0, s90, 122880
    s_mov_b32 s57, 947968
    buffer_load_dwordx4 v2, s[8:11], s57 offen offset:0 lds
    s_mov_b32 s57, 957696
    buffer_load_dwordx4 v2, s[8:11], s57 offen offset:1024 lds
    ds_read_b64_tr_b16 v[240:241], v120 offset:8192
    ds_read_b64_tr_b16 v[242:243], v120 offset:9216
    ds_read_b64_tr_b16 v[244:245], v121 offset:8192
    ds_read_b64_tr_b16 v[246:247], v121 offset:9216
    s_add_u32 m0, s90, 131072
    s_mov_b32 s57, 1033984
    buffer_load_dwordx4 v2, s[8:11], s57 offen offset:0 lds
    s_mov_b32 s57, 1043712
    buffer_load_dwordx4 v2, s[8:11], s57 offen offset:1024 lds
    ds_read_b64_tr_b16 a[16:17], v122 offset:16384
    ds_read_b64_tr_b16 a[18:19], v122 offset:17408
    ds_read_b64_tr_b16 a[20:21], v123 offset:16384
    ds_read_b64_tr_b16 a[22:23], v123 offset:17408
    s_waitcnt vmcnt(18)
    s_waitcnt lgkmcnt(0)
    s_barrier
    ds_read_b64_tr_b16 a[40:41], v122 offset:24576
    ds_read_b64_tr_b16 a[42:43], v122 offset:25600
    ds_read_b64_tr_b16 a[44:45], v123 offset:24576
    ds_read_b64_tr_b16 a[46:47], v123 offset:25600
    ds_read_b64_tr_b16 a[64:65], v122 offset:32768
    ds_read_b64_tr_b16 a[66:67], v122 offset:33792
    ds_read_b64_tr_b16 a[68:69], v123 offset:32768
    ds_read_b64_tr_b16 a[70:71], v123 offset:33792
    buffer_load_dword v21, v19, s[24:27], 0 offen sc1
    ds_read_b64_tr_b16 a[88:89], v122 offset:40960
    ds_read_b64_tr_b16 a[90:91], v122 offset:41984
    ds_read_b64_tr_b16 a[92:93], v123 offset:40960
    ds_read_b64_tr_b16 a[94:95], v123 offset:41984
    s_add_u32 m0, s90, 139264
    s_mov_b32 s57, 1120000
    buffer_load_dwordx4 v2, s[8:11], s57 offen offset:0 lds
    s_waitcnt vmcnt(14)
    s_waitcnt lgkmcnt(0)
    s_barrier
    ds_read_b64_tr_b16 a[112:113], v8 offset:0
    ds_read_b64_tr_b16 a[114:115], v8 offset:1024
    ds_read_b64_tr_b16 a[116:117], v9 offset:0
    ds_read_b64_tr_b16 a[118:119], v9 offset:1024
    ds_read_b64_tr_b16 a[136:137], v8 offset:8192
    ds_read_b64_tr_b16 a[138:139], v8 offset:9216
    ds_read_b64_tr_b16 a[140:141], v9 offset:8192
    ds_read_b64_tr_b16 a[142:143], v9 offset:9216
    ds_read_b64_tr_b16 a[160:161], v8 offset:16384
    ds_read_b64_tr_b16 a[162:163], v8 offset:17408
    ds_read_b64_tr_b16 a[164:165], v9 offset:16384
    ds_read_b64_tr_b16 a[166:167], v9 offset:17408
    s_mov_b32 s57, 1129728
    buffer_load_dwordx4 v2, s[8:11], s57 offen offset:1024 lds
    s_add_u32 m0, s90, 147456
    s_mov_b32 s57, 0
    buffer_load_dwordx4 v2, s[8:11], s57 offen offset:0 lds
    s_waitcnt vmcnt(10)
    s_waitcnt lgkmcnt(0)
    s_barrier
    ds_read_b64_tr_b16 a[184:185], v8 offset:24576
    ds_read_b64_tr_b16 a[186:187], v8 offset:25600
    ds_read_b64_tr_b16 a[188:189], v9 offset:24576
    ds_read_b64_tr_b16 a[190:191], v9 offset:25600
    ds_read_b64_tr_b16 a[208:209], v8 offset:32768
    ds_read_b64_tr_b16 a[210:211], v8 offset:33792
    ds_read_b64_tr_b16 a[212:213], v9 offset:32768
    ds_read_b64_tr_b16 a[214:215], v9 offset:33792
    ds_read_b64_tr_b16 a[232:233], v8 offset:40960
    ds_read_b64_tr_b16 a[234:235], v8 offset:41984
    ds_read_b64_tr_b16 a[236:237], v9 offset:40960
    ds_read_b64_tr_b16 a[238:239], v9 offset:41984
    s_mov_b32 s57, 9728
    buffer_load_dwordx4 v2, s[8:11], s57 offen offset:1024 lds
    s_add_u32 m0, s90, 155648
    s_mov_b32 s57, 86016
    buffer_load_dwordx4 v2, s[8:11], s57 offen offset:0 lds
    s_mov_b32 s57, 95744
    buffer_load_dwordx4 v2, s[8:11], s57 offen offset:1024 lds
    s_waitcnt vmcnt(6)
    v_cmp_ne_u32 vcc, s47, v21
    s_nop 0
    s_cbranch_vccz L_ok15
    s_mov_b32 s59, 20000
L_spin14:
    buffer_load_dword v21, v19, s[24:27], 0 offen sc1
    s_waitcnt vmcnt(0)
    v_cmp_ne_u32 vcc, s47, v21
    s_nop 0
    s_cbranch_vccz L_ok15
    s_sub_u32 s59, s59, 1
    s_cbranch_scc0 L_spin14
L_ok15:
    s_add_u32 m0, s52, 0
    s_sub_u32 s58, s72, 14336
    s_max_u32 s58, s58, 6291456
    s_add_u32 s57, s58, s68
    buffer_load_dwordx4 v3, s[24:27], s57 offen offset:0 sc1 lds
    s_add_u32 s57, s58, s69
    buffer_load_dwordx4 v3, s[24:27], s57 offen offset:1024 sc1 lds
    s_add_u32 s57, s58, s70
    buffer_load_dwordx4 v3, s[24:27], s57 offen offset:2048 sc1 lds
    s_waitcnt lgkmcnt(0)
    s_barrier
    ds_read_b64_tr_b16 v[176:177], v12 offset:0
    ds_read_b64_tr_b16 v[178:179], v12 offset:1024
    ds_read_b64_tr_b16 v[180:181], v13 offset:0
    ds_read_b64_tr_b16 v[182:183], v13 offset:1024
    ds_read_b64_tr_b16 v[200:201], v12 offset:8192
    ds_read_b64_tr_b16 v[202:203], v12 offset:9216
    ds_read_b64_tr_b16 v[204:205], v13 offset:8192
    ds_read_b64_tr_b16 v[206:207], v13 offset:9216
    ds_read_b64_tr_b16 v[224:225], v12 offset:16384
    ds_read_b64_tr_b16 v[226:227], v12 offset:17408
    ds_read_b64_tr_b16 v[228:229], v13 offset:16384
    ds_read_b64_tr_b16 v[230:231], v13 offset:17408
    s_add_u32 s57, s58, s71
    buffer_load_dwordx4 v3, s[24:27], s57 offen offset:3072 sc1 lds
    s_add_u32 m0, s52, 16384
    s_add_u32 s58, s72, 0
    s_add_u32 s57, s58, s68
    buffer_load_dwordx4 v3, s[24:27], s57 offen offset:0 sc1 lds
    s_add_u32 s57, s58, s69
    buffer_load_dwordx4 v3, s[24:27], s57 offen offset:1024 sc1 lds
    s_add_u32 s57, s58, s70
    buffer_load_dwordx4 v3, s[24:27], s57 offen offset:2048 sc1 lds
    s_add_u32 s57, s58, s71
    buffer_load_dwordx4 v3, s[24:27], s57 offen offset:3072 sc1 lds
    s_add_u32 m0, s90, 65536
    s_mov_b32 s57, 172032
    buffer_load_dwordx4 v2, s[8:11], s57 offen offset:0 lds
    s_mov_b32 s57, 181760
    buffer_load_dwordx4 v2, s[8:11], s57 offen offset:1024 lds
    s_add_u32 m0, s90, 73728
    s_mov_b32 s57, 258048
    buffer_load_dwordx4 v2, s[8:11], s57 offen offset:0 lds
    s_mov_b32 s57, 267776
    buffer_load_dwordx4 v2, s[8:11], s57 offen offset:1024 lds
    s_add_u32 m0, s90, 81920
    s_mov_b32 s57, 344064
    buffer_load_dwordx4 v2, s[8:11], s57 offen offset:0 lds
    s_mov_b32 s57, 353792
    buffer_load_dwordx4 v2, s[8:11], s57 offen offset:1024 lds
    s_add_u32 m0, s90, 90112
    s_mov_b32 s57, 430080
    buffer_load_dwordx4 v2, s[8:11], s57 offen offset:0 lds
    s_mov_b32 s57, 439808
    buffer_load_dwordx4 v2, s[8:11], s57 offen offset:1024 lds
    s_add_u32 m0, s90, 98304
    s_mov_b32 s57, 516096
    buffer_load_dwordx4 v2, s[8:11], s57 offen offset:0 lds
    s_mov_b32 s57, 525824
    buffer_load_dwordx4 v2, s[8:11], s57 offen offset:1024 lds
    s_waitcnt vmcnt(10)
    s_waitcnt lgkmcnt(0)
    s_barrier
    ds_read_b64_tr_b16 v[248:249], v12 offset:24576
    ds_read_b64_tr_b16 v[250:251], v12 offset:25600
    ds_read_b64_tr_b16 v[252:253], v13 offset:24576
    ds_read_b64_tr_b16 v[254:255], v13 offset:25600
    ds_read_b64_tr_b16 a[0:1], v10 offset:32768
    ds_read_b64_tr_b16 a[2:3], v10 offset:33792
    ds_read_b64_tr_b16 a[4:5], v11 offset:32768
    ds_read_b64_tr_b16 a[6:7], v11 offset:33792
    ds_read_b64_tr_b16 a[24:25], v10 offset:40960
    ds_read_b64_tr_b16 a[26:27], v10 offset:41984
    ds_read_b64_tr_b16 a[28:29], v11 offset:40960
    ds_read_b64_tr_b16 a[30:31], v11 offset:41984
    s_add_u32 m0, s90, 106496
    s_mov_b32 s57, 602112
    buffer_load_dwordx4 v2, s[8:11], s57 offen offset:0 lds
    ds_read_b128 v[120:123], v4 offset:0
    ds_read_b128 v[124:127], v25 offset:0
    ds_read_b128 v[128:131], v4 offset:2048
    ds_read_b128 v[132:135], v25 offset:2048
    ds_read_b128 v[136:139], v4 offset:4096
    ds_read_b128 v[140:143], v25 offset:4096
    ds_read_b128 v[144:147], v4 offset:6144
    ds_read_b128 v[148:151], v25 offset:6144
    ds_read_b128 v[152:155], v4 offset:8192
    ds_read_b128 v[156:159], v25 offset:8192
    ds_read_b128 v[160:163], v4 offset:10240
    ds_read_b128 v[164:167], v25 offset:10240
    ds_read_b128 v[168:171], v4 offset:12288
    ds_read_b128 v[172:175], v25 offset:12288
    s_waitcnt lgkmcnt(13)
    v_mfma_f32_16x16x32_bf16 v[104:107], a[8:11], v[120:123], 0
    s_mov_b32 s57, 611840
    buffer_load_dwordx4 v2, s[8:11], s57 offen offset:1024 lds
    s_waitcnt lgkmcnt(12)
    v_mfma_f32_16x16x32_bf16 v[104:107], a[32:35], v[124:127], v[104:107]
    s_waitcnt lgkmcnt(11)
    v_mfma_f32_16x16x32_bf16 v[104:107], a[56:59], v[128:131], v[104:107]
    s_waitcnt lgkmcnt(10)
    v_mfma_f32_16x16x32_bf16 v[104:107], a[80:83], v[132:135], v[104:107]
    s_waitcnt lgkmcnt(9)
    v_mfma_f32_16x16x32_bf16 v[104:107], a[104:107], v[136:139], v[104:107]
    s_add_u32 m0, s90, 114688
    s_mov_b32 s57, 688128
    buffer_load_dwordx4 v2, s[8:11], s57 offen offset:0 lds
    s_waitcnt lgkmcnt(8)
    v_mfma_f32_16x16x32_bf16 v[104:107], a[128:131], v[140:143], v[104:107]
    s_waitcnt lgkmcnt(7)
    v_mfma_f32_16x16x32_bf16 v[104:107], a[152:155], v[144:147], v[104:107]
    s_waitcnt lgkmcnt(6)
    v_mfma_f32_16x16x32_bf16 v[104:107], a[176:179], v[148:151], v[104:107]
    s_waitcnt lgkmcnt(5)
    v_mfma_f32_16x16x32_bf16 v[104:107], a[200:203], v[152:155], v[104:107]
    s_mov_b32 s57, 697856
    buffer_load_dwordx4 v2, s[8:11], s57 offen offset:1024 lds
    s_waitcnt lgkmcnt(4)
    v_mfma_f32_16x16x32_bf16 v[104:107], a[224:227], v[156:159], v[104:107]
    s_waitcnt lgkmcnt(3)
    v_mfma_f32_16x16x32_bf16 v[104:107], a[248:251], v[160:163], v[104:107]
    s_waitcnt lgkmcnt(2)
    v_mfma_f32_16x16x32_bf16 v[104:107], v[192:195], v[164:167], v[104:107]
    s_waitcnt lgkmcnt(1)
    v_mfma_f32_16x16x32_bf16 v[104:107], v[216:219], v[168:171], v[104:107]
    s_add_u32 m0, s90, 122880
    s_mov_b32 s57, 774144
    buffer_load_dwordx4 v2, s[8:11], s57 offen offset:0 lds
    s_waitcnt lgkmcnt(0)
    v_mfma_f32_16x16x32_bf16 v[104:107], v[240:243], v[172:175], v[104:107]
    v_mfma_f32_16x16x32_bf16 v[108:111], a[12:15], v[120:123], 0
    v_mfma_f32_16x16x32_bf16 v[108:111], a[36:39], v[124:127], v[108:111]
    s_mov_b32 s57, 783872
    buffer_load_dwordx4 v2, s[8:11], s57 offen offset:1024 lds
    s_waitcnt vmcnt(10)
    s_barrier
    ds_read_b64_tr_b16 a[48:49], v6 offset:0
    ds_read_b64_tr_b16 a[50:51], v6 offset:1024
    ds_read_b64_tr_b16 a[52:53], v7 offset:0
    ds_read_b64_tr_b16 a[54:55], v7 offset:1024
    v_mfma_f32_16x16x32_bf16 v[108:111], a[60:63], v[128:131], v[108:111]
    v_mfma_f32_16x16x32_bf16 v[108:111], a[84:87], v[132:135], v[108:111]
    s_add_u32 m0, s90, 131072
    s_mov_b32 s57, 860160
    buffer_load_dwordx4 v2, s[8:11], s57 offen offset:0 lds
    v_mfma_f32_16x16x32_bf16 v[108:111], a[108:111], v[136:139], v[108:111]
    v_mfma_f32_16x16x32_bf16 v[108:111], a[132:135], v[140:143], v[108:111]
    v_mfma_f32_16x16x32_bf16 v[108:111], a[156:159], v[144:147], v[108:111]
    v_mfma_f32_16x16x32_bf16 v[108:111], a[180:183], v[148:151], v[108:111]
    s_mov_b32 s57, 869888
    buffer_load_dwordx4 v2, s[8:11], s57 offen offset:1024 lds
    v_mfma_f32_16x16x32_bf16 v[108:111], a[204:207], v[152:155], v[108:111]
    v_cvt_pk_bf16_f32 v36, v104, v105
    v_cvt_pk_bf16_f32 v37, v106, v107
    v_mfma_f32_16x16x32_bf16 v[108:111], a[228:231], v[156:159], v[108:111]
    ds_read_b64_tr_b16 a[72:73], v6 offset:8192
    ds_read_b64_tr_b16 a[74:75], v6 offset:9216
    ds_read_b64_tr_b16 a[76:77], v7 offset:8192
    ds_read_b64_tr_b16 a[78:79], v7 offset:9216
    v_mfma_f32_16x16x32_bf16 v[108:111], a[252:255], v[160:163], v[108:111]
    s_add_u32 m0, s90, 139264
    s_mov_b32 s57, 946176
    buffer_load_dwordx4 v2, s[8:11], s57 offen offset:0 lds
    v_mfma_f32_16x16x32_bf16 v[108:111], v[196:199], v[164:167], v[108:111]
    v_mfma_f32_16x16x32_bf16 v[108:111], v[220:223], v[168:171], v[108:111]
    v_mfma_f32_16x16x32_bf16 v[108:111], v[244:247], v[172:175], v[108:111]
    v_mfma_f32_16x16x32_bf16 v[112:115], v[120:123], a[16:19], 0
    s_mov_b32 s57, 955904
    buffer_load_dwordx4 v2, s[8:11], s57 offen offset:1024 lds
    v_mfma_f32_16x16x32_bf16 v[112:115], v[124:127], a[40:43], v[112:115]
    v_mfma_f32_16x16x32_bf16 v[112:115], v[128:131], a[64:67], v[112:115]
    v_mfma_f32_16x16x32_bf16 v[112:115], v[132:135], a[88:91], v[112:115]
    ds_read_b64_tr_b16 a[96:97], v6 offset:16384
    ds_read_b64_tr_b16 a[98:99], v6 offset:17408
    ds_read_b64_tr_b16 a[100:101], v7 offset:16384
    ds_read_b64_tr_b16 a[102:103], v7 offset:17408
    s_add_u32 m0, s90, 147456
    s_mov_b32 s57, 1032192
    buffer_load_dwordx4 v2, s[8:11], s57 offen offset:0 lds
    v_mfma_f32_16x16x32_bf16 v[112:115], v[136:139], a[112:115], v[112:115]
    v_mfma_f32_16x16x32_bf16 v[112:115], v[140:143], a[136:139], v[112:115]
    v_mfma_f32_16x16x32_bf16 v[112:115], v[144:147], a[160:163], v[112:115]
    v_mfma_f32_16x16x32_bf16 v[112:115], v[148:151], a[184:187], v[112:115]
    s_mov_b32 s57, 1041920
    buffer_load_dwordx4 v2, s[8:11], s57 offen offset:1024 lds
    v_mfma_f32_16x16x32_bf16 v[112:115], v[152:155], a[208:211], v[112:115]
    v_cvt_pk_bf16_f32 v38, v108, v109
    v_cvt_pk_bf16_f32 v39, v110, v111
    v_mfma_f32_16x16x32_bf16 v[112:115], v[156:159], a[232:235], v[112:115]
    v_cndmask_b32 v38, v38, 0, s[82:83]
    v_cndmask_b32 v39, v39, 0, s[82:83]
    v_mfma_f32_16x16x32_bf16 v[112:115], v[160:163], v[176:179], v[112:115]
    v_mfma_f32_16x16x32_bf16 v[112:115], v[164:167], v[200:203], v[112:115]
    s_add_u32 m0, s90, 155648
    s_mov_b32 s57, 1118208
    buffer_load_dwordx4 v2, s[8:11], s57 offen offset:0 lds
    s_waitcnt vmcnt(11)
    s_waitcnt lgkmcnt(0)
    s_barrier
    ds_read_b64_tr_b16 a[120:121], v6 offset:24576
    ds_read_b64_tr_b16 a[122:123], v6 offset:25600
    ds_read_b64_tr_b16 a[124:125], v7 offset:24576
    ds_read_b64_tr_b16 a[126:127], v7 offset:25600
    v_mfma_f32_16x16x32_bf16 v[112:115], v[168:171], v[224:227], v[112:115]
    v_mfma_f32_16x16x32_bf16 v[112:115], v[172:175], v[248:251], v[112:115]
    s_mov_b32 s57, 1127936
    buffer_load_dwordx4 v2, s[8:11], s57 offen offset:1024 lds
    v_mfma_f32_16x16x32_bf16 v[116:119], v[120:123], a[20:23], 0
    ds_read_b128 v[120:123], v4 offset:16384
    v_mfma_f32_16x16x32_bf16 v[116:119], v[124:127], a[44:47], v[116:119]
    ds_read_b128 v[124:127], v25 offset:16384
    v_mfma_f32_16x16x32_bf16 v[116:119], v[128:131], a[68:71], v[116:119]
    ds_read_b128 v[128:131], v4 offset:18432
    v_mfma_f32_16x16x32_bf16 v[116:119], v[132:135], a[92:95], v[116:119]
    ds_read_b128 v[132:135], v25 offset:18432
    s_add_u32 m0, s52, 32768
    s_add_u32 s58, s72, 14336
    s_add_u32 s57, s58, s68
    buffer_load_dwordx4 v3, s[24:27], s57 offen offset:0 sc1 lds
    v_mfma_f32_16x16x32_bf16 v[116:119], v[136:139], a[116:119], v[116:119]
    ds_read_b128 v[136:139], v4 offset:20480
    v_mfma_f32_16x16x32_bf16 v[116:119], v[140:143], a[140:143], v[116:119]
    ds_read_b128 v[140:143], v25 offset:20480
    ds_read_b64_tr_b16 a[144:145], v6 offset:32768
    ds_read_b64_tr_b16 a[146:147], v6 offset:33792
    ds_read_b64_tr_b16 a[148:149], v7 offset:32768
    ds_read_b64_tr_b16 a[150:151], v7 offset:33792
    v_mfma_f32_16x16x32_bf16 v[116:119], v[144:147], a[164:167], v[116:119]
    ds_read_b128 v[144:147], v4 offset:22528
    s_add_u32 s57, s58, s69
    buffer_load_dwordx4 v3, s[24:27], s57 offen offset:1024 sc1 lds
    v_mfma_f32_16x16x32_bf16 v[116:119], v[148:151], a[188:191], v[116:119]
    ds_read_b128 v[148:151], v25 offset:22528
    v_mfma_f32_16x16x32_bf16 v[116:119], v[152:155], a[212:215], v[116:119]
    v_cvt_pk_bf16_f32 v44, v112, v113
    v_cvt_pk_bf16_f32 v45, v114, v115
    ds_read_b128 v[152:155], v4 offset:24576
    v_mfma_f32_16x16x32_bf16 v[116:119], v[156:159], a[236:239], v[116:119]
    ds_read_b128 v[156:159], v25 offset:24576
    v_mfma_f32_16x16x32_bf16 v[116:119], v[160:163], v[180:183], v[116:119]
    ds_read_b128 v[160:163], v4 offset:26624
    s_add_u32 s57, s58, s70
    buffer_load_dwordx4 v3, s[24:27], s57 offen offset:2048 sc1 lds
    v_mfma_f32_16x16x32_bf16 v[116:119], v[164:167], v[204:207], v[116:119]
    ds_read_b128 v[164:167], v25 offset:26624
    v_mfma_f32_16x16x32_bf16 v[116:119], v[168:171], v[228:231], v[116:119]
    ds_read_b128 v[168:171], v4 offset:28672
    v_mfma_f32_16x16x32_bf16 v[116:119], v[172:175], v[252:255], v[116:119]
    ds_read_b128 v[172:175], v25 offset:28672
    ds_read_b64_tr_b16 a[168:169], v6 offset:40960
    ds_read_b64_tr_b16 a[170:171], v6 offset:41984
    ds_read_b64_tr_b16 a[172:173], v7 offset:40960
    ds_read_b64_tr_b16 a[174:175], v7 offset:41984
    s_add_u32 s57, s58, s71
    buffer_load_dwordx4 v3, s[24:27], s57 offen offset:3072 sc1 lds
    s_waitcnt lgkmcnt(15)
    v_mfma_f32_16x16x32_bf16 v[104:107], a[8:11], v[120:123], 0
    v_mfma_f32_16x16x32_bf16 v[104:107], a[32:35], v[124:127], v[104:107]
    v_mfma_f32_16x16x32_bf16 v[104:107], a[56:59], v[128:131], v[104:107]
    v_mfma_f32_16x16x32_bf16 v[104:107], a[80:83], v[132:135], v[104:107]
    v_mfma_f32_16x16x32_bf16 v[104:107], a[104:107], v[136:139], v[104:107]
    v_mfma_f32_16x16x32_bf16 v[104:107], a[128:131], v[140:143], v[104:107]
    s_waitcnt lgkmcnt(11)
    v_mfma_f32_16x16x32_bf16 v[104:107], a[152:155], v[144:147], v[104:107]
    s_waitcnt lgkmcnt(10)
    v_mfma_f32_16x16x32_bf16 v[104:107], a[176:179], v[148:151], v[104:107]
    s_waitcnt vmcnt(10)
    s_waitcnt lgkmcnt(0)
    s_barrier
    ds_read_b64_tr_b16 a[192:193], v10 offset:0
    ds_read_b64_tr_b16 a[194:195], v10 offset:1024
    ds_read_b64_tr_b16 a[196:197], v11 offset:0
    ds_read_b64_tr_b16 a[198:199], v11 offset:1024
    v_mfma_f32_16x16x32_bf16 v[104:107], a[200:203], v[152:155], v[104:107]
    v_cvt_pk_bf16_f32 v48, v116, v117
    v_cvt_pk_bf16_f32 v49, v118, v119
    v_mfma_f32_16x16x32_bf16 v[104:107], a[224:227], v[156:159], v[104:107]
    v_mfma_f32_16x16x32_bf16 v[104:107], a[248:251], v[160:163], v[104:107]
    v_mfma_f32_16x16x32_bf16 v[104:107], v[192:195], v[164:167], v[104:107]
    v_mfma_f32_16x16x32_bf16 v[104:107], v[216:219], v[168:171], v[104:107]
    v_mfma_f32_16x16x32_bf16 v[104:107], v[240:243], v[172:175], v[104:107]
    v_mfma_f32_16x16x32_bf16 v[108:111], a[12:15], v[120:123], 0
    v_mfma_f32_16x16x32_bf16 v[108:111], a[36:39], v[124:127], v[108:111]
    ds_read_b64_tr_b16 a[216:217], v10 offset:8192
    ds_read_b64_tr_b16 a[218:219], v10 offset:9216
    ds_read_b64_tr_b16 a[220:221], v11 offset:8192
    ds_read_b64_tr_b16 a[222:223], v11 offset:9216
    v_mfma_f32_16x16x32_bf16 v[108:111], a[60:63], v[128:131], v[108:111]
    v_mfma_f32_16x16x32_bf16 v[108:111], a[84:87], v[132:135], v[108:111]
    v_mfma_f32_16x16x32_bf16 v[108:111], a[108:111], v[136:139], v[108:111]
    v_mfma_f32_16x16x32_bf16 v[108:111], a[132:135], v[140:143], v[108:111]
    v_mfma_f32_16x16x32_bf16 v[108:111], a[156:159], v[144:147], v[108:111]
    v_mfma_f32_16x16x32_bf16 v[108:111], a[180:183], v[148:151], v[108:111]
    v_mfma_f32_16x16x32_bf16 v[108:111], a[204:207], v[152:155], v[108:111]
    v_cvt_pk_bf16_f32 v40, v104, v105
    v_cvt_pk_bf16_f32 v41, v106, v107
    v_mfma_f32_16x16x32_bf16 v[108:111], a[228:231], v[156:159], v[108:111]
    ds_read_b64_tr_b16 a[240:241], v10 offset:16384
    ds_read_b64_tr_b16 a[242:243], v10 offset:17408
    ds_read_b64_tr_b16 a[244:245], v11 offset:16384
    ds_read_b64_tr_b16 a[246:247], v11 offset:17408
    v_mfma_f32_16x16x32_bf16 v[108:111], a[252:255], v[160:163], v[108:111]
    v_mfma_f32_16x16x32_bf16 v[108:111], v[196:199], v[164:167], v[108:111]
    v_mfma_f32_16x16x32_bf16 v[108:111], v[220:223], v[168:171], v[108:111]
    v_mfma_f32_16x16x32_bf16 v[108:111], v[244:247], v[172:175], v[108:111]
    v_mfma_f32_16x16x32_bf16 v[112:115], v[120:123], a[16:19], 0
    v_mfma_f32_16x16x32_bf16 v[112:115], v[124:127], a[40:43], v[112:115]
    v_mfma_f32_16x16x32_bf16 v[112:115], v[128:131], a[64:67], v[112:115]
    v_mfma_f32_16x16x32_bf16 v[112:115], v[132:135], a[88:91], v[112:115]
    s_waitcnt vmcnt(4)
    s_waitcnt lgkmcnt(0)
    s_barrier
    ds_read_b64_tr_b16 v[184:185], v10 offset:24576
    ds_read_b64_tr_b16 v[186:187], v10 offset:25600
    ds_read_b64_tr_b16 v[188:189], v11 offset:24576
    ds_read_b64_tr_b16 v[190:191], v11 offset:25600
    v_mfma_f32_16x16x32_bf16 v[112:115], v[136:139], a[112:115], v[112:115]
    v_mfma_f32_16x16x32_bf16 v[112:115], v[140:143], a[136:139], v[112:115]
    v_mfma_f32_16x16x32_bf16 v[112:115], v[144:147], a[160:163], v[112:115]
    v_mfma_f32_16x16x32_bf16 v[112:115], v[148:151], a[184:187], v[112:115]
    v_mfma_f32_16x16x32_bf16 v[112:115], v[152:155], a[208:211], v[112:115]
    v_cvt_pk_bf16_f32 v42, v108, v109
    v_cvt_pk_bf16_f32 v43, v110, v111
    v_mfma_f32_16x16x32_bf16 v[112:115], v[156:159], a[232:235], v[112:115]
    v_cndmask_b32 v42, v42, 0, s[82:83]
    v_cndmask_b32 v43, v43, 0, s[82:83]
    v_mfma_f32_16x16x32_bf16 v[112:115], v[160:163], v[176:179], v[112:115]
    v_mfma_f32_16x16x32_bf16 v[112:115], v[164:167], v[200:203], v[112:115]
    ds_read_b64_tr_b16 v[208:209], v10 offset:32768
    ds_read_b64_tr_b16 v[210:211], v10 offset:33792
    ds_read_b64_tr_b16 v[212:213], v11 offset:32768
    ds_read_b64_tr_b16 v[214:215], v11 offset:33792
    v_mfma_f32_16x16x32_bf16 v[112:115], v[168:171], v[224:227], v[112:115]
    v_mfma_f32_16x16x32_bf16 v[112:115], v[172:175], v[248:251], v[112:115]
    v_mfma_f32_16x16x32_bf16 v[116:119], v[120:123], a[20:23], 0
    v_mfma_f32_16x16x32_bf16 v[116:119], v[124:127], a[44:47], v[116:119]
    v_mfma_f32_16x16x32_bf16 v[116:119], v[128:131], a[68:71], v[116:119]
    v_mfma_f32_16x16x32_bf16 v[116:119], v[132:135], a[92:95], v[116:119]
    v_mfma_f32_16x16x32_bf16 v[116:119], v[136:139], a[116:119], v[116:119]
    v_mfma_f32_16x16x32_bf16 v[116:119], v[140:143], a[140:143], v[116:119]
    ds_read_b64_tr_b16 v[232:233], v10 offset:40960
    ds_read_b64_tr_b16 v[234:235], v10 offset:41984
    ds_read_b64_tr_b16 v[236:237], v11 offset:40960
    ds_read_b64_tr_b16 v[238:239], v11 offset:41984
    v_mfma_f32_16x16x32_bf16 v[116:119], v[144:147], a[164:167], v[116:119]
    v_mfma_f32_16x16x32_bf16 v[116:119], v[148:151], a[188:191], v[116:119]
    v_mfma_f32_16x16x32_bf16 v[116:119], v[152:155], a[212:215], v[116:119]
    v_mfma_f32_16x16x32_bf16 v[116:119], v[156:159], a[236:239], v[116:119]
    v_mfma_f32_16x16x32_bf16 v[116:119], v[160:163], v[180:183], v[116:119]
    v_mfma_f32_16x16x32_bf16 v[116:119], v[164:167], v[204:207], v[116:119]
    v_mfma_f32_16x16x32_bf16 v[116:119], v[168:171], v[228:231], v[116:119]
    v_mfma_f32_16x16x32_bf16 v[116:119], v[172:175], v[252:255], v[116:119]
    s_mov_b32 s65, 1
    s_add_u32 s73, s52, 49152
    s_add_u32 s72, s72, 28672
    v_add_u32 v4, 16384, v4
    s_waitcnt lgkmcnt(0)
    s_branch L_a_entry
L_a_loop:
    s_waitcnt lgkmcnt(11)
    v_mfma_f32_16x16x32_bf16 v[104:107], a[8:11], v[120:123], 0
    s_cmp_eq_u32 s65, 2
    s_cselect_b64 s[84:85], s[88:89], 0
    v_mfma_f32_16x16x32_bf16 v[104:107], a[32:35], v[124:127], v[104:107]
    s_andn2_b64 s[86:87], s[84:85], s[80:81]
    s_andn2_b64 s[84:85], s[84:85], s[78:79]
    v_mfma_f32_16x16x32_bf16 v[104:107], a[56:59], v[128:131], v[104:107]
    s_waitcnt lgkmcnt(8)
    v_mfma_f32_16x16x32_bf16 v[104:107], a[80:83], v[132:135], v[104:107]
    v_mfma_f32_16x16x32_bf16 v[104:107], a[104:107], v[136:139], v[104:107]
    v_cvt_pk_bf16_f32 v34, v100, v101
    v_cvt_pk_bf16_f32 v35, v102, v103
    v_mfma_f32_16x16x32_bf16 v[104:107], a[128:131], v[140:143], v[104:107]
    v_cndmask_b32 v34, v34, 0, s[82:83]
    v_cndmask_b32 v35, v35, 0, s[82:83]
    s_waitcnt lgkmcnt(5)
    v_mfma_f32_16x16x32_bf16 v[104:107], a[152:155], v[144:147], v[104:107]
    v_mfma_f32_16x16x32_bf16 v[104:107], a[176:179], v[148:151], v[104:107]
    v_mfma_f32_16x16x32_bf16 v[52:55], v[36:39], v[32:35], 0
    v_mfma_f32_16x16x32_bf16 v[104:107], a[200:203], v[152:155], v[104:107]
    v_mfma_f32_16x16x32_bf16 v[56:59], v[40:43], v[32:35], 0
    s_waitcnt lgkmcnt(2)
    v_mfma_f32_16x16x32_bf16 v[104:107], a[224:227], v[156:159], v[104:107]
    v_mov_b32 v36, v40
    v_mfma_f32_16x16x32_bf16 v[104:107], a[248:251], v[160:163], v[104:107]
    v_mov_b32 v37, v41
    v_mfma_f32_16x16x32_bf16 v[104:107], v[192:195], v[164:167], v[104:107]
    v_mov_b32 v38, v42
    s_waitcnt lgkmcnt(0)
    v_mfma_f32_16x16x32_bf16 v[104:107], v[216:219], v[168:171], v[104:107]
    v_mov_b32 v39, v43
    v_mfma_f32_16x16x32_bf16 v[104:107], v[240:243], v[172:175], v[104:107]
    v_cndmask_b32 v76, v52, v53, s[76:77]
    v_mfma_f32_16x16x32_bf16 v[108:111], a[12:15], v[120:123], 0
    v_cndmask_b32 v77, v54, v55, s[76:77]
    v_mfma_f32_16x16x32_bf16 v[108:111], a[36:39], v[124:127], v[108:111]
    v_cndmask_b32 v78, v56, v57, s[76:77]
    v_mfma_f32_16x16x32_bf16 v[108:111], a[60:63], v[128:131], v[108:111]
    v_cndmask_b32 v79, v58, v59, s[76:77]
    v_mfma_f32_16x16x32_bf16 v[108:111], a[84:87], v[132:135], v[108:111]
    v_cndmask_b32 v76, v76, v78, s[78:79]
    v_mfma_f32_16x16x32_bf16 v[108:111], a[108:111], v[136:139], v[108:111]
    v_cndmask_b32 v77, v77, v79, s[80:81]
    v_mfma_f32_16x16x32_bf16 v[108:111], a[132:135], v[140:143], v[108:111]
    v_cndmask_b32 v76, v76, v18, s[84:85]
    v_cvt_pk_bf16_f32 v40, v104, v105
    v_mfma_f32_16x16x32_bf16 v[108:111], a[156:159], v[144:147], v[108:111]
    v_cndmask_b32 v77, v77, v18, s[86:87]
    v_cvt_pk_bf16_f32 v41, v106, v107
    v_mfma_f32_16x16x32_bf16 v[108:111], a[180:183], v[148:151], v[108:111]
    v_max_f32 v78, v76, v77
    v_mfma_f32_16x16x32_bf16 v[108:111], a[204:207], v[152:155], v[108:111]
    v_mov_b32 v79, v78
    v_mfma_f32_16x16x32_bf16 v[108:111], a[228:231], v[156:159], v[108:111]
    v_mfma_f32_16x16x32_bf16 v[108:111], a[252:255], v[160:163], v[108:111]
    v_permlane16_swap_b32 v78, v79
    v_mfma_f32_16x16x32_bf16 v[108:111], v[196:199], v[164:167], v[108:111]
    v_max_f32 v78, v78, v79
    v_mfma_f32_16x16x32_bf16 v[108:111], v[220:223], v[168:171], v[108:111]
    v_mov_b32 v79, v78
    v_mfma_f32_16x16x32_bf16 v[108:111], v[244:247], v[172:175], v[108:111]
    v_mfma_f32_16x16x32_bf16 v[112:115], v[120:123], a[16:19], 0
    v_permlane32_swap_b32 v78, v79
    v_mfma_f32_16x16x32_bf16 v[112:115], v[124:127], a[40:43], v[112:115]
    v_max_f32 v78, v78, v79
    v_mfma_f32_16x16x32_bf16 v[112:115], v[128:131], a[64:67], v[112:115]
    v_sub_f32 v76, v76, v78
    v_sub_f32 v77, v77, v78
    v_mfma_f32_16x16x32_bf16 v[112:115], v[132:135], a[88:91], v[112:115]
    v_mul_f32 v76, s91, v76
    v_mul_f32 v77, s91, v77
    v_mfma_f32_16x16x32_bf16 v[112:115], v[136:139], a[112:115], v[112:115]
    v_exp_f32 v76, v76
    v_mfma_f32_16x16x32_bf16 v[112:115], v[140:143], a[136:139], v[112:115]
    v_exp_f32 v77, v77
    v_mfma_f32_16x16x32_bf16 v[112:115], v[144:147], a[160:163], v[112:115]
    v_add_f32 v78, v76, v77
    v_mfma_f32_16x16x32_bf16 v[112:115], v[148:151], a[184:187], v[112:115]
    v_mov_b32 v79, v78
    v_mfma_f32_16x16x32_bf16 v[112:115], v[152:155], a[208:211], v[112:115]
    v_cvt_pk_bf16_f32 v42, v108, v109
    v_mfma_f32_16x16x32_bf16 v[112:115], v[156:159], a[232:235], v[112:115]
    v_permlane16_swap_b32 v78, v79
    v_cvt_pk_bf16_f32 v43, v110, v111
    v_mfma_f32_16x16x32_bf16 v[112:115], v[160:163], v[176:179], v[112:115]
    v_add_f32 v78, v78, v79
    v_cndmask_b32 v42, v42, 0, s[82:83]
    v_mfma_f32_16x16x32_bf16 v[112:115], v[164:167], v[200:203], v[112:115]
    v_mov_b32 v79, v78
    v_cndmask_b32 v43, v43, 0, s[82:83]
    v_mfma_f32_16x16x32_bf16 v[112:115], v[168:171], v[224:227], v[112:115]
    v_mfma_f32_16x16x32_bf16 v[112:115], v[172:175], v[248:251], v[112:115]
    v_permlane32_swap_b32 v78, v79
    v_mfma_f32_16x16x32_bf16 v[116:119], v[120:123], a[20:23], 0
    v_add_f32 v78, v78, v79
    v_mfma_f32_16x16x32_bf16 v[116:119], v[124:127], a[44:47], v[116:119]
    v_rcp_f32 v78, v78
    v_mfma_f32_16x16x32_bf16 v[116:119], v[128:131], a[68:71], v[116:119]
    v_mul_f32 v76, v76, v78
    v_mul_f32 v77, v77, v78
    v_mfma_f32_16x16x32_bf16 v[116:119], v[132:135], a[92:95], v[116:119]
    v_cvt_pk_bf16_f32 v76, v76, v76
    v_cvt_pk_bf16_f32 v77, v77, v77
    v_mfma_f32_16x16x32_bf16 v[116:119], v[136:139], a[116:119], v[116:119]
    v_and_b32 v60, v76, v14
    v_and_b32 v61, v77, v15
    v_mfma_f32_16x16x32_bf16 v[116:119], v[140:143], a[140:143], v[116:119]
    v_and_b32 v62, v76, v16
    v_and_b32 v63, v77, v17
    v_mfma_f32_16x16x32_bf16 v[116:119], v[144:147], a[164:167], v[116:119]
    v_mfma_f32_16x16x32_bf16 v[116:119], v[148:151], a[188:191], v[116:119]
    v_mfma_f32_16x16x32_bf16 v[64:67], v[44:47], v[60:63], 0
    v_mfma_f32_16x16x32_bf16 v[116:119], v[152:155], a[212:215], v[116:119]
    v_mfma_f32_16x16x32_bf16 v[68:71], v[48:51], v[60:63], 0
    v_mfma_f32_16x16x32_bf16 v[116:119], v[156:159], a[236:239], v[116:119]
    v_mov_b32 v44, v46
    v_mfma_f32_16x16x32_bf16 v[116:119], v[160:163], v[180:183], v[116:119]
    v_mov_b32 v45, v47
    v_mfma_f32_16x16x32_bf16 v[116:119], v[164:167], v[204:207], v[116:119]
    v_mov_b32 v48, v50
    v_mfma_f32_16x16x32_bf16 v[116:119], v[168:171], v[228:231], v[116:119]
    v_mov_b32 v49, v51
    v_mfma_f32_16x16x32_bf16 v[116:119], v[172:175], v[252:255], v[116:119]
L_a_entry:
    v_mfma_f32_16x16x32_bf16 v[96:99], a[0:3], v[120:123], 0
    s_cmp_lt_u32 s65, 2
    s_cselect_b32 s53, 2130706432, s74
    v_mfma_f32_16x16x32_bf16 v[96:99], a[24:27], v[124:127], v[96:99]
    v_cvt_pk_bf16_f32 v72, v64, v65
    s_add_u32 s74, s74, 16384
    v_mfma_f32_16x16x32_bf16 v[96:99], a[48:51], v[128:131], v[96:99]
    v_cvt_pk_bf16_f32 v73, v66, v67
    v_add_u32 v4, 16384, v4
    v_mfma_f32_16x16x32_bf16 v[96:99], a[72:75], v[132:135], v[96:99]
    v_cvt_pk_bf16_f32 v74, v68, v69
    v_and_b32 v4, 0xffff, v4
    v_mfma_f32_16x16x32_bf16 v[96:99], a[96:99], v[136:139], v[96:99]
    v_cvt_pk_bf16_f32 v75, v70, v71
    v_xor_b32 v25, 64, v4
    v_mfma_f32_16x16x32_bf16 v[96:99], a[120:123], v[140:143], v[96:99]
    v_cndmask_b32 v74, v74, 0, s[82:83]
    v_mfma_f32_16x16x32_bf16 v[96:99], a[144:147], v[144:147], v[96:99]
    v_cndmask_b32 v75, v75, 0, s[82:83]
    v_mfma_f32_16x16x32_bf16 v[96:99], a[168:171], v[148:151], v[96:99]
    buffer_store_dwordx4 v[72:75], v23, s[24:27], s53 offen sc1
    v_mfma_f32_16x16x32_bf16 v[96:99], a[192:195], v[152:155], v[96:99]
    v_cvt_pk_bf16_f32 v46, v112, v113
    v_mfma_f32_16x16x32_bf16 v[96:99], a[216:219], v[156:159], v[96:99]
    v_cvt_pk_bf16_f32 v47, v114, v115
    v_mfma_f32_16x16x32_bf16 v[96:99], a[240:243], v[160:163], v[96:99]
    v_cvt_pk_bf16_f32 v50, v116, v117
    v_mfma_f32_16x16x32_bf16 v[96:99], v[184:187], v[164:167], v[96:99]
    v_cvt_pk_bf16_f32 v51, v118, v119
    s_mov_b32 m0, s73
    v_mfma_f32_16x16x32_bf16 v[96:99], v[208:211], v[168:171], v[96:99]
    s_add_u32 s73, s73, 16384
    s_and_b32 s73, s73, 0xffff
    v_mfma_f32_16x16x32_bf16 v[96:99], v[232:235], v[172:175], v[96:99]
    s_waitcnt vmcnt(1)
    s_barrier
    v_mfma_f32_16x16x32_bf16 v[100:103], a[4:7], v[120:123], 0
    ds_read_b128 v[120:123], v4 offset:0
    s_add_u32 s57, s72, s68
    v_mfma_f32_16x16x32_bf16 v[100:103], a[28:31], v[124:127], v[100:103]
    ds_read_b128 v[124:127], v25 offset:0
    buffer_load_dwordx4 v3, s[24:27], s57 offen offset:0 sc1 lds
    v_mfma_f32_16x16x32_bf16 v[100:103], a[52:55], v[128:131], v[100:103]
    ds_read_b128 v[128:131], v4 offset:2048
    v_mfma_f32_16x16x32_bf16 v[100:103], a[76:79], v[132:135], v[100:103]
    ds_read_b128 v[132:135], v25 offset:2048
    s_add_u32 s57, s72, s69
    v_mfma_f32_16x16x32_bf16 v[100:103], a[100:103], v[136:139], v[100:103]
    ds_read_b128 v[136:139], v4 offset:4096
    buffer_load_dwordx4 v3, s[24:27], s57 offen offset:1024 sc1 lds
    v_mfma_f32_16x16x32_bf16 v[100:103], a[124:127], v[140:143], v[100:103]
    ds_read_b128 v[140:143], v25 offset:4096
    v_cvt_pk_bf16_f32 v32, v96, v97
    v_mfma_f32_16x16x32_bf16 v[100:103], a[148:151], v[144:147], v[100:103]
    ds_read_b128 v[144:147], v4 offset:6144
    v_cvt_pk_bf16_f32 v33, v98, v99
    v_mfma_f32_16x16x32_bf16 v[100:103], a[172:175], v[148:151], v[100:103]
    ds_read_b128 v[148:151], v25 offset:6144
    s_add_u32 s57, s72, s70
    v_mfma_f32_16x16x32_bf16 v[100:103], a[196:199], v[152:155], v[100:103]
    ds_read_b128 v[152:155], v4 offset:8192
    buffer_load_dwordx4 v3, s[24:27], s57 offen offset:2048 sc1 lds
    v_mfma_f32_16x16x32_bf16 v[100:103], a[220:223], v[156:159], v[100:103]
    ds_read_b128 v[156:159], v25 offset:8192
    v_mfma_f32_16x16x32_bf16 v[100:103], a[244:247], v[160:163], v[100:103]
    ds_read_b128 v[160:163], v4 offset:10240
    s_add_u32 s57, s72, s71
    v_mfma_f32_16x16x32_bf16 v[100:103], v[188:191], v[164:167], v[100:103]
    ds_read_b128 v[164:167], v25 offset:10240
    buffer_load_dwordx4 v3, s[24:27], s57 offen offset:3072 sc1 lds
    v_mfma_f32_16x16x32_bf16 v[100:103], v[212:215], v[168:171], v[100:103]
    ds_read_b128 v[168:171], v4 offset:12288
    s_add_u32 s72, s72, 14336
    v_mfma_f32_16x16x32_bf16 v[100:103], v[236:239], v[172:175], v[100:103]
    ds_read_b128 v[172:175], v25 offset:12288
    s_add_u32 s65, s65, 1
    s_cmp_lt_u32 s65, 9
    s_cbranch_scc1 L_a_loop
    s_cmp_eq_u32 s65, 2
    s_cselect_b64 s[84:85], s[88:89], 0
    s_andn2_b64 s[86:87], s[84:85], s[80:81]
    s_andn2_b64 s[84:85], s[84:85], s[78:79]
    v_cvt_pk_bf16_f32 v34, v100, v101
    v_cvt_pk_bf16_f32 v35, v102, v103
    v_cndmask_b32 v34, v34, 0, s[82:83]
    v_cndmask_b32 v35, v35, 0, s[82:83]
    s_nop 1
    v_mfma_f32_16x16x32_bf16 v[52:55], v[36:39], v[32:35], 0
    v_mfma_f32_16x16x32_bf16 v[56:59], v[40:43], v[32:35], 0
    s_nop 6
    v_cndmask_b32 v76, v52, v53, s[76:77]
    v_cndmask_b32 v77, v54, v55, s[76:77]
    v_cndmask_b32 v78, v56, v57, s[76:77]
    v_cndmask_b32 v79, v58, v59, s[76:77]
    v_cndmask_b32 v76, v76, v78, s[78:79]
    v_cndmask_b32 v77, v77, v79, s[80:81]
    v_cndmask_b32 v76, v76, v18, s[84:85]
    v_cndmask_b32 v77, v77, v18, s[86:87]
    v_max_f32 v78, v76, v77
    v_mov_b32 v79, v78
    s_nop 1
    v_permlane16_swap_b32 v78, v79
    v_max_f32 v78, v78, v79
    v_mov_b32 v79, v78
    s_nop 1
    v_permlane32_swap_b32 v78, v79
    v_max_f32 v78, v78, v79
    v_sub_f32 v76, v76, v78
    v_sub_f32 v77, v77, v78
    v_mul_f32 v76, s91, v76
    v_mul_f32 v77, s91, v77
    v_exp_f32 v76, v76
    v_exp_f32 v77, v77
    s_nop 0
    v_add_f32 v78, v76, v77
    v_mov_b32 v79, v78
    s_nop 1
    v_permlane16_swap_b32 v78, v79
    v_add_f32 v78, v78, v79
    v_mov_b32 v79, v78
    s_nop 1
    v_permlane32_swap_b32 v78, v79
    v_add_f32 v78, v78, v79
    v_rcp_f32 v78, v78
    s_nop 0
    v_mul_f32 v76, v76, v78
    v_mul_f32 v77, v77, v78
    v_cvt_pk_bf16_f32 v76, v76, v76
    v_cvt_pk_bf16_f32 v77, v77, v77
    v_and_b32 v60, v76, v14
    v_and_b32 v61, v77, v15
    v_and_b32 v62, v76, v16
    v_and_b32 v63, v77, v17
    s_nop 1
    v_mfma_f32_16x16x32_bf16 v[64:67], v[44:47], v[60:63], 0
    v_mfma_f32_16x16x32_bf16 v[68:71], v[48:51], v[60:63], 0
    s_cmp_lt_u32 s65, 2
    s_cselect_b32 s53, 2130706432, s74
    s_nop 4
    v_cvt_pk_bf16_f32 v72, v64, v65
    v_cvt_pk_bf16_f32 v73, v66, v67
    v_cvt_pk_bf16_f32 v74, v68, v69
    v_cvt_pk_bf16_f32 v75, v70, v71
    v_cndmask_b32 v74, v74, 0, s[82:83]
    v_cndmask_b32 v75, v75, 0, s[82:83]
    buffer_store_dwordx4 v[72:75], v23, s[24:27], s53 offen sc1
    s_waitcnt vmcnt(0) lgkmcnt(0)
    s_barrier
    s_cmp_lg_u32 s44, 0
    s_cbranch_scc1 L_nopub16
    s_lshl_b32 s60, s48, 4
    s_add_u32 s60, s60, s49
    s_lshl_b32 s60, s60, 7
    s_add_u32 s60, s60, 12779520
    v_mov_b32 v30, s47
    s_mov_b64 exec, 1
    buffer_store_dword v30, off, s[24:27], s60 sc1
    s_mov_b64 exec, -1
L_nopub16:
    s_endpgm
L_codeend:
.section .rodata,"a"
.p2align 6
.amdhsa_kernel parallel_sum__sliding_local_dilated__mixer_token_mlp__prompt_kernel
  .amdhsa_next_free_vgpr 512
  .amdhsa_next_free_sgpr 102
  .amdhsa_accum_offset 256
  .amdhsa_group_segment_fixed_size 0
  .amdhsa_kernarg_size 88
  .amdhsa_user_sgpr_count 2
  .amdhsa_user_sgpr_kernarg_segment_ptr 1
  .amdhsa_system_sgpr_workgroup_id_x 1
  .amdhsa_float_denorm_mode_32 3
.end_amdhsa_kernel
```

```asm
; @launch grid=(256,1,1) block=(256,1,1) lds=163840
.amdgcn_target "amdgcn-amd-amdhsa--gfx950"
.text
.globl parallel_sum__sliding_local_dilated__mixer_token_mlp__prompt_kernel
.p2align 8
.type parallel_sum__sliding_local_dilated__mixer_token_mlp__prompt_kernel,@function
parallel_sum__sliding_local_dilated__mixer_token_mlp__prompt_kernel:
    s_cmp_ge_u32 s2, 256
    s_cbranch_scc1 L_end
    s_load_dwordx2 s[4:5], s[0:1], 0
    s_load_dwordx16 s[76:91], s[0:1], 0
    s_load_dwordx4 s[92:95], s[0:1], 64
    s_load_dwordx2 s[24:25], s[0:1], 80
    s_lshr_b32 s46, s2, 3
    s_getpc_b64 s[98:99]
L_pc:
    s_mul_i32 s53, s46, 1408
    v_lshrrev_b32 v26, 4, v0
    v_min_u32 v26, 10, v26
    v_lshl_add_u32 v26, v26, 7, s53
    v_lshrrev_b32 v25, 5, v0
    v_min_u32 v26, L_codeend-L_pc-4, v26
    v_mov_b32 v29, s99
    v_add_co_u32 v28, vcc, s98, v26
    s_nop 1
    v_addc_co_u32 v29, vcc, 0, v29, vcc
    global_load_dword v108, v[28:29], off
    v_and_b32 v26, 31, v0
    v_mul_u32_u24 v24, 896, v25
    v_lshl_add_u32 v24, v26, 4, v24
    s_mul_i32 s53, s2, 7168
    v_add_u32 v24, s53, v24
    v_cmp_gt_u32 vcc, 28, v26
    v_mov_b32 v27, 2130706432
    s_mov_b32 s6, 1835008
    s_mov_b32 s7, 0x20000
    v_cndmask_b32 v24, v27, v24, vcc
    v_lshrrev_b32 v27, 6, v0
    v_and_b32 v1, 63, v0
    s_waitcnt lgkmcnt(0)
    buffer_load_dwordx4 v[32:35], v24, s[4:7], 0 offen
    buffer_load_dwordx4 v[36:39], v24, s[4:7], 0 offen offset:448
    v_readfirstlane_b32 s44, v27
    s_and_b32 s45, s2, 7
    s_mov_b64 s[8:9], s[78:79]
    s_mov_b32 s10, 1204224
    s_mov_b32 s11, s7
    s_lshr_b32 s53, s45, 1
    s_add_u32 s54, s53, 1
    s_bfe_u32 s54, s54, 0x10001
    s_add_u32 s54, s54, 1
    s_mul_i32 s53, s53, 224
    s_andn2_b32 s53, s53, 127
    s_mul_i32 s55, s46, 43008
    s_add_u32 s53, s53, s55
    v_and_b32 v27, 3, v0
    v_min_u32 v27, s54, v27
    v_bfe_u32 v28, v0, 2, 2
    v_min_u32 v28, 2, v28
    v_mul_u32_u24 v28, 7, v28
    v_add_u32 v27, v27, v28
    v_lshrrev_b32 v28, 4, v0
    v_min_u32 v28, 15, v28
    v_mul_u32_u24 v28, 21, v28
    v_add_lshl_u32 v27, v27, v28, 7
    buffer_load_dword v108, v27, s[8:11], s53 offen
    s_mov_b64 s[40:41], s[94:95]
    s_mov_b32 s42, 256
    s_mov_b32 s43, s7
    s_or_b32 s53, s2, s44
    s_cbranch_scc1 L_nononce
    s_memrealtime s[98:99]
    s_waitcnt lgkmcnt(0)
    s_or_b32 s98, s98, 1
    v_mov_b32 v28, s98
    s_mov_b64 exec, 1
    buffer_store_dword v28, off, s[40:43], 0 sc1
    s_mov_b64 exec, -1
L_nononce:
    s_mov_b64 s[16:17], s[84:85]
    s_mov_b32 s18, 7340032
    s_mov_b32 s19, s7
    s_mov_b32 s26, 16777216
    s_mov_b32 s27, s7
    s_mov_b64 s[20:21], s[88:89]
    s_mov_b32 s22, 7340032
    s_mov_b32 s23, s7
    s_mov_b64 s[12:13], s[80:81]
    s_mov_b32 s14, 401408
    s_mov_b32 s15, s7
    v_lshrrev_b32 v27, 4, v0
    v_min_u32 v27, 12, v27
    v_lshlrev_b32 v27, 7, v27
    s_mul_i32 s53, s2, 1664
    buffer_load_dword v108, v27, s[12:15], s53 offen
    s_mov_b64 s[28:29], s[92:93]
    s_mov_b32 s30, 1835008
    s_mov_b32 s31, s7
    s_mov_b64 s[32:33], s[86:87]
    s_mov_b32 s34, 3584
    s_mov_b32 s35, s7
    s_mov_b64 s[36:37], s[90:91]
    s_mov_b32 s38, 4096
    s_mov_b32 s39, s7
    s_lshl_b32 s52, s44, 12
    v_lshlrev_b32 v23, 4, v1
    s_cmp_ge_u32 s46, 24
    s_cbranch_scc1 L_role_a
    v_lshrrev_b32 v208, 4, v1
    v_bfe_u32 v209, v1, 2, 2
    v_and_b32 v210, 3, v1
    v_and_b32 v211, 15, v1
    v_lshrrev_b32 v212, 5, v1
    s_mul_i32 s55, s45, 0
    s_max_u32 s55, s55, 1
    s_add_u32 s55, s55, s46
    s_sub_u32 s55, s55, 1
    s_sub_u32 s56, s55, 21
    s_min_u32 s55, s55, s56
    s_and_b32 s54, s45, 1
    s_mul_i32 s54, s54, 24
    s_sub_u32 s54, s46, s54
    s_cmp_ge_u32 s46, 21
    s_cselect_b32 s54, s54, s55
    s_mul_i32 s53, s45, 21
    s_add_u32 s53, s53, s54
    s_mul_i32 s50, s53, 171
    s_lshr_b32 s50, s50, 10
    s_mul_i32 s54, s50, 6
    s_sub_u32 s51, s53, s54
    s_lshl3_add_u32 s65, s51, 1
    s_mul_i32 s65, s65, 43
    s_lshr_b32 s65, s65, 7
    v_lshl_add_u32 v213, v212, 2, v209
    v_and_b32 v215, 1, v208
    v_lshlrev_b32 v214, 4, v210
    v_lshl_add_u32 v214, v215, 6, v214
    s_mul_i32 s53, s44, 1835008
    s_lshl_b32 s54, s50, 7
    s_add_u32 s53, s53, s54
    v_mul_u32_u24 v10, 3584, v213
    v_add3_u32 v10, v10, v214, s53
    v_xor_b32 v11, 32, v10
    s_add_u32 m0, s52, 49152
    s_add_u32 s57, s65, 0
    s_and_b32 s57, s57, 15
    s_mul_i32 s57, s57, 114688
    buffer_load_dwordx4 v10, s[16:19], s57 offen offset:0 lds
    s_add_u32 s57, s57, 27648
    buffer_load_dwordx4 v11, s[16:19], s57 offen offset:1024 lds
    v_mul_u32_u24 v109, 960, v25
    v_lshl_add_u32 v109, v26, 4, v109
    v_mul_u32_u24 v110, 960, v209
    v_lshl_add_u32 v110, v208, 5, v110
    v_lshl_add_u32 v110, v210, 3, v110
    s_lshl_b32 s53, s44, 7
    v_add_u32 v110, s53, v110
    v_mul_u32_u24 v111, 66816, v208
    v_lshl_add_u32 v111, v211, 4, v111
    s_mul_i32 s63, s44, 267264
    s_lshl_b32 s53, s2, 8
    s_add_u32 s63, s63, s53
    s_add_u32 s64, s63, 1069056
    s_cmp_eq_u32 s44, 3
    s_cselect_b32 s64, 2130706432, s64
    s_mov_b32 s62, 0x3f803f80
    s_mov_b32 s61, 0xffff0000
    s_mov_b32 s66, 6291456
    v_mov_b32 v96, 0
    v_mov_b32 v97, 0
    v_lshlrev_b32 v216, 6, v209
    v_lshl_add_u32 v216, v210, 3, v216
    v_lshl_add_u32 v216, v215, 5, v216
    s_add_u32 s53, s52, 49152
    v_lshl_add_u32 v2, v208, 10, v216
    v_add_u32 v2, s53, v2
    v_xor_b32 v3, 32, v2
    v_add_u32 v4, 65536, v2
    v_add_u32 v5, 65536, v3
    v_lshl_add_u32 v6, v208, 9, v216
    v_add_u32 v6, s53, v6
    v_xor_b32 v7, 32, v6
    v_add_u32 v8, 65536, v6
    v_add_u32 v9, 65536, v7
    s_waitcnt vmcnt(5)
    v_dot2c_f32_bf16 v96, s62, v32
    v_dot2c_f32_bf16 v97, v32, v32
    v_lshlrev_b32 v40, 16, v32
    v_and_b32 v41, s61, v32
    v_dot2c_f32_bf16 v96, s62, v33
    v_dot2c_f32_bf16 v97, v33, v33
    v_lshlrev_b32 v42, 16, v33
    v_and_b32 v43, s61, v33
    v_dot2c_f32_bf16 v96, s62, v34
    v_dot2c_f32_bf16 v97, v34, v34
    v_lshlrev_b32 v44, 16, v34
    v_and_b32 v45, s61, v34
    v_dot2c_f32_bf16 v96, s62, v35
    v_dot2c_f32_bf16 v97, v35, v35
    v_lshlrev_b32 v46, 16, v35
    v_and_b32 v47, s61, v35
    s_waitcnt vmcnt(4)
    v_dot2c_f32_bf16 v96, s62, v36
    v_dot2c_f32_bf16 v97, v36, v36
    v_lshlrev_b32 v48, 16, v36
    v_and_b32 v49, s61, v36
    v_dot2c_f32_bf16 v96, s62, v37
    v_dot2c_f32_bf16 v97, v37, v37
    v_lshlrev_b32 v50, 16, v37
    v_and_b32 v51, s61, v37
    v_dot2c_f32_bf16 v96, s62, v38
    v_dot2c_f32_bf16 v97, v38, v38
    v_lshlrev_b32 v52, 16, v38
    v_and_b32 v53, s61, v38
    v_dot2c_f32_bf16 v96, s62, v39
    v_dot2c_f32_bf16 v97, v39, v39
    v_lshlrev_b32 v54, 16, v39
    v_and_b32 v55, s61, v39
    buffer_load_dword v29, off, s[40:43], 0 sc1
    v_add_f32_dpp v96, v96, v96 quad_perm:[1,0,3,2] row_mask:0xf bank_mask:0xf
    v_add_f32_dpp v97, v97, v97 quad_perm:[1,0,3,2] row_mask:0xf bank_mask:0xf
    s_nop 0
    v_add_f32_dpp v96, v96, v96 quad_perm:[2,3,0,1] row_mask:0xf bank_mask:0xf
    v_add_f32_dpp v97, v97, v97 quad_perm:[2,3,0,1] row_mask:0xf bank_mask:0xf
    s_nop 0
    v_add_f32_dpp v96, v96, v96 row_half_mirror row_mask:0xf bank_mask:0xf
    v_add_f32_dpp v97, v97, v97 row_half_mirror row_mask:0xf bank_mask:0xf
    s_nop 0
    v_add_f32_dpp v96, v96, v96 row_mirror row_mask:0xf bank_mask:0xf
    v_add_f32_dpp v97, v97, v97 row_mirror row_mask:0xf bank_mask:0xf
    v_mov_b32 v98, v96
    v_mov_b32 v99, v97
    s_nop 0
    v_permlane16_swap_b32 v96, v98
    v_permlane16_swap_b32 v97, v99
    v_add_f32 v96, v96, v98
    v_add_f32 v97, v97, v99
    v_mul_f32 v98, 0x3b124925, v96
    v_mul_f32 v99, 0x3b124925, v97
    v_fma_f32 v99, -v98, v98, v99
    v_max_f32 v99, 0, v99
    v_cvt_pk_bf16_f32 v100, 0, v99
    v_add_f32 v100, 0x3727c5ac, v100
    v_cvt_pk_bf16_f32 v100, 0, v100
    v_sqrt_f32 v100, v100
    s_nop 0
    v_cvt_pk_bf16_f32 v100, 0, v100
    v_rcp_f32 v100, v100
    s_nop 0
    v_mul_f32 v99, v99, v100
    v_mul_f32 v102, v98, v100
    v_mul_f32 v99, v99, v100
    v_cvt_pk_bf16_f32 v104, 0, v99
    v_add_f32 v104, 0x3727c5ac, v104
    v_cvt_pk_bf16_f32 v104, 0, v104
    v_sqrt_f32 v104, v104
    s_nop 0
    v_cvt_pk_bf16_f32 v104, 0, v104
    v_rcp_f32 v104, v104
    s_nop 0
    v_mul_f32 v104, v104, v100
    v_mul_f32 v106, v98, v104
    v_pk_fma_f32 v[56:57], v[40:41], v[104:105], v[106:107] op_sel_hi:[1,0,0] neg_lo:[0,0,1] neg_hi:[0,0,1]
    v_pk_fma_f32 v[58:59], v[42:43], v[104:105], v[106:107] op_sel_hi:[1,0,0] neg_lo:[0,0,1] neg_hi:[0,0,1]
    v_pk_fma_f32 v[60:61], v[44:45], v[104:105], v[106:107] op_sel_hi:[1,0,0] neg_lo:[0,0,1] neg_hi:[0,0,1]
    v_pk_fma_f32 v[62:63], v[46:47], v[104:105], v[106:107] op_sel_hi:[1,0,0] neg_lo:[0,0,1] neg_hi:[0,0,1]
    v_pk_fma_f32 v[64:65], v[48:49], v[104:105], v[106:107] op_sel_hi:[1,0,0] neg_lo:[0,0,1] neg_hi:[0,0,1]
    v_pk_fma_f32 v[66:67], v[50:51], v[104:105], v[106:107] op_sel_hi:[1,0,0] neg_lo:[0,0,1] neg_hi:[0,0,1]
    v_pk_fma_f32 v[68:69], v[52:53], v[104:105], v[106:107] op_sel_hi:[1,0,0] neg_lo:[0,0,1] neg_hi:[0,0,1]
    v_pk_fma_f32 v[70:71], v[54:55], v[104:105], v[106:107] op_sel_hi:[1,0,0] neg_lo:[0,0,1] neg_hi:[0,0,1]
    v_cvt_pk_bf16_f32 v80, v56, v57
    v_cvt_pk_bf16_f32 v81, v58, v59
    v_cvt_pk_bf16_f32 v82, v60, v61
    v_cvt_pk_bf16_f32 v83, v62, v63
    v_cvt_pk_bf16_f32 v84, v64, v65
    v_cvt_pk_bf16_f32 v85, v66, v67
    v_cvt_pk_bf16_f32 v86, v68, v69
    v_cvt_pk_bf16_f32 v87, v70, v71
    ds_write_b128 v109, v[80:83] offset:0
    ds_write_b128 v109, v[84:87] offset:448
    v_pk_fma_f32 v[40:41], v[40:41], v[100:101], v[102:103] op_sel_hi:[1,0,0] neg_lo:[0,0,1] neg_hi:[0,0,1]
    v_pk_fma_f32 v[42:43], v[42:43], v[100:101], v[102:103] op_sel_hi:[1,0,0] neg_lo:[0,0,1] neg_hi:[0,0,1]
    v_pk_fma_f32 v[44:45], v[44:45], v[100:101], v[102:103] op_sel_hi:[1,0,0] neg_lo:[0,0,1] neg_hi:[0,0,1]
    v_pk_fma_f32 v[46:47], v[46:47], v[100:101], v[102:103] op_sel_hi:[1,0,0] neg_lo:[0,0,1] neg_hi:[0,0,1]
    v_pk_fma_f32 v[48:49], v[48:49], v[100:101], v[102:103] op_sel_hi:[1,0,0] neg_lo:[0,0,1] neg_hi:[0,0,1]
    v_pk_fma_f32 v[50:51], v[50:51], v[100:101], v[102:103] op_sel_hi:[1,0,0] neg_lo:[0,0,1] neg_hi:[0,0,1]
    v_pk_fma_f32 v[52:53], v[52:53], v[100:101], v[102:103] op_sel_hi:[1,0,0] neg_lo:[0,0,1] neg_hi:[0,0,1]
    v_pk_fma_f32 v[54:55], v[54:55], v[100:101], v[102:103] op_sel_hi:[1,0,0] neg_lo:[0,0,1] neg_hi:[0,0,1]
    v_cvt_pk_bf16_f32 v72, v40, v41
    v_cvt_pk_bf16_f32 v73, v42, v43
    v_cvt_pk_bf16_f32 v74, v44, v45
    v_cvt_pk_bf16_f32 v75, v46, v47
    v_cvt_pk_bf16_f32 v76, v48, v49
    v_cvt_pk_bf16_f32 v77, v50, v51
    v_cvt_pk_bf16_f32 v78, v52, v53
    v_cvt_pk_bf16_f32 v79, v54, v55
    s_waitcnt lgkmcnt(0)
    s_barrier
    ds_read_b64_tr_b16 v[88:89], v110 offset:0
    ds_read_b64_tr_b16 v[90:91], v110 offset:3840
    ds_read_b64_tr_b16 v[92:93], v110 offset:512
    ds_read_b64_tr_b16 v[94:95], v110 offset:4352
    buffer_store_dwordx4 v[72:75], v24, s[24:27], s66 offen offset:0 sc1
    buffer_store_dwordx4 v[76:79], v24, s[24:27], s66 offen offset:448 sc1
    s_waitcnt lgkmcnt(2)
    buffer_store_dwordx4 v[88:91], v111, s[24:27], s63 offen sc1
    s_waitcnt lgkmcnt(0)
    buffer_store_dwordx4 v[92:95], v111, s[24:27], s64 offen sc1
    s_add_u32 s57, s57, 27648
    buffer_load_dwordx4 v10, s[16:19], s57 offen offset:2048 lds
    s_add_u32 s57, s57, 27648
    buffer_load_dwordx4 v11, s[16:19], s57 offen offset:3072 lds
    s_add_u32 m0, s52, 65536
    s_add_u32 s57, s65, 1
    s_and_b32 s57, s57, 15
    s_mul_i32 s57, s57, 114688
    buffer_load_dwordx4 v10, s[16:19], s57 offen offset:0 lds
    s_add_u32 s57, s57, 27648
    buffer_load_dwordx4 v11, s[16:19], s57 offen offset:1024 lds
    s_add_u32 s57, s57, 27648
    buffer_load_dwordx4 v10, s[16:19], s57 offen offset:2048 lds
    s_add_u32 s57, s57, 27648
    buffer_load_dwordx4 v11, s[16:19], s57 offen offset:3072 lds
    s_add_u32 m0, s52, 81920
    s_add_u32 s57, s65, 2
    s_and_b32 s57, s57, 15
    s_mul_i32 s57, s57, 114688
    buffer_load_dwordx4 v10, s[16:19], s57 offen offset:0 lds
    s_add_u32 s57, s57, 27648
    buffer_load_dwordx4 v11, s[16:19], s57 offen offset:1024 lds
    s_add_u32 s57, s57, 27648
    buffer_load_dwordx4 v10, s[16:19], s57 offen offset:2048 lds
    s_add_u32 s57, s57, 27648
    buffer_load_dwordx4 v11, s[16:19], s57 offen offset:3072 lds
    s_waitcnt vmcnt(10)
    v_cmp_eq_u32 vcc, 0, v29
    s_nop 0
    s_cbranch_vccz L_ok2
    s_mov_b32 s59, 20000
L_spin1:
    s_sleep 2
    buffer_load_dword v29, off, s[40:43], 0 sc1
    s_waitcnt vmcnt(0)
    v_cmp_eq_u32 vcc, 0, v29
    s_nop 0
    s_cbranch_vccz L_ok2
    s_sub_u32 s59, s59, 1
    s_cbranch_scc0 L_spin1
L_ok2:
    v_readfirstlane_b32 s47, v29
    s_barrier
    s_cmp_lg_u32 s44, 0
    s_cbranch_scc1 L_nopub3
    s_lshl_b32 s60, s2, 5
    s_add_u32 s60, s60, 12582912
    v_mov_b32 v30, s47
    s_mov_b64 exec, 1
    buffer_store_dword v30, off, s[24:27], s60 sc1
    s_mov_b64 exec, -1
L_nopub3:
    s_cmp_ge_u32 s46, 21
    s_cbranch_scc1 L_help
    s_lshl_b32 s53, s44, 11
    s_add_u32 s53, s53, 12582912
    v_lshl_add_u32 v18, v1, 5, s53
    s_lshl_b32 s53, s50, 7
    s_add_u32 m0, s52, 98304
    s_add_u32 s57, s65, 3
    s_and_b32 s57, s57, 15
    s_mul_i32 s57, s57, 114688
    buffer_load_dwordx4 v10, s[16:19], s57 offen offset:0 lds
    v_lshl_add_u32 v19, v208, 3, s53
    s_lshl2_add_u32 s67, s51, s44
    s_mul_i32 s67, s67, 58624
    s_lshl_b32 s53, s50, 11
    s_add_u32 s57, s57, 27648
    buffer_load_dwordx4 v11, s[16:19], s57 offen offset:1024 lds
    s_waitcnt vmcnt(10)
    ds_read_b64_tr_b16 a[0:1], v2 offset:0
    ds_read_b64_tr_b16 a[2:3], v2 offset:512
    ds_read_b64_tr_b16 a[4:5], v3 offset:0
    ds_read_b64_tr_b16 a[6:7], v3 offset:512
    s_add_u32 s57, s57, 27648
    buffer_load_dwordx4 v10, s[16:19], s57 offen offset:2048 lds
    ds_read_b64_tr_b16 a[8:9], v2 offset:256
    ds_read_b64_tr_b16 a[10:11], v2 offset:768
    ds_read_b64_tr_b16 a[12:13], v3 offset:256
    ds_read_b64_tr_b16 a[14:15], v3 offset:768
    s_add_u32 s67, s67, s53
    s_add_u32 s67, s67, 2097152
    v_add_u32 v232, s52, v23
    v_xor_b32 v233, 4096, v232
    s_add_u32 s57, s57, 27648
    buffer_load_dwordx4 v11, s[16:19], s57 offen offset:3072 lds
    v_xor_b32 v234, 8192, v232
    v_xor_b32 v235, 12288, v232
    v_mov_b32 v236, 0xbdd2d3e8
    v_mov_b32 v237, 0xc0135761
    s_add_u32 m0, s52, 114688
    s_add_u32 s57, s65, 4
    s_and_b32 s57, s57, 15
    s_mul_i32 s57, s57, 114688
    buffer_load_dwordx4 v10, s[16:19], s57 offen offset:0 lds
    s_mul_i32 s88, s50, 4
    s_add_u32 s88, s88, s51
    s_mul_i32 s54, s88, 171
    s_lshr_b32 s54, s54, 10
    s_add_u32 s57, s57, 27648
    buffer_load_dwordx4 v11, s[16:19], s57 offen offset:1024 lds
    s_waitcnt vmcnt(10)
    ds_read_b64_tr_b16 a[16:17], v2 offset:16384
    ds_read_b64_tr_b16 a[18:19], v2 offset:16896
    ds_read_b64_tr_b16 a[20:21], v3 offset:16384
    ds_read_b64_tr_b16 a[22:23], v3 offset:16896
    s_mul_i32 s54, s54, 6
    s_sub_u32 s88, s88, s54
    s_add_u32 s54, s88, 24
    s_mul_i32 s84, s54, 66816
    ds_read_b64_tr_b16 a[24:25], v2 offset:16640
    ds_read_b64_tr_b16 a[26:27], v2 offset:17152
    ds_read_b64_tr_b16 a[28:29], v3 offset:16640
    ds_read_b64_tr_b16 a[30:31], v3 offset:17152
    s_add_u32 s57, s57, 27648
    buffer_load_dwordx4 v10, s[16:19], s57 offen offset:2048 lds
    s_lshl2_add_u32 s84, s52, s84
    s_mul_i32 s83, s54, 58624
    s_add_u32 s83, s83, s53
    s_and_b32 s54, s44, 1
    s_add_u32 s57, s57, 27648
    buffer_load_dwordx4 v11, s[16:19], s57 offen offset:3072 lds
    s_lshl_b32 s54, s54, 10
    s_add_u32 s83, s83, s54
    s_add_u32 s83, s83, 2097152
    s_lshl1_add_u32 s54, s54, 49152
    s_add_u32 m0, s52, 131072
    s_add_u32 s57, s65, 5
    s_and_b32 s57, s57, 15
    s_mul_i32 s57, s57, 114688
    buffer_load_dwordx4 v10, s[16:19], s57 offen offset:0 lds
    v_add_u32 v243, s54, v23
    s_cmp_lt_u32 s88, 4
    s_cselect_b32 s84, s84, 2130706432
    s_cselect_b32 s83, s83, 2130706432
    s_cmp_lt_u32 s44, 2
    s_cselect_b32 s83, s83, 2130706432
    s_cmp_eq_u32 s44, 0
    s_cselect_b32 s85, 1.0, 0
    s_mul_i32 s53, s45, 7
    s_lshr_b32 s53, s53, 1
    s_sub_u32 s53, s50, s53
    s_lshl1_add_u32 s53, s53, s88
    s_sub_u32 s53, s53, 4
    s_mul_i32 s54, s44, 28
    s_add_u32 s54, s54, s53
    s_lshl_b32 s87, s54, 16
    s_lshl_b32 s54, s45, 9
    s_add_u32 s87, s87, s54
    s_cmp_ge_u32 s88, 4
    s_cselect_b32 s87, s87, 2130706432
    v_lshrrev_b32 v254, 2, v1
    v_lshlrev_b32 v254, 12, v254
    v_lshl_add_u32 v254, v210, 7, v254
    s_add_u32 s57, s57, 27648
    buffer_load_dwordx4 v11, s[16:19], s57 offen offset:1024 lds
    s_waitcnt vmcnt(10)
    ds_read_b64_tr_b16 a[32:33], v2 offset:32768
    ds_read_b64_tr_b16 a[34:35], v2 offset:33280
    ds_read_b64_tr_b16 a[36:37], v3 offset:32768
    ds_read_b64_tr_b16 a[38:39], v3 offset:33280
    s_add_u32 s57, s57, 27648
    buffer_load_dwordx4 v10, s[16:19], s57 offen offset:2048 lds
    ds_read_b64_tr_b16 a[40:41], v2 offset:33024
    ds_read_b64_tr_b16 a[42:43], v2 offset:33536
    ds_read_b64_tr_b16 a[44:45], v3 offset:33024
    ds_read_b64_tr_b16 a[46:47], v3 offset:33536
    s_add_u32 s57, s57, 27648
    buffer_load_dwordx4 v11, s[16:19], s57 offen offset:3072 lds
    s_lshr_b32 s53, s46, 2
    s_and_b32 s89, s46, 3
    s_bfe_u32 s54, s46, 0x20001
    s_and_b32 s55, s46, 1
    s_add_u32 s55, s55, 4
    s_cmp_lt_u32 s46, 16
    s_cselect_b32 s53, s53, s54
    s_cselect_b32 s89, s89, s55
    s_mul_i32 s49, s53, 2
    s_add_u32 s49, s49, s89
    s_sub_u32 s54, s49, 6
    s_min_u32 s49, s49, s54
    s_add_u32 m0, s52, 147456
    s_add_u32 s57, s65, 6
    s_and_b32 s57, s57, 15
    s_mul_i32 s57, s57, 114688
    buffer_load_dwordx4 v10, s[16:19], s57 offen offset:0 lds
    s_lshl2_add_u32 s48, s45, s53
    s_mul_i32 s53, s44, 1835008
    s_lshl_b32 s74, s48, 7
    s_add_u32 s53, s53, s74
    s_add_u32 s57, s57, 27648
    buffer_load_dwordx4 v11, s[16:19], s57 offen offset:1024 lds
    s_waitcnt vmcnt(10)
    ds_read_b64_tr_b16 a[48:49], v2 offset:49152
    ds_read_b64_tr_b16 a[50:51], v2 offset:49664
    ds_read_b64_tr_b16 a[52:53], v3 offset:49152
    ds_read_b64_tr_b16 a[54:55], v3 offset:49664
    s_add_u32 s57, s57, 27648
    buffer_load_dwordx4 v10, s[16:19], s57 offen offset:2048 lds
    ds_read_b64_tr_b16 a[56:57], v2 offset:49408
    ds_read_b64_tr_b16 a[58:59], v2 offset:49920
    ds_read_b64_tr_b16 a[60:61], v3 offset:49408
    ds_read_b64_tr_b16 a[62:63], v3 offset:49920
    v_lshlrev_b32 v217, 5, v212
    v_xor_b32 v217, v217, v214
    v_lshlrev_b32 v12, 12, v213
    v_add3_u32 v12, v12, v217, s53
    s_add_u32 s57, s57, 27648
    buffer_load_dwordx4 v11, s[16:19], s57 offen offset:3072 lds
    s_mul_i32 s53, s44, 100352
    s_lshl_b32 s54, s49, 7
    s_add_u32 s55, s53, s54
    s_lshl_b32 s56, s44, 5
    s_waitcnt lgkmcnt(15)
    s_add_u32 m0, s52, 49152
    s_add_u32 s57, s65, 7
    s_and_b32 s57, s57, 15
    s_mul_i32 s57, s57, 114688
    buffer_load_dwordx4 v10, s[16:19], s57 offen offset:0 lds
    v_xor_b32 v217, s56, v214
    v_mul_u32_u24 v13, 896, v213
    v_add3_u32 v13, v13, v217, s55
    v_xor_b32 v14, 32, v13
    s_add_u32 s57, s57, 27648
    buffer_load_dwordx4 v11, s[16:19], s57 offen offset:1024 lds
    s_waitcnt vmcnt(10)
    ds_read_b64_tr_b16 a[64:65], v4 offset:0
    ds_read_b64_tr_b16 a[66:67], v4 offset:512
    ds_read_b64_tr_b16 a[68:69], v5 offset:0
    ds_read_b64_tr_b16 a[70:71], v5 offset:512
    s_mul_i32 s73, s48, 57344
    s_add_u32 s71, s73, s54
    s_add_u32 s72, s71, 28672
    v_lshrrev_b32 v217, 1, v1
    ds_read_b64_tr_b16 a[72:73], v4 offset:256
    ds_read_b64_tr_b16 a[74:75], v4 offset:768
    ds_read_b64_tr_b16 a[76:77], v5 offset:256
    ds_read_b64_tr_b16 a[78:79], v5 offset:768
    s_add_u32 s57, s57, 27648
    buffer_load_dwordx4 v10, s[16:19], s57 offen offset:2048 lds
    v_mul_u32_u24 v15, 896, v217
    v_and_b32 v217, 1, v1
    v_lshl_add_u32 v15, v217, 4, v15
    v_add_u32 v15, s53, v15
    s_add_u32 s57, s57, 27648
    buffer_load_dwordx4 v11, s[16:19], s57 offen offset:3072 lds
    s_lshl_b32 s54, s89, 5
    s_add_u32 s54, s54, 768
    s_add_u32 s68, s89, 24
    s_mul_i32 s68, s68, 58624
    s_add_u32 m0, s52, 65536
    s_add_u32 s57, s65, 8
    s_and_b32 s57, s57, 15
    s_mul_i32 s57, s57, 114688
    buffer_load_dwordx4 v10, s[16:19], s57 offen offset:0 lds
    s_mul_i32 s69, s44, 14336
    s_add_u32 s69, s69, 2097152
    s_add_u32 s68, s68, s69
    s_add_u32 s73, s73, s54
    s_mov_b32 s76, 0
    s_add_u32 s77, s76, 2048
    s_cmp_eq_u32 s77, 14336
    s_cselect_b32 s77, 0, s77
    s_add_u32 s78, s77, 2048
    s_cmp_eq_u32 s78, 14336
    s_cselect_b32 s78, 0, s78
    s_add_u32 s79, s78, 2048
    s_cmp_eq_u32 s79, 14336
    s_cselect_b32 s79, 0, s79
    s_add_u32 s80, s79, 2048
    s_cmp_eq_u32 s80, 14336
    s_cselect_b32 s80, 0, s80
    s_add_u32 s81, s80, 2048
    s_cmp_eq_u32 s81, 14336
    s_cselect_b32 s81, 0, s81
    s_add_u32 s82, s81, 2048
    s_cmp_eq_u32 s82, 14336
    s_cselect_b32 s82, 0, s82
    s_add_u32 s57, s57, 27648
    buffer_load_dwordx4 v11, s[16:19], s57 offen offset:1024 lds
    s_waitcnt vmcnt(10)
    ds_read_b64_tr_b16 a[80:81], v4 offset:16384
    ds_read_b64_tr_b16 a[82:83], v4 offset:16896
    ds_read_b64_tr_b16 a[84:85], v5 offset:16384
    ds_read_b64_tr_b16 a[86:87], v5 offset:16896
    s_add_u32 s57, s57, 27648
    buffer_load_dwordx4 v10, s[16:19], s57 offen offset:2048 lds
    ds_read_b64_tr_b16 a[88:89], v4 offset:16640
    ds_read_b64_tr_b16 a[90:91], v4 offset:17152
    ds_read_b64_tr_b16 a[92:93], v5 offset:16640
    ds_read_b64_tr_b16 a[94:95], v5 offset:17152
    s_add_u32 s57, s57, 27648
    buffer_load_dwordx4 v11, s[16:19], s57 offen offset:3072 lds
    s_cmp_lt_u32 s89, 4
    s_cselect_b32 s75, s54, 2130706432
    s_cselect_b32 s68, s68, 2130706432
    s_cselect_b32 s73, s73, 2130706432
    v_lshl_add_u32 v217, v208, 3, v209
    v_lshlrev_b32 v16, 5, v217
    v_lshl_add_u32 v16, v210, 3, v16
    v_add_u32 v16, s52, v16
    s_waitcnt lgkmcnt(15)
    s_add_u32 m0, s52, 81920
    s_add_u32 s57, s65, 9
    s_and_b32 s57, s57, 15
    s_mul_i32 s57, s57, 114688
    buffer_load_dwordx4 v10, s[16:19], s57 offen offset:0 lds
    v_and_b32 v217, 7, v1
    v_min_u32 v218, 6, v217
    s_mul_i32 s54, s44, 7
    v_add_u32 v218, s54, v218
    s_add_u32 s57, s57, 27648
    buffer_load_dwordx4 v11, s[16:19], s57 offen offset:1024 lds
    s_waitcnt vmcnt(10)
    ds_read_b64_tr_b16 a[96:97], v4 offset:32768
    ds_read_b64_tr_b16 a[98:99], v4 offset:33280
    ds_read_b64_tr_b16 a[100:101], v5 offset:32768
    ds_read_b64_tr_b16 a[102:103], v5 offset:33280
    s_add_u32 s57, s57, 27648
    buffer_load_dwordx4 v10, s[16:19], s57 offen offset:2048 lds
    ds_read_b64_tr_b16 a[104:105], v4 offset:33024
    ds_read_b64_tr_b16 a[106:107], v4 offset:33536
    ds_read_b64_tr_b16 a[108:109], v5 offset:33024
    ds_read_b64_tr_b16 a[110:111], v5 offset:33536
    v_mul_u32_u24 v219, 2, v218
    v_add_u32 v219, s89, v219
    v_mul_u32_u24 v220, 43, v219
    v_lshrrev_b32 v220, 8, v220
    s_add_u32 s57, s57, 27648
    buffer_load_dwordx4 v11, s[16:19], s57 offen offset:3072 lds
    v_mul_u32_u24 v220, 6, v220
    v_sub_u32 v219, v219, v220
    v_subrev_u32 v219, s49, v219
    v_bfe_u32 v220, v1, 3, 1
    buffer_load_dwordx2 v[224:225], v19, s[32:35], 0 offen offset:0
    v_mul_i32_i24 v219, v219, v220
    v_add_u32 v219, s49, v219
    v_lshl_add_u32 v218, v219, 5, v218
    v_lshlrev_b32 v20, 7, v218
    buffer_load_dwordx2 v[226:227], v19, s[32:35], 0 offen offset:32
    s_waitcnt vmcnt(10)
    ds_read_b64_tr_b16 a[112:113], v2 offset:0
    ds_read_b64_tr_b16 a[114:115], v2 offset:512
    ds_read_b64_tr_b16 a[116:117], v3 offset:0
    ds_read_b64_tr_b16 a[118:119], v3 offset:512
    buffer_load_dwordx2 v[228:229], v19, s[32:35], 0 offen offset:64
    ds_read_b64_tr_b16 a[120:121], v2 offset:256
    ds_read_b64_tr_b16 a[122:123], v2 offset:768
    ds_read_b64_tr_b16 a[124:125], v3 offset:256
    ds_read_b64_tr_b16 a[126:127], v3 offset:768
    buffer_load_dwordx2 v[230:231], v19, s[32:35], 0 offen offset:96
    v_add_u32 v20, 12713984, v20
    s_lshr_b32 s53, s48, 1
    s_lshl4_add_u32 s53, s44, s53
    s_lshl_b32 s53, s53, 7
    s_add_u32 m0, s52, 98304
    s_add_u32 s57, s65, 10
    s_and_b32 s57, s57, 15
    s_mul_i32 s57, s57, 114688
    buffer_load_dwordx4 v10, s[16:19], s57 offen offset:0 lds
    s_add_u32 s53, s53, 12779520
    v_mov_b32 v21, s53
    s_lshl_b32 s70, s48, 16
    s_add_u32 s70, s70, s52
    s_add_u32 s70, s70, 4194304
    v_lshrrev_b32 v218, 3, v0
    v_mul_u32_u24 v22, 896, v218
    v_lshl_add_u32 v22, v217, 4, v22
    s_add_u32 s57, s57, 27648
    buffer_load_dwordx4 v11, s[16:19], s57 offen offset:1024 lds
    s_waitcnt vmcnt(10)
    ds_read_b64_tr_b16 a[128:129], v2 offset:16384
    ds_read_b64_tr_b16 a[130:131], v2 offset:16896
    ds_read_b64_tr_b16 a[132:133], v3 offset:16384
    ds_read_b64_tr_b16 a[134:135], v3 offset:16896
    s_add_u32 s57, s57, 27648
    buffer_load_dwordx4 v10, s[16:19], s57 offen offset:2048 lds
    ds_read_b64_tr_b16 a[136:137], v2 offset:16640
    ds_read_b64_tr_b16 a[138:139], v2 offset:17152
    ds_read_b64_tr_b16 a[140:141], v3 offset:16640
    ds_read_b64_tr_b16 a[142:143], v3 offset:17152
    s_add_u32 s57, s57, 27648
    buffer_load_dwordx4 v11, s[16:19], s57 offen offset:3072 lds
    v_lshlrev_b32 v25, 1, v218
    v_lshrrev_b32 v219, 4, v218
    v_lshlrev_b32 v244, 14, v219
    v_lshrrev_b32 v219, 1, v217
    v_lshl_add_u32 v244, v219, 12, v244
    v_and_b32 v219, 15, v218
    v_lshl_add_u32 v244, v219, 8, v244
    v_bfe_u32 v219, v218, 1, 1
    s_waitcnt lgkmcnt(15)
    s_add_u32 m0, s52, 114688
    s_add_u32 s57, s65, 11
    s_and_b32 s57, s57, 15
    s_mul_i32 s57, s57, 114688
    buffer_load_dwordx4 v10, s[16:19], s57 offen offset:0 lds
    v_lshl_add_u32 v244, v219, 7, v244
    v_and_b32 v219, 7, v218
    v_xor_b32 v219, v219, v217
    v_lshl_add_u32 v244, v219, 4, v244
    s_add_u32 s57, s57, 27648
    buffer_load_dwordx4 v11, s[16:19], s57 offen offset:1024 lds
    s_waitcnt vmcnt(10)
    ds_read_b64_tr_b16 a[144:145], v2 offset:32768
    ds_read_b64_tr_b16 a[146:147], v2 offset:33280
    ds_read_b64_tr_b16 a[148:149], v3 offset:32768
    ds_read_b64_tr_b16 a[150:151], v3 offset:33280
    s_add_u32 s57, s57, 27648
    buffer_load_dwordx4 v10, s[16:19], s57 offen offset:2048 lds
    ds_read_b64_tr_b16 a[152:153], v2 offset:33024
    ds_read_b64_tr_b16 a[154:155], v2 offset:33536
    ds_read_b64_tr_b16 a[156:157], v3 offset:33024
    ds_read_b64_tr_b16 a[158:159], v3 offset:33536
    v_xor_b32 v245, 128, v244
    v_xor_b32 v246, 4096, v244
    v_xor_b32 v247, 4224, v244
    v_xor_b32 v248, 8192, v244
    s_add_u32 s57, s57, 27648
    buffer_load_dwordx4 v11, s[16:19], s57 offen offset:3072 lds
    v_xor_b32 v249, 8320, v244
    v_xor_b32 v250, 12288, v244
    v_xor_b32 v251, 12416, v244
    v_lshrrev_b32 v218, 2, v0
    s_add_u32 m0, s52, 131072
    s_add_u32 s57, s65, 12
    s_and_b32 s57, s57, 15
    s_mul_i32 s57, s57, 114688
    buffer_load_dwordx4 v10, s[16:19], s57 offen offset:0 lds
    v_mul_u32_u24 v26, 896, v218
    v_lshl_add_u32 v26, v210, 3, v26
    v_lshlrev_b32 v27, 1, v218
    v_bfe_u32 v219, v218, 1, 2
    s_add_u32 s57, s57, 27648
    buffer_load_dwordx4 v11, s[16:19], s57 offen offset:1024 lds
    v_xor_b32 v219, v219, v210
    v_lshlrev_b32 v252, 6, v218
    v_lshl_add_u32 v252, v219, 4, v252
    v_add_u32 v252, 65536, v252
    v_bfe_u32 v219, v1, 1, 2
    v_xor_b32 v219, v219, v208
    v_lshlrev_b32 v242, 6, v211
    v_lshl_add_u32 v242, v219, 4, v242
    s_add_u32 s57, s57, 27648
    buffer_load_dwordx4 v10, s[16:19], s57 offen offset:2048 lds
    s_add_u32 s53, s52, 65536
    v_add_u32 v242, s53, v242
    v_xor_b32 v218, v217, v212
    v_lshlrev_b32 v238, 4, v218
    s_add_u32 s57, s57, 27648
    buffer_load_dwordx4 v11, s[16:19], s57 offen offset:3072 lds
    v_xor_b32 v238, s56, v238
    v_bfe_u32 v219, v1, 1, 1
    v_xor_b32 v219, v219, v215
    v_lshl_add_u32 v238, v219, 7, v238
    buffer_load_dword v17, v18, s[24:27], 0 offen sc1
    v_lshl_add_u32 v238, v211, 8, v238
    v_add_u32 v238, s52, v238
    v_xor_b32 v239, 32, v238
    v_xor_b32 v240, 64, v238
    v_xor_b32 v241, 96, v238
    s_waitcnt vmcnt(13)
    v_lshlrev_b32 v32, 16, v224
    v_and_b32 v33, s61, v224
    v_lshlrev_b32 v34, 16, v225
    v_and_b32 v35, s61, v225
    s_add_u32 m0, s52, 147456
    s_add_u32 s57, s65, 13
    s_and_b32 s57, s57, 15
    s_mul_i32 s57, s57, 114688
    buffer_load_dwordx4 v10, s[16:19], s57 offen offset:0 lds
    s_waitcnt vmcnt(10)
    ds_read_b64_tr_b16 a[160:161], v2 offset:49152
    ds_read_b64_tr_b16 a[162:163], v2 offset:49664
    ds_read_b64_tr_b16 a[164:165], v3 offset:49152
    ds_read_b64_tr_b16 a[166:167], v3 offset:49664
    s_add_u32 s57, s57, 27648
    buffer_load_dwordx4 v11, s[16:19], s57 offen offset:1024 lds
    ds_read_b64_tr_b16 a[168:169], v2 offset:49408
    ds_read_b64_tr_b16 a[170:171], v2 offset:49920
    ds_read_b64_tr_b16 a[172:173], v3 offset:49408
    ds_read_b64_tr_b16 a[174:175], v3 offset:49920
    v_lshlrev_b32 v36, 16, v226
    v_and_b32 v37, s61, v226
    v_lshlrev_b32 v38, 16, v227
    v_and_b32 v39, s61, v227
    s_add_u32 s57, s57, 27648
    buffer_load_dwordx4 v10, s[16:19], s57 offen offset:2048 lds
    v_lshlrev_b32 v40, 16, v228
    v_and_b32 v41, s61, v228
    v_lshlrev_b32 v42, 16, v229
    v_and_b32 v43, s61, v229
    s_add_u32 s57, s57, 27648
    buffer_load_dwordx4 v11, s[16:19], s57 offen offset:3072 lds
    v_lshlrev_b32 v44, 16, v230
    v_and_b32 v45, s61, v230
    v_lshlrev_b32 v46, 16, v231
    v_and_b32 v47, s61, v231
    s_waitcnt lgkmcnt(15)
    s_add_u32 m0, s52, 49152
    s_add_u32 s57, s65, 14
    s_and_b32 s57, s57, 15
    s_mul_i32 s57, s57, 114688
    buffer_load_dwordx4 v10, s[16:19], s57 offen offset:0 lds
    s_waitcnt vmcnt(10)
    ds_read_b64_tr_b16 a[176:177], v4 offset:0
    ds_read_b64_tr_b16 a[178:179], v4 offset:512
    ds_read_b64_tr_b16 a[180:181], v5 offset:0
    ds_read_b64_tr_b16 a[182:183], v5 offset:512
    v_mul_f32 v96, s85, v32
    v_mul_f32 v97, s85, v33
    v_mul_f32 v98, s85, v34
    v_mul_f32 v99, s85, v35
    ds_read_b64_tr_b16 a[184:185], v4 offset:256
    ds_read_b64_tr_b16 a[186:187], v4 offset:768
    ds_read_b64_tr_b16 a[188:189], v5 offset:256
    ds_read_b64_tr_b16 a[190:191], v5 offset:768
    s_add_u32 s57, s57, 27648
    buffer_load_dwordx4 v11, s[16:19], s57 offen offset:1024 lds
    v_mul_f32 v100, s85, v36
    v_mul_f32 v101, s85, v37
    v_mul_f32 v102, s85, v38
    v_mul_f32 v103, s85, v39
    s_add_u32 s57, s57, 27648
    buffer_load_dwordx4 v10, s[16:19], s57 offen offset:2048 lds
    v_mul_f32 v104, s85, v40
    v_mul_f32 v105, s85, v41
    v_mul_f32 v106, s85, v42
    v_mul_f32 v107, s85, v43
    s_add_u32 s57, s57, 27648
    buffer_load_dwordx4 v11, s[16:19], s57 offen offset:3072 lds
    v_mul_f32 v108, s85, v44
    v_mul_f32 v109, s85, v45
    v_mul_f32 v110, s85, v46
    v_mul_f32 v111, s85, v47
    s_add_u32 m0, s52, 65536
    s_add_u32 s57, s65, 15
    s_and_b32 s57, s57, 15
    s_mul_i32 s57, s57, 114688
    buffer_load_dwordx4 v10, s[16:19], s57 offen offset:0 lds
    s_waitcnt vmcnt(10)
    ds_read_b64_tr_b16 a[192:193], v4 offset:16384
    ds_read_b64_tr_b16 a[194:195], v4 offset:16896
    ds_read_b64_tr_b16 a[196:197], v5 offset:16384
    ds_read_b64_tr_b16 a[198:199], v5 offset:16896
    s_add_u32 s57, s57, 27648
    buffer_load_dwordx4 v11, s[16:19], s57 offen offset:1024 lds
    ds_read_b64_tr_b16 a[200:201], v4 offset:16640
    ds_read_b64_tr_b16 a[202:203], v4 offset:17152
    ds_read_b64_tr_b16 a[204:205], v5 offset:16640
    ds_read_b64_tr_b16 a[206:207], v5 offset:17152
    s_waitcnt vmcnt(10)
    v_cmp_ne_u32 vcc, s47, v17
    s_nop 0
    s_cbranch_vccz L_ok5
    s_mov_b32 s59, 20000
L_spin4:
    s_sleep 2
    buffer_load_dword v17, v18, s[24:27], 0 offen sc1
    s_waitcnt vmcnt(0)
    v_cmp_ne_u32 vcc, s47, v17
    s_nop 0
    s_cbranch_vccz L_ok5
    s_sub_u32 s59, s59, 1
    s_cbranch_scc0 L_spin4
L_ok5:
    s_cmp_ge_u32 s88, 4
    s_cbranch_scc1 L_p2_alt
    s_add_u32 s57, s57, 27648
    buffer_load_dwordx4 v10, s[16:19], s57 offen offset:2048 lds
    s_add_u32 s57, s57, 27648
    buffer_load_dwordx4 v11, s[16:19], s57 offen offset:3072 lds
    s_mov_b32 s66, s84
    s_lshl_b32 s86, s65, 10
    s_add_u32 s58, s86, s66
    buffer_load_dwordx4 v[112:115], v23, s[24:27], s58 offen offset:0 sc1
    s_add_u32 s86, s86, 1024
    s_and_b32 s86, s86, 16383
    s_add_u32 s58, s86, s66
    buffer_load_dwordx4 v[116:119], v23, s[24:27], s58 offen offset:0 sc1
    s_waitcnt vmcnt(10)
    ds_read_b64_tr_b16 a[208:209], v4 offset:32768
    ds_read_b64_tr_b16 a[210:211], v4 offset:33280
    ds_read_b64_tr_b16 a[212:213], v5 offset:32768
    ds_read_b64_tr_b16 a[214:215], v5 offset:33280
    s_add_u32 s86, s86, 1024
    s_and_b32 s86, s86, 16383
    s_add_u32 s58, s86, s66
    buffer_load_dwordx4 v[120:123], v23, s[24:27], s58 offen offset:0 sc1
    ds_read_b64_tr_b16 a[216:217], v4 offset:33024
    ds_read_b64_tr_b16 a[218:219], v4 offset:33536
    ds_read_b64_tr_b16 a[220:221], v5 offset:33024
    ds_read_b64_tr_b16 a[222:223], v5 offset:33536
    s_add_u32 s86, s86, 1024
    s_and_b32 s86, s86, 16383
    s_add_u32 s58, s86, s66
    buffer_load_dwordx4 v[124:127], v23, s[24:27], s58 offen offset:0 sc1
    s_add_u32 s86, s86, 1024
    s_and_b32 s86, s86, 16383
    s_add_u32 s58, s86, s66
    buffer_load_dwordx4 v[128:131], v23, s[24:27], s58 offen offset:0 sc1
    s_add_u32 s86, s86, 1024
    s_and_b32 s86, s86, 16383
    s_add_u32 s58, s86, s66
    buffer_load_dwordx4 v[132:135], v23, s[24:27], s58 offen offset:0 sc1
    s_waitcnt vmcnt(10)
    ds_read_b64_tr_b16 a[224:225], v2 offset:0
    ds_read_b64_tr_b16 a[226:227], v2 offset:512
    ds_read_b64_tr_b16 a[228:229], v3 offset:0
    ds_read_b64_tr_b16 a[230:231], v3 offset:512
    s_add_u32 s86, s86, 1024
    s_and_b32 s86, s86, 16383
    s_add_u32 s58, s86, s66
    buffer_load_dwordx4 v[136:139], v23, s[24:27], s58 offen offset:0 sc1
    ds_read_b64_tr_b16 a[232:233], v2 offset:256
    ds_read_b64_tr_b16 a[234:235], v2 offset:768
    ds_read_b64_tr_b16 a[236:237], v3 offset:256
    ds_read_b64_tr_b16 a[238:239], v3 offset:768
    s_add_u32 s86, s86, 1024
    s_and_b32 s86, s86, 16383
    s_add_u32 s58, s86, s66
    buffer_load_dwordx4 v[140:143], v23, s[24:27], s58 offen offset:0 sc1
    s_add_u32 s86, s86, 1024
    s_and_b32 s86, s86, 16383
    s_add_u32 s58, s86, s66
    buffer_load_dwordx4 v[144:147], v23, s[24:27], s58 offen offset:0 sc1
    s_add_u32 s86, s86, 1024
    s_and_b32 s86, s86, 16383
    s_add_u32 s58, s86, s66
    buffer_load_dwordx4 v[148:151], v23, s[24:27], s58 offen offset:0 sc1
    s_waitcnt vmcnt(10)
    ds_read_b64_tr_b16 a[240:241], v2 offset:16384
    ds_read_b64_tr_b16 a[242:243], v2 offset:16896
    ds_read_b64_tr_b16 a[244:245], v3 offset:16384
    ds_read_b64_tr_b16 a[246:247], v3 offset:16896
    s_waitcnt vmcnt(9)
    v_mfma_f32_16x16x32_bf16 v[96:99], a[0:3], v[112:115], v[96:99]
    s_add_u32 s86, s86, 1024
    s_and_b32 s86, s86, 16383
    s_add_u32 s58, s86, s66
    v_mfma_f32_16x16x32_bf16 v[100:103], a[4:7], v[112:115], v[100:103]
    buffer_load_dwordx4 v[152:155], v23, s[24:27], s58 offen offset:0 sc1
    v_mfma_f32_16x16x32_bf16 v[104:107], a[8:11], v[112:115], v[104:107]
    v_mfma_f32_16x16x32_bf16 v[108:111], a[12:15], v[112:115], v[108:111]
    ds_read_b64_tr_b16 a[248:249], v2 offset:16640
    ds_read_b64_tr_b16 a[250:251], v2 offset:17152
    ds_read_b64_tr_b16 a[252:253], v3 offset:16640
    ds_read_b64_tr_b16 a[254:255], v3 offset:17152
    s_waitcnt vmcnt(9)
    v_mfma_f32_16x16x32_bf16 v[96:99], a[16:19], v[116:119], v[96:99]
    s_add_u32 s86, s86, 1024
    s_and_b32 s86, s86, 16383
    s_add_u32 s58, s86, s66
    v_mfma_f32_16x16x32_bf16 v[100:103], a[20:23], v[116:119], v[100:103]
    buffer_load_dwordx4 v[156:159], v23, s[24:27], s58 offen offset:0 sc1
    v_mfma_f32_16x16x32_bf16 v[104:107], a[24:27], v[116:119], v[104:107]
    v_mfma_f32_16x16x32_bf16 v[108:111], a[28:31], v[116:119], v[108:111]
    s_waitcnt vmcnt(9)
    v_mfma_f32_16x16x32_bf16 v[96:99], a[32:35], v[120:123], v[96:99]
    s_add_u32 s86, s86, 1024
    s_and_b32 s86, s86, 16383
    s_add_u32 s58, s86, s66
    v_mfma_f32_16x16x32_bf16 v[100:103], a[36:39], v[120:123], v[100:103]
    buffer_load_dwordx4 v[112:115], v23, s[24:27], s58 offen offset:0 sc1
    v_mfma_f32_16x16x32_bf16 v[104:107], a[40:43], v[120:123], v[104:107]
    v_mfma_f32_16x16x32_bf16 v[108:111], a[44:47], v[120:123], v[108:111]
    s_waitcnt vmcnt(9)
    v_mfma_f32_16x16x32_bf16 v[96:99], a[48:51], v[124:127], v[96:99]
    s_add_u32 s86, s86, 1024
    s_and_b32 s86, s86, 16383
    s_add_u32 s58, s86, s66
    v_mfma_f32_16x16x32_bf16 v[100:103], a[52:55], v[124:127], v[100:103]
    buffer_load_dwordx4 v[116:119], v23, s[24:27], s58 offen offset:0 sc1
    v_mfma_f32_16x16x32_bf16 v[104:107], a[56:59], v[124:127], v[104:107]
    v_mfma_f32_16x16x32_bf16 v[108:111], a[60:63], v[124:127], v[108:111]
    s_waitcnt vmcnt(9)
    v_mfma_f32_16x16x32_bf16 v[96:99], a[64:67], v[128:131], v[96:99]
    s_add_u32 s86, s86, 1024
    s_and_b32 s86, s86, 16383
    s_add_u32 s58, s86, s66
    v_mfma_f32_16x16x32_bf16 v[100:103], a[68:71], v[128:131], v[100:103]
    buffer_load_dwordx4 v[120:123], v23, s[24:27], s58 offen offset:0 sc1
    v_mfma_f32_16x16x32_bf16 v[104:107], a[72:75], v[128:131], v[104:107]
    v_mfma_f32_16x16x32_bf16 v[108:111], a[76:79], v[128:131], v[108:111]
    s_waitcnt vmcnt(9)
    v_mfma_f32_16x16x32_bf16 v[96:99], a[80:83], v[132:135], v[96:99]
    s_add_u32 s86, s86, 1024
    s_and_b32 s86, s86, 16383
    s_add_u32 s58, s86, s66
    v_mfma_f32_16x16x32_bf16 v[100:103], a[84:87], v[132:135], v[100:103]
    buffer_load_dwordx4 v[124:127], v23, s[24:27], s58 offen offset:0 sc1
    v_mfma_f32_16x16x32_bf16 v[104:107], a[88:91], v[132:135], v[104:107]
    v_mfma_f32_16x16x32_bf16 v[108:111], a[92:95], v[132:135], v[108:111]
    s_waitcnt vmcnt(9)
    v_mfma_f32_16x16x32_bf16 v[96:99], a[96:99], v[136:139], v[96:99]
    s_xor_b32 s66, s44, 3
    s_lshl2_add_u32 s66, s51, s66
    s_mul_i32 s66, s66, 66816
    s_lshl2_add_u32 s66, s52, s66
    s_lshl_b32 s86, s65, 10
    s_add_u32 s58, s86, s66
    v_mfma_f32_16x16x32_bf16 v[100:103], a[100:103], v[136:139], v[100:103]
    buffer_load_dwordx4 v[128:131], v23, s[24:27], s58 offen offset:0 sc1
    v_mfma_f32_16x16x32_bf16 v[104:107], a[104:107], v[136:139], v[104:107]
    v_mfma_f32_16x16x32_bf16 v[108:111], a[108:111], v[136:139], v[108:111]
    s_waitcnt vmcnt(9)
    v_mfma_f32_16x16x32_bf16 v[96:99], a[112:115], v[140:143], v[96:99]
    s_add_u32 s86, s86, 1024
    s_and_b32 s86, s86, 16383
    s_add_u32 s58, s86, s66
    v_mfma_f32_16x16x32_bf16 v[100:103], a[116:119], v[140:143], v[100:103]
    buffer_load_dwordx4 v[132:135], v23, s[24:27], s58 offen offset:0 sc1
    v_mfma_f32_16x16x32_bf16 v[104:107], a[120:123], v[140:143], v[104:107]
    v_mfma_f32_16x16x32_bf16 v[108:111], a[124:127], v[140:143], v[108:111]
    s_waitcnt vmcnt(9)
    v_mfma_f32_16x16x32_bf16 v[96:99], a[128:131], v[144:147], v[96:99]
    s_add_u32 s86, s86, 1024
    s_and_b32 s86, s86, 16383
    s_add_u32 s58, s86, s66
    v_mfma_f32_16x16x32_bf16 v[100:103], a[132:135], v[144:147], v[100:103]
    buffer_load_dwordx4 v[136:139], v23, s[24:27], s58 offen offset:0 sc1
    v_mfma_f32_16x16x32_bf16 v[104:107], a[136:139], v[144:147], v[104:107]
    v_mfma_f32_16x16x32_bf16 v[108:111], a[140:143], v[144:147], v[108:111]
    s_waitcnt vmcnt(9)
    s_waitcnt lgkmcnt(15)
    v_mfma_f32_16x16x32_bf16 v[96:99], a[144:147], v[148:151], v[96:99]
    s_add_u32 s86, s86, 1024
    s_and_b32 s86, s86, 16383
    s_add_u32 s58, s86, s66
    v_mfma_f32_16x16x32_bf16 v[100:103], a[148:151], v[148:151], v[100:103]
    buffer_load_dwordx4 v[140:143], v23, s[24:27], s58 offen offset:0 sc1
    v_mfma_f32_16x16x32_bf16 v[104:107], a[152:155], v[148:151], v[104:107]
    v_mfma_f32_16x16x32_bf16 v[108:111], a[156:159], v[148:151], v[108:111]
    s_waitcnt vmcnt(9)
    v_mfma_f32_16x16x32_bf16 v[96:99], a[160:163], v[152:155], v[96:99]
    s_add_u32 s86, s86, 1024
    s_and_b32 s86, s86, 16383
    s_add_u32 s58, s86, s66
    v_mfma_f32_16x16x32_bf16 v[100:103], a[164:167], v[152:155], v[100:103]
    buffer_load_dwordx4 v[144:147], v23, s[24:27], s58 offen offset:0 sc1
    v_mfma_f32_16x16x32_bf16 v[104:107], a[168:171], v[152:155], v[104:107]
    v_mfma_f32_16x16x32_bf16 v[108:111], a[172:175], v[152:155], v[108:111]
    s_waitcnt vmcnt(9)
    v_mfma_f32_16x16x32_bf16 v[96:99], a[176:179], v[156:159], v[96:99]
    s_add_u32 s86, s86, 1024
    s_and_b32 s86, s86, 16383
    s_add_u32 s58, s86, s66
    v_mfma_f32_16x16x32_bf16 v[100:103], a[180:183], v[156:159], v[100:103]
    buffer_load_dwordx4 v[148:151], v23, s[24:27], s58 offen offset:0 sc1
    v_mfma_f32_16x16x32_bf16 v[104:107], a[184:187], v[156:159], v[104:107]
    v_mfma_f32_16x16x32_bf16 v[108:111], a[188:191], v[156:159], v[108:111]
    s_waitcnt vmcnt(9)
    v_mfma_f32_16x16x32_bf16 v[96:99], a[192:195], v[112:115], v[96:99]
    s_add_u32 s86, s86, 1024
    s_and_b32 s86, s86, 16383
    s_add_u32 s58, s86, s66
    v_mfma_f32_16x16x32_bf16 v[100:103], a[196:199], v[112:115], v[100:103]
    buffer_load_dwordx4 v[152:155], v23, s[24:27], s58 offen offset:0 sc1
    v_mfma_f32_16x16x32_bf16 v[104:107], a[200:203], v[112:115], v[104:107]
    v_mfma_f32_16x16x32_bf16 v[108:111], a[204:207], v[112:115], v[108:111]
    s_waitcnt vmcnt(9)
    v_mfma_f32_16x16x32_bf16 v[96:99], a[208:211], v[116:119], v[96:99]
    s_add_u32 s86, s86, 1024
    s_and_b32 s86, s86, 16383
    s_add_u32 s58, s86, s66
    v_mfma_f32_16x16x32_bf16 v[100:103], a[212:215], v[116:119], v[100:103]
    buffer_load_dwordx4 v[156:159], v23, s[24:27], s58 offen offset:0 sc1
    v_mfma_f32_16x16x32_bf16 v[104:107], a[216:219], v[116:119], v[104:107]
    v_mfma_f32_16x16x32_bf16 v[108:111], a[220:223], v[116:119], v[108:111]
    s_waitcnt vmcnt(9)
    s_waitcnt lgkmcnt(8)
    v_mfma_f32_16x16x32_bf16 v[96:99], a[224:227], v[120:123], v[96:99]
    s_add_u32 s86, s86, 1024
    s_and_b32 s86, s86, 16383
    s_add_u32 s58, s86, s66
    v_mfma_f32_16x16x32_bf16 v[100:103], a[228:231], v[120:123], v[100:103]
    buffer_load_dwordx4 v[112:115], v23, s[24:27], s58 offen offset:0 sc1
    v_mfma_f32_16x16x32_bf16 v[104:107], a[232:235], v[120:123], v[104:107]
    v_mfma_f32_16x16x32_bf16 v[108:111], a[236:239], v[120:123], v[108:111]
    s_waitcnt vmcnt(9)
    s_waitcnt lgkmcnt(0)
    v_mfma_f32_16x16x32_bf16 v[96:99], a[240:243], v[124:127], v[96:99]
    s_add_u32 s86, s86, 1024
    s_and_b32 s86, s86, 16383
    s_add_u32 s58, s86, s66
    v_mfma_f32_16x16x32_bf16 v[100:103], a[244:247], v[124:127], v[100:103]
    buffer_load_dwordx4 v[116:119], v23, s[24:27], s58 offen offset:0 sc1
    v_mfma_f32_16x16x32_bf16 v[104:107], a[248:251], v[124:127], v[104:107]
    v_mfma_f32_16x16x32_bf16 v[108:111], a[252:255], v[124:127], v[108:111]
L_p2_join:
    s_waitcnt vmcnt(9)
    v_mfma_f32_16x16x32_bf16 v[80:83], a[0:3], v[128:131], 0
    s_add_u32 s86, s86, 1024
    s_and_b32 s86, s86, 16383
    s_add_u32 s58, s86, s66
    v_mfma_f32_16x16x32_bf16 v[84:87], a[4:7], v[128:131], 0
    buffer_load_dwordx4 v[120:123], v23, s[24:27], s58 offen offset:0 sc1
    v_mfma_f32_16x16x32_bf16 v[88:91], a[8:11], v[128:131], 0
    v_mfma_f32_16x16x32_bf16 v[92:95], a[12:15], v[128:131], 0
    s_waitcnt vmcnt(9)
    v_mfma_f32_16x16x32_bf16 v[80:83], a[16:19], v[132:135], v[80:83]
    s_add_u32 s86, s86, 1024
    s_and_b32 s86, s86, 16383
    s_add_u32 s58, s86, s66
    v_mfma_f32_16x16x32_bf16 v[84:87], a[20:23], v[132:135], v[84:87]
    buffer_load_dwordx4 v[124:127], v23, s[24:27], s58 offen offset:0 sc1
    v_mfma_f32_16x16x32_bf16 v[88:91], a[24:27], v[132:135], v[88:91]
    ds_write_b128 v232, v[96:99] offset:49152
    v_mfma_f32_16x16x32_bf16 v[92:95], a[28:31], v[132:135], v[92:95]
    s_waitcnt vmcnt(9)
    v_mfma_f32_16x16x32_bf16 v[80:83], a[32:35], v[136:139], v[80:83]
    s_add_u32 s86, s86, 1024
    s_and_b32 s86, s86, 16383
    s_add_u32 s58, s86, s66
    v_mfma_f32_16x16x32_bf16 v[84:87], a[36:39], v[136:139], v[84:87]
    buffer_load_dwordx4 v[128:131], v23, s[24:27], s58 offen offset:0 sc1
    v_mfma_f32_16x16x32_bf16 v[88:91], a[40:43], v[136:139], v[88:91]
    ds_write_b128 v232, v[100:103] offset:50176
    v_mfma_f32_16x16x32_bf16 v[92:95], a[44:47], v[136:139], v[92:95]
    s_waitcnt vmcnt(9)
    v_mfma_f32_16x16x32_bf16 v[80:83], a[48:51], v[140:143], v[80:83]
    s_add_u32 s86, s86, 1024
    s_and_b32 s86, s86, 16383
    s_add_u32 s58, s86, s66
    v_mfma_f32_16x16x32_bf16 v[84:87], a[52:55], v[140:143], v[84:87]
    buffer_load_dwordx4 v[132:135], v23, s[24:27], s58 offen offset:0 sc1
    v_mfma_f32_16x16x32_bf16 v[88:91], a[56:59], v[140:143], v[88:91]
    ds_write_b128 v232, v[104:107] offset:51200
    v_mfma_f32_16x16x32_bf16 v[92:95], a[60:63], v[140:143], v[92:95]
    s_waitcnt vmcnt(9)
    v_mfma_f32_16x16x32_bf16 v[80:83], a[64:67], v[144:147], v[80:83]
    s_add_u32 s86, s86, 1024
    s_and_b32 s86, s86, 16383
    s_add_u32 s58, s86, s66
    v_mfma_f32_16x16x32_bf16 v[84:87], a[68:71], v[144:147], v[84:87]
    buffer_load_dwordx4 v[136:139], v23, s[24:27], s58 offen offset:0 sc1
    v_mfma_f32_16x16x32_bf16 v[88:91], a[72:75], v[144:147], v[88:91]
    ds_write_b128 v232, v[108:111] offset:52224
    v_mfma_f32_16x16x32_bf16 v[92:95], a[76:79], v[144:147], v[92:95]
    s_waitcnt vmcnt(9)
    v_mfma_f32_16x16x32_bf16 v[80:83], a[80:83], v[148:151], v[80:83]
    s_add_u32 s86, s86, 1024
    s_and_b32 s86, s86, 16383
    s_add_u32 s58, s86, s66
    v_mfma_f32_16x16x32_bf16 v[84:87], a[84:87], v[148:151], v[84:87]
    buffer_load_dwordx4 v[140:143], v23, s[24:27], s58 offen offset:0 sc1
    v_mfma_f32_16x16x32_bf16 v[88:91], a[88:91], v[148:151], v[88:91]
    v_mfma_f32_16x16x32_bf16 v[92:95], a[92:95], v[148:151], v[92:95]
    s_waitcnt vmcnt(9)
    v_mfma_f32_16x16x32_bf16 v[80:83], a[96:99], v[152:155], v[80:83]
    s_xor_b32 s66, s44, 2
    s_lshl2_add_u32 s66, s51, s66
    s_mul_i32 s66, s66, 66816
    s_lshl2_add_u32 s66, s52, s66
    s_lshl_b32 s86, s65, 10
    s_add_u32 s58, s86, s66
    v_mfma_f32_16x16x32_bf16 v[84:87], a[100:103], v[152:155], v[84:87]
    buffer_load_dwordx4 v[144:147], v23, s[24:27], s58 offen offset:0 sc1
    v_mfma_f32_16x16x32_bf16 v[88:91], a[104:107], v[152:155], v[88:91]
    v_mfma_f32_16x16x32_bf16 v[92:95], a[108:111], v[152:155], v[92:95]
    s_waitcnt vmcnt(9)
    v_mfma_f32_16x16x32_bf16 v[80:83], a[112:115], v[156:159], v[80:83]
    s_add_u32 s86, s86, 1024
    s_and_b32 s86, s86, 16383
    s_add_u32 s58, s86, s66
    v_mfma_f32_16x16x32_bf16 v[84:87], a[116:119], v[156:159], v[84:87]
    buffer_load_dwordx4 v[148:151], v23, s[24:27], s58 offen offset:0 sc1
    v_mfma_f32_16x16x32_bf16 v[88:91], a[120:123], v[156:159], v[88:91]
    s_waitcnt lgkmcnt(0)
    s_barrier
    v_mfma_f32_16x16x32_bf16 v[92:95], a[124:127], v[156:159], v[92:95]
    s_waitcnt vmcnt(9)
    v_mfma_f32_16x16x32_bf16 v[80:83], a[128:131], v[112:115], v[80:83]
    s_add_u32 s86, s86, 1024
    s_and_b32 s86, s86, 16383
    s_add_u32 s58, s86, s66
    v_mfma_f32_16x16x32_bf16 v[84:87], a[132:135], v[112:115], v[84:87]
    buffer_load_dwordx4 v[152:155], v23, s[24:27], s58 offen offset:0 sc1
    v_mfma_f32_16x16x32_bf16 v[88:91], a[136:139], v[112:115], v[88:91]
    ds_read_b128 v[160:163], v243 offset:0
    ds_read_b128 v[164:167], v243 offset:1024
    v_mfma_f32_16x16x32_bf16 v[92:95], a[140:143], v[112:115], v[92:95]
    ds_read_b128 v[168:171], v243 offset:4096
    s_waitcnt vmcnt(9)
    v_mfma_f32_16x16x32_bf16 v[80:83], a[144:147], v[116:119], v[80:83]
    s_add_u32 s86, s86, 1024
    s_and_b32 s86, s86, 16383
    s_add_u32 s58, s86, s66
    v_mfma_f32_16x16x32_bf16 v[84:87], a[148:151], v[116:119], v[84:87]
    buffer_load_dwordx4 v[156:159], v23, s[24:27], s58 offen offset:0 sc1
    v_mfma_f32_16x16x32_bf16 v[88:91], a[152:155], v[116:119], v[88:91]
    ds_read_b128 v[172:175], v243 offset:5120
    ds_read_b128 v[176:179], v243 offset:8192
    v_mfma_f32_16x16x32_bf16 v[92:95], a[156:159], v[116:119], v[92:95]
    ds_read_b128 v[180:183], v243 offset:9216
    s_waitcnt vmcnt(9)
    v_mfma_f32_16x16x32_bf16 v[80:83], a[160:163], v[120:123], v[80:83]
    s_add_u32 s86, s86, 1024
    s_and_b32 s86, s86, 16383
    s_add_u32 s58, s86, s66
    v_mfma_f32_16x16x32_bf16 v[84:87], a[164:167], v[120:123], v[84:87]
    buffer_load_dwordx4 v[112:115], v23, s[24:27], s58 offen offset:0 sc1
    v_mfma_f32_16x16x32_bf16 v[88:91], a[168:171], v[120:123], v[88:91]
    ds_read_b128 v[184:187], v243 offset:12288
    v_mfma_f32_16x16x32_bf16 v[92:95], a[172:175], v[120:123], v[92:95]
    ds_read_b128 v[188:191], v243 offset:13312
    s_waitcnt vmcnt(9)
    v_mfma_f32_16x16x32_bf16 v[80:83], a[176:179], v[124:127], v[80:83]
    s_add_u32 s86, s86, 1024
    s_and_b32 s86, s86, 16383
    s_add_u32 s58, s86, s66
    v_mfma_f32_16x16x32_bf16 v[84:87], a[180:183], v[124:127], v[84:87]
    buffer_load_dwordx4 v[116:119], v23, s[24:27], s58 offen offset:0 sc1
    v_mfma_f32_16x16x32_bf16 v[88:91], a[184:187], v[124:127], v[88:91]
    v_mfma_f32_16x16x32_bf16 v[92:95], a[188:191], v[124:127], v[92:95]
    s_waitcnt vmcnt(9)
    v_mfma_f32_16x16x32_bf16 v[80:83], a[192:195], v[128:131], v[80:83]
    s_add_u32 s86, s86, 1024
    s_and_b32 s86, s86, 16383
    s_add_u32 s58, s86, s66
    v_mfma_f32_16x16x32_bf16 v[84:87], a[196:199], v[128:131], v[84:87]
    buffer_load_dwordx4 v[120:123], v23, s[24:27], s58 offen offset:0 sc1
    v_mfma_f32_16x16x32_bf16 v[88:91], a[200:203], v[128:131], v[88:91]
    s_waitcnt lgkmcnt(0)
    v_add_f32 v160, v160, v168
    v_mfma_f32_16x16x32_bf16 v[92:95], a[204:207], v[128:131], v[92:95]
    v_add_f32 v161, v161, v169
    s_waitcnt vmcnt(9)
    v_mfma_f32_16x16x32_bf16 v[80:83], a[208:211], v[132:135], v[80:83]
    s_add_u32 s86, s86, 1024
    s_and_b32 s86, s86, 16383
    s_add_u32 s58, s86, s66
    v_mfma_f32_16x16x32_bf16 v[84:87], a[212:215], v[132:135], v[84:87]
    buffer_load_dwordx4 v[124:127], v23, s[24:27], s58 offen offset:0 sc1
    v_mfma_f32_16x16x32_bf16 v[88:91], a[216:219], v[132:135], v[88:91]
    v_add_f32 v162, v162, v170
    v_add_f32 v163, v163, v171
    v_mfma_f32_16x16x32_bf16 v[92:95], a[220:223], v[132:135], v[92:95]
    v_add_f32 v164, v164, v172
    s_waitcnt vmcnt(9)
    v_mfma_f32_16x16x32_bf16 v[80:83], a[224:227], v[136:139], v[80:83]
    s_add_u32 s86, s86, 1024
    s_and_b32 s86, s86, 16383
    s_add_u32 s58, s86, s66
    v_mfma_f32_16x16x32_bf16 v[84:87], a[228:231], v[136:139], v[84:87]
    buffer_load_dwordx4 v[128:131], v23, s[24:27], s58 offen offset:0 sc1
    v_mfma_f32_16x16x32_bf16 v[88:91], a[232:235], v[136:139], v[88:91]
    v_add_f32 v165, v165, v173
    v_add_f32 v166, v166, v174
    v_mfma_f32_16x16x32_bf16 v[92:95], a[236:239], v[136:139], v[92:95]
    v_add_f32 v167, v167, v175
    s_waitcnt vmcnt(9)
    v_mfma_f32_16x16x32_bf16 v[80:83], a[240:243], v[140:143], v[80:83]
    s_add_u32 s86, s86, 1024
    s_and_b32 s86, s86, 16383
    s_add_u32 s58, s86, s66
    v_mfma_f32_16x16x32_bf16 v[84:87], a[244:247], v[140:143], v[84:87]
    buffer_load_dwordx4 v[132:135], v23, s[24:27], s58 offen offset:0 sc1
    v_mfma_f32_16x16x32_bf16 v[88:91], a[248:251], v[140:143], v[88:91]
    v_add_f32 v160, v160, v176
    v_add_f32 v161, v161, v177
    v_mfma_f32_16x16x32_bf16 v[92:95], a[252:255], v[140:143], v[92:95]
    v_add_f32 v162, v162, v178
    s_waitcnt vmcnt(9)
    v_mfma_f32_16x16x32_bf16 v[64:67], a[0:3], v[144:147], 0
    s_add_u32 s86, s86, 1024
    s_and_b32 s86, s86, 16383
    s_add_u32 s58, s86, s66
    v_mfma_f32_16x16x32_bf16 v[68:71], a[4:7], v[144:147], 0
    buffer_load_dwordx4 v[136:139], v23, s[24:27], s58 offen offset:0 sc1
    v_mfma_f32_16x16x32_bf16 v[72:75], a[8:11], v[144:147], 0
    v_mfma_f32_16x16x32_bf16 v[76:79], a[12:15], v[144:147], 0
    s_waitcnt vmcnt(9)
    v_mfma_f32_16x16x32_bf16 v[64:67], a[16:19], v[148:151], v[64:67]
    s_add_u32 s86, s86, 1024
    s_and_b32 s86, s86, 16383
    s_add_u32 s58, s86, s66
    v_mfma_f32_16x16x32_bf16 v[68:71], a[20:23], v[148:151], v[68:71]
    buffer_load_dwordx4 v[140:143], v23, s[24:27], s58 offen offset:0 sc1
    v_mfma_f32_16x16x32_bf16 v[72:75], a[24:27], v[148:151], v[72:75]
    ds_write_b128 v232, v[80:83] offset:32768
    v_mfma_f32_16x16x32_bf16 v[76:79], a[28:31], v[148:151], v[76:79]
    s_waitcnt vmcnt(9)
    v_mfma_f32_16x16x32_bf16 v[64:67], a[32:35], v[152:155], v[64:67]
    s_add_u32 s86, s86, 1024
    s_and_b32 s86, s86, 16383
    s_add_u32 s58, s86, s66
    v_mfma_f32_16x16x32_bf16 v[68:71], a[36:39], v[152:155], v[68:71]
    buffer_load_dwordx4 v[144:147], v23, s[24:27], s58 offen offset:0 sc1
    v_mfma_f32_16x16x32_bf16 v[72:75], a[40:43], v[152:155], v[72:75]
    ds_write_b128 v232, v[84:87] offset:33792
    v_mfma_f32_16x16x32_bf16 v[76:79], a[44:47], v[152:155], v[76:79]
    s_waitcnt vmcnt(9)
    v_mfma_f32_16x16x32_bf16 v[64:67], a[48:51], v[156:159], v[64:67]
    s_add_u32 s86, s86, 1024
    s_and_b32 s86, s86, 16383
    s_add_u32 s58, s86, s66
    ds_write_b128 v232, v[88:91] offset:34816
    v_mfma_f32_16x16x32_bf16 v[68:71], a[52:55], v[156:159], v[68:71]
    buffer_load_dwordx4 v[148:151], v23, s[24:27], s58 offen offset:0 sc1
    v_mfma_f32_16x16x32_bf16 v[72:75], a[56:59], v[156:159], v[72:75]
    v_add_f32 v163, v163, v179
    v_add_f32 v164, v164, v180
    v_mfma_f32_16x16x32_bf16 v[76:79], a[60:63], v[156:159], v[76:79]
    v_add_f32 v165, v165, v181
    s_waitcnt vmcnt(9)
    v_mfma_f32_16x16x32_bf16 v[64:67], a[64:67], v[112:115], v[64:67]
    s_add_u32 s86, s86, 1024
    s_and_b32 s86, s86, 16383
    s_add_u32 s58, s86, s66
    ds_write_b128 v232, v[92:95] offset:35840
    v_mfma_f32_16x16x32_bf16 v[68:71], a[68:71], v[112:115], v[68:71]
    buffer_load_dwordx4 v[152:155], v23, s[24:27], s58 offen offset:0 sc1
    v_mfma_f32_16x16x32_bf16 v[72:75], a[72:75], v[112:115], v[72:75]
    v_add_f32 v166, v166, v182
    v_add_f32 v167, v167, v183
    v_mfma_f32_16x16x32_bf16 v[76:79], a[76:79], v[112:115], v[76:79]
    v_add_f32 v160, v160, v184
    s_waitcnt vmcnt(9)
    v_mfma_f32_16x16x32_bf16 v[64:67], a[80:83], v[116:119], v[64:67]
    s_add_u32 s86, s86, 1024
    s_and_b32 s86, s86, 16383
    s_add_u32 s58, s86, s66
    v_mfma_f32_16x16x32_bf16 v[68:71], a[84:87], v[116:119], v[68:71]
    buffer_load_dwordx4 v[156:159], v23, s[24:27], s58 offen offset:0 sc1
    v_mfma_f32_16x16x32_bf16 v[72:75], a[88:91], v[116:119], v[72:75]
    v_add_f32 v161, v161, v185
    v_add_f32 v162, v162, v186
    v_mfma_f32_16x16x32_bf16 v[76:79], a[92:95], v[116:119], v[76:79]
    v_add_f32 v163, v163, v187
    s_waitcnt vmcnt(9)
    v_mfma_f32_16x16x32_bf16 v[64:67], a[96:99], v[120:123], v[64:67]
    s_xor_b32 s66, s44, 1
    s_lshl2_add_u32 s66, s51, s66
    s_mul_i32 s66, s66, 66816
    s_lshl2_add_u32 s66, s52, s66
    s_lshl_b32 s86, s65, 10
    s_add_u32 s58, s86, s66
    v_mfma_f32_16x16x32_bf16 v[68:71], a[100:103], v[120:123], v[68:71]
    buffer_load_dwordx4 v[112:115], v23, s[24:27], s58 offen offset:0 sc1
    v_mfma_f32_16x16x32_bf16 v[72:75], a[104:107], v[120:123], v[72:75]
    v_add_f32 v164, v164, v188
    v_add_f32 v165, v165, v189
    v_mfma_f32_16x16x32_bf16 v[76:79], a[108:111], v[120:123], v[76:79]
    v_add_f32 v166, v166, v190
    s_waitcnt vmcnt(9)
    v_mfma_f32_16x16x32_bf16 v[64:67], a[112:115], v[124:127], v[64:67]
    s_add_u32 s86, s86, 1024
    s_and_b32 s86, s86, 16383
    s_add_u32 s58, s86, s66
    v_mfma_f32_16x16x32_bf16 v[68:71], a[116:119], v[124:127], v[68:71]
    buffer_load_dwordx4 v[116:119], v23, s[24:27], s58 offen offset:0 sc1
    v_mfma_f32_16x16x32_bf16 v[72:75], a[120:123], v[124:127], v[72:75]
    v_add_f32 v167, v167, v191
    v_mul_f32 v192, v160, v160
    v_mfma_f32_16x16x32_bf16 v[76:79], a[124:127], v[124:127], v[76:79]
    v_mul_f32 v193, v161, v161
    s_waitcnt vmcnt(9)
    v_mfma_f32_16x16x32_bf16 v[64:67], a[128:131], v[128:131], v[64:67]
    s_add_u32 s86, s86, 1024
    s_and_b32 s86, s86, 16383
    s_add_u32 s58, s86, s66
    v_mfma_f32_16x16x32_bf16 v[68:71], a[132:135], v[128:131], v[68:71]
    buffer_load_dwordx4 v[120:123], v23, s[24:27], s58 offen offset:0 sc1
    v_mfma_f32_16x16x32_bf16 v[72:75], a[136:139], v[128:131], v[72:75]
    v_mul_f32 v194, v162, v162
    v_mul_f32 v195, v163, v163
    v_mfma_f32_16x16x32_bf16 v[76:79], a[140:143], v[128:131], v[76:79]
    v_mul_f32 v196, v164, v164
    s_waitcnt vmcnt(9)
    v_mfma_f32_16x16x32_bf16 v[64:67], a[144:147], v[132:135], v[64:67]
    s_add_u32 s86, s86, 1024
    s_and_b32 s86, s86, 16383
    s_add_u32 s58, s86, s66
    v_mfma_f32_16x16x32_bf16 v[68:71], a[148:151], v[132:135], v[68:71]
    buffer_load_dwordx4 v[124:127], v23, s[24:27], s58 offen offset:0 sc1
    v_mfma_f32_16x16x32_bf16 v[72:75], a[152:155], v[132:135], v[72:75]
    v_mul_f32 v197, v165, v165
    v_mul_f32 v198, v166, v166
    v_mfma_f32_16x16x32_bf16 v[76:79], a[156:159], v[132:135], v[76:79]
    v_mul_f32 v199, v167, v167
    s_waitcnt vmcnt(9)
    v_mfma_f32_16x16x32_bf16 v[64:67], a[160:163], v[136:139], v[64:67]
    s_add_u32 s86, s86, 1024
    s_and_b32 s86, s86, 16383
    s_add_u32 s58, s86, s66
    v_mfma_f32_16x16x32_bf16 v[68:71], a[164:167], v[136:139], v[68:71]
    buffer_load_dwordx4 v[128:131], v23, s[24:27], s58 offen offset:0 sc1
    v_mfma_f32_16x16x32_bf16 v[72:75], a[168:171], v[136:139], v[72:75]
    v_fma_f32 v192, v192, v236, v237
    v_fma_f32 v193, v193, v236, v237
    v_mfma_f32_16x16x32_bf16 v[76:79], a[172:175], v[136:139], v[76:79]
    v_fma_f32 v194, v194, v236, v237
    s_waitcnt vmcnt(9)
    v_mfma_f32_16x16x32_bf16 v[64:67], a[176:179], v[140:143], v[64:67]
    s_add_u32 s86, s86, 1024
    s_and_b32 s86, s86, 16383
    s_add_u32 s58, s86, s66
    v_mfma_f32_16x16x32_bf16 v[68:71], a[180:183], v[140:143], v[68:71]
    buffer_load_dwordx4 v[132:135], v23, s[24:27], s58 offen offset:0 sc1
    v_mfma_f32_16x16x32_bf16 v[72:75], a[184:187], v[140:143], v[72:75]
    v_fma_f32 v195, v195, v236, v237
    v_fma_f32 v196, v196, v236, v237
    v_mfma_f32_16x16x32_bf16 v[76:79], a[188:191], v[140:143], v[76:79]
    v_fma_f32 v197, v197, v236, v237
    s_waitcnt vmcnt(9)
    v_mfma_f32_16x16x32_bf16 v[64:67], a[192:195], v[144:147], v[64:67]
    s_add_u32 s86, s86, 1024
    s_and_b32 s86, s86, 16383
    s_add_u32 s58, s86, s66
    v_mfma_f32_16x16x32_bf16 v[68:71], a[196:199], v[144:147], v[68:71]
    buffer_load_dwordx4 v[136:139], v23, s[24:27], s58 offen offset:0 sc1
    v_mfma_f32_16x16x32_bf16 v[72:75], a[200:203], v[144:147], v[72:75]
    v_fma_f32 v198, v198, v236, v237
    v_fma_f32 v199, v199, v236, v237
    v_mfma_f32_16x16x32_bf16 v[76:79], a[204:207], v[144:147], v[76:79]
    v_mul_f32 v192, v192, v160
    s_waitcnt vmcnt(9)
    v_mfma_f32_16x16x32_bf16 v[64:67], a[208:211], v[148:151], v[64:67]
    s_add_u32 s86, s86, 1024
    s_and_b32 s86, s86, 16383
    s_add_u32 s58, s86, s66
    v_mfma_f32_16x16x32_bf16 v[68:71], a[212:215], v[148:151], v[68:71]
    buffer_load_dwordx4 v[140:143], v23, s[24:27], s58 offen offset:0 sc1
    v_mfma_f32_16x16x32_bf16 v[72:75], a[216:219], v[148:151], v[72:75]
    v_mul_f32 v193, v193, v161
    v_mul_f32 v194, v194, v162
    v_mfma_f32_16x16x32_bf16 v[76:79], a[220:223], v[148:151], v[76:79]
    v_mul_f32 v195, v195, v163
    s_waitcnt vmcnt(9)
    v_mfma_f32_16x16x32_bf16 v[64:67], a[224:227], v[152:155], v[64:67]
    s_add_u32 s86, s86, 1024
    s_and_b32 s86, s86, 16383
    s_add_u32 s58, s86, s66
    v_mfma_f32_16x16x32_bf16 v[68:71], a[228:231], v[152:155], v[68:71]
    buffer_load_dwordx4 v[144:147], v23, s[24:27], s58 offen offset:0 sc1
    v_mfma_f32_16x16x32_bf16 v[72:75], a[232:235], v[152:155], v[72:75]
    v_mul_f32 v196, v196, v164
    v_mul_f32 v197, v197, v165
    v_mfma_f32_16x16x32_bf16 v[76:79], a[236:239], v[152:155], v[76:79]
    v_mul_f32 v198, v198, v166
    s_waitcnt vmcnt(9)
    v_mfma_f32_16x16x32_bf16 v[64:67], a[240:243], v[156:159], v[64:67]
    s_add_u32 s86, s86, 1024
    s_and_b32 s86, s86, 16383
    s_add_u32 s58, s86, s66
    v_mfma_f32_16x16x32_bf16 v[68:71], a[244:247], v[156:159], v[68:71]
    buffer_load_dwordx4 v[148:151], v23, s[24:27], s58 offen offset:0 sc1
    v_mfma_f32_16x16x32_bf16 v[72:75], a[248:251], v[156:159], v[72:75]
    v_mul_f32 v199, v199, v167
    v_mfma_f32_16x16x32_bf16 v[76:79], a[252:255], v[156:159], v[76:79]
    s_waitcnt vmcnt(9)
    v_mfma_f32_16x16x32_bf16 v[48:51], a[0:3], v[112:115], 0
    s_add_u32 s86, s86, 1024
    s_and_b32 s86, s86, 16383
    s_add_u32 s58, s86, s66
    v_mfma_f32_16x16x32_bf16 v[52:55], a[4:7], v[112:115], 0
    buffer_load_dwordx4 v[152:155], v23, s[24:27], s58 offen offset:0 sc1
    v_mfma_f32_16x16x32_bf16 v[56:59], a[8:11], v[112:115], 0
    v_mfma_f32_16x16x32_bf16 v[60:63], a[12:15], v[112:115], 0
    s_waitcnt vmcnt(9)
    v_mfma_f32_16x16x32_bf16 v[48:51], a[16:19], v[116:119], v[48:51]
    s_add_u32 s86, s86, 1024
    s_and_b32 s86, s86, 16383
    s_add_u32 s58, s86, s66
    v_mfma_f32_16x16x32_bf16 v[52:55], a[20:23], v[116:119], v[52:55]
    buffer_load_dwordx4 v[156:159], v23, s[24:27], s58 offen offset:0 sc1
    v_mfma_f32_16x16x32_bf16 v[56:59], a[24:27], v[116:119], v[56:59]
    ds_write_b128 v232, v[64:67] offset:16384
    v_mfma_f32_16x16x32_bf16 v[60:63], a[28:31], v[116:119], v[60:63]
    s_waitcnt vmcnt(9)
    v_mfma_f32_16x16x32_bf16 v[48:51], a[32:35], v[120:123], v[48:51]
    s_add_u32 s86, s86, 1024
    s_and_b32 s86, s86, 16383
    s_add_u32 s58, s86, s66
    v_mfma_f32_16x16x32_bf16 v[52:55], a[36:39], v[120:123], v[52:55]
    buffer_load_dwordx4 v[112:115], v23, s[24:27], s58 offen offset:0 sc1
    v_mfma_f32_16x16x32_bf16 v[56:59], a[40:43], v[120:123], v[56:59]
    ds_write_b128 v232, v[68:71] offset:17408
    v_mfma_f32_16x16x32_bf16 v[60:63], a[44:47], v[120:123], v[60:63]
    s_waitcnt vmcnt(9)
    v_mfma_f32_16x16x32_bf16 v[48:51], a[48:51], v[124:127], v[48:51]
    s_add_u32 s86, s86, 1024
    s_and_b32 s86, s86, 16383
    s_add_u32 s58, s86, s66
    ds_write_b128 v232, v[72:75] offset:18432
    v_mfma_f32_16x16x32_bf16 v[52:55], a[52:55], v[124:127], v[52:55]
    buffer_load_dwordx4 v[116:119], v23, s[24:27], s58 offen offset:0 sc1
    v_mfma_f32_16x16x32_bf16 v[56:59], a[56:59], v[124:127], v[56:59]
    v_exp_f32 v192, v192
    v_exp_f32 v193, v193
    v_mfma_f32_16x16x32_bf16 v[60:63], a[60:63], v[124:127], v[60:63]
    v_exp_f32 v194, v194
    s_waitcnt vmcnt(9)
    v_mfma_f32_16x16x32_bf16 v[48:51], a[64:67], v[128:131], v[48:51]
    s_add_u32 s86, s86, 1024
    s_and_b32 s86, s86, 16383
    s_add_u32 s58, s86, s66
    ds_write_b128 v232, v[76:79] offset:19456
    v_mfma_f32_16x16x32_bf16 v[52:55], a[68:71], v[128:131], v[52:55]
    buffer_load_dwordx4 v[120:123], v23, s[24:27], s58 offen offset:0 sc1
    v_mfma_f32_16x16x32_bf16 v[56:59], a[72:75], v[128:131], v[56:59]
    v_exp_f32 v195, v195
    v_exp_f32 v196, v196
    v_mfma_f32_16x16x32_bf16 v[60:63], a[76:79], v[128:131], v[60:63]
    v_exp_f32 v197, v197
    s_waitcnt vmcnt(9)
    v_mfma_f32_16x16x32_bf16 v[48:51], a[80:83], v[132:135], v[48:51]
    s_add_u32 s86, s86, 1024
    s_and_b32 s86, s86, 16383
    s_add_u32 s58, s86, s66
    v_mfma_f32_16x16x32_bf16 v[52:55], a[84:87], v[132:135], v[52:55]
    buffer_load_dwordx4 v[124:127], v23, s[24:27], s58 offen offset:0 sc1
    v_mfma_f32_16x16x32_bf16 v[56:59], a[88:91], v[132:135], v[56:59]
    v_exp_f32 v198, v198
    v_exp_f32 v199, v199
    v_mfma_f32_16x16x32_bf16 v[60:63], a[92:95], v[132:135], v[60:63]
    v_add_f32 v192, 1.0, v192
    s_waitcnt vmcnt(9)
    v_mfma_f32_16x16x32_bf16 v[48:51], a[96:99], v[136:139], v[48:51]
    s_xor_b32 s66, s44, 0
    s_lshl2_add_u32 s66, s51, s66
    s_mul_i32 s66, s66, 66816
    s_lshl2_add_u32 s66, s52, s66
    s_lshl_b32 s86, s65, 10
    s_add_u32 s58, s86, s66
    v_mfma_f32_16x16x32_bf16 v[52:55], a[100:103], v[136:139], v[52:55]
    buffer_load_dwordx4 v[128:131], v23, s[24:27], s58 offen offset:0 sc1
    v_mfma_f32_16x16x32_bf16 v[56:59], a[104:107], v[136:139], v[56:59]
    v_add_f32 v193, 1.0, v193
    v_add_f32 v194, 1.0, v194
    v_mfma_f32_16x16x32_bf16 v[60:63], a[108:111], v[136:139], v[60:63]
    v_add_f32 v195, 1.0, v195
    s_waitcnt vmcnt(9)
    v_mfma_f32_16x16x32_bf16 v[48:51], a[112:115], v[140:143], v[48:51]
    s_add_u32 s86, s86, 1024
    s_and_b32 s86, s86, 16383
    s_add_u32 s58, s86, s66
    v_mfma_f32_16x16x32_bf16 v[52:55], a[116:119], v[140:143], v[52:55]
    buffer_load_dwordx4 v[132:135], v23, s[24:27], s58 offen offset:0 sc1
    v_mfma_f32_16x16x32_bf16 v[56:59], a[120:123], v[140:143], v[56:59]
    v_add_f32 v196, 1.0, v196
    v_add_f32 v197, 1.0, v197
    v_mfma_f32_16x16x32_bf16 v[60:63], a[124:127], v[140:143], v[60:63]
    v_add_f32 v198, 1.0, v198
    s_waitcnt vmcnt(9)
    v_mfma_f32_16x16x32_bf16 v[48:51], a[128:131], v[144:147], v[48:51]
    s_add_u32 s86, s86, 1024
    s_and_b32 s86, s86, 16383
    s_add_u32 s58, s86, s66
    v_mfma_f32_16x16x32_bf16 v[52:55], a[132:135], v[144:147], v[52:55]
    buffer_load_dwordx4 v[136:139], v23, s[24:27], s58 offen offset:0 sc1
    v_mfma_f32_16x16x32_bf16 v[56:59], a[136:139], v[144:147], v[56:59]
    v_add_f32 v199, 1.0, v199
    v_rcp_f32 v192, v192
    v_mfma_f32_16x16x32_bf16 v[60:63], a[140:143], v[144:147], v[60:63]
    v_rcp_f32 v193, v193
    s_waitcnt vmcnt(9)
    v_mfma_f32_16x16x32_bf16 v[48:51], a[144:147], v[148:151], v[48:51]
    s_add_u32 s86, s86, 1024
    s_and_b32 s86, s86, 16383
    s_add_u32 s58, s86, s66
    v_mfma_f32_16x16x32_bf16 v[52:55], a[148:151], v[148:151], v[52:55]
    buffer_load_dwordx4 v[140:143], v23, s[24:27], s58 offen offset:0 sc1
    v_mfma_f32_16x16x32_bf16 v[56:59], a[152:155], v[148:151], v[56:59]
    v_rcp_f32 v194, v194
    v_rcp_f32 v195, v195
    v_mfma_f32_16x16x32_bf16 v[60:63], a[156:159], v[148:151], v[60:63]
    v_rcp_f32 v196, v196
    s_waitcnt vmcnt(9)
    v_mfma_f32_16x16x32_bf16 v[48:51], a[160:163], v[152:155], v[48:51]
    s_add_u32 s86, s86, 1024
    s_and_b32 s86, s86, 16383
    s_add_u32 s58, s86, s66
    v_mfma_f32_16x16x32_bf16 v[52:55], a[164:167], v[152:155], v[52:55]
    buffer_load_dwordx4 v[144:147], v23, s[24:27], s58 offen offset:0 sc1
    v_mfma_f32_16x16x32_bf16 v[56:59], a[168:171], v[152:155], v[56:59]
    v_rcp_f32 v197, v197
    v_rcp_f32 v198, v198
    v_mfma_f32_16x16x32_bf16 v[60:63], a[172:175], v[152:155], v[60:63]
    v_rcp_f32 v199, v199
    s_waitcnt vmcnt(9)
    v_mfma_f32_16x16x32_bf16 v[48:51], a[176:179], v[156:159], v[48:51]
    s_add_u32 s86, s86, 1024
    s_and_b32 s86, s86, 16383
    s_add_u32 s58, s86, s66
    v_mfma_f32_16x16x32_bf16 v[52:55], a[180:183], v[156:159], v[52:55]
    buffer_load_dwordx4 v[148:151], v23, s[24:27], s58 offen offset:0 sc1
    v_mfma_f32_16x16x32_bf16 v[56:59], a[184:187], v[156:159], v[56:59]
    v_mul_f32 v192, v192, v160
    v_mul_f32 v193, v193, v161
    v_mfma_f32_16x16x32_bf16 v[60:63], a[188:191], v[156:159], v[60:63]
    v_mul_f32 v194, v194, v162
    s_waitcnt vmcnt(9)
    v_mfma_f32_16x16x32_bf16 v[48:51], a[192:195], v[112:115], v[48:51]
    s_add_u32 s86, s86, 1024
    s_and_b32 s86, s86, 16383
    s_add_u32 s58, s86, s66
    v_mfma_f32_16x16x32_bf16 v[52:55], a[196:199], v[112:115], v[52:55]
    buffer_load_dwordx4 v[152:155], v23, s[24:27], s58 offen offset:0 sc1
    v_mfma_f32_16x16x32_bf16 v[56:59], a[200:203], v[112:115], v[56:59]
    v_mul_f32 v195, v195, v163
    v_mul_f32 v196, v196, v164
    v_mfma_f32_16x16x32_bf16 v[60:63], a[204:207], v[112:115], v[60:63]
    v_mul_f32 v197, v197, v165
    s_waitcnt vmcnt(9)
    v_mfma_f32_16x16x32_bf16 v[48:51], a[208:211], v[116:119], v[48:51]
    s_add_u32 s86, s86, 1024
    s_and_b32 s86, s86, 16383
    s_add_u32 s58, s86, s66
    v_mfma_f32_16x16x32_bf16 v[52:55], a[212:215], v[116:119], v[52:55]
    buffer_load_dwordx4 v[156:159], v23, s[24:27], s58 offen offset:0 sc1
    v_mfma_f32_16x16x32_bf16 v[56:59], a[216:219], v[116:119], v[56:59]
    v_mul_f32 v198, v198, v166
    v_mul_f32 v199, v199, v167
    v_mfma_f32_16x16x32_bf16 v[60:63], a[220:223], v[116:119], v[60:63]
    v_cvt_pk_bf16_f32 v96, v192, v193
    s_waitcnt vmcnt(9)
    v_mfma_f32_16x16x32_bf16 v[48:51], a[224:227], v[120:123], v[48:51]
    s_add_u32 s86, s86, 1024
    s_and_b32 s86, s86, 16383
    s_add_u32 s58, s86, s66
    v_mfma_f32_16x16x32_bf16 v[52:55], a[228:231], v[120:123], v[52:55]
    buffer_load_dwordx4 v[112:115], v23, s[24:27], s58 offen offset:0 sc1
    v_mfma_f32_16x16x32_bf16 v[56:59], a[232:235], v[120:123], v[56:59]
    v_cvt_pk_bf16_f32 v97, v194, v195
    v_cvt_pk_bf16_f32 v98, v196, v197
    v_mfma_f32_16x16x32_bf16 v[60:63], a[236:239], v[120:123], v[60:63]
    v_cvt_pk_bf16_f32 v99, v198, v199
    s_waitcnt vmcnt(9)
    v_mfma_f32_16x16x32_bf16 v[48:51], a[240:243], v[124:127], v[48:51]
    s_add_u32 s86, s86, 1024
    s_and_b32 s86, s86, 16383
    s_add_u32 s58, s86, s66
    v_mfma_f32_16x16x32_bf16 v[52:55], a[244:247], v[124:127], v[52:55]
    buffer_load_dwordx4 v[116:119], v23, s[24:27], s58 offen offset:0 sc1
    v_mfma_f32_16x16x32_bf16 v[56:59], a[248:251], v[124:127], v[56:59]
    v_mfma_f32_16x16x32_bf16 v[60:63], a[252:255], v[124:127], v[60:63]
    s_waitcnt vmcnt(9)
    v_mfma_f32_16x16x32_bf16 v[32:35], a[0:3], v[128:131], v[32:35]
    s_add_u32 s86, s86, 1024
    s_and_b32 s86, s86, 16383
    s_add_u32 s58, s86, s66
    v_mfma_f32_16x16x32_bf16 v[36:39], a[4:7], v[128:131], v[36:39]
    buffer_load_dwordx4 v[120:123], v23, s[24:27], s58 offen offset:0 sc1
    v_mfma_f32_16x16x32_bf16 v[40:43], a[8:11], v[128:131], v[40:43]
    v_mfma_f32_16x16x32_bf16 v[44:47], a[12:15], v[128:131], v[44:47]
    s_waitcnt vmcnt(9)
    v_mfma_f32_16x16x32_bf16 v[32:35], a[16:19], v[132:135], v[32:35]
    s_add_u32 s86, s86, 1024
    s_and_b32 s86, s86, 16383
    s_add_u32 s58, s86, s66
    v_mfma_f32_16x16x32_bf16 v[36:39], a[20:23], v[132:135], v[36:39]
    buffer_load_dwordx4 v[124:127], v23, s[24:27], s58 offen offset:0 sc1
    v_mfma_f32_16x16x32_bf16 v[40:43], a[24:27], v[132:135], v[40:43]
    ds_write_b128 v232, v[48:51] offset:0
    v_mfma_f32_16x16x32_bf16 v[44:47], a[28:31], v[132:135], v[44:47]
    ds_write_b128 v232, v[52:55] offset:1024
    s_waitcnt vmcnt(9)
    v_mfma_f32_16x16x32_bf16 v[32:35], a[32:35], v[136:139], v[32:35]
    s_add_u32 s86, s86, 1024
    s_and_b32 s86, s86, 16383
    s_add_u32 s58, s86, s66
    v_mfma_f32_16x16x32_bf16 v[36:39], a[36:39], v[136:139], v[36:39]
    buffer_load_dwordx4 v[128:131], v23, s[24:27], s58 offen offset:0 sc1
    v_mfma_f32_16x16x32_bf16 v[40:43], a[40:43], v[136:139], v[40:43]
    ds_write_b128 v232, v[56:59] offset:2048
    v_mfma_f32_16x16x32_bf16 v[44:47], a[44:47], v[136:139], v[44:47]
    ds_write_b128 v232, v[60:63] offset:3072
    s_waitcnt vmcnt(9)
    v_mfma_f32_16x16x32_bf16 v[32:35], a[48:51], v[140:143], v[32:35]
    s_add_u32 s86, s86, 1024
    s_and_b32 s86, s86, 16383
    s_add_u32 s58, s86, s66
    v_mfma_f32_16x16x32_bf16 v[36:39], a[52:55], v[140:143], v[36:39]
    buffer_load_dwordx4 v[132:135], v23, s[24:27], s58 offen offset:0 sc1
    v_mfma_f32_16x16x32_bf16 v[40:43], a[56:59], v[140:143], v[40:43]
    v_mfma_f32_16x16x32_bf16 v[44:47], a[60:63], v[140:143], v[44:47]
    s_waitcnt vmcnt(9)
    v_mfma_f32_16x16x32_bf16 v[32:35], a[64:67], v[144:147], v[32:35]
    s_add_u32 s86, s86, 1024
    s_and_b32 s86, s86, 16383
    s_add_u32 s58, s86, s66
    v_mfma_f32_16x16x32_bf16 v[36:39], a[68:71], v[144:147], v[36:39]
    buffer_load_dwordx4 v[136:139], v23, s[24:27], s58 offen offset:0 sc1
    v_mfma_f32_16x16x32_bf16 v[40:43], a[72:75], v[144:147], v[40:43]
    v_mfma_f32_16x16x32_bf16 v[44:47], a[76:79], v[144:147], v[44:47]
    s_waitcnt vmcnt(9)
    v_mfma_f32_16x16x32_bf16 v[32:35], a[80:83], v[148:151], v[32:35]
    s_add_u32 s86, s86, 1024
    s_and_b32 s86, s86, 16383
    s_add_u32 s58, s86, s66
    v_mfma_f32_16x16x32_bf16 v[36:39], a[84:87], v[148:151], v[36:39]
    buffer_load_dwordx4 v[140:143], v23, s[24:27], s58 offen offset:0 sc1
    v_mfma_f32_16x16x32_bf16 v[40:43], a[88:91], v[148:151], v[40:43]
    s_waitcnt lgkmcnt(0)
    s_barrier
    v_mfma_f32_16x16x32_bf16 v[44:47], a[92:95], v[148:151], v[44:47]
    buffer_load_dwordx4 v[216:219], v22, s[4:7], s71 offen
    s_waitcnt vmcnt(10)
    v_mfma_f32_16x16x32_bf16 v[32:35], a[96:99], v[152:155], v[32:35]
    ds_read_b128 v[160:163], v233 offset:0
    v_mfma_f32_16x16x32_bf16 v[36:39], a[100:103], v[152:155], v[36:39]
    ds_read_b128 v[176:179], v234 offset:16384
    v_mfma_f32_16x16x32_bf16 v[40:43], a[104:107], v[152:155], v[40:43]
    ds_read_b128 v[192:195], v235 offset:32768
    v_mfma_f32_16x16x32_bf16 v[44:47], a[108:111], v[152:155], v[44:47]
    buffer_load_dwordx4 v[220:223], v22, s[4:7], s72 offen
    s_waitcnt vmcnt(10)
    v_mfma_f32_16x16x32_bf16 v[32:35], a[112:115], v[156:159], v[32:35]
    ds_read_b128 v[164:167], v233 offset:1024
    v_mfma_f32_16x16x32_bf16 v[36:39], a[116:119], v[156:159], v[36:39]
    ds_read_b128 v[180:183], v234 offset:17408
    v_mfma_f32_16x16x32_bf16 v[40:43], a[120:123], v[156:159], v[40:43]
    ds_read_b128 v[196:199], v235 offset:33792
    v_mfma_f32_16x16x32_bf16 v[44:47], a[124:127], v[156:159], v[44:47]
    buffer_load_dwordx2 v[226:227], v26, s[4:7], s73 offen
    s_waitcnt vmcnt(10)
    v_mfma_f32_16x16x32_bf16 v[32:35], a[128:131], v[112:115], v[32:35]
    ds_read_b128 v[168:171], v233 offset:2048
    v_mfma_f32_16x16x32_bf16 v[36:39], a[132:135], v[112:115], v[36:39]
    ds_read_b128 v[184:187], v234 offset:18432
    v_mfma_f32_16x16x32_bf16 v[40:43], a[136:139], v[112:115], v[40:43]
    ds_read_b128 v[200:203], v235 offset:34816
    v_mfma_f32_16x16x32_bf16 v[44:47], a[140:143], v[112:115], v[44:47]
    buffer_load_ushort v224, v25, s[36:39], s74 offen
    s_waitcnt vmcnt(10)
    v_mfma_f32_16x16x32_bf16 v[32:35], a[144:147], v[116:119], v[32:35]
    ds_read_b128 v[172:175], v233 offset:3072
    v_mfma_f32_16x16x32_bf16 v[36:39], a[148:151], v[116:119], v[36:39]
    ds_read_b128 v[188:191], v234 offset:19456
    v_mfma_f32_16x16x32_bf16 v[40:43], a[152:155], v[116:119], v[40:43]
    ds_read_b128 v[204:207], v235 offset:35840
    v_mfma_f32_16x16x32_bf16 v[44:47], a[156:159], v[116:119], v[44:47]
    buffer_load_ushort v225, v25, s[36:39], s74 offen offset:64
    s_waitcnt vmcnt(10)
    v_mfma_f32_16x16x32_bf16 v[32:35], a[160:163], v[120:123], v[32:35]
    v_mfma_f32_16x16x32_bf16 v[36:39], a[164:167], v[120:123], v[36:39]
    v_mfma_f32_16x16x32_bf16 v[40:43], a[168:171], v[120:123], v[40:43]
    v_mfma_f32_16x16x32_bf16 v[44:47], a[172:175], v[120:123], v[44:47]
    buffer_load_ushort v228, v27, s[36:39], s74 offen
    s_waitcnt vmcnt(10)
    v_mfma_f32_16x16x32_bf16 v[32:35], a[176:179], v[124:127], v[32:35]
    s_waitcnt lgkmcnt(9)
    v_mfma_f32_16x16x32_bf16 v[36:39], a[180:183], v[124:127], v[36:39]
    v_add_f32 v160, v160, v176
    v_mfma_f32_16x16x32_bf16 v[40:43], a[184:187], v[124:127], v[40:43]
    v_add_f32 v161, v161, v177
    v_mfma_f32_16x16x32_bf16 v[44:47], a[188:191], v[124:127], v[44:47]
    v_add_f32 v162, v162, v178
    s_add_u32 m0, s52, 81920
    s_lshl_b32 s57, s76, 7
    buffer_load_dwordx4 v12, s[20:23], s57 offen offset:0 lds
    s_waitcnt vmcnt(10)
    v_mfma_f32_16x16x32_bf16 v[32:35], a[192:195], v[128:131], v[32:35]
    v_add_f32 v163, v163, v179
    v_mfma_f32_16x16x32_bf16 v[36:39], a[196:199], v[128:131], v[36:39]
    s_waitcnt lgkmcnt(6)
    v_mfma_f32_16x16x32_bf16 v[40:43], a[200:203], v[128:131], v[40:43]
    v_add_f32 v164, v164, v180
    v_mfma_f32_16x16x32_bf16 v[44:47], a[204:207], v[128:131], v[44:47]
    v_add_f32 v165, v165, v181
    s_add_u32 s57, s57, 31744
    buffer_load_dwordx4 v12, s[20:23], s57 offen offset:1024 lds
    s_waitcnt vmcnt(10)
    v_mfma_f32_16x16x32_bf16 v[32:35], a[208:211], v[132:135], v[32:35]
    v_add_f32 v166, v166, v182
    v_mfma_f32_16x16x32_bf16 v[36:39], a[212:215], v[132:135], v[36:39]
    v_add_f32 v167, v167, v183
    v_mfma_f32_16x16x32_bf16 v[40:43], a[216:219], v[132:135], v[40:43]
    s_waitcnt lgkmcnt(3)
    v_mfma_f32_16x16x32_bf16 v[44:47], a[220:223], v[132:135], v[44:47]
    v_add_f32 v168, v168, v184
    s_add_u32 s57, s57, 31744
    buffer_load_dwordx4 v12, s[20:23], s57 offen offset:2048 lds
    s_waitcnt vmcnt(10)
    v_mfma_f32_16x16x32_bf16 v[32:35], a[224:227], v[136:139], v[32:35]
    v_add_f32 v169, v169, v185
    v_mfma_f32_16x16x32_bf16 v[36:39], a[228:231], v[136:139], v[36:39]
    v_add_f32 v170, v170, v186
    v_mfma_f32_16x16x32_bf16 v[40:43], a[232:235], v[136:139], v[40:43]
    v_add_f32 v171, v171, v187
    v_mfma_f32_16x16x32_bf16 v[44:47], a[236:239], v[136:139], v[44:47]
    s_waitcnt lgkmcnt(0)
    s_add_u32 s57, s57, 31744
    buffer_load_dwordx4 v12, s[20:23], s57 offen offset:3072 lds
    s_waitcnt vmcnt(10)
    v_mfma_f32_16x16x32_bf16 v[32:35], a[240:243], v[140:143], v[32:35]
    v_add_f32 v172, v172, v188
    v_mfma_f32_16x16x32_bf16 v[36:39], a[244:247], v[140:143], v[36:39]
    v_add_f32 v173, v173, v189
    v_mfma_f32_16x16x32_bf16 v[40:43], a[248:251], v[140:143], v[40:43]
    v_add_f32 v174, v174, v190
    v_mfma_f32_16x16x32_bf16 v[44:47], a[252:255], v[140:143], v[44:47]
    v_add_f32 v175, v175, v191
    v_pk_add_f32 v[160:161], v[160:161], v[192:193]
    v_pk_add_f32 v[162:163], v[162:163], v[194:195]
    v_pk_add_f32 v[164:165], v[164:165], v[196:197]
    v_pk_add_f32 v[166:167], v[166:167], v[198:199]
    v_pk_add_f32 v[168:169], v[168:169], v[200:201]
    v_pk_add_f32 v[170:171], v[170:171], v[202:203]
    v_pk_add_f32 v[172:173], v[172:173], v[204:205]
    v_pk_add_f32 v[174:175], v[174:175], v[206:207]
    buffer_store_dwordx4 v[96:99], v23, s[24:27], s83 offen sc1
    s_add_u32 m0, s52, 98304
    s_lshl_b32 s57, s76, 7
    s_add_u32 s57, s57, 131072
    buffer_load_dwordx4 v12, s[20:23], s57 offen offset:0 lds
    v_pk_add_f32 v[32:33], v[32:33], v[160:161]
    v_pk_add_f32 v[34:35], v[34:35], v[162:163]
    v_pk_add_f32 v[36:37], v[36:37], v[164:165]
    v_pk_add_f32 v[38:39], v[38:39], v[166:167]
    v_pk_mul_f32 v[48:49], v[32:33], v[32:33]
    v_pk_mul_f32 v[50:51], v[34:35], v[34:35]
    v_pk_mul_f32 v[52:53], v[36:37], v[36:37]
    v_pk_mul_f32 v[54:55], v[38:39], v[38:39]
    s_add_u32 s57, s57, 31744
    buffer_load_dwordx4 v12, s[20:23], s57 offen offset:1024 lds
    v_pk_fma_f32 v[48:49], v[48:49], v[236:237], v[236:237] op_sel:[0,0,1] op_sel_hi:[1,0,1]
    v_pk_fma_f32 v[50:51], v[50:51], v[236:237], v[236:237] op_sel:[0,0,1] op_sel_hi:[1,0,1]
    v_pk_fma_f32 v[52:53], v[52:53], v[236:237], v[236:237] op_sel:[0,0,1] op_sel_hi:[1,0,1]
    v_pk_fma_f32 v[54:55], v[54:55], v[236:237], v[236:237] op_sel:[0,0,1] op_sel_hi:[1,0,1]
    v_pk_mul_f32 v[48:49], v[48:49], v[32:33]
    v_pk_mul_f32 v[50:51], v[50:51], v[34:35]
    v_pk_mul_f32 v[52:53], v[52:53], v[36:37]
    v_pk_mul_f32 v[54:55], v[54:55], v[38:39]
    s_add_u32 s57, s57, 31744
    buffer_load_dwordx4 v12, s[20:23], s57 offen offset:2048 lds
    v_exp_f32 v48, v48
    v_exp_f32 v49, v49
    v_exp_f32 v50, v50
    v_exp_f32 v51, v51
    v_exp_f32 v52, v52
    v_exp_f32 v53, v53
    v_exp_f32 v54, v54
    v_exp_f32 v55, v55
    v_pk_add_f32 v[48:49], v[48:49], 1.0 op_sel_hi:[1,0]
    v_pk_add_f32 v[50:51], v[50:51], 1.0 op_sel_hi:[1,0]
    v_pk_add_f32 v[52:53], v[52:53], 1.0 op_sel_hi:[1,0]
    v_pk_add_f32 v[54:55], v[54:55], 1.0 op_sel_hi:[1,0]
    s_add_u32 s57, s57, 31744
    buffer_load_dwordx4 v12, s[20:23], s57 offen offset:3072 lds
    v_rcp_f32 v48, v48
    v_rcp_f32 v49, v49
    v_rcp_f32 v50, v50
    v_rcp_f32 v51, v51
    v_rcp_f32 v52, v52
    v_rcp_f32 v53, v53
    v_rcp_f32 v54, v54
    v_rcp_f32 v55, v55
    s_add_u32 m0, s52, 114688
    s_lshl_b32 s57, s77, 7
    buffer_load_dwordx4 v12, s[20:23], s57 offen offset:0 lds
    v_pk_mul_f32 v[48:49], v[48:49], v[32:33]
    v_pk_mul_f32 v[50:51], v[50:51], v[34:35]
    v_pk_mul_f32 v[52:53], v[52:53], v[36:37]
    v_pk_mul_f32 v[54:55], v[54:55], v[38:39]
    v_cvt_pk_bf16_f32 v56, v48, v49
    v_cvt_pk_bf16_f32 v57, v50, v51
    v_cvt_pk_bf16_f32 v58, v52, v53
    v_cvt_pk_bf16_f32 v59, v54, v55
    buffer_store_dwordx4 v[56:59], v23, s[24:27], s67 offen offset:0 sc1
    v_pk_add_f32 v[40:41], v[40:41], v[168:169]
    v_pk_add_f32 v[42:43], v[42:43], v[170:171]
    v_pk_add_f32 v[44:45], v[44:45], v[172:173]
    v_pk_add_f32 v[46:47], v[46:47], v[174:175]
    s_add_u32 s57, s57, 31744
    buffer_load_dwordx4 v12, s[20:23], s57 offen offset:1024 lds
    v_pk_mul_f32 v[48:49], v[40:41], v[40:41]
    v_pk_mul_f32 v[50:51], v[42:43], v[42:43]
    v_pk_mul_f32 v[52:53], v[44:45], v[44:45]
    v_pk_mul_f32 v[54:55], v[46:47], v[46:47]
    v_pk_fma_f32 v[48:49], v[48:49], v[236:237], v[236:237] op_sel:[0,0,1] op_sel_hi:[1,0,1]
    v_pk_fma_f32 v[50:51], v[50:51], v[236:237], v[236:237] op_sel:[0,0,1] op_sel_hi:[1,0,1]
    v_pk_fma_f32 v[52:53], v[52:53], v[236:237], v[236:237] op_sel:[0,0,1] op_sel_hi:[1,0,1]
    v_pk_fma_f32 v[54:55], v[54:55], v[236:237], v[236:237] op_sel:[0,0,1] op_sel_hi:[1,0,1]
    s_add_u32 s57, s57, 31744
    buffer_load_dwordx4 v12, s[20:23], s57 offen offset:2048 lds
    v_pk_mul_f32 v[48:49], v[48:49], v[40:41]
    v_pk_mul_f32 v[50:51], v[50:51], v[42:43]
    v_pk_mul_f32 v[52:53], v[52:53], v[44:45]
    v_pk_mul_f32 v[54:55], v[54:55], v[46:47]
    v_exp_f32 v48, v48
    v_exp_f32 v49, v49
    v_exp_f32 v50, v50
    v_exp_f32 v51, v51
    v_exp_f32 v52, v52
    v_exp_f32 v53, v53
    v_exp_f32 v54, v54
    v_exp_f32 v55, v55
    s_add_u32 s57, s57, 31744
    buffer_load_dwordx4 v12, s[20:23], s57 offen offset:3072 lds
    v_pk_add_f32 v[48:49], v[48:49], 1.0 op_sel_hi:[1,0]
    v_pk_add_f32 v[50:51], v[50:51], 1.0 op_sel_hi:[1,0]
    v_pk_add_f32 v[52:53], v[52:53], 1.0 op_sel_hi:[1,0]
    v_pk_add_f32 v[54:55], v[54:55], 1.0 op_sel_hi:[1,0]
    v_rcp_f32 v48, v48
    v_rcp_f32 v49, v49
    v_rcp_f32 v50, v50
    v_rcp_f32 v51, v51
    s_add_u32 m0, s52, 131072
    s_lshl_b32 s57, s77, 7
    s_add_u32 s57, s57, 131072
    buffer_load_dwordx4 v12, s[20:23], s57 offen offset:0 lds
    v_rcp_f32 v52, v52
    v_rcp_f32 v53, v53
    v_rcp_f32 v54, v54
    v_rcp_f32 v55, v55
    v_pk_mul_f32 v[48:49], v[48:49], v[40:41]
    v_pk_mul_f32 v[50:51], v[50:51], v[42:43]
    v_pk_mul_f32 v[52:53], v[52:53], v[44:45]
    v_pk_mul_f32 v[54:55], v[54:55], v[46:47]
    v_cvt_pk_bf16_f32 v60, v48, v49
    v_cvt_pk_bf16_f32 v61, v50, v51
    v_cvt_pk_bf16_f32 v62, v52, v53
    v_cvt_pk_bf16_f32 v63, v54, v55
    buffer_store_dwordx4 v[60:63], v23, s[24:27], s67 offen offset:1024 sc1
    s_add_u32 s57, s57, 31744
    buffer_load_dwordx4 v12, s[20:23], s57 offen offset:1024 lds
    s_waitcnt vmcnt(13)
    ds_read_b64_tr_b16 a[0:1], v6 offset:32768
    ds_read_b64_tr_b16 a[2:3], v6 offset:34816
    ds_read_b64_tr_b16 a[4:5], v7 offset:32768
    ds_read_b64_tr_b16 a[6:7], v7 offset:34816
    ds_read_b64_tr_b16 a[8:9], v6 offset:33024
    ds_read_b64_tr_b16 a[10:11], v6 offset:35072
    ds_read_b64_tr_b16 a[12:13], v7 offset:33024
    ds_read_b64_tr_b16 a[14:15], v7 offset:35072
    s_add_u32 s57, s57, 31744
    buffer_load_dwordx4 v12, s[20:23], s57 offen offset:2048 lds
    s_add_u32 s57, s57, 31744
    buffer_load_dwordx4 v12, s[20:23], s57 offen offset:3072 lds
    s_add_u32 m0, s52, 147456
    s_lshl_b32 s57, s78, 7
    buffer_load_dwordx4 v12, s[20:23], s57 offen offset:0 lds
    s_add_u32 s57, s57, 31744
    buffer_load_dwordx4 v12, s[20:23], s57 offen offset:1024 lds
    s_waitcnt vmcnt(12)
    ds_read_b64_tr_b16 a[16:17], v6 offset:49152
    ds_read_b64_tr_b16 a[18:19], v6 offset:51200
    ds_read_b64_tr_b16 a[20:21], v7 offset:49152
    ds_read_b64_tr_b16 a[22:23], v7 offset:51200
    s_add_u32 s57, s57, 31744
    buffer_load_dwordx4 v12, s[20:23], s57 offen offset:2048 lds
    ds_read_b64_tr_b16 a[24:25], v6 offset:49408
    ds_read_b64_tr_b16 a[26:27], v6 offset:51456
    ds_read_b64_tr_b16 a[28:29], v7 offset:49408
    ds_read_b64_tr_b16 a[30:31], v7 offset:51456
    s_add_u32 s57, s57, 31744
    buffer_load_dwordx4 v12, s[20:23], s57 offen offset:3072 lds
    s_add_u32 m0, s52, 49152
    s_lshl_b32 s57, s78, 7
    s_add_u32 s57, s57, 131072
    buffer_load_dwordx4 v12, s[20:23], s57 offen offset:0 lds
    s_add_u32 s57, s57, 31744
    buffer_load_dwordx4 v12, s[20:23], s57 offen offset:1024 lds
    s_waitcnt vmcnt(11)
    ds_read_b64_tr_b16 a[32:33], v8 offset:0
    ds_read_b64_tr_b16 a[34:35], v8 offset:2048
    ds_read_b64_tr_b16 a[36:37], v9 offset:0
    ds_read_b64_tr_b16 a[38:39], v9 offset:2048
    s_add_u32 s57, s57, 31744
    buffer_load_dwordx4 v12, s[20:23], s57 offen offset:2048 lds
    ds_read_b64_tr_b16 a[40:41], v8 offset:256
    ds_read_b64_tr_b16 a[42:43], v8 offset:2304
    ds_read_b64_tr_b16 a[44:45], v9 offset:256
    ds_read_b64_tr_b16 a[46:47], v9 offset:2304
    s_add_u32 s57, s57, 31744
    buffer_load_dwordx4 v12, s[20:23], s57 offen offset:3072 lds
    s_waitcnt vmcnt(11)
    s_barrier
    s_cmp_lg_u32 s44, 0
    s_cbranch_scc1 L_nopub6
    s_lshl_b32 s60, s51, 5
    s_add_u32 s60, s60, s50
    s_lshl_b32 s60, s60, 7
    s_add_u32 s60, s60, 12713984
    v_mov_b32 v30, s47
    s_mov_b64 exec, 1
    buffer_store_dword v30, off, s[24:27], s60 sc1
    s_mov_b64 exec, -1
L_nopub6:
L_p3join:
    v_lshlrev_b32 v224, 16, v224
    v_lshlrev_b32 v176, 16, v216
    v_and_b32 v177, s61, v216
    v_lshlrev_b32 v178, 16, v217
    s_add_u32 m0, s52, 65536
    s_lshl_b32 s57, s79, 7
    buffer_load_dwordx4 v12, s[20:23], s57 offen offset:0 lds
    v_and_b32 v179, s61, v217
    v_lshlrev_b32 v180, 16, v218
    v_and_b32 v181, s61, v218
    v_lshlrev_b32 v182, 16, v219
    s_add_u32 s57, s57, 31744
    buffer_load_dwordx4 v12, s[20:23], s57 offen offset:1024 lds
    s_waitcnt vmcnt(10)
    ds_read_b64_tr_b16 a[48:49], v8 offset:16384
    ds_read_b64_tr_b16 a[50:51], v8 offset:18432
    ds_read_b64_tr_b16 a[52:53], v9 offset:16384
    ds_read_b64_tr_b16 a[54:55], v9 offset:18432
    s_add_u32 s57, s57, 31744
    buffer_load_dwordx4 v12, s[20:23], s57 offen offset:2048 lds
    ds_read_b64_tr_b16 a[56:57], v8 offset:16640
    ds_read_b64_tr_b16 a[58:59], v8 offset:18688
    ds_read_b64_tr_b16 a[60:61], v9 offset:16640
    ds_read_b64_tr_b16 a[62:63], v9 offset:18688
    v_and_b32 v183, s61, v219
    v_add_f32 v176, v176, v224
    v_add_f32 v177, v177, v224
    v_add_f32 v178, v178, v224
    s_add_u32 s57, s57, 31744
    buffer_load_dwordx4 v12, s[20:23], s57 offen offset:3072 lds
    v_add_f32 v179, v179, v224
    v_add_f32 v180, v180, v224
    v_add_f32 v181, v181, v224
    v_add_f32 v182, v182, v224
    s_waitcnt lgkmcnt(15)
    s_add_u32 m0, s52, 81920
    s_lshl_b32 s57, s79, 7
    s_add_u32 s57, s57, 131072
    buffer_load_dwordx4 v12, s[20:23], s57 offen offset:0 lds
    v_add_f32 v183, v183, v224
    v_lshlrev_b32 v225, 16, v225
    v_lshlrev_b32 v184, 16, v220
    v_and_b32 v185, s61, v220
    s_add_u32 s57, s57, 31744
    buffer_load_dwordx4 v12, s[20:23], s57 offen offset:1024 lds
    s_waitcnt vmcnt(10)
    ds_read_b64_tr_b16 a[64:65], v8 offset:32768
    ds_read_b64_tr_b16 a[66:67], v8 offset:34816
    ds_read_b64_tr_b16 a[68:69], v9 offset:32768
    ds_read_b64_tr_b16 a[70:71], v9 offset:34816
    v_lshlrev_b32 v186, 16, v221
    v_and_b32 v187, s61, v221
    v_lshlrev_b32 v188, 16, v222
    v_and_b32 v189, s61, v222
    ds_read_b64_tr_b16 a[72:73], v8 offset:33024
    ds_read_b64_tr_b16 a[74:75], v8 offset:35072
    ds_read_b64_tr_b16 a[76:77], v9 offset:33024
    ds_read_b64_tr_b16 a[78:79], v9 offset:35072
    s_add_u32 s57, s57, 31744
    buffer_load_dwordx4 v12, s[20:23], s57 offen offset:2048 lds
    v_lshlrev_b32 v190, 16, v223
    v_and_b32 v191, s61, v223
    v_add_f32 v184, v184, v225
    v_add_f32 v185, v185, v225
    s_add_u32 s57, s57, 31744
    buffer_load_dwordx4 v12, s[20:23], s57 offen offset:3072 lds
    v_add_f32 v186, v186, v225
    v_add_f32 v187, v187, v225
    v_add_f32 v188, v188, v225
    v_add_f32 v189, v189, v225
    s_add_u32 m0, s52, 98304
    s_lshl_b32 s57, s80, 7
    buffer_load_dwordx4 v12, s[20:23], s57 offen offset:0 lds
    v_add_f32 v190, v190, v225
    v_add_f32 v191, v191, v225
    v_lshlrev_b32 v228, 16, v228
    v_lshlrev_b32 v232, 16, v226
    v_and_b32 v233, s61, v226
    v_lshlrev_b32 v234, 16, v227
    v_and_b32 v235, s61, v227
    v_add_f32 v232, v232, v228
    s_add_u32 s57, s57, 31744
    buffer_load_dwordx4 v12, s[20:23], s57 offen offset:1024 lds
    s_waitcnt vmcnt(10)
    ds_read_b64_tr_b16 a[80:81], v6 offset:0
    ds_read_b64_tr_b16 a[82:83], v6 offset:2048
    ds_read_b64_tr_b16 a[84:85], v7 offset:0
    ds_read_b64_tr_b16 a[86:87], v7 offset:2048
    s_add_u32 s57, s57, 31744
    buffer_load_dwordx4 v12, s[20:23], s57 offen offset:2048 lds
    ds_read_b64_tr_b16 a[88:89], v6 offset:256
    ds_read_b64_tr_b16 a[90:91], v6 offset:2304
    ds_read_b64_tr_b16 a[92:93], v7 offset:256
    ds_read_b64_tr_b16 a[94:95], v7 offset:2304
    s_add_u32 s57, s57, 31744
    buffer_load_dwordx4 v12, s[20:23], s57 offen offset:3072 lds
    v_add_f32 v233, v233, v228
    v_add_f32 v234, v234, v228
    v_add_f32 v235, v235, v228
    s_waitcnt lgkmcnt(15)
    s_add_u32 m0, s52, 114688
    s_lshl_b32 s57, s80, 7
    s_add_u32 s57, s57, 131072
    buffer_load_dwordx4 v12, s[20:23], s57 offen offset:0 lds
    s_add_u32 s57, s57, 31744
    buffer_load_dwordx4 v12, s[20:23], s57 offen offset:1024 lds
    s_waitcnt vmcnt(10)
    ds_read_b64_tr_b16 a[96:97], v6 offset:16384
    ds_read_b64_tr_b16 a[98:99], v6 offset:18432
    ds_read_b64_tr_b16 a[100:101], v7 offset:16384
    ds_read_b64_tr_b16 a[102:103], v7 offset:18432
    s_add_u32 s57, s57, 31744
    buffer_load_dwordx4 v12, s[20:23], s57 offen offset:2048 lds
    ds_read_b64_tr_b16 a[104:105], v6 offset:16640
    ds_read_b64_tr_b16 a[106:107], v6 offset:18688
    ds_read_b64_tr_b16 a[108:109], v7 offset:16640
    ds_read_b64_tr_b16 a[110:111], v7 offset:18688
    s_add_u32 s57, s57, 31744
    buffer_load_dwordx4 v12, s[20:23], s57 offen offset:3072 lds
    s_add_u32 m0, s52, 131072
    s_lshl_b32 s57, s81, 7
    buffer_load_dwordx4 v12, s[20:23], s57 offen offset:0 lds
    s_add_u32 s57, s57, 31744
    buffer_load_dwordx4 v12, s[20:23], s57 offen offset:1024 lds
    s_waitcnt vmcnt(10)
    ds_read_b64_tr_b16 a[112:113], v6 offset:32768
    ds_read_b64_tr_b16 a[114:115], v6 offset:34816
    ds_read_b64_tr_b16 a[116:117], v7 offset:32768
    ds_read_b64_tr_b16 a[118:119], v7 offset:34816
    s_add_u32 s57, s57, 31744
    buffer_load_dwordx4 v12, s[20:23], s57 offen offset:2048 lds
    ds_read_b64_tr_b16 a[120:121], v6 offset:33024
    ds_read_b64_tr_b16 a[122:123], v6 offset:35072
    ds_read_b64_tr_b16 a[124:125], v7 offset:33024
    ds_read_b64_tr_b16 a[126:127], v7 offset:35072
    s_add_u32 s57, s57, 31744
    buffer_load_dwordx4 v12, s[20:23], s57 offen offset:3072 lds
    s_waitcnt lgkmcnt(15)
    s_add_u32 m0, s52, 147456
    s_lshl_b32 s57, s81, 7
    s_add_u32 s57, s57, 131072
    buffer_load_dwordx4 v12, s[20:23], s57 offen offset:0 lds
    s_add_u32 s57, s57, 31744
    buffer_load_dwordx4 v12, s[20:23], s57 offen offset:1024 lds
    s_waitcnt vmcnt(10)
    ds_read_b64_tr_b16 a[128:129], v6 offset:49152
    ds_read_b64_tr_b16 a[130:131], v6 offset:51200
    ds_read_b64_tr_b16 a[132:133], v7 offset:49152
    ds_read_b64_tr_b16 a[134:135], v7 offset:51200
    s_add_u32 s57, s57, 31744
    buffer_load_dwordx4 v12, s[20:23], s57 offen offset:2048 lds
    ds_read_b64_tr_b16 a[136:137], v6 offset:49408
    ds_read_b64_tr_b16 a[138:139], v6 offset:51456
    ds_read_b64_tr_b16 a[140:141], v7 offset:49408
    ds_read_b64_tr_b16 a[142:143], v7 offset:51456
    s_add_u32 s57, s57, 31744
    buffer_load_dwordx4 v12, s[20:23], s57 offen offset:3072 lds
    s_add_u32 m0, s52, 49152
    s_lshl_b32 s57, s82, 7
    buffer_load_dwordx4 v12, s[20:23], s57 offen offset:0 lds
    s_add_u32 s57, s57, 31744
    buffer_load_dwordx4 v12, s[20:23], s57 offen offset:1024 lds
    s_waitcnt vmcnt(10)
    ds_read_b64_tr_b16 a[144:145], v8 offset:0
    ds_read_b64_tr_b16 a[146:147], v8 offset:2048
    ds_read_b64_tr_b16 a[148:149], v9 offset:0
    ds_read_b64_tr_b16 a[150:151], v9 offset:2048
    s_add_u32 s57, s57, 31744
    buffer_load_dwordx4 v12, s[20:23], s57 offen offset:2048 lds
    ds_read_b64_tr_b16 a[152:153], v8 offset:256
    ds_read_b64_tr_b16 a[154:155], v8 offset:2304
    ds_read_b64_tr_b16 a[156:157], v9 offset:256
    ds_read_b64_tr_b16 a[158:159], v9 offset:2304
    s_add_u32 s57, s57, 31744
    buffer_load_dwordx4 v12, s[20:23], s57 offen offset:3072 lds
    s_waitcnt lgkmcnt(15)
    s_add_u32 m0, s52, 65536
    s_lshl_b32 s57, s82, 7
    s_add_u32 s57, s57, 131072
    buffer_load_dwordx4 v12, s[20:23], s57 offen offset:0 lds
    s_add_u32 s57, s57, 31744
    buffer_load_dwordx4 v12, s[20:23], s57 offen offset:1024 lds
    s_waitcnt vmcnt(10)
    ds_read_b64_tr_b16 a[160:161], v8 offset:16384
    ds_read_b64_tr_b16 a[162:163], v8 offset:18432
    ds_read_b64_tr_b16 a[164:165], v9 offset:16384
    ds_read_b64_tr_b16 a[166:167], v9 offset:18432
    s_add_u32 s57, s57, 31744
    buffer_load_dwordx4 v12, s[20:23], s57 offen offset:2048 lds
    ds_read_b64_tr_b16 a[168:169], v8 offset:16640
    ds_read_b64_tr_b16 a[170:171], v8 offset:18688
    ds_read_b64_tr_b16 a[172:173], v9 offset:16640
    ds_read_b64_tr_b16 a[174:175], v9 offset:18688
    s_add_u32 s57, s57, 31744
    buffer_load_dwordx4 v12, s[20:23], s57 offen offset:3072 lds
    s_add_u32 m0, s52, 81920
    s_mov_b32 s57, s75
    buffer_load_dwordx4 v15, s[12:15], s57 offen offset:0 lds
    s_add_u32 s57, s57, 24064
    buffer_load_dwordx4 v15, s[12:15], s57 offen offset:1024 lds
    s_waitcnt vmcnt(10)
    ds_read_b64_tr_b16 a[176:177], v8 offset:32768
    ds_read_b64_tr_b16 a[178:179], v8 offset:34816
    ds_read_b64_tr_b16 a[180:181], v9 offset:32768
    ds_read_b64_tr_b16 a[182:183], v9 offset:34816
    s_add_u32 s57, s57, 24064
    buffer_load_dwordx4 v15, s[12:15], s57 offen offset:2048 lds
    ds_read_b64_tr_b16 a[184:185], v8 offset:33024
    ds_read_b64_tr_b16 a[186:187], v8 offset:35072
    ds_read_b64_tr_b16 a[188:189], v9 offset:33024
    ds_read_b64_tr_b16 a[190:191], v9 offset:35072
    s_add_u32 s57, s57, 24064
    buffer_load_dwordx4 v15, s[12:15], s57 offen offset:3072 lds
    s_waitcnt lgkmcnt(15)
    s_add_u32 m0, s52, 98304
    s_mov_b32 s57, 0
    buffer_load_dwordx4 v13, s[12:15], s57 offen offset:0 lds
    s_add_u32 s57, s57, 6144
    buffer_load_dwordx4 v14, s[12:15], s57 offen offset:1024 lds
    s_waitcnt vmcnt(10)
    ds_read_b64_tr_b16 a[192:193], v6 offset:0
    ds_read_b64_tr_b16 a[194:195], v6 offset:2048
    ds_read_b64_tr_b16 a[196:197], v7 offset:0
    ds_read_b64_tr_b16 a[198:199], v7 offset:2048
    s_add_u32 s57, s57, 6144
    buffer_load_dwordx4 v13, s[12:15], s57 offen offset:2048 lds
    ds_read_b64_tr_b16 a[200:201], v6 offset:256
    ds_read_b64_tr_b16 a[202:203], v6 offset:2304
    ds_read_b64_tr_b16 a[204:205], v7 offset:256
    ds_read_b64_tr_b16 a[206:207], v7 offset:2304
    s_add_u32 s57, s57, 6144
    buffer_load_dwordx4 v14, s[12:15], s57 offen offset:3072 lds
    s_add_u32 m0, s52, 114688
    s_mov_b32 s57, 25088
    buffer_load_dwordx4 v13, s[12:15], s57 offen offset:0 lds
    s_add_u32 s57, s57, 6144
    buffer_load_dwordx4 v14, s[12:15], s57 offen offset:1024 lds
    s_waitcnt vmcnt(10)
    ds_read_b64_tr_b16 a[208:209], v6 offset:16384
    ds_read_b64_tr_b16 a[210:211], v6 offset:18432
    ds_read_b64_tr_b16 a[212:213], v7 offset:16384
    ds_read_b64_tr_b16 a[214:215], v7 offset:18432
    buffer_load_dword v17, v20, s[24:27], 0 offen sc1
    ds_read_b64_tr_b16 a[216:217], v6 offset:16640
    ds_read_b64_tr_b16 a[218:219], v6 offset:18688
    ds_read_b64_tr_b16 a[220:221], v7 offset:16640
    ds_read_b64_tr_b16 a[222:223], v7 offset:18688
    s_add_u32 s57, s57, 6144
    buffer_load_dwordx4 v13, s[12:15], s57 offen offset:2048 lds
    s_add_u32 s57, s57, 6144
    buffer_load_dwordx4 v14, s[12:15], s57 offen offset:3072 lds
    s_waitcnt lgkmcnt(15)
    s_add_u32 m0, s52, 131072
    s_mov_b32 s57, 50176
    buffer_load_dwordx4 v13, s[12:15], s57 offen offset:0 lds
    s_waitcnt vmcnt(10)
    v_add_u32 v16, 81920, v16
    ds_read_b64_tr_b16 v[192:193], v16 offset:0
    ds_read_b64_tr_b16 v[194:195], v16 offset:128
    ds_read_b64_tr_b16 v[196:197], v16 offset:1024
    ds_read_b64_tr_b16 v[198:199], v16 offset:1152
    ds_read_b64_tr_b16 v[200:201], v16 offset:2048
    ds_read_b64_tr_b16 v[202:203], v16 offset:2176
    ds_read_b64_tr_b16 v[204:205], v16 offset:3072
    ds_read_b64_tr_b16 v[206:207], v16 offset:3200
    s_add_u32 s57, s57, 6144
    buffer_load_dwordx4 v14, s[12:15], s57 offen offset:1024 lds
    s_add_u32 s57, s57, 6144
    buffer_load_dwordx4 v13, s[12:15], s57 offen offset:2048 lds
    s_add_u32 s57, s57, 6144
    buffer_load_dwordx4 v14, s[12:15], s57 offen offset:3072 lds
    s_add_u32 m0, s52, 147456
    s_mov_b32 s57, 75264
    buffer_load_dwordx4 v13, s[12:15], s57 offen offset:0 lds
    s_waitcnt vmcnt(10)
    ds_read_b64_tr_b16 a[224:225], v2 offset:49152
    ds_read_b64_tr_b16 a[226:227], v2 offset:49664
    ds_read_b64_tr_b16 a[228:229], v3 offset:49152
    ds_read_b64_tr_b16 a[230:231], v3 offset:49664
    s_add_u32 s57, s57, 6144
    buffer_load_dwordx4 v14, s[12:15], s57 offen offset:1024 lds
    ds_read_b64_tr_b16 a[232:233], v2 offset:49408
    ds_read_b64_tr_b16 a[234:235], v2 offset:49920
    ds_read_b64_tr_b16 a[236:237], v3 offset:49408
    ds_read_b64_tr_b16 a[238:239], v3 offset:49920
    s_add_u32 s57, s57, 6144
    buffer_load_dwordx4 v13, s[12:15], s57 offen offset:2048 lds
    s_add_u32 s57, s57, 6144
    buffer_load_dwordx4 v14, s[12:15], s57 offen offset:3072 lds
    s_waitcnt vmcnt(10)
    v_cmp_ne_u32 vcc, s47, v17
    s_nop 0
    s_cbranch_vccz L_ok8
    s_mov_b32 s59, 20000
L_spin7:
    s_sleep 2
    buffer_load_dword v17, v20, s[24:27], 0 offen sc1
    s_waitcnt vmcnt(0)
    v_cmp_ne_u32 vcc, s47, v17
    s_nop 0
    s_cbranch_vccz L_ok8
    s_sub_u32 s59, s59, 1
    s_cbranch_scc0 L_spin7
L_ok8:
    s_cmp_ge_u32 s89, 4
    s_cbranch_scc1 L_p3_alt
    s_mov_b32 s66, s68
    s_add_u32 s58, s66, s76
    buffer_load_dwordx4 v[144:147], v23, s[24:27], s58 offen offset:0 sc1
    buffer_load_dwordx4 v[148:151], v23, s[24:27], s58 offen offset:1024 sc1
    s_waitcnt vmcnt(10)
    ds_read_b64_tr_b16 a[240:241], v4 offset:0
    ds_read_b64_tr_b16 a[242:243], v4 offset:512
    ds_read_b64_tr_b16 a[244:245], v5 offset:0
    ds_read_b64_tr_b16 a[246:247], v5 offset:512
    s_add_u32 s58, s66, s77
    buffer_load_dwordx4 v[152:155], v23, s[24:27], s58 offen offset:0 sc1
    ds_read_b64_tr_b16 a[248:249], v4 offset:256
    ds_read_b64_tr_b16 a[250:251], v4 offset:768
    ds_read_b64_tr_b16 a[252:253], v5 offset:256
    ds_read_b64_tr_b16 a[254:255], v5 offset:768
    buffer_load_dwordx4 v[156:159], v23, s[24:27], s58 offen offset:1024 sc1
    s_add_u32 s58, s66, s78
    buffer_load_dwordx4 v[112:115], v23, s[24:27], s58 offen offset:0 sc1
    buffer_load_dwordx4 v[116:119], v23, s[24:27], s58 offen offset:1024 sc1
    s_add_u32 s58, s66, s79
    buffer_load_dwordx4 v[120:123], v23, s[24:27], s58 offen offset:0 sc1
    buffer_load_dwordx4 v[124:127], v23, s[24:27], s58 offen offset:1024 sc1
    s_add_u32 s58, s66, s80
    buffer_load_dwordx4 v[128:131], v23, s[24:27], s58 offen offset:0 sc1
    buffer_load_dwordx4 v[132:135], v23, s[24:27], s58 offen offset:1024 sc1
    s_waitcnt vmcnt(9)
    v_mfma_f32_16x16x32_bf16 v[96:99], v[144:147], a[0:3], 0
    s_add_u32 s58, s66, s81
    v_mfma_f32_16x16x32_bf16 v[100:103], v[144:147], a[4:7], 0
    buffer_load_dwordx4 v[136:139], v23, s[24:27], s58 offen offset:0 sc1
    v_mfma_f32_16x16x32_bf16 v[104:107], v[144:147], a[8:11], 0
    v_mfma_f32_16x16x32_bf16 v[108:111], v[144:147], a[12:15], 0
    s_waitcnt vmcnt(9)
    v_mfma_f32_16x16x32_bf16 v[96:99], v[148:151], a[16:19], v[96:99]
    v_mfma_f32_16x16x32_bf16 v[100:103], v[148:151], a[20:23], v[100:103]
    buffer_load_dwordx4 v[140:143], v23, s[24:27], s58 offen offset:1024 sc1
    v_mfma_f32_16x16x32_bf16 v[104:107], v[148:151], a[24:27], v[104:107]
    v_mfma_f32_16x16x32_bf16 v[108:111], v[148:151], a[28:31], v[108:111]
    s_waitcnt vmcnt(9)
    v_mfma_f32_16x16x32_bf16 v[96:99], v[152:155], a[32:35], v[96:99]
    s_add_u32 s58, s66, s82
    v_mfma_f32_16x16x32_bf16 v[100:103], v[152:155], a[36:39], v[100:103]
    buffer_load_dwordx4 v[144:147], v23, s[24:27], s58 offen offset:0 sc1
    v_mfma_f32_16x16x32_bf16 v[104:107], v[152:155], a[40:43], v[104:107]
    v_mfma_f32_16x16x32_bf16 v[108:111], v[152:155], a[44:47], v[108:111]
    s_waitcnt vmcnt(9)
    v_mfma_f32_16x16x32_bf16 v[96:99], v[156:159], a[48:51], v[96:99]
    v_mfma_f32_16x16x32_bf16 v[100:103], v[156:159], a[52:55], v[100:103]
    buffer_load_dwordx4 v[148:151], v23, s[24:27], s58 offen offset:1024 sc1
    v_mfma_f32_16x16x32_bf16 v[104:107], v[156:159], a[56:59], v[104:107]
    v_mfma_f32_16x16x32_bf16 v[108:111], v[156:159], a[60:63], v[108:111]
    s_waitcnt vmcnt(9)
    v_mfma_f32_16x16x32_bf16 v[96:99], v[112:115], a[64:67], v[96:99]
    s_xor_b32 s66, s44, 3
    s_lshl2_add_u32 s66, s49, s66
    s_mul_i32 s66, s66, 58624
    s_add_u32 s66, s66, s69
    s_add_u32 s58, s66, s76
    v_mfma_f32_16x16x32_bf16 v[100:103], v[112:115], a[68:71], v[100:103]
    buffer_load_dwordx4 v[152:155], v23, s[24:27], s58 offen offset:0 sc1
    v_mfma_f32_16x16x32_bf16 v[104:107], v[112:115], a[72:75], v[104:107]
    v_mfma_f32_16x16x32_bf16 v[108:111], v[112:115], a[76:79], v[108:111]
    s_waitcnt vmcnt(9)
    v_mfma_f32_16x16x32_bf16 v[96:99], v[116:119], a[80:83], v[96:99]
    v_mfma_f32_16x16x32_bf16 v[100:103], v[116:119], a[84:87], v[100:103]
    buffer_load_dwordx4 v[156:159], v23, s[24:27], s58 offen offset:1024 sc1
    v_mfma_f32_16x16x32_bf16 v[104:107], v[116:119], a[88:91], v[104:107]
    v_mfma_f32_16x16x32_bf16 v[108:111], v[116:119], a[92:95], v[108:111]
    s_waitcnt vmcnt(9)
    v_mfma_f32_16x16x32_bf16 v[96:99], v[120:123], a[96:99], v[96:99]
    s_add_u32 s58, s66, s77
    v_mfma_f32_16x16x32_bf16 v[100:103], v[120:123], a[100:103], v[100:103]
    buffer_load_dwordx4 v[112:115], v23, s[24:27], s58 offen offset:0 sc1
    v_mfma_f32_16x16x32_bf16 v[104:107], v[120:123], a[104:107], v[104:107]
    v_mfma_f32_16x16x32_bf16 v[108:111], v[120:123], a[108:111], v[108:111]
    s_waitcnt vmcnt(9)
    v_mfma_f32_16x16x32_bf16 v[96:99], v[124:127], a[112:115], v[96:99]
    v_mfma_f32_16x16x32_bf16 v[100:103], v[124:127], a[116:119], v[100:103]
    buffer_load_dwordx4 v[116:119], v23, s[24:27], s58 offen offset:1024 sc1
    v_mfma_f32_16x16x32_bf16 v[104:107], v[124:127], a[120:123], v[104:107]
    v_mfma_f32_16x16x32_bf16 v[108:111], v[124:127], a[124:127], v[108:111]
    s_waitcnt vmcnt(9)
    v_mfma_f32_16x16x32_bf16 v[96:99], v[128:131], a[128:131], v[96:99]
    s_add_u32 s58, s66, s78
    v_mfma_f32_16x16x32_bf16 v[100:103], v[128:131], a[132:135], v[100:103]
    buffer_load_dwordx4 v[120:123], v23, s[24:27], s58 offen offset:0 sc1
    v_mfma_f32_16x16x32_bf16 v[104:107], v[128:131], a[136:139], v[104:107]
    v_mfma_f32_16x16x32_bf16 v[108:111], v[128:131], a[140:143], v[108:111]
    s_waitcnt vmcnt(9)
    v_mfma_f32_16x16x32_bf16 v[96:99], v[132:135], a[144:147], v[96:99]
    v_mfma_f32_16x16x32_bf16 v[100:103], v[132:135], a[148:151], v[100:103]
    buffer_load_dwordx4 v[124:127], v23, s[24:27], s58 offen offset:1024 sc1
    v_mfma_f32_16x16x32_bf16 v[104:107], v[132:135], a[152:155], v[104:107]
    v_mfma_f32_16x16x32_bf16 v[108:111], v[132:135], a[156:159], v[108:111]
    s_waitcnt vmcnt(9)
    v_mfma_f32_16x16x32_bf16 v[96:99], v[136:139], a[160:163], v[96:99]
    s_add_u32 s58, s66, s79
    v_mfma_f32_16x16x32_bf16 v[100:103], v[136:139], a[164:167], v[100:103]
    buffer_load_dwordx4 v[128:131], v23, s[24:27], s58 offen offset:0 sc1
    v_mfma_f32_16x16x32_bf16 v[104:107], v[136:139], a[168:171], v[104:107]
    v_mfma_f32_16x16x32_bf16 v[108:111], v[136:139], a[172:175], v[108:111]
    s_waitcnt vmcnt(9)
    v_mfma_f32_16x16x32_bf16 v[96:99], v[140:143], a[176:179], v[96:99]
    v_mfma_f32_16x16x32_bf16 v[100:103], v[140:143], a[180:183], v[100:103]
    buffer_load_dwordx4 v[132:135], v23, s[24:27], s58 offen offset:1024 sc1
    v_mfma_f32_16x16x32_bf16 v[104:107], v[140:143], a[184:187], v[104:107]
    v_mfma_f32_16x16x32_bf16 v[108:111], v[140:143], a[188:191], v[108:111]
    s_waitcnt vmcnt(9)
    s_waitcnt lgkmcnt(15)
    v_mfma_f32_16x16x32_bf16 v[96:99], v[144:147], a[192:195], v[96:99]
    s_add_u32 s58, s66, s80
    v_mfma_f32_16x16x32_bf16 v[100:103], v[144:147], a[196:199], v[100:103]
    buffer_load_dwordx4 v[136:139], v23, s[24:27], s58 offen offset:0 sc1
    v_mfma_f32_16x16x32_bf16 v[104:107], v[144:147], a[200:203], v[104:107]
    v_mfma_f32_16x16x32_bf16 v[108:111], v[144:147], a[204:207], v[108:111]
    s_waitcnt vmcnt(9)
    v_mfma_f32_16x16x32_bf16 v[96:99], v[148:151], a[208:211], v[96:99]
    v_mfma_f32_16x16x32_bf16 v[100:103], v[148:151], a[212:215], v[100:103]
    buffer_load_dwordx4 v[140:143], v23, s[24:27], s58 offen offset:1024 sc1
    v_mfma_f32_16x16x32_bf16 v[104:107], v[148:151], a[216:219], v[104:107]
    v_mfma_f32_16x16x32_bf16 v[108:111], v[148:151], a[220:223], v[108:111]
L_p3_join:
    s_waitcnt vmcnt(9)
    v_mfma_f32_16x16x32_bf16 v[80:83], v[152:155], a[0:3], 0
    s_add_u32 s58, s66, s81
    v_mfma_f32_16x16x32_bf16 v[84:87], v[152:155], a[4:7], 0
    buffer_load_dwordx4 v[144:147], v23, s[24:27], s58 offen offset:0 sc1
    v_mfma_f32_16x16x32_bf16 v[88:91], v[152:155], a[8:11], 0
    v_mfma_f32_16x16x32_bf16 v[92:95], v[152:155], a[12:15], 0
    s_waitcnt vmcnt(9)
    v_mfma_f32_16x16x32_bf16 v[80:83], v[156:159], a[16:19], v[80:83]
    v_mfma_f32_16x16x32_bf16 v[84:87], v[156:159], a[20:23], v[84:87]
    buffer_load_dwordx4 v[148:151], v23, s[24:27], s58 offen offset:1024 sc1
    v_mfma_f32_16x16x32_bf16 v[88:91], v[156:159], a[24:27], v[88:91]
    v_mfma_f32_16x16x32_bf16 v[92:95], v[156:159], a[28:31], v[92:95]
    s_waitcnt vmcnt(9)
    v_mfma_f32_16x16x32_bf16 v[80:83], v[112:115], a[32:35], v[80:83]
    s_add_u32 s58, s66, s82
    v_mfma_f32_16x16x32_bf16 v[84:87], v[112:115], a[36:39], v[84:87]
    buffer_load_dwordx4 v[152:155], v23, s[24:27], s58 offen offset:0 sc1
    v_mfma_f32_16x16x32_bf16 v[88:91], v[112:115], a[40:43], v[88:91]
    v_mfma_f32_16x16x32_bf16 v[92:95], v[112:115], a[44:47], v[92:95]
    s_waitcnt vmcnt(9)
    v_mfma_f32_16x16x32_bf16 v[80:83], v[116:119], a[48:51], v[80:83]
    v_mfma_f32_16x16x32_bf16 v[84:87], v[116:119], a[52:55], v[84:87]
    buffer_load_dwordx4 v[156:159], v23, s[24:27], s58 offen offset:1024 sc1
    v_mfma_f32_16x16x32_bf16 v[88:91], v[116:119], a[56:59], v[88:91]
    v_mfma_f32_16x16x32_bf16 v[92:95], v[116:119], a[60:63], v[92:95]
    s_waitcnt vmcnt(9)
    v_mfma_f32_16x16x32_bf16 v[80:83], v[120:123], a[64:67], v[80:83]
    s_xor_b32 s66, s44, 2
    s_lshl2_add_u32 s66, s49, s66
    s_mul_i32 s66, s66, 58624
    s_add_u32 s66, s66, s69
    s_add_u32 s58, s66, s76
    v_mfma_f32_16x16x32_bf16 v[84:87], v[120:123], a[68:71], v[84:87]
    buffer_load_dwordx4 v[112:115], v23, s[24:27], s58 offen offset:0 sc1
    v_mfma_f32_16x16x32_bf16 v[88:91], v[120:123], a[72:75], v[88:91]
    v_mfma_f32_16x16x32_bf16 v[92:95], v[120:123], a[76:79], v[92:95]
    s_waitcnt vmcnt(9)
    v_mfma_f32_16x16x32_bf16 v[80:83], v[124:127], a[80:83], v[80:83]
    v_mfma_f32_16x16x32_bf16 v[84:87], v[124:127], a[84:87], v[84:87]
    buffer_load_dwordx4 v[116:119], v23, s[24:27], s58 offen offset:1024 sc1
    v_mfma_f32_16x16x32_bf16 v[88:91], v[124:127], a[88:91], v[88:91]
    v_mfma_f32_16x16x32_bf16 v[92:95], v[124:127], a[92:95], v[92:95]
    s_waitcnt vmcnt(9)
    v_mfma_f32_16x16x32_bf16 v[80:83], v[128:131], a[96:99], v[80:83]
    s_add_u32 s58, s66, s77
    v_mfma_f32_16x16x32_bf16 v[84:87], v[128:131], a[100:103], v[84:87]
    buffer_load_dwordx4 v[120:123], v23, s[24:27], s58 offen offset:0 sc1
    v_mfma_f32_16x16x32_bf16 v[88:91], v[128:131], a[104:107], v[88:91]
    v_mfma_f32_16x16x32_bf16 v[92:95], v[128:131], a[108:111], v[92:95]
    s_waitcnt vmcnt(9)
    v_mfma_f32_16x16x32_bf16 v[80:83], v[132:135], a[112:115], v[80:83]
    v_mfma_f32_16x16x32_bf16 v[84:87], v[132:135], a[116:119], v[84:87]
    buffer_load_dwordx4 v[124:127], v23, s[24:27], s58 offen offset:1024 sc1
    v_mfma_f32_16x16x32_bf16 v[88:91], v[132:135], a[120:123], v[88:91]
    v_mfma_f32_16x16x32_bf16 v[92:95], v[132:135], a[124:127], v[92:95]
    buffer_load_dword v19, v21, s[24:27], 0 offen sc1
    s_waitcnt vmcnt(10)
    v_mfma_f32_16x16x32_bf16 v[80:83], v[136:139], a[128:131], v[80:83]
    v_mfma_f32_16x16x32_bf16 v[84:87], v[136:139], a[132:135], v[84:87]
    v_mfma_f32_16x16x32_bf16 v[88:91], v[136:139], a[136:139], v[88:91]
    v_mfma_f32_16x16x32_bf16 v[92:95], v[136:139], a[140:143], v[92:95]
    s_waitcnt vmcnt(9)
    v_mfma_f32_16x16x32_bf16 v[80:83], v[140:143], a[144:147], v[80:83]
    s_add_u32 s58, s66, s78
    v_mfma_f32_16x16x32_bf16 v[84:87], v[140:143], a[148:151], v[84:87]
    buffer_load_dwordx4 v[128:131], v23, s[24:27], s58 offen offset:0 sc1
    v_mfma_f32_16x16x32_bf16 v[88:91], v[140:143], a[152:155], v[88:91]
    v_mfma_f32_16x16x32_bf16 v[92:95], v[140:143], a[156:159], v[92:95]
    s_waitcnt vmcnt(9)
    v_mfma_f32_16x16x32_bf16 v[80:83], v[144:147], a[160:163], v[80:83]
    v_mfma_f32_16x16x32_bf16 v[84:87], v[144:147], a[164:167], v[84:87]
    buffer_load_dwordx4 v[132:135], v23, s[24:27], s58 offen offset:1024 sc1
    v_mfma_f32_16x16x32_bf16 v[88:91], v[144:147], a[168:171], v[88:91]
    v_mfma_f32_16x16x32_bf16 v[92:95], v[144:147], a[172:175], v[92:95]
    s_waitcnt vmcnt(9)
    v_mfma_f32_16x16x32_bf16 v[80:83], v[148:151], a[176:179], v[80:83]
    s_add_u32 s58, s66, s79
    v_mfma_f32_16x16x32_bf16 v[84:87], v[148:151], a[180:183], v[84:87]
    buffer_load_dwordx4 v[136:139], v23, s[24:27], s58 offen offset:0 sc1
    v_mfma_f32_16x16x32_bf16 v[88:91], v[148:151], a[184:187], v[88:91]
    v_mfma_f32_16x16x32_bf16 v[92:95], v[148:151], a[188:191], v[92:95]
    s_waitcnt vmcnt(9)
    v_mfma_f32_16x16x32_bf16 v[80:83], v[152:155], a[192:195], v[80:83]
    v_mfma_f32_16x16x32_bf16 v[84:87], v[152:155], a[196:199], v[84:87]
    buffer_load_dwordx4 v[140:143], v23, s[24:27], s58 offen offset:1024 sc1
    v_mfma_f32_16x16x32_bf16 v[88:91], v[152:155], a[200:203], v[88:91]
    v_mfma_f32_16x16x32_bf16 v[92:95], v[152:155], a[204:207], v[92:95]
    s_waitcnt vmcnt(9)
    v_mfma_f32_16x16x32_bf16 v[80:83], v[156:159], a[208:211], v[80:83]
    s_add_u32 s58, s66, s80
    v_mfma_f32_16x16x32_bf16 v[84:87], v[156:159], a[212:215], v[84:87]
    buffer_load_dwordx4 v[144:147], v23, s[24:27], s58 offen offset:0 sc1
    v_mfma_f32_16x16x32_bf16 v[88:91], v[156:159], a[216:219], v[88:91]
    v_mfma_f32_16x16x32_bf16 v[92:95], v[156:159], a[220:223], v[92:95]
    s_waitcnt vmcnt(9)
    v_mfma_f32_16x16x32_bf16 v[64:67], v[112:115], a[0:3], 0
    v_mfma_f32_16x16x32_bf16 v[68:71], v[112:115], a[4:7], 0
    buffer_load_dwordx4 v[148:151], v23, s[24:27], s58 offen offset:1024 sc1
    v_mfma_f32_16x16x32_bf16 v[72:75], v[112:115], a[8:11], 0
    v_mfma_f32_16x16x32_bf16 v[76:79], v[112:115], a[12:15], 0
    s_waitcnt vmcnt(9)
    v_mfma_f32_16x16x32_bf16 v[64:67], v[116:119], a[16:19], v[64:67]
    s_add_u32 s58, s66, s81
    v_mfma_f32_16x16x32_bf16 v[68:71], v[116:119], a[20:23], v[68:71]
    buffer_load_dwordx4 v[152:155], v23, s[24:27], s58 offen offset:0 sc1
    v_mfma_f32_16x16x32_bf16 v[72:75], v[116:119], a[24:27], v[72:75]
    v_mfma_f32_16x16x32_bf16 v[76:79], v[116:119], a[28:31], v[76:79]
    s_waitcnt vmcnt(9)
    v_mfma_f32_16x16x32_bf16 v[64:67], v[120:123], a[32:35], v[64:67]
    v_mfma_f32_16x16x32_bf16 v[68:71], v[120:123], a[36:39], v[68:71]
    buffer_load_dwordx4 v[156:159], v23, s[24:27], s58 offen offset:1024 sc1
    v_mfma_f32_16x16x32_bf16 v[72:75], v[120:123], a[40:43], v[72:75]
    v_mfma_f32_16x16x32_bf16 v[76:79], v[120:123], a[44:47], v[76:79]
    s_waitcnt vmcnt(9)
    v_mfma_f32_16x16x32_bf16 v[64:67], v[124:127], a[48:51], v[64:67]
    s_add_u32 s58, s66, s82
    v_mfma_f32_16x16x32_bf16 v[68:71], v[124:127], a[52:55], v[68:71]
    buffer_load_dwordx4 v[112:115], v23, s[24:27], s58 offen offset:0 sc1
    v_mfma_f32_16x16x32_bf16 v[72:75], v[124:127], a[56:59], v[72:75]
    v_mfma_f32_16x16x32_bf16 v[76:79], v[124:127], a[60:63], v[76:79]
    buffer_load_dwordx4 v[116:119], v23, s[24:27], s58 offen offset:1024 sc1
    s_waitcnt vmcnt(10)
    v_cmp_ne_u32 vcc, s47, v19
    s_nop 0
    s_cbranch_vccz L_ok10
    s_mov_b32 s59, 20000
L_spin9:
    s_sleep 2
    buffer_load_dword v19, v21, s[24:27], 0 offen sc1
    s_waitcnt vmcnt(0)
    v_cmp_ne_u32 vcc, s47, v19
    s_nop 0
    s_cbranch_vccz L_ok10
    s_sub_u32 s59, s59, 1
    s_cbranch_scc0 L_spin9
L_ok10:
    s_waitcnt vmcnt(9)
    v_mfma_f32_16x16x32_bf16 v[64:67], v[128:131], a[64:67], v[64:67]
    s_add_u32 s58, s70, 0
    v_mfma_f32_16x16x32_bf16 v[68:71], v[128:131], a[68:71], v[68:71]
    buffer_load_dwordx4 v[120:123], v23, s[24:27], s58 offen offset:0 sc1
    v_mfma_f32_16x16x32_bf16 v[72:75], v[128:131], a[72:75], v[72:75]
    v_mfma_f32_16x16x32_bf16 v[76:79], v[128:131], a[76:79], v[76:79]
    s_waitcnt vmcnt(9)
    v_mfma_f32_16x16x32_bf16 v[64:67], v[132:135], a[80:83], v[64:67]
    s_add_u32 s58, s70, 16384
    v_mfma_f32_16x16x32_bf16 v[68:71], v[132:135], a[84:87], v[68:71]
    buffer_load_dwordx4 v[124:127], v23, s[24:27], s58 offen offset:0 sc1
    v_mfma_f32_16x16x32_bf16 v[72:75], v[132:135], a[88:91], v[72:75]
    v_mfma_f32_16x16x32_bf16 v[76:79], v[132:135], a[92:95], v[76:79]
    s_waitcnt vmcnt(9)
    v_mfma_f32_16x16x32_bf16 v[64:67], v[136:139], a[96:99], v[64:67]
    s_add_u32 s58, s70, 32768
    v_mfma_f32_16x16x32_bf16 v[68:71], v[136:139], a[100:103], v[68:71]
    buffer_load_dwordx4 v[128:131], v23, s[24:27], s58 offen offset:0 sc1
    v_mfma_f32_16x16x32_bf16 v[72:75], v[136:139], a[104:107], v[72:75]
    v_mfma_f32_16x16x32_bf16 v[76:79], v[136:139], a[108:111], v[76:79]
    s_waitcnt vmcnt(9)
    v_mfma_f32_16x16x32_bf16 v[64:67], v[140:143], a[112:115], v[64:67]
    s_add_u32 s58, s70, 49152
    v_mfma_f32_16x16x32_bf16 v[68:71], v[140:143], a[116:119], v[68:71]
    buffer_load_dwordx4 v[132:135], v23, s[24:27], s58 offen offset:0 sc1
    v_mfma_f32_16x16x32_bf16 v[72:75], v[140:143], a[120:123], v[72:75]
    v_mfma_f32_16x16x32_bf16 v[76:79], v[140:143], a[124:127], v[76:79]
    s_waitcnt vmcnt(9)
    v_mfma_f32_16x16x32_bf16 v[64:67], v[144:147], a[128:131], v[64:67]
    s_add_u32 s58, s70, 0
    v_mfma_f32_16x16x32_bf16 v[68:71], v[144:147], a[132:135], v[68:71]
    buffer_load_dwordx4 v[136:139], v23, s[24:27], s58 offen offset:1024 sc1
    v_mfma_f32_16x16x32_bf16 v[72:75], v[144:147], a[136:139], v[72:75]
    v_mfma_f32_16x16x32_bf16 v[76:79], v[144:147], a[140:143], v[76:79]
    s_waitcnt vmcnt(9)
    v_mfma_f32_16x16x32_bf16 v[64:67], v[148:151], a[144:147], v[64:67]
    s_add_u32 s58, s70, 16384
    v_mfma_f32_16x16x32_bf16 v[68:71], v[148:151], a[148:151], v[68:71]
    buffer_load_dwordx4 v[140:143], v23, s[24:27], s58 offen offset:1024 sc1
    v_mfma_f32_16x16x32_bf16 v[72:75], v[148:151], a[152:155], v[72:75]
    v_mfma_f32_16x16x32_bf16 v[76:79], v[148:151], a[156:159], v[76:79]
    s_waitcnt vmcnt(9)
    v_mfma_f32_16x16x32_bf16 v[64:67], v[152:155], a[160:163], v[64:67]
    s_add_u32 s58, s70, 32768
    v_mfma_f32_16x16x32_bf16 v[68:71], v[152:155], a[164:167], v[68:71]
    buffer_load_dwordx4 v[144:147], v23, s[24:27], s58 offen offset:1024 sc1
    v_mfma_f32_16x16x32_bf16 v[72:75], v[152:155], a[168:171], v[72:75]
    v_mfma_f32_16x16x32_bf16 v[76:79], v[152:155], a[172:175], v[76:79]
    s_waitcnt vmcnt(9)
    v_mfma_f32_16x16x32_bf16 v[64:67], v[156:159], a[176:179], v[64:67]
    s_add_u32 s58, s70, 49152
    v_mfma_f32_16x16x32_bf16 v[68:71], v[156:159], a[180:183], v[68:71]
    buffer_load_dwordx4 v[148:151], v23, s[24:27], s58 offen offset:1024 sc1
    v_mfma_f32_16x16x32_bf16 v[72:75], v[156:159], a[184:187], v[72:75]
    v_mfma_f32_16x16x32_bf16 v[76:79], v[156:159], a[188:191], v[76:79]
    s_waitcnt vmcnt(9)
    v_mfma_f32_16x16x32_bf16 v[64:67], v[112:115], a[192:195], v[64:67]
    s_add_u32 s58, s70, 0
    v_mfma_f32_16x16x32_bf16 v[68:71], v[112:115], a[196:199], v[68:71]
    buffer_load_dwordx4 v[152:155], v23, s[24:27], s58 offen offset:2048 sc1
    v_mfma_f32_16x16x32_bf16 v[72:75], v[112:115], a[200:203], v[72:75]
    v_mfma_f32_16x16x32_bf16 v[76:79], v[112:115], a[204:207], v[76:79]
    s_waitcnt vmcnt(9)
    v_mfma_f32_16x16x32_bf16 v[64:67], v[116:119], a[208:211], v[64:67]
    s_add_u32 s58, s70, 16384
    v_mfma_f32_16x16x32_bf16 v[68:71], v[116:119], a[212:215], v[68:71]
    buffer_load_dwordx4 v[156:159], v23, s[24:27], s58 offen offset:2048 sc1
    v_mfma_f32_16x16x32_bf16 v[72:75], v[116:119], a[216:219], v[72:75]
    v_mfma_f32_16x16x32_bf16 v[76:79], v[116:119], a[220:223], v[76:79]
    s_waitcnt vmcnt(9)
    s_waitcnt lgkmcnt(8)
    v_mfma_f32_16x16x32_bf16 v[32:35], a[224:227], v[120:123], 0
    s_add_u32 s58, s70, 32768
    v_mfma_f32_16x16x32_bf16 v[48:51], a[228:231], v[120:123], 0
    buffer_load_dwordx4 v[112:115], v23, s[24:27], s58 offen offset:2048 sc1
    v_mfma_f32_16x16x32_bf16 v[64:67], a[232:235], v[120:123], v[64:67]
    v_mfma_f32_16x16x32_bf16 v[80:83], a[236:239], v[120:123], v[80:83]
    v_mfma_f32_16x16x32_bf16 v[96:99], v[192:195], v[120:123], v[96:99]
    s_waitcnt vmcnt(9)
    v_mfma_f32_16x16x32_bf16 v[36:39], a[224:227], v[124:127], 0
    s_add_u32 s58, s70, 49152
    v_mfma_f32_16x16x32_bf16 v[52:55], a[228:231], v[124:127], 0
    buffer_load_dwordx4 v[116:119], v23, s[24:27], s58 offen offset:2048 sc1
    v_mfma_f32_16x16x32_bf16 v[68:71], a[232:235], v[124:127], v[68:71]
    v_mfma_f32_16x16x32_bf16 v[84:87], a[236:239], v[124:127], v[84:87]
    v_mfma_f32_16x16x32_bf16 v[100:103], v[192:195], v[124:127], v[100:103]
    s_waitcnt vmcnt(9)
    v_mfma_f32_16x16x32_bf16 v[40:43], a[224:227], v[128:131], 0
    s_add_u32 s58, s70, 0
    v_mfma_f32_16x16x32_bf16 v[56:59], a[228:231], v[128:131], 0
    buffer_load_dwordx4 v[120:123], v23, s[24:27], s58 offen offset:3072 sc1
    v_mfma_f32_16x16x32_bf16 v[72:75], a[232:235], v[128:131], v[72:75]
    v_mfma_f32_16x16x32_bf16 v[88:91], a[236:239], v[128:131], v[88:91]
    v_mfma_f32_16x16x32_bf16 v[104:107], v[192:195], v[128:131], v[104:107]
    s_waitcnt vmcnt(9)
    v_mfma_f32_16x16x32_bf16 v[44:47], a[224:227], v[132:135], 0
    s_add_u32 s58, s70, 16384
    v_mfma_f32_16x16x32_bf16 v[60:63], a[228:231], v[132:135], 0
    buffer_load_dwordx4 v[124:127], v23, s[24:27], s58 offen offset:3072 sc1
    v_mfma_f32_16x16x32_bf16 v[76:79], a[232:235], v[132:135], v[76:79]
    v_mfma_f32_16x16x32_bf16 v[92:95], a[236:239], v[132:135], v[92:95]
    v_mfma_f32_16x16x32_bf16 v[108:111], v[192:195], v[132:135], v[108:111]
    ds_read_b64_tr_b16 a[224:225], v4 offset:16384
    ds_read_b64_tr_b16 a[226:227], v4 offset:16896
    ds_read_b64_tr_b16 a[228:229], v5 offset:16384
    ds_read_b64_tr_b16 a[230:231], v5 offset:16896
    s_waitcnt vmcnt(9)
    s_waitcnt lgkmcnt(4)
    v_mfma_f32_16x16x32_bf16 v[32:35], a[240:243], v[136:139], v[32:35]
    s_add_u32 s58, s70, 32768
    v_mfma_f32_16x16x32_bf16 v[48:51], a[244:247], v[136:139], v[48:51]
    buffer_load_dwordx4 v[128:131], v23, s[24:27], s58 offen offset:3072 sc1
    v_mfma_f32_16x16x32_bf16 v[64:67], a[248:251], v[136:139], v[64:67]
    v_mfma_f32_16x16x32_bf16 v[80:83], a[252:255], v[136:139], v[80:83]
    v_mfma_f32_16x16x32_bf16 v[96:99], v[196:199], v[136:139], v[96:99]
    ds_read_b64_tr_b16 a[232:233], v4 offset:16640
    ds_read_b64_tr_b16 a[234:235], v4 offset:17152
    ds_read_b64_tr_b16 a[236:237], v5 offset:16640
    ds_read_b64_tr_b16 a[238:239], v5 offset:17152
    s_waitcnt vmcnt(9)
    v_mfma_f32_16x16x32_bf16 v[36:39], a[240:243], v[140:143], v[36:39]
    s_add_u32 s58, s70, 49152
    v_mfma_f32_16x16x32_bf16 v[52:55], a[244:247], v[140:143], v[52:55]
    buffer_load_dwordx4 v[132:135], v23, s[24:27], s58 offen offset:3072 sc1
    v_mfma_f32_16x16x32_bf16 v[68:71], a[248:251], v[140:143], v[68:71]
    v_mfma_f32_16x16x32_bf16 v[84:87], a[252:255], v[140:143], v[84:87]
    v_mfma_f32_16x16x32_bf16 v[100:103], v[196:199], v[140:143], v[100:103]
    s_waitcnt vmcnt(9)
    v_mfma_f32_16x16x32_bf16 v[40:43], a[240:243], v[144:147], v[40:43]
    s_xor_b32 s66, s44, 1
    s_lshl2_add_u32 s66, s49, s66
    s_mul_i32 s66, s66, 58624
    s_add_u32 s66, s66, s69
    s_add_u32 s58, s66, s76
    v_mfma_f32_16x16x32_bf16 v[56:59], a[244:247], v[144:147], v[56:59]
    buffer_load_dwordx4 v[136:139], v23, s[24:27], s58 offen offset:0 sc1
    v_mfma_f32_16x16x32_bf16 v[72:75], a[248:251], v[144:147], v[72:75]
    v_mfma_f32_16x16x32_bf16 v[88:91], a[252:255], v[144:147], v[88:91]
    v_mfma_f32_16x16x32_bf16 v[104:107], v[196:199], v[144:147], v[104:107]
    s_waitcnt vmcnt(9)
    v_mfma_f32_16x16x32_bf16 v[44:47], a[240:243], v[148:151], v[44:47]
    v_mfma_f32_16x16x32_bf16 v[60:63], a[244:247], v[148:151], v[60:63]
    buffer_load_dwordx4 v[140:143], v23, s[24:27], s58 offen offset:1024 sc1
    v_mfma_f32_16x16x32_bf16 v[76:79], a[248:251], v[148:151], v[76:79]
    v_mfma_f32_16x16x32_bf16 v[92:95], a[252:255], v[148:151], v[92:95]
    v_mfma_f32_16x16x32_bf16 v[108:111], v[196:199], v[148:151], v[108:111]
    ds_read_b64_tr_b16 a[240:241], v4 offset:32768
    ds_read_b64_tr_b16 a[242:243], v4 offset:33280
    ds_read_b64_tr_b16 a[244:245], v5 offset:32768
    ds_read_b64_tr_b16 a[246:247], v5 offset:33280
    s_waitcnt vmcnt(9)
    s_waitcnt lgkmcnt(4)
    v_mfma_f32_16x16x32_bf16 v[32:35], a[224:227], v[152:155], v[32:35]
    s_add_u32 s58, s66, s77
    v_mfma_f32_16x16x32_bf16 v[48:51], a[228:231], v[152:155], v[48:51]
    buffer_load_dwordx4 v[144:147], v23, s[24:27], s58 offen offset:0 sc1
    v_mfma_f32_16x16x32_bf16 v[64:67], a[232:235], v[152:155], v[64:67]
    v_mfma_f32_16x16x32_bf16 v[80:83], a[236:239], v[152:155], v[80:83]
    v_mfma_f32_16x16x32_bf16 v[96:99], v[200:203], v[152:155], v[96:99]
    ds_read_b64_tr_b16 a[248:249], v4 offset:33024
    ds_read_b64_tr_b16 a[250:251], v4 offset:33536
    ds_read_b64_tr_b16 a[252:253], v5 offset:33024
    ds_read_b64_tr_b16 a[254:255], v5 offset:33536
    s_waitcnt vmcnt(9)
    v_mfma_f32_16x16x32_bf16 v[36:39], a[224:227], v[156:159], v[36:39]
    v_mfma_f32_16x16x32_bf16 v[52:55], a[228:231], v[156:159], v[52:55]
    buffer_load_dwordx4 v[148:151], v23, s[24:27], s58 offen offset:1024 sc1
    v_mfma_f32_16x16x32_bf16 v[68:71], a[232:235], v[156:159], v[68:71]
    v_mfma_f32_16x16x32_bf16 v[84:87], a[236:239], v[156:159], v[84:87]
    v_mfma_f32_16x16x32_bf16 v[100:103], v[200:203], v[156:159], v[100:103]
    s_waitcnt vmcnt(9)
    v_mfma_f32_16x16x32_bf16 v[40:43], a[224:227], v[112:115], v[40:43]
    s_add_u32 s58, s66, s78
    v_mfma_f32_16x16x32_bf16 v[56:59], a[228:231], v[112:115], v[56:59]
    buffer_load_dwordx4 v[152:155], v23, s[24:27], s58 offen offset:0 sc1
    v_mfma_f32_16x16x32_bf16 v[72:75], a[232:235], v[112:115], v[72:75]
    v_mfma_f32_16x16x32_bf16 v[88:91], a[236:239], v[112:115], v[88:91]
    v_mfma_f32_16x16x32_bf16 v[104:107], v[200:203], v[112:115], v[104:107]
    s_waitcnt vmcnt(9)
    v_mfma_f32_16x16x32_bf16 v[44:47], a[224:227], v[116:119], v[44:47]
    v_mfma_f32_16x16x32_bf16 v[60:63], a[228:231], v[116:119], v[60:63]
    buffer_load_dwordx4 v[156:159], v23, s[24:27], s58 offen offset:1024 sc1
    v_mfma_f32_16x16x32_bf16 v[76:79], a[232:235], v[116:119], v[76:79]
    v_mfma_f32_16x16x32_bf16 v[92:95], a[236:239], v[116:119], v[92:95]
    v_mfma_f32_16x16x32_bf16 v[108:111], v[200:203], v[116:119], v[108:111]
    s_waitcnt vmcnt(9)
    s_waitcnt lgkmcnt(0)
    v_mfma_f32_16x16x32_bf16 v[32:35], a[240:243], v[120:123], v[32:35]
    s_add_u32 s58, s66, s79
    v_mfma_f32_16x16x32_bf16 v[48:51], a[244:247], v[120:123], v[48:51]
    buffer_load_dwordx4 v[112:115], v23, s[24:27], s58 offen offset:0 sc1
    v_mfma_f32_16x16x32_bf16 v[64:67], a[248:251], v[120:123], v[64:67]
    v_mfma_f32_16x16x32_bf16 v[80:83], a[252:255], v[120:123], v[80:83]
    v_mfma_f32_16x16x32_bf16 v[96:99], v[204:207], v[120:123], v[96:99]
    s_waitcnt vmcnt(9)
    v_mfma_f32_16x16x32_bf16 v[36:39], a[240:243], v[124:127], v[36:39]
    v_mfma_f32_16x16x32_bf16 v[52:55], a[244:247], v[124:127], v[52:55]
    buffer_load_dwordx4 v[116:119], v23, s[24:27], s58 offen offset:1024 sc1
    v_mfma_f32_16x16x32_bf16 v[68:71], a[248:251], v[124:127], v[68:71]
    v_mfma_f32_16x16x32_bf16 v[84:87], a[252:255], v[124:127], v[84:87]
    v_mfma_f32_16x16x32_bf16 v[100:103], v[204:207], v[124:127], v[100:103]
    s_waitcnt vmcnt(9)
    v_mfma_f32_16x16x32_bf16 v[40:43], a[240:243], v[128:131], v[40:43]
    s_add_u32 s58, s66, s80
    v_mfma_f32_16x16x32_bf16 v[56:59], a[244:247], v[128:131], v[56:59]
    buffer_load_dwordx4 v[120:123], v23, s[24:27], s58 offen offset:0 sc1
    v_mfma_f32_16x16x32_bf16 v[72:75], a[248:251], v[128:131], v[72:75]
    v_mfma_f32_16x16x32_bf16 v[88:91], a[252:255], v[128:131], v[88:91]
    v_mfma_f32_16x16x32_bf16 v[104:107], v[204:207], v[128:131], v[104:107]
    s_waitcnt vmcnt(9)
    v_mfma_f32_16x16x32_bf16 v[44:47], a[240:243], v[132:135], v[44:47]
    v_mfma_f32_16x16x32_bf16 v[60:63], a[244:247], v[132:135], v[60:63]
    buffer_load_dwordx4 v[124:127], v23, s[24:27], s58 offen offset:1024 sc1
    v_mfma_f32_16x16x32_bf16 v[76:79], a[248:251], v[132:135], v[76:79]
    v_mfma_f32_16x16x32_bf16 v[92:95], a[252:255], v[132:135], v[92:95]
    v_mfma_f32_16x16x32_bf16 v[108:111], v[204:207], v[132:135], v[108:111]
    s_waitcnt vmcnt(9)
    v_mfma_f32_16x16x32_bf16 v[48:51], v[136:139], a[0:3], v[48:51]
    s_add_u32 s58, s66, s81
    v_mfma_f32_16x16x32_bf16 v[52:55], v[136:139], a[4:7], v[52:55]
    buffer_load_dwordx4 v[128:131], v23, s[24:27], s58 offen offset:0 sc1
    v_mfma_f32_16x16x32_bf16 v[56:59], v[136:139], a[8:11], v[56:59]
    v_mfma_f32_16x16x32_bf16 v[60:63], v[136:139], a[12:15], v[60:63]
    s_waitcnt vmcnt(9)
    v_mfma_f32_16x16x32_bf16 v[48:51], v[140:143], a[16:19], v[48:51]
    v_mfma_f32_16x16x32_bf16 v[52:55], v[140:143], a[20:23], v[52:55]
    buffer_load_dwordx4 v[132:135], v23, s[24:27], s58 offen offset:1024 sc1
    v_mfma_f32_16x16x32_bf16 v[56:59], v[140:143], a[24:27], v[56:59]
    v_mfma_f32_16x16x32_bf16 v[60:63], v[140:143], a[28:31], v[60:63]
    s_waitcnt vmcnt(9)
    v_mfma_f32_16x16x32_bf16 v[48:51], v[144:147], a[32:35], v[48:51]
    s_add_u32 s58, s66, s82
    v_mfma_f32_16x16x32_bf16 v[52:55], v[144:147], a[36:39], v[52:55]
    buffer_load_dwordx4 v[136:139], v23, s[24:27], s58 offen offset:0 sc1
    v_mfma_f32_16x16x32_bf16 v[56:59], v[144:147], a[40:43], v[56:59]
    ds_write_b128 v242, v[96:99] offset:0
    v_mfma_f32_16x16x32_bf16 v[60:63], v[144:147], a[44:47], v[60:63]
    s_waitcnt vmcnt(9)
    v_mfma_f32_16x16x32_bf16 v[48:51], v[148:151], a[48:51], v[48:51]
    v_mfma_f32_16x16x32_bf16 v[52:55], v[148:151], a[52:55], v[52:55]
    buffer_load_dwordx4 v[140:143], v23, s[24:27], s58 offen offset:1024 sc1
    v_mfma_f32_16x16x32_bf16 v[56:59], v[148:151], a[56:59], v[56:59]
    ds_write_b128 v242, v[100:103] offset:1024
    v_mfma_f32_16x16x32_bf16 v[60:63], v[148:151], a[60:63], v[60:63]
    s_waitcnt vmcnt(9)
    v_mfma_f32_16x16x32_bf16 v[48:51], v[152:155], a[64:67], v[48:51]
    s_xor_b32 s66, s44, 0
    s_lshl2_add_u32 s66, s49, s66
    s_mul_i32 s66, s66, 58624
    s_add_u32 s66, s66, s69
    s_add_u32 s58, s66, s76
    v_mfma_f32_16x16x32_bf16 v[52:55], v[152:155], a[68:71], v[52:55]
    buffer_load_dwordx4 v[144:147], v23, s[24:27], s58 offen offset:0 sc1
    v_mfma_f32_16x16x32_bf16 v[56:59], v[152:155], a[72:75], v[56:59]
    ds_write_b128 v242, v[104:107] offset:2048
    v_mfma_f32_16x16x32_bf16 v[60:63], v[152:155], a[76:79], v[60:63]
    s_waitcnt vmcnt(9)
    v_mfma_f32_16x16x32_bf16 v[48:51], v[156:159], a[80:83], v[48:51]
    v_mfma_f32_16x16x32_bf16 v[52:55], v[156:159], a[84:87], v[52:55]
    buffer_load_dwordx4 v[148:151], v23, s[24:27], s58 offen offset:1024 sc1
    v_mfma_f32_16x16x32_bf16 v[56:59], v[156:159], a[88:91], v[56:59]
    ds_write_b128 v242, v[108:111] offset:3072
    v_mfma_f32_16x16x32_bf16 v[60:63], v[156:159], a[92:95], v[60:63]
    s_waitcnt vmcnt(9)
    v_mfma_f32_16x16x32_bf16 v[48:51], v[112:115], a[96:99], v[48:51]
    s_add_u32 s58, s66, s77
    v_mfma_f32_16x16x32_bf16 v[52:55], v[112:115], a[100:103], v[52:55]
    buffer_load_dwordx4 v[152:155], v23, s[24:27], s58 offen offset:0 sc1
    v_mfma_f32_16x16x32_bf16 v[56:59], v[112:115], a[104:107], v[56:59]
    ds_write_b128 v241, v[80:83] offset:0
    v_mfma_f32_16x16x32_bf16 v[60:63], v[112:115], a[108:111], v[60:63]
    s_waitcnt vmcnt(9)
    v_mfma_f32_16x16x32_bf16 v[48:51], v[116:119], a[112:115], v[48:51]
    v_mfma_f32_16x16x32_bf16 v[52:55], v[116:119], a[116:119], v[52:55]
    buffer_load_dwordx4 v[156:159], v23, s[24:27], s58 offen offset:1024 sc1
    v_mfma_f32_16x16x32_bf16 v[56:59], v[116:119], a[120:123], v[56:59]
    ds_write_b128 v241, v[84:87] offset:16384
    v_mfma_f32_16x16x32_bf16 v[60:63], v[116:119], a[124:127], v[60:63]
    s_waitcnt vmcnt(9)
    v_mfma_f32_16x16x32_bf16 v[48:51], v[120:123], a[128:131], v[48:51]
    s_add_u32 s58, s66, s78
    v_mfma_f32_16x16x32_bf16 v[52:55], v[120:123], a[132:135], v[52:55]
    buffer_load_dwordx4 v[112:115], v23, s[24:27], s58 offen offset:0 sc1
    v_mfma_f32_16x16x32_bf16 v[56:59], v[120:123], a[136:139], v[56:59]
    ds_write_b128 v241, v[88:91] offset:32768
    v_mfma_f32_16x16x32_bf16 v[60:63], v[120:123], a[140:143], v[60:63]
    s_waitcnt vmcnt(9)
    v_mfma_f32_16x16x32_bf16 v[48:51], v[124:127], a[144:147], v[48:51]
    v_mfma_f32_16x16x32_bf16 v[52:55], v[124:127], a[148:151], v[52:55]
    buffer_load_dwordx4 v[116:119], v23, s[24:27], s58 offen offset:1024 sc1
    v_mfma_f32_16x16x32_bf16 v[56:59], v[124:127], a[152:155], v[56:59]
    ds_write_b128 v241, v[92:95] offset:49152
    v_mfma_f32_16x16x32_bf16 v[60:63], v[124:127], a[156:159], v[60:63]
    s_waitcnt vmcnt(9)
    v_mfma_f32_16x16x32_bf16 v[48:51], v[128:131], a[160:163], v[48:51]
    s_add_u32 s58, s66, s79
    v_mfma_f32_16x16x32_bf16 v[52:55], v[128:131], a[164:167], v[52:55]
    buffer_load_dwordx4 v[120:123], v23, s[24:27], s58 offen offset:0 sc1
    v_mfma_f32_16x16x32_bf16 v[56:59], v[128:131], a[168:171], v[56:59]
    ds_write_b128 v240, v[64:67] offset:0
    v_mfma_f32_16x16x32_bf16 v[60:63], v[128:131], a[172:175], v[60:63]
    s_waitcnt vmcnt(9)
    v_mfma_f32_16x16x32_bf16 v[48:51], v[132:135], a[176:179], v[48:51]
    v_mfma_f32_16x16x32_bf16 v[52:55], v[132:135], a[180:183], v[52:55]
    buffer_load_dwordx4 v[124:127], v23, s[24:27], s58 offen offset:1024 sc1
    v_mfma_f32_16x16x32_bf16 v[56:59], v[132:135], a[184:187], v[56:59]
    ds_write_b128 v240, v[68:71] offset:16384
    v_mfma_f32_16x16x32_bf16 v[60:63], v[132:135], a[188:191], v[60:63]
    s_waitcnt vmcnt(9)
    v_mfma_f32_16x16x32_bf16 v[48:51], v[136:139], a[192:195], v[48:51]
    s_add_u32 s58, s66, s80
    v_mfma_f32_16x16x32_bf16 v[52:55], v[136:139], a[196:199], v[52:55]
    buffer_load_dwordx4 v[128:131], v23, s[24:27], s58 offen offset:0 sc1
    v_mfma_f32_16x16x32_bf16 v[56:59], v[136:139], a[200:203], v[56:59]
    ds_write_b128 v240, v[72:75] offset:32768
    v_mfma_f32_16x16x32_bf16 v[60:63], v[136:139], a[204:207], v[60:63]
    s_waitcnt vmcnt(9)
    v_mfma_f32_16x16x32_bf16 v[48:51], v[140:143], a[208:211], v[48:51]
    v_mfma_f32_16x16x32_bf16 v[52:55], v[140:143], a[212:215], v[52:55]
    buffer_load_dwordx4 v[132:135], v23, s[24:27], s58 offen offset:1024 sc1
    v_mfma_f32_16x16x32_bf16 v[56:59], v[140:143], a[216:219], v[56:59]
    ds_write_b128 v240, v[76:79] offset:49152
    v_mfma_f32_16x16x32_bf16 v[60:63], v[140:143], a[220:223], v[60:63]
    s_waitcnt vmcnt(9)
    v_mfma_f32_16x16x32_bf16 v[32:35], v[144:147], a[0:3], v[32:35]
    s_add_u32 s58, s66, s81
    v_mfma_f32_16x16x32_bf16 v[36:39], v[144:147], a[4:7], v[36:39]
    buffer_load_dwordx4 v[136:139], v23, s[24:27], s58 offen offset:0 sc1
    v_mfma_f32_16x16x32_bf16 v[40:43], v[144:147], a[8:11], v[40:43]
    v_mfma_f32_16x16x32_bf16 v[44:47], v[144:147], a[12:15], v[44:47]
    s_waitcnt vmcnt(9)
    v_mfma_f32_16x16x32_bf16 v[32:35], v[148:151], a[16:19], v[32:35]
    v_mfma_f32_16x16x32_bf16 v[36:39], v[148:151], a[20:23], v[36:39]
    buffer_load_dwordx4 v[140:143], v23, s[24:27], s58 offen offset:1024 sc1
    v_mfma_f32_16x16x32_bf16 v[40:43], v[148:151], a[24:27], v[40:43]
    ds_write_b128 v239, v[48:51] offset:0
    v_mfma_f32_16x16x32_bf16 v[44:47], v[148:151], a[28:31], v[44:47]
    ds_write_b128 v239, v[52:55] offset:16384
    s_waitcnt vmcnt(9)
    v_mfma_f32_16x16x32_bf16 v[32:35], v[152:155], a[32:35], v[32:35]
    s_add_u32 s58, s66, s82
    v_mfma_f32_16x16x32_bf16 v[36:39], v[152:155], a[36:39], v[36:39]
    buffer_load_dwordx4 v[144:147], v23, s[24:27], s58 offen offset:0 sc1
    v_mfma_f32_16x16x32_bf16 v[40:43], v[152:155], a[40:43], v[40:43]
    ds_write_b128 v239, v[56:59] offset:32768
    v_mfma_f32_16x16x32_bf16 v[44:47], v[152:155], a[44:47], v[44:47]
    ds_write_b128 v239, v[60:63] offset:49152
    s_waitcnt vmcnt(9)
    v_mfma_f32_16x16x32_bf16 v[32:35], v[156:159], a[48:51], v[32:35]
    v_mfma_f32_16x16x32_bf16 v[36:39], v[156:159], a[52:55], v[36:39]
    buffer_load_dwordx4 v[148:151], v23, s[24:27], s58 offen offset:1024 sc1
    v_mfma_f32_16x16x32_bf16 v[40:43], v[156:159], a[56:59], v[40:43]
    v_mfma_f32_16x16x32_bf16 v[44:47], v[156:159], a[60:63], v[44:47]
    s_waitcnt vmcnt(9)
    v_mfma_f32_16x16x32_bf16 v[32:35], v[112:115], a[64:67], v[32:35]
    v_mfma_f32_16x16x32_bf16 v[36:39], v[112:115], a[68:71], v[36:39]
    v_mfma_f32_16x16x32_bf16 v[40:43], v[112:115], a[72:75], v[40:43]
    v_mfma_f32_16x16x32_bf16 v[44:47], v[112:115], a[76:79], v[44:47]
    s_waitcnt vmcnt(8)
    v_mfma_f32_16x16x32_bf16 v[32:35], v[116:119], a[80:83], v[32:35]
    s_waitcnt lgkmcnt(0)
    s_barrier
    v_mfma_f32_16x16x32_bf16 v[36:39], v[116:119], a[84:87], v[36:39]
    v_mfma_f32_16x16x32_bf16 v[40:43], v[116:119], a[88:91], v[40:43]
    v_mfma_f32_16x16x32_bf16 v[44:47], v[116:119], a[92:95], v[44:47]
    s_waitcnt vmcnt(7)
    v_mfma_f32_16x16x32_bf16 v[32:35], v[120:123], a[96:99], v[32:35]
    ds_read_b128 v[160:163], v252 offset:0
    v_mfma_f32_16x16x32_bf16 v[36:39], v[120:123], a[100:103], v[36:39]
    ds_read_b128 v[164:167], v252 offset:4096
    v_mfma_f32_16x16x32_bf16 v[40:43], v[120:123], a[104:107], v[40:43]
    ds_read_b128 v[168:171], v252 offset:8192
    v_mfma_f32_16x16x32_bf16 v[44:47], v[120:123], a[108:111], v[44:47]
    ds_read_b128 v[172:175], v252 offset:12288
    s_waitcnt vmcnt(6)
    v_mfma_f32_16x16x32_bf16 v[32:35], v[124:127], a[112:115], v[32:35]
    ds_read_b128 v[48:51], v246 offset:0
    v_mfma_f32_16x16x32_bf16 v[36:39], v[124:127], a[116:119], v[36:39]
    ds_read_b128 v[64:67], v248 offset:0
    v_mfma_f32_16x16x32_bf16 v[40:43], v[124:127], a[120:123], v[40:43]
    ds_read_b128 v[80:83], v250 offset:0
    v_mfma_f32_16x16x32_bf16 v[44:47], v[124:127], a[124:127], v[44:47]
    ds_read_b128 v[52:55], v247 offset:0
    s_waitcnt vmcnt(5)
    v_mfma_f32_16x16x32_bf16 v[32:35], v[128:131], a[128:131], v[32:35]
    ds_read_b128 v[68:71], v249 offset:0
    v_mfma_f32_16x16x32_bf16 v[36:39], v[128:131], a[132:135], v[36:39]
    ds_read_b128 v[84:87], v251 offset:0
    v_mfma_f32_16x16x32_bf16 v[40:43], v[128:131], a[136:139], v[40:43]
    ds_read_b128 v[56:59], v246 offset:32768
    v_mfma_f32_16x16x32_bf16 v[44:47], v[128:131], a[140:143], v[44:47]
    ds_read_b128 v[72:75], v248 offset:32768
    s_waitcnt vmcnt(4)
    v_mfma_f32_16x16x32_bf16 v[32:35], v[132:135], a[144:147], v[32:35]
    ds_read_b128 v[88:91], v250 offset:32768
    v_mfma_f32_16x16x32_bf16 v[36:39], v[132:135], a[148:151], v[36:39]
    ds_read_b128 v[60:63], v247 offset:32768
    v_mfma_f32_16x16x32_bf16 v[40:43], v[132:135], a[152:155], v[40:43]
    ds_read_b128 v[76:79], v249 offset:32768
    v_mfma_f32_16x16x32_bf16 v[44:47], v[132:135], a[156:159], v[44:47]
    ds_read_b128 v[92:95], v251 offset:32768
    s_waitcnt vmcnt(3)
    v_mfma_f32_16x16x32_bf16 v[32:35], v[136:139], a[160:163], v[32:35]
    s_waitcnt lgkmcnt(12)
    v_add_f32 v232, v232, v160
    v_mfma_f32_16x16x32_bf16 v[36:39], v[136:139], a[164:167], v[36:39]
    v_add_f32 v233, v233, v161
    v_mfma_f32_16x16x32_bf16 v[40:43], v[136:139], a[168:171], v[40:43]
    v_add_f32 v234, v234, v162
    v_mfma_f32_16x16x32_bf16 v[44:47], v[136:139], a[172:175], v[44:47]
    v_add_f32 v235, v235, v163
    s_waitcnt vmcnt(2)
    v_mfma_f32_16x16x32_bf16 v[32:35], v[140:143], a[176:179], v[32:35]
    v_add_f32 v232, v232, v164
    v_add_f32 v233, v233, v165
    v_mfma_f32_16x16x32_bf16 v[36:39], v[140:143], a[180:183], v[36:39]
    v_add_f32 v234, v234, v166
    v_mfma_f32_16x16x32_bf16 v[40:43], v[140:143], a[184:187], v[40:43]
    v_add_f32 v235, v235, v167
    v_mfma_f32_16x16x32_bf16 v[44:47], v[140:143], a[188:191], v[44:47]
    v_add_f32 v232, v232, v168
    s_waitcnt vmcnt(1)
    v_mfma_f32_16x16x32_bf16 v[32:35], v[144:147], a[192:195], v[32:35]
    v_add_f32 v233, v233, v169
    v_add_f32 v234, v234, v170
    v_mfma_f32_16x16x32_bf16 v[36:39], v[144:147], a[196:199], v[36:39]
    v_add_f32 v235, v235, v171
    v_mfma_f32_16x16x32_bf16 v[40:43], v[144:147], a[200:203], v[40:43]
    v_add_f32 v232, v232, v172
    v_mfma_f32_16x16x32_bf16 v[44:47], v[144:147], a[204:207], v[44:47]
    v_add_f32 v233, v233, v173
    s_waitcnt vmcnt(0)
    v_mfma_f32_16x16x32_bf16 v[32:35], v[148:151], a[208:211], v[32:35]
    v_add_f32 v234, v234, v174
    v_mfma_f32_16x16x32_bf16 v[36:39], v[148:151], a[212:215], v[36:39]
    v_add_f32 v235, v235, v175
    v_mfma_f32_16x16x32_bf16 v[40:43], v[148:151], a[216:219], v[40:43]
    v_cvt_pk_bf16_f32 v226, v232, v233
    v_cvt_pk_bf16_f32 v227, v234, v235
    v_mfma_f32_16x16x32_bf16 v[44:47], v[148:151], a[220:223], v[44:47]
    s_waitcnt lgkmcnt(0)
    buffer_store_dwordx2 v[226:227], v26, s[28:31], s73 offen
    v_pk_add_f32 v[176:177], v[176:177], v[48:49]
    v_pk_add_f32 v[178:179], v[178:179], v[50:51]
    v_pk_add_f32 v[180:181], v[180:181], v[52:53]
    v_pk_add_f32 v[182:183], v[182:183], v[54:55]
    v_pk_add_f32 v[184:185], v[184:185], v[56:57]
    v_pk_add_f32 v[186:187], v[186:187], v[58:59]
    ds_write_b128 v238, v[32:35] offset:0
    ds_write_b128 v238, v[36:39] offset:16384
    ds_write_b128 v238, v[40:43] offset:32768
    ds_write_b128 v238, v[44:47] offset:49152
    v_pk_add_f32 v[188:189], v[188:189], v[60:61]
    v_pk_add_f32 v[190:191], v[190:191], v[62:63]
    v_pk_add_f32 v[176:177], v[176:177], v[64:65]
    v_pk_add_f32 v[178:179], v[178:179], v[66:67]
    v_pk_add_f32 v[180:181], v[180:181], v[68:69]
    v_pk_add_f32 v[182:183], v[182:183], v[70:71]
    v_pk_add_f32 v[184:185], v[184:185], v[72:73]
    v_pk_add_f32 v[186:187], v[186:187], v[74:75]
    v_pk_add_f32 v[188:189], v[188:189], v[76:77]
    v_pk_add_f32 v[190:191], v[190:191], v[78:79]
    v_pk_add_f32 v[176:177], v[176:177], v[80:81]
    v_pk_add_f32 v[178:179], v[178:179], v[82:83]
    v_pk_add_f32 v[180:181], v[180:181], v[84:85]
    v_pk_add_f32 v[182:183], v[182:183], v[86:87]
    v_pk_add_f32 v[184:185], v[184:185], v[88:89]
    v_pk_add_f32 v[186:187], v[186:187], v[90:91]
    v_pk_add_f32 v[188:189], v[188:189], v[92:93]
    v_pk_add_f32 v[190:191], v[190:191], v[94:95]
    s_waitcnt lgkmcnt(0)
    s_barrier
    ds_read_b128 v[160:163], v244 offset:0
    ds_read_b128 v[164:167], v245 offset:0
    ds_read_b128 v[168:171], v244 offset:32768
    ds_read_b128 v[172:175], v245 offset:32768
    s_waitcnt lgkmcnt(2)
    v_pk_add_f32 v[176:177], v[176:177], v[160:161]
    v_pk_add_f32 v[178:179], v[178:179], v[162:163]
    v_pk_add_f32 v[180:181], v[180:181], v[164:165]
    v_pk_add_f32 v[182:183], v[182:183], v[166:167]
    v_cvt_pk_bf16_f32 v216, v176, v177
    v_cvt_pk_bf16_f32 v217, v178, v179
    v_cvt_pk_bf16_f32 v218, v180, v181
    v_cvt_pk_bf16_f32 v219, v182, v183
    buffer_store_dwordx4 v[216:219], v22, s[28:31], s71 offen
    s_waitcnt lgkmcnt(0)
    v_pk_add_f32 v[184:185], v[184:185], v[168:169]
    v_pk_add_f32 v[186:187], v[186:187], v[170:171]
    v_pk_add_f32 v[188:189], v[188:189], v[172:173]
    v_pk_add_f32 v[190:191], v[190:191], v[174:175]
    v_cvt_pk_bf16_f32 v220, v184, v185
    v_cvt_pk_bf16_f32 v221, v186, v187
    v_cvt_pk_bf16_f32 v222, v188, v189
    v_cvt_pk_bf16_f32 v223, v190, v191
    buffer_store_dwordx4 v[220:223], v22, s[28:31], s72 offen
L_end:
    s_endpgm
L_p2_alt:
    s_add_u32 s57, s57, 27648
    buffer_load_dwordx4 v10, s[16:19], s57 offen offset:2048 lds
    s_add_u32 s57, s57, 27648
    buffer_load_dwordx4 v11, s[16:19], s57 offen offset:3072 lds
    s_xor_b32 s66, s44, 3
    s_lshl2_add_u32 s66, s51, s66
    s_mul_i32 s66, s66, 66816
    s_lshl2_add_u32 s66, s52, s66
    s_lshl_b32 s86, s65, 10
    s_add_u32 s58, s86, s66
    buffer_load_dwordx4 v[128:131], v23, s[24:27], s58 offen offset:0 sc1
    s_add_u32 s86, s86, 1024
    s_and_b32 s86, s86, 16383
    s_add_u32 s58, s86, s66
    buffer_load_dwordx4 v[132:135], v23, s[24:27], s58 offen offset:0 sc1
    s_add_u32 s86, s86, 1024
    s_and_b32 s86, s86, 16383
    s_add_u32 s58, s86, s66
    buffer_load_dwordx4 v[136:139], v23, s[24:27], s58 offen offset:0 sc1
    s_add_u32 s86, s86, 1024
    s_and_b32 s86, s86, 16383
    s_add_u32 s58, s86, s66
    buffer_load_dwordx4 v[140:143], v23, s[24:27], s58 offen offset:0 sc1
    s_add_u32 s86, s86, 1024
    s_and_b32 s86, s86, 16383
    s_add_u32 s58, s86, s66
    buffer_load_dwordx4 v[144:147], v23, s[24:27], s58 offen offset:0 sc1
    s_add_u32 s86, s86, 1024
    s_and_b32 s86, s86, 16383
    s_add_u32 s58, s86, s66
    buffer_load_dwordx4 v[148:151], v23, s[24:27], s58 offen offset:0 sc1
    s_add_u32 s86, s86, 1024
    s_and_b32 s86, s86, 16383
    s_add_u32 s58, s86, s66
    buffer_load_dwordx4 v[152:155], v23, s[24:27], s58 offen offset:0 sc1
    s_add_u32 s86, s86, 1024
    s_and_b32 s86, s86, 16383
    s_add_u32 s58, s86, s66
    buffer_load_dwordx4 v[156:159], v23, s[24:27], s58 offen offset:0 sc1
    s_add_u32 s86, s86, 1024
    s_and_b32 s86, s86, 16383
    s_add_u32 s58, s86, s66
    buffer_load_dwordx4 v[112:115], v23, s[24:27], s58 offen offset:0 sc1
    s_add_u32 s86, s86, 1024
    s_and_b32 s86, s86, 16383
    s_add_u32 s58, s86, s66
    buffer_load_dwordx4 v[116:119], v23, s[24:27], s58 offen offset:0 sc1
    s_waitcnt vmcnt(18)
    ds_read_b64_tr_b16 a[208:209], v4 offset:32768
    ds_read_b64_tr_b16 a[210:211], v4 offset:33280
    ds_read_b64_tr_b16 a[212:213], v5 offset:32768
    ds_read_b64_tr_b16 a[214:215], v5 offset:33280
    ds_read_b64_tr_b16 a[216:217], v4 offset:33024
    ds_read_b64_tr_b16 a[218:219], v4 offset:33536
    ds_read_b64_tr_b16 a[220:221], v5 offset:33024
    ds_read_b64_tr_b16 a[222:223], v5 offset:33536
    s_waitcnt vmcnt(14)
    ds_read_b64_tr_b16 a[224:225], v2 offset:0
    ds_read_b64_tr_b16 a[226:227], v2 offset:512
    ds_read_b64_tr_b16 a[228:229], v3 offset:0
    ds_read_b64_tr_b16 a[230:231], v3 offset:512
    ds_read_b64_tr_b16 a[232:233], v2 offset:256
    ds_read_b64_tr_b16 a[234:235], v2 offset:768
    ds_read_b64_tr_b16 a[236:237], v3 offset:256
    ds_read_b64_tr_b16 a[238:239], v3 offset:768
    s_waitcnt vmcnt(10)
    ds_read_b64_tr_b16 a[240:241], v2 offset:16384
    ds_read_b64_tr_b16 a[242:243], v2 offset:16896
    ds_read_b64_tr_b16 a[244:245], v3 offset:16384
    ds_read_b64_tr_b16 a[246:247], v3 offset:16896
    ds_read_b64_tr_b16 a[248:249], v2 offset:16640
    ds_read_b64_tr_b16 a[250:251], v2 offset:17152
    ds_read_b64_tr_b16 a[252:253], v3 offset:16640
    ds_read_b64_tr_b16 a[254:255], v3 offset:17152
    s_waitcnt lgkmcnt(0)
    s_branch L_p2_join
L_p3_alt:
    s_xor_b32 s66, s44, 3
    s_lshl2_add_u32 s66, s49, s66
    s_mul_i32 s66, s66, 58624
    s_add_u32 s66, s66, s69
    s_add_u32 s58, s66, s76
    buffer_load_dwordx4 v[152:155], v23, s[24:27], s58 offen offset:0 sc1
    buffer_load_dwordx4 v[156:159], v23, s[24:27], s58 offen offset:1024 sc1
    s_add_u32 s58, s66, s77
    buffer_load_dwordx4 v[112:115], v23, s[24:27], s58 offen offset:0 sc1
    buffer_load_dwordx4 v[116:119], v23, s[24:27], s58 offen offset:1024 sc1
    s_add_u32 s58, s66, s78
    buffer_load_dwordx4 v[120:123], v23, s[24:27], s58 offen offset:0 sc1
    buffer_load_dwordx4 v[124:127], v23, s[24:27], s58 offen offset:1024 sc1
    s_add_u32 s58, s66, s79
    buffer_load_dwordx4 v[128:131], v23, s[24:27], s58 offen offset:0 sc1
    buffer_load_dwordx4 v[132:135], v23, s[24:27], s58 offen offset:1024 sc1
    s_add_u32 s58, s66, s80
    buffer_load_dwordx4 v[136:139], v23, s[24:27], s58 offen offset:0 sc1
    buffer_load_dwordx4 v[140:143], v23, s[24:27], s58 offen offset:1024 sc1
    s_waitcnt vmcnt(18)
    ds_read_b64_tr_b16 a[240:241], v4 offset:0
    ds_read_b64_tr_b16 a[242:243], v4 offset:512
    ds_read_b64_tr_b16 a[244:245], v5 offset:0
    ds_read_b64_tr_b16 a[246:247], v5 offset:512
    ds_read_b64_tr_b16 a[248:249], v4 offset:256
    ds_read_b64_tr_b16 a[250:251], v4 offset:768
    ds_read_b64_tr_b16 a[252:253], v5 offset:256
    ds_read_b64_tr_b16 a[254:255], v5 offset:768
    s_waitcnt vmcnt(10) lgkmcnt(0)
    s_branch L_p3_join
L_help:
    s_sub_u32 s55, s46, 21
    v_lshlrev_b32 v217, 7, v1
    v_lshrrev_b32 v218, 2, v1
    v_lshlrev_b32 v218, 12, v218
    v_lshl_add_u32 v218, v210, 7, v218
    buffer_load_dword v108, v217, s[32:35], 0 offen
    s_mul_i32 s54, s44, 28
    s_add_u32 s54, s54, s55
    s_add_u32 s54, s54, 0
    s_lshl_b32 s54, s54, 16
    s_lshl_b32 s56, s45, 9
    s_add_u32 s54, s54, s56
    buffer_load_dword v108, v218, s[20:23], s54 offen
    s_add_u32 s54, s54, 196608
    buffer_load_dword v108, v218, s[20:23], s54 offen
    s_add_u32 s54, s54, 196608
    buffer_load_dword v108, v218, s[20:23], s54 offen
    s_add_u32 s54, s54, 196608
    buffer_load_dword v108, v218, s[20:23], s54 offen
    s_add_u32 s54, s54, 196608
    buffer_load_dword v108, v218, s[20:23], s54 offen
    s_add_u32 s54, s54, 196608
    buffer_load_dword v108, v218, s[20:23], s54 offen
    s_add_u32 s54, s54, 196608
    s_mul_i32 s56, s55, 20480
    s_sub_u32 s54, s54, s56
    v_min_u32 v218, 45055, v218
    buffer_load_dword v108, v218, s[20:23], s54 offen
    s_add_u32 s54, s54, 196608
    buffer_load_dword v108, v217, s[36:39], 0 offen
    s_waitcnt vmcnt(0) lgkmcnt(0)
    s_lshr_b32 s53, s46, 2
    s_and_b32 s89, s46, 3
    s_bfe_u32 s54, s46, 0x20001
    s_and_b32 s55, s46, 1
    s_add_u32 s55, s55, 4
    s_cmp_lt_u32 s46, 16
    s_cselect_b32 s53, s53, s54
    s_cselect_b32 s89, s89, s55
    s_mul_i32 s49, s53, 2
    s_add_u32 s49, s49, s89
    s_sub_u32 s54, s49, 6
    s_min_u32 s49, s49, s54
    s_lshl2_add_u32 s48, s45, s53
    s_mul_i32 s53, s44, 1835008
    s_lshl_b32 s74, s48, 7
    s_add_u32 s53, s53, s74
    v_lshlrev_b32 v217, 5, v212
    v_xor_b32 v217, v217, v214
    v_lshlrev_b32 v12, 12, v213
    v_add3_u32 v12, v12, v217, s53
    s_mul_i32 s53, s44, 100352
    s_lshl_b32 s54, s49, 7
    s_add_u32 s55, s53, s54
    s_lshl_b32 s56, s44, 5
    v_xor_b32 v217, s56, v214
    v_mul_u32_u24 v13, 896, v213
    v_add3_u32 v13, v13, v217, s55
    v_xor_b32 v14, 32, v13
    s_mul_i32 s73, s48, 57344
    s_add_u32 s71, s73, s54
    s_add_u32 s72, s71, 28672
    v_lshrrev_b32 v217, 1, v1
    v_mul_u32_u24 v15, 896, v217
    v_and_b32 v217, 1, v1
    v_lshl_add_u32 v15, v217, 4, v15
    v_add_u32 v15, s53, v15
    s_lshl_b32 s54, s89, 5
    s_add_u32 s54, s54, 768
    s_add_u32 s68, s89, 24
    s_mul_i32 s68, s68, 58624
    s_mul_i32 s69, s44, 14336
    s_add_u32 s69, s69, 2097152
    s_add_u32 s68, s68, s69
    s_add_u32 s73, s73, s54
    s_mov_b32 s76, 0
    s_add_u32 s77, s76, 2048
    s_cmp_eq_u32 s77, 14336
    s_cselect_b32 s77, 0, s77
    s_add_u32 s78, s77, 2048
    s_cmp_eq_u32 s78, 14336
    s_cselect_b32 s78, 0, s78
    s_add_u32 s79, s78, 2048
    s_cmp_eq_u32 s79, 14336
    s_cselect_b32 s79, 0, s79
    s_add_u32 s80, s79, 2048
    s_cmp_eq_u32 s80, 14336
    s_cselect_b32 s80, 0, s80
    s_add_u32 s81, s80, 2048
    s_cmp_eq_u32 s81, 14336
    s_cselect_b32 s81, 0, s81
    s_add_u32 s82, s81, 2048
    s_cmp_eq_u32 s82, 14336
    s_cselect_b32 s82, 0, s82
    s_cmp_lt_u32 s89, 4
    s_cselect_b32 s75, s54, 2130706432
    s_cselect_b32 s68, s68, 2130706432
    s_cselect_b32 s73, s73, 2130706432
    v_lshl_add_u32 v217, v208, 3, v209
    v_lshlrev_b32 v16, 5, v217
    v_lshl_add_u32 v16, v210, 3, v16
    v_add_u32 v16, s52, v16
    v_and_b32 v217, 7, v1
    v_min_u32 v218, 6, v217
    s_mul_i32 s54, s44, 7
    v_add_u32 v218, s54, v218
    v_mul_u32_u24 v219, 2, v218
    v_add_u32 v219, s89, v219
    v_mul_u32_u24 v220, 43, v219
    v_lshrrev_b32 v220, 8, v220
    v_mul_u32_u24 v220, 6, v220
    v_sub_u32 v219, v219, v220
    v_subrev_u32 v219, s49, v219
    v_bfe_u32 v220, v1, 3, 1
    v_mul_i32_i24 v219, v219, v220
    v_add_u32 v219, s49, v219
    v_lshl_add_u32 v218, v219, 5, v218
    v_lshlrev_b32 v20, 7, v218
    v_add_u32 v20, 12713984, v20
    s_lshr_b32 s53, s48, 1
    s_lshl4_add_u32 s53, s44, s53
    s_lshl_b32 s53, s53, 7
    s_add_u32 s53, s53, 12779520
    v_mov_b32 v21, s53
    s_lshl_b32 s70, s48, 16
    s_add_u32 s70, s70, s52
    s_add_u32 s70, s70, 4194304
    v_lshrrev_b32 v218, 3, v0
    v_mul_u32_u24 v22, 896, v218
    v_lshl_add_u32 v22, v217, 4, v22
    v_lshlrev_b32 v25, 1, v218
    v_lshrrev_b32 v219, 4, v218
    v_lshlrev_b32 v244, 14, v219
    v_lshrrev_b32 v219, 1, v217
    v_lshl_add_u32 v244, v219, 12, v244
    v_and_b32 v219, 15, v218
    v_lshl_add_u32 v244, v219, 8, v244
    v_bfe_u32 v219, v218, 1, 1
    v_lshl_add_u32 v244, v219, 7, v244
    v_and_b32 v219, 7, v218
    v_xor_b32 v219, v219, v217
    v_lshl_add_u32 v244, v219, 4, v244
    v_xor_b32 v245, 128, v244
    v_xor_b32 v246, 4096, v244
    v_xor_b32 v247, 4224, v244
    v_xor_b32 v248, 8192, v244
    v_xor_b32 v249, 8320, v244
    v_xor_b32 v250, 12288, v244
    v_xor_b32 v251, 12416, v244
    v_lshrrev_b32 v218, 2, v0
    v_mul_u32_u24 v26, 896, v218
    v_lshl_add_u32 v26, v210, 3, v26
    v_lshlrev_b32 v27, 1, v218
    v_bfe_u32 v219, v218, 1, 2
    v_xor_b32 v219, v219, v210
    v_lshlrev_b32 v252, 6, v218
    v_lshl_add_u32 v252, v219, 4, v252
    v_add_u32 v252, 65536, v252
    v_bfe_u32 v219, v1, 1, 2
    v_xor_b32 v219, v219, v208
    v_lshlrev_b32 v242, 6, v211
    v_lshl_add_u32 v242, v219, 4, v242
    s_add_u32 s53, s52, 65536
    v_add_u32 v242, s53, v242
    v_xor_b32 v218, v217, v212
    v_lshlrev_b32 v238, 4, v218
    v_xor_b32 v238, s56, v238
    v_bfe_u32 v219, v1, 1, 1
    v_xor_b32 v219, v219, v215
    v_lshl_add_u32 v238, v219, 7, v238
    v_lshl_add_u32 v238, v211, 8, v238
    v_add_u32 v238, s52, v238
    v_xor_b32 v239, 32, v238
    v_xor_b32 v240, 64, v238
    v_xor_b32 v241, 96, v238
    buffer_load_dwordx4 v[216:219], v22, s[4:7], s71 offen
    buffer_load_dwordx4 v[220:223], v22, s[4:7], s72 offen
    buffer_load_dwordx2 v[226:227], v26, s[4:7], s73 offen
    buffer_load_ushort v224, v25, s[36:39], s74 offen
    buffer_load_ushort v225, v25, s[36:39], s74 offen offset:64
    buffer_load_ushort v228, v27, s[36:39], s74 offen
    s_add_u32 m0, s52, 81920
    s_lshl_b32 s57, s76, 7
    buffer_load_dwordx4 v12, s[20:23], s57 offen offset:0 lds
    s_add_u32 s57, s57, 31744
    buffer_load_dwordx4 v12, s[20:23], s57 offen offset:1024 lds
    s_add_u32 s57, s57, 31744
    buffer_load_dwordx4 v12, s[20:23], s57 offen offset:2048 lds
    s_add_u32 s57, s57, 31744
    buffer_load_dwordx4 v12, s[20:23], s57 offen offset:3072 lds
    s_add_u32 m0, s52, 98304
    s_lshl_b32 s57, s76, 7
    s_add_u32 s57, s57, 131072
    buffer_load_dwordx4 v12, s[20:23], s57 offen offset:0 lds
    s_add_u32 s57, s57, 31744
    buffer_load_dwordx4 v12, s[20:23], s57 offen offset:1024 lds
    s_add_u32 s57, s57, 31744
    buffer_load_dwordx4 v12, s[20:23], s57 offen offset:2048 lds
    s_add_u32 s57, s57, 31744
    buffer_load_dwordx4 v12, s[20:23], s57 offen offset:3072 lds
    s_add_u32 m0, s52, 114688
    s_lshl_b32 s57, s77, 7
    buffer_load_dwordx4 v12, s[20:23], s57 offen offset:0 lds
    s_add_u32 s57, s57, 31744
    buffer_load_dwordx4 v12, s[20:23], s57 offen offset:1024 lds
    s_add_u32 s57, s57, 31744
    buffer_load_dwordx4 v12, s[20:23], s57 offen offset:2048 lds
    s_add_u32 s57, s57, 31744
    buffer_load_dwordx4 v12, s[20:23], s57 offen offset:3072 lds
    s_add_u32 m0, s52, 131072
    s_lshl_b32 s57, s77, 7
    s_add_u32 s57, s57, 131072
    buffer_load_dwordx4 v12, s[20:23], s57 offen offset:0 lds
    s_add_u32 s57, s57, 31744
    buffer_load_dwordx4 v12, s[20:23], s57 offen offset:1024 lds
    s_waitcnt vmcnt(10)
    ds_read_b64_tr_b16 a[0:1], v6 offset:32768
    ds_read_b64_tr_b16 a[2:3], v6 offset:34816
    ds_read_b64_tr_b16 a[4:5], v7 offset:32768
    ds_read_b64_tr_b16 a[6:7], v7 offset:34816
    ds_read_b64_tr_b16 a[8:9], v6 offset:33024
    ds_read_b64_tr_b16 a[10:11], v6 offset:35072
    ds_read_b64_tr_b16 a[12:13], v7 offset:33024
    ds_read_b64_tr_b16 a[14:15], v7 offset:35072
    s_add_u32 s57, s57, 31744
    buffer_load_dwordx4 v12, s[20:23], s57 offen offset:2048 lds
    s_add_u32 s57, s57, 31744
    buffer_load_dwordx4 v12, s[20:23], s57 offen offset:3072 lds
    s_add_u32 m0, s52, 147456
    s_lshl_b32 s57, s78, 7
    buffer_load_dwordx4 v12, s[20:23], s57 offen offset:0 lds
    s_add_u32 s57, s57, 31744
    buffer_load_dwordx4 v12, s[20:23], s57 offen offset:1024 lds
    s_waitcnt vmcnt(10)
    ds_read_b64_tr_b16 a[16:17], v6 offset:49152
    ds_read_b64_tr_b16 a[18:19], v6 offset:51200
    ds_read_b64_tr_b16 a[20:21], v7 offset:49152
    ds_read_b64_tr_b16 a[22:23], v7 offset:51200
    s_add_u32 s57, s57, 31744
    buffer_load_dwordx4 v12, s[20:23], s57 offen offset:2048 lds
    ds_read_b64_tr_b16 a[24:25], v6 offset:49408
    ds_read_b64_tr_b16 a[26:27], v6 offset:51456
    ds_read_b64_tr_b16 a[28:29], v7 offset:49408
    ds_read_b64_tr_b16 a[30:31], v7 offset:51456
    s_add_u32 s57, s57, 31744
    buffer_load_dwordx4 v12, s[20:23], s57 offen offset:3072 lds
    s_add_u32 m0, s52, 49152
    s_lshl_b32 s57, s78, 7
    s_add_u32 s57, s57, 131072
    buffer_load_dwordx4 v12, s[20:23], s57 offen offset:0 lds
    s_add_u32 s57, s57, 31744
    buffer_load_dwordx4 v12, s[20:23], s57 offen offset:1024 lds
    s_waitcnt vmcnt(10)
    ds_read_b64_tr_b16 a[32:33], v8 offset:0
    ds_read_b64_tr_b16 a[34:35], v8 offset:2048
    ds_read_b64_tr_b16 a[36:37], v9 offset:0
    ds_read_b64_tr_b16 a[38:39], v9 offset:2048
    s_add_u32 s57, s57, 31744
    buffer_load_dwordx4 v12, s[20:23], s57 offen offset:2048 lds
    ds_read_b64_tr_b16 a[40:41], v8 offset:256
    ds_read_b64_tr_b16 a[42:43], v8 offset:2304
    ds_read_b64_tr_b16 a[44:45], v9 offset:256
    ds_read_b64_tr_b16 a[46:47], v9 offset:2304
    s_add_u32 s57, s57, 31744
    buffer_load_dwordx4 v12, s[20:23], s57 offen offset:3072 lds
    s_waitcnt vmcnt(0) lgkmcnt(0)
    s_branch L_p3join
L_role_a:
    v_lshrrev_b32 v112, 4, v1
    v_bfe_u32 v113, v1, 2, 2
    v_and_b32 v114, 3, v1
    v_and_b32 v115, 15, v1
    v_lshrrev_b32 v116, 5, v1
    s_lshr_b32 s48, s45, 1
    s_and_b32 s53, s45, 1
    s_lshl3_add_u32 s49, s53, s46
    s_sub_u32 s49, s49, 24
    s_lshl_b32 s90, s44, 11
    s_and_b32 s53, s44, 1
    s_lshl_b32 s53, s53, 1
    v_lshlrev_b32 v117, 2, v112
    v_sub_u32 v117, v115, v117
    v_and_b32 v117, 15, v117
    v_xor_b32 v117, s53, v117
    v_mul_u32_u24 v2, 2688, v112
    v_lshl_add_u32 v2, v117, 4, v2
    s_mul_i32 s53, s44, 21504
    s_mul_i32 s54, s48, 224
    s_andn2_b32 s54, s54, 63
    s_add_u32 s53, s53, s54
    v_add_u32 v2, s53, v2
    s_add_u32 m0, s90, 65536
    s_mov_b32 s57, 896
    buffer_load_dwordx4 v2, s[8:11], s57 offen offset:0 lds
    s_mov_b32 s57, 10624
    buffer_load_dwordx4 v2, s[8:11], s57 offen offset:1024 lds
    s_add_u32 m0, s90, 73728
    s_mov_b32 s57, 86912
    buffer_load_dwordx4 v2, s[8:11], s57 offen offset:0 lds
    s_mov_b32 s57, 96640
    buffer_load_dwordx4 v2, s[8:11], s57 offen offset:1024 lds
    v_mul_u32_u24 v109, 960, v25
    v_lshl_add_u32 v109, v26, 4, v109
    v_mul_u32_u24 v110, 960, v113
    v_lshl_add_u32 v110, v112, 5, v110
    v_lshl_add_u32 v110, v114, 3, v110
    s_lshl_b32 s53, s44, 7
    v_add_u32 v110, s53, v110
    v_mul_u32_u24 v111, 66816, v112
    v_lshl_add_u32 v111, v115, 4, v111
    s_mul_i32 s63, s44, 267264
    s_lshl_b32 s53, s2, 8
    s_add_u32 s63, s63, s53
    s_add_u32 s64, s63, 1069056
    s_cmp_eq_u32 s44, 3
    s_cselect_b32 s64, 2130706432, s64
    s_mov_b32 s62, 0x3f803f80
    s_mov_b32 s61, 0xffff0000
    s_mov_b32 s66, 6291456
    v_mov_b32 v96, 0
    v_mov_b32 v97, 0
    v_and_b32 v117, 1, v112
    v_lshlrev_b32 v117, 5, v117
    s_mul_i32 s53, s44, 56
    s_and_b32 s54, s48, 1
    s_lshl_b32 s54, s54, 5
    s_add_u32 s53, s53, s54
    v_lshlrev_b32 v118, 11, v112
    v_lshl_add_u32 v118, v113, 8, v118
    v_add_u32 v118, 65536, v118
    v_lshl_add_u32 v119, v114, 3, s53
    v_add_u32 v119, 0, v119
    v_xor_b32 v119, v119, v117
    v_lshl_add_u32 v119, v113, 6, v119
    v_and_b32 v119, 255, v119
    v_add_u32 v6, v118, v119
    v_add_u32 v10, 49152, v6
    v_subrev_u32 v120, 65536, v6
    v_lshl_add_u32 v119, v114, 3, s53
    v_add_u32 v119, 32, v119
    v_xor_b32 v119, v119, v117
    v_lshl_add_u32 v119, v113, 6, v119
    v_and_b32 v119, 255, v119
    v_add_u32 v7, v118, v119
    v_add_u32 v11, 49152, v7
    v_subrev_u32 v121, 65536, v7
    v_lshl_add_u32 v119, v114, 4, s53
    v_add_u32 v119, 0, v119
    v_xor_b32 v119, v119, v117
    v_lshl_add_u32 v119, v113, 6, v119
    v_and_b32 v119, 255, v119
    v_add_u32 v8, v118, v119
    v_add_u32 v12, 49152, v8
    v_subrev_u32 v122, 65536, v8
    v_lshl_add_u32 v119, v114, 4, s53
    v_add_u32 v119, 8, v119
    v_xor_b32 v119, v119, v117
    v_lshl_add_u32 v119, v113, 6, v119
    v_and_b32 v119, 255, v119
    v_add_u32 v9, v118, v119
    v_add_u32 v13, 49152, v9
    v_subrev_u32 v123, 65536, v9
    s_waitcnt vmcnt(7)
    v_dot2c_f32_bf16 v96, s62, v32
    v_dot2c_f32_bf16 v97, v32, v32
    v_lshlrev_b32 v40, 16, v32
    v_and_b32 v41, s61, v32
    v_dot2c_f32_bf16 v96, s62, v33
    v_dot2c_f32_bf16 v97, v33, v33
    v_lshlrev_b32 v42, 16, v33
    v_and_b32 v43, s61, v33
    v_dot2c_f32_bf16 v96, s62, v34
    v_dot2c_f32_bf16 v97, v34, v34
    v_lshlrev_b32 v44, 16, v34
    v_and_b32 v45, s61, v34
    v_dot2c_f32_bf16 v96, s62, v35
    v_dot2c_f32_bf16 v97, v35, v35
    v_lshlrev_b32 v46, 16, v35
    v_and_b32 v47, s61, v35
    s_waitcnt vmcnt(6)
    v_dot2c_f32_bf16 v96, s62, v36
    v_dot2c_f32_bf16 v97, v36, v36
    v_lshlrev_b32 v48, 16, v36
    v_and_b32 v49, s61, v36
    v_dot2c_f32_bf16 v96, s62, v37
    v_dot2c_f32_bf16 v97, v37, v37
    v_lshlrev_b32 v50, 16, v37
    v_and_b32 v51, s61, v37
    v_dot2c_f32_bf16 v96, s62, v38
    v_dot2c_f32_bf16 v97, v38, v38
    v_lshlrev_b32 v52, 16, v38
    v_and_b32 v53, s61, v38
    v_dot2c_f32_bf16 v96, s62, v39
    v_dot2c_f32_bf16 v97, v39, v39
    v_lshlrev_b32 v54, 16, v39
    v_and_b32 v55, s61, v39
    buffer_load_dword v29, off, s[40:43], 0 sc1
    v_add_f32_dpp v96, v96, v96 quad_perm:[1,0,3,2] row_mask:0xf bank_mask:0xf
    v_add_f32_dpp v97, v97, v97 quad_perm:[1,0,3,2] row_mask:0xf bank_mask:0xf
    s_nop 0
    v_add_f32_dpp v96, v96, v96 quad_perm:[2,3,0,1] row_mask:0xf bank_mask:0xf
    v_add_f32_dpp v97, v97, v97 quad_perm:[2,3,0,1] row_mask:0xf bank_mask:0xf
    s_nop 0
    v_add_f32_dpp v96, v96, v96 row_half_mirror row_mask:0xf bank_mask:0xf
    v_add_f32_dpp v97, v97, v97 row_half_mirror row_mask:0xf bank_mask:0xf
    s_nop 0
    v_add_f32_dpp v96, v96, v96 row_mirror row_mask:0xf bank_mask:0xf
    v_add_f32_dpp v97, v97, v97 row_mirror row_mask:0xf bank_mask:0xf
    v_mov_b32 v98, v96
    v_mov_b32 v99, v97
    s_nop 0
    v_permlane16_swap_b32 v96, v98
    v_permlane16_swap_b32 v97, v99
    v_add_f32 v96, v96, v98
    v_add_f32 v97, v97, v99
    v_mul_f32 v98, 0x3b124925, v96
    v_mul_f32 v99, 0x3b124925, v97
    v_fma_f32 v99, -v98, v98, v99
    v_max_f32 v99, 0, v99
    v_cvt_pk_bf16_f32 v100, 0, v99
    v_add_f32 v100, 0x3727c5ac, v100
    v_cvt_pk_bf16_f32 v100, 0, v100
    v_sqrt_f32 v100, v100
    s_nop 0
    v_cvt_pk_bf16_f32 v100, 0, v100
    v_rcp_f32 v100, v100
    s_nop 0
    v_mul_f32 v99, v99, v100
    v_mul_f32 v102, v98, v100
    v_mul_f32 v99, v99, v100
    v_cvt_pk_bf16_f32 v104, 0, v99
    v_add_f32 v104, 0x3727c5ac, v104
    v_cvt_pk_bf16_f32 v104, 0, v104
    v_sqrt_f32 v104, v104
    s_nop 0
    v_cvt_pk_bf16_f32 v104, 0, v104
    v_rcp_f32 v104, v104
    s_nop 0
    v_mul_f32 v104, v104, v100
    v_mul_f32 v106, v98, v104
    v_pk_fma_f32 v[56:57], v[40:41], v[104:105], v[106:107] op_sel_hi:[1,0,0] neg_lo:[0,0,1] neg_hi:[0,0,1]
    v_pk_fma_f32 v[58:59], v[42:43], v[104:105], v[106:107] op_sel_hi:[1,0,0] neg_lo:[0,0,1] neg_hi:[0,0,1]
    v_pk_fma_f32 v[60:61], v[44:45], v[104:105], v[106:107] op_sel_hi:[1,0,0] neg_lo:[0,0,1] neg_hi:[0,0,1]
    v_pk_fma_f32 v[62:63], v[46:47], v[104:105], v[106:107] op_sel_hi:[1,0,0] neg_lo:[0,0,1] neg_hi:[0,0,1]
    v_pk_fma_f32 v[64:65], v[48:49], v[104:105], v[106:107] op_sel_hi:[1,0,0] neg_lo:[0,0,1] neg_hi:[0,0,1]
    v_pk_fma_f32 v[66:67], v[50:51], v[104:105], v[106:107] op_sel_hi:[1,0,0] neg_lo:[0,0,1] neg_hi:[0,0,1]
    v_pk_fma_f32 v[68:69], v[52:53], v[104:105], v[106:107] op_sel_hi:[1,0,0] neg_lo:[0,0,1] neg_hi:[0,0,1]
    v_pk_fma_f32 v[70:71], v[54:55], v[104:105], v[106:107] op_sel_hi:[1,0,0] neg_lo:[0,0,1] neg_hi:[0,0,1]
    v_cvt_pk_bf16_f32 v80, v56, v57
    v_cvt_pk_bf16_f32 v81, v58, v59
    v_cvt_pk_bf16_f32 v82, v60, v61
    v_cvt_pk_bf16_f32 v83, v62, v63
    v_cvt_pk_bf16_f32 v84, v64, v65
    v_cvt_pk_bf16_f32 v85, v66, v67
    v_cvt_pk_bf16_f32 v86, v68, v69
    v_cvt_pk_bf16_f32 v87, v70, v71
    ds_write_b128 v109, v[80:83] offset:49152
    ds_write_b128 v109, v[84:87] offset:49600
    v_pk_fma_f32 v[40:41], v[40:41], v[100:101], v[102:103] op_sel_hi:[1,0,0] neg_lo:[0,0,1] neg_hi:[0,0,1]
    v_pk_fma_f32 v[42:43], v[42:43], v[100:101], v[102:103] op_sel_hi:[1,0,0] neg_lo:[0,0,1] neg_hi:[0,0,1]
    v_pk_fma_f32 v[44:45], v[44:45], v[100:101], v[102:103] op_sel_hi:[1,0,0] neg_lo:[0,0,1] neg_hi:[0,0,1]
    v_pk_fma_f32 v[46:47], v[46:47], v[100:101], v[102:103] op_sel_hi:[1,0,0] neg_lo:[0,0,1] neg_hi:[0,0,1]
    v_pk_fma_f32 v[48:49], v[48:49], v[100:101], v[102:103] op_sel_hi:[1,0,0] neg_lo:[0,0,1] neg_hi:[0,0,1]
    v_pk_fma_f32 v[50:51], v[50:51], v[100:101], v[102:103] op_sel_hi:[1,0,0] neg_lo:[0,0,1] neg_hi:[0,0,1]
    v_pk_fma_f32 v[52:53], v[52:53], v[100:101], v[102:103] op_sel_hi:[1,0,0] neg_lo:[0,0,1] neg_hi:[0,0,1]
    v_pk_fma_f32 v[54:55], v[54:55], v[100:101], v[102:103] op_sel_hi:[1,0,0] neg_lo:[0,0,1] neg_hi:[0,0,1]
    v_cvt_pk_bf16_f32 v72, v40, v41
    v_cvt_pk_bf16_f32 v73, v42, v43
    v_cvt_pk_bf16_f32 v74, v44, v45
    v_cvt_pk_bf16_f32 v75, v46, v47
    v_cvt_pk_bf16_f32 v76, v48, v49
    v_cvt_pk_bf16_f32 v77, v50, v51
    v_cvt_pk_bf16_f32 v78, v52, v53
    v_cvt_pk_bf16_f32 v79, v54, v55
    s_waitcnt lgkmcnt(0)
    s_barrier
    ds_read_b64_tr_b16 v[88:89], v110 offset:49152
    ds_read_b64_tr_b16 v[90:91], v110 offset:52992
    ds_read_b64_tr_b16 v[92:93], v110 offset:49664
    ds_read_b64_tr_b16 v[94:95], v110 offset:53504
    buffer_store_dwordx4 v[72:75], v24, s[24:27], s66 offen offset:0 sc1
    buffer_store_dwordx4 v[76:79], v24, s[24:27], s66 offen offset:448 sc1
    s_waitcnt lgkmcnt(2)
    buffer_store_dwordx4 v[88:91], v111, s[24:27], s63 offen sc1
    s_waitcnt lgkmcnt(0)
    buffer_store_dwordx4 v[92:95], v111, s[24:27], s64 offen sc1
    s_add_u32 m0, s90, 81920
    s_mov_b32 s57, 172928
    buffer_load_dwordx4 v2, s[8:11], s57 offen offset:0 lds
    v_lshrrev_b32 v119, 3, v1
    v_mul_u32_u24 v3, 896, v119
    v_xor_b32 v118, v119, v1
    v_and_b32 v118, 6, v118
    v_and_or_b32 v118, v1, 1, v118
    v_lshl_add_u32 v3, v118, 4, v3
    v_and_b32 v118, 6, v1
    v_xor_b32 v118, v118, v112
    s_mov_b32 s57, 182656
    buffer_load_dwordx4 v2, s[8:11], s57 offen offset:1024 lds
    v_lshlrev_b32 v4, 7, v115
    v_lshl_add_u32 v4, v118, 4, v4
    v_xor_b32 v25, 64, v4
    s_lshl_b32 s53, s49, 4
    s_sub_u32 s53, s53, 2
    v_min_u32 v117, 17, v1
    v_add_u32 v117, s53, v117
    v_max_i32 v117, 0, v117
    v_lshlrev_b32 v19, 5, v117
    v_add_u32 v19, 12582912, v19
    v_and_b32 v117, 1, v115
    v_cmp_eq_u32 s[76:77], 1, v117
    v_lshl_add_u32 v117, v112, 2, v117
    v_cmp_le_u32 s[78:79], v117, v115
    v_add_u32 v117, 2, v117
    v_cmp_le_u32 s[80:81], v117, v115
    s_add_u32 m0, s90, 90112
    s_mov_b32 s57, 258944
    buffer_load_dwordx4 v2, s[8:11], s57 offen offset:0 lds
    v_cmp_eq_u32 s[82:83], 3, v112
    v_mov_b32 v117, 0xffff
    v_mov_b32 v118, 0xffff0000
    v_cndmask_b32 v117, v117, v118, s[76:77]
    v_cndmask_b32 v14, v117, 0, s[78:79]
    v_cndmask_b32 v15, v117, 0, s[80:81]
    v_cndmask_b32 v16, 0, v117, s[78:79]
    v_cndmask_b32 v17, 0, v117, s[80:81]
    s_mov_b32 s91, 0x3e8b97f6
    v_mov_b32 v18, 0xf149f2ca
    s_lshl_b32 s53, s49, 3
    s_mul_i32 s72, s53, 14336
    s_add_u32 s72, s72, 6291456
    s_lshl_b32 s74, s53, 14
    s_lshl2_add_u32 s54, s48, s44
    s_lshl_b32 s54, s54, 10
    s_mov_b32 s57, 268672
    buffer_load_dwordx4 v2, s[8:11], s57 offen offset:1024 lds
    s_add_u32 s74, s74, s54
    s_add_u32 s74, s74, 4194304
    s_lshl2_add_u32 s53, s44, 0
    s_lshl_b32 s54, s44, 8
    s_add_u32 s54, s54, 0
    s_cmp_lt_u32 s53, 14
    s_cselect_b32 s68, s54, 2130706432
    s_lshl2_add_u32 s53, s44, 1
    s_lshl_b32 s54, s44, 8
    s_add_u32 s54, s54, 6144
    s_cmp_lt_u32 s53, 14
    s_cselect_b32 s69, s54, 2130706432
    s_lshl2_add_u32 s53, s44, 2
    s_lshl_b32 s54, s44, 8
    s_add_u32 s54, s54, -1920
    s_cmp_lt_u32 s53, 14
    s_cselect_b32 s70, s54, 2130706432
    s_lshl2_add_u32 s53, s44, 3
    s_lshl_b32 s54, s44, 8
    s_add_u32 s54, s54, 4224
    s_cmp_lt_u32 s53, 14
    s_cselect_b32 s71, s54, 2130706432
    s_cmp_eq_u32 s49, 0
    s_cselect_b64 s[84:85], -1, 0
    s_andn2_b64 s[86:87], s[84:85], s[80:81]
    s_andn2_b64 s[84:85], s[84:85], s[78:79]
    s_and_b32 s53, s46, 7
    s_mul_i32 s54, s44, 28
    s_add_u32 s54, s54, s53
    s_add_u32 s54, s54, 20
    s_lshl_b32 s73, s54, 16
    s_lshl_b32 s54, s45, 9
    s_add_u32 s73, s73, s54
    s_lshl3_add_u32 s75, s44, s53
    s_lshl_b32 s75, s75, 13
    v_lshrrev_b32 v5, 2, v1
    v_lshlrev_b32 v5, 12, v5
    v_lshl_add_u32 v5, v114, 7, v5
    v_lshlrev_b32 v20, 7, v1
    s_add_u32 m0, s90, 98304
    s_mov_b32 s57, 344960
    buffer_load_dwordx4 v2, s[8:11], s57 offen offset:0 lds
    s_mov_b32 s57, 354688
    buffer_load_dwordx4 v2, s[8:11], s57 offen offset:1024 lds
    s_add_u32 m0, s90, 106496
    s_mov_b32 s57, 430976
    buffer_load_dwordx4 v2, s[8:11], s57 offen offset:0 lds
    s_mov_b32 s57, 440704
    buffer_load_dwordx4 v2, s[8:11], s57 offen offset:1024 lds
    s_add_u32 m0, s90, 114688
    s_mov_b32 s57, 516992
    buffer_load_dwordx4 v2, s[8:11], s57 offen offset:0 lds
    s_mov_b32 s57, 526720
    buffer_load_dwordx4 v2, s[8:11], s57 offen offset:1024 lds
    s_add_u32 m0, s90, 122880
    s_mov_b32 s57, 603008
    buffer_load_dwordx4 v2, s[8:11], s57 offen offset:0 lds
    s_mov_b32 s57, 612736
    buffer_load_dwordx4 v2, s[8:11], s57 offen offset:1024 lds
    s_add_u32 m0, s90, 131072
    s_mov_b32 s57, 689024
    buffer_load_dwordx4 v2, s[8:11], s57 offen offset:0 lds
    s_mov_b32 s57, 698752
    buffer_load_dwordx4 v2, s[8:11], s57 offen offset:1024 lds
    s_add_u32 m0, s90, 139264
    s_mov_b32 s57, 775040
    buffer_load_dwordx4 v2, s[8:11], s57 offen offset:0 lds
    s_mov_b32 s57, 784768
    buffer_load_dwordx4 v2, s[8:11], s57 offen offset:1024 lds
    s_add_u32 m0, s90, 147456
    s_mov_b32 s57, 861056
    buffer_load_dwordx4 v2, s[8:11], s57 offen offset:0 lds
    s_mov_b32 s57, 870784
    buffer_load_dwordx4 v2, s[8:11], s57 offen offset:1024 lds
    s_add_u32 m0, s90, 155648
    s_mov_b32 s57, 947072
    buffer_load_dwordx4 v2, s[8:11], s57 offen offset:0 lds
    s_mov_b32 s57, 956800
    buffer_load_dwordx4 v2, s[8:11], s57 offen offset:1024 lds
    s_waitcnt vmcnt(20)
    v_cmp_eq_u32 vcc, 0, v29
    s_nop 0
    s_cbranch_vccz L_ok12
    s_mov_b32 s59, 20000
L_spin11:
    s_sleep 2
    buffer_load_dword v29, off, s[40:43], 0 sc1
    s_waitcnt vmcnt(0)
    v_cmp_eq_u32 vcc, 0, v29
    s_nop 0
    s_cbranch_vccz L_ok12
    s_sub_u32 s59, s59, 1
    s_cbranch_scc0 L_spin11
L_ok12:
    v_readfirstlane_b32 s47, v29
    s_barrier
    s_cmp_lg_u32 s44, 0
    s_cbranch_scc1 L_nopub13
    s_lshl_b32 s60, s2, 5
    s_add_u32 s60, s60, 12582912
    v_mov_b32 v30, s47
    s_mov_b64 exec, 1
    buffer_store_dword v30, off, s[24:27], s60 sc1
    s_mov_b64 exec, -1
L_nopub13:
    s_waitcnt vmcnt(18)
    s_barrier
    s_add_u32 m0, s90, 0
    s_mov_b32 s57, 1033088
    buffer_load_dwordx4 v2, s[8:11], s57 offen offset:0 lds
    s_mov_b32 s57, 1042816
    buffer_load_dwordx4 v2, s[8:11], s57 offen offset:1024 lds
    ds_read_b64_tr_b16 a[8:9], v6 offset:0
    ds_read_b64_tr_b16 a[10:11], v6 offset:1024
    ds_read_b64_tr_b16 a[12:13], v7 offset:0
    ds_read_b64_tr_b16 a[14:15], v7 offset:1024
    s_add_u32 m0, s90, 8192
    s_mov_b32 s57, 1119104
    buffer_load_dwordx4 v2, s[8:11], s57 offen offset:0 lds
    s_mov_b32 s57, 1128832
    buffer_load_dwordx4 v2, s[8:11], s57 offen offset:1024 lds
    ds_read_b64_tr_b16 a[32:33], v6 offset:8192
    ds_read_b64_tr_b16 a[34:35], v6 offset:9216
    ds_read_b64_tr_b16 a[36:37], v7 offset:8192
    ds_read_b64_tr_b16 a[38:39], v7 offset:9216
    s_add_u32 m0, s90, 16384
    s_mov_b32 s57, 1792
    buffer_load_dwordx4 v2, s[8:11], s57 offen offset:0 lds
    s_mov_b32 s57, 11520
    buffer_load_dwordx4 v2, s[8:11], s57 offen offset:1024 lds
    ds_read_b64_tr_b16 a[56:57], v6 offset:16384
    ds_read_b64_tr_b16 a[58:59], v6 offset:17408
    ds_read_b64_tr_b16 a[60:61], v7 offset:16384
    ds_read_b64_tr_b16 a[62:63], v7 offset:17408
    s_waitcnt vmcnt(18)
    s_waitcnt lgkmcnt(0)
    s_barrier
    s_add_u32 m0, s90, 24576
    s_mov_b32 s57, 87808
    buffer_load_dwordx4 v2, s[8:11], s57 offen offset:0 lds
    s_mov_b32 s57, 97536
    buffer_load_dwordx4 v2, s[8:11], s57 offen offset:1024 lds
    ds_read_b64_tr_b16 a[80:81], v6 offset:24576
    ds_read_b64_tr_b16 a[82:83], v6 offset:25600
    ds_read_b64_tr_b16 a[84:85], v7 offset:24576
    ds_read_b64_tr_b16 a[86:87], v7 offset:25600
    s_add_u32 m0, s90, 32768
    s_mov_b32 s57, 173824
    buffer_load_dwordx4 v2, s[8:11], s57 offen offset:0 lds
    s_mov_b32 s57, 183552
    buffer_load_dwordx4 v2, s[8:11], s57 offen offset:1024 lds
    ds_read_b64_tr_b16 a[104:105], v6 offset:32768
    ds_read_b64_tr_b16 a[106:107], v6 offset:33792
    ds_read_b64_tr_b16 a[108:109], v7 offset:32768
    ds_read_b64_tr_b16 a[110:111], v7 offset:33792
    s_add_u32 m0, s90, 40960
    s_mov_b32 s57, 259840
    buffer_load_dwordx4 v2, s[8:11], s57 offen offset:0 lds
    s_mov_b32 s57, 269568
    buffer_load_dwordx4 v2, s[8:11], s57 offen offset:1024 lds
    ds_read_b64_tr_b16 a[128:129], v6 offset:40960
    ds_read_b64_tr_b16 a[130:131], v6 offset:41984
    ds_read_b64_tr_b16 a[132:133], v7 offset:40960
    ds_read_b64_tr_b16 a[134:135], v7 offset:41984
    s_waitcnt vmcnt(18)
    s_waitcnt lgkmcnt(0)
    s_barrier
    s_add_u32 m0, s90, 65536
    s_mov_b32 s57, 345856
    buffer_load_dwordx4 v2, s[8:11], s57 offen offset:0 lds
    s_mov_b32 s57, 355584
    buffer_load_dwordx4 v2, s[8:11], s57 offen offset:1024 lds
    ds_read_b64_tr_b16 a[152:153], v10 offset:0
    ds_read_b64_tr_b16 a[154:155], v10 offset:1024
    ds_read_b64_tr_b16 a[156:157], v11 offset:0
    ds_read_b64_tr_b16 a[158:159], v11 offset:1024
    s_add_u32 m0, s90, 73728
    s_mov_b32 s57, 431872
    buffer_load_dwordx4 v2, s[8:11], s57 offen offset:0 lds
    s_mov_b32 s57, 441600
    buffer_load_dwordx4 v2, s[8:11], s57 offen offset:1024 lds
    ds_read_b64_tr_b16 a[176:177], v10 offset:8192
    ds_read_b64_tr_b16 a[178:179], v10 offset:9216
    ds_read_b64_tr_b16 a[180:181], v11 offset:8192
    ds_read_b64_tr_b16 a[182:183], v11 offset:9216
    s_add_u32 m0, s90, 81920
    s_mov_b32 s57, 517888
    buffer_load_dwordx4 v2, s[8:11], s57 offen offset:0 lds
    s_mov_b32 s57, 527616
    buffer_load_dwordx4 v2, s[8:11], s57 offen offset:1024 lds
    ds_read_b64_tr_b16 a[200:201], v10 offset:16384
    ds_read_b64_tr_b16 a[202:203], v10 offset:17408
    ds_read_b64_tr_b16 a[204:205], v11 offset:16384
    ds_read_b64_tr_b16 a[206:207], v11 offset:17408
    s_waitcnt vmcnt(18)
    s_waitcnt lgkmcnt(0)
    s_barrier
    s_add_u32 m0, s90, 90112
    s_mov_b32 s57, 603904
    buffer_load_dwordx4 v2, s[8:11], s57 offen offset:0 lds
    s_mov_b32 s57, 613632
    buffer_load_dwordx4 v2, s[8:11], s57 offen offset:1024 lds
    ds_read_b64_tr_b16 a[224:225], v10 offset:24576
    ds_read_b64_tr_b16 a[226:227], v10 offset:25600
    ds_read_b64_tr_b16 a[228:229], v11 offset:24576
    ds_read_b64_tr_b16 a[230:231], v11 offset:25600
    s_add_u32 m0, s90, 98304
    s_mov_b32 s57, 689920
    buffer_load_dwordx4 v2, s[8:11], s57 offen offset:0 lds
    s_mov_b32 s57, 699648
    buffer_load_dwordx4 v2, s[8:11], s57 offen offset:1024 lds
    ds_read_b64_tr_b16 a[248:249], v10 offset:32768
    ds_read_b64_tr_b16 a[250:251], v10 offset:33792
    ds_read_b64_tr_b16 a[252:253], v11 offset:32768
    ds_read_b64_tr_b16 a[254:255], v11 offset:33792
    s_add_u32 m0, s90, 106496
    s_mov_b32 s57, 775936
    buffer_load_dwordx4 v2, s[8:11], s57 offen offset:0 lds
    s_mov_b32 s57, 785664
    buffer_load_dwordx4 v2, s[8:11], s57 offen offset:1024 lds
    ds_read_b64_tr_b16 v[192:193], v10 offset:40960
    ds_read_b64_tr_b16 v[194:195], v10 offset:41984
    ds_read_b64_tr_b16 v[196:197], v11 offset:40960
    ds_read_b64_tr_b16 v[198:199], v11 offset:41984
    s_waitcnt vmcnt(18)
    s_waitcnt lgkmcnt(0)
    s_barrier
    ds_read_b64_tr_b16 v[216:217], v120 offset:0
    ds_read_b64_tr_b16 v[218:219], v120 offset:1024
    ds_read_b64_tr_b16 v[220:221], v121 offset:0
    ds_read_b64_tr_b16 v[222:223], v121 offset:1024
    ds_read_b64_tr_b16 v[240:241], v120 offset:8192
    ds_read_b64_tr_b16 v[242:243], v120 offset:9216
    ds_read_b64_tr_b16 v[244:245], v121 offset:8192
    ds_read_b64_tr_b16 v[246:247], v121 offset:9216
    buffer_load_dword v21, v19, s[24:27], 0 offen sc1
    ds_read_b64_tr_b16 a[16:17], v122 offset:16384
    ds_read_b64_tr_b16 a[18:19], v122 offset:17408
    ds_read_b64_tr_b16 a[20:21], v123 offset:16384
    ds_read_b64_tr_b16 a[22:23], v123 offset:17408
    s_add_u32 m0, s90, 114688
    s_mov_b32 s57, 861952
    buffer_load_dwordx4 v2, s[8:11], s57 offen offset:0 lds
    s_waitcnt vmcnt(14)
    s_waitcnt lgkmcnt(0)
    s_barrier
    ds_read_b64_tr_b16 a[40:41], v122 offset:24576
    ds_read_b64_tr_b16 a[42:43], v122 offset:25600
    ds_read_b64_tr_b16 a[44:45], v123 offset:24576
    ds_read_b64_tr_b16 a[46:47], v123 offset:25600
    ds_read_b64_tr_b16 a[64:65], v122 offset:32768
    ds_read_b64_tr_b16 a[66:67], v122 offset:33792
    ds_read_b64_tr_b16 a[68:69], v123 offset:32768
    ds_read_b64_tr_b16 a[70:71], v123 offset:33792
    ds_read_b64_tr_b16 a[88:89], v122 offset:40960
    ds_read_b64_tr_b16 a[90:91], v122 offset:41984
    ds_read_b64_tr_b16 a[92:93], v123 offset:40960
    ds_read_b64_tr_b16 a[94:95], v123 offset:41984
    s_mov_b32 s57, 871680
    buffer_load_dwordx4 v2, s[8:11], s57 offen offset:1024 lds
    s_add_u32 m0, s90, 122880
    s_mov_b32 s57, 947968
    buffer_load_dwordx4 v2, s[8:11], s57 offen offset:0 lds
    s_mov_b32 s57, 957696
    buffer_load_dwordx4 v2, s[8:11], s57 offen offset:1024 lds
    s_add_u32 m0, s90, 131072
    s_mov_b32 s57, 1033984
    buffer_load_dwordx4 v2, s[8:11], s57 offen offset:0 lds
    s_waitcnt vmcnt(12)
    s_waitcnt lgkmcnt(0)
    s_barrier
    ds_read_b64_tr_b16 a[112:113], v8 offset:0
    ds_read_b64_tr_b16 a[114:115], v8 offset:1024
    ds_read_b64_tr_b16 a[116:117], v9 offset:0
    ds_read_b64_tr_b16 a[118:119], v9 offset:1024
    ds_read_b64_tr_b16 a[136:137], v8 offset:8192
    ds_read_b64_tr_b16 a[138:139], v8 offset:9216
    ds_read_b64_tr_b16 a[140:141], v9 offset:8192
    ds_read_b64_tr_b16 a[142:143], v9 offset:9216
    ds_read_b64_tr_b16 a[160:161], v8 offset:16384
    ds_read_b64_tr_b16 a[162:163], v8 offset:17408
    ds_read_b64_tr_b16 a[164:165], v9 offset:16384
    ds_read_b64_tr_b16 a[166:167], v9 offset:17408
    s_mov_b32 s57, 1043712
    buffer_load_dwordx4 v2, s[8:11], s57 offen offset:1024 lds
    s_waitcnt vmcnt(6)
    v_cmp_ne_u32 vcc, s47, v21
    s_nop 0
    s_cbranch_vccz L_ok15
    s_mov_b32 s59, 20000
L_spin14:
    s_sleep 2
    buffer_load_dword v21, v19, s[24:27], 0 offen sc1
    s_waitcnt vmcnt(0)
    v_cmp_ne_u32 vcc, s47, v21
    s_nop 0
    s_cbranch_vccz L_ok15
    s_sub_u32 s59, s59, 1
    s_cbranch_scc0 L_spin14
L_ok15:
    s_add_u32 m0, s52, 0
    s_sub_u32 s58, s72, 14336
    s_max_u32 s58, s58, 6291456
    s_add_u32 s57, s58, s68
    buffer_load_dwordx4 v3, s[24:27], s57 offen offset:0 sc1 lds
    s_add_u32 s57, s58, s69
    buffer_load_dwordx4 v3, s[24:27], s57 offen offset:1024 sc1 lds
    s_add_u32 s57, s58, s70
    buffer_load_dwordx4 v3, s[24:27], s57 offen offset:2048 sc1 lds
    s_add_u32 s57, s58, s71
    buffer_load_dwordx4 v3, s[24:27], s57 offen offset:3072 sc1 lds
    s_add_u32 m0, s52, 16384
    s_add_u32 s58, s72, 0
    s_add_u32 s57, s58, s68
    buffer_load_dwordx4 v3, s[24:27], s57 offen offset:0 sc1 lds
    s_waitcnt lgkmcnt(0)
    s_barrier
    ds_read_b64_tr_b16 a[184:185], v8 offset:24576
    ds_read_b64_tr_b16 a[186:187], v8 offset:25600
    ds_read_b64_tr_b16 a[188:189], v9 offset:24576
    ds_read_b64_tr_b16 a[190:191], v9 offset:25600
    ds_read_b64_tr_b16 a[208:209], v8 offset:32768
    ds_read_b64_tr_b16 a[210:211], v8 offset:33792
    ds_read_b64_tr_b16 a[212:213], v9 offset:32768
    ds_read_b64_tr_b16 a[214:215], v9 offset:33792
    ds_read_b64_tr_b16 a[232:233], v8 offset:40960
    ds_read_b64_tr_b16 a[234:235], v8 offset:41984
    ds_read_b64_tr_b16 a[236:237], v9 offset:40960
    ds_read_b64_tr_b16 a[238:239], v9 offset:41984
    s_add_u32 s57, s58, s69
    buffer_load_dwordx4 v3, s[24:27], s57 offen offset:1024 sc1 lds
    s_add_u32 s57, s58, s70
    buffer_load_dwordx4 v3, s[24:27], s57 offen offset:2048 sc1 lds
    s_add_u32 s57, s58, s71
    buffer_load_dwordx4 v3, s[24:27], s57 offen offset:3072 sc1 lds
    s_add_u32 m0, s90, 139264
    s_mov_b32 s57, 1120000
    buffer_load_dwordx4 v2, s[8:11], s57 offen offset:0 lds
    s_mov_b32 s57, 1129728
    buffer_load_dwordx4 v2, s[8:11], s57 offen offset:1024 lds
    s_add_u32 m0, s90, 147456
    s_mov_b32 s57, 0
    buffer_load_dwordx4 v2, s[8:11], s57 offen offset:0 lds
    s_mov_b32 s57, 9728
    buffer_load_dwordx4 v2, s[8:11], s57 offen offset:1024 lds
    s_add_u32 m0, s90, 155648
    s_mov_b32 s57, 86016
    buffer_load_dwordx4 v2, s[8:11], s57 offen offset:0 lds
    s_mov_b32 s57, 95744
    buffer_load_dwordx4 v2, s[8:11], s57 offen offset:1024 lds
    s_add_u32 m0, s52, 32768
    s_add_u32 s58, s72, 14336
    s_add_u32 s57, s58, s68
    buffer_load_dwordx4 v3, s[24:27], s57 offen offset:0 sc1 lds
    s_add_u32 s57, s58, s69
    buffer_load_dwordx4 v3, s[24:27], s57 offen offset:1024 sc1 lds
    s_waitcnt vmcnt(12)
    s_waitcnt lgkmcnt(0)
    s_barrier
    ds_read_b128 v[120:123], v4 offset:0
    ds_read_b128 v[124:127], v25 offset:0
    ds_read_b128 v[128:131], v4 offset:2048
    ds_read_b128 v[132:135], v25 offset:2048
    ds_read_b128 v[136:139], v4 offset:4096
    ds_read_b128 v[140:143], v25 offset:4096
    ds_read_b128 v[144:147], v4 offset:6144
    ds_read_b128 v[148:151], v25 offset:6144
    ds_read_b128 v[152:155], v4 offset:8192
    ds_read_b128 v[156:159], v25 offset:8192
    ds_read_b128 v[160:163], v4 offset:10240
    ds_read_b128 v[164:167], v25 offset:10240
    ds_read_b128 v[168:171], v4 offset:12288
    ds_read_b128 v[172:175], v25 offset:12288
    s_waitcnt lgkmcnt(11)
    v_mfma_f32_16x16x32_bf16 v[96:99], a[8:11], v[120:123], 0
    s_add_u32 s57, s58, s70
    ds_read_b64_tr_b16 v[176:177], v12 offset:0
    v_mfma_f32_16x16x32_bf16 v[96:99], a[32:35], v[124:127], v[96:99]
    buffer_load_dwordx4 v3, s[24:27], s57 offen offset:2048 sc1 lds
    v_mfma_f32_16x16x32_bf16 v[96:99], a[56:59], v[128:131], v[96:99]
    ds_read_b64_tr_b16 v[178:179], v12 offset:1024
    ds_read_b64_tr_b16 v[180:181], v13 offset:0
    s_waitcnt lgkmcnt(11)
    v_mfma_f32_16x16x32_bf16 v[96:99], a[80:83], v[132:135], v[96:99]
    ds_read_b64_tr_b16 v[182:183], v13 offset:1024
    ds_read_b64_tr_b16 v[200:201], v12 offset:8192
    v_mfma_f32_16x16x32_bf16 v[96:99], a[104:107], v[136:139], v[96:99]
    s_add_u32 s57, s58, s71
    ds_read_b64_tr_b16 v[202:203], v12 offset:9216
    v_mfma_f32_16x16x32_bf16 v[96:99], a[128:131], v[140:143], v[96:99]
    buffer_load_dwordx4 v3, s[24:27], s57 offen offset:3072 sc1 lds
    s_waitcnt lgkmcnt(11)
    v_mfma_f32_16x16x32_bf16 v[96:99], a[152:155], v[144:147], v[96:99]
    ds_read_b64_tr_b16 v[204:205], v13 offset:8192
    ds_read_b64_tr_b16 v[206:207], v13 offset:9216
    v_mfma_f32_16x16x32_bf16 v[96:99], a[176:179], v[148:151], v[96:99]
    ds_read_b64_tr_b16 v[224:225], v12 offset:16384
    ds_read_b64_tr_b16 v[226:227], v12 offset:17408
    v_mfma_f32_16x16x32_bf16 v[96:99], a[200:203], v[152:155], v[96:99]
    s_add_u32 m0, s90, 65536
    s_mov_b32 s57, 172032
    ds_read_b64_tr_b16 v[228:229], v13 offset:16384
    s_waitcnt lgkmcnt(13)
    v_mfma_f32_16x16x32_bf16 v[96:99], a[224:227], v[156:159], v[96:99]
    buffer_load_dwordx4 v2, s[8:11], s57 offen offset:0 lds
    v_mfma_f32_16x16x32_bf16 v[96:99], a[248:251], v[160:163], v[96:99]
    ds_read_b64_tr_b16 v[230:231], v13 offset:17408
    v_mfma_f32_16x16x32_bf16 v[96:99], v[192:195], v[164:167], v[96:99]
    s_waitcnt lgkmcnt(12)
    v_mfma_f32_16x16x32_bf16 v[96:99], v[216:219], v[168:171], v[96:99]
    s_mov_b32 s57, 181760
    v_mfma_f32_16x16x32_bf16 v[96:99], v[240:243], v[172:175], v[96:99]
    buffer_load_dwordx4 v2, s[8:11], s57 offen offset:1024 lds
    s_waitcnt vmcnt(12)
    s_barrier
    v_mfma_f32_16x16x32_bf16 v[100:103], a[12:15], v[120:123], 0
    ds_read_b128 v[120:123], v4 offset:16384
    v_mfma_f32_16x16x32_bf16 v[100:103], a[36:39], v[124:127], v[100:103]
    ds_read_b128 v[124:127], v25 offset:16384
    v_mfma_f32_16x16x32_bf16 v[100:103], a[60:63], v[128:131], v[100:103]
    ds_read_b128 v[128:131], v4 offset:18432
    s_add_u32 m0, s90, 73728
    s_mov_b32 s57, 258048
    v_mfma_f32_16x16x32_bf16 v[100:103], a[84:87], v[132:135], v[100:103]
    ds_read_b128 v[132:135], v25 offset:18432
    buffer_load_dwordx4 v2, s[8:11], s57 offen offset:0 lds
    v_mfma_f32_16x16x32_bf16 v[100:103], a[108:111], v[136:139], v[100:103]
    ds_read_b128 v[136:139], v4 offset:20480
    v_mfma_f32_16x16x32_bf16 v[100:103], a[132:135], v[140:143], v[100:103]
    ds_read_b128 v[140:143], v25 offset:20480
    v_mfma_f32_16x16x32_bf16 v[100:103], a[156:159], v[144:147], v[100:103]
    ds_read_b128 v[144:147], v4 offset:22528
    s_mov_b32 s57, 267776
    v_mfma_f32_16x16x32_bf16 v[100:103], a[180:183], v[148:151], v[100:103]
    ds_read_b128 v[148:151], v25 offset:22528
    buffer_load_dwordx4 v2, s[8:11], s57 offen offset:1024 lds
    v_mfma_f32_16x16x32_bf16 v[100:103], a[204:207], v[152:155], v[100:103]
    ds_read_b128 v[152:155], v4 offset:24576
    v_cvt_pk_bf16_f32 v52, v96, v97
    v_mfma_f32_16x16x32_bf16 v[100:103], a[228:231], v[156:159], v[100:103]
    ds_read_b128 v[156:159], v25 offset:24576
    v_cvt_pk_bf16_f32 v53, v98, v99
    v_mfma_f32_16x16x32_bf16 v[100:103], a[252:255], v[160:163], v[100:103]
    ds_read_b128 v[160:163], v4 offset:26624
    s_add_u32 m0, s90, 81920
    s_mov_b32 s57, 344064
    v_mfma_f32_16x16x32_bf16 v[100:103], v[196:199], v[164:167], v[100:103]
    ds_read_b128 v[164:167], v25 offset:26624
    buffer_load_dwordx4 v2, s[8:11], s57 offen offset:0 lds
    v_mfma_f32_16x16x32_bf16 v[100:103], v[220:223], v[168:171], v[100:103]
    ds_read_b128 v[168:171], v4 offset:28672
    v_mfma_f32_16x16x32_bf16 v[100:103], v[244:247], v[172:175], v[100:103]
    ds_read_b128 v[172:175], v25 offset:28672
    s_waitcnt lgkmcnt(11)
    v_mfma_f32_16x16x32_bf16 v[104:107], a[8:11], v[120:123], 0
    s_mov_b32 s57, 353792
    v_mfma_f32_16x16x32_bf16 v[104:107], a[32:35], v[124:127], v[104:107]
    buffer_load_dwordx4 v2, s[8:11], s57 offen offset:1024 lds
    v_mfma_f32_16x16x32_bf16 v[104:107], a[56:59], v[128:131], v[104:107]
    s_waitcnt lgkmcnt(8)
    v_mfma_f32_16x16x32_bf16 v[104:107], a[80:83], v[132:135], v[104:107]
    s_waitcnt vmcnt(10)
    s_barrier
    v_mfma_f32_16x16x32_bf16 v[104:107], a[104:107], v[136:139], v[104:107]
    s_add_u32 m0, s90, 90112
    s_mov_b32 s57, 430080
    ds_read_b64_tr_b16 v[248:249], v12 offset:24576
    v_mfma_f32_16x16x32_bf16 v[104:107], a[128:131], v[140:143], v[104:107]
    buffer_load_dwordx4 v2, s[8:11], s57 offen offset:0 lds
    s_waitcnt lgkmcnt(6)
    v_mfma_f32_16x16x32_bf16 v[104:107], a[152:155], v[144:147], v[104:107]
    v_cvt_pk_bf16_f32 v54, v100, v101
    v_cvt_pk_bf16_f32 v55, v102, v103
    v_mfma_f32_16x16x32_bf16 v[104:107], a[176:179], v[148:151], v[104:107]
    v_cndmask_b32 v54, v54, 0, s[82:83]
    v_cndmask_b32 v55, v55, 0, s[82:83]
    v_mfma_f32_16x16x32_bf16 v[104:107], a[200:203], v[152:155], v[104:107]
    s_mov_b32 s57, 439808
    ds_read_b64_tr_b16 v[250:251], v12 offset:25600
    s_waitcnt lgkmcnt(4)
    v_mfma_f32_16x16x32_bf16 v[104:107], a[224:227], v[156:159], v[104:107]
    buffer_load_dwordx4 v2, s[8:11], s57 offen offset:1024 lds
    v_mfma_f32_16x16x32_bf16 v[104:107], a[248:251], v[160:163], v[104:107]
    ds_read_b64_tr_b16 v[252:253], v13 offset:24576
    ds_read_b64_tr_b16 v[254:255], v13 offset:25600
    v_mfma_f32_16x16x32_bf16 v[104:107], v[192:195], v[164:167], v[104:107]
    ds_read_b64_tr_b16 a[0:1], v10 offset:32768
    ds_read_b64_tr_b16 a[2:3], v10 offset:33792
    s_waitcnt lgkmcnt(6)
    v_mfma_f32_16x16x32_bf16 v[104:107], v[216:219], v[168:171], v[104:107]
    s_add_u32 m0, s90, 98304
    s_mov_b32 s57, 516096
    ds_read_b64_tr_b16 a[4:5], v11 offset:32768
    v_mfma_f32_16x16x32_bf16 v[104:107], v[240:243], v[172:175], v[104:107]
    buffer_load_dwordx4 v2, s[8:11], s57 offen offset:0 lds
    s_waitcnt vmcnt(9)
    s_barrier
    v_mfma_f32_16x16x32_bf16 v[108:111], a[12:15], v[120:123], 0
    ds_read_b128 v[120:123], v4 offset:32768
    ds_read_b64_tr_b16 a[6:7], v11 offset:33792
    v_mfma_f32_16x16x32_bf16 v[108:111], a[36:39], v[124:127], v[108:111]
    ds_read_b128 v[124:127], v25 offset:32768
    ds_read_b64_tr_b16 a[24:25], v10 offset:40960
    v_mfma_f32_16x16x32_bf16 v[108:111], a[60:63], v[128:131], v[108:111]
    ds_read_b128 v[128:131], v4 offset:34816
    s_mov_b32 s57, 525824
    v_mfma_f32_16x16x32_bf16 v[108:111], a[84:87], v[132:135], v[108:111]
    ds_read_b128 v[132:135], v25 offset:34816
    buffer_load_dwordx4 v2, s[8:11], s57 offen offset:1024 lds
    v_mfma_f32_16x16x32_bf16 v[108:111], a[108:111], v[136:139], v[108:111]
    ds_read_b128 v[136:139], v4 offset:36864
    ds_read_b64_tr_b16 a[26:27], v10 offset:41984
    v_mfma_f32_16x16x32_bf16 v[108:111], a[132:135], v[140:143], v[108:111]
    ds_read_b128 v[140:143], v25 offset:36864
    ds_read_b64_tr_b16 a[28:29], v11 offset:40960
    v_mfma_f32_16x16x32_bf16 v[108:111], a[156:159], v[144:147], v[108:111]
    ds_read_b128 v[144:147], v4 offset:38912
    s_add_u32 m0, s90, 106496
    s_mov_b32 s57, 602112
    v_mfma_f32_16x16x32_bf16 v[108:111], a[180:183], v[148:151], v[108:111]
    ds_read_b128 v[148:151], v25 offset:38912
    buffer_load_dwordx4 v2, s[8:11], s57 offen offset:0 lds
    v_mfma_f32_16x16x32_bf16 v[108:111], a[204:207], v[152:155], v[108:111]
    ds_read_b128 v[152:155], v4 offset:40960
    v_cvt_pk_bf16_f32 v56, v104, v105
    v_mfma_f32_16x16x32_bf16 v[108:111], a[228:231], v[156:159], v[108:111]
    ds_read_b128 v[156:159], v25 offset:40960
    v_cvt_pk_bf16_f32 v57, v106, v107
    v_mfma_f32_16x16x32_bf16 v[108:111], a[252:255], v[160:163], v[108:111]
    ds_read_b128 v[160:163], v4 offset:43008
    s_mov_b32 s57, 611840
    v_mfma_f32_16x16x32_bf16 v[108:111], v[196:199], v[164:167], v[108:111]
    ds_read_b128 v[164:167], v25 offset:43008
    buffer_load_dwordx4 v2, s[8:11], s57 offen offset:1024 lds
    v_mfma_f32_16x16x32_bf16 v[108:111], v[220:223], v[168:171], v[108:111]
    ds_read_b128 v[168:171], v4 offset:45056
    ds_read_b64_tr_b16 a[30:31], v11 offset:41984
    v_mfma_f32_16x16x32_bf16 v[108:111], v[244:247], v[172:175], v[108:111]
    ds_read_b128 v[172:175], v25 offset:45056
    s_waitcnt lgkmcnt(14)
    v_mfma_f32_16x16x32_bf16 v[112:115], a[8:11], v[120:123], 0
    s_add_u32 m0, s90, 114688
    s_mov_b32 s57, 688128
    v_mfma_f32_16x16x32_bf16 v[112:115], a[32:35], v[124:127], v[112:115]
    buffer_load_dwordx4 v2, s[8:11], s57 offen offset:0 lds
    v_mfma_f32_16x16x32_bf16 v[112:115], a[56:59], v[128:131], v[112:115]
    s_waitcnt lgkmcnt(10)
    v_mfma_f32_16x16x32_bf16 v[112:115], a[80:83], v[132:135], v[112:115]
    v_mfma_f32_16x16x32_bf16 v[112:115], a[104:107], v[136:139], v[112:115]
    s_mov_b32 s57, 697856
    v_mfma_f32_16x16x32_bf16 v[112:115], a[128:131], v[140:143], v[112:115]
    buffer_load_dwordx4 v2, s[8:11], s57 offen offset:1024 lds
    s_waitcnt lgkmcnt(6)
    v_mfma_f32_16x16x32_bf16 v[112:115], a[152:155], v[144:147], v[112:115]
    v_cvt_pk_bf16_f32 v58, v108, v109
    v_cvt_pk_bf16_f32 v59, v110, v111
    v_mfma_f32_16x16x32_bf16 v[112:115], a[176:179], v[148:151], v[112:115]
    v_cndmask_b32 v58, v58, 0, s[82:83]
    v_cndmask_b32 v59, v59, 0, s[82:83]
    v_mfma_f32_16x16x32_bf16 v[112:115], a[200:203], v[152:155], v[112:115]
    s_add_u32 m0, s90, 122880
    s_mov_b32 s57, 774144
    s_waitcnt lgkmcnt(3)
    v_mfma_f32_16x16x32_bf16 v[112:115], a[224:227], v[156:159], v[112:115]
    buffer_load_dwordx4 v2, s[8:11], s57 offen offset:0 lds
    v_mfma_f32_16x16x32_bf16 v[112:115], a[248:251], v[160:163], v[112:115]
    v_mfma_f32_16x16x32_bf16 v[112:115], v[192:195], v[164:167], v[112:115]
    s_waitcnt lgkmcnt(0)
    v_mfma_f32_16x16x32_bf16 v[112:115], v[216:219], v[168:171], v[112:115]
    s_mov_b32 s57, 783872
    v_mfma_f32_16x16x32_bf16 v[112:115], v[240:243], v[172:175], v[112:115]
    buffer_load_dwordx4 v2, s[8:11], s57 offen offset:1024 lds
    v_mfma_f32_16x16x32_bf16 v[116:119], a[12:15], v[120:123], 0
    v_mfma_f32_16x16x32_bf16 v[116:119], a[36:39], v[124:127], v[116:119]
    s_waitcnt vmcnt(10)
    s_barrier
    v_mfma_f32_16x16x32_bf16 v[116:119], a[60:63], v[128:131], v[116:119]
    s_add_u32 m0, s90, 131072
    s_mov_b32 s57, 860160
    ds_read_b64_tr_b16 a[48:49], v6 offset:0
    v_mfma_f32_16x16x32_bf16 v[116:119], a[84:87], v[132:135], v[116:119]
    buffer_load_dwordx4 v2, s[8:11], s57 offen offset:0 lds
    v_mfma_f32_16x16x32_bf16 v[116:119], a[108:111], v[136:139], v[116:119]
    ds_read_b64_tr_b16 a[50:51], v6 offset:1024
    ds_read_b64_tr_b16 a[52:53], v7 offset:0
    v_mfma_f32_16x16x32_bf16 v[116:119], a[132:135], v[140:143], v[116:119]
    ds_read_b64_tr_b16 a[54:55], v7 offset:1024
    ds_read_b64_tr_b16 a[72:73], v6 offset:8192
    v_mfma_f32_16x16x32_bf16 v[116:119], a[156:159], v[144:147], v[116:119]
    s_mov_b32 s57, 869888
    v_cvt_pk_bf16_f32 v60, v112, v113
    v_mfma_f32_16x16x32_bf16 v[116:119], a[180:183], v[148:151], v[116:119]
    buffer_load_dwordx4 v2, s[8:11], s57 offen offset:1024 lds
    v_mfma_f32_16x16x32_bf16 v[116:119], a[204:207], v[152:155], v[116:119]
    v_cvt_pk_bf16_f32 v61, v114, v115
    ds_read_b64_tr_b16 a[74:75], v6 offset:9216
    v_mfma_f32_16x16x32_bf16 v[116:119], a[228:231], v[156:159], v[116:119]
    ds_read_b64_tr_b16 a[76:77], v7 offset:8192
    ds_read_b64_tr_b16 a[78:79], v7 offset:9216
    v_mfma_f32_16x16x32_bf16 v[116:119], a[252:255], v[160:163], v[116:119]
    s_add_u32 m0, s90, 139264
    s_mov_b32 s57, 946176
    ds_read_b64_tr_b16 a[96:97], v6 offset:16384
    v_mfma_f32_16x16x32_bf16 v[116:119], v[196:199], v[164:167], v[116:119]
    buffer_load_dwordx4 v2, s[8:11], s57 offen offset:0 lds
    v_mfma_f32_16x16x32_bf16 v[116:119], v[220:223], v[168:171], v[116:119]
    ds_read_b64_tr_b16 a[98:99], v6 offset:17408
    ds_read_b64_tr_b16 a[100:101], v7 offset:16384
    v_mfma_f32_16x16x32_bf16 v[116:119], v[244:247], v[172:175], v[116:119]
    ds_read_b64_tr_b16 a[102:103], v7 offset:17408
    v_mfma_f32_16x16x32_bf16 v[96:99], v[120:123], a[16:19], 0
    s_mov_b32 s57, 955904
    v_mfma_f32_16x16x32_bf16 v[96:99], v[124:127], a[40:43], v[96:99]
    buffer_load_dwordx4 v2, s[8:11], s57 offen offset:1024 lds
    v_mfma_f32_16x16x32_bf16 v[96:99], v[128:131], a[64:67], v[96:99]
    v_mfma_f32_16x16x32_bf16 v[96:99], v[132:135], a[88:91], v[96:99]
    v_mfma_f32_16x16x32_bf16 v[96:99], v[136:139], a[112:115], v[96:99]
    s_add_u32 m0, s90, 147456
    s_mov_b32 s57, 1032192
    v_mfma_f32_16x16x32_bf16 v[96:99], v[140:143], a[136:139], v[96:99]
    buffer_load_dwordx4 v2, s[8:11], s57 offen offset:0 lds
    v_mfma_f32_16x16x32_bf16 v[96:99], v[144:147], a[160:163], v[96:99]
    v_cvt_pk_bf16_f32 v62, v116, v117
    v_cvt_pk_bf16_f32 v63, v118, v119
    v_mfma_f32_16x16x32_bf16 v[96:99], v[148:151], a[184:187], v[96:99]
    v_cndmask_b32 v62, v62, 0, s[82:83]
    v_cndmask_b32 v63, v63, 0, s[82:83]
    v_mfma_f32_16x16x32_bf16 v[96:99], v[152:155], a[208:211], v[96:99]
    s_mov_b32 s57, 1041920
    v_mfma_f32_16x16x32_bf16 v[96:99], v[156:159], a[232:235], v[96:99]
    buffer_load_dwordx4 v2, s[8:11], s57 offen offset:1024 lds
    v_mfma_f32_16x16x32_bf16 v[96:99], v[160:163], v[176:179], v[96:99]
    v_mfma_f32_16x16x32_bf16 v[96:99], v[164:167], v[200:203], v[96:99]
    s_waitcnt vmcnt(10)
    s_waitcnt lgkmcnt(0)
    s_barrier
    v_mfma_f32_16x16x32_bf16 v[96:99], v[168:171], v[224:227], v[96:99]
    s_add_u32 m0, s90, 155648
    s_mov_b32 s57, 1118208
    ds_read_b64_tr_b16 a[120:121], v6 offset:24576
    v_mfma_f32_16x16x32_bf16 v[96:99], v[172:175], v[248:251], v[96:99]
    buffer_load_dwordx4 v2, s[8:11], s57 offen offset:0 lds
    v_mfma_f32_16x16x32_bf16 v[100:103], v[120:123], a[20:23], 0
    ds_read_b128 v[120:123], v4 offset:16384
    ds_read_b64_tr_b16 a[122:123], v6 offset:25600
    v_mfma_f32_16x16x32_bf16 v[100:103], v[124:127], a[44:47], v[100:103]
    ds_read_b128 v[124:127], v25 offset:16384
    ds_read_b64_tr_b16 a[124:125], v7 offset:24576
    v_mfma_f32_16x16x32_bf16 v[100:103], v[128:131], a[68:71], v[100:103]
    ds_read_b128 v[128:131], v4 offset:18432
    s_mov_b32 s57, 1127936
    v_mfma_f32_16x16x32_bf16 v[100:103], v[132:135], a[92:95], v[100:103]
    ds_read_b128 v[132:135], v25 offset:18432
    buffer_load_dwordx4 v2, s[8:11], s57 offen offset:1024 lds
    v_mfma_f32_16x16x32_bf16 v[100:103], v[136:139], a[116:119], v[100:103]
    ds_read_b128 v[136:139], v4 offset:20480
    ds_read_b64_tr_b16 a[126:127], v7 offset:25600
    v_mfma_f32_16x16x32_bf16 v[100:103], v[140:143], a[140:143], v[100:103]
    ds_read_b128 v[140:143], v25 offset:20480
    ds_read_b64_tr_b16 a[144:145], v6 offset:32768
    v_mfma_f32_16x16x32_bf16 v[100:103], v[144:147], a[164:167], v[100:103]
    ds_read_b128 v[144:147], v4 offset:22528
    s_add_u32 m0, s52, 49152
    s_add_u32 s58, s72, 28672
    s_add_u32 s57, s58, s68
    v_mfma_f32_16x16x32_bf16 v[100:103], v[148:151], a[188:191], v[100:103]
    ds_read_b128 v[148:151], v25 offset:22528
    buffer_load_dwordx4 v3, s[24:27], s57 offen offset:0 sc1 lds
    v_mfma_f32_16x16x32_bf16 v[100:103], v[152:155], a[212:215], v[100:103]
    ds_read_b128 v[152:155], v4 offset:24576
    v_cvt_pk_bf16_f32 v36, v96, v97
    v_mfma_f32_16x16x32_bf16 v[100:103], v[156:159], a[236:239], v[100:103]
    ds_read_b128 v[156:159], v25 offset:24576
    v_cvt_pk_bf16_f32 v37, v98, v99
    v_mfma_f32_16x16x32_bf16 v[100:103], v[160:163], v[180:183], v[100:103]
    ds_read_b128 v[160:163], v4 offset:26624
    s_add_u32 s57, s58, s69
    v_mfma_f32_16x16x32_bf16 v[100:103], v[164:167], v[204:207], v[100:103]
    ds_read_b128 v[164:167], v25 offset:26624
    buffer_load_dwordx4 v3, s[24:27], s57 offen offset:1024 sc1 lds
    v_mfma_f32_16x16x32_bf16 v[100:103], v[168:171], v[228:231], v[100:103]
    ds_read_b128 v[168:171], v4 offset:28672
    ds_read_b64_tr_b16 a[146:147], v6 offset:33792
    v_mfma_f32_16x16x32_bf16 v[100:103], v[172:175], v[252:255], v[100:103]
    ds_read_b128 v[172:175], v25 offset:28672
    ds_read_b64_tr_b16 a[148:149], v7 offset:32768
    s_waitcnt lgkmcnt(15)
    v_mfma_f32_16x16x32_bf16 v[104:107], v[120:123], a[16:19], 0
    s_add_u32 s57, s58, s70
    ds_read_b64_tr_b16 a[150:151], v7 offset:33792
    v_mfma_f32_16x16x32_bf16 v[104:107], v[124:127], a[40:43], v[104:107]
    buffer_load_dwordx4 v3, s[24:27], s57 offen offset:2048 sc1 lds
    v_mfma_f32_16x16x32_bf16 v[104:107], v[128:131], a[64:67], v[104:107]
    ds_read_b64_tr_b16 a[168:169], v6 offset:40960
    ds_read_b64_tr_b16 a[170:171], v6 offset:41984
    s_waitcnt lgkmcnt(14)
    v_mfma_f32_16x16x32_bf16 v[104:107], v[132:135], a[88:91], v[104:107]
    ds_read_b64_tr_b16 a[172:173], v7 offset:40960
    ds_read_b64_tr_b16 a[174:175], v7 offset:41984
    v_mfma_f32_16x16x32_bf16 v[104:107], v[136:139], a[112:115], v[104:107]
    s_add_u32 s57, s58, s71
    v_mfma_f32_16x16x32_bf16 v[104:107], v[140:143], a[136:139], v[104:107]
    buffer_load_dwordx4 v3, s[24:27], s57 offen offset:3072 sc1 lds
    s_waitcnt lgkmcnt(12)
    v_mfma_f32_16x16x32_bf16 v[104:107], v[144:147], a[160:163], v[104:107]
    v_cvt_pk_bf16_f32 v46, v100, v101
    v_cvt_pk_bf16_f32 v47, v102, v103
    v_mfma_f32_16x16x32_bf16 v[104:107], v[148:151], a[184:187], v[104:107]
    s_waitcnt vmcnt(10)
    s_waitcnt lgkmcnt(0)
    s_barrier
    v_mfma_f32_16x16x32_bf16 v[104:107], v[152:155], a[208:211], v[104:107]
    ds_read_b64_tr_b16 a[192:193], v10 offset:0
    ds_read_b64_tr_b16 a[194:195], v10 offset:1024
    v_mfma_f32_16x16x32_bf16 v[104:107], v[156:159], a[232:235], v[104:107]
    ds_read_b64_tr_b16 a[196:197], v11 offset:0
    ds_read_b64_tr_b16 a[198:199], v11 offset:1024
    v_mfma_f32_16x16x32_bf16 v[104:107], v[160:163], v[176:179], v[104:107]
    ds_read_b64_tr_b16 a[216:217], v10 offset:8192
    ds_read_b64_tr_b16 a[218:219], v10 offset:9216
    v_mfma_f32_16x16x32_bf16 v[104:107], v[164:167], v[200:203], v[104:107]
    ds_read_b64_tr_b16 a[220:221], v11 offset:8192
    ds_read_b64_tr_b16 a[222:223], v11 offset:9216
    v_mfma_f32_16x16x32_bf16 v[104:107], v[168:171], v[224:227], v[104:107]
    ds_read_b64_tr_b16 a[240:241], v10 offset:16384
    ds_read_b64_tr_b16 a[242:243], v10 offset:17408
    v_mfma_f32_16x16x32_bf16 v[104:107], v[172:175], v[248:251], v[104:107]
    ds_read_b64_tr_b16 a[244:245], v11 offset:16384
    ds_read_b64_tr_b16 a[246:247], v11 offset:17408
    v_mfma_f32_16x16x32_bf16 v[108:111], v[120:123], a[20:23], 0
    ds_read_b128 v[120:123], v4 offset:0
    v_mfma_f32_16x16x32_bf16 v[108:111], v[124:127], a[44:47], v[108:111]
    ds_read_b128 v[124:127], v25 offset:0
    v_mfma_f32_16x16x32_bf16 v[108:111], v[128:131], a[68:71], v[108:111]
    ds_read_b128 v[128:131], v4 offset:2048
    v_mfma_f32_16x16x32_bf16 v[108:111], v[132:135], a[92:95], v[108:111]
    ds_read_b128 v[132:135], v25 offset:2048
    v_mfma_f32_16x16x32_bf16 v[108:111], v[136:139], a[116:119], v[108:111]
    ds_read_b128 v[136:139], v4 offset:4096
    v_mfma_f32_16x16x32_bf16 v[108:111], v[140:143], a[140:143], v[108:111]
    ds_read_b128 v[140:143], v25 offset:4096
    v_mfma_f32_16x16x32_bf16 v[108:111], v[144:147], a[164:167], v[108:111]
    ds_read_b128 v[144:147], v4 offset:6144
    v_cvt_pk_bf16_f32 v34, v104, v105
    v_mfma_f32_16x16x32_bf16 v[108:111], v[148:151], a[188:191], v[108:111]
    ds_read_b128 v[148:151], v25 offset:6144
    v_cvt_pk_bf16_f32 v35, v106, v107
    v_mfma_f32_16x16x32_bf16 v[108:111], v[152:155], a[212:215], v[108:111]
    ds_read_b128 v[152:155], v4 offset:8192
    v_mfma_f32_16x16x32_bf16 v[108:111], v[156:159], a[236:239], v[108:111]
    ds_read_b128 v[156:159], v25 offset:8192
    v_mfma_f32_16x16x32_bf16 v[108:111], v[160:163], v[180:183], v[108:111]
    ds_read_b128 v[160:163], v4 offset:10240
    v_mfma_f32_16x16x32_bf16 v[108:111], v[164:167], v[204:207], v[108:111]
    ds_read_b128 v[164:167], v25 offset:10240
    v_mfma_f32_16x16x32_bf16 v[108:111], v[168:171], v[228:231], v[108:111]
    ds_read_b128 v[168:171], v4 offset:12288
    v_mfma_f32_16x16x32_bf16 v[108:111], v[172:175], v[252:255], v[108:111]
    ds_read_b128 v[172:175], v25 offset:12288
    s_waitcnt lgkmcnt(11)
    v_mfma_f32_16x16x32_bf16 v[112:115], v[120:123], a[16:19], 0
    v_mfma_f32_16x16x32_bf16 v[112:115], v[124:127], a[40:43], v[112:115]
    v_mfma_f32_16x16x32_bf16 v[112:115], v[128:131], a[64:67], v[112:115]
    s_waitcnt lgkmcnt(8)
    v_mfma_f32_16x16x32_bf16 v[112:115], v[132:135], a[88:91], v[112:115]
    s_waitcnt vmcnt(4)
    s_barrier
    v_mfma_f32_16x16x32_bf16 v[112:115], v[136:139], a[112:115], v[112:115]
    ds_read_b64_tr_b16 v[184:185], v10 offset:24576
    ds_read_b64_tr_b16 v[186:187], v10 offset:25600
    v_mfma_f32_16x16x32_bf16 v[112:115], v[140:143], a[136:139], v[112:115]
    ds_read_b64_tr_b16 v[188:189], v11 offset:24576
    ds_read_b64_tr_b16 v[190:191], v11 offset:25600
    s_waitcnt lgkmcnt(9)
    v_mfma_f32_16x16x32_bf16 v[112:115], v[144:147], a[160:163], v[112:115]
    v_cvt_pk_bf16_f32 v44, v108, v109
    v_cvt_pk_bf16_f32 v45, v110, v111
    v_mfma_f32_16x16x32_bf16 v[112:115], v[148:151], a[184:187], v[112:115]
    ds_read_b64_tr_b16 v[208:209], v10 offset:32768
    ds_read_b64_tr_b16 v[210:211], v10 offset:33792
    v_mfma_f32_16x16x32_bf16 v[112:115], v[152:155], a[208:211], v[112:115]
    ds_read_b64_tr_b16 v[212:213], v11 offset:32768
    ds_read_b64_tr_b16 v[214:215], v11 offset:33792
    s_waitcnt lgkmcnt(10)
    v_mfma_f32_16x16x32_bf16 v[112:115], v[156:159], a[232:235], v[112:115]
    ds_read_b64_tr_b16 v[232:233], v10 offset:40960
    ds_read_b64_tr_b16 v[234:235], v10 offset:41984
    v_mfma_f32_16x16x32_bf16 v[112:115], v[160:163], v[176:179], v[112:115]
    ds_read_b64_tr_b16 v[236:237], v11 offset:40960
    ds_read_b64_tr_b16 v[238:239], v11 offset:41984
    v_mfma_f32_16x16x32_bf16 v[112:115], v[164:167], v[200:203], v[112:115]
    s_waitcnt lgkmcnt(12)
    v_mfma_f32_16x16x32_bf16 v[112:115], v[168:171], v[224:227], v[112:115]
    v_mfma_f32_16x16x32_bf16 v[112:115], v[172:175], v[248:251], v[112:115]
    v_mfma_f32_16x16x32_bf16 v[116:119], v[120:123], a[20:23], 0
    ds_read_b128 v[120:123], v4 offset:16384
    v_mfma_f32_16x16x32_bf16 v[116:119], v[124:127], a[44:47], v[116:119]
    ds_read_b128 v[124:127], v25 offset:16384
    s_waitcnt lgkmcnt(2)
    s_barrier
    v_mfma_f32_16x16x32_bf16 v[116:119], v[128:131], a[68:71], v[116:119]
    ds_read_b128 v[128:131], v4 offset:18432
    s_add_u32 m0, s52, 65536
    s_add_u32 s58, s72, 43008
    s_add_u32 s57, s58, s68
    v_mfma_f32_16x16x32_bf16 v[116:119], v[132:135], a[92:95], v[116:119]
    ds_read_b128 v[132:135], v25 offset:18432
    buffer_load_dwordx4 v3, s[24:27], s57 offen offset:0 sc1 lds
    v_mfma_f32_16x16x32_bf16 v[116:119], v[136:139], a[116:119], v[116:119]
    ds_read_b128 v[136:139], v4 offset:20480
    v_mfma_f32_16x16x32_bf16 v[116:119], v[140:143], a[140:143], v[116:119]
    ds_read_b128 v[140:143], v25 offset:20480
    v_mfma_f32_16x16x32_bf16 v[116:119], v[144:147], a[164:167], v[116:119]
    ds_read_b128 v[144:147], v4 offset:22528
    v_cvt_pk_bf16_f32 v32, v112, v113
    v_mfma_f32_16x16x32_bf16 v[116:119], v[148:151], a[188:191], v[116:119]
    ds_read_b128 v[148:151], v25 offset:22528
    v_cvt_pk_bf16_f32 v33, v114, v115
    v_mfma_f32_16x16x32_bf16 v[116:119], v[152:155], a[212:215], v[116:119]
    ds_read_b128 v[152:155], v4 offset:24576
    s_add_u32 s57, s58, s69
    v_mfma_f32_16x16x32_bf16 v[116:119], v[156:159], a[236:239], v[116:119]
    ds_read_b128 v[156:159], v25 offset:24576
    buffer_load_dwordx4 v3, s[24:27], s57 offen offset:1024 sc1 lds
    v_mfma_f32_16x16x32_bf16 v[116:119], v[160:163], v[180:183], v[116:119]
    ds_read_b128 v[160:163], v4 offset:26624
    v_mfma_f32_16x16x32_bf16 v[116:119], v[164:167], v[204:207], v[116:119]
    ds_read_b128 v[164:167], v25 offset:26624
    v_mfma_f32_16x16x32_bf16 v[116:119], v[168:171], v[228:231], v[116:119]
    ds_read_b128 v[168:171], v4 offset:28672
    v_mfma_f32_16x16x32_bf16 v[116:119], v[172:175], v[252:255], v[116:119]
    ds_read_b128 v[172:175], v25 offset:28672
    s_waitcnt lgkmcnt(11)
    v_mfma_f32_16x16x32_bf16 v[96:99], a[0:3], v[120:123], 0
    s_add_u32 s57, s58, s70
    v_mfma_f32_16x16x32_bf16 v[96:99], a[24:27], v[124:127], v[96:99]
    buffer_load_dwordx4 v3, s[24:27], s57 offen offset:2048 sc1 lds
    v_mfma_f32_16x16x32_bf16 v[96:99], a[48:51], v[128:131], v[96:99]
    s_waitcnt lgkmcnt(8)
    v_mfma_f32_16x16x32_bf16 v[96:99], a[72:75], v[132:135], v[96:99]
    v_mfma_f32_16x16x32_bf16 v[96:99], a[96:99], v[136:139], v[96:99]
    v_mfma_f32_16x16x32_bf16 v[96:99], a[120:123], v[140:143], v[96:99]
    s_waitcnt lgkmcnt(5)
    v_mfma_f32_16x16x32_bf16 v[96:99], a[144:147], v[144:147], v[96:99]
    s_add_u32 s57, s58, s71
    v_cvt_pk_bf16_f32 v42, v116, v117
    v_mfma_f32_16x16x32_bf16 v[96:99], a[168:171], v[148:151], v[96:99]
    buffer_load_dwordx4 v3, s[24:27], s57 offen offset:3072 sc1 lds
    v_mfma_f32_16x16x32_bf16 v[96:99], a[192:195], v[152:155], v[96:99]
    v_cvt_pk_bf16_f32 v43, v118, v119
    s_waitcnt lgkmcnt(2)
    v_mfma_f32_16x16x32_bf16 v[96:99], a[216:219], v[156:159], v[96:99]
    v_mfma_f32_16x16x32_bf16 v[96:99], a[240:243], v[160:163], v[96:99]
    v_mfma_f32_16x16x32_bf16 v[96:99], v[184:187], v[164:167], v[96:99]
    s_waitcnt lgkmcnt(0)
    v_mfma_f32_16x16x32_bf16 v[96:99], v[208:211], v[168:171], v[96:99]
    s_add_u32 m0, s52, 81920
    s_add_u32 s58, s72, 57344
    s_add_u32 s57, s58, s68
    v_mfma_f32_16x16x32_bf16 v[96:99], v[232:235], v[172:175], v[96:99]
    buffer_load_dwordx4 v3, s[24:27], s57 offen offset:0 sc1 lds
    v_mfma_f32_16x16x32_bf16 v[100:103], a[4:7], v[120:123], 0
    ds_read_b128 v[120:123], v4 offset:32768
    v_mfma_f32_16x16x32_bf16 v[100:103], a[28:31], v[124:127], v[100:103]
    ds_read_b128 v[124:127], v25 offset:32768
    v_mfma_f32_16x16x32_bf16 v[100:103], a[52:55], v[128:131], v[100:103]
    ds_read_b128 v[128:131], v4 offset:34816
    v_mfma_f32_16x16x32_bf16 v[100:103], a[76:79], v[132:135], v[100:103]
    ds_read_b128 v[132:135], v25 offset:34816
    v_mfma_f32_16x16x32_bf16 v[100:103], a[100:103], v[136:139], v[100:103]
    ds_read_b128 v[136:139], v4 offset:36864
    s_add_u32 s57, s58, s69
    v_mfma_f32_16x16x32_bf16 v[100:103], a[124:127], v[140:143], v[100:103]
    ds_read_b128 v[140:143], v25 offset:36864
    buffer_load_dwordx4 v3, s[24:27], s57 offen offset:1024 sc1 lds
    v_mfma_f32_16x16x32_bf16 v[100:103], a[148:151], v[144:147], v[100:103]
    ds_read_b128 v[144:147], v4 offset:38912
    v_cvt_pk_bf16_f32 v68, v96, v97
    v_mfma_f32_16x16x32_bf16 v[100:103], a[172:175], v[148:151], v[100:103]
    ds_read_b128 v[148:151], v25 offset:38912
    v_cvt_pk_bf16_f32 v69, v98, v99
    v_mfma_f32_16x16x32_bf16 v[100:103], a[196:199], v[152:155], v[100:103]
    ds_read_b128 v[152:155], v4 offset:40960
    v_mfma_f32_16x16x32_bf16 v[100:103], a[220:223], v[156:159], v[100:103]
    ds_read_b128 v[156:159], v25 offset:40960
    v_mfma_f32_16x16x32_bf16 v[100:103], a[244:247], v[160:163], v[100:103]
    ds_read_b128 v[160:163], v4 offset:43008
    s_add_u32 s57, s58, s70
    v_mfma_f32_16x16x32_bf16 v[100:103], v[188:191], v[164:167], v[100:103]
    ds_read_b128 v[164:167], v25 offset:43008
    buffer_load_dwordx4 v3, s[24:27], s57 offen offset:2048 sc1 lds
    v_mfma_f32_16x16x32_bf16 v[100:103], v[212:215], v[168:171], v[100:103]
    ds_read_b128 v[168:171], v4 offset:45056
    v_mfma_f32_16x16x32_bf16 v[100:103], v[236:239], v[172:175], v[100:103]
    ds_read_b128 v[172:175], v25 offset:45056
    s_waitcnt lgkmcnt(11)
    v_mfma_f32_16x16x32_bf16 v[104:107], a[0:3], v[120:123], 0
    v_mfma_f32_16x16x32_bf16 v[104:107], a[24:27], v[124:127], v[104:107]
    v_mfma_f32_16x16x32_bf16 v[104:107], a[48:51], v[128:131], v[104:107]
    s_add_u32 s57, s58, s71
    s_waitcnt lgkmcnt(8)
    v_mfma_f32_16x16x32_bf16 v[104:107], a[72:75], v[132:135], v[104:107]
    buffer_load_dwordx4 v3, s[24:27], s57 offen offset:3072 sc1 lds
    v_mfma_f32_16x16x32_bf16 v[104:107], a[96:99], v[136:139], v[104:107]
    v_mfma_f32_16x16x32_bf16 v[104:107], a[120:123], v[140:143], v[104:107]
    s_waitcnt lgkmcnt(5)
    v_mfma_f32_16x16x32_bf16 v[104:107], a[144:147], v[144:147], v[104:107]
    v_cvt_pk_bf16_f32 v70, v100, v101
    v_cvt_pk_bf16_f32 v71, v102, v103
    v_mfma_f32_16x16x32_bf16 v[104:107], a[168:171], v[148:151], v[104:107]
    v_cndmask_b32 v70, v70, 0, s[82:83]
    v_cndmask_b32 v71, v71, 0, s[82:83]
    v_mfma_f32_16x16x32_bf16 v[104:107], a[192:195], v[152:155], v[104:107]
    s_add_u32 m0, s52, 98304
    s_add_u32 s58, s72, 71680
    s_add_u32 s57, s58, s68
    s_waitcnt lgkmcnt(2)
    v_mfma_f32_16x16x32_bf16 v[104:107], a[216:219], v[156:159], v[104:107]
    buffer_load_dwordx4 v3, s[24:27], s57 offen offset:0 sc1 lds
    v_mfma_f32_16x16x32_bf16 v[104:107], a[240:243], v[160:163], v[104:107]
    v_mfma_f32_16x16x32_bf16 v[72:75], v[52:55], v[68:71], 0
    v_mfma_f32_16x16x32_bf16 v[104:107], v[184:187], v[164:167], v[104:107]
    v_mfma_f32_16x16x32_bf16 v[76:79], v[56:59], v[68:71], 0
    s_waitcnt lgkmcnt(0)
    v_mfma_f32_16x16x32_bf16 v[104:107], v[208:211], v[168:171], v[104:107]
    v_mfma_f32_16x16x32_bf16 v[104:107], v[232:235], v[172:175], v[104:107]
    s_waitcnt vmcnt(9)
    s_barrier
    v_mfma_f32_16x16x32_bf16 v[108:111], a[4:7], v[120:123], 0
    ds_read_b128 v[120:123], v4 offset:49152
    s_add_u32 s57, s58, s69
    v_mfma_f32_16x16x32_bf16 v[108:111], a[28:31], v[124:127], v[108:111]
    ds_read_b128 v[124:127], v25 offset:49152
    buffer_load_dwordx4 v3, s[24:27], s57 offen offset:1024 sc1 lds
    v_mfma_f32_16x16x32_bf16 v[108:111], a[52:55], v[128:131], v[108:111]
    ds_read_b128 v[128:131], v4 offset:51200
    v_cndmask_b32 v26, v72, v73, s[76:77]
    v_mfma_f32_16x16x32_bf16 v[108:111], a[76:79], v[132:135], v[108:111]
    ds_read_b128 v[132:135], v25 offset:51200
    v_cndmask_b32 v27, v74, v75, s[76:77]
    v_mfma_f32_16x16x32_bf16 v[108:111], a[100:103], v[136:139], v[108:111]
    ds_read_b128 v[136:139], v4 offset:53248
    v_cndmask_b32 v28, v76, v77, s[76:77]
    v_mfma_f32_16x16x32_bf16 v[108:111], a[124:127], v[140:143], v[108:111]
    ds_read_b128 v[140:143], v25 offset:53248
    v_cndmask_b32 v29, v78, v79, s[76:77]
    v_mfma_f32_16x16x32_bf16 v[108:111], a[148:151], v[144:147], v[108:111]
    ds_read_b128 v[144:147], v4 offset:55296
    s_add_u32 s57, s58, s70
    v_mfma_f32_16x16x32_bf16 v[108:111], a[172:175], v[148:151], v[108:111]
    ds_read_b128 v[148:151], v25 offset:55296
    buffer_load_dwordx4 v3, s[24:27], s57 offen offset:2048 sc1 lds
    v_mfma_f32_16x16x32_bf16 v[108:111], a[196:199], v[152:155], v[108:111]
    ds_read_b128 v[152:155], v4 offset:57344
    v_cvt_pk_bf16_f32 v64, v104, v105
    v_mfma_f32_16x16x32_bf16 v[108:111], a[220:223], v[156:159], v[108:111]
    ds_read_b128 v[156:159], v25 offset:57344
    v_cvt_pk_bf16_f32 v65, v106, v107
    v_mfma_f32_16x16x32_bf16 v[108:111], a[244:247], v[160:163], v[108:111]
    ds_read_b128 v[160:163], v4 offset:59392
    v_cndmask_b32 v26, v26, v28, s[78:79]
    v_mfma_f32_16x16x32_bf16 v[108:111], v[188:191], v[164:167], v[108:111]
    ds_read_b128 v[164:167], v25 offset:59392
    v_cndmask_b32 v27, v27, v29, s[80:81]
    v_mfma_f32_16x16x32_bf16 v[108:111], v[212:215], v[168:171], v[108:111]
    ds_read_b128 v[168:171], v4 offset:61440
    s_add_u32 s57, s58, s71
    v_mfma_f32_16x16x32_bf16 v[108:111], v[236:239], v[172:175], v[108:111]
    ds_read_b128 v[172:175], v25 offset:61440
    buffer_load_dwordx4 v3, s[24:27], s57 offen offset:3072 sc1 lds
    s_waitcnt lgkmcnt(11)
    v_mfma_f32_16x16x32_bf16 v[112:115], a[8:11], v[120:123], 0
    v_cndmask_b32 v26, v26, v18, s[84:85]
    v_cndmask_b32 v27, v27, v18, s[86:87]
    v_mfma_f32_16x16x32_bf16 v[112:115], a[32:35], v[124:127], v[112:115]
    v_max_f32 v28, v26, v27
    v_mov_b32 v29, v28
    v_mfma_f32_16x16x32_bf16 v[112:115], a[56:59], v[128:131], v[112:115]
    s_waitcnt lgkmcnt(8)
    v_mfma_f32_16x16x32_bf16 v[112:115], a[80:83], v[132:135], v[112:115]
    v_permlane16_swap_b32 v28, v29
    v_max_f32 v28, v28, v29
    v_mfma_f32_16x16x32_bf16 v[112:115], a[104:107], v[136:139], v[112:115]
    s_add_u32 m0, s52, 114688
    s_add_u32 s58, s72, 86016
    s_add_u32 s57, s58, s68
    v_mov_b32 v29, v28
    v_mfma_f32_16x16x32_bf16 v[112:115], a[128:131], v[140:143], v[112:115]
    buffer_load_dwordx4 v3, s[24:27], s57 offen offset:0 sc1 lds
    s_waitcnt lgkmcnt(5)
    v_mfma_f32_16x16x32_bf16 v[112:115], a[152:155], v[144:147], v[112:115]
    v_cvt_pk_bf16_f32 v66, v108, v109
    v_cvt_pk_bf16_f32 v67, v110, v111
    v_mfma_f32_16x16x32_bf16 v[112:115], a[176:179], v[148:151], v[112:115]
    v_cndmask_b32 v66, v66, 0, s[82:83]
    v_cndmask_b32 v67, v67, 0, s[82:83]
    v_mfma_f32_16x16x32_bf16 v[112:115], a[200:203], v[152:155], v[112:115]
    v_permlane32_swap_b32 v28, v29
    v_max_f32 v28, v28, v29
    s_waitcnt lgkmcnt(2)
    v_mfma_f32_16x16x32_bf16 v[112:115], a[224:227], v[156:159], v[112:115]
    v_sub_f32 v26, v26, v28
    v_sub_f32 v27, v27, v28
    v_mfma_f32_16x16x32_bf16 v[112:115], a[248:251], v[160:163], v[112:115]
    s_add_u32 s57, s58, s69
    v_mul_f32 v26, s91, v26
    v_mfma_f32_16x16x32_bf16 v[112:115], v[192:195], v[164:167], v[112:115]
    buffer_load_dwordx4 v3, s[24:27], s57 offen offset:1024 sc1 lds
    s_waitcnt lgkmcnt(0)
    v_mfma_f32_16x16x32_bf16 v[112:115], v[216:219], v[168:171], v[112:115]
    v_mul_f32 v27, s91, v27
    v_exp_f32 v26, v26
    v_mfma_f32_16x16x32_bf16 v[112:115], v[240:243], v[172:175], v[112:115]
    v_exp_f32 v27, v27
    v_mfma_f32_16x16x32_bf16 v[116:119], a[12:15], v[120:123], 0
    v_add_f32 v28, v26, v27
    v_mov_b32 v29, v28
    v_mfma_f32_16x16x32_bf16 v[116:119], a[36:39], v[124:127], v[116:119]
    v_mfma_f32_16x16x32_bf16 v[116:119], a[60:63], v[128:131], v[116:119]
    s_add_u32 s57, s58, s70
    v_permlane16_swap_b32 v28, v29
    v_mfma_f32_16x16x32_bf16 v[116:119], a[84:87], v[132:135], v[116:119]
    buffer_load_dwordx4 v3, s[24:27], s57 offen offset:2048 sc1 lds
    v_mfma_f32_16x16x32_bf16 v[116:119], a[108:111], v[136:139], v[116:119]
    v_add_f32 v28, v28, v29
    v_mov_b32 v29, v28
    v_mfma_f32_16x16x32_bf16 v[116:119], a[132:135], v[140:143], v[116:119]
    v_mfma_f32_16x16x32_bf16 v[116:119], a[156:159], v[144:147], v[116:119]
    v_cvt_pk_bf16_f32 v52, v112, v113
    v_cvt_pk_bf16_f32 v53, v114, v115
    v_mfma_f32_16x16x32_bf16 v[116:119], a[180:183], v[148:151], v[116:119]
    v_permlane32_swap_b32 v28, v29
    v_add_f32 v28, v28, v29
    v_mfma_f32_16x16x32_bf16 v[116:119], a[204:207], v[152:155], v[116:119]
    s_add_u32 s57, s58, s71
    v_rcp_f32 v28, v28
    v_mfma_f32_16x16x32_bf16 v[116:119], a[228:231], v[156:159], v[116:119]
    buffer_load_dwordx4 v3, s[24:27], s57 offen offset:3072 sc1 lds
    v_mfma_f32_16x16x32_bf16 v[116:119], a[252:255], v[160:163], v[116:119]
    v_mul_f32 v26, v26, v28
    v_mul_f32 v27, v27, v28
    v_mfma_f32_16x16x32_bf16 v[116:119], v[196:199], v[164:167], v[116:119]
    v_cvt_pk_bf16_f32 v26, v26, v26
    v_cvt_pk_bf16_f32 v27, v27, v27
    v_mfma_f32_16x16x32_bf16 v[116:119], v[220:223], v[168:171], v[116:119]
    v_and_b32 v80, v26, v14
    v_and_b32 v81, v27, v15
    v_mfma_f32_16x16x32_bf16 v[116:119], v[244:247], v[172:175], v[116:119]
    v_and_b32 v82, v26, v16
    v_and_b32 v83, v27, v17
    v_mfma_f32_16x16x32_bf16 v[96:99], v[120:123], a[16:19], 0
    s_add_u32 m0, s52, 131072
    s_add_u32 s58, s72, 100352
    s_add_u32 s57, s58, s68
    v_mfma_f32_16x16x32_bf16 v[96:99], v[124:127], a[40:43], v[96:99]
    buffer_load_dwordx4 v3, s[24:27], s57 offen offset:0 sc1 lds
    v_mfma_f32_16x16x32_bf16 v[96:99], v[128:131], a[64:67], v[96:99]
    v_mfma_f32_16x16x32_bf16 v[72:75], v[32:35], v[80:83], 0
    v_mfma_f32_16x16x32_bf16 v[96:99], v[132:135], a[88:91], v[96:99]
    v_mfma_f32_16x16x32_bf16 v[76:79], v[42:45], v[80:83], 0
    v_mfma_f32_16x16x32_bf16 v[96:99], v[136:139], a[112:115], v[96:99]
    s_add_u32 s53, s74, 0
    v_mfma_f32_16x16x32_bf16 v[96:99], v[140:143], a[136:139], v[96:99]
    v_mfma_f32_16x16x32_bf16 v[96:99], v[144:147], a[160:163], v[96:99]
    s_add_u32 s57, s58, s69
    v_cvt_pk_bf16_f32 v54, v116, v117
    v_mfma_f32_16x16x32_bf16 v[96:99], v[148:151], a[184:187], v[96:99]
    buffer_load_dwordx4 v3, s[24:27], s57 offen offset:1024 sc1 lds
    v_mfma_f32_16x16x32_bf16 v[96:99], v[152:155], a[208:211], v[96:99]
    v_cvt_pk_bf16_f32 v55, v118, v119
    v_cndmask_b32 v54, v54, 0, s[82:83]
    v_mfma_f32_16x16x32_bf16 v[96:99], v[156:159], a[232:235], v[96:99]
    v_cndmask_b32 v55, v55, 0, s[82:83]
    v_cvt_pk_bf16_f32 v84, v72, v73
    v_mfma_f32_16x16x32_bf16 v[96:99], v[160:163], v[176:179], v[96:99]
    v_cvt_pk_bf16_f32 v85, v74, v75
    v_cvt_pk_bf16_f32 v86, v76, v77
    v_mfma_f32_16x16x32_bf16 v[96:99], v[164:167], v[200:203], v[96:99]
    v_cvt_pk_bf16_f32 v87, v78, v79
    v_cndmask_b32 v86, v86, 0, s[82:83]
    v_mfma_f32_16x16x32_bf16 v[96:99], v[168:171], v[224:227], v[96:99]
    s_add_u32 s57, s58, s70
    v_cndmask_b32 v87, v87, 0, s[82:83]
    v_mfma_f32_16x16x32_bf16 v[96:99], v[172:175], v[248:251], v[96:99]
    buffer_load_dwordx4 v3, s[24:27], s57 offen offset:2048 sc1 lds
    v_mfma_f32_16x16x32_bf16 v[100:103], v[120:123], a[20:23], 0
    buffer_store_dwordx4 v[84:87], v23, s[24:27], s53 offen sc1
    v_mfma_f32_16x16x32_bf16 v[100:103], v[124:127], a[44:47], v[100:103]
    v_mfma_f32_16x16x32_bf16 v[100:103], v[128:131], a[68:71], v[100:103]
    v_mfma_f32_16x16x32_bf16 v[72:75], v[56:59], v[64:67], 0
    v_mfma_f32_16x16x32_bf16 v[100:103], v[132:135], a[92:95], v[100:103]
    v_mfma_f32_16x16x32_bf16 v[76:79], v[60:63], v[64:67], 0
    v_mfma_f32_16x16x32_bf16 v[100:103], v[136:139], a[116:119], v[100:103]
    s_add_u32 s57, s58, s71
    v_mfma_f32_16x16x32_bf16 v[100:103], v[140:143], a[140:143], v[100:103]
    buffer_load_dwordx4 v3, s[24:27], s57 offen offset:3072 sc1 lds
    v_mfma_f32_16x16x32_bf16 v[100:103], v[144:147], a[164:167], v[100:103]
    v_cvt_pk_bf16_f32 v38, v96, v97
    v_cvt_pk_bf16_f32 v39, v98, v99
    v_mfma_f32_16x16x32_bf16 v[100:103], v[148:151], a[188:191], v[100:103]
    v_mfma_f32_16x16x32_bf16 v[100:103], v[152:155], a[212:215], v[100:103]
    v_cndmask_b32 v26, v72, v73, s[76:77]
    v_cndmask_b32 v27, v74, v75, s[76:77]
    v_mfma_f32_16x16x32_bf16 v[100:103], v[156:159], a[236:239], v[100:103]
    v_cndmask_b32 v28, v76, v77, s[76:77]
    v_cndmask_b32 v29, v78, v79, s[76:77]
    v_mfma_f32_16x16x32_bf16 v[100:103], v[160:163], v[180:183], v[100:103]
    s_add_u32 s57, s73, 0
    v_cndmask_b32 v26, v26, v28, s[78:79]
    v_mfma_f32_16x16x32_bf16 v[100:103], v[164:167], v[204:207], v[100:103]
    buffer_load_dword v22, v5, s[20:23], s57 offen
    v_mfma_f32_16x16x32_bf16 v[100:103], v[168:171], v[228:231], v[100:103]
    v_cndmask_b32 v27, v27, v29, s[80:81]
    v_max_f32 v28, v26, v27
    v_mfma_f32_16x16x32_bf16 v[100:103], v[172:175], v[252:255], v[100:103]
    v_mov_b32 v29, v28
    v_mfma_f32_16x16x32_bf16 v[104:107], a[0:3], v[120:123], 0
    v_mfma_f32_16x16x32_bf16 v[104:107], a[24:27], v[124:127], v[104:107]
    v_permlane16_swap_b32 v28, v29
    v_max_f32 v28, v28, v29
    v_mfma_f32_16x16x32_bf16 v[104:107], a[48:51], v[128:131], v[104:107]
    v_mov_b32 v29, v28
    v_mfma_f32_16x16x32_bf16 v[104:107], a[72:75], v[132:135], v[104:107]
    v_mfma_f32_16x16x32_bf16 v[104:107], a[96:99], v[136:139], v[104:107]
    v_permlane32_swap_b32 v28, v29
    v_max_f32 v28, v28, v29
    v_mfma_f32_16x16x32_bf16 v[104:107], a[120:123], v[140:143], v[104:107]
    v_sub_f32 v26, v26, v28
    v_sub_f32 v27, v27, v28
    v_mfma_f32_16x16x32_bf16 v[104:107], a[144:147], v[144:147], v[104:107]
    v_cvt_pk_bf16_f32 v48, v100, v101
    v_cvt_pk_bf16_f32 v49, v102, v103
    v_mfma_f32_16x16x32_bf16 v[104:107], a[168:171], v[148:151], v[104:107]
    v_mul_f32 v26, s91, v26
    v_mul_f32 v27, s91, v27
    v_mfma_f32_16x16x32_bf16 v[104:107], a[192:195], v[152:155], v[104:107]
    v_exp_f32 v26, v26
    v_mfma_f32_16x16x32_bf16 v[104:107], a[216:219], v[156:159], v[104:107]
    v_exp_f32 v27, v27
    v_mfma_f32_16x16x32_bf16 v[104:107], a[240:243], v[160:163], v[104:107]
    v_add_f32 v28, v26, v27
    v_mov_b32 v29, v28
    v_mfma_f32_16x16x32_bf16 v[104:107], v[184:187], v[164:167], v[104:107]
    v_mfma_f32_16x16x32_bf16 v[104:107], v[208:211], v[168:171], v[104:107]
    v_permlane16_swap_b32 v28, v29
    v_add_f32 v28, v28, v29
    v_mfma_f32_16x16x32_bf16 v[104:107], v[232:235], v[172:175], v[104:107]
    v_mov_b32 v29, v28
    s_waitcnt vmcnt(6)
    s_barrier
    v_mfma_f32_16x16x32_bf16 v[108:111], a[4:7], v[120:123], 0
    v_add_u32 v4, 65536, v4
    v_add_u32 v25, 65536, v25
    ds_read_b128 v[120:123], v4 offset:0
    v_mfma_f32_16x16x32_bf16 v[108:111], a[28:31], v[124:127], v[108:111]
    ds_read_b128 v[124:127], v25 offset:0
    v_permlane32_swap_b32 v28, v29
    v_mfma_f32_16x16x32_bf16 v[108:111], a[52:55], v[128:131], v[108:111]
    ds_read_b128 v[128:131], v4 offset:2048
    v_add_f32 v28, v28, v29
    v_mfma_f32_16x16x32_bf16 v[108:111], a[76:79], v[132:135], v[108:111]
    ds_read_b128 v[132:135], v25 offset:2048
    v_rcp_f32 v28, v28
    v_mfma_f32_16x16x32_bf16 v[108:111], a[100:103], v[136:139], v[108:111]
    ds_read_b128 v[136:139], v4 offset:4096
    v_mul_f32 v26, v26, v28
    v_mfma_f32_16x16x32_bf16 v[108:111], a[124:127], v[140:143], v[108:111]
    ds_read_b128 v[140:143], v25 offset:4096
    v_mul_f32 v27, v27, v28
    v_mfma_f32_16x16x32_bf16 v[108:111], a[148:151], v[144:147], v[108:111]
    ds_read_b128 v[144:147], v4 offset:6144
    v_cvt_pk_bf16_f32 v68, v104, v105
    v_mfma_f32_16x16x32_bf16 v[108:111], a[172:175], v[148:151], v[108:111]
    ds_read_b128 v[148:151], v25 offset:6144
    v_cvt_pk_bf16_f32 v69, v106, v107
    v_mfma_f32_16x16x32_bf16 v[108:111], a[196:199], v[152:155], v[108:111]
    ds_read_b128 v[152:155], v4 offset:8192
    v_cvt_pk_bf16_f32 v26, v26, v26
    v_mfma_f32_16x16x32_bf16 v[108:111], a[220:223], v[156:159], v[108:111]
    ds_read_b128 v[156:159], v25 offset:8192
    v_cvt_pk_bf16_f32 v27, v27, v27
    v_mfma_f32_16x16x32_bf16 v[108:111], a[244:247], v[160:163], v[108:111]
    ds_read_b128 v[160:163], v4 offset:10240
    v_and_b32 v80, v26, v14
    v_mfma_f32_16x16x32_bf16 v[108:111], v[188:191], v[164:167], v[108:111]
    ds_read_b128 v[164:167], v25 offset:10240
    v_and_b32 v81, v27, v15
    v_mfma_f32_16x16x32_bf16 v[108:111], v[212:215], v[168:171], v[108:111]
    ds_read_b128 v[168:171], v4 offset:12288
    v_and_b32 v82, v26, v16
    v_mfma_f32_16x16x32_bf16 v[108:111], v[236:239], v[172:175], v[108:111]
    ds_read_b128 v[172:175], v25 offset:12288
    v_and_b32 v83, v27, v17
    s_waitcnt lgkmcnt(11)
    v_mfma_f32_16x16x32_bf16 v[112:115], a[8:11], v[120:123], 0
    v_mfma_f32_16x16x32_bf16 v[112:115], a[32:35], v[124:127], v[112:115]
    v_mfma_f32_16x16x32_bf16 v[72:75], v[34:37], v[80:83], 0
    v_mfma_f32_16x16x32_bf16 v[112:115], a[56:59], v[128:131], v[112:115]
    v_mfma_f32_16x16x32_bf16 v[76:79], v[44:47], v[80:83], 0
    s_waitcnt lgkmcnt(8)
    v_mfma_f32_16x16x32_bf16 v[112:115], a[80:83], v[132:135], v[112:115]
    s_add_u32 s53, s74, 16384
    v_mfma_f32_16x16x32_bf16 v[112:115], a[104:107], v[136:139], v[112:115]
    v_mfma_f32_16x16x32_bf16 v[112:115], a[128:131], v[140:143], v[112:115]
    s_waitcnt lgkmcnt(5)
    v_mfma_f32_16x16x32_bf16 v[112:115], a[152:155], v[144:147], v[112:115]
    v_cvt_pk_bf16_f32 v70, v108, v109
    v_cvt_pk_bf16_f32 v71, v110, v111
    v_mfma_f32_16x16x32_bf16 v[112:115], a[176:179], v[148:151], v[112:115]
    v_cndmask_b32 v70, v70, 0, s[82:83]
    v_cndmask_b32 v71, v71, 0, s[82:83]
    v_mfma_f32_16x16x32_bf16 v[112:115], a[200:203], v[152:155], v[112:115]
    v_cvt_pk_bf16_f32 v84, v72, v73
    v_cvt_pk_bf16_f32 v85, v74, v75
    s_waitcnt lgkmcnt(2)
    v_mfma_f32_16x16x32_bf16 v[112:115], a[224:227], v[156:159], v[112:115]
    v_cvt_pk_bf16_f32 v86, v76, v77
    v_cvt_pk_bf16_f32 v87, v78, v79
    v_mfma_f32_16x16x32_bf16 v[112:115], a[248:251], v[160:163], v[112:115]
    v_cndmask_b32 v86, v86, 0, s[82:83]
    v_cndmask_b32 v87, v87, 0, s[82:83]
    v_mfma_f32_16x16x32_bf16 v[112:115], v[192:195], v[164:167], v[112:115]
    buffer_store_dwordx4 v[84:87], v23, s[24:27], s53 offen sc1
    s_waitcnt lgkmcnt(0)
    v_mfma_f32_16x16x32_bf16 v[112:115], v[216:219], v[168:171], v[112:115]
    v_mfma_f32_16x16x32_bf16 v[112:115], v[240:243], v[172:175], v[112:115]
    v_mfma_f32_16x16x32_bf16 v[72:75], v[60:63], v[68:71], 0
    v_mfma_f32_16x16x32_bf16 v[116:119], a[12:15], v[120:123], 0
    v_mfma_f32_16x16x32_bf16 v[76:79], v[52:55], v[68:71], 0
    v_mfma_f32_16x16x32_bf16 v[116:119], a[36:39], v[124:127], v[116:119]
    v_mfma_f32_16x16x32_bf16 v[116:119], a[60:63], v[128:131], v[116:119]
    v_mfma_f32_16x16x32_bf16 v[116:119], a[84:87], v[132:135], v[116:119]
    v_mfma_f32_16x16x32_bf16 v[116:119], a[108:111], v[136:139], v[116:119]
    v_mfma_f32_16x16x32_bf16 v[116:119], a[132:135], v[140:143], v[116:119]
    s_nop 0
    v_cndmask_b32 v26, v72, v73, s[76:77]
    v_cndmask_b32 v27, v74, v75, s[76:77]
    v_mfma_f32_16x16x32_bf16 v[116:119], a[156:159], v[144:147], v[116:119]
    v_cvt_pk_bf16_f32 v56, v112, v113
    v_cvt_pk_bf16_f32 v57, v114, v115
    v_mfma_f32_16x16x32_bf16 v[116:119], a[180:183], v[148:151], v[116:119]
    v_cndmask_b32 v28, v76, v77, s[76:77]
    v_cndmask_b32 v29, v78, v79, s[76:77]
    v_mfma_f32_16x16x32_bf16 v[116:119], a[204:207], v[152:155], v[116:119]
    v_cndmask_b32 v26, v26, v28, s[78:79]
    v_cndmask_b32 v27, v27, v29, s[80:81]
    v_mfma_f32_16x16x32_bf16 v[116:119], a[228:231], v[156:159], v[116:119]
    v_max_f32 v28, v26, v27
    v_mov_b32 v29, v28
    v_mfma_f32_16x16x32_bf16 v[116:119], a[252:255], v[160:163], v[116:119]
    v_mfma_f32_16x16x32_bf16 v[116:119], v[196:199], v[164:167], v[116:119]
    v_permlane16_swap_b32 v28, v29
    v_max_f32 v28, v28, v29
    v_mfma_f32_16x16x32_bf16 v[116:119], v[220:223], v[168:171], v[116:119]
    v_mov_b32 v29, v28
    v_mfma_f32_16x16x32_bf16 v[116:119], v[244:247], v[172:175], v[116:119]
    v_mfma_f32_16x16x32_bf16 v[96:99], v[120:123], a[16:19], 0
    v_permlane32_swap_b32 v28, v29
    v_max_f32 v28, v28, v29
    v_mfma_f32_16x16x32_bf16 v[96:99], v[124:127], a[40:43], v[96:99]
    v_sub_f32 v26, v26, v28
    v_sub_f32 v27, v27, v28
    v_mfma_f32_16x16x32_bf16 v[96:99], v[128:131], a[64:67], v[96:99]
    v_mul_f32 v26, s91, v26
    v_mul_f32 v27, s91, v27
    v_mfma_f32_16x16x32_bf16 v[96:99], v[132:135], a[88:91], v[96:99]
    v_exp_f32 v26, v26
    v_mfma_f32_16x16x32_bf16 v[96:99], v[136:139], a[112:115], v[96:99]
    v_exp_f32 v27, v27
    v_mfma_f32_16x16x32_bf16 v[96:99], v[140:143], a[136:139], v[96:99]
    v_add_f32 v28, v26, v27
    v_mov_b32 v29, v28
    v_mfma_f32_16x16x32_bf16 v[96:99], v[144:147], a[160:163], v[96:99]
    v_cvt_pk_bf16_f32 v58, v116, v117
    v_cvt_pk_bf16_f32 v59, v118, v119
    v_mfma_f32_16x16x32_bf16 v[96:99], v[148:151], a[184:187], v[96:99]
    v_cndmask_b32 v58, v58, 0, s[82:83]
    v_cndmask_b32 v59, v59, 0, s[82:83]
    v_mfma_f32_16x16x32_bf16 v[96:99], v[152:155], a[208:211], v[96:99]
    v_permlane16_swap_b32 v28, v29
    v_add_f32 v28, v28, v29
    v_mfma_f32_16x16x32_bf16 v[96:99], v[156:159], a[232:235], v[96:99]
    v_mov_b32 v29, v28
    v_mfma_f32_16x16x32_bf16 v[96:99], v[160:163], v[176:179], v[96:99]
    v_mfma_f32_16x16x32_bf16 v[96:99], v[164:167], v[200:203], v[96:99]
    v_permlane32_swap_b32 v28, v29
    v_add_f32 v28, v28, v29
    v_mfma_f32_16x16x32_bf16 v[96:99], v[168:171], v[224:227], v[96:99]
    v_rcp_f32 v28, v28
    v_mfma_f32_16x16x32_bf16 v[96:99], v[172:175], v[248:251], v[96:99]
    v_mul_f32 v26, v26, v28
    v_mul_f32 v27, v27, v28
    v_mfma_f32_16x16x32_bf16 v[100:103], v[120:123], a[20:23], 0
    v_cvt_pk_bf16_f32 v26, v26, v26
    v_cvt_pk_bf16_f32 v27, v27, v27
    v_mfma_f32_16x16x32_bf16 v[100:103], v[124:127], a[44:47], v[100:103]
    v_and_b32 v80, v26, v14
    v_and_b32 v81, v27, v15
    v_mfma_f32_16x16x32_bf16 v[100:103], v[128:131], a[68:71], v[100:103]
    v_and_b32 v82, v26, v16
    v_and_b32 v83, v27, v17
    v_mfma_f32_16x16x32_bf16 v[100:103], v[132:135], a[92:95], v[100:103]
    v_mfma_f32_16x16x32_bf16 v[100:103], v[136:139], a[116:119], v[100:103]
    v_mfma_f32_16x16x32_bf16 v[72:75], v[36:39], v[80:83], 0
    v_mfma_f32_16x16x32_bf16 v[100:103], v[140:143], a[140:143], v[100:103]
    v_mfma_f32_16x16x32_bf16 v[76:79], v[46:49], v[80:83], 0
    v_mfma_f32_16x16x32_bf16 v[100:103], v[144:147], a[164:167], v[100:103]
    v_cvt_pk_bf16_f32 v40, v96, v97
    v_cvt_pk_bf16_f32 v41, v98, v99
    v_mfma_f32_16x16x32_bf16 v[100:103], v[148:151], a[188:191], v[100:103]
    v_cvt_pk_bf16_f32 v32, v96, v97
    v_cvt_pk_bf16_f32 v33, v98, v99
    v_mfma_f32_16x16x32_bf16 v[100:103], v[152:155], a[212:215], v[100:103]
    s_add_u32 s53, s74, 32768
    v_mfma_f32_16x16x32_bf16 v[100:103], v[156:159], a[236:239], v[100:103]
    v_mfma_f32_16x16x32_bf16 v[100:103], v[160:163], v[180:183], v[100:103]
    v_mfma_f32_16x16x32_bf16 v[100:103], v[164:167], v[204:207], v[100:103]
    v_mfma_f32_16x16x32_bf16 v[100:103], v[168:171], v[228:231], v[100:103]
    v_mfma_f32_16x16x32_bf16 v[100:103], v[172:175], v[252:255], v[100:103]
    v_cvt_pk_bf16_f32 v84, v72, v73
    v_cvt_pk_bf16_f32 v85, v74, v75
    v_mfma_f32_16x16x32_bf16 v[104:107], a[0:3], v[120:123], 0
    v_cvt_pk_bf16_f32 v86, v76, v77
    v_cvt_pk_bf16_f32 v87, v78, v79
    v_mfma_f32_16x16x32_bf16 v[104:107], a[24:27], v[124:127], v[104:107]
    v_cndmask_b32 v86, v86, 0, s[82:83]
    v_cndmask_b32 v87, v87, 0, s[82:83]
    v_mfma_f32_16x16x32_bf16 v[104:107], a[48:51], v[128:131], v[104:107]
    buffer_store_dwordx4 v[84:87], v23, s[24:27], s53 offen sc1
    v_mfma_f32_16x16x32_bf16 v[104:107], a[72:75], v[132:135], v[104:107]
    v_mfma_f32_16x16x32_bf16 v[104:107], a[96:99], v[136:139], v[104:107]
    v_mfma_f32_16x16x32_bf16 v[104:107], a[120:123], v[140:143], v[104:107]
    v_mfma_f32_16x16x32_bf16 v[104:107], a[144:147], v[144:147], v[104:107]
    v_cvt_pk_bf16_f32 v50, v100, v101
    v_cvt_pk_bf16_f32 v51, v102, v103
    v_mfma_f32_16x16x32_bf16 v[104:107], a[168:171], v[148:151], v[104:107]
    v_cvt_pk_bf16_f32 v42, v100, v101
    v_cvt_pk_bf16_f32 v43, v102, v103
    v_mfma_f32_16x16x32_bf16 v[104:107], a[192:195], v[152:155], v[104:107]
    v_mfma_f32_16x16x32_bf16 v[104:107], a[216:219], v[156:159], v[104:107]
    v_mfma_f32_16x16x32_bf16 v[104:107], a[240:243], v[160:163], v[104:107]
    v_mfma_f32_16x16x32_bf16 v[104:107], v[184:187], v[164:167], v[104:107]
    v_mfma_f32_16x16x32_bf16 v[104:107], v[208:211], v[168:171], v[104:107]
    v_mfma_f32_16x16x32_bf16 v[104:107], v[232:235], v[172:175], v[104:107]
    v_mfma_f32_16x16x32_bf16 v[108:111], a[4:7], v[120:123], 0
    ds_read_b128 v[120:123], v4 offset:16384
    v_mfma_f32_16x16x32_bf16 v[108:111], a[28:31], v[124:127], v[108:111]
    ds_read_b128 v[124:127], v25 offset:16384
    v_mfma_f32_16x16x32_bf16 v[108:111], a[52:55], v[128:131], v[108:111]
    ds_read_b128 v[128:131], v4 offset:18432
    v_mfma_f32_16x16x32_bf16 v[108:111], a[76:79], v[132:135], v[108:111]
    ds_read_b128 v[132:135], v25 offset:18432
    v_mfma_f32_16x16x32_bf16 v[108:111], a[100:103], v[136:139], v[108:111]
    ds_read_b128 v[136:139], v4 offset:20480
    v_mfma_f32_16x16x32_bf16 v[108:111], a[124:127], v[140:143], v[108:111]
    ds_read_b128 v[140:143], v25 offset:20480
    v_mfma_f32_16x16x32_bf16 v[108:111], a[148:151], v[144:147], v[108:111]
    ds_read_b128 v[144:147], v4 offset:22528
    v_cvt_pk_bf16_f32 v64, v104, v105
    v_mfma_f32_16x16x32_bf16 v[108:111], a[172:175], v[148:151], v[108:111]
    ds_read_b128 v[148:151], v25 offset:22528
    v_cvt_pk_bf16_f32 v65, v106, v107
    v_mfma_f32_16x16x32_bf16 v[108:111], a[196:199], v[152:155], v[108:111]
    ds_read_b128 v[152:155], v4 offset:24576
    v_mfma_f32_16x16x32_bf16 v[108:111], a[220:223], v[156:159], v[108:111]
    ds_read_b128 v[156:159], v25 offset:24576
    v_mfma_f32_16x16x32_bf16 v[108:111], a[244:247], v[160:163], v[108:111]
    ds_read_b128 v[160:163], v4 offset:26624
    v_mfma_f32_16x16x32_bf16 v[108:111], v[188:191], v[164:167], v[108:111]
    ds_read_b128 v[164:167], v25 offset:26624
    v_mfma_f32_16x16x32_bf16 v[108:111], v[212:215], v[168:171], v[108:111]
    ds_read_b128 v[168:171], v4 offset:28672
    v_mfma_f32_16x16x32_bf16 v[108:111], v[236:239], v[172:175], v[108:111]
    ds_read_b128 v[172:175], v25 offset:28672
    s_waitcnt lgkmcnt(11)
    v_mfma_f32_16x16x32_bf16 v[112:115], a[8:11], v[120:123], 0
    v_mfma_f32_16x16x32_bf16 v[112:115], a[32:35], v[124:127], v[112:115]
    v_mfma_f32_16x16x32_bf16 v[112:115], a[56:59], v[128:131], v[112:115]
    s_waitcnt lgkmcnt(8)
    v_mfma_f32_16x16x32_bf16 v[112:115], a[80:83], v[132:135], v[112:115]
    v_mfma_f32_16x16x32_bf16 v[112:115], a[104:107], v[136:139], v[112:115]
    v_mfma_f32_16x16x32_bf16 v[112:115], a[128:131], v[140:143], v[112:115]
    s_waitcnt lgkmcnt(5)
    v_mfma_f32_16x16x32_bf16 v[112:115], a[152:155], v[144:147], v[112:115]
    v_cvt_pk_bf16_f32 v66, v108, v109
    v_cvt_pk_bf16_f32 v67, v110, v111
    v_mfma_f32_16x16x32_bf16 v[112:115], a[176:179], v[148:151], v[112:115]
    v_cndmask_b32 v66, v66, 0, s[82:83]
    v_cndmask_b32 v67, v67, 0, s[82:83]
    v_mfma_f32_16x16x32_bf16 v[112:115], a[200:203], v[152:155], v[112:115]
    s_waitcnt lgkmcnt(2)
    v_mfma_f32_16x16x32_bf16 v[112:115], a[224:227], v[156:159], v[112:115]
    v_mfma_f32_16x16x32_bf16 v[72:75], v[52:55], v[64:67], 0
    v_mfma_f32_16x16x32_bf16 v[112:115], a[248:251], v[160:163], v[112:115]
    v_mfma_f32_16x16x32_bf16 v[76:79], v[56:59], v[64:67], 0
    v_mfma_f32_16x16x32_bf16 v[112:115], v[192:195], v[164:167], v[112:115]
    s_waitcnt lgkmcnt(0)
    v_mfma_f32_16x16x32_bf16 v[112:115], v[216:219], v[168:171], v[112:115]
    v_mfma_f32_16x16x32_bf16 v[112:115], v[240:243], v[172:175], v[112:115]
    v_mfma_f32_16x16x32_bf16 v[116:119], a[12:15], v[120:123], 0
    v_mfma_f32_16x16x32_bf16 v[116:119], a[36:39], v[124:127], v[116:119]
    v_cndmask_b32 v26, v72, v73, s[76:77]
    v_cndmask_b32 v27, v74, v75, s[76:77]
    v_mfma_f32_16x16x32_bf16 v[116:119], a[60:63], v[128:131], v[116:119]
    v_cndmask_b32 v28, v76, v77, s[76:77]
    v_cndmask_b32 v29, v78, v79, s[76:77]
    v_mfma_f32_16x16x32_bf16 v[116:119], a[84:87], v[132:135], v[116:119]
    v_cndmask_b32 v26, v26, v28, s[78:79]
    v_cndmask_b32 v27, v27, v29, s[80:81]
    v_mfma_f32_16x16x32_bf16 v[116:119], a[108:111], v[136:139], v[116:119]
    v_max_f32 v28, v26, v27
    v_mov_b32 v29, v28
    v_mfma_f32_16x16x32_bf16 v[116:119], a[132:135], v[140:143], v[116:119]
    v_mfma_f32_16x16x32_bf16 v[116:119], a[156:159], v[144:147], v[116:119]
    v_cvt_pk_bf16_f32 v60, v112, v113
    v_cvt_pk_bf16_f32 v61, v114, v115
    v_mfma_f32_16x16x32_bf16 v[116:119], a[180:183], v[148:151], v[116:119]
    v_permlane16_swap_b32 v28, v29
    v_max_f32 v28, v28, v29
    v_mfma_f32_16x16x32_bf16 v[116:119], a[204:207], v[152:155], v[116:119]
    v_mov_b32 v29, v28
    v_mfma_f32_16x16x32_bf16 v[116:119], a[228:231], v[156:159], v[116:119]
    v_mfma_f32_16x16x32_bf16 v[116:119], a[252:255], v[160:163], v[116:119]
    v_permlane32_swap_b32 v28, v29
    v_max_f32 v28, v28, v29
    v_mfma_f32_16x16x32_bf16 v[116:119], v[196:199], v[164:167], v[116:119]
    v_sub_f32 v26, v26, v28
    v_sub_f32 v27, v27, v28
    v_mfma_f32_16x16x32_bf16 v[116:119], v[220:223], v[168:171], v[116:119]
    v_mul_f32 v26, s91, v26
    v_mul_f32 v27, s91, v27
    v_mfma_f32_16x16x32_bf16 v[116:119], v[244:247], v[172:175], v[116:119]
    v_exp_f32 v26, v26
    v_mfma_f32_16x16x32_bf16 v[96:99], v[120:123], a[16:19], 0
    v_exp_f32 v27, v27
    v_mfma_f32_16x16x32_bf16 v[96:99], v[124:127], a[40:43], v[96:99]
    v_add_f32 v28, v26, v27
    v_mov_b32 v29, v28
    v_mfma_f32_16x16x32_bf16 v[96:99], v[128:131], a[64:67], v[96:99]
    v_mfma_f32_16x16x32_bf16 v[96:99], v[132:135], a[88:91], v[96:99]
    v_permlane16_swap_b32 v28, v29
    v_add_f32 v28, v28, v29
    v_mfma_f32_16x16x32_bf16 v[96:99], v[136:139], a[112:115], v[96:99]
    v_mov_b32 v29, v28
    v_mfma_f32_16x16x32_bf16 v[96:99], v[140:143], a[136:139], v[96:99]
    v_mfma_f32_16x16x32_bf16 v[96:99], v[144:147], a[160:163], v[96:99]
    v_cvt_pk_bf16_f32 v62, v116, v117
    v_cvt_pk_bf16_f32 v63, v118, v119
    v_mfma_f32_16x16x32_bf16 v[96:99], v[148:151], a[184:187], v[96:99]
    v_cndmask_b32 v62, v62, 0, s[82:83]
    v_cndmask_b32 v63, v63, 0, s[82:83]
    v_mfma_f32_16x16x32_bf16 v[96:99], v[152:155], a[208:211], v[96:99]
    v_permlane32_swap_b32 v28, v29
    v_add_f32 v28, v28, v29
    v_mfma_f32_16x16x32_bf16 v[96:99], v[156:159], a[232:235], v[96:99]
    v_rcp_f32 v28, v28
    v_mfma_f32_16x16x32_bf16 v[96:99], v[160:163], v[176:179], v[96:99]
    v_mul_f32 v26, v26, v28
    v_mul_f32 v27, v27, v28
    v_mfma_f32_16x16x32_bf16 v[96:99], v[164:167], v[200:203], v[96:99]
    v_cvt_pk_bf16_f32 v26, v26, v26
    v_cvt_pk_bf16_f32 v27, v27, v27
    v_mfma_f32_16x16x32_bf16 v[96:99], v[168:171], v[224:227], v[96:99]
    v_and_b32 v80, v26, v14
    v_and_b32 v81, v27, v15
    v_mfma_f32_16x16x32_bf16 v[96:99], v[172:175], v[248:251], v[96:99]
    v_and_b32 v82, v26, v16
    v_and_b32 v83, v27, v17
    v_mfma_f32_16x16x32_bf16 v[100:103], v[120:123], a[20:23], 0
    v_mfma_f32_16x16x32_bf16 v[100:103], v[124:127], a[44:47], v[100:103]
    v_mfma_f32_16x16x32_bf16 v[72:75], v[38:41], v[80:83], 0
    v_mfma_f32_16x16x32_bf16 v[100:103], v[128:131], a[68:71], v[100:103]
    v_mfma_f32_16x16x32_bf16 v[76:79], v[48:51], v[80:83], 0
    v_mfma_f32_16x16x32_bf16 v[100:103], v[132:135], a[92:95], v[100:103]
    s_add_u32 s53, s74, 49152
    v_mfma_f32_16x16x32_bf16 v[100:103], v[136:139], a[116:119], v[100:103]
    v_mfma_f32_16x16x32_bf16 v[100:103], v[140:143], a[140:143], v[100:103]
    v_mfma_f32_16x16x32_bf16 v[100:103], v[144:147], a[164:167], v[100:103]
    v_cvt_pk_bf16_f32 v34, v96, v97
    v_cvt_pk_bf16_f32 v35, v98, v99
    v_mfma_f32_16x16x32_bf16 v[100:103], v[148:151], a[188:191], v[100:103]
    v_mfma_f32_16x16x32_bf16 v[100:103], v[152:155], a[212:215], v[100:103]
    v_cvt_pk_bf16_f32 v84, v72, v73
    v_cvt_pk_bf16_f32 v85, v74, v75
    v_mfma_f32_16x16x32_bf16 v[100:103], v[156:159], a[236:239], v[100:103]
    v_cvt_pk_bf16_f32 v86, v76, v77
    v_cvt_pk_bf16_f32 v87, v78, v79
    v_mfma_f32_16x16x32_bf16 v[100:103], v[160:163], v[180:183], v[100:103]
    v_cndmask_b32 v86, v86, 0, s[82:83]
    v_cndmask_b32 v87, v87, 0, s[82:83]
    v_mfma_f32_16x16x32_bf16 v[100:103], v[164:167], v[204:207], v[100:103]
    buffer_store_dwordx4 v[84:87], v23, s[24:27], s53 offen sc1
    v_mfma_f32_16x16x32_bf16 v[100:103], v[168:171], v[228:231], v[100:103]
    v_mfma_f32_16x16x32_bf16 v[100:103], v[172:175], v[252:255], v[100:103]
    v_mfma_f32_16x16x32_bf16 v[104:107], a[0:3], v[120:123], 0
    v_mfma_f32_16x16x32_bf16 v[104:107], a[24:27], v[124:127], v[104:107]
    v_mfma_f32_16x16x32_bf16 v[104:107], a[48:51], v[128:131], v[104:107]
    v_mfma_f32_16x16x32_bf16 v[104:107], a[72:75], v[132:135], v[104:107]
    v_mfma_f32_16x16x32_bf16 v[104:107], a[96:99], v[136:139], v[104:107]
    v_mfma_f32_16x16x32_bf16 v[104:107], a[120:123], v[140:143], v[104:107]
    v_mfma_f32_16x16x32_bf16 v[104:107], a[144:147], v[144:147], v[104:107]
    s_nop 0
    v_cvt_pk_bf16_f32 v44, v100, v101
    v_cvt_pk_bf16_f32 v45, v102, v103
    v_mfma_f32_16x16x32_bf16 v[104:107], a[168:171], v[148:151], v[104:107]
    v_mfma_f32_16x16x32_bf16 v[104:107], a[192:195], v[152:155], v[104:107]
    v_mfma_f32_16x16x32_bf16 v[104:107], a[216:219], v[156:159], v[104:107]
    v_mfma_f32_16x16x32_bf16 v[104:107], a[240:243], v[160:163], v[104:107]
    v_mfma_f32_16x16x32_bf16 v[104:107], v[184:187], v[164:167], v[104:107]
    v_mfma_f32_16x16x32_bf16 v[104:107], v[208:211], v[168:171], v[104:107]
    v_mfma_f32_16x16x32_bf16 v[104:107], v[232:235], v[172:175], v[104:107]
    v_mfma_f32_16x16x32_bf16 v[108:111], a[4:7], v[120:123], 0
    ds_read_b128 v[120:123], v4 offset:32768
    v_mfma_f32_16x16x32_bf16 v[108:111], a[28:31], v[124:127], v[108:111]
    ds_read_b128 v[124:127], v25 offset:32768
    v_mfma_f32_16x16x32_bf16 v[108:111], a[52:55], v[128:131], v[108:111]
    ds_read_b128 v[128:131], v4 offset:34816
    v_mfma_f32_16x16x32_bf16 v[108:111], a[76:79], v[132:135], v[108:111]
    ds_read_b128 v[132:135], v25 offset:34816
    v_mfma_f32_16x16x32_bf16 v[108:111], a[100:103], v[136:139], v[108:111]
    ds_read_b128 v[136:139], v4 offset:36864
    v_mfma_f32_16x16x32_bf16 v[108:111], a[124:127], v[140:143], v[108:111]
    ds_read_b128 v[140:143], v25 offset:36864
    v_mfma_f32_16x16x32_bf16 v[108:111], a[148:151], v[144:147], v[108:111]
    ds_read_b128 v[144:147], v4 offset:38912
    v_cvt_pk_bf16_f32 v68, v104, v105
    v_mfma_f32_16x16x32_bf16 v[108:111], a[172:175], v[148:151], v[108:111]
    ds_read_b128 v[148:151], v25 offset:38912
    v_cvt_pk_bf16_f32 v69, v106, v107
    v_mfma_f32_16x16x32_bf16 v[108:111], a[196:199], v[152:155], v[108:111]
    ds_read_b128 v[152:155], v4 offset:40960
    v_mfma_f32_16x16x32_bf16 v[108:111], a[220:223], v[156:159], v[108:111]
    ds_read_b128 v[156:159], v25 offset:40960
    v_mfma_f32_16x16x32_bf16 v[108:111], a[244:247], v[160:163], v[108:111]
    ds_read_b128 v[160:163], v4 offset:43008
    v_mfma_f32_16x16x32_bf16 v[108:111], v[188:191], v[164:167], v[108:111]
    ds_read_b128 v[164:167], v25 offset:43008
    v_mfma_f32_16x16x32_bf16 v[108:111], v[212:215], v[168:171], v[108:111]
    ds_read_b128 v[168:171], v4 offset:45056
    v_mfma_f32_16x16x32_bf16 v[108:111], v[236:239], v[172:175], v[108:111]
    ds_read_b128 v[172:175], v25 offset:45056
    s_waitcnt lgkmcnt(11)
    v_mfma_f32_16x16x32_bf16 v[112:115], a[8:11], v[120:123], 0
    v_mfma_f32_16x16x32_bf16 v[112:115], a[32:35], v[124:127], v[112:115]
    v_mfma_f32_16x16x32_bf16 v[112:115], a[56:59], v[128:131], v[112:115]
    s_waitcnt lgkmcnt(8)
    v_mfma_f32_16x16x32_bf16 v[112:115], a[80:83], v[132:135], v[112:115]
    v_mfma_f32_16x16x32_bf16 v[112:115], a[104:107], v[136:139], v[112:115]
    v_mfma_f32_16x16x32_bf16 v[112:115], a[128:131], v[140:143], v[112:115]
    s_waitcnt lgkmcnt(5)
    v_mfma_f32_16x16x32_bf16 v[112:115], a[152:155], v[144:147], v[112:115]
    v_cvt_pk_bf16_f32 v70, v108, v109
    v_cvt_pk_bf16_f32 v71, v110, v111
    v_mfma_f32_16x16x32_bf16 v[112:115], a[176:179], v[148:151], v[112:115]
    v_cndmask_b32 v70, v70, 0, s[82:83]
    v_cndmask_b32 v71, v71, 0, s[82:83]
    v_mfma_f32_16x16x32_bf16 v[112:115], a[200:203], v[152:155], v[112:115]
    s_waitcnt lgkmcnt(2)
    v_mfma_f32_16x16x32_bf16 v[112:115], a[224:227], v[156:159], v[112:115]
    v_mfma_f32_16x16x32_bf16 v[72:75], v[56:59], v[68:71], 0
    v_mfma_f32_16x16x32_bf16 v[112:115], a[248:251], v[160:163], v[112:115]
    v_mfma_f32_16x16x32_bf16 v[76:79], v[60:63], v[68:71], 0
    v_mfma_f32_16x16x32_bf16 v[112:115], v[192:195], v[164:167], v[112:115]
    s_waitcnt lgkmcnt(0)
    v_mfma_f32_16x16x32_bf16 v[112:115], v[216:219], v[168:171], v[112:115]
    v_mfma_f32_16x16x32_bf16 v[112:115], v[240:243], v[172:175], v[112:115]
    v_mfma_f32_16x16x32_bf16 v[116:119], a[12:15], v[120:123], 0
    v_mfma_f32_16x16x32_bf16 v[116:119], a[36:39], v[124:127], v[116:119]
    v_cndmask_b32 v26, v72, v73, s[76:77]
    v_cndmask_b32 v27, v74, v75, s[76:77]
    v_mfma_f32_16x16x32_bf16 v[116:119], a[60:63], v[128:131], v[116:119]
    v_cndmask_b32 v28, v76, v77, s[76:77]
    v_cndmask_b32 v29, v78, v79, s[76:77]
    v_mfma_f32_16x16x32_bf16 v[116:119], a[84:87], v[132:135], v[116:119]
    v_cndmask_b32 v26, v26, v28, s[78:79]
    v_cndmask_b32 v27, v27, v29, s[80:81]
    v_mfma_f32_16x16x32_bf16 v[116:119], a[108:111], v[136:139], v[116:119]
    v_max_f32 v28, v26, v27
    v_mov_b32 v29, v28
    v_mfma_f32_16x16x32_bf16 v[116:119], a[132:135], v[140:143], v[116:119]
    v_mfma_f32_16x16x32_bf16 v[116:119], a[156:159], v[144:147], v[116:119]
    v_cvt_pk_bf16_f32 v52, v112, v113
    v_cvt_pk_bf16_f32 v53, v114, v115
    v_mfma_f32_16x16x32_bf16 v[116:119], a[180:183], v[148:151], v[116:119]
    v_permlane16_swap_b32 v28, v29
    v_max_f32 v28, v28, v29
    v_mfma_f32_16x16x32_bf16 v[116:119], a[204:207], v[152:155], v[116:119]
    v_mov_b32 v29, v28
    v_mfma_f32_16x16x32_bf16 v[116:119], a[228:231], v[156:159], v[116:119]
    v_mfma_f32_16x16x32_bf16 v[116:119], a[252:255], v[160:163], v[116:119]
    v_permlane32_swap_b32 v28, v29
    v_max_f32 v28, v28, v29
    v_mfma_f32_16x16x32_bf16 v[116:119], v[196:199], v[164:167], v[116:119]
    v_sub_f32 v26, v26, v28
    v_sub_f32 v27, v27, v28
    v_mfma_f32_16x16x32_bf16 v[116:119], v[220:223], v[168:171], v[116:119]
    v_mul_f32 v26, s91, v26
    v_mul_f32 v27, s91, v27
    v_mfma_f32_16x16x32_bf16 v[116:119], v[244:247], v[172:175], v[116:119]
    v_exp_f32 v26, v26
    v_mfma_f32_16x16x32_bf16 v[96:99], v[120:123], a[16:19], 0
    v_exp_f32 v27, v27
    v_mfma_f32_16x16x32_bf16 v[96:99], v[124:127], a[40:43], v[96:99]
    v_add_f32 v28, v26, v27
    v_mov_b32 v29, v28
    v_mfma_f32_16x16x32_bf16 v[96:99], v[128:131], a[64:67], v[96:99]
    v_mfma_f32_16x16x32_bf16 v[96:99], v[132:135], a[88:91], v[96:99]
    v_permlane16_swap_b32 v28, v29
    v_add_f32 v28, v28, v29
    v_mfma_f32_16x16x32_bf16 v[96:99], v[136:139], a[112:115], v[96:99]
    v_mov_b32 v29, v28
    v_mfma_f32_16x16x32_bf16 v[96:99], v[140:143], a[136:139], v[96:99]
    v_mfma_f32_16x16x32_bf16 v[96:99], v[144:147], a[160:163], v[96:99]
    v_cvt_pk_bf16_f32 v54, v116, v117
    v_cvt_pk_bf16_f32 v55, v118, v119
    v_mfma_f32_16x16x32_bf16 v[96:99], v[148:151], a[184:187], v[96:99]
    v_cndmask_b32 v54, v54, 0, s[82:83]
    v_cndmask_b32 v55, v55, 0, s[82:83]
    v_mfma_f32_16x16x32_bf16 v[96:99], v[152:155], a[208:211], v[96:99]
    v_permlane32_swap_b32 v28, v29
    v_add_f32 v28, v28, v29
    v_mfma_f32_16x16x32_bf16 v[96:99], v[156:159], a[232:235], v[96:99]
    v_rcp_f32 v28, v28
    v_mfma_f32_16x16x32_bf16 v[96:99], v[160:163], v[176:179], v[96:99]
    v_mul_f32 v26, v26, v28
    v_mul_f32 v27, v27, v28
    v_mfma_f32_16x16x32_bf16 v[96:99], v[164:167], v[200:203], v[96:99]
    v_cvt_pk_bf16_f32 v26, v26, v26
    v_cvt_pk_bf16_f32 v27, v27, v27
    v_mfma_f32_16x16x32_bf16 v[96:99], v[168:171], v[224:227], v[96:99]
    v_and_b32 v80, v26, v14
    v_and_b32 v81, v27, v15
    v_mfma_f32_16x16x32_bf16 v[96:99], v[172:175], v[248:251], v[96:99]
    v_and_b32 v82, v26, v16
    v_and_b32 v83, v27, v17
    v_mfma_f32_16x16x32_bf16 v[100:103], v[120:123], a[20:23], 0
    v_mfma_f32_16x16x32_bf16 v[100:103], v[124:127], a[44:47], v[100:103]
    v_mfma_f32_16x16x32_bf16 v[72:75], v[32:35], v[80:83], 0
    v_mfma_f32_16x16x32_bf16 v[100:103], v[128:131], a[68:71], v[100:103]
    v_mfma_f32_16x16x32_bf16 v[76:79], v[42:45], v[80:83], 0
    v_mfma_f32_16x16x32_bf16 v[100:103], v[132:135], a[92:95], v[100:103]
    s_add_u32 s53, s74, 65536
    v_mfma_f32_16x16x32_bf16 v[100:103], v[136:139], a[116:119], v[100:103]
    v_mfma_f32_16x16x32_bf16 v[100:103], v[140:143], a[140:143], v[100:103]
    v_mfma_f32_16x16x32_bf16 v[100:103], v[144:147], a[164:167], v[100:103]
    v_cvt_pk_bf16_f32 v36, v96, v97
    v_cvt_pk_bf16_f32 v37, v98, v99
    v_mfma_f32_16x16x32_bf16 v[100:103], v[148:151], a[188:191], v[100:103]
    v_mfma_f32_16x16x32_bf16 v[100:103], v[152:155], a[212:215], v[100:103]
    v_cvt_pk_bf16_f32 v84, v72, v73
    v_cvt_pk_bf16_f32 v85, v74, v75
    v_mfma_f32_16x16x32_bf16 v[100:103], v[156:159], a[236:239], v[100:103]
    v_cvt_pk_bf16_f32 v86, v76, v77
    v_cvt_pk_bf16_f32 v87, v78, v79
    v_mfma_f32_16x16x32_bf16 v[100:103], v[160:163], v[180:183], v[100:103]
    v_cndmask_b32 v86, v86, 0, s[82:83]
    v_cndmask_b32 v87, v87, 0, s[82:83]
    v_mfma_f32_16x16x32_bf16 v[100:103], v[164:167], v[204:207], v[100:103]
    buffer_store_dwordx4 v[84:87], v23, s[24:27], s53 offen sc1
    v_mfma_f32_16x16x32_bf16 v[100:103], v[168:171], v[228:231], v[100:103]
    v_mfma_f32_16x16x32_bf16 v[100:103], v[172:175], v[252:255], v[100:103]
    v_mfma_f32_16x16x32_bf16 v[104:107], a[0:3], v[120:123], 0
    v_mfma_f32_16x16x32_bf16 v[104:107], a[24:27], v[124:127], v[104:107]
    v_mfma_f32_16x16x32_bf16 v[104:107], a[48:51], v[128:131], v[104:107]
    v_mfma_f32_16x16x32_bf16 v[104:107], a[72:75], v[132:135], v[104:107]
    v_mfma_f32_16x16x32_bf16 v[104:107], a[96:99], v[136:139], v[104:107]
    v_mfma_f32_16x16x32_bf16 v[104:107], a[120:123], v[140:143], v[104:107]
    v_mfma_f32_16x16x32_bf16 v[104:107], a[144:147], v[144:147], v[104:107]
    s_nop 0
    v_cvt_pk_bf16_f32 v46, v100, v101
    v_cvt_pk_bf16_f32 v47, v102, v103
    v_mfma_f32_16x16x32_bf16 v[104:107], a[168:171], v[148:151], v[104:107]
    v_mfma_f32_16x16x32_bf16 v[104:107], a[192:195], v[152:155], v[104:107]
    v_mfma_f32_16x16x32_bf16 v[104:107], a[216:219], v[156:159], v[104:107]
    v_mfma_f32_16x16x32_bf16 v[104:107], a[240:243], v[160:163], v[104:107]
    v_mfma_f32_16x16x32_bf16 v[104:107], v[184:187], v[164:167], v[104:107]
    v_mfma_f32_16x16x32_bf16 v[104:107], v[208:211], v[168:171], v[104:107]
    v_mfma_f32_16x16x32_bf16 v[104:107], v[232:235], v[172:175], v[104:107]
    v_mfma_f32_16x16x32_bf16 v[108:111], a[4:7], v[120:123], 0
    ds_read_b128 v[120:123], v4 offset:49152
    v_mfma_f32_16x16x32_bf16 v[108:111], a[28:31], v[124:127], v[108:111]
    ds_read_b128 v[124:127], v25 offset:49152
    v_mfma_f32_16x16x32_bf16 v[108:111], a[52:55], v[128:131], v[108:111]
    ds_read_b128 v[128:131], v4 offset:51200
    v_mfma_f32_16x16x32_bf16 v[108:111], a[76:79], v[132:135], v[108:111]
    ds_read_b128 v[132:135], v25 offset:51200
    v_mfma_f32_16x16x32_bf16 v[108:111], a[100:103], v[136:139], v[108:111]
    ds_read_b128 v[136:139], v4 offset:53248
    v_mfma_f32_16x16x32_bf16 v[108:111], a[124:127], v[140:143], v[108:111]
    ds_read_b128 v[140:143], v25 offset:53248
    v_mfma_f32_16x16x32_bf16 v[108:111], a[148:151], v[144:147], v[108:111]
    ds_read_b128 v[144:147], v4 offset:55296
    v_cvt_pk_bf16_f32 v64, v104, v105
    v_mfma_f32_16x16x32_bf16 v[108:111], a[172:175], v[148:151], v[108:111]
    ds_read_b128 v[148:151], v25 offset:55296
    v_cvt_pk_bf16_f32 v65, v106, v107
    v_mfma_f32_16x16x32_bf16 v[108:111], a[196:199], v[152:155], v[108:111]
    ds_read_b128 v[152:155], v4 offset:57344
    v_mfma_f32_16x16x32_bf16 v[108:111], a[220:223], v[156:159], v[108:111]
    ds_read_b128 v[156:159], v25 offset:57344
    v_mfma_f32_16x16x32_bf16 v[108:111], a[244:247], v[160:163], v[108:111]
    ds_read_b128 v[160:163], v4 offset:59392
    v_mfma_f32_16x16x32_bf16 v[108:111], v[188:191], v[164:167], v[108:111]
    ds_read_b128 v[164:167], v25 offset:59392
    v_mfma_f32_16x16x32_bf16 v[108:111], v[212:215], v[168:171], v[108:111]
    ds_read_b128 v[168:171], v4 offset:61440
    v_mfma_f32_16x16x32_bf16 v[108:111], v[236:239], v[172:175], v[108:111]
    ds_read_b128 v[172:175], v25 offset:61440
    s_waitcnt lgkmcnt(11)
    v_mfma_f32_16x16x32_bf16 v[112:115], a[8:11], v[120:123], 0
    v_mfma_f32_16x16x32_bf16 v[112:115], a[32:35], v[124:127], v[112:115]
    v_mfma_f32_16x16x32_bf16 v[112:115], a[56:59], v[128:131], v[112:115]
    s_waitcnt lgkmcnt(8)
    v_mfma_f32_16x16x32_bf16 v[112:115], a[80:83], v[132:135], v[112:115]
    v_mfma_f32_16x16x32_bf16 v[112:115], a[104:107], v[136:139], v[112:115]
    v_mfma_f32_16x16x32_bf16 v[112:115], a[128:131], v[140:143], v[112:115]
    s_waitcnt lgkmcnt(5)
    v_mfma_f32_16x16x32_bf16 v[112:115], a[152:155], v[144:147], v[112:115]
    v_cvt_pk_bf16_f32 v66, v108, v109
    v_cvt_pk_bf16_f32 v67, v110, v111
    v_mfma_f32_16x16x32_bf16 v[112:115], a[176:179], v[148:151], v[112:115]
    v_cndmask_b32 v66, v66, 0, s[82:83]
    v_cndmask_b32 v67, v67, 0, s[82:83]
    v_mfma_f32_16x16x32_bf16 v[112:115], a[200:203], v[152:155], v[112:115]
    s_waitcnt lgkmcnt(2)
    v_mfma_f32_16x16x32_bf16 v[112:115], a[224:227], v[156:159], v[112:115]
    v_mfma_f32_16x16x32_bf16 v[72:75], v[60:63], v[64:67], 0
    v_mfma_f32_16x16x32_bf16 v[112:115], a[248:251], v[160:163], v[112:115]
    v_mfma_f32_16x16x32_bf16 v[76:79], v[52:55], v[64:67], 0
    v_mfma_f32_16x16x32_bf16 v[112:115], v[192:195], v[164:167], v[112:115]
    s_waitcnt lgkmcnt(0)
    v_mfma_f32_16x16x32_bf16 v[112:115], v[216:219], v[168:171], v[112:115]
    v_mfma_f32_16x16x32_bf16 v[112:115], v[240:243], v[172:175], v[112:115]
    v_mfma_f32_16x16x32_bf16 v[116:119], a[12:15], v[120:123], 0
    v_mfma_f32_16x16x32_bf16 v[116:119], a[36:39], v[124:127], v[116:119]
    v_cndmask_b32 v26, v72, v73, s[76:77]
    v_cndmask_b32 v27, v74, v75, s[76:77]
    v_mfma_f32_16x16x32_bf16 v[116:119], a[60:63], v[128:131], v[116:119]
    v_cndmask_b32 v28, v76, v77, s[76:77]
    v_cndmask_b32 v29, v78, v79, s[76:77]
    v_mfma_f32_16x16x32_bf16 v[116:119], a[84:87], v[132:135], v[116:119]
    v_cndmask_b32 v26, v26, v28, s[78:79]
    v_cndmask_b32 v27, v27, v29, s[80:81]
    v_mfma_f32_16x16x32_bf16 v[116:119], a[108:111], v[136:139], v[116:119]
    v_max_f32 v28, v26, v27
    v_mov_b32 v29, v28
    v_mfma_f32_16x16x32_bf16 v[116:119], a[132:135], v[140:143], v[116:119]
    v_mfma_f32_16x16x32_bf16 v[116:119], a[156:159], v[144:147], v[116:119]
    v_cvt_pk_bf16_f32 v56, v112, v113
    v_cvt_pk_bf16_f32 v57, v114, v115
    v_mfma_f32_16x16x32_bf16 v[116:119], a[180:183], v[148:151], v[116:119]
    v_permlane16_swap_b32 v28, v29
    v_max_f32 v28, v28, v29
    v_mfma_f32_16x16x32_bf16 v[116:119], a[204:207], v[152:155], v[116:119]
    v_mov_b32 v29, v28
    v_mfma_f32_16x16x32_bf16 v[116:119], a[228:231], v[156:159], v[116:119]
    v_mfma_f32_16x16x32_bf16 v[116:119], a[252:255], v[160:163], v[116:119]
    v_permlane32_swap_b32 v28, v29
    v_max_f32 v28, v28, v29
    v_mfma_f32_16x16x32_bf16 v[116:119], v[196:199], v[164:167], v[116:119]
    v_sub_f32 v26, v26, v28
    v_sub_f32 v27, v27, v28
    v_mfma_f32_16x16x32_bf16 v[116:119], v[220:223], v[168:171], v[116:119]
    v_mul_f32 v26, s91, v26
    v_mul_f32 v27, s91, v27
    v_mfma_f32_16x16x32_bf16 v[116:119], v[244:247], v[172:175], v[116:119]
    v_exp_f32 v26, v26
    v_mfma_f32_16x16x32_bf16 v[96:99], v[120:123], a[16:19], 0
    v_exp_f32 v27, v27
    v_mfma_f32_16x16x32_bf16 v[96:99], v[124:127], a[40:43], v[96:99]
    v_add_f32 v28, v26, v27
    v_mov_b32 v29, v28
    v_mfma_f32_16x16x32_bf16 v[96:99], v[128:131], a[64:67], v[96:99]
    v_mfma_f32_16x16x32_bf16 v[96:99], v[132:135], a[88:91], v[96:99]
    v_permlane16_swap_b32 v28, v29
    v_add_f32 v28, v28, v29
    v_mfma_f32_16x16x32_bf16 v[96:99], v[136:139], a[112:115], v[96:99]
    v_mov_b32 v29, v28
    v_mfma_f32_16x16x32_bf16 v[96:99], v[140:143], a[136:139], v[96:99]
    v_mfma_f32_16x16x32_bf16 v[96:99], v[144:147], a[160:163], v[96:99]
    v_cvt_pk_bf16_f32 v58, v116, v117
    v_cvt_pk_bf16_f32 v59, v118, v119
    v_mfma_f32_16x16x32_bf16 v[96:99], v[148:151], a[184:187], v[96:99]
    v_cndmask_b32 v58, v58, 0, s[82:83]
    v_cndmask_b32 v59, v59, 0, s[82:83]
    v_mfma_f32_16x16x32_bf16 v[96:99], v[152:155], a[208:211], v[96:99]
    v_permlane32_swap_b32 v28, v29
    v_add_f32 v28, v28, v29
    v_mfma_f32_16x16x32_bf16 v[96:99], v[156:159], a[232:235], v[96:99]
    v_rcp_f32 v28, v28
    v_mfma_f32_16x16x32_bf16 v[96:99], v[160:163], v[176:179], v[96:99]
    v_mul_f32 v26, v26, v28
    v_mul_f32 v27, v27, v28
    v_mfma_f32_16x16x32_bf16 v[96:99], v[164:167], v[200:203], v[96:99]
    v_cvt_pk_bf16_f32 v26, v26, v26
    v_cvt_pk_bf16_f32 v27, v27, v27
    v_mfma_f32_16x16x32_bf16 v[96:99], v[168:171], v[224:227], v[96:99]
    v_and_b32 v80, v26, v14
    v_and_b32 v81, v27, v15
    v_mfma_f32_16x16x32_bf16 v[96:99], v[172:175], v[248:251], v[96:99]
    v_and_b32 v82, v26, v16
    v_and_b32 v83, v27, v17
    v_mfma_f32_16x16x32_bf16 v[100:103], v[120:123], a[20:23], 0
    v_mfma_f32_16x16x32_bf16 v[100:103], v[124:127], a[44:47], v[100:103]
    v_mfma_f32_16x16x32_bf16 v[72:75], v[34:37], v[80:83], 0
    v_mfma_f32_16x16x32_bf16 v[100:103], v[128:131], a[68:71], v[100:103]
    v_mfma_f32_16x16x32_bf16 v[76:79], v[44:47], v[80:83], 0
    v_mfma_f32_16x16x32_bf16 v[100:103], v[132:135], a[92:95], v[100:103]
    s_add_u32 s53, s74, 81920
    v_mfma_f32_16x16x32_bf16 v[100:103], v[136:139], a[116:119], v[100:103]
    v_mfma_f32_16x16x32_bf16 v[100:103], v[140:143], a[140:143], v[100:103]
    v_mfma_f32_16x16x32_bf16 v[100:103], v[144:147], a[164:167], v[100:103]
    v_cvt_pk_bf16_f32 v38, v96, v97
    v_cvt_pk_bf16_f32 v39, v98, v99
    v_mfma_f32_16x16x32_bf16 v[100:103], v[148:151], a[188:191], v[100:103]
    v_mfma_f32_16x16x32_bf16 v[100:103], v[152:155], a[212:215], v[100:103]
    v_cvt_pk_bf16_f32 v84, v72, v73
    v_cvt_pk_bf16_f32 v85, v74, v75
    v_mfma_f32_16x16x32_bf16 v[100:103], v[156:159], a[236:239], v[100:103]
    v_cvt_pk_bf16_f32 v86, v76, v77
    v_cvt_pk_bf16_f32 v87, v78, v79
    v_mfma_f32_16x16x32_bf16 v[100:103], v[160:163], v[180:183], v[100:103]
    v_cndmask_b32 v86, v86, 0, s[82:83]
    v_cndmask_b32 v87, v87, 0, s[82:83]
    v_mfma_f32_16x16x32_bf16 v[100:103], v[164:167], v[204:207], v[100:103]
    buffer_store_dwordx4 v[84:87], v23, s[24:27], s53 offen sc1
    v_mfma_f32_16x16x32_bf16 v[100:103], v[168:171], v[228:231], v[100:103]
    v_mfma_f32_16x16x32_bf16 v[100:103], v[172:175], v[252:255], v[100:103]
    v_mfma_f32_16x16x32_bf16 v[104:107], a[0:3], v[120:123], 0
    v_mfma_f32_16x16x32_bf16 v[104:107], a[24:27], v[124:127], v[104:107]
    v_mfma_f32_16x16x32_bf16 v[104:107], a[48:51], v[128:131], v[104:107]
    v_mfma_f32_16x16x32_bf16 v[104:107], a[72:75], v[132:135], v[104:107]
    v_mfma_f32_16x16x32_bf16 v[104:107], a[96:99], v[136:139], v[104:107]
    v_mfma_f32_16x16x32_bf16 v[104:107], a[120:123], v[140:143], v[104:107]
    v_mfma_f32_16x16x32_bf16 v[104:107], a[144:147], v[144:147], v[104:107]
    s_nop 0
    v_cvt_pk_bf16_f32 v48, v100, v101
    v_cvt_pk_bf16_f32 v49, v102, v103
    v_mfma_f32_16x16x32_bf16 v[104:107], a[168:171], v[148:151], v[104:107]
    v_mfma_f32_16x16x32_bf16 v[104:107], a[192:195], v[152:155], v[104:107]
    v_mfma_f32_16x16x32_bf16 v[104:107], a[216:219], v[156:159], v[104:107]
    v_mfma_f32_16x16x32_bf16 v[104:107], a[240:243], v[160:163], v[104:107]
    v_mfma_f32_16x16x32_bf16 v[104:107], v[184:187], v[164:167], v[104:107]
    v_mfma_f32_16x16x32_bf16 v[104:107], v[208:211], v[168:171], v[104:107]
    v_mfma_f32_16x16x32_bf16 v[104:107], v[232:235], v[172:175], v[104:107]
    s_waitcnt vmcnt(6)
    s_barrier
    v_mfma_f32_16x16x32_bf16 v[108:111], a[4:7], v[120:123], 0
    v_add_u32 v4, 65536, v4
    v_add_u32 v25, 65536, v25
    ds_read_b128 v[120:123], v4 offset:0
    v_mfma_f32_16x16x32_bf16 v[108:111], a[28:31], v[124:127], v[108:111]
    ds_read_b128 v[124:127], v25 offset:0
    v_mfma_f32_16x16x32_bf16 v[108:111], a[52:55], v[128:131], v[108:111]
    ds_read_b128 v[128:131], v4 offset:2048
    v_mfma_f32_16x16x32_bf16 v[108:111], a[76:79], v[132:135], v[108:111]
    ds_read_b128 v[132:135], v25 offset:2048
    v_mfma_f32_16x16x32_bf16 v[108:111], a[100:103], v[136:139], v[108:111]
    ds_read_b128 v[136:139], v4 offset:4096
    v_mfma_f32_16x16x32_bf16 v[108:111], a[124:127], v[140:143], v[108:111]
    ds_read_b128 v[140:143], v25 offset:4096
    v_mfma_f32_16x16x32_bf16 v[108:111], a[148:151], v[144:147], v[108:111]
    ds_read_b128 v[144:147], v4 offset:6144
    v_cvt_pk_bf16_f32 v68, v104, v105
    v_mfma_f32_16x16x32_bf16 v[108:111], a[172:175], v[148:151], v[108:111]
    ds_read_b128 v[148:151], v25 offset:6144
    v_cvt_pk_bf16_f32 v69, v106, v107
    v_mfma_f32_16x16x32_bf16 v[108:111], a[196:199], v[152:155], v[108:111]
    ds_read_b128 v[152:155], v4 offset:8192
    v_mfma_f32_16x16x32_bf16 v[108:111], a[220:223], v[156:159], v[108:111]
    ds_read_b128 v[156:159], v25 offset:8192
    v_mfma_f32_16x16x32_bf16 v[108:111], a[244:247], v[160:163], v[108:111]
    ds_read_b128 v[160:163], v4 offset:10240
    v_mfma_f32_16x16x32_bf16 v[108:111], v[188:191], v[164:167], v[108:111]
    ds_read_b128 v[164:167], v25 offset:10240
    v_mfma_f32_16x16x32_bf16 v[108:111], v[212:215], v[168:171], v[108:111]
    ds_read_b128 v[168:171], v4 offset:12288
    v_mfma_f32_16x16x32_bf16 v[108:111], v[236:239], v[172:175], v[108:111]
    ds_read_b128 v[172:175], v25 offset:12288
    s_waitcnt lgkmcnt(11)
    v_mfma_f32_16x16x32_bf16 v[112:115], a[0:3], v[120:123], 0
    v_mfma_f32_16x16x32_bf16 v[112:115], a[24:27], v[124:127], v[112:115]
    v_mfma_f32_16x16x32_bf16 v[112:115], a[48:51], v[128:131], v[112:115]
    s_waitcnt lgkmcnt(8)
    v_mfma_f32_16x16x32_bf16 v[112:115], a[72:75], v[132:135], v[112:115]
    v_mfma_f32_16x16x32_bf16 v[112:115], a[96:99], v[136:139], v[112:115]
    v_mfma_f32_16x16x32_bf16 v[112:115], a[120:123], v[140:143], v[112:115]
    s_waitcnt lgkmcnt(5)
    v_mfma_f32_16x16x32_bf16 v[112:115], a[144:147], v[144:147], v[112:115]
    v_cvt_pk_bf16_f32 v70, v108, v109
    v_cvt_pk_bf16_f32 v71, v110, v111
    v_mfma_f32_16x16x32_bf16 v[112:115], a[168:171], v[148:151], v[112:115]
    v_cndmask_b32 v70, v70, 0, s[82:83]
    v_cndmask_b32 v71, v71, 0, s[82:83]
    v_mfma_f32_16x16x32_bf16 v[112:115], a[192:195], v[152:155], v[112:115]
    s_waitcnt lgkmcnt(2)
    v_mfma_f32_16x16x32_bf16 v[112:115], a[216:219], v[156:159], v[112:115]
    v_mfma_f32_16x16x32_bf16 v[72:75], v[52:55], v[68:71], 0
    v_mfma_f32_16x16x32_bf16 v[112:115], a[240:243], v[160:163], v[112:115]
    v_mfma_f32_16x16x32_bf16 v[76:79], v[56:59], v[68:71], 0
    v_mfma_f32_16x16x32_bf16 v[112:115], v[184:187], v[164:167], v[112:115]
    s_waitcnt lgkmcnt(0)
    v_mfma_f32_16x16x32_bf16 v[112:115], v[208:211], v[168:171], v[112:115]
    v_mfma_f32_16x16x32_bf16 v[112:115], v[232:235], v[172:175], v[112:115]
    v_mfma_f32_16x16x32_bf16 v[116:119], a[4:7], v[120:123], 0
    v_mfma_f32_16x16x32_bf16 v[116:119], a[28:31], v[124:127], v[116:119]
    v_cndmask_b32 v26, v72, v73, s[76:77]
    v_cndmask_b32 v27, v74, v75, s[76:77]
    v_mfma_f32_16x16x32_bf16 v[116:119], a[52:55], v[128:131], v[116:119]
    v_cndmask_b32 v28, v76, v77, s[76:77]
    v_cndmask_b32 v29, v78, v79, s[76:77]
    v_mfma_f32_16x16x32_bf16 v[116:119], a[76:79], v[132:135], v[116:119]
    v_cndmask_b32 v26, v26, v28, s[78:79]
    v_cndmask_b32 v27, v27, v29, s[80:81]
    v_mfma_f32_16x16x32_bf16 v[116:119], a[100:103], v[136:139], v[116:119]
    v_max_f32 v28, v26, v27
    v_mov_b32 v29, v28
    v_mfma_f32_16x16x32_bf16 v[116:119], a[124:127], v[140:143], v[116:119]
    v_mfma_f32_16x16x32_bf16 v[116:119], a[148:151], v[144:147], v[116:119]
    v_cvt_pk_bf16_f32 v64, v112, v113
    v_cvt_pk_bf16_f32 v65, v114, v115
    v_mfma_f32_16x16x32_bf16 v[116:119], a[172:175], v[148:151], v[116:119]
    v_permlane16_swap_b32 v28, v29
    v_max_f32 v28, v28, v29
    v_mfma_f32_16x16x32_bf16 v[116:119], a[196:199], v[152:155], v[116:119]
    v_mov_b32 v29, v28
    v_mfma_f32_16x16x32_bf16 v[116:119], a[220:223], v[156:159], v[116:119]
    v_mfma_f32_16x16x32_bf16 v[116:119], a[244:247], v[160:163], v[116:119]
    v_permlane32_swap_b32 v28, v29
    v_max_f32 v28, v28, v29
    v_mfma_f32_16x16x32_bf16 v[116:119], v[188:191], v[164:167], v[116:119]
    v_sub_f32 v26, v26, v28
    v_sub_f32 v27, v27, v28
    v_mfma_f32_16x16x32_bf16 v[116:119], v[212:215], v[168:171], v[116:119]
    v_mul_f32 v26, s91, v26
    v_mul_f32 v27, s91, v27
    v_mfma_f32_16x16x32_bf16 v[116:119], v[236:239], v[172:175], v[116:119]
    v_exp_f32 v26, v26
    v_mfma_f32_16x16x32_bf16 v[96:99], a[8:11], v[120:123], 0
    v_exp_f32 v27, v27
    v_mfma_f32_16x16x32_bf16 v[96:99], a[32:35], v[124:127], v[96:99]
    v_add_f32 v28, v26, v27
    v_mov_b32 v29, v28
    v_mfma_f32_16x16x32_bf16 v[96:99], a[56:59], v[128:131], v[96:99]
    v_mfma_f32_16x16x32_bf16 v[96:99], a[80:83], v[132:135], v[96:99]
    v_permlane16_swap_b32 v28, v29
    v_add_f32 v28, v28, v29
    v_mfma_f32_16x16x32_bf16 v[96:99], a[104:107], v[136:139], v[96:99]
    v_mov_b32 v29, v28
    v_mfma_f32_16x16x32_bf16 v[96:99], a[128:131], v[140:143], v[96:99]
    v_mfma_f32_16x16x32_bf16 v[96:99], a[152:155], v[144:147], v[96:99]
    v_cvt_pk_bf16_f32 v66, v116, v117
    v_cvt_pk_bf16_f32 v67, v118, v119
    v_mfma_f32_16x16x32_bf16 v[96:99], a[176:179], v[148:151], v[96:99]
    v_cndmask_b32 v66, v66, 0, s[82:83]
    v_cndmask_b32 v67, v67, 0, s[82:83]
    v_mfma_f32_16x16x32_bf16 v[96:99], a[200:203], v[152:155], v[96:99]
    v_permlane32_swap_b32 v28, v29
    v_add_f32 v28, v28, v29
    v_mfma_f32_16x16x32_bf16 v[96:99], a[224:227], v[156:159], v[96:99]
    v_rcp_f32 v28, v28
    v_mfma_f32_16x16x32_bf16 v[96:99], a[248:251], v[160:163], v[96:99]
    v_mul_f32 v26, v26, v28
    v_mul_f32 v27, v27, v28
    v_mfma_f32_16x16x32_bf16 v[96:99], v[192:195], v[164:167], v[96:99]
    v_cvt_pk_bf16_f32 v26, v26, v26
    v_cvt_pk_bf16_f32 v27, v27, v27
    v_mfma_f32_16x16x32_bf16 v[96:99], v[216:219], v[168:171], v[96:99]
    v_and_b32 v80, v26, v14
    v_and_b32 v81, v27, v15
    v_mfma_f32_16x16x32_bf16 v[96:99], v[240:243], v[172:175], v[96:99]
    v_and_b32 v82, v26, v16
    v_and_b32 v83, v27, v17
    v_mfma_f32_16x16x32_bf16 v[100:103], a[12:15], v[120:123], 0
    v_mfma_f32_16x16x32_bf16 v[100:103], a[36:39], v[124:127], v[100:103]
    v_mfma_f32_16x16x32_bf16 v[72:75], v[36:39], v[80:83], 0
    v_mfma_f32_16x16x32_bf16 v[100:103], a[60:63], v[128:131], v[100:103]
    v_mfma_f32_16x16x32_bf16 v[76:79], v[46:49], v[80:83], 0
    v_mfma_f32_16x16x32_bf16 v[100:103], a[84:87], v[132:135], v[100:103]
    s_add_u32 s53, s74, 98304
    v_mfma_f32_16x16x32_bf16 v[100:103], a[108:111], v[136:139], v[100:103]
    v_mfma_f32_16x16x32_bf16 v[100:103], a[132:135], v[140:143], v[100:103]
    v_mfma_f32_16x16x32_bf16 v[100:103], a[156:159], v[144:147], v[100:103]
    v_cvt_pk_bf16_f32 v60, v96, v97
    v_cvt_pk_bf16_f32 v61, v98, v99
    v_mfma_f32_16x16x32_bf16 v[100:103], a[180:183], v[148:151], v[100:103]
    v_mfma_f32_16x16x32_bf16 v[100:103], a[204:207], v[152:155], v[100:103]
    v_cvt_pk_bf16_f32 v84, v72, v73
    v_cvt_pk_bf16_f32 v85, v74, v75
    v_mfma_f32_16x16x32_bf16 v[100:103], a[228:231], v[156:159], v[100:103]
    v_cvt_pk_bf16_f32 v86, v76, v77
    v_cvt_pk_bf16_f32 v87, v78, v79
    v_mfma_f32_16x16x32_bf16 v[100:103], a[252:255], v[160:163], v[100:103]
    v_cndmask_b32 v86, v86, 0, s[82:83]
    v_cndmask_b32 v87, v87, 0, s[82:83]
    v_mfma_f32_16x16x32_bf16 v[100:103], v[196:199], v[164:167], v[100:103]
    buffer_store_dwordx4 v[84:87], v23, s[24:27], s53 offen sc1
    v_mfma_f32_16x16x32_bf16 v[100:103], v[220:223], v[168:171], v[100:103]
    v_mfma_f32_16x16x32_bf16 v[100:103], v[244:247], v[172:175], v[100:103]
    v_mfma_f32_16x16x32_bf16 v[104:107], v[120:123], a[16:19], 0
    v_mfma_f32_16x16x32_bf16 v[104:107], v[124:127], a[40:43], v[104:107]
    v_mfma_f32_16x16x32_bf16 v[104:107], v[128:131], a[64:67], v[104:107]
    v_mfma_f32_16x16x32_bf16 v[104:107], v[132:135], a[88:91], v[104:107]
    v_mfma_f32_16x16x32_bf16 v[104:107], v[136:139], a[112:115], v[104:107]
    v_mfma_f32_16x16x32_bf16 v[104:107], v[140:143], a[136:139], v[104:107]
    v_mfma_f32_16x16x32_bf16 v[104:107], v[144:147], a[160:163], v[104:107]
    s_nop 0
    v_cvt_pk_bf16_f32 v62, v100, v101
    v_cvt_pk_bf16_f32 v63, v102, v103
    v_mfma_f32_16x16x32_bf16 v[104:107], v[148:151], a[184:187], v[104:107]
    v_cndmask_b32 v62, v62, 0, s[82:83]
    v_cndmask_b32 v63, v63, 0, s[82:83]
    v_mfma_f32_16x16x32_bf16 v[104:107], v[152:155], a[208:211], v[104:107]
    v_mfma_f32_16x16x32_bf16 v[104:107], v[156:159], a[232:235], v[104:107]
    v_mfma_f32_16x16x32_bf16 v[72:75], v[56:59], v[64:67], 0
    v_mfma_f32_16x16x32_bf16 v[104:107], v[160:163], v[176:179], v[104:107]
    v_mfma_f32_16x16x32_bf16 v[76:79], v[60:63], v[64:67], 0
    v_mfma_f32_16x16x32_bf16 v[104:107], v[164:167], v[200:203], v[104:107]
    v_mfma_f32_16x16x32_bf16 v[104:107], v[168:171], v[224:227], v[104:107]
    v_mfma_f32_16x16x32_bf16 v[104:107], v[172:175], v[248:251], v[104:107]
    v_mfma_f32_16x16x32_bf16 v[108:111], v[120:123], a[20:23], 0
    v_mfma_f32_16x16x32_bf16 v[108:111], v[124:127], a[44:47], v[108:111]
    s_nop 0
    v_cndmask_b32 v26, v72, v73, s[76:77]
    v_cndmask_b32 v27, v74, v75, s[76:77]
    v_mfma_f32_16x16x32_bf16 v[108:111], v[128:131], a[68:71], v[108:111]
    v_cndmask_b32 v28, v76, v77, s[76:77]
    v_cndmask_b32 v29, v78, v79, s[76:77]
    v_mfma_f32_16x16x32_bf16 v[108:111], v[132:135], a[92:95], v[108:111]
    v_cndmask_b32 v26, v26, v28, s[78:79]
    v_cndmask_b32 v27, v27, v29, s[80:81]
    v_mfma_f32_16x16x32_bf16 v[108:111], v[136:139], a[116:119], v[108:111]
    v_max_f32 v28, v26, v27
    v_mov_b32 v29, v28
    v_mfma_f32_16x16x32_bf16 v[108:111], v[140:143], a[140:143], v[108:111]
    v_mfma_f32_16x16x32_bf16 v[108:111], v[144:147], a[164:167], v[108:111]
    v_cvt_pk_bf16_f32 v40, v104, v105
    v_cvt_pk_bf16_f32 v41, v106, v107
    v_mfma_f32_16x16x32_bf16 v[108:111], v[148:151], a[188:191], v[108:111]
    v_permlane16_swap_b32 v28, v29
    v_max_f32 v28, v28, v29
    v_mfma_f32_16x16x32_bf16 v[108:111], v[152:155], a[212:215], v[108:111]
    v_mov_b32 v29, v28
    v_mfma_f32_16x16x32_bf16 v[108:111], v[156:159], a[236:239], v[108:111]
    v_mfma_f32_16x16x32_bf16 v[108:111], v[160:163], v[180:183], v[108:111]
    v_permlane32_swap_b32 v28, v29
    v_max_f32 v28, v28, v29
    v_mfma_f32_16x16x32_bf16 v[108:111], v[164:167], v[204:207], v[108:111]
    v_sub_f32 v26, v26, v28
    v_sub_f32 v27, v27, v28
    v_mfma_f32_16x16x32_bf16 v[108:111], v[168:171], v[228:231], v[108:111]
    v_mul_f32 v26, s91, v26
    v_mul_f32 v27, s91, v27
    v_mfma_f32_16x16x32_bf16 v[108:111], v[172:175], v[252:255], v[108:111]
    v_exp_f32 v26, v26
    s_nop 6
    v_cvt_pk_bf16_f32 v50, v108, v109
    v_cvt_pk_bf16_f32 v51, v110, v111
    v_exp_f32 v27, v27
    s_nop 0
    v_add_f32 v28, v26, v27
    v_mov_b32 v29, v28
    s_nop 1
    v_permlane16_swap_b32 v28, v29
    v_add_f32 v28, v28, v29
    v_mov_b32 v29, v28
    s_nop 1
    v_permlane32_swap_b32 v28, v29
    v_add_f32 v28, v28, v29
    v_rcp_f32 v28, v28
    s_nop 0
    v_mul_f32 v26, v26, v28
    v_mul_f32 v27, v27, v28
    v_cvt_pk_bf16_f32 v26, v26, v26
    v_cvt_pk_bf16_f32 v27, v27, v27
    v_and_b32 v80, v26, v14
    v_and_b32 v81, v27, v15
    v_and_b32 v82, v26, v16
    v_and_b32 v83, v27, v17
    s_nop 1
    v_mfma_f32_16x16x32_bf16 v[72:75], v[38:41], v[80:83], 0
    v_mfma_f32_16x16x32_bf16 v[76:79], v[48:51], v[80:83], 0
    s_add_u32 s53, s74, 114688
    s_nop 5
    v_cvt_pk_bf16_f32 v84, v72, v73
    v_cvt_pk_bf16_f32 v85, v74, v75
    v_cvt_pk_bf16_f32 v86, v76, v77
    v_cvt_pk_bf16_f32 v87, v78, v79
    v_cndmask_b32 v86, v86, 0, s[82:83]
    v_cndmask_b32 v87, v87, 0, s[82:83]
    buffer_store_dwordx4 v[84:87], v23, s[24:27], s53 offen sc1
    s_waitcnt vmcnt(0) lgkmcnt(0)
    s_barrier
    s_cmp_lg_u32 s44, 0
    s_cbranch_scc1 L_nopub16
    s_lshl_b32 s60, s48, 4
    s_add_u32 s60, s60, s49
    s_lshl_b32 s60, s60, 7
    s_add_u32 s60, s60, 12779520
    v_mov_b32 v30, s47
    s_mov_b64 exec, 1
    buffer_store_dword v30, off, s[24:27], s60 sc1
    s_mov_b64 exec, -1
L_nopub16:
    s_endpgm
L_codeend:
.section .rodata,"a"
.p2align 6
.amdhsa_kernel parallel_sum__sliding_local_dilated__mixer_token_mlp__prompt_kernel
  .amdhsa_next_free_vgpr 512
  .amdhsa_next_free_sgpr 102
  .amdhsa_accum_offset 256
  .amdhsa_group_segment_fixed_size 0
  .amdhsa_kernarg_size 88
  .amdhsa_user_sgpr_count 2
  .amdhsa_user_sgpr_kernarg_segment_ptr 1
  .amdhsa_system_sgpr_workgroup_id_x 1
  .amdhsa_float_denorm_mode_32 3
.end_amdhsa_kernel
```

```asm
; @launch grid=(256,1,1) block=(256,1,1) lds=163840
.amdgcn_target "amdgcn-amd-amdhsa--gfx950"
.text
.globl parallel_sum__sliding_local_dilated__mixer_token_mlp__prompt_kernel
.p2align 8
.type parallel_sum__sliding_local_dilated__mixer_token_mlp__prompt_kernel,@function
parallel_sum__sliding_local_dilated__mixer_token_mlp__prompt_kernel:
    s_cmp_ge_u32 s2, 256
    s_cbranch_scc1 L_end
    s_load_dwordx2 s[4:5], s[0:1], 0
    s_load_dwordx16 s[76:91], s[0:1], 0
    s_load_dwordx4 s[92:95], s[0:1], 64
    s_load_dwordx2 s[24:25], s[0:1], 80
    s_lshr_b32 s46, s2, 3
    s_getpc_b64 s[98:99]
L_pc:
    s_mul_i32 s53, s46, 1408
    v_lshrrev_b32 v26, 4, v0
    v_min_u32 v26, 10, v26
    v_lshl_add_u32 v26, v26, 7, s53
    v_lshrrev_b32 v25, 5, v0
    v_min_u32 v26, L_codeend-L_pc-4, v26
    v_mov_b32 v29, s99
    v_add_co_u32 v28, vcc, s98, v26
    s_nop 1
    v_addc_co_u32 v29, vcc, 0, v29, vcc
    global_load_dword v108, v[28:29], off
    v_and_b32 v26, 31, v0
    v_mul_u32_u24 v24, 896, v25
    v_lshl_add_u32 v24, v26, 4, v24
    s_mul_i32 s53, s2, 7168
    v_add_u32 v24, s53, v24
    v_cmp_gt_u32 vcc, 28, v26
    v_mov_b32 v27, 2130706432
    s_mov_b32 s6, 1835008
    s_mov_b32 s7, 0x20000
    v_cndmask_b32 v24, v27, v24, vcc
    v_lshrrev_b32 v27, 6, v0
    v_and_b32 v1, 63, v0
    s_waitcnt lgkmcnt(0)
    buffer_load_dwordx4 v[32:35], v24, s[4:7], 0 offen
    buffer_load_dwordx4 v[36:39], v24, s[4:7], 0 offen offset:448
    v_readfirstlane_b32 s44, v27
    s_and_b32 s45, s2, 7
    s_mov_b64 s[8:9], s[78:79]
    s_mov_b32 s10, 1204224
    s_mov_b32 s11, s7
    s_lshr_b32 s53, s45, 1
    s_add_u32 s54, s53, 1
    s_bfe_u32 s54, s54, 0x10001
    s_add_u32 s54, s54, 1
    s_mul_i32 s53, s53, 224
    s_andn2_b32 s53, s53, 127
    s_mul_i32 s55, s46, 43008
    s_add_u32 s53, s53, s55
    v_and_b32 v27, 3, v0
    v_min_u32 v27, s54, v27
    v_bfe_u32 v28, v0, 2, 2
    v_min_u32 v28, 2, v28
    v_mul_u32_u24 v28, 7, v28
    v_add_u32 v27, v27, v28
    v_lshrrev_b32 v28, 4, v0
    v_min_u32 v28, 15, v28
    v_mul_u32_u24 v28, 21, v28
    v_add_lshl_u32 v27, v27, v28, 7
    buffer_load_dword v108, v27, s[8:11], s53 offen
    s_mov_b64 s[40:41], s[94:95]
    s_mov_b32 s42, 256
    s_mov_b32 s43, s7
    s_or_b32 s53, s2, s44
    s_cbranch_scc1 L_nononce
    s_memrealtime s[98:99]
    s_waitcnt lgkmcnt(0)
    s_or_b32 s98, s98, 1
    v_mov_b32 v28, s98
    s_mov_b64 exec, 1
    buffer_store_dword v28, off, s[40:43], 0 sc1
    s_mov_b64 exec, -1
L_nononce:
    s_mov_b64 s[16:17], s[84:85]
    s_mov_b32 s18, 7340032
    s_mov_b32 s19, s7
    s_mov_b32 s26, 16777216
    s_mov_b32 s27, s7
    s_mov_b64 s[20:21], s[88:89]
    s_mov_b32 s22, 7340032
    s_mov_b32 s23, s7
    s_mov_b64 s[12:13], s[80:81]
    s_mov_b32 s14, 401408
    s_mov_b32 s15, s7
    v_lshrrev_b32 v27, 4, v0
    v_min_u32 v27, 12, v27
    v_lshlrev_b32 v27, 7, v27
    s_mul_i32 s53, s2, 1664
    buffer_load_dword v108, v27, s[12:15], s53 offen
    s_mov_b64 s[28:29], s[92:93]
    s_mov_b32 s30, 1835008
    s_mov_b32 s31, s7
    s_mov_b64 s[32:33], s[86:87]
    s_mov_b32 s34, 3584
    s_mov_b32 s35, s7
    s_mov_b64 s[36:37], s[90:91]
    s_mov_b32 s38, 4096
    s_mov_b32 s39, s7
    s_lshl_b32 s52, s44, 12
    v_lshlrev_b32 v23, 4, v1
    s_cmp_ge_u32 s46, 24
    s_cbranch_scc1 L_role_a
    v_lshrrev_b32 v208, 4, v1
    v_bfe_u32 v209, v1, 2, 2
    v_and_b32 v210, 3, v1
    v_and_b32 v211, 15, v1
    v_lshrrev_b32 v212, 5, v1
    s_mul_i32 s55, s45, 0
    s_max_u32 s55, s55, 1
    s_add_u32 s55, s55, s46
    s_sub_u32 s55, s55, 1
    s_sub_u32 s56, s55, 21
    s_min_u32 s55, s55, s56
    s_and_b32 s54, s45, 1
    s_mul_i32 s54, s54, 24
    s_sub_u32 s54, s46, s54
    s_cmp_ge_u32 s46, 21
    s_cselect_b32 s54, s54, s55
    s_mul_i32 s53, s45, 21
    s_add_u32 s53, s53, s54
    s_mul_i32 s50, s53, 171
    s_lshr_b32 s50, s50, 10
    s_mul_i32 s54, s50, 6
    s_sub_u32 s51, s53, s54
    s_lshl3_add_u32 s65, s51, 1
    s_mul_i32 s65, s65, 43
    s_lshr_b32 s65, s65, 7
    v_lshl_add_u32 v213, v212, 2, v209
    v_and_b32 v215, 1, v208
    v_lshlrev_b32 v214, 4, v210
    v_lshl_add_u32 v214, v215, 6, v214
    s_mul_i32 s53, s44, 1835008
    s_lshl_b32 s54, s50, 7
    s_add_u32 s53, s53, s54
    v_mul_u32_u24 v10, 3584, v213
    v_add3_u32 v10, v10, v214, s53
    v_xor_b32 v11, 32, v10
    s_add_u32 m0, s52, 49152
    s_add_u32 s57, s65, 0
    s_and_b32 s57, s57, 15
    s_mul_i32 s57, s57, 114688
    buffer_load_dwordx4 v10, s[16:19], s57 offen offset:0 lds
    s_add_u32 s57, s57, 27648
    buffer_load_dwordx4 v11, s[16:19], s57 offen offset:1024 lds
    v_mul_u32_u24 v109, 960, v25
    v_lshl_add_u32 v109, v26, 4, v109
    v_mul_u32_u24 v110, 960, v209
    v_lshl_add_u32 v110, v208, 5, v110
    v_lshl_add_u32 v110, v210, 3, v110
    s_lshl_b32 s53, s44, 7
    v_add_u32 v110, s53, v110
    v_mul_u32_u24 v111, 66816, v208
    v_lshl_add_u32 v111, v211, 4, v111
    s_mul_i32 s63, s44, 267264
    s_lshl_b32 s53, s2, 8
    s_add_u32 s63, s63, s53
    s_add_u32 s64, s63, 1069056
    s_cmp_eq_u32 s44, 3
    s_cselect_b32 s64, 2130706432, s64
    s_mov_b32 s62, 0x3f803f80
    s_mov_b32 s61, 0xffff0000
    s_mov_b32 s66, 6291456
    v_mov_b32 v96, 0
    v_mov_b32 v97, 0
    v_lshlrev_b32 v216, 6, v209
    v_lshl_add_u32 v216, v210, 3, v216
    v_lshl_add_u32 v216, v215, 5, v216
    s_add_u32 s53, s52, 49152
    v_lshl_add_u32 v2, v208, 10, v216
    v_add_u32 v2, s53, v2
    v_xor_b32 v3, 32, v2
    v_add_u32 v4, 65536, v2
    v_add_u32 v5, 65536, v3
    v_lshl_add_u32 v6, v208, 9, v216
    v_add_u32 v6, s53, v6
    v_xor_b32 v7, 32, v6
    v_add_u32 v8, 65536, v6
    v_add_u32 v9, 65536, v7
    s_waitcnt vmcnt(5)
    v_dot2c_f32_bf16 v96, s62, v32
    v_dot2c_f32_bf16 v97, v32, v32
    v_lshlrev_b32 v40, 16, v32
    v_and_b32 v41, s61, v32
    v_dot2c_f32_bf16 v96, s62, v33
    v_dot2c_f32_bf16 v97, v33, v33
    v_lshlrev_b32 v42, 16, v33
    v_and_b32 v43, s61, v33
    v_dot2c_f32_bf16 v96, s62, v34
    v_dot2c_f32_bf16 v97, v34, v34
    v_lshlrev_b32 v44, 16, v34
    v_and_b32 v45, s61, v34
    v_dot2c_f32_bf16 v96, s62, v35
    v_dot2c_f32_bf16 v97, v35, v35
    v_lshlrev_b32 v46, 16, v35
    v_and_b32 v47, s61, v35
    s_waitcnt vmcnt(4)
    v_dot2c_f32_bf16 v96, s62, v36
    v_dot2c_f32_bf16 v97, v36, v36
    v_lshlrev_b32 v48, 16, v36
    v_and_b32 v49, s61, v36
    v_dot2c_f32_bf16 v96, s62, v37
    v_dot2c_f32_bf16 v97, v37, v37
    v_lshlrev_b32 v50, 16, v37
    v_and_b32 v51, s61, v37
    v_dot2c_f32_bf16 v96, s62, v38
    v_dot2c_f32_bf16 v97, v38, v38
    v_lshlrev_b32 v52, 16, v38
    v_and_b32 v53, s61, v38
    v_dot2c_f32_bf16 v96, s62, v39
    v_dot2c_f32_bf16 v97, v39, v39
    v_lshlrev_b32 v54, 16, v39
    v_and_b32 v55, s61, v39
    buffer_load_dword v29, off, s[40:43], 0 sc1
    v_add_f32_dpp v96, v96, v96 quad_perm:[1,0,3,2] row_mask:0xf bank_mask:0xf
    v_add_f32_dpp v97, v97, v97 quad_perm:[1,0,3,2] row_mask:0xf bank_mask:0xf
    s_nop 0
    v_add_f32_dpp v96, v96, v96 quad_perm:[2,3,0,1] row_mask:0xf bank_mask:0xf
    v_add_f32_dpp v97, v97, v97 quad_perm:[2,3,0,1] row_mask:0xf bank_mask:0xf
    s_nop 0
    v_add_f32_dpp v96, v96, v96 row_half_mirror row_mask:0xf bank_mask:0xf
    v_add_f32_dpp v97, v97, v97 row_half_mirror row_mask:0xf bank_mask:0xf
    s_nop 0
    v_add_f32_dpp v96, v96, v96 row_mirror row_mask:0xf bank_mask:0xf
    v_add_f32_dpp v97, v97, v97 row_mirror row_mask:0xf bank_mask:0xf
    v_mov_b32 v98, v96
    v_mov_b32 v99, v97
    s_nop 0
    v_permlane16_swap_b32 v96, v98
    v_permlane16_swap_b32 v97, v99
    v_add_f32 v96, v96, v98
    v_add_f32 v97, v97, v99
    v_mul_f32 v98, 0x3b124925, v96
    v_mul_f32 v99, 0x3b124925, v97
    v_fma_f32 v99, -v98, v98, v99
    v_max_f32 v99, 0, v99
    v_cvt_pk_bf16_f32 v100, 0, v99
    v_add_f32 v100, 0x3727c5ac, v100
    v_cvt_pk_bf16_f32 v100, 0, v100
    v_sqrt_f32 v100, v100
    s_nop 0
    v_cvt_pk_bf16_f32 v100, 0, v100
    v_rcp_f32 v100, v100
    s_nop 0
    v_mul_f32 v99, v99, v100
    v_mul_f32 v102, v98, v100
    v_mul_f32 v99, v99, v100
    v_cvt_pk_bf16_f32 v104, 0, v99
    v_add_f32 v104, 0x3727c5ac, v104
    v_cvt_pk_bf16_f32 v104, 0, v104
    v_sqrt_f32 v104, v104
    s_nop 0
    v_cvt_pk_bf16_f32 v104, 0, v104
    v_rcp_f32 v104, v104
    s_nop 0
    v_mul_f32 v104, v104, v100
    v_mul_f32 v106, v98, v104
    v_pk_fma_f32 v[56:57], v[40:41], v[104:105], v[106:107] op_sel_hi:[1,0,0] neg_lo:[0,0,1] neg_hi:[0,0,1]
    v_pk_fma_f32 v[58:59], v[42:43], v[104:105], v[106:107] op_sel_hi:[1,0,0] neg_lo:[0,0,1] neg_hi:[0,0,1]
    v_pk_fma_f32 v[60:61], v[44:45], v[104:105], v[106:107] op_sel_hi:[1,0,0] neg_lo:[0,0,1] neg_hi:[0,0,1]
    v_pk_fma_f32 v[62:63], v[46:47], v[104:105], v[106:107] op_sel_hi:[1,0,0] neg_lo:[0,0,1] neg_hi:[0,0,1]
    v_pk_fma_f32 v[64:65], v[48:49], v[104:105], v[106:107] op_sel_hi:[1,0,0] neg_lo:[0,0,1] neg_hi:[0,0,1]
    v_pk_fma_f32 v[66:67], v[50:51], v[104:105], v[106:107] op_sel_hi:[1,0,0] neg_lo:[0,0,1] neg_hi:[0,0,1]
    v_pk_fma_f32 v[68:69], v[52:53], v[104:105], v[106:107] op_sel_hi:[1,0,0] neg_lo:[0,0,1] neg_hi:[0,0,1]
    v_pk_fma_f32 v[70:71], v[54:55], v[104:105], v[106:107] op_sel_hi:[1,0,0] neg_lo:[0,0,1] neg_hi:[0,0,1]
    v_cvt_pk_bf16_f32 v80, v56, v57
    v_cvt_pk_bf16_f32 v81, v58, v59
    v_cvt_pk_bf16_f32 v82, v60, v61
    v_cvt_pk_bf16_f32 v83, v62, v63
    v_cvt_pk_bf16_f32 v84, v64, v65
    v_cvt_pk_bf16_f32 v85, v66, v67
    v_cvt_pk_bf16_f32 v86, v68, v69
    v_cvt_pk_bf16_f32 v87, v70, v71
    ds_write_b128 v109, v[80:83] offset:0
    ds_write_b128 v109, v[84:87] offset:448
    v_pk_fma_f32 v[40:41], v[40:41], v[100:101], v[102:103] op_sel_hi:[1,0,0] neg_lo:[0,0,1] neg_hi:[0,0,1]
    v_pk_fma_f32 v[42:43], v[42:43], v[100:101], v[102:103] op_sel_hi:[1,0,0] neg_lo:[0,0,1] neg_hi:[0,0,1]
    v_pk_fma_f32 v[44:45], v[44:45], v[100:101], v[102:103] op_sel_hi:[1,0,0] neg_lo:[0,0,1] neg_hi:[0,0,1]
    v_pk_fma_f32 v[46:47], v[46:47], v[100:101], v[102:103] op_sel_hi:[1,0,0] neg_lo:[0,0,1] neg_hi:[0,0,1]
    v_pk_fma_f32 v[48:49], v[48:49], v[100:101], v[102:103] op_sel_hi:[1,0,0] neg_lo:[0,0,1] neg_hi:[0,0,1]
    v_pk_fma_f32 v[50:51], v[50:51], v[100:101], v[102:103] op_sel_hi:[1,0,0] neg_lo:[0,0,1] neg_hi:[0,0,1]
    v_pk_fma_f32 v[52:53], v[52:53], v[100:101], v[102:103] op_sel_hi:[1,0,0] neg_lo:[0,0,1] neg_hi:[0,0,1]
    v_pk_fma_f32 v[54:55], v[54:55], v[100:101], v[102:103] op_sel_hi:[1,0,0] neg_lo:[0,0,1] neg_hi:[0,0,1]
    v_cvt_pk_bf16_f32 v72, v40, v41
    v_cvt_pk_bf16_f32 v73, v42, v43
    v_cvt_pk_bf16_f32 v74, v44, v45
    v_cvt_pk_bf16_f32 v75, v46, v47
    v_cvt_pk_bf16_f32 v76, v48, v49
    v_cvt_pk_bf16_f32 v77, v50, v51
    v_cvt_pk_bf16_f32 v78, v52, v53
    v_cvt_pk_bf16_f32 v79, v54, v55
    s_waitcnt lgkmcnt(0)
    s_barrier
    ds_read_b64_tr_b16 v[88:89], v110 offset:0
    ds_read_b64_tr_b16 v[90:91], v110 offset:3840
    ds_read_b64_tr_b16 v[92:93], v110 offset:512
    ds_read_b64_tr_b16 v[94:95], v110 offset:4352
    buffer_store_dwordx4 v[72:75], v24, s[24:27], s66 offen offset:0 sc1
    buffer_store_dwordx4 v[76:79], v24, s[24:27], s66 offen offset:448 sc1
    s_waitcnt lgkmcnt(2)
    buffer_store_dwordx4 v[88:91], v111, s[24:27], s63 offen sc1
    s_waitcnt lgkmcnt(0)
    buffer_store_dwordx4 v[92:95], v111, s[24:27], s64 offen sc1
    s_add_u32 s57, s57, 27648
    buffer_load_dwordx4 v10, s[16:19], s57 offen offset:2048 lds
    s_add_u32 s57, s57, 27648
    buffer_load_dwordx4 v11, s[16:19], s57 offen offset:3072 lds
    s_add_u32 m0, s52, 65536
    s_add_u32 s57, s65, 1
    s_and_b32 s57, s57, 15
    s_mul_i32 s57, s57, 114688
    buffer_load_dwordx4 v10, s[16:19], s57 offen offset:0 lds
    s_add_u32 s57, s57, 27648
    buffer_load_dwordx4 v11, s[16:19], s57 offen offset:1024 lds
    s_add_u32 s57, s57, 27648
    buffer_load_dwordx4 v10, s[16:19], s57 offen offset:2048 lds
    s_add_u32 s57, s57, 27648
    buffer_load_dwordx4 v11, s[16:19], s57 offen offset:3072 lds
    s_add_u32 m0, s52, 81920
    s_add_u32 s57, s65, 2
    s_and_b32 s57, s57, 15
    s_mul_i32 s57, s57, 114688
    buffer_load_dwordx4 v10, s[16:19], s57 offen offset:0 lds
    s_add_u32 s57, s57, 27648
    buffer_load_dwordx4 v11, s[16:19], s57 offen offset:1024 lds
    s_add_u32 s57, s57, 27648
    buffer_load_dwordx4 v10, s[16:19], s57 offen offset:2048 lds
    s_add_u32 s57, s57, 27648
    buffer_load_dwordx4 v11, s[16:19], s57 offen offset:3072 lds
    s_waitcnt vmcnt(10)
    v_cmp_eq_u32 vcc, 0, v29
    s_nop 0
    s_cbranch_vccz L_ok2
    s_mov_b32 s59, 20000
L_spin1:
    s_sleep 2
    buffer_load_dword v29, off, s[40:43], 0 sc1
    s_waitcnt vmcnt(0)
    v_cmp_eq_u32 vcc, 0, v29
    s_nop 0
    s_cbranch_vccz L_ok2
    s_sub_u32 s59, s59, 1
    s_cbranch_scc0 L_spin1
L_ok2:
    v_readfirstlane_b32 s47, v29
    s_barrier
    s_cmp_lg_u32 s44, 0
    s_cbranch_scc1 L_nopub3
    s_lshl_b32 s60, s2, 5
    s_add_u32 s60, s60, 12582912
    v_mov_b32 v30, s47
    s_mov_b64 exec, 1
    buffer_store_dword v30, off, s[24:27], s60 sc1
    s_mov_b64 exec, -1
L_nopub3:
    s_cmp_ge_u32 s46, 21
    s_cbranch_scc1 L_help
    s_lshl_b32 s53, s44, 11
    s_add_u32 s53, s53, 12582912
    v_lshl_add_u32 v18, v1, 5, s53
    s_lshl_b32 s53, s50, 7
    s_add_u32 m0, s52, 98304
    s_add_u32 s57, s65, 3
    s_and_b32 s57, s57, 15
    s_mul_i32 s57, s57, 114688
    buffer_load_dwordx4 v10, s[16:19], s57 offen offset:0 lds
    v_lshl_add_u32 v19, v208, 3, s53
    s_lshl2_add_u32 s67, s51, s44
    s_mul_i32 s67, s67, 58624
    s_lshl_b32 s53, s50, 11
    s_add_u32 s57, s57, 27648
    buffer_load_dwordx4 v11, s[16:19], s57 offen offset:1024 lds
    s_waitcnt vmcnt(10)
    ds_read_b64_tr_b16 a[0:1], v2 offset:0
    ds_read_b64_tr_b16 a[2:3], v2 offset:512
    ds_read_b64_tr_b16 a[4:5], v3 offset:0
    ds_read_b64_tr_b16 a[6:7], v3 offset:512
    s_add_u32 s57, s57, 27648
    buffer_load_dwordx4 v10, s[16:19], s57 offen offset:2048 lds
    ds_read_b64_tr_b16 a[8:9], v2 offset:256
    ds_read_b64_tr_b16 a[10:11], v2 offset:768
    ds_read_b64_tr_b16 a[12:13], v3 offset:256
    ds_read_b64_tr_b16 a[14:15], v3 offset:768
    s_add_u32 s67, s67, s53
    s_add_u32 s67, s67, 2097152
    v_add_u32 v232, s52, v23
    v_xor_b32 v233, 4096, v232
    s_add_u32 s57, s57, 27648
    buffer_load_dwordx4 v11, s[16:19], s57 offen offset:3072 lds
    v_xor_b32 v234, 8192, v232
    v_xor_b32 v235, 12288, v232
    v_mov_b32 v236, 0xbdd2d3e8
    v_mov_b32 v237, 0xc0135761
    s_add_u32 m0, s52, 114688
    s_add_u32 s57, s65, 4
    s_and_b32 s57, s57, 15
    s_mul_i32 s57, s57, 114688
    buffer_load_dwordx4 v10, s[16:19], s57 offen offset:0 lds
    s_mul_i32 s88, s50, 4
    s_add_u32 s88, s88, s51
    s_mul_i32 s54, s88, 171
    s_lshr_b32 s54, s54, 10
    s_add_u32 s57, s57, 27648
    buffer_load_dwordx4 v11, s[16:19], s57 offen offset:1024 lds
    s_waitcnt vmcnt(10)
    ds_read_b64_tr_b16 a[16:17], v2 offset:16384
    ds_read_b64_tr_b16 a[18:19], v2 offset:16896
    ds_read_b64_tr_b16 a[20:21], v3 offset:16384
    ds_read_b64_tr_b16 a[22:23], v3 offset:16896
    s_mul_i32 s54, s54, 6
    s_sub_u32 s88, s88, s54
    s_add_u32 s54, s88, 24
    s_mul_i32 s84, s54, 66816
    ds_read_b64_tr_b16 a[24:25], v2 offset:16640
    ds_read_b64_tr_b16 a[26:27], v2 offset:17152
    ds_read_b64_tr_b16 a[28:29], v3 offset:16640
    ds_read_b64_tr_b16 a[30:31], v3 offset:17152
    s_add_u32 s57, s57, 27648
    buffer_load_dwordx4 v10, s[16:19], s57 offen offset:2048 lds
    s_lshl2_add_u32 s84, s52, s84
    s_mul_i32 s83, s54, 58624
    s_add_u32 s83, s83, s53
    s_and_b32 s54, s44, 1
    s_add_u32 s57, s57, 27648
    buffer_load_dwordx4 v11, s[16:19], s57 offen offset:3072 lds
    s_lshl_b32 s54, s54, 10
    s_add_u32 s83, s83, s54
    s_add_u32 s83, s83, 2097152
    s_lshl1_add_u32 s54, s54, 49152
    s_add_u32 m0, s52, 131072
    s_add_u32 s57, s65, 5
    s_and_b32 s57, s57, 15
    s_mul_i32 s57, s57, 114688
    buffer_load_dwordx4 v10, s[16:19], s57 offen offset:0 lds
    v_add_u32 v243, s54, v23
    s_cmp_lt_u32 s88, 4
    s_cselect_b32 s84, s84, 2130706432
    s_cselect_b32 s83, s83, 2130706432
    s_cmp_lt_u32 s44, 2
    s_cselect_b32 s83, s83, 2130706432
    s_cmp_eq_u32 s44, 0
    s_cselect_b32 s85, 1.0, 0
    s_mul_i32 s53, s45, 7
    s_lshr_b32 s53, s53, 1
    s_sub_u32 s53, s50, s53
    s_lshl1_add_u32 s53, s53, s88
    s_sub_u32 s53, s53, 4
    s_mul_i32 s54, s44, 28
    s_add_u32 s54, s54, s53
    s_lshl_b32 s87, s54, 16
    s_lshl_b32 s54, s45, 9
    s_add_u32 s87, s87, s54
    s_cmp_ge_u32 s88, 4
    s_cselect_b32 s87, s87, 2130706432
    v_lshrrev_b32 v254, 2, v1
    v_lshlrev_b32 v254, 12, v254
    v_lshl_add_u32 v254, v210, 7, v254
    s_add_u32 s57, s57, 27648
    buffer_load_dwordx4 v11, s[16:19], s57 offen offset:1024 lds
    s_waitcnt vmcnt(10)
    ds_read_b64_tr_b16 a[32:33], v2 offset:32768
    ds_read_b64_tr_b16 a[34:35], v2 offset:33280
    ds_read_b64_tr_b16 a[36:37], v3 offset:32768
    ds_read_b64_tr_b16 a[38:39], v3 offset:33280
    s_add_u32 s57, s57, 27648
    buffer_load_dwordx4 v10, s[16:19], s57 offen offset:2048 lds
    ds_read_b64_tr_b16 a[40:41], v2 offset:33024
    ds_read_b64_tr_b16 a[42:43], v2 offset:33536
    ds_read_b64_tr_b16 a[44:45], v3 offset:33024
    ds_read_b64_tr_b16 a[46:47], v3 offset:33536
    s_add_u32 s57, s57, 27648
    buffer_load_dwordx4 v11, s[16:19], s57 offen offset:3072 lds
    s_lshr_b32 s53, s46, 2
    s_and_b32 s89, s46, 3
    s_bfe_u32 s54, s46, 0x20001
    s_and_b32 s55, s46, 1
    s_add_u32 s55, s55, 4
    s_cmp_lt_u32 s46, 16
    s_cselect_b32 s53, s53, s54
    s_cselect_b32 s89, s89, s55
    s_mul_i32 s49, s53, 2
    s_add_u32 s49, s49, s89
    s_sub_u32 s54, s49, 6
    s_min_u32 s49, s49, s54
    s_add_u32 m0, s52, 147456
    s_add_u32 s57, s65, 6
    s_and_b32 s57, s57, 15
    s_mul_i32 s57, s57, 114688
    buffer_load_dwordx4 v10, s[16:19], s57 offen offset:0 lds
    s_lshl2_add_u32 s48, s45, s53
    s_mul_i32 s53, s44, 1835008
    s_lshl_b32 s74, s48, 7
    s_add_u32 s53, s53, s74
    s_add_u32 s57, s57, 27648
    buffer_load_dwordx4 v11, s[16:19], s57 offen offset:1024 lds
    s_waitcnt vmcnt(10)
    ds_read_b64_tr_b16 a[48:49], v2 offset:49152
    ds_read_b64_tr_b16 a[50:51], v2 offset:49664
    ds_read_b64_tr_b16 a[52:53], v3 offset:49152
    ds_read_b64_tr_b16 a[54:55], v3 offset:49664
    s_add_u32 s57, s57, 27648
    buffer_load_dwordx4 v10, s[16:19], s57 offen offset:2048 lds
    ds_read_b64_tr_b16 a[56:57], v2 offset:49408
    ds_read_b64_tr_b16 a[58:59], v2 offset:49920
    ds_read_b64_tr_b16 a[60:61], v3 offset:49408
    ds_read_b64_tr_b16 a[62:63], v3 offset:49920
    v_lshlrev_b32 v217, 5, v212
    v_xor_b32 v217, v217, v214
    v_lshlrev_b32 v12, 12, v213
    v_add3_u32 v12, v12, v217, s53
    s_add_u32 s57, s57, 27648
    buffer_load_dwordx4 v11, s[16:19], s57 offen offset:3072 lds
    s_mul_i32 s53, s44, 100352
    s_lshl_b32 s54, s49, 7
    s_add_u32 s55, s53, s54
    s_lshl_b32 s56, s44, 5
    s_waitcnt lgkmcnt(15)
    s_add_u32 m0, s52, 49152
    s_add_u32 s57, s65, 7
    s_and_b32 s57, s57, 15
    s_mul_i32 s57, s57, 114688
    buffer_load_dwordx4 v10, s[16:19], s57 offen offset:0 lds
    v_xor_b32 v217, s56, v214
    v_mul_u32_u24 v13, 896, v213
    v_add3_u32 v13, v13, v217, s55
    v_xor_b32 v14, 32, v13
    s_add_u32 s57, s57, 27648
    buffer_load_dwordx4 v11, s[16:19], s57 offen offset:1024 lds
    s_waitcnt vmcnt(10)
    ds_read_b64_tr_b16 a[64:65], v4 offset:0
    ds_read_b64_tr_b16 a[66:67], v4 offset:512
    ds_read_b64_tr_b16 a[68:69], v5 offset:0
    ds_read_b64_tr_b16 a[70:71], v5 offset:512
    s_mul_i32 s73, s48, 57344
    s_add_u32 s71, s73, s54
    s_add_u32 s72, s71, 28672
    v_lshrrev_b32 v217, 1, v1
    ds_read_b64_tr_b16 a[72:73], v4 offset:256
    ds_read_b64_tr_b16 a[74:75], v4 offset:768
    ds_read_b64_tr_b16 a[76:77], v5 offset:256
    ds_read_b64_tr_b16 a[78:79], v5 offset:768
    s_add_u32 s57, s57, 27648
    buffer_load_dwordx4 v10, s[16:19], s57 offen offset:2048 lds
    v_mul_u32_u24 v15, 896, v217
    v_and_b32 v217, 1, v1
    v_lshl_add_u32 v15, v217, 4, v15
    v_add_u32 v15, s53, v15
    s_add_u32 s57, s57, 27648
    buffer_load_dwordx4 v11, s[16:19], s57 offen offset:3072 lds
    s_lshl_b32 s54, s89, 5
    s_add_u32 s54, s54, 768
    s_add_u32 s68, s89, 24
    s_mul_i32 s68, s68, 58624
    s_add_u32 m0, s52, 65536
    s_add_u32 s57, s65, 8
    s_and_b32 s57, s57, 15
    s_mul_i32 s57, s57, 114688
    buffer_load_dwordx4 v10, s[16:19], s57 offen offset:0 lds
    s_mul_i32 s69, s44, 14336
    s_add_u32 s69, s69, 2097152
    s_add_u32 s68, s68, s69
    s_add_u32 s73, s73, s54
    s_mov_b32 s76, 0
    s_add_u32 s77, s76, 2048
    s_cmp_eq_u32 s77, 14336
    s_cselect_b32 s77, 0, s77
    s_add_u32 s78, s77, 2048
    s_cmp_eq_u32 s78, 14336
    s_cselect_b32 s78, 0, s78
    s_add_u32 s79, s78, 2048
    s_cmp_eq_u32 s79, 14336
    s_cselect_b32 s79, 0, s79
    s_add_u32 s80, s79, 2048
    s_cmp_eq_u32 s80, 14336
    s_cselect_b32 s80, 0, s80
    s_add_u32 s81, s80, 2048
    s_cmp_eq_u32 s81, 14336
    s_cselect_b32 s81, 0, s81
    s_add_u32 s82, s81, 2048
    s_cmp_eq_u32 s82, 14336
    s_cselect_b32 s82, 0, s82
    s_add_u32 s57, s57, 27648
    buffer_load_dwordx4 v11, s[16:19], s57 offen offset:1024 lds
    s_waitcnt vmcnt(10)
    ds_read_b64_tr_b16 a[80:81], v4 offset:16384
    ds_read_b64_tr_b16 a[82:83], v4 offset:16896
    ds_read_b64_tr_b16 a[84:85], v5 offset:16384
    ds_read_b64_tr_b16 a[86:87], v5 offset:16896
    s_add_u32 s57, s57, 27648
    buffer_load_dwordx4 v10, s[16:19], s57 offen offset:2048 lds
    ds_read_b64_tr_b16 a[88:89], v4 offset:16640
    ds_read_b64_tr_b16 a[90:91], v4 offset:17152
    ds_read_b64_tr_b16 a[92:93], v5 offset:16640
    ds_read_b64_tr_b16 a[94:95], v5 offset:17152
    s_add_u32 s57, s57, 27648
    buffer_load_dwordx4 v11, s[16:19], s57 offen offset:3072 lds
    s_cmp_lt_u32 s89, 4
    s_cselect_b32 s75, s54, 2130706432
    s_cselect_b32 s68, s68, 2130706432
    s_cselect_b32 s73, s73, 2130706432
    v_lshl_add_u32 v217, v208, 3, v209
    v_lshlrev_b32 v16, 5, v217
    v_lshl_add_u32 v16, v210, 3, v16
    v_add_u32 v16, s52, v16
    s_waitcnt lgkmcnt(15)
    s_add_u32 m0, s52, 81920
    s_add_u32 s57, s65, 9
    s_and_b32 s57, s57, 15
    s_mul_i32 s57, s57, 114688
    buffer_load_dwordx4 v10, s[16:19], s57 offen offset:0 lds
    v_and_b32 v217, 7, v1
    v_min_u32 v218, 6, v217
    s_mul_i32 s54, s44, 7
    v_add_u32 v218, s54, v218
    s_add_u32 s57, s57, 27648
    buffer_load_dwordx4 v11, s[16:19], s57 offen offset:1024 lds
    s_waitcnt vmcnt(10)
    ds_read_b64_tr_b16 a[96:97], v4 offset:32768
    ds_read_b64_tr_b16 a[98:99], v4 offset:33280
    ds_read_b64_tr_b16 a[100:101], v5 offset:32768
    ds_read_b64_tr_b16 a[102:103], v5 offset:33280
    s_add_u32 s57, s57, 27648
    buffer_load_dwordx4 v10, s[16:19], s57 offen offset:2048 lds
    ds_read_b64_tr_b16 a[104:105], v4 offset:33024
    ds_read_b64_tr_b16 a[106:107], v4 offset:33536
    ds_read_b64_tr_b16 a[108:109], v5 offset:33024
    ds_read_b64_tr_b16 a[110:111], v5 offset:33536
    v_mul_u32_u24 v219, 2, v218
    v_add_u32 v219, s89, v219
    v_mul_u32_u24 v220, 43, v219
    v_lshrrev_b32 v220, 8, v220
    s_add_u32 s57, s57, 27648
    buffer_load_dwordx4 v11, s[16:19], s57 offen offset:3072 lds
    v_mul_u32_u24 v220, 6, v220
    v_sub_u32 v219, v219, v220
    v_subrev_u32 v219, s49, v219
    v_bfe_u32 v220, v1, 3, 1
    buffer_load_dwordx2 v[224:225], v19, s[32:35], 0 offen offset:0
    v_mul_i32_i24 v219, v219, v220
    v_add_u32 v219, s49, v219
    v_lshl_add_u32 v218, v219, 5, v218
    v_lshlrev_b32 v20, 7, v218
    buffer_load_dwordx2 v[226:227], v19, s[32:35], 0 offen offset:32
    s_waitcnt vmcnt(10)
    ds_read_b64_tr_b16 a[112:113], v2 offset:0
    ds_read_b64_tr_b16 a[114:115], v2 offset:512
    ds_read_b64_tr_b16 a[116:117], v3 offset:0
    ds_read_b64_tr_b16 a[118:119], v3 offset:512
    buffer_load_dwordx2 v[228:229], v19, s[32:35], 0 offen offset:64
    ds_read_b64_tr_b16 a[120:121], v2 offset:256
    ds_read_b64_tr_b16 a[122:123], v2 offset:768
    ds_read_b64_tr_b16 a[124:125], v3 offset:256
    ds_read_b64_tr_b16 a[126:127], v3 offset:768
    buffer_load_dwordx2 v[230:231], v19, s[32:35], 0 offen offset:96
    v_add_u32 v20, 12713984, v20
    s_lshr_b32 s53, s48, 1
    s_lshl4_add_u32 s53, s44, s53
    s_lshl_b32 s53, s53, 7
    s_add_u32 m0, s52, 98304
    s_add_u32 s57, s65, 10
    s_and_b32 s57, s57, 15
    s_mul_i32 s57, s57, 114688
    buffer_load_dwordx4 v10, s[16:19], s57 offen offset:0 lds
    s_add_u32 s53, s53, 12779520
    v_mov_b32 v21, s53
    s_lshl_b32 s70, s48, 16
    s_add_u32 s70, s70, s52
    s_add_u32 s70, s70, 4194304
    v_lshrrev_b32 v218, 3, v0
    v_mul_u32_u24 v22, 896, v218
    v_lshl_add_u32 v22, v217, 4, v22
    s_add_u32 s57, s57, 27648
    buffer_load_dwordx4 v11, s[16:19], s57 offen offset:1024 lds
    s_waitcnt vmcnt(10)
    ds_read_b64_tr_b16 a[128:129], v2 offset:16384
    ds_read_b64_tr_b16 a[130:131], v2 offset:16896
    ds_read_b64_tr_b16 a[132:133], v3 offset:16384
    ds_read_b64_tr_b16 a[134:135], v3 offset:16896
    s_add_u32 s57, s57, 27648
    buffer_load_dwordx4 v10, s[16:19], s57 offen offset:2048 lds
    ds_read_b64_tr_b16 a[136:137], v2 offset:16640
    ds_read_b64_tr_b16 a[138:139], v2 offset:17152
    ds_read_b64_tr_b16 a[140:141], v3 offset:16640
    ds_read_b64_tr_b16 a[142:143], v3 offset:17152
    s_add_u32 s57, s57, 27648
    buffer_load_dwordx4 v11, s[16:19], s57 offen offset:3072 lds
    v_lshlrev_b32 v25, 1, v218
    v_lshrrev_b32 v219, 4, v218
    v_lshlrev_b32 v244, 14, v219
    v_lshrrev_b32 v219, 1, v217
    v_lshl_add_u32 v244, v219, 12, v244
    v_and_b32 v219, 15, v218
    v_lshl_add_u32 v244, v219, 8, v244
    v_bfe_u32 v219, v218, 1, 1
    s_waitcnt lgkmcnt(15)
    s_add_u32 m0, s52, 114688
    s_add_u32 s57, s65, 11
    s_and_b32 s57, s57, 15
    s_mul_i32 s57, s57, 114688
    buffer_load_dwordx4 v10, s[16:19], s57 offen offset:0 lds
    v_lshl_add_u32 v244, v219, 7, v244
    v_and_b32 v219, 7, v218
    v_xor_b32 v219, v219, v217
    v_lshl_add_u32 v244, v219, 4, v244
    s_add_u32 s57, s57, 27648
    buffer_load_dwordx4 v11, s[16:19], s57 offen offset:1024 lds
    s_waitcnt vmcnt(10)
    ds_read_b64_tr_b16 a[144:145], v2 offset:32768
    ds_read_b64_tr_b16 a[146:147], v2 offset:33280
    ds_read_b64_tr_b16 a[148:149], v3 offset:32768
    ds_read_b64_tr_b16 a[150:151], v3 offset:33280
    s_add_u32 s57, s57, 27648
    buffer_load_dwordx4 v10, s[16:19], s57 offen offset:2048 lds
    ds_read_b64_tr_b16 a[152:153], v2 offset:33024
    ds_read_b64_tr_b16 a[154:155], v2 offset:33536
    ds_read_b64_tr_b16 a[156:157], v3 offset:33024
    ds_read_b64_tr_b16 a[158:159], v3 offset:33536
    v_xor_b32 v245, 128, v244
    v_xor_b32 v246, 4096, v244
    v_xor_b32 v247, 4224, v244
    v_xor_b32 v248, 8192, v244
    s_add_u32 s57, s57, 27648
    buffer_load_dwordx4 v11, s[16:19], s57 offen offset:3072 lds
    v_xor_b32 v249, 8320, v244
    v_xor_b32 v250, 12288, v244
    v_xor_b32 v251, 12416, v244
    v_lshrrev_b32 v218, 2, v0
    s_add_u32 m0, s52, 131072
    s_add_u32 s57, s65, 12
    s_and_b32 s57, s57, 15
    s_mul_i32 s57, s57, 114688
    buffer_load_dwordx4 v10, s[16:19], s57 offen offset:0 lds
    v_mul_u32_u24 v26, 896, v218
    v_lshl_add_u32 v26, v210, 3, v26
    v_lshlrev_b32 v27, 1, v218
    v_bfe_u32 v219, v218, 1, 2
    s_add_u32 s57, s57, 27648
    buffer_load_dwordx4 v11, s[16:19], s57 offen offset:1024 lds
    v_xor_b32 v219, v219, v210
    v_lshlrev_b32 v252, 6, v218
    v_lshl_add_u32 v252, v219, 4, v252
    v_add_u32 v252, 65536, v252
    v_bfe_u32 v219, v1, 1, 2
    v_xor_b32 v219, v219, v208
    v_lshlrev_b32 v242, 6, v211
    v_lshl_add_u32 v242, v219, 4, v242
    s_add_u32 s57, s57, 27648
    buffer_load_dwordx4 v10, s[16:19], s57 offen offset:2048 lds
    s_add_u32 s53, s52, 65536
    v_add_u32 v242, s53, v242
    v_xor_b32 v218, v217, v212
    v_lshlrev_b32 v238, 4, v218
    s_add_u32 s57, s57, 27648
    buffer_load_dwordx4 v11, s[16:19], s57 offen offset:3072 lds
    v_xor_b32 v238, s56, v238
    v_bfe_u32 v219, v1, 1, 1
    v_xor_b32 v219, v219, v215
    v_lshl_add_u32 v238, v219, 7, v238
    buffer_load_dword v17, v18, s[24:27], 0 offen sc1
    v_lshl_add_u32 v238, v211, 8, v238
    v_add_u32 v238, s52, v238
    v_xor_b32 v239, 32, v238
    v_xor_b32 v240, 64, v238
    v_xor_b32 v241, 96, v238
    s_waitcnt vmcnt(13)
    v_lshlrev_b32 v32, 16, v224
    v_and_b32 v33, s61, v224
    v_lshlrev_b32 v34, 16, v225
    v_and_b32 v35, s61, v225
    s_add_u32 m0, s52, 147456
    s_add_u32 s57, s65, 13
    s_and_b32 s57, s57, 15
    s_mul_i32 s57, s57, 114688
    buffer_load_dwordx4 v10, s[16:19], s57 offen offset:0 lds
    s_waitcnt vmcnt(10)
    ds_read_b64_tr_b16 a[160:161], v2 offset:49152
    ds_read_b64_tr_b16 a[162:163], v2 offset:49664
    ds_read_b64_tr_b16 a[164:165], v3 offset:49152
    ds_read_b64_tr_b16 a[166:167], v3 offset:49664
    s_add_u32 s57, s57, 27648
    buffer_load_dwordx4 v11, s[16:19], s57 offen offset:1024 lds
    ds_read_b64_tr_b16 a[168:169], v2 offset:49408
    ds_read_b64_tr_b16 a[170:171], v2 offset:49920
    ds_read_b64_tr_b16 a[172:173], v3 offset:49408
    ds_read_b64_tr_b16 a[174:175], v3 offset:49920
    v_lshlrev_b32 v36, 16, v226
    v_and_b32 v37, s61, v226
    v_lshlrev_b32 v38, 16, v227
    v_and_b32 v39, s61, v227
    s_add_u32 s57, s57, 27648
    buffer_load_dwordx4 v10, s[16:19], s57 offen offset:2048 lds
    v_lshlrev_b32 v40, 16, v228
    v_and_b32 v41, s61, v228
    v_lshlrev_b32 v42, 16, v229
    v_and_b32 v43, s61, v229
    s_add_u32 s57, s57, 27648
    buffer_load_dwordx4 v11, s[16:19], s57 offen offset:3072 lds
    v_lshlrev_b32 v44, 16, v230
    v_and_b32 v45, s61, v230
    v_lshlrev_b32 v46, 16, v231
    v_and_b32 v47, s61, v231
    s_waitcnt lgkmcnt(15)
    s_add_u32 m0, s52, 49152
    s_add_u32 s57, s65, 14
    s_and_b32 s57, s57, 15
    s_mul_i32 s57, s57, 114688
    buffer_load_dwordx4 v10, s[16:19], s57 offen offset:0 lds
    s_waitcnt vmcnt(10)
    ds_read_b64_tr_b16 a[176:177], v4 offset:0
    ds_read_b64_tr_b16 a[178:179], v4 offset:512
    ds_read_b64_tr_b16 a[180:181], v5 offset:0
    ds_read_b64_tr_b16 a[182:183], v5 offset:512
    v_mul_f32 v96, s85, v32
    v_mul_f32 v97, s85, v33
    v_mul_f32 v98, s85, v34
    v_mul_f32 v99, s85, v35
    ds_read_b64_tr_b16 a[184:185], v4 offset:256
    ds_read_b64_tr_b16 a[186:187], v4 offset:768
    ds_read_b64_tr_b16 a[188:189], v5 offset:256
    ds_read_b64_tr_b16 a[190:191], v5 offset:768
    s_add_u32 s57, s57, 27648
    buffer_load_dwordx4 v11, s[16:19], s57 offen offset:1024 lds
    v_mul_f32 v100, s85, v36
    v_mul_f32 v101, s85, v37
    v_mul_f32 v102, s85, v38
    v_mul_f32 v103, s85, v39
    s_add_u32 s57, s57, 27648
    buffer_load_dwordx4 v10, s[16:19], s57 offen offset:2048 lds
    v_mul_f32 v104, s85, v40
    v_mul_f32 v105, s85, v41
    v_mul_f32 v106, s85, v42
    v_mul_f32 v107, s85, v43
    s_add_u32 s57, s57, 27648
    buffer_load_dwordx4 v11, s[16:19], s57 offen offset:3072 lds
    v_mul_f32 v108, s85, v44
    v_mul_f32 v109, s85, v45
    v_mul_f32 v110, s85, v46
    v_mul_f32 v111, s85, v47
    s_add_u32 m0, s52, 65536
    s_add_u32 s57, s65, 15
    s_and_b32 s57, s57, 15
    s_mul_i32 s57, s57, 114688
    buffer_load_dwordx4 v10, s[16:19], s57 offen offset:0 lds
    s_waitcnt vmcnt(10)
    ds_read_b64_tr_b16 a[192:193], v4 offset:16384
    ds_read_b64_tr_b16 a[194:195], v4 offset:16896
    ds_read_b64_tr_b16 a[196:197], v5 offset:16384
    ds_read_b64_tr_b16 a[198:199], v5 offset:16896
    s_add_u32 s57, s57, 27648
    buffer_load_dwordx4 v11, s[16:19], s57 offen offset:1024 lds
    ds_read_b64_tr_b16 a[200:201], v4 offset:16640
    ds_read_b64_tr_b16 a[202:203], v4 offset:17152
    ds_read_b64_tr_b16 a[204:205], v5 offset:16640
    ds_read_b64_tr_b16 a[206:207], v5 offset:17152
    s_waitcnt vmcnt(10)
    v_cmp_ne_u32 vcc, s47, v17
    s_nop 0
    s_cbranch_vccz L_ok5
    s_mov_b32 s59, 20000
L_spin4:
    s_sleep 2
    buffer_load_dword v17, v18, s[24:27], 0 offen sc1
    s_waitcnt vmcnt(0)
    v_cmp_ne_u32 vcc, s47, v17
    s_nop 0
    s_cbranch_vccz L_ok5
    s_sub_u32 s59, s59, 1
    s_cbranch_scc0 L_spin4
L_ok5:
    s_cmp_ge_u32 s88, 4
    s_cbranch_scc1 L_p2_alt
    s_add_u32 s57, s57, 27648
    buffer_load_dwordx4 v10, s[16:19], s57 offen offset:2048 lds
    s_add_u32 s57, s57, 27648
    buffer_load_dwordx4 v11, s[16:19], s57 offen offset:3072 lds
    s_mov_b32 s66, s84
    s_lshl_b32 s86, s65, 10
    s_add_u32 s58, s86, s66
    buffer_load_dwordx4 v[112:115], v23, s[24:27], s58 offen offset:0 sc1
    s_add_u32 s86, s86, 1024
    s_and_b32 s86, s86, 16383
    s_add_u32 s58, s86, s66
    buffer_load_dwordx4 v[116:119], v23, s[24:27], s58 offen offset:0 sc1
    s_waitcnt vmcnt(10)
    ds_read_b64_tr_b16 a[208:209], v4 offset:32768
    ds_read_b64_tr_b16 a[210:211], v4 offset:33280
    ds_read_b64_tr_b16 a[212:213], v5 offset:32768
    ds_read_b64_tr_b16 a[214:215], v5 offset:33280
    s_add_u32 s86, s86, 1024
    s_and_b32 s86, s86, 16383
    s_add_u32 s58, s86, s66
    buffer_load_dwordx4 v[120:123], v23, s[24:27], s58 offen offset:0 sc1
    ds_read_b64_tr_b16 a[216:217], v4 offset:33024
    ds_read_b64_tr_b16 a[218:219], v4 offset:33536
    ds_read_b64_tr_b16 a[220:221], v5 offset:33024
    ds_read_b64_tr_b16 a[222:223], v5 offset:33536
    s_add_u32 s86, s86, 1024
    s_and_b32 s86, s86, 16383
    s_add_u32 s58, s86, s66
    buffer_load_dwordx4 v[124:127], v23, s[24:27], s58 offen offset:0 sc1
    s_add_u32 s86, s86, 1024
    s_and_b32 s86, s86, 16383
    s_add_u32 s58, s86, s66
    buffer_load_dwordx4 v[128:131], v23, s[24:27], s58 offen offset:0 sc1
    s_add_u32 s86, s86, 1024
    s_and_b32 s86, s86, 16383
    s_add_u32 s58, s86, s66
    buffer_load_dwordx4 v[132:135], v23, s[24:27], s58 offen offset:0 sc1
    s_waitcnt vmcnt(10)
    ds_read_b64_tr_b16 a[224:225], v2 offset:0
    ds_read_b64_tr_b16 a[226:227], v2 offset:512
    ds_read_b64_tr_b16 a[228:229], v3 offset:0
    ds_read_b64_tr_b16 a[230:231], v3 offset:512
    s_add_u32 s86, s86, 1024
    s_and_b32 s86, s86, 16383
    s_add_u32 s58, s86, s66
    buffer_load_dwordx4 v[136:139], v23, s[24:27], s58 offen offset:0 sc1
    ds_read_b64_tr_b16 a[232:233], v2 offset:256
    ds_read_b64_tr_b16 a[234:235], v2 offset:768
    ds_read_b64_tr_b16 a[236:237], v3 offset:256
    ds_read_b64_tr_b16 a[238:239], v3 offset:768
    s_add_u32 s86, s86, 1024
    s_and_b32 s86, s86, 16383
    s_add_u32 s58, s86, s66
    buffer_load_dwordx4 v[140:143], v23, s[24:27], s58 offen offset:0 sc1
    s_add_u32 s86, s86, 1024
    s_and_b32 s86, s86, 16383
    s_add_u32 s58, s86, s66
    buffer_load_dwordx4 v[144:147], v23, s[24:27], s58 offen offset:0 sc1
    s_add_u32 s86, s86, 1024
    s_and_b32 s86, s86, 16383
    s_add_u32 s58, s86, s66
    buffer_load_dwordx4 v[148:151], v23, s[24:27], s58 offen offset:0 sc1
    s_waitcnt vmcnt(10)
    ds_read_b64_tr_b16 a[240:241], v2 offset:16384
    ds_read_b64_tr_b16 a[242:243], v2 offset:16896
    ds_read_b64_tr_b16 a[244:245], v3 offset:16384
    ds_read_b64_tr_b16 a[246:247], v3 offset:16896
    s_waitcnt vmcnt(9)
    v_mfma_f32_16x16x32_bf16 v[96:99], a[0:3], v[112:115], v[96:99]
    s_add_u32 s86, s86, 1024
    s_and_b32 s86, s86, 16383
    s_add_u32 s58, s86, s66
    v_mfma_f32_16x16x32_bf16 v[100:103], a[4:7], v[112:115], v[100:103]
    buffer_load_dwordx4 v[152:155], v23, s[24:27], s58 offen offset:0 sc1
    v_mfma_f32_16x16x32_bf16 v[104:107], a[8:11], v[112:115], v[104:107]
    v_mfma_f32_16x16x32_bf16 v[108:111], a[12:15], v[112:115], v[108:111]
    ds_read_b64_tr_b16 a[248:249], v2 offset:16640
    ds_read_b64_tr_b16 a[250:251], v2 offset:17152
    ds_read_b64_tr_b16 a[252:253], v3 offset:16640
    ds_read_b64_tr_b16 a[254:255], v3 offset:17152
    s_waitcnt vmcnt(9)
    v_mfma_f32_16x16x32_bf16 v[96:99], a[16:19], v[116:119], v[96:99]
    s_add_u32 s86, s86, 1024
    s_and_b32 s86, s86, 16383
    s_add_u32 s58, s86, s66
    v_mfma_f32_16x16x32_bf16 v[100:103], a[20:23], v[116:119], v[100:103]
    buffer_load_dwordx4 v[156:159], v23, s[24:27], s58 offen offset:0 sc1
    v_mfma_f32_16x16x32_bf16 v[104:107], a[24:27], v[116:119], v[104:107]
    v_mfma_f32_16x16x32_bf16 v[108:111], a[28:31], v[116:119], v[108:111]
    s_waitcnt vmcnt(9)
    v_mfma_f32_16x16x32_bf16 v[96:99], a[32:35], v[120:123], v[96:99]
    s_add_u32 s86, s86, 1024
    s_and_b32 s86, s86, 16383
    s_add_u32 s58, s86, s66
    v_mfma_f32_16x16x32_bf16 v[100:103], a[36:39], v[120:123], v[100:103]
    buffer_load_dwordx4 v[112:115], v23, s[24:27], s58 offen offset:0 sc1
    v_mfma_f32_16x16x32_bf16 v[104:107], a[40:43], v[120:123], v[104:107]
    v_mfma_f32_16x16x32_bf16 v[108:111], a[44:47], v[120:123], v[108:111]
    s_waitcnt vmcnt(9)
    v_mfma_f32_16x16x32_bf16 v[96:99], a[48:51], v[124:127], v[96:99]
    s_add_u32 s86, s86, 1024
    s_and_b32 s86, s86, 16383
    s_add_u32 s58, s86, s66
    v_mfma_f32_16x16x32_bf16 v[100:103], a[52:55], v[124:127], v[100:103]
    buffer_load_dwordx4 v[116:119], v23, s[24:27], s58 offen offset:0 sc1
    v_mfma_f32_16x16x32_bf16 v[104:107], a[56:59], v[124:127], v[104:107]
    v_mfma_f32_16x16x32_bf16 v[108:111], a[60:63], v[124:127], v[108:111]
    s_waitcnt vmcnt(9)
    v_mfma_f32_16x16x32_bf16 v[96:99], a[64:67], v[128:131], v[96:99]
    s_add_u32 s86, s86, 1024
    s_and_b32 s86, s86, 16383
    s_add_u32 s58, s86, s66
    v_mfma_f32_16x16x32_bf16 v[100:103], a[68:71], v[128:131], v[100:103]
    buffer_load_dwordx4 v[120:123], v23, s[24:27], s58 offen offset:0 sc1
    v_mfma_f32_16x16x32_bf16 v[104:107], a[72:75], v[128:131], v[104:107]
    v_mfma_f32_16x16x32_bf16 v[108:111], a[76:79], v[128:131], v[108:111]
    s_waitcnt vmcnt(9)
    v_mfma_f32_16x16x32_bf16 v[96:99], a[80:83], v[132:135], v[96:99]
    s_add_u32 s86, s86, 1024
    s_and_b32 s86, s86, 16383
    s_add_u32 s58, s86, s66
    v_mfma_f32_16x16x32_bf16 v[100:103], a[84:87], v[132:135], v[100:103]
    buffer_load_dwordx4 v[124:127], v23, s[24:27], s58 offen offset:0 sc1
    v_mfma_f32_16x16x32_bf16 v[104:107], a[88:91], v[132:135], v[104:107]
    v_mfma_f32_16x16x32_bf16 v[108:111], a[92:95], v[132:135], v[108:111]
    s_waitcnt vmcnt(9)
    v_mfma_f32_16x16x32_bf16 v[96:99], a[96:99], v[136:139], v[96:99]
    s_xor_b32 s66, s44, 3
    s_lshl2_add_u32 s66, s51, s66
    s_mul_i32 s66, s66, 66816
    s_lshl2_add_u32 s66, s52, s66
    s_lshl_b32 s86, s65, 10
    s_add_u32 s58, s86, s66
    v_mfma_f32_16x16x32_bf16 v[100:103], a[100:103], v[136:139], v[100:103]
    buffer_load_dwordx4 v[128:131], v23, s[24:27], s58 offen offset:0 sc1
    v_mfma_f32_16x16x32_bf16 v[104:107], a[104:107], v[136:139], v[104:107]
    v_mfma_f32_16x16x32_bf16 v[108:111], a[108:111], v[136:139], v[108:111]
    s_waitcnt vmcnt(9)
    v_mfma_f32_16x16x32_bf16 v[96:99], a[112:115], v[140:143], v[96:99]
    s_add_u32 s86, s86, 1024
    s_and_b32 s86, s86, 16383
    s_add_u32 s58, s86, s66
    v_mfma_f32_16x16x32_bf16 v[100:103], a[116:119], v[140:143], v[100:103]
    buffer_load_dwordx4 v[132:135], v23, s[24:27], s58 offen offset:0 sc1
    v_mfma_f32_16x16x32_bf16 v[104:107], a[120:123], v[140:143], v[104:107]
    v_mfma_f32_16x16x32_bf16 v[108:111], a[124:127], v[140:143], v[108:111]
    s_waitcnt vmcnt(9)
    v_mfma_f32_16x16x32_bf16 v[96:99], a[128:131], v[144:147], v[96:99]
    s_add_u32 s86, s86, 1024
    s_and_b32 s86, s86, 16383
    s_add_u32 s58, s86, s66
    v_mfma_f32_16x16x32_bf16 v[100:103], a[132:135], v[144:147], v[100:103]
    buffer_load_dwordx4 v[136:139], v23, s[24:27], s58 offen offset:0 sc1
    v_mfma_f32_16x16x32_bf16 v[104:107], a[136:139], v[144:147], v[104:107]
    v_mfma_f32_16x16x32_bf16 v[108:111], a[140:143], v[144:147], v[108:111]
    s_waitcnt vmcnt(9)
    s_waitcnt lgkmcnt(15)
    v_mfma_f32_16x16x32_bf16 v[96:99], a[144:147], v[148:151], v[96:99]
    s_add_u32 s86, s86, 1024
    s_and_b32 s86, s86, 16383
    s_add_u32 s58, s86, s66
    v_mfma_f32_16x16x32_bf16 v[100:103], a[148:151], v[148:151], v[100:103]
    buffer_load_dwordx4 v[140:143], v23, s[24:27], s58 offen offset:0 sc1
    v_mfma_f32_16x16x32_bf16 v[104:107], a[152:155], v[148:151], v[104:107]
    v_mfma_f32_16x16x32_bf16 v[108:111], a[156:159], v[148:151], v[108:111]
    s_waitcnt vmcnt(9)
    v_mfma_f32_16x16x32_bf16 v[96:99], a[160:163], v[152:155], v[96:99]
    s_add_u32 s86, s86, 1024
    s_and_b32 s86, s86, 16383
    s_add_u32 s58, s86, s66
    v_mfma_f32_16x16x32_bf16 v[100:103], a[164:167], v[152:155], v[100:103]
    buffer_load_dwordx4 v[144:147], v23, s[24:27], s58 offen offset:0 sc1
    v_mfma_f32_16x16x32_bf16 v[104:107], a[168:171], v[152:155], v[104:107]
    v_mfma_f32_16x16x32_bf16 v[108:111], a[172:175], v[152:155], v[108:111]
    s_waitcnt vmcnt(9)
    v_mfma_f32_16x16x32_bf16 v[96:99], a[176:179], v[156:159], v[96:99]
    s_add_u32 s86, s86, 1024
    s_and_b32 s86, s86, 16383
    s_add_u32 s58, s86, s66
    v_mfma_f32_16x16x32_bf16 v[100:103], a[180:183], v[156:159], v[100:103]
    buffer_load_dwordx4 v[148:151], v23, s[24:27], s58 offen offset:0 sc1
    v_mfma_f32_16x16x32_bf16 v[104:107], a[184:187], v[156:159], v[104:107]
    v_mfma_f32_16x16x32_bf16 v[108:111], a[188:191], v[156:159], v[108:111]
    s_waitcnt vmcnt(9)
    v_mfma_f32_16x16x32_bf16 v[96:99], a[192:195], v[112:115], v[96:99]
    s_add_u32 s86, s86, 1024
    s_and_b32 s86, s86, 16383
    s_add_u32 s58, s86, s66
    v_mfma_f32_16x16x32_bf16 v[100:103], a[196:199], v[112:115], v[100:103]
    buffer_load_dwordx4 v[152:155], v23, s[24:27], s58 offen offset:0 sc1
    v_mfma_f32_16x16x32_bf16 v[104:107], a[200:203], v[112:115], v[104:107]
    v_mfma_f32_16x16x32_bf16 v[108:111], a[204:207], v[112:115], v[108:111]
    s_waitcnt vmcnt(9)
    v_mfma_f32_16x16x32_bf16 v[96:99], a[208:211], v[116:119], v[96:99]
    s_add_u32 s86, s86, 1024
    s_and_b32 s86, s86, 16383
    s_add_u32 s58, s86, s66
    v_mfma_f32_16x16x32_bf16 v[100:103], a[212:215], v[116:119], v[100:103]
    buffer_load_dwordx4 v[156:159], v23, s[24:27], s58 offen offset:0 sc1
    v_mfma_f32_16x16x32_bf16 v[104:107], a[216:219], v[116:119], v[104:107]
    v_mfma_f32_16x16x32_bf16 v[108:111], a[220:223], v[116:119], v[108:111]
    s_waitcnt vmcnt(9)
    s_waitcnt lgkmcnt(8)
    v_mfma_f32_16x16x32_bf16 v[96:99], a[224:227], v[120:123], v[96:99]
    s_add_u32 s86, s86, 1024
    s_and_b32 s86, s86, 16383
    s_add_u32 s58, s86, s66
    v_mfma_f32_16x16x32_bf16 v[100:103], a[228:231], v[120:123], v[100:103]
    buffer_load_dwordx4 v[112:115], v23, s[24:27], s58 offen offset:0 sc1
    v_mfma_f32_16x16x32_bf16 v[104:107], a[232:235], v[120:123], v[104:107]
    v_mfma_f32_16x16x32_bf16 v[108:111], a[236:239], v[120:123], v[108:111]
    s_waitcnt vmcnt(9)
    s_waitcnt lgkmcnt(0)
    v_mfma_f32_16x16x32_bf16 v[96:99], a[240:243], v[124:127], v[96:99]
    s_add_u32 s86, s86, 1024
    s_and_b32 s86, s86, 16383
    s_add_u32 s58, s86, s66
    v_mfma_f32_16x16x32_bf16 v[100:103], a[244:247], v[124:127], v[100:103]
    buffer_load_dwordx4 v[116:119], v23, s[24:27], s58 offen offset:0 sc1
    v_mfma_f32_16x16x32_bf16 v[104:107], a[248:251], v[124:127], v[104:107]
    v_mfma_f32_16x16x32_bf16 v[108:111], a[252:255], v[124:127], v[108:111]
L_p2_join:
    s_waitcnt vmcnt(9)
    v_mfma_f32_16x16x32_bf16 v[80:83], a[0:3], v[128:131], 0
    s_add_u32 s86, s86, 1024
    s_and_b32 s86, s86, 16383
    s_add_u32 s58, s86, s66
    v_mfma_f32_16x16x32_bf16 v[84:87], a[4:7], v[128:131], 0
    buffer_load_dwordx4 v[120:123], v23, s[24:27], s58 offen offset:0 sc1
    v_mfma_f32_16x16x32_bf16 v[88:91], a[8:11], v[128:131], 0
    v_mfma_f32_16x16x32_bf16 v[92:95], a[12:15], v[128:131], 0
    s_waitcnt vmcnt(9)
    v_mfma_f32_16x16x32_bf16 v[80:83], a[16:19], v[132:135], v[80:83]
    s_add_u32 s86, s86, 1024
    s_and_b32 s86, s86, 16383
    s_add_u32 s58, s86, s66
    v_mfma_f32_16x16x32_bf16 v[84:87], a[20:23], v[132:135], v[84:87]
    buffer_load_dwordx4 v[124:127], v23, s[24:27], s58 offen offset:0 sc1
    v_mfma_f32_16x16x32_bf16 v[88:91], a[24:27], v[132:135], v[88:91]
    ds_write_b128 v232, v[96:99] offset:49152
    v_mfma_f32_16x16x32_bf16 v[92:95], a[28:31], v[132:135], v[92:95]
    s_waitcnt vmcnt(9)
    v_mfma_f32_16x16x32_bf16 v[80:83], a[32:35], v[136:139], v[80:83]
    s_add_u32 s86, s86, 1024
    s_and_b32 s86, s86, 16383
    s_add_u32 s58, s86, s66
    v_mfma_f32_16x16x32_bf16 v[84:87], a[36:39], v[136:139], v[84:87]
    buffer_load_dwordx4 v[128:131], v23, s[24:27], s58 offen offset:0 sc1
    v_mfma_f32_16x16x32_bf16 v[88:91], a[40:43], v[136:139], v[88:91]
    ds_write_b128 v232, v[100:103] offset:50176
    v_mfma_f32_16x16x32_bf16 v[92:95], a[44:47], v[136:139], v[92:95]
    s_waitcnt vmcnt(9)
    v_mfma_f32_16x16x32_bf16 v[80:83], a[48:51], v[140:143], v[80:83]
    s_add_u32 s86, s86, 1024
    s_and_b32 s86, s86, 16383
    s_add_u32 s58, s86, s66
    v_mfma_f32_16x16x32_bf16 v[84:87], a[52:55], v[140:143], v[84:87]
    buffer_load_dwordx4 v[132:135], v23, s[24:27], s58 offen offset:0 sc1
    v_mfma_f32_16x16x32_bf16 v[88:91], a[56:59], v[140:143], v[88:91]
    ds_write_b128 v232, v[104:107] offset:51200
    v_mfma_f32_16x16x32_bf16 v[92:95], a[60:63], v[140:143], v[92:95]
    s_waitcnt vmcnt(9)
    v_mfma_f32_16x16x32_bf16 v[80:83], a[64:67], v[144:147], v[80:83]
    s_add_u32 s86, s86, 1024
    s_and_b32 s86, s86, 16383
    s_add_u32 s58, s86, s66
    v_mfma_f32_16x16x32_bf16 v[84:87], a[68:71], v[144:147], v[84:87]
    buffer_load_dwordx4 v[136:139], v23, s[24:27], s58 offen offset:0 sc1
    v_mfma_f32_16x16x32_bf16 v[88:91], a[72:75], v[144:147], v[88:91]
    ds_write_b128 v232, v[108:111] offset:52224
    v_mfma_f32_16x16x32_bf16 v[92:95], a[76:79], v[144:147], v[92:95]
    s_waitcnt vmcnt(9)
    v_mfma_f32_16x16x32_bf16 v[80:83], a[80:83], v[148:151], v[80:83]
    s_add_u32 s86, s86, 1024
    s_and_b32 s86, s86, 16383
    s_add_u32 s58, s86, s66
    v_mfma_f32_16x16x32_bf16 v[84:87], a[84:87], v[148:151], v[84:87]
    buffer_load_dwordx4 v[140:143], v23, s[24:27], s58 offen offset:0 sc1
    v_mfma_f32_16x16x32_bf16 v[88:91], a[88:91], v[148:151], v[88:91]
    v_mfma_f32_16x16x32_bf16 v[92:95], a[92:95], v[148:151], v[92:95]
    s_waitcnt vmcnt(9)
    v_mfma_f32_16x16x32_bf16 v[80:83], a[96:99], v[152:155], v[80:83]
    s_xor_b32 s66, s44, 2
    s_lshl2_add_u32 s66, s51, s66
    s_mul_i32 s66, s66, 66816
    s_lshl2_add_u32 s66, s52, s66
    s_lshl_b32 s86, s65, 10
    s_add_u32 s58, s86, s66
    v_mfma_f32_16x16x32_bf16 v[84:87], a[100:103], v[152:155], v[84:87]
    buffer_load_dwordx4 v[144:147], v23, s[24:27], s58 offen offset:0 sc1
    v_mfma_f32_16x16x32_bf16 v[88:91], a[104:107], v[152:155], v[88:91]
    v_mfma_f32_16x16x32_bf16 v[92:95], a[108:111], v[152:155], v[92:95]
    s_waitcnt vmcnt(9)
    v_mfma_f32_16x16x32_bf16 v[80:83], a[112:115], v[156:159], v[80:83]
    s_add_u32 s86, s86, 1024
    s_and_b32 s86, s86, 16383
    s_add_u32 s58, s86, s66
    v_mfma_f32_16x16x32_bf16 v[84:87], a[116:119], v[156:159], v[84:87]
    buffer_load_dwordx4 v[148:151], v23, s[24:27], s58 offen offset:0 sc1
    v_mfma_f32_16x16x32_bf16 v[88:91], a[120:123], v[156:159], v[88:91]
    s_waitcnt lgkmcnt(0)
    s_barrier
    v_mfma_f32_16x16x32_bf16 v[92:95], a[124:127], v[156:159], v[92:95]
    s_waitcnt vmcnt(9)
    v_mfma_f32_16x16x32_bf16 v[80:83], a[128:131], v[112:115], v[80:83]
    s_add_u32 s86, s86, 1024
    s_and_b32 s86, s86, 16383
    s_add_u32 s58, s86, s66
    v_mfma_f32_16x16x32_bf16 v[84:87], a[132:135], v[112:115], v[84:87]
    buffer_load_dwordx4 v[152:155], v23, s[24:27], s58 offen offset:0 sc1
    v_mfma_f32_16x16x32_bf16 v[88:91], a[136:139], v[112:115], v[88:91]
    ds_read_b128 v[160:163], v243 offset:0
    ds_read_b128 v[164:167], v243 offset:1024
    v_mfma_f32_16x16x32_bf16 v[92:95], a[140:143], v[112:115], v[92:95]
    ds_read_b128 v[168:171], v243 offset:4096
    s_waitcnt vmcnt(9)
    v_mfma_f32_16x16x32_bf16 v[80:83], a[144:147], v[116:119], v[80:83]
    s_add_u32 s86, s86, 1024
    s_and_b32 s86, s86, 16383
    s_add_u32 s58, s86, s66
    v_mfma_f32_16x16x32_bf16 v[84:87], a[148:151], v[116:119], v[84:87]
    buffer_load_dwordx4 v[156:159], v23, s[24:27], s58 offen offset:0 sc1
    v_mfma_f32_16x16x32_bf16 v[88:91], a[152:155], v[116:119], v[88:91]
    ds_read_b128 v[172:175], v243 offset:5120
    ds_read_b128 v[176:179], v243 offset:8192
    v_mfma_f32_16x16x32_bf16 v[92:95], a[156:159], v[116:119], v[92:95]
    ds_read_b128 v[180:183], v243 offset:9216
    s_waitcnt vmcnt(9)
    v_mfma_f32_16x16x32_bf16 v[80:83], a[160:163], v[120:123], v[80:83]
    s_add_u32 s86, s86, 1024
    s_and_b32 s86, s86, 16383
    s_add_u32 s58, s86, s66
    v_mfma_f32_16x16x32_bf16 v[84:87], a[164:167], v[120:123], v[84:87]
    buffer_load_dwordx4 v[112:115], v23, s[24:27], s58 offen offset:0 sc1
    v_mfma_f32_16x16x32_bf16 v[88:91], a[168:171], v[120:123], v[88:91]
    ds_read_b128 v[184:187], v243 offset:12288
    v_mfma_f32_16x16x32_bf16 v[92:95], a[172:175], v[120:123], v[92:95]
    ds_read_b128 v[188:191], v243 offset:13312
    s_waitcnt vmcnt(9)
    v_mfma_f32_16x16x32_bf16 v[80:83], a[176:179], v[124:127], v[80:83]
    s_add_u32 s86, s86, 1024
    s_and_b32 s86, s86, 16383
    s_add_u32 s58, s86, s66
    v_mfma_f32_16x16x32_bf16 v[84:87], a[180:183], v[124:127], v[84:87]
    buffer_load_dwordx4 v[116:119], v23, s[24:27], s58 offen offset:0 sc1
    v_mfma_f32_16x16x32_bf16 v[88:91], a[184:187], v[124:127], v[88:91]
    v_mfma_f32_16x16x32_bf16 v[92:95], a[188:191], v[124:127], v[92:95]
    s_waitcnt vmcnt(9)
    v_mfma_f32_16x16x32_bf16 v[80:83], a[192:195], v[128:131], v[80:83]
    s_add_u32 s86, s86, 1024
    s_and_b32 s86, s86, 16383
    s_add_u32 s58, s86, s66
    v_mfma_f32_16x16x32_bf16 v[84:87], a[196:199], v[128:131], v[84:87]
    buffer_load_dwordx4 v[120:123], v23, s[24:27], s58 offen offset:0 sc1
    v_mfma_f32_16x16x32_bf16 v[88:91], a[200:203], v[128:131], v[88:91]
    s_waitcnt lgkmcnt(0)
    v_add_f32 v160, v160, v168
    v_mfma_f32_16x16x32_bf16 v[92:95], a[204:207], v[128:131], v[92:95]
    v_add_f32 v161, v161, v169
    s_waitcnt vmcnt(9)
    v_mfma_f32_16x16x32_bf16 v[80:83], a[208:211], v[132:135], v[80:83]
    s_add_u32 s86, s86, 1024
    s_and_b32 s86, s86, 16383
    s_add_u32 s58, s86, s66
    v_mfma_f32_16x16x32_bf16 v[84:87], a[212:215], v[132:135], v[84:87]
    buffer_load_dwordx4 v[124:127], v23, s[24:27], s58 offen offset:0 sc1
    v_mfma_f32_16x16x32_bf16 v[88:91], a[216:219], v[132:135], v[88:91]
    v_add_f32 v162, v162, v170
    v_add_f32 v163, v163, v171
    v_mfma_f32_16x16x32_bf16 v[92:95], a[220:223], v[132:135], v[92:95]
    v_add_f32 v164, v164, v172
    s_waitcnt vmcnt(9)
    v_mfma_f32_16x16x32_bf16 v[80:83], a[224:227], v[136:139], v[80:83]
    s_add_u32 s86, s86, 1024
    s_and_b32 s86, s86, 16383
    s_add_u32 s58, s86, s66
    v_mfma_f32_16x16x32_bf16 v[84:87], a[228:231], v[136:139], v[84:87]
    buffer_load_dwordx4 v[128:131], v23, s[24:27], s58 offen offset:0 sc1
    v_mfma_f32_16x16x32_bf16 v[88:91], a[232:235], v[136:139], v[88:91]
    v_add_f32 v165, v165, v173
    v_add_f32 v166, v166, v174
    v_mfma_f32_16x16x32_bf16 v[92:95], a[236:239], v[136:139], v[92:95]
    v_add_f32 v167, v167, v175
    s_waitcnt vmcnt(9)
    v_mfma_f32_16x16x32_bf16 v[80:83], a[240:243], v[140:143], v[80:83]
    s_add_u32 s86, s86, 1024
    s_and_b32 s86, s86, 16383
    s_add_u32 s58, s86, s66
    v_mfma_f32_16x16x32_bf16 v[84:87], a[244:247], v[140:143], v[84:87]
    buffer_load_dwordx4 v[132:135], v23, s[24:27], s58 offen offset:0 sc1
    v_mfma_f32_16x16x32_bf16 v[88:91], a[248:251], v[140:143], v[88:91]
    v_add_f32 v160, v160, v176
    v_add_f32 v161, v161, v177
    v_mfma_f32_16x16x32_bf16 v[92:95], a[252:255], v[140:143], v[92:95]
    v_add_f32 v162, v162, v178
    s_waitcnt vmcnt(9)
    v_mfma_f32_16x16x32_bf16 v[64:67], a[0:3], v[144:147], 0
    s_add_u32 s86, s86, 1024
    s_and_b32 s86, s86, 16383
    s_add_u32 s58, s86, s66
    v_mfma_f32_16x16x32_bf16 v[68:71], a[4:7], v[144:147], 0
    buffer_load_dwordx4 v[136:139], v23, s[24:27], s58 offen offset:0 sc1
    v_mfma_f32_16x16x32_bf16 v[72:75], a[8:11], v[144:147], 0
    v_mfma_f32_16x16x32_bf16 v[76:79], a[12:15], v[144:147], 0
    s_waitcnt vmcnt(9)
    v_mfma_f32_16x16x32_bf16 v[64:67], a[16:19], v[148:151], v[64:67]
    s_add_u32 s86, s86, 1024
    s_and_b32 s86, s86, 16383
    s_add_u32 s58, s86, s66
    v_mfma_f32_16x16x32_bf16 v[68:71], a[20:23], v[148:151], v[68:71]
    buffer_load_dwordx4 v[140:143], v23, s[24:27], s58 offen offset:0 sc1
    v_mfma_f32_16x16x32_bf16 v[72:75], a[24:27], v[148:151], v[72:75]
    ds_write_b128 v232, v[80:83] offset:32768
    v_mfma_f32_16x16x32_bf16 v[76:79], a[28:31], v[148:151], v[76:79]
    s_waitcnt vmcnt(9)
    v_mfma_f32_16x16x32_bf16 v[64:67], a[32:35], v[152:155], v[64:67]
    s_add_u32 s86, s86, 1024
    s_and_b32 s86, s86, 16383
    s_add_u32 s58, s86, s66
    v_mfma_f32_16x16x32_bf16 v[68:71], a[36:39], v[152:155], v[68:71]
    buffer_load_dwordx4 v[144:147], v23, s[24:27], s58 offen offset:0 sc1
    v_mfma_f32_16x16x32_bf16 v[72:75], a[40:43], v[152:155], v[72:75]
    ds_write_b128 v232, v[84:87] offset:33792
    v_mfma_f32_16x16x32_bf16 v[76:79], a[44:47], v[152:155], v[76:79]
    s_waitcnt vmcnt(9)
    v_mfma_f32_16x16x32_bf16 v[64:67], a[48:51], v[156:159], v[64:67]
    s_add_u32 s86, s86, 1024
    s_and_b32 s86, s86, 16383
    s_add_u32 s58, s86, s66
    ds_write_b128 v232, v[88:91] offset:34816
    v_mfma_f32_16x16x32_bf16 v[68:71], a[52:55], v[156:159], v[68:71]
    buffer_load_dwordx4 v[148:151], v23, s[24:27], s58 offen offset:0 sc1
    v_mfma_f32_16x16x32_bf16 v[72:75], a[56:59], v[156:159], v[72:75]
    v_add_f32 v163, v163, v179
    v_add_f32 v164, v164, v180
    v_mfma_f32_16x16x32_bf16 v[76:79], a[60:63], v[156:159], v[76:79]
    v_add_f32 v165, v165, v181
    s_waitcnt vmcnt(9)
    v_mfma_f32_16x16x32_bf16 v[64:67], a[64:67], v[112:115], v[64:67]
    s_add_u32 s86, s86, 1024
    s_and_b32 s86, s86, 16383
    s_add_u32 s58, s86, s66
    ds_write_b128 v232, v[92:95] offset:35840
    v_mfma_f32_16x16x32_bf16 v[68:71], a[68:71], v[112:115], v[68:71]
    buffer_load_dwordx4 v[152:155], v23, s[24:27], s58 offen offset:0 sc1
    v_mfma_f32_16x16x32_bf16 v[72:75], a[72:75], v[112:115], v[72:75]
    v_add_f32 v166, v166, v182
    v_add_f32 v167, v167, v183
    v_mfma_f32_16x16x32_bf16 v[76:79], a[76:79], v[112:115], v[76:79]
    v_add_f32 v160, v160, v184
    s_waitcnt vmcnt(9)
    v_mfma_f32_16x16x32_bf16 v[64:67], a[80:83], v[116:119], v[64:67]
    s_add_u32 s86, s86, 1024
    s_and_b32 s86, s86, 16383
    s_add_u32 s58, s86, s66
    v_mfma_f32_16x16x32_bf16 v[68:71], a[84:87], v[116:119], v[68:71]
    buffer_load_dwordx4 v[156:159], v23, s[24:27], s58 offen offset:0 sc1
    v_mfma_f32_16x16x32_bf16 v[72:75], a[88:91], v[116:119], v[72:75]
    v_add_f32 v161, v161, v185
    v_add_f32 v162, v162, v186
    v_mfma_f32_16x16x32_bf16 v[76:79], a[92:95], v[116:119], v[76:79]
    v_add_f32 v163, v163, v187
    s_waitcnt vmcnt(9)
    v_mfma_f32_16x16x32_bf16 v[64:67], a[96:99], v[120:123], v[64:67]
    s_xor_b32 s66, s44, 1
    s_lshl2_add_u32 s66, s51, s66
    s_mul_i32 s66, s66, 66816
    s_lshl2_add_u32 s66, s52, s66
    s_lshl_b32 s86, s65, 10
    s_add_u32 s58, s86, s66
    v_mfma_f32_16x16x32_bf16 v[68:71], a[100:103], v[120:123], v[68:71]
    buffer_load_dwordx4 v[112:115], v23, s[24:27], s58 offen offset:0 sc1
    v_mfma_f32_16x16x32_bf16 v[72:75], a[104:107], v[120:123], v[72:75]
    v_add_f32 v164, v164, v188
    v_add_f32 v165, v165, v189
    v_mfma_f32_16x16x32_bf16 v[76:79], a[108:111], v[120:123], v[76:79]
    v_add_f32 v166, v166, v190
    s_waitcnt vmcnt(9)
    v_mfma_f32_16x16x32_bf16 v[64:67], a[112:115], v[124:127], v[64:67]
    s_add_u32 s86, s86, 1024
    s_and_b32 s86, s86, 16383
    s_add_u32 s58, s86, s66
    v_mfma_f32_16x16x32_bf16 v[68:71], a[116:119], v[124:127], v[68:71]
    buffer_load_dwordx4 v[116:119], v23, s[24:27], s58 offen offset:0 sc1
    v_mfma_f32_16x16x32_bf16 v[72:75], a[120:123], v[124:127], v[72:75]
    v_add_f32 v167, v167, v191
    v_mul_f32 v192, v160, v160
    v_mfma_f32_16x16x32_bf16 v[76:79], a[124:127], v[124:127], v[76:79]
    v_mul_f32 v193, v161, v161
    s_waitcnt vmcnt(9)
    v_mfma_f32_16x16x32_bf16 v[64:67], a[128:131], v[128:131], v[64:67]
    s_add_u32 s86, s86, 1024
    s_and_b32 s86, s86, 16383
    s_add_u32 s58, s86, s66
    v_mfma_f32_16x16x32_bf16 v[68:71], a[132:135], v[128:131], v[68:71]
    buffer_load_dwordx4 v[120:123], v23, s[24:27], s58 offen offset:0 sc1
    v_mfma_f32_16x16x32_bf16 v[72:75], a[136:139], v[128:131], v[72:75]
    v_mul_f32 v194, v162, v162
    v_mul_f32 v195, v163, v163
    v_mfma_f32_16x16x32_bf16 v[76:79], a[140:143], v[128:131], v[76:79]
    v_mul_f32 v196, v164, v164
    s_waitcnt vmcnt(9)
    v_mfma_f32_16x16x32_bf16 v[64:67], a[144:147], v[132:135], v[64:67]
    s_add_u32 s86, s86, 1024
    s_and_b32 s86, s86, 16383
    s_add_u32 s58, s86, s66
    v_mfma_f32_16x16x32_bf16 v[68:71], a[148:151], v[132:135], v[68:71]
    buffer_load_dwordx4 v[124:127], v23, s[24:27], s58 offen offset:0 sc1
    v_mfma_f32_16x16x32_bf16 v[72:75], a[152:155], v[132:135], v[72:75]
    v_mul_f32 v197, v165, v165
    v_mul_f32 v198, v166, v166
    v_mfma_f32_16x16x32_bf16 v[76:79], a[156:159], v[132:135], v[76:79]
    v_mul_f32 v199, v167, v167
    s_waitcnt vmcnt(9)
    v_mfma_f32_16x16x32_bf16 v[64:67], a[160:163], v[136:139], v[64:67]
    s_add_u32 s86, s86, 1024
    s_and_b32 s86, s86, 16383
    s_add_u32 s58, s86, s66
    v_mfma_f32_16x16x32_bf16 v[68:71], a[164:167], v[136:139], v[68:71]
    buffer_load_dwordx4 v[128:131], v23, s[24:27], s58 offen offset:0 sc1
    v_mfma_f32_16x16x32_bf16 v[72:75], a[168:171], v[136:139], v[72:75]
    v_fma_f32 v192, v192, v236, v237
    v_fma_f32 v193, v193, v236, v237
    v_mfma_f32_16x16x32_bf16 v[76:79], a[172:175], v[136:139], v[76:79]
    v_fma_f32 v194, v194, v236, v237
    s_waitcnt vmcnt(9)
    v_mfma_f32_16x16x32_bf16 v[64:67], a[176:179], v[140:143], v[64:67]
    s_add_u32 s86, s86, 1024
    s_and_b32 s86, s86, 16383
    s_add_u32 s58, s86, s66
    v_mfma_f32_16x16x32_bf16 v[68:71], a[180:183], v[140:143], v[68:71]
    buffer_load_dwordx4 v[132:135], v23, s[24:27], s58 offen offset:0 sc1
    v_mfma_f32_16x16x32_bf16 v[72:75], a[184:187], v[140:143], v[72:75]
    v_fma_f32 v195, v195, v236, v237
    v_fma_f32 v196, v196, v236, v237
    v_mfma_f32_16x16x32_bf16 v[76:79], a[188:191], v[140:143], v[76:79]
    v_fma_f32 v197, v197, v236, v237
    s_waitcnt vmcnt(9)
    v_mfma_f32_16x16x32_bf16 v[64:67], a[192:195], v[144:147], v[64:67]
    s_add_u32 s86, s86, 1024
    s_and_b32 s86, s86, 16383
    s_add_u32 s58, s86, s66
    v_mfma_f32_16x16x32_bf16 v[68:71], a[196:199], v[144:147], v[68:71]
    buffer_load_dwordx4 v[136:139], v23, s[24:27], s58 offen offset:0 sc1
    v_mfma_f32_16x16x32_bf16 v[72:75], a[200:203], v[144:147], v[72:75]
    v_fma_f32 v198, v198, v236, v237
    v_fma_f32 v199, v199, v236, v237
    v_mfma_f32_16x16x32_bf16 v[76:79], a[204:207], v[144:147], v[76:79]
    v_mul_f32 v192, v192, v160
    s_waitcnt vmcnt(9)
    v_mfma_f32_16x16x32_bf16 v[64:67], a[208:211], v[148:151], v[64:67]
    s_add_u32 s86, s86, 1024
    s_and_b32 s86, s86, 16383
    s_add_u32 s58, s86, s66
    v_mfma_f32_16x16x32_bf16 v[68:71], a[212:215], v[148:151], v[68:71]
    buffer_load_dwordx4 v[140:143], v23, s[24:27], s58 offen offset:0 sc1
    v_mfma_f32_16x16x32_bf16 v[72:75], a[216:219], v[148:151], v[72:75]
    v_mul_f32 v193, v193, v161
    v_mul_f32 v194, v194, v162
    v_mfma_f32_16x16x32_bf16 v[76:79], a[220:223], v[148:151], v[76:79]
    v_mul_f32 v195, v195, v163
    s_waitcnt vmcnt(9)
    v_mfma_f32_16x16x32_bf16 v[64:67], a[224:227], v[152:155], v[64:67]
    s_add_u32 s86, s86, 1024
    s_and_b32 s86, s86, 16383
    s_add_u32 s58, s86, s66
    v_mfma_f32_16x16x32_bf16 v[68:71], a[228:231], v[152:155], v[68:71]
    buffer_load_dwordx4 v[144:147], v23, s[24:27], s58 offen offset:0 sc1
    v_mfma_f32_16x16x32_bf16 v[72:75], a[232:235], v[152:155], v[72:75]
    v_mul_f32 v196, v196, v164
    v_mul_f32 v197, v197, v165
    v_mfma_f32_16x16x32_bf16 v[76:79], a[236:239], v[152:155], v[76:79]
    v_mul_f32 v198, v198, v166
    s_waitcnt vmcnt(9)
    v_mfma_f32_16x16x32_bf16 v[64:67], a[240:243], v[156:159], v[64:67]
    s_add_u32 s86, s86, 1024
    s_and_b32 s86, s86, 16383
    s_add_u32 s58, s86, s66
    v_mfma_f32_16x16x32_bf16 v[68:71], a[244:247], v[156:159], v[68:71]
    buffer_load_dwordx4 v[148:151], v23, s[24:27], s58 offen offset:0 sc1
    v_mfma_f32_16x16x32_bf16 v[72:75], a[248:251], v[156:159], v[72:75]
    v_mul_f32 v199, v199, v167
    v_mfma_f32_16x16x32_bf16 v[76:79], a[252:255], v[156:159], v[76:79]
    s_waitcnt vmcnt(9)
    v_mfma_f32_16x16x32_bf16 v[48:51], a[0:3], v[112:115], 0
    s_add_u32 s86, s86, 1024
    s_and_b32 s86, s86, 16383
    s_add_u32 s58, s86, s66
    v_mfma_f32_16x16x32_bf16 v[52:55], a[4:7], v[112:115], 0
    buffer_load_dwordx4 v[152:155], v23, s[24:27], s58 offen offset:0 sc1
    v_mfma_f32_16x16x32_bf16 v[56:59], a[8:11], v[112:115], 0
    v_mfma_f32_16x16x32_bf16 v[60:63], a[12:15], v[112:115], 0
    s_waitcnt vmcnt(9)
    v_mfma_f32_16x16x32_bf16 v[48:51], a[16:19], v[116:119], v[48:51]
    s_add_u32 s86, s86, 1024
    s_and_b32 s86, s86, 16383
    s_add_u32 s58, s86, s66
    v_mfma_f32_16x16x32_bf16 v[52:55], a[20:23], v[116:119], v[52:55]
    buffer_load_dwordx4 v[156:159], v23, s[24:27], s58 offen offset:0 sc1
    v_mfma_f32_16x16x32_bf16 v[56:59], a[24:27], v[116:119], v[56:59]
    ds_write_b128 v232, v[64:67] offset:16384
    v_mfma_f32_16x16x32_bf16 v[60:63], a[28:31], v[116:119], v[60:63]
    s_waitcnt vmcnt(9)
    v_mfma_f32_16x16x32_bf16 v[48:51], a[32:35], v[120:123], v[48:51]
    s_add_u32 s86, s86, 1024
    s_and_b32 s86, s86, 16383
    s_add_u32 s58, s86, s66
    v_mfma_f32_16x16x32_bf16 v[52:55], a[36:39], v[120:123], v[52:55]
    buffer_load_dwordx4 v[112:115], v23, s[24:27], s58 offen offset:0 sc1
    v_mfma_f32_16x16x32_bf16 v[56:59], a[40:43], v[120:123], v[56:59]
    ds_write_b128 v232, v[68:71] offset:17408
    v_mfma_f32_16x16x32_bf16 v[60:63], a[44:47], v[120:123], v[60:63]
    s_waitcnt vmcnt(9)
    v_mfma_f32_16x16x32_bf16 v[48:51], a[48:51], v[124:127], v[48:51]
    s_add_u32 s86, s86, 1024
    s_and_b32 s86, s86, 16383
    s_add_u32 s58, s86, s66
    ds_write_b128 v232, v[72:75] offset:18432
    v_mfma_f32_16x16x32_bf16 v[52:55], a[52:55], v[124:127], v[52:55]
    buffer_load_dwordx4 v[116:119], v23, s[24:27], s58 offen offset:0 sc1
    v_mfma_f32_16x16x32_bf16 v[56:59], a[56:59], v[124:127], v[56:59]
    v_exp_f32 v192, v192
    v_exp_f32 v193, v193
    v_mfma_f32_16x16x32_bf16 v[60:63], a[60:63], v[124:127], v[60:63]
    v_exp_f32 v194, v194
    s_waitcnt vmcnt(9)
    v_mfma_f32_16x16x32_bf16 v[48:51], a[64:67], v[128:131], v[48:51]
    s_add_u32 s86, s86, 1024
    s_and_b32 s86, s86, 16383
    s_add_u32 s58, s86, s66
    ds_write_b128 v232, v[76:79] offset:19456
    v_mfma_f32_16x16x32_bf16 v[52:55], a[68:71], v[128:131], v[52:55]
    buffer_load_dwordx4 v[120:123], v23, s[24:27], s58 offen offset:0 sc1
    v_mfma_f32_16x16x32_bf16 v[56:59], a[72:75], v[128:131], v[56:59]
    v_exp_f32 v195, v195
    v_exp_f32 v196, v196
    v_mfma_f32_16x16x32_bf16 v[60:63], a[76:79], v[128:131], v[60:63]
    v_exp_f32 v197, v197
    s_waitcnt vmcnt(9)
    v_mfma_f32_16x16x32_bf16 v[48:51], a[80:83], v[132:135], v[48:51]
    s_add_u32 s86, s86, 1024
    s_and_b32 s86, s86, 16383
    s_add_u32 s58, s86, s66
    v_mfma_f32_16x16x32_bf16 v[52:55], a[84:87], v[132:135], v[52:55]
    buffer_load_dwordx4 v[124:127], v23, s[24:27], s58 offen offset:0 sc1
    v_mfma_f32_16x16x32_bf16 v[56:59], a[88:91], v[132:135], v[56:59]
    v_exp_f32 v198, v198
    v_exp_f32 v199, v199
    v_mfma_f32_16x16x32_bf16 v[60:63], a[92:95], v[132:135], v[60:63]
    v_add_f32 v192, 1.0, v192
    s_waitcnt vmcnt(9)
    v_mfma_f32_16x16x32_bf16 v[48:51], a[96:99], v[136:139], v[48:51]
    s_xor_b32 s66, s44, 0
    s_lshl2_add_u32 s66, s51, s66
    s_mul_i32 s66, s66, 66816
    s_lshl2_add_u32 s66, s52, s66
    s_lshl_b32 s86, s65, 10
    s_add_u32 s58, s86, s66
    v_mfma_f32_16x16x32_bf16 v[52:55], a[100:103], v[136:139], v[52:55]
    buffer_load_dwordx4 v[128:131], v23, s[24:27], s58 offen offset:0 sc1
    v_mfma_f32_16x16x32_bf16 v[56:59], a[104:107], v[136:139], v[56:59]
    v_add_f32 v193, 1.0, v193
    v_add_f32 v194, 1.0, v194
    v_mfma_f32_16x16x32_bf16 v[60:63], a[108:111], v[136:139], v[60:63]
    v_add_f32 v195, 1.0, v195
    s_waitcnt vmcnt(9)
    v_mfma_f32_16x16x32_bf16 v[48:51], a[112:115], v[140:143], v[48:51]
    s_add_u32 s86, s86, 1024
    s_and_b32 s86, s86, 16383
    s_add_u32 s58, s86, s66
    v_mfma_f32_16x16x32_bf16 v[52:55], a[116:119], v[140:143], v[52:55]
    buffer_load_dwordx4 v[132:135], v23, s[24:27], s58 offen offset:0 sc1
    v_mfma_f32_16x16x32_bf16 v[56:59], a[120:123], v[140:143], v[56:59]
    v_add_f32 v196, 1.0, v196
    v_add_f32 v197, 1.0, v197
    v_mfma_f32_16x16x32_bf16 v[60:63], a[124:127], v[140:143], v[60:63]
    v_add_f32 v198, 1.0, v198
    s_waitcnt vmcnt(9)
    v_mfma_f32_16x16x32_bf16 v[48:51], a[128:131], v[144:147], v[48:51]
    s_add_u32 s86, s86, 1024
    s_and_b32 s86, s86, 16383
    s_add_u32 s58, s86, s66
    v_mfma_f32_16x16x32_bf16 v[52:55], a[132:135], v[144:147], v[52:55]
    buffer_load_dwordx4 v[136:139], v23, s[24:27], s58 offen offset:0 sc1
    v_mfma_f32_16x16x32_bf16 v[56:59], a[136:139], v[144:147], v[56:59]
    v_add_f32 v199, 1.0, v199
    v_rcp_f32 v192, v192
    v_mfma_f32_16x16x32_bf16 v[60:63], a[140:143], v[144:147], v[60:63]
    v_rcp_f32 v193, v193
    s_waitcnt vmcnt(9)
    v_mfma_f32_16x16x32_bf16 v[48:51], a[144:147], v[148:151], v[48:51]
    s_add_u32 s86, s86, 1024
    s_and_b32 s86, s86, 16383
    s_add_u32 s58, s86, s66
    v_mfma_f32_16x16x32_bf16 v[52:55], a[148:151], v[148:151], v[52:55]
    buffer_load_dwordx4 v[140:143], v23, s[24:27], s58 offen offset:0 sc1
    v_mfma_f32_16x16x32_bf16 v[56:59], a[152:155], v[148:151], v[56:59]
    v_rcp_f32 v194, v194
    v_rcp_f32 v195, v195
    v_mfma_f32_16x16x32_bf16 v[60:63], a[156:159], v[148:151], v[60:63]
    v_rcp_f32 v196, v196
    s_waitcnt vmcnt(9)
    v_mfma_f32_16x16x32_bf16 v[48:51], a[160:163], v[152:155], v[48:51]
    s_add_u32 s86, s86, 1024
    s_and_b32 s86, s86, 16383
    s_add_u32 s58, s86, s66
    v_mfma_f32_16x16x32_bf16 v[52:55], a[164:167], v[152:155], v[52:55]
    buffer_load_dwordx4 v[144:147], v23, s[24:27], s58 offen offset:0 sc1
    v_mfma_f32_16x16x32_bf16 v[56:59], a[168:171], v[152:155], v[56:59]
    v_rcp_f32 v197, v197
    v_rcp_f32 v198, v198
    v_mfma_f32_16x16x32_bf16 v[60:63], a[172:175], v[152:155], v[60:63]
    v_rcp_f32 v199, v199
    s_waitcnt vmcnt(9)
    v_mfma_f32_16x16x32_bf16 v[48:51], a[176:179], v[156:159], v[48:51]
    s_add_u32 s86, s86, 1024
    s_and_b32 s86, s86, 16383
    s_add_u32 s58, s86, s66
    v_mfma_f32_16x16x32_bf16 v[52:55], a[180:183], v[156:159], v[52:55]
    buffer_load_dwordx4 v[148:151], v23, s[24:27], s58 offen offset:0 sc1
    v_mfma_f32_16x16x32_bf16 v[56:59], a[184:187], v[156:159], v[56:59]
    v_mul_f32 v192, v192, v160
    v_mul_f32 v193, v193, v161
    v_mfma_f32_16x16x32_bf16 v[60:63], a[188:191], v[156:159], v[60:63]
    v_mul_f32 v194, v194, v162
    s_waitcnt vmcnt(9)
    v_mfma_f32_16x16x32_bf16 v[48:51], a[192:195], v[112:115], v[48:51]
    s_add_u32 s86, s86, 1024
    s_and_b32 s86, s86, 16383
    s_add_u32 s58, s86, s66
    v_mfma_f32_16x16x32_bf16 v[52:55], a[196:199], v[112:115], v[52:55]
    buffer_load_dwordx4 v[152:155], v23, s[24:27], s58 offen offset:0 sc1
    v_mfma_f32_16x16x32_bf16 v[56:59], a[200:203], v[112:115], v[56:59]
    v_mul_f32 v195, v195, v163
    v_mul_f32 v196, v196, v164
    v_mfma_f32_16x16x32_bf16 v[60:63], a[204:207], v[112:115], v[60:63]
    v_mul_f32 v197, v197, v165
    s_waitcnt vmcnt(9)
    v_mfma_f32_16x16x32_bf16 v[48:51], a[208:211], v[116:119], v[48:51]
    s_add_u32 s86, s86, 1024
    s_and_b32 s86, s86, 16383
    s_add_u32 s58, s86, s66
    v_mfma_f32_16x16x32_bf16 v[52:55], a[212:215], v[116:119], v[52:55]
    buffer_load_dwordx4 v[156:159], v23, s[24:27], s58 offen offset:0 sc1
    v_mfma_f32_16x16x32_bf16 v[56:59], a[216:219], v[116:119], v[56:59]
    v_mul_f32 v198, v198, v166
    v_mul_f32 v199, v199, v167
    v_mfma_f32_16x16x32_bf16 v[60:63], a[220:223], v[116:119], v[60:63]
    v_cvt_pk_bf16_f32 v96, v192, v193
    s_waitcnt vmcnt(9)
    v_mfma_f32_16x16x32_bf16 v[48:51], a[224:227], v[120:123], v[48:51]
    s_add_u32 s86, s86, 1024
    s_and_b32 s86, s86, 16383
    s_add_u32 s58, s86, s66
    v_mfma_f32_16x16x32_bf16 v[52:55], a[228:231], v[120:123], v[52:55]
    buffer_load_dwordx4 v[112:115], v23, s[24:27], s58 offen offset:0 sc1
    v_mfma_f32_16x16x32_bf16 v[56:59], a[232:235], v[120:123], v[56:59]
    v_cvt_pk_bf16_f32 v97, v194, v195
    v_cvt_pk_bf16_f32 v98, v196, v197
    v_mfma_f32_16x16x32_bf16 v[60:63], a[236:239], v[120:123], v[60:63]
    v_cvt_pk_bf16_f32 v99, v198, v199
    s_waitcnt vmcnt(9)
    v_mfma_f32_16x16x32_bf16 v[48:51], a[240:243], v[124:127], v[48:51]
    s_add_u32 s86, s86, 1024
    s_and_b32 s86, s86, 16383
    s_add_u32 s58, s86, s66
    v_mfma_f32_16x16x32_bf16 v[52:55], a[244:247], v[124:127], v[52:55]
    buffer_load_dwordx4 v[116:119], v23, s[24:27], s58 offen offset:0 sc1
    v_mfma_f32_16x16x32_bf16 v[56:59], a[248:251], v[124:127], v[56:59]
    v_mfma_f32_16x16x32_bf16 v[60:63], a[252:255], v[124:127], v[60:63]
    s_waitcnt vmcnt(9)
    v_mfma_f32_16x16x32_bf16 v[32:35], a[0:3], v[128:131], v[32:35]
    s_add_u32 s86, s86, 1024
    s_and_b32 s86, s86, 16383
    s_add_u32 s58, s86, s66
    v_mfma_f32_16x16x32_bf16 v[36:39], a[4:7], v[128:131], v[36:39]
    buffer_load_dwordx4 v[120:123], v23, s[24:27], s58 offen offset:0 sc1
    v_mfma_f32_16x16x32_bf16 v[40:43], a[8:11], v[128:131], v[40:43]
    v_mfma_f32_16x16x32_bf16 v[44:47], a[12:15], v[128:131], v[44:47]
    s_waitcnt vmcnt(9)
    v_mfma_f32_16x16x32_bf16 v[32:35], a[16:19], v[132:135], v[32:35]
    s_add_u32 s86, s86, 1024
    s_and_b32 s86, s86, 16383
    s_add_u32 s58, s86, s66
    v_mfma_f32_16x16x32_bf16 v[36:39], a[20:23], v[132:135], v[36:39]
    buffer_load_dwordx4 v[124:127], v23, s[24:27], s58 offen offset:0 sc1
    v_mfma_f32_16x16x32_bf16 v[40:43], a[24:27], v[132:135], v[40:43]
    ds_write_b128 v232, v[48:51] offset:0
    v_mfma_f32_16x16x32_bf16 v[44:47], a[28:31], v[132:135], v[44:47]
    ds_write_b128 v232, v[52:55] offset:1024
    s_waitcnt vmcnt(9)
    v_mfma_f32_16x16x32_bf16 v[32:35], a[32:35], v[136:139], v[32:35]
    s_add_u32 s86, s86, 1024
    s_and_b32 s86, s86, 16383
    s_add_u32 s58, s86, s66
    v_mfma_f32_16x16x32_bf16 v[36:39], a[36:39], v[136:139], v[36:39]
    buffer_load_dwordx4 v[128:131], v23, s[24:27], s58 offen offset:0 sc1
    v_mfma_f32_16x16x32_bf16 v[40:43], a[40:43], v[136:139], v[40:43]
    ds_write_b128 v232, v[56:59] offset:2048
    v_mfma_f32_16x16x32_bf16 v[44:47], a[44:47], v[136:139], v[44:47]
    ds_write_b128 v232, v[60:63] offset:3072
    s_waitcnt vmcnt(9)
    v_mfma_f32_16x16x32_bf16 v[32:35], a[48:51], v[140:143], v[32:35]
    s_add_u32 s86, s86, 1024
    s_and_b32 s86, s86, 16383
    s_add_u32 s58, s86, s66
    v_mfma_f32_16x16x32_bf16 v[36:39], a[52:55], v[140:143], v[36:39]
    buffer_load_dwordx4 v[132:135], v23, s[24:27], s58 offen offset:0 sc1
    v_mfma_f32_16x16x32_bf16 v[40:43], a[56:59], v[140:143], v[40:43]
    v_mfma_f32_16x16x32_bf16 v[44:47], a[60:63], v[140:143], v[44:47]
    s_waitcnt vmcnt(9)
    v_mfma_f32_16x16x32_bf16 v[32:35], a[64:67], v[144:147], v[32:35]
    s_add_u32 s86, s86, 1024
    s_and_b32 s86, s86, 16383
    s_add_u32 s58, s86, s66
    v_mfma_f32_16x16x32_bf16 v[36:39], a[68:71], v[144:147], v[36:39]
    buffer_load_dwordx4 v[136:139], v23, s[24:27], s58 offen offset:0 sc1
    v_mfma_f32_16x16x32_bf16 v[40:43], a[72:75], v[144:147], v[40:43]
    v_mfma_f32_16x16x32_bf16 v[44:47], a[76:79], v[144:147], v[44:47]
    s_waitcnt vmcnt(9)
    v_mfma_f32_16x16x32_bf16 v[32:35], a[80:83], v[148:151], v[32:35]
    s_add_u32 s86, s86, 1024
    s_and_b32 s86, s86, 16383
    s_add_u32 s58, s86, s66
    v_mfma_f32_16x16x32_bf16 v[36:39], a[84:87], v[148:151], v[36:39]
    buffer_load_dwordx4 v[140:143], v23, s[24:27], s58 offen offset:0 sc1
    v_mfma_f32_16x16x32_bf16 v[40:43], a[88:91], v[148:151], v[40:43]
    s_waitcnt lgkmcnt(0)
    s_barrier
    v_mfma_f32_16x16x32_bf16 v[44:47], a[92:95], v[148:151], v[44:47]
    buffer_load_dwordx4 v[216:219], v22, s[4:7], s71 offen
    s_waitcnt vmcnt(10)
    v_mfma_f32_16x16x32_bf16 v[32:35], a[96:99], v[152:155], v[32:35]
    ds_read_b128 v[160:163], v233 offset:0
    v_mfma_f32_16x16x32_bf16 v[36:39], a[100:103], v[152:155], v[36:39]
    ds_read_b128 v[176:179], v234 offset:16384
    v_mfma_f32_16x16x32_bf16 v[40:43], a[104:107], v[152:155], v[40:43]
    ds_read_b128 v[192:195], v235 offset:32768
    v_mfma_f32_16x16x32_bf16 v[44:47], a[108:111], v[152:155], v[44:47]
    buffer_load_dwordx4 v[220:223], v22, s[4:7], s72 offen
    s_waitcnt vmcnt(10)
    v_mfma_f32_16x16x32_bf16 v[32:35], a[112:115], v[156:159], v[32:35]
    ds_read_b128 v[164:167], v233 offset:1024
    v_mfma_f32_16x16x32_bf16 v[36:39], a[116:119], v[156:159], v[36:39]
    ds_read_b128 v[180:183], v234 offset:17408
    v_mfma_f32_16x16x32_bf16 v[40:43], a[120:123], v[156:159], v[40:43]
    ds_read_b128 v[196:199], v235 offset:33792
    v_mfma_f32_16x16x32_bf16 v[44:47], a[124:127], v[156:159], v[44:47]
    buffer_load_dwordx2 v[226:227], v26, s[4:7], s73 offen
    s_waitcnt vmcnt(10)
    v_mfma_f32_16x16x32_bf16 v[32:35], a[128:131], v[112:115], v[32:35]
    ds_read_b128 v[168:171], v233 offset:2048
    v_mfma_f32_16x16x32_bf16 v[36:39], a[132:135], v[112:115], v[36:39]
    ds_read_b128 v[184:187], v234 offset:18432
    v_mfma_f32_16x16x32_bf16 v[40:43], a[136:139], v[112:115], v[40:43]
    ds_read_b128 v[200:203], v235 offset:34816
    v_mfma_f32_16x16x32_bf16 v[44:47], a[140:143], v[112:115], v[44:47]
    buffer_load_ushort v224, v25, s[36:39], s74 offen
    s_waitcnt vmcnt(10)
    v_mfma_f32_16x16x32_bf16 v[32:35], a[144:147], v[116:119], v[32:35]
    ds_read_b128 v[172:175], v233 offset:3072
    v_mfma_f32_16x16x32_bf16 v[36:39], a[148:151], v[116:119], v[36:39]
    ds_read_b128 v[188:191], v234 offset:19456
    v_mfma_f32_16x16x32_bf16 v[40:43], a[152:155], v[116:119], v[40:43]
    ds_read_b128 v[204:207], v235 offset:35840
    v_mfma_f32_16x16x32_bf16 v[44:47], a[156:159], v[116:119], v[44:47]
    buffer_load_ushort v225, v25, s[36:39], s74 offen offset:64
    s_waitcnt vmcnt(10)
    v_mfma_f32_16x16x32_bf16 v[32:35], a[160:163], v[120:123], v[32:35]
    v_mfma_f32_16x16x32_bf16 v[36:39], a[164:167], v[120:123], v[36:39]
    v_mfma_f32_16x16x32_bf16 v[40:43], a[168:171], v[120:123], v[40:43]
    v_mfma_f32_16x16x32_bf16 v[44:47], a[172:175], v[120:123], v[44:47]
    buffer_load_ushort v228, v27, s[36:39], s74 offen
    s_waitcnt vmcnt(10)
    v_mfma_f32_16x16x32_bf16 v[32:35], a[176:179], v[124:127], v[32:35]
    s_waitcnt lgkmcnt(9)
    v_mfma_f32_16x16x32_bf16 v[36:39], a[180:183], v[124:127], v[36:39]
    v_add_f32 v160, v160, v176
    v_mfma_f32_16x16x32_bf16 v[40:43], a[184:187], v[124:127], v[40:43]
    v_add_f32 v161, v161, v177
    v_mfma_f32_16x16x32_bf16 v[44:47], a[188:191], v[124:127], v[44:47]
    v_add_f32 v162, v162, v178
    s_add_u32 m0, s52, 81920
    s_lshl_b32 s57, s76, 7
    buffer_load_dwordx4 v12, s[20:23], s57 offen offset:0 lds
    s_waitcnt vmcnt(10)
    v_mfma_f32_16x16x32_bf16 v[32:35], a[192:195], v[128:131], v[32:35]
    v_add_f32 v163, v163, v179
    v_mfma_f32_16x16x32_bf16 v[36:39], a[196:199], v[128:131], v[36:39]
    s_waitcnt lgkmcnt(6)
    v_mfma_f32_16x16x32_bf16 v[40:43], a[200:203], v[128:131], v[40:43]
    v_add_f32 v164, v164, v180
    v_mfma_f32_16x16x32_bf16 v[44:47], a[204:207], v[128:131], v[44:47]
    v_add_f32 v165, v165, v181
    s_add_u32 s57, s57, 31744
    buffer_load_dwordx4 v12, s[20:23], s57 offen offset:1024 lds
    s_waitcnt vmcnt(10)
    v_mfma_f32_16x16x32_bf16 v[32:35], a[208:211], v[132:135], v[32:35]
    v_add_f32 v166, v166, v182
    v_mfma_f32_16x16x32_bf16 v[36:39], a[212:215], v[132:135], v[36:39]
    v_add_f32 v167, v167, v183
    v_mfma_f32_16x16x32_bf16 v[40:43], a[216:219], v[132:135], v[40:43]
    s_waitcnt lgkmcnt(3)
    v_mfma_f32_16x16x32_bf16 v[44:47], a[220:223], v[132:135], v[44:47]
    v_add_f32 v168, v168, v184
    s_add_u32 s57, s57, 31744
    buffer_load_dwordx4 v12, s[20:23], s57 offen offset:2048 lds
    s_waitcnt vmcnt(10)
    v_mfma_f32_16x16x32_bf16 v[32:35], a[224:227], v[136:139], v[32:35]
    v_add_f32 v169, v169, v185
    v_mfma_f32_16x16x32_bf16 v[36:39], a[228:231], v[136:139], v[36:39]
    v_add_f32 v170, v170, v186
    v_mfma_f32_16x16x32_bf16 v[40:43], a[232:235], v[136:139], v[40:43]
    v_add_f32 v171, v171, v187
    v_mfma_f32_16x16x32_bf16 v[44:47], a[236:239], v[136:139], v[44:47]
    s_waitcnt lgkmcnt(0)
    s_add_u32 s57, s57, 31744
    buffer_load_dwordx4 v12, s[20:23], s57 offen offset:3072 lds
    s_waitcnt vmcnt(10)
    v_mfma_f32_16x16x32_bf16 v[32:35], a[240:243], v[140:143], v[32:35]
    v_add_f32 v172, v172, v188
    v_mfma_f32_16x16x32_bf16 v[36:39], a[244:247], v[140:143], v[36:39]
    v_add_f32 v173, v173, v189
    v_mfma_f32_16x16x32_bf16 v[40:43], a[248:251], v[140:143], v[40:43]
    v_add_f32 v174, v174, v190
    v_mfma_f32_16x16x32_bf16 v[44:47], a[252:255], v[140:143], v[44:47]
    v_add_f32 v175, v175, v191
    v_pk_add_f32 v[160:161], v[160:161], v[192:193]
    v_pk_add_f32 v[162:163], v[162:163], v[194:195]
    v_pk_add_f32 v[164:165], v[164:165], v[196:197]
    v_pk_add_f32 v[166:167], v[166:167], v[198:199]
    v_pk_add_f32 v[168:169], v[168:169], v[200:201]
    v_pk_add_f32 v[170:171], v[170:171], v[202:203]
    v_pk_add_f32 v[172:173], v[172:173], v[204:205]
    v_pk_add_f32 v[174:175], v[174:175], v[206:207]
    buffer_store_dwordx4 v[96:99], v23, s[24:27], s83 offen sc1
    s_add_u32 m0, s52, 98304
    s_lshl_b32 s57, s76, 7
    s_add_u32 s57, s57, 131072
    buffer_load_dwordx4 v12, s[20:23], s57 offen offset:0 lds
    v_pk_add_f32 v[32:33], v[32:33], v[160:161]
    v_pk_add_f32 v[34:35], v[34:35], v[162:163]
    v_pk_add_f32 v[36:37], v[36:37], v[164:165]
    v_pk_add_f32 v[38:39], v[38:39], v[166:167]
    v_pk_mul_f32 v[48:49], v[32:33], v[32:33]
    v_pk_mul_f32 v[50:51], v[34:35], v[34:35]
    v_pk_mul_f32 v[52:53], v[36:37], v[36:37]
    v_pk_mul_f32 v[54:55], v[38:39], v[38:39]
    s_add_u32 s57, s57, 31744
    buffer_load_dwordx4 v12, s[20:23], s57 offen offset:1024 lds
    v_pk_fma_f32 v[48:49], v[48:49], v[236:237], v[236:237] op_sel:[0,0,1] op_sel_hi:[1,0,1]
    v_pk_fma_f32 v[50:51], v[50:51], v[236:237], v[236:237] op_sel:[0,0,1] op_sel_hi:[1,0,1]
    v_pk_fma_f32 v[52:53], v[52:53], v[236:237], v[236:237] op_sel:[0,0,1] op_sel_hi:[1,0,1]
    v_pk_fma_f32 v[54:55], v[54:55], v[236:237], v[236:237] op_sel:[0,0,1] op_sel_hi:[1,0,1]
    v_pk_mul_f32 v[48:49], v[48:49], v[32:33]
    v_pk_mul_f32 v[50:51], v[50:51], v[34:35]
    v_pk_mul_f32 v[52:53], v[52:53], v[36:37]
    v_pk_mul_f32 v[54:55], v[54:55], v[38:39]
    s_add_u32 s57, s57, 31744
    buffer_load_dwordx4 v12, s[20:23], s57 offen offset:2048 lds
    v_exp_f32 v48, v48
    v_exp_f32 v49, v49
    v_exp_f32 v50, v50
    v_exp_f32 v51, v51
    v_exp_f32 v52, v52
    v_exp_f32 v53, v53
    v_exp_f32 v54, v54
    v_exp_f32 v55, v55
    v_pk_add_f32 v[48:49], v[48:49], 1.0 op_sel_hi:[1,0]
    v_pk_add_f32 v[50:51], v[50:51], 1.0 op_sel_hi:[1,0]
    v_pk_add_f32 v[52:53], v[52:53], 1.0 op_sel_hi:[1,0]
    v_pk_add_f32 v[54:55], v[54:55], 1.0 op_sel_hi:[1,0]
    s_add_u32 s57, s57, 31744
    buffer_load_dwordx4 v12, s[20:23], s57 offen offset:3072 lds
    v_rcp_f32 v48, v48
    v_rcp_f32 v49, v49
    v_rcp_f32 v50, v50
    v_rcp_f32 v51, v51
    v_rcp_f32 v52, v52
    v_rcp_f32 v53, v53
    v_rcp_f32 v54, v54
    v_rcp_f32 v55, v55
    s_add_u32 m0, s52, 114688
    s_lshl_b32 s57, s77, 7
    buffer_load_dwordx4 v12, s[20:23], s57 offen offset:0 lds
    v_pk_mul_f32 v[48:49], v[48:49], v[32:33]
    v_pk_mul_f32 v[50:51], v[50:51], v[34:35]
    v_pk_mul_f32 v[52:53], v[52:53], v[36:37]
    v_pk_mul_f32 v[54:55], v[54:55], v[38:39]
    v_cvt_pk_bf16_f32 v56, v48, v49
    v_cvt_pk_bf16_f32 v57, v50, v51
    v_cvt_pk_bf16_f32 v58, v52, v53
    v_cvt_pk_bf16_f32 v59, v54, v55
    buffer_store_dwordx4 v[56:59], v23, s[24:27], s67 offen offset:0 sc1
    v_pk_add_f32 v[40:41], v[40:41], v[168:169]
    v_pk_add_f32 v[42:43], v[42:43], v[170:171]
    v_pk_add_f32 v[44:45], v[44:45], v[172:173]
    v_pk_add_f32 v[46:47], v[46:47], v[174:175]
    s_add_u32 s57, s57, 31744
    buffer_load_dwordx4 v12, s[20:23], s57 offen offset:1024 lds
    v_pk_mul_f32 v[48:49], v[40:41], v[40:41]
    v_pk_mul_f32 v[50:51], v[42:43], v[42:43]
    v_pk_mul_f32 v[52:53], v[44:45], v[44:45]
    v_pk_mul_f32 v[54:55], v[46:47], v[46:47]
    v_pk_fma_f32 v[48:49], v[48:49], v[236:237], v[236:237] op_sel:[0,0,1] op_sel_hi:[1,0,1]
    v_pk_fma_f32 v[50:51], v[50:51], v[236:237], v[236:237] op_sel:[0,0,1] op_sel_hi:[1,0,1]
    v_pk_fma_f32 v[52:53], v[52:53], v[236:237], v[236:237] op_sel:[0,0,1] op_sel_hi:[1,0,1]
    v_pk_fma_f32 v[54:55], v[54:55], v[236:237], v[236:237] op_sel:[0,0,1] op_sel_hi:[1,0,1]
    s_add_u32 s57, s57, 31744
    buffer_load_dwordx4 v12, s[20:23], s57 offen offset:2048 lds
    v_pk_mul_f32 v[48:49], v[48:49], v[40:41]
    v_pk_mul_f32 v[50:51], v[50:51], v[42:43]
    v_pk_mul_f32 v[52:53], v[52:53], v[44:45]
    v_pk_mul_f32 v[54:55], v[54:55], v[46:47]
    v_exp_f32 v48, v48
    v_exp_f32 v49, v49
    v_exp_f32 v50, v50
    v_exp_f32 v51, v51
    v_exp_f32 v52, v52
    v_exp_f32 v53, v53
    v_exp_f32 v54, v54
    v_exp_f32 v55, v55
    s_add_u32 s57, s57, 31744
    buffer_load_dwordx4 v12, s[20:23], s57 offen offset:3072 lds
    v_pk_add_f32 v[48:49], v[48:49], 1.0 op_sel_hi:[1,0]
    v_pk_add_f32 v[50:51], v[50:51], 1.0 op_sel_hi:[1,0]
    v_pk_add_f32 v[52:53], v[52:53], 1.0 op_sel_hi:[1,0]
    v_pk_add_f32 v[54:55], v[54:55], 1.0 op_sel_hi:[1,0]
    v_rcp_f32 v48, v48
    v_rcp_f32 v49, v49
    v_rcp_f32 v50, v50
    v_rcp_f32 v51, v51
    s_add_u32 m0, s52, 131072
    s_lshl_b32 s57, s77, 7
    s_add_u32 s57, s57, 131072
    buffer_load_dwordx4 v12, s[20:23], s57 offen offset:0 lds
    v_rcp_f32 v52, v52
    v_rcp_f32 v53, v53
    v_rcp_f32 v54, v54
    v_rcp_f32 v55, v55
    v_pk_mul_f32 v[48:49], v[48:49], v[40:41]
    v_pk_mul_f32 v[50:51], v[50:51], v[42:43]
    v_pk_mul_f32 v[52:53], v[52:53], v[44:45]
    v_pk_mul_f32 v[54:55], v[54:55], v[46:47]
    v_cvt_pk_bf16_f32 v60, v48, v49
    v_cvt_pk_bf16_f32 v61, v50, v51
    v_cvt_pk_bf16_f32 v62, v52, v53
    v_cvt_pk_bf16_f32 v63, v54, v55
    buffer_store_dwordx4 v[60:63], v23, s[24:27], s67 offen offset:1024 sc1
    s_add_u32 s57, s57, 31744
    buffer_load_dwordx4 v12, s[20:23], s57 offen offset:1024 lds
    s_waitcnt vmcnt(13)
    ds_read_b64_tr_b16 a[0:1], v6 offset:32768
    ds_read_b64_tr_b16 a[2:3], v6 offset:34816
    ds_read_b64_tr_b16 a[4:5], v7 offset:32768
    ds_read_b64_tr_b16 a[6:7], v7 offset:34816
    ds_read_b64_tr_b16 a[8:9], v6 offset:33024
    ds_read_b64_tr_b16 a[10:11], v6 offset:35072
    ds_read_b64_tr_b16 a[12:13], v7 offset:33024
    ds_read_b64_tr_b16 a[14:15], v7 offset:35072
    s_add_u32 s57, s57, 31744
    buffer_load_dwordx4 v12, s[20:23], s57 offen offset:2048 lds
    s_add_u32 s57, s57, 31744
    buffer_load_dwordx4 v12, s[20:23], s57 offen offset:3072 lds
    s_add_u32 m0, s52, 147456
    s_lshl_b32 s57, s78, 7
    buffer_load_dwordx4 v12, s[20:23], s57 offen offset:0 lds
    s_add_u32 s57, s57, 31744
    buffer_load_dwordx4 v12, s[20:23], s57 offen offset:1024 lds
    s_waitcnt vmcnt(12)
    ds_read_b64_tr_b16 a[16:17], v6 offset:49152
    ds_read_b64_tr_b16 a[18:19], v6 offset:51200
    ds_read_b64_tr_b16 a[20:21], v7 offset:49152
    ds_read_b64_tr_b16 a[22:23], v7 offset:51200
    s_add_u32 s57, s57, 31744
    buffer_load_dwordx4 v12, s[20:23], s57 offen offset:2048 lds
    ds_read_b64_tr_b16 a[24:25], v6 offset:49408
    ds_read_b64_tr_b16 a[26:27], v6 offset:51456
    ds_read_b64_tr_b16 a[28:29], v7 offset:49408
    ds_read_b64_tr_b16 a[30:31], v7 offset:51456
    s_add_u32 s57, s57, 31744
    buffer_load_dwordx4 v12, s[20:23], s57 offen offset:3072 lds
    s_add_u32 m0, s52, 49152
    s_lshl_b32 s57, s78, 7
    s_add_u32 s57, s57, 131072
    buffer_load_dwordx4 v12, s[20:23], s57 offen offset:0 lds
    s_add_u32 s57, s57, 31744
    buffer_load_dwordx4 v12, s[20:23], s57 offen offset:1024 lds
    s_waitcnt vmcnt(11)
    ds_read_b64_tr_b16 a[32:33], v8 offset:0
    ds_read_b64_tr_b16 a[34:35], v8 offset:2048
    ds_read_b64_tr_b16 a[36:37], v9 offset:0
    ds_read_b64_tr_b16 a[38:39], v9 offset:2048
    s_add_u32 s57, s57, 31744
    buffer_load_dwordx4 v12, s[20:23], s57 offen offset:2048 lds
    ds_read_b64_tr_b16 a[40:41], v8 offset:256
    ds_read_b64_tr_b16 a[42:43], v8 offset:2304
    ds_read_b64_tr_b16 a[44:45], v9 offset:256
    ds_read_b64_tr_b16 a[46:47], v9 offset:2304
    s_add_u32 s57, s57, 31744
    buffer_load_dwordx4 v12, s[20:23], s57 offen offset:3072 lds
    s_waitcnt vmcnt(11)
    s_barrier
    s_cmp_lg_u32 s44, 0
    s_cbranch_scc1 L_nopub6
    s_lshl_b32 s60, s51, 5
    s_add_u32 s60, s60, s50
    s_lshl_b32 s60, s60, 7
    s_add_u32 s60, s60, 12713984
    v_mov_b32 v30, s47
    s_mov_b64 exec, 1
    buffer_store_dword v30, off, s[24:27], s60 sc1
    s_mov_b64 exec, -1
L_nopub6:
L_p3join:
    v_lshlrev_b32 v224, 16, v224
    v_lshlrev_b32 v176, 16, v216
    v_and_b32 v177, s61, v216
    v_lshlrev_b32 v178, 16, v217
    s_add_u32 m0, s52, 65536
    s_lshl_b32 s57, s79, 7
    buffer_load_dwordx4 v12, s[20:23], s57 offen offset:0 lds
    v_and_b32 v179, s61, v217
    v_lshlrev_b32 v180, 16, v218
    v_and_b32 v181, s61, v218
    v_lshlrev_b32 v182, 16, v219
    s_add_u32 s57, s57, 31744
    buffer_load_dwordx4 v12, s[20:23], s57 offen offset:1024 lds
    s_waitcnt vmcnt(10)
    ds_read_b64_tr_b16 a[48:49], v8 offset:16384
    ds_read_b64_tr_b16 a[50:51], v8 offset:18432
    ds_read_b64_tr_b16 a[52:53], v9 offset:16384
    ds_read_b64_tr_b16 a[54:55], v9 offset:18432
    s_add_u32 s57, s57, 31744
    buffer_load_dwordx4 v12, s[20:23], s57 offen offset:2048 lds
    ds_read_b64_tr_b16 a[56:57], v8 offset:16640
    ds_read_b64_tr_b16 a[58:59], v8 offset:18688
    ds_read_b64_tr_b16 a[60:61], v9 offset:16640
    ds_read_b64_tr_b16 a[62:63], v9 offset:18688
    v_and_b32 v183, s61, v219
    v_add_f32 v176, v176, v224
    v_add_f32 v177, v177, v224
    v_add_f32 v178, v178, v224
    s_add_u32 s57, s57, 31744
    buffer_load_dwordx4 v12, s[20:23], s57 offen offset:3072 lds
    v_add_f32 v179, v179, v224
    v_add_f32 v180, v180, v224
    v_add_f32 v181, v181, v224
    v_add_f32 v182, v182, v224
    s_waitcnt lgkmcnt(15)
    s_add_u32 m0, s52, 81920
    s_lshl_b32 s57, s79, 7
    s_add_u32 s57, s57, 131072
    buffer_load_dwordx4 v12, s[20:23], s57 offen offset:0 lds
    v_add_f32 v183, v183, v224
    v_lshlrev_b32 v225, 16, v225
    v_lshlrev_b32 v184, 16, v220
    v_and_b32 v185, s61, v220
    s_add_u32 s57, s57, 31744
    buffer_load_dwordx4 v12, s[20:23], s57 offen offset:1024 lds
    s_waitcnt vmcnt(10)
    ds_read_b64_tr_b16 a[64:65], v8 offset:32768
    ds_read_b64_tr_b16 a[66:67], v8 offset:34816
    ds_read_b64_tr_b16 a[68:69], v9 offset:32768
    ds_read_b64_tr_b16 a[70:71], v9 offset:34816
    v_lshlrev_b32 v186, 16, v221
    v_and_b32 v187, s61, v221
    v_lshlrev_b32 v188, 16, v222
    v_and_b32 v189, s61, v222
    ds_read_b64_tr_b16 a[72:73], v8 offset:33024
    ds_read_b64_tr_b16 a[74:75], v8 offset:35072
    ds_read_b64_tr_b16 a[76:77], v9 offset:33024
    ds_read_b64_tr_b16 a[78:79], v9 offset:35072
    s_add_u32 s57, s57, 31744
    buffer_load_dwordx4 v12, s[20:23], s57 offen offset:2048 lds
    v_lshlrev_b32 v190, 16, v223
    v_and_b32 v191, s61, v223
    v_add_f32 v184, v184, v225
    v_add_f32 v185, v185, v225
    s_add_u32 s57, s57, 31744
    buffer_load_dwordx4 v12, s[20:23], s57 offen offset:3072 lds
    v_add_f32 v186, v186, v225
    v_add_f32 v187, v187, v225
    v_add_f32 v188, v188, v225
    v_add_f32 v189, v189, v225
    s_add_u32 m0, s52, 98304
    s_lshl_b32 s57, s80, 7
    buffer_load_dwordx4 v12, s[20:23], s57 offen offset:0 lds
    v_add_f32 v190, v190, v225
    v_add_f32 v191, v191, v225
    v_lshlrev_b32 v228, 16, v228
    v_lshlrev_b32 v232, 16, v226
    v_and_b32 v233, s61, v226
    v_lshlrev_b32 v234, 16, v227
    v_and_b32 v235, s61, v227
    v_add_f32 v232, v232, v228
    s_add_u32 s57, s57, 31744
    buffer_load_dwordx4 v12, s[20:23], s57 offen offset:1024 lds
    s_waitcnt vmcnt(10)
    ds_read_b64_tr_b16 a[80:81], v6 offset:0
    ds_read_b64_tr_b16 a[82:83], v6 offset:2048
    ds_read_b64_tr_b16 a[84:85], v7 offset:0
    ds_read_b64_tr_b16 a[86:87], v7 offset:2048
    s_add_u32 s57, s57, 31744
    buffer_load_dwordx4 v12, s[20:23], s57 offen offset:2048 lds
    ds_read_b64_tr_b16 a[88:89], v6 offset:256
    ds_read_b64_tr_b16 a[90:91], v6 offset:2304
    ds_read_b64_tr_b16 a[92:93], v7 offset:256
    ds_read_b64_tr_b16 a[94:95], v7 offset:2304
    s_add_u32 s57, s57, 31744
    buffer_load_dwordx4 v12, s[20:23], s57 offen offset:3072 lds
    v_add_f32 v233, v233, v228
    v_add_f32 v234, v234, v228
    v_add_f32 v235, v235, v228
    s_waitcnt lgkmcnt(15)
    s_add_u32 m0, s52, 114688
    s_lshl_b32 s57, s80, 7
    s_add_u32 s57, s57, 131072
    buffer_load_dwordx4 v12, s[20:23], s57 offen offset:0 lds
    s_add_u32 s57, s57, 31744
    buffer_load_dwordx4 v12, s[20:23], s57 offen offset:1024 lds
    s_waitcnt vmcnt(10)
    ds_read_b64_tr_b16 a[96:97], v6 offset:16384
    ds_read_b64_tr_b16 a[98:99], v6 offset:18432
    ds_read_b64_tr_b16 a[100:101], v7 offset:16384
    ds_read_b64_tr_b16 a[102:103], v7 offset:18432
    s_add_u32 s57, s57, 31744
    buffer_load_dwordx4 v12, s[20:23], s57 offen offset:2048 lds
    ds_read_b64_tr_b16 a[104:105], v6 offset:16640
    ds_read_b64_tr_b16 a[106:107], v6 offset:18688
    ds_read_b64_tr_b16 a[108:109], v7 offset:16640
    ds_read_b64_tr_b16 a[110:111], v7 offset:18688
    s_add_u32 s57, s57, 31744
    buffer_load_dwordx4 v12, s[20:23], s57 offen offset:3072 lds
    s_add_u32 m0, s52, 131072
    s_lshl_b32 s57, s81, 7
    buffer_load_dwordx4 v12, s[20:23], s57 offen offset:0 lds
    s_add_u32 s57, s57, 31744
    buffer_load_dwordx4 v12, s[20:23], s57 offen offset:1024 lds
    s_waitcnt vmcnt(10)
    ds_read_b64_tr_b16 a[112:113], v6 offset:32768
    ds_read_b64_tr_b16 a[114:115], v6 offset:34816
    ds_read_b64_tr_b16 a[116:117], v7 offset:32768
    ds_read_b64_tr_b16 a[118:119], v7 offset:34816
    s_add_u32 s57, s57, 31744
    buffer_load_dwordx4 v12, s[20:23], s57 offen offset:2048 lds
    ds_read_b64_tr_b16 a[120:121], v6 offset:33024
    ds_read_b64_tr_b16 a[122:123], v6 offset:35072
    ds_read_b64_tr_b16 a[124:125], v7 offset:33024
    ds_read_b64_tr_b16 a[126:127], v7 offset:35072
    s_add_u32 s57, s57, 31744
    buffer_load_dwordx4 v12, s[20:23], s57 offen offset:3072 lds
    s_waitcnt lgkmcnt(15)
    s_add_u32 m0, s52, 147456
    s_lshl_b32 s57, s81, 7
    s_add_u32 s57, s57, 131072
    buffer_load_dwordx4 v12, s[20:23], s57 offen offset:0 lds
    s_add_u32 s57, s57, 31744
    buffer_load_dwordx4 v12, s[20:23], s57 offen offset:1024 lds
    s_waitcnt vmcnt(10)
    ds_read_b64_tr_b16 a[128:129], v6 offset:49152
    ds_read_b64_tr_b16 a[130:131], v6 offset:51200
    ds_read_b64_tr_b16 a[132:133], v7 offset:49152
    ds_read_b64_tr_b16 a[134:135], v7 offset:51200
    s_add_u32 s57, s57, 31744
    buffer_load_dwordx4 v12, s[20:23], s57 offen offset:2048 lds
    ds_read_b64_tr_b16 a[136:137], v6 offset:49408
    ds_read_b64_tr_b16 a[138:139], v6 offset:51456
    ds_read_b64_tr_b16 a[140:141], v7 offset:49408
    ds_read_b64_tr_b16 a[142:143], v7 offset:51456
    s_add_u32 s57, s57, 31744
    buffer_load_dwordx4 v12, s[20:23], s57 offen offset:3072 lds
    s_add_u32 m0, s52, 49152
    s_lshl_b32 s57, s82, 7
    buffer_load_dwordx4 v12, s[20:23], s57 offen offset:0 lds
    s_add_u32 s57, s57, 31744
    buffer_load_dwordx4 v12, s[20:23], s57 offen offset:1024 lds
    s_waitcnt vmcnt(10)
    ds_read_b64_tr_b16 a[144:145], v8 offset:0
    ds_read_b64_tr_b16 a[146:147], v8 offset:2048
    ds_read_b64_tr_b16 a[148:149], v9 offset:0
    ds_read_b64_tr_b16 a[150:151], v9 offset:2048
    s_add_u32 s57, s57, 31744
    buffer_load_dwordx4 v12, s[20:23], s57 offen offset:2048 lds
    ds_read_b64_tr_b16 a[152:153], v8 offset:256
    ds_read_b64_tr_b16 a[154:155], v8 offset:2304
    ds_read_b64_tr_b16 a[156:157], v9 offset:256
    ds_read_b64_tr_b16 a[158:159], v9 offset:2304
    s_add_u32 s57, s57, 31744
    buffer_load_dwordx4 v12, s[20:23], s57 offen offset:3072 lds
    s_waitcnt lgkmcnt(15)
    s_add_u32 m0, s52, 65536
    s_lshl_b32 s57, s82, 7
    s_add_u32 s57, s57, 131072
    buffer_load_dwordx4 v12, s[20:23], s57 offen offset:0 lds
    s_add_u32 s57, s57, 31744
    buffer_load_dwordx4 v12, s[20:23], s57 offen offset:1024 lds
    s_waitcnt vmcnt(10)
    ds_read_b64_tr_b16 a[160:161], v8 offset:16384
    ds_read_b64_tr_b16 a[162:163], v8 offset:18432
    ds_read_b64_tr_b16 a[164:165], v9 offset:16384
    ds_read_b64_tr_b16 a[166:167], v9 offset:18432
    s_add_u32 s57, s57, 31744
    buffer_load_dwordx4 v12, s[20:23], s57 offen offset:2048 lds
    ds_read_b64_tr_b16 a[168:169], v8 offset:16640
    ds_read_b64_tr_b16 a[170:171], v8 offset:18688
    ds_read_b64_tr_b16 a[172:173], v9 offset:16640
    ds_read_b64_tr_b16 a[174:175], v9 offset:18688
    s_add_u32 s57, s57, 31744
    buffer_load_dwordx4 v12, s[20:23], s57 offen offset:3072 lds
    s_add_u32 m0, s52, 81920
    s_mov_b32 s57, s75
    buffer_load_dwordx4 v15, s[12:15], s57 offen offset:0 lds
    s_add_u32 s57, s57, 24064
    buffer_load_dwordx4 v15, s[12:15], s57 offen offset:1024 lds
    s_waitcnt vmcnt(10)
    ds_read_b64_tr_b16 a[176:177], v8 offset:32768
    ds_read_b64_tr_b16 a[178:179], v8 offset:34816
    ds_read_b64_tr_b16 a[180:181], v9 offset:32768
    ds_read_b64_tr_b16 a[182:183], v9 offset:34816
    s_add_u32 s57, s57, 24064
    buffer_load_dwordx4 v15, s[12:15], s57 offen offset:2048 lds
    ds_read_b64_tr_b16 a[184:185], v8 offset:33024
    ds_read_b64_tr_b16 a[186:187], v8 offset:35072
    ds_read_b64_tr_b16 a[188:189], v9 offset:33024
    ds_read_b64_tr_b16 a[190:191], v9 offset:35072
    s_add_u32 s57, s57, 24064
    buffer_load_dwordx4 v15, s[12:15], s57 offen offset:3072 lds
    s_waitcnt lgkmcnt(15)
    s_add_u32 m0, s52, 98304
    s_mov_b32 s57, 0
    buffer_load_dwordx4 v13, s[12:15], s57 offen offset:0 lds
    s_add_u32 s57, s57, 6144
    buffer_load_dwordx4 v14, s[12:15], s57 offen offset:1024 lds
    s_waitcnt vmcnt(10)
    ds_read_b64_tr_b16 a[192:193], v6 offset:0
    ds_read_b64_tr_b16 a[194:195], v6 offset:2048
    ds_read_b64_tr_b16 a[196:197], v7 offset:0
    ds_read_b64_tr_b16 a[198:199], v7 offset:2048
    s_add_u32 s57, s57, 6144
    buffer_load_dwordx4 v13, s[12:15], s57 offen offset:2048 lds
    ds_read_b64_tr_b16 a[200:201], v6 offset:256
    ds_read_b64_tr_b16 a[202:203], v6 offset:2304
    ds_read_b64_tr_b16 a[204:205], v7 offset:256
    ds_read_b64_tr_b16 a[206:207], v7 offset:2304
    s_add_u32 s57, s57, 6144
    buffer_load_dwordx4 v14, s[12:15], s57 offen offset:3072 lds
    s_add_u32 m0, s52, 114688
    s_mov_b32 s57, 25088
    buffer_load_dwordx4 v13, s[12:15], s57 offen offset:0 lds
    s_add_u32 s57, s57, 6144
    buffer_load_dwordx4 v14, s[12:15], s57 offen offset:1024 lds
    s_waitcnt vmcnt(10)
    ds_read_b64_tr_b16 a[208:209], v6 offset:16384
    ds_read_b64_tr_b16 a[210:211], v6 offset:18432
    ds_read_b64_tr_b16 a[212:213], v7 offset:16384
    ds_read_b64_tr_b16 a[214:215], v7 offset:18432
    buffer_load_dword v17, v20, s[24:27], 0 offen sc1
    ds_read_b64_tr_b16 a[216:217], v6 offset:16640
    ds_read_b64_tr_b16 a[218:219], v6 offset:18688
    ds_read_b64_tr_b16 a[220:221], v7 offset:16640
    ds_read_b64_tr_b16 a[222:223], v7 offset:18688
    s_add_u32 s57, s57, 6144
    buffer_load_dwordx4 v13, s[12:15], s57 offen offset:2048 lds
    s_add_u32 s57, s57, 6144
    buffer_load_dwordx4 v14, s[12:15], s57 offen offset:3072 lds
    s_waitcnt lgkmcnt(15)
    s_add_u32 m0, s52, 131072
    s_mov_b32 s57, 50176
    buffer_load_dwordx4 v13, s[12:15], s57 offen offset:0 lds
    s_waitcnt vmcnt(10)
    v_add_u32 v16, 81920, v16
    ds_read_b64_tr_b16 v[192:193], v16 offset:0
    ds_read_b64_tr_b16 v[194:195], v16 offset:128
    ds_read_b64_tr_b16 v[196:197], v16 offset:1024
    ds_read_b64_tr_b16 v[198:199], v16 offset:1152
    ds_read_b64_tr_b16 v[200:201], v16 offset:2048
    ds_read_b64_tr_b16 v[202:203], v16 offset:2176
    ds_read_b64_tr_b16 v[204:205], v16 offset:3072
    ds_read_b64_tr_b16 v[206:207], v16 offset:3200
    s_add_u32 s57, s57, 6144
    buffer_load_dwordx4 v14, s[12:15], s57 offen offset:1024 lds
    s_add_u32 s57, s57, 6144
    buffer_load_dwordx4 v13, s[12:15], s57 offen offset:2048 lds
    s_add_u32 s57, s57, 6144
    buffer_load_dwordx4 v14, s[12:15], s57 offen offset:3072 lds
    s_add_u32 m0, s52, 147456
    s_mov_b32 s57, 75264
    buffer_load_dwordx4 v13, s[12:15], s57 offen offset:0 lds
    s_waitcnt vmcnt(10)
    ds_read_b64_tr_b16 a[224:225], v2 offset:49152
    ds_read_b64_tr_b16 a[226:227], v2 offset:49664
    ds_read_b64_tr_b16 a[228:229], v3 offset:49152
    ds_read_b64_tr_b16 a[230:231], v3 offset:49664
    s_add_u32 s57, s57, 6144
    buffer_load_dwordx4 v14, s[12:15], s57 offen offset:1024 lds
    ds_read_b64_tr_b16 a[232:233], v2 offset:49408
    ds_read_b64_tr_b16 a[234:235], v2 offset:49920
    ds_read_b64_tr_b16 a[236:237], v3 offset:49408
    ds_read_b64_tr_b16 a[238:239], v3 offset:49920
    s_add_u32 s57, s57, 6144
    buffer_load_dwordx4 v13, s[12:15], s57 offen offset:2048 lds
    s_add_u32 s57, s57, 6144
    buffer_load_dwordx4 v14, s[12:15], s57 offen offset:3072 lds
    s_waitcnt vmcnt(10)
    v_cmp_ne_u32 vcc, s47, v17
    s_nop 0
    s_cbranch_vccz L_ok8
    s_mov_b32 s59, 20000
L_spin7:
    s_sleep 2
    buffer_load_dword v17, v20, s[24:27], 0 offen sc1
    s_waitcnt vmcnt(0)
    v_cmp_ne_u32 vcc, s47, v17
    s_nop 0
    s_cbranch_vccz L_ok8
    s_sub_u32 s59, s59, 1
    s_cbranch_scc0 L_spin7
L_ok8:
    s_cmp_ge_u32 s89, 4
    s_cbranch_scc1 L_p3_alt
    s_mov_b32 s66, s68
    s_add_u32 s58, s66, s76
    buffer_load_dwordx4 v[144:147], v23, s[24:27], s58 offen offset:0 sc1
    buffer_load_dwordx4 v[148:151], v23, s[24:27], s58 offen offset:1024 sc1
    s_waitcnt vmcnt(10)
    ds_read_b64_tr_b16 a[240:241], v4 offset:0
    ds_read_b64_tr_b16 a[242:243], v4 offset:512
    ds_read_b64_tr_b16 a[244:245], v5 offset:0
    ds_read_b64_tr_b16 a[246:247], v5 offset:512
    s_add_u32 s58, s66, s77
    buffer_load_dwordx4 v[152:155], v23, s[24:27], s58 offen offset:0 sc1
    ds_read_b64_tr_b16 a[248:249], v4 offset:256
    ds_read_b64_tr_b16 a[250:251], v4 offset:768
    ds_read_b64_tr_b16 a[252:253], v5 offset:256
    ds_read_b64_tr_b16 a[254:255], v5 offset:768
    buffer_load_dwordx4 v[156:159], v23, s[24:27], s58 offen offset:1024 sc1
    s_add_u32 s58, s66, s78
    buffer_load_dwordx4 v[112:115], v23, s[24:27], s58 offen offset:0 sc1
    buffer_load_dwordx4 v[116:119], v23, s[24:27], s58 offen offset:1024 sc1
    s_add_u32 s58, s66, s79
    buffer_load_dwordx4 v[120:123], v23, s[24:27], s58 offen offset:0 sc1
    buffer_load_dwordx4 v[124:127], v23, s[24:27], s58 offen offset:1024 sc1
    s_add_u32 s58, s66, s80
    buffer_load_dwordx4 v[128:131], v23, s[24:27], s58 offen offset:0 sc1
    buffer_load_dwordx4 v[132:135], v23, s[24:27], s58 offen offset:1024 sc1
    s_waitcnt vmcnt(9)
    v_mfma_f32_16x16x32_bf16 v[96:99], v[144:147], a[0:3], 0
    s_add_u32 s58, s66, s81
    v_mfma_f32_16x16x32_bf16 v[100:103], v[144:147], a[4:7], 0
    buffer_load_dwordx4 v[136:139], v23, s[24:27], s58 offen offset:0 sc1
    v_mfma_f32_16x16x32_bf16 v[104:107], v[144:147], a[8:11], 0
    v_mfma_f32_16x16x32_bf16 v[108:111], v[144:147], a[12:15], 0
    s_waitcnt vmcnt(9)
    v_mfma_f32_16x16x32_bf16 v[96:99], v[148:151], a[16:19], v[96:99]
    v_mfma_f32_16x16x32_bf16 v[100:103], v[148:151], a[20:23], v[100:103]
    buffer_load_dwordx4 v[140:143], v23, s[24:27], s58 offen offset:1024 sc1
    v_mfma_f32_16x16x32_bf16 v[104:107], v[148:151], a[24:27], v[104:107]
    v_mfma_f32_16x16x32_bf16 v[108:111], v[148:151], a[28:31], v[108:111]
    s_waitcnt vmcnt(9)
    v_mfma_f32_16x16x32_bf16 v[96:99], v[152:155], a[32:35], v[96:99]
    s_add_u32 s58, s66, s82
    v_mfma_f32_16x16x32_bf16 v[100:103], v[152:155], a[36:39], v[100:103]
    buffer_load_dwordx4 v[144:147], v23, s[24:27], s58 offen offset:0 sc1
    v_mfma_f32_16x16x32_bf16 v[104:107], v[152:155], a[40:43], v[104:107]
    v_mfma_f32_16x16x32_bf16 v[108:111], v[152:155], a[44:47], v[108:111]
    s_waitcnt vmcnt(9)
    v_mfma_f32_16x16x32_bf16 v[96:99], v[156:159], a[48:51], v[96:99]
    v_mfma_f32_16x16x32_bf16 v[100:103], v[156:159], a[52:55], v[100:103]
    buffer_load_dwordx4 v[148:151], v23, s[24:27], s58 offen offset:1024 sc1
    v_mfma_f32_16x16x32_bf16 v[104:107], v[156:159], a[56:59], v[104:107]
    v_mfma_f32_16x16x32_bf16 v[108:111], v[156:159], a[60:63], v[108:111]
    s_waitcnt vmcnt(9)
    v_mfma_f32_16x16x32_bf16 v[96:99], v[112:115], a[64:67], v[96:99]
    s_xor_b32 s66, s44, 3
    s_lshl2_add_u32 s66, s49, s66
    s_mul_i32 s66, s66, 58624
    s_add_u32 s66, s66, s69
    s_add_u32 s58, s66, s76
    v_mfma_f32_16x16x32_bf16 v[100:103], v[112:115], a[68:71], v[100:103]
    buffer_load_dwordx4 v[152:155], v23, s[24:27], s58 offen offset:0 sc1
    v_mfma_f32_16x16x32_bf16 v[104:107], v[112:115], a[72:75], v[104:107]
    v_mfma_f32_16x16x32_bf16 v[108:111], v[112:115], a[76:79], v[108:111]
    s_waitcnt vmcnt(9)
    v_mfma_f32_16x16x32_bf16 v[96:99], v[116:119], a[80:83], v[96:99]
    v_mfma_f32_16x16x32_bf16 v[100:103], v[116:119], a[84:87], v[100:103]
    buffer_load_dwordx4 v[156:159], v23, s[24:27], s58 offen offset:1024 sc1
    v_mfma_f32_16x16x32_bf16 v[104:107], v[116:119], a[88:91], v[104:107]
    v_mfma_f32_16x16x32_bf16 v[108:111], v[116:119], a[92:95], v[108:111]
    s_waitcnt vmcnt(9)
    v_mfma_f32_16x16x32_bf16 v[96:99], v[120:123], a[96:99], v[96:99]
    s_add_u32 s58, s66, s77
    v_mfma_f32_16x16x32_bf16 v[100:103], v[120:123], a[100:103], v[100:103]
    buffer_load_dwordx4 v[112:115], v23, s[24:27], s58 offen offset:0 sc1
    v_mfma_f32_16x16x32_bf16 v[104:107], v[120:123], a[104:107], v[104:107]
    v_mfma_f32_16x16x32_bf16 v[108:111], v[120:123], a[108:111], v[108:111]
    s_waitcnt vmcnt(9)
    v_mfma_f32_16x16x32_bf16 v[96:99], v[124:127], a[112:115], v[96:99]
    v_mfma_f32_16x16x32_bf16 v[100:103], v[124:127], a[116:119], v[100:103]
    buffer_load_dwordx4 v[116:119], v23, s[24:27], s58 offen offset:1024 sc1
    v_mfma_f32_16x16x32_bf16 v[104:107], v[124:127], a[120:123], v[104:107]
    v_mfma_f32_16x16x32_bf16 v[108:111], v[124:127], a[124:127], v[108:111]
    s_waitcnt vmcnt(9)
    v_mfma_f32_16x16x32_bf16 v[96:99], v[128:131], a[128:131], v[96:99]
    s_add_u32 s58, s66, s78
    v_mfma_f32_16x16x32_bf16 v[100:103], v[128:131], a[132:135], v[100:103]
    buffer_load_dwordx4 v[120:123], v23, s[24:27], s58 offen offset:0 sc1
    v_mfma_f32_16x16x32_bf16 v[104:107], v[128:131], a[136:139], v[104:107]
    v_mfma_f32_16x16x32_bf16 v[108:111], v[128:131], a[140:143], v[108:111]
    s_waitcnt vmcnt(9)
    v_mfma_f32_16x16x32_bf16 v[96:99], v[132:135], a[144:147], v[96:99]
    v_mfma_f32_16x16x32_bf16 v[100:103], v[132:135], a[148:151], v[100:103]
    buffer_load_dwordx4 v[124:127], v23, s[24:27], s58 offen offset:1024 sc1
    v_mfma_f32_16x16x32_bf16 v[104:107], v[132:135], a[152:155], v[104:107]
    v_mfma_f32_16x16x32_bf16 v[108:111], v[132:135], a[156:159], v[108:111]
    s_waitcnt vmcnt(9)
    v_mfma_f32_16x16x32_bf16 v[96:99], v[136:139], a[160:163], v[96:99]
    s_add_u32 s58, s66, s79
    v_mfma_f32_16x16x32_bf16 v[100:103], v[136:139], a[164:167], v[100:103]
    buffer_load_dwordx4 v[128:131], v23, s[24:27], s58 offen offset:0 sc1
    v_mfma_f32_16x16x32_bf16 v[104:107], v[136:139], a[168:171], v[104:107]
    v_mfma_f32_16x16x32_bf16 v[108:111], v[136:139], a[172:175], v[108:111]
    s_waitcnt vmcnt(9)
    v_mfma_f32_16x16x32_bf16 v[96:99], v[140:143], a[176:179], v[96:99]
    v_mfma_f32_16x16x32_bf16 v[100:103], v[140:143], a[180:183], v[100:103]
    buffer_load_dwordx4 v[132:135], v23, s[24:27], s58 offen offset:1024 sc1
    v_mfma_f32_16x16x32_bf16 v[104:107], v[140:143], a[184:187], v[104:107]
    v_mfma_f32_16x16x32_bf16 v[108:111], v[140:143], a[188:191], v[108:111]
    s_waitcnt vmcnt(9)
    s_waitcnt lgkmcnt(15)
    v_mfma_f32_16x16x32_bf16 v[96:99], v[144:147], a[192:195], v[96:99]
    s_add_u32 s58, s66, s80
    v_mfma_f32_16x16x32_bf16 v[100:103], v[144:147], a[196:199], v[100:103]
    buffer_load_dwordx4 v[136:139], v23, s[24:27], s58 offen offset:0 sc1
    v_mfma_f32_16x16x32_bf16 v[104:107], v[144:147], a[200:203], v[104:107]
    v_mfma_f32_16x16x32_bf16 v[108:111], v[144:147], a[204:207], v[108:111]
    s_waitcnt vmcnt(9)
    v_mfma_f32_16x16x32_bf16 v[96:99], v[148:151], a[208:211], v[96:99]
    v_mfma_f32_16x16x32_bf16 v[100:103], v[148:151], a[212:215], v[100:103]
    buffer_load_dwordx4 v[140:143], v23, s[24:27], s58 offen offset:1024 sc1
    v_mfma_f32_16x16x32_bf16 v[104:107], v[148:151], a[216:219], v[104:107]
    v_mfma_f32_16x16x32_bf16 v[108:111], v[148:151], a[220:223], v[108:111]
L_p3_join:
    s_waitcnt vmcnt(9)
    v_mfma_f32_16x16x32_bf16 v[80:83], v[152:155], a[0:3], 0
    s_add_u32 s58, s66, s81
    v_mfma_f32_16x16x32_bf16 v[84:87], v[152:155], a[4:7], 0
    buffer_load_dwordx4 v[144:147], v23, s[24:27], s58 offen offset:0 sc1
    v_mfma_f32_16x16x32_bf16 v[88:91], v[152:155], a[8:11], 0
    v_mfma_f32_16x16x32_bf16 v[92:95], v[152:155], a[12:15], 0
    s_waitcnt vmcnt(9)
    v_mfma_f32_16x16x32_bf16 v[80:83], v[156:159], a[16:19], v[80:83]
    v_mfma_f32_16x16x32_bf16 v[84:87], v[156:159], a[20:23], v[84:87]
    buffer_load_dwordx4 v[148:151], v23, s[24:27], s58 offen offset:1024 sc1
    v_mfma_f32_16x16x32_bf16 v[88:91], v[156:159], a[24:27], v[88:91]
    v_mfma_f32_16x16x32_bf16 v[92:95], v[156:159], a[28:31], v[92:95]
    s_waitcnt vmcnt(9)
    v_mfma_f32_16x16x32_bf16 v[80:83], v[112:115], a[32:35], v[80:83]
    s_add_u32 s58, s66, s82
    v_mfma_f32_16x16x32_bf16 v[84:87], v[112:115], a[36:39], v[84:87]
    buffer_load_dwordx4 v[152:155], v23, s[24:27], s58 offen offset:0 sc1
    v_mfma_f32_16x16x32_bf16 v[88:91], v[112:115], a[40:43], v[88:91]
    v_mfma_f32_16x16x32_bf16 v[92:95], v[112:115], a[44:47], v[92:95]
    s_waitcnt vmcnt(9)
    v_mfma_f32_16x16x32_bf16 v[80:83], v[116:119], a[48:51], v[80:83]
    v_mfma_f32_16x16x32_bf16 v[84:87], v[116:119], a[52:55], v[84:87]
    buffer_load_dwordx4 v[156:159], v23, s[24:27], s58 offen offset:1024 sc1
    v_mfma_f32_16x16x32_bf16 v[88:91], v[116:119], a[56:59], v[88:91]
    v_mfma_f32_16x16x32_bf16 v[92:95], v[116:119], a[60:63], v[92:95]
    s_waitcnt vmcnt(9)
    v_mfma_f32_16x16x32_bf16 v[80:83], v[120:123], a[64:67], v[80:83]
    s_xor_b32 s66, s44, 2
    s_lshl2_add_u32 s66, s49, s66
    s_mul_i32 s66, s66, 58624
    s_add_u32 s66, s66, s69
    s_add_u32 s58, s66, s76
    v_mfma_f32_16x16x32_bf16 v[84:87], v[120:123], a[68:71], v[84:87]
    buffer_load_dwordx4 v[112:115], v23, s[24:27], s58 offen offset:0 sc1
    v_mfma_f32_16x16x32_bf16 v[88:91], v[120:123], a[72:75], v[88:91]
    v_mfma_f32_16x16x32_bf16 v[92:95], v[120:123], a[76:79], v[92:95]
    s_waitcnt vmcnt(9)
    v_mfma_f32_16x16x32_bf16 v[80:83], v[124:127], a[80:83], v[80:83]
    v_mfma_f32_16x16x32_bf16 v[84:87], v[124:127], a[84:87], v[84:87]
    buffer_load_dwordx4 v[116:119], v23, s[24:27], s58 offen offset:1024 sc1
    v_mfma_f32_16x16x32_bf16 v[88:91], v[124:127], a[88:91], v[88:91]
    v_mfma_f32_16x16x32_bf16 v[92:95], v[124:127], a[92:95], v[92:95]
    s_waitcnt vmcnt(9)
    v_mfma_f32_16x16x32_bf16 v[80:83], v[128:131], a[96:99], v[80:83]
    s_add_u32 s58, s66, s77
    v_mfma_f32_16x16x32_bf16 v[84:87], v[128:131], a[100:103], v[84:87]
    buffer_load_dwordx4 v[120:123], v23, s[24:27], s58 offen offset:0 sc1
    v_mfma_f32_16x16x32_bf16 v[88:91], v[128:131], a[104:107], v[88:91]
    v_mfma_f32_16x16x32_bf16 v[92:95], v[128:131], a[108:111], v[92:95]
    s_waitcnt vmcnt(9)
    v_mfma_f32_16x16x32_bf16 v[80:83], v[132:135], a[112:115], v[80:83]
    v_mfma_f32_16x16x32_bf16 v[84:87], v[132:135], a[116:119], v[84:87]
    buffer_load_dwordx4 v[124:127], v23, s[24:27], s58 offen offset:1024 sc1
    v_mfma_f32_16x16x32_bf16 v[88:91], v[132:135], a[120:123], v[88:91]
    v_mfma_f32_16x16x32_bf16 v[92:95], v[132:135], a[124:127], v[92:95]
    buffer_load_dword v19, v21, s[24:27], 0 offen sc1
    s_waitcnt vmcnt(10)
    v_mfma_f32_16x16x32_bf16 v[80:83], v[136:139], a[128:131], v[80:83]
    v_mfma_f32_16x16x32_bf16 v[84:87], v[136:139], a[132:135], v[84:87]
    v_mfma_f32_16x16x32_bf16 v[88:91], v[136:139], a[136:139], v[88:91]
    v_mfma_f32_16x16x32_bf16 v[92:95], v[136:139], a[140:143], v[92:95]
    s_waitcnt vmcnt(9)
    v_mfma_f32_16x16x32_bf16 v[80:83], v[140:143], a[144:147], v[80:83]
    s_add_u32 s58, s66, s78
    v_mfma_f32_16x16x32_bf16 v[84:87], v[140:143], a[148:151], v[84:87]
    buffer_load_dwordx4 v[128:131], v23, s[24:27], s58 offen offset:0 sc1
    v_mfma_f32_16x16x32_bf16 v[88:91], v[140:143], a[152:155], v[88:91]
    v_mfma_f32_16x16x32_bf16 v[92:95], v[140:143], a[156:159], v[92:95]
    s_waitcnt vmcnt(9)
    v_mfma_f32_16x16x32_bf16 v[80:83], v[144:147], a[160:163], v[80:83]
    v_mfma_f32_16x16x32_bf16 v[84:87], v[144:147], a[164:167], v[84:87]
    buffer_load_dwordx4 v[132:135], v23, s[24:27], s58 offen offset:1024 sc1
    v_mfma_f32_16x16x32_bf16 v[88:91], v[144:147], a[168:171], v[88:91]
    v_mfma_f32_16x16x32_bf16 v[92:95], v[144:147], a[172:175], v[92:95]
    s_waitcnt vmcnt(9)
    v_mfma_f32_16x16x32_bf16 v[80:83], v[148:151], a[176:179], v[80:83]
    s_add_u32 s58, s66, s79
    v_mfma_f32_16x16x32_bf16 v[84:87], v[148:151], a[180:183], v[84:87]
    buffer_load_dwordx4 v[136:139], v23, s[24:27], s58 offen offset:0 sc1
    v_mfma_f32_16x16x32_bf16 v[88:91], v[148:151], a[184:187], v[88:91]
    v_mfma_f32_16x16x32_bf16 v[92:95], v[148:151], a[188:191], v[92:95]
    s_waitcnt vmcnt(9)
    v_mfma_f32_16x16x32_bf16 v[80:83], v[152:155], a[192:195], v[80:83]
    v_mfma_f32_16x16x32_bf16 v[84:87], v[152:155], a[196:199], v[84:87]
    buffer_load_dwordx4 v[140:143], v23, s[24:27], s58 offen offset:1024 sc1
    v_mfma_f32_16x16x32_bf16 v[88:91], v[152:155], a[200:203], v[88:91]
    v_mfma_f32_16x16x32_bf16 v[92:95], v[152:155], a[204:207], v[92:95]
    s_waitcnt vmcnt(9)
    v_mfma_f32_16x16x32_bf16 v[80:83], v[156:159], a[208:211], v[80:83]
    s_add_u32 s58, s66, s80
    v_mfma_f32_16x16x32_bf16 v[84:87], v[156:159], a[212:215], v[84:87]
    buffer_load_dwordx4 v[144:147], v23, s[24:27], s58 offen offset:0 sc1
    v_mfma_f32_16x16x32_bf16 v[88:91], v[156:159], a[216:219], v[88:91]
    v_mfma_f32_16x16x32_bf16 v[92:95], v[156:159], a[220:223], v[92:95]
    s_waitcnt vmcnt(9)
    v_mfma_f32_16x16x32_bf16 v[64:67], v[112:115], a[0:3], 0
    v_mfma_f32_16x16x32_bf16 v[68:71], v[112:115], a[4:7], 0
    buffer_load_dwordx4 v[148:151], v23, s[24:27], s58 offen offset:1024 sc1
    v_mfma_f32_16x16x32_bf16 v[72:75], v[112:115], a[8:11], 0
    v_mfma_f32_16x16x32_bf16 v[76:79], v[112:115], a[12:15], 0
    s_waitcnt vmcnt(9)
    v_mfma_f32_16x16x32_bf16 v[64:67], v[116:119], a[16:19], v[64:67]
    s_add_u32 s58, s66, s81
    v_mfma_f32_16x16x32_bf16 v[68:71], v[116:119], a[20:23], v[68:71]
    buffer_load_dwordx4 v[152:155], v23, s[24:27], s58 offen offset:0 sc1
    v_mfma_f32_16x16x32_bf16 v[72:75], v[116:119], a[24:27], v[72:75]
    v_mfma_f32_16x16x32_bf16 v[76:79], v[116:119], a[28:31], v[76:79]
    s_waitcnt vmcnt(9)
    v_mfma_f32_16x16x32_bf16 v[64:67], v[120:123], a[32:35], v[64:67]
    v_mfma_f32_16x16x32_bf16 v[68:71], v[120:123], a[36:39], v[68:71]
    buffer_load_dwordx4 v[156:159], v23, s[24:27], s58 offen offset:1024 sc1
    v_mfma_f32_16x16x32_bf16 v[72:75], v[120:123], a[40:43], v[72:75]
    v_mfma_f32_16x16x32_bf16 v[76:79], v[120:123], a[44:47], v[76:79]
    s_waitcnt vmcnt(9)
    v_mfma_f32_16x16x32_bf16 v[64:67], v[124:127], a[48:51], v[64:67]
    s_add_u32 s58, s66, s82
    v_mfma_f32_16x16x32_bf16 v[68:71], v[124:127], a[52:55], v[68:71]
    buffer_load_dwordx4 v[112:115], v23, s[24:27], s58 offen offset:0 sc1
    v_mfma_f32_16x16x32_bf16 v[72:75], v[124:127], a[56:59], v[72:75]
    v_mfma_f32_16x16x32_bf16 v[76:79], v[124:127], a[60:63], v[76:79]
    buffer_load_dwordx4 v[116:119], v23, s[24:27], s58 offen offset:1024 sc1
    s_waitcnt vmcnt(10)
    v_cmp_ne_u32 vcc, s47, v19
    s_nop 0
    s_cbranch_vccz L_ok10
    s_mov_b32 s59, 20000
L_spin9:
    s_sleep 2
    buffer_load_dword v19, v21, s[24:27], 0 offen sc1
    s_waitcnt vmcnt(0)
    v_cmp_ne_u32 vcc, s47, v19
    s_nop 0
    s_cbranch_vccz L_ok10
    s_sub_u32 s59, s59, 1
    s_cbranch_scc0 L_spin9
L_ok10:
    s_waitcnt vmcnt(9)
    v_mfma_f32_16x16x32_bf16 v[64:67], v[128:131], a[64:67], v[64:67]
    s_add_u32 s58, s70, 0
    v_mfma_f32_16x16x32_bf16 v[68:71], v[128:131], a[68:71], v[68:71]
    buffer_load_dwordx4 v[120:123], v23, s[24:27], s58 offen offset:0 sc1
    v_mfma_f32_16x16x32_bf16 v[72:75], v[128:131], a[72:75], v[72:75]
    v_mfma_f32_16x16x32_bf16 v[76:79], v[128:131], a[76:79], v[76:79]
    s_waitcnt vmcnt(9)
    v_mfma_f32_16x16x32_bf16 v[64:67], v[132:135], a[80:83], v[64:67]
    s_add_u32 s58, s70, 16384
    v_mfma_f32_16x16x32_bf16 v[68:71], v[132:135], a[84:87], v[68:71]
    buffer_load_dwordx4 v[124:127], v23, s[24:27], s58 offen offset:0 sc1
    v_mfma_f32_16x16x32_bf16 v[72:75], v[132:135], a[88:91], v[72:75]
    v_mfma_f32_16x16x32_bf16 v[76:79], v[132:135], a[92:95], v[76:79]
    s_waitcnt vmcnt(9)
    v_mfma_f32_16x16x32_bf16 v[64:67], v[136:139], a[96:99], v[64:67]
    s_add_u32 s58, s70, 32768
    v_mfma_f32_16x16x32_bf16 v[68:71], v[136:139], a[100:103], v[68:71]
    buffer_load_dwordx4 v[128:131], v23, s[24:27], s58 offen offset:0 sc1
    v_mfma_f32_16x16x32_bf16 v[72:75], v[136:139], a[104:107], v[72:75]
    v_mfma_f32_16x16x32_bf16 v[76:79], v[136:139], a[108:111], v[76:79]
    s_waitcnt vmcnt(9)
    v_mfma_f32_16x16x32_bf16 v[64:67], v[140:143], a[112:115], v[64:67]
    s_add_u32 s58, s70, 49152
    v_mfma_f32_16x16x32_bf16 v[68:71], v[140:143], a[116:119], v[68:71]
    buffer_load_dwordx4 v[132:135], v23, s[24:27], s58 offen offset:0 sc1
    v_mfma_f32_16x16x32_bf16 v[72:75], v[140:143], a[120:123], v[72:75]
    v_mfma_f32_16x16x32_bf16 v[76:79], v[140:143], a[124:127], v[76:79]
    s_waitcnt vmcnt(9)
    v_mfma_f32_16x16x32_bf16 v[64:67], v[144:147], a[128:131], v[64:67]
    s_add_u32 s58, s70, 0
    v_mfma_f32_16x16x32_bf16 v[68:71], v[144:147], a[132:135], v[68:71]
    buffer_load_dwordx4 v[136:139], v23, s[24:27], s58 offen offset:1024 sc1
    v_mfma_f32_16x16x32_bf16 v[72:75], v[144:147], a[136:139], v[72:75]
    v_mfma_f32_16x16x32_bf16 v[76:79], v[144:147], a[140:143], v[76:79]
    s_waitcnt vmcnt(9)
    v_mfma_f32_16x16x32_bf16 v[64:67], v[148:151], a[144:147], v[64:67]
    s_add_u32 s58, s70, 16384
    v_mfma_f32_16x16x32_bf16 v[68:71], v[148:151], a[148:151], v[68:71]
    buffer_load_dwordx4 v[140:143], v23, s[24:27], s58 offen offset:1024 sc1
    v_mfma_f32_16x16x32_bf16 v[72:75], v[148:151], a[152:155], v[72:75]
    v_mfma_f32_16x16x32_bf16 v[76:79], v[148:151], a[156:159], v[76:79]
    s_waitcnt vmcnt(9)
    v_mfma_f32_16x16x32_bf16 v[64:67], v[152:155], a[160:163], v[64:67]
    s_add_u32 s58, s70, 32768
    v_mfma_f32_16x16x32_bf16 v[68:71], v[152:155], a[164:167], v[68:71]
    buffer_load_dwordx4 v[144:147], v23, s[24:27], s58 offen offset:1024 sc1
    v_mfma_f32_16x16x32_bf16 v[72:75], v[152:155], a[168:171], v[72:75]
    v_mfma_f32_16x16x32_bf16 v[76:79], v[152:155], a[172:175], v[76:79]
    s_waitcnt vmcnt(9)
    v_mfma_f32_16x16x32_bf16 v[64:67], v[156:159], a[176:179], v[64:67]
    s_add_u32 s58, s70, 49152
    v_mfma_f32_16x16x32_bf16 v[68:71], v[156:159], a[180:183], v[68:71]
    buffer_load_dwordx4 v[148:151], v23, s[24:27], s58 offen offset:1024 sc1
    v_mfma_f32_16x16x32_bf16 v[72:75], v[156:159], a[184:187], v[72:75]
    v_mfma_f32_16x16x32_bf16 v[76:79], v[156:159], a[188:191], v[76:79]
    s_waitcnt vmcnt(9)
    v_mfma_f32_16x16x32_bf16 v[64:67], v[112:115], a[192:195], v[64:67]
    s_add_u32 s58, s70, 0
    v_mfma_f32_16x16x32_bf16 v[68:71], v[112:115], a[196:199], v[68:71]
    buffer_load_dwordx4 v[152:155], v23, s[24:27], s58 offen offset:2048 sc1
    v_mfma_f32_16x16x32_bf16 v[72:75], v[112:115], a[200:203], v[72:75]
    v_mfma_f32_16x16x32_bf16 v[76:79], v[112:115], a[204:207], v[76:79]
    s_waitcnt vmcnt(9)
    v_mfma_f32_16x16x32_bf16 v[64:67], v[116:119], a[208:211], v[64:67]
    s_add_u32 s58, s70, 16384
    v_mfma_f32_16x16x32_bf16 v[68:71], v[116:119], a[212:215], v[68:71]
    buffer_load_dwordx4 v[156:159], v23, s[24:27], s58 offen offset:2048 sc1
    v_mfma_f32_16x16x32_bf16 v[72:75], v[116:119], a[216:219], v[72:75]
    v_mfma_f32_16x16x32_bf16 v[76:79], v[116:119], a[220:223], v[76:79]
    s_waitcnt vmcnt(9)
    s_waitcnt lgkmcnt(8)
    v_mfma_f32_16x16x32_bf16 v[32:35], a[224:227], v[120:123], 0
    s_add_u32 s58, s70, 32768
    v_mfma_f32_16x16x32_bf16 v[48:51], a[228:231], v[120:123], 0
    buffer_load_dwordx4 v[112:115], v23, s[24:27], s58 offen offset:2048 sc1
    v_mfma_f32_16x16x32_bf16 v[64:67], a[232:235], v[120:123], v[64:67]
    v_mfma_f32_16x16x32_bf16 v[80:83], a[236:239], v[120:123], v[80:83]
    v_mfma_f32_16x16x32_bf16 v[96:99], v[192:195], v[120:123], v[96:99]
    s_waitcnt vmcnt(9)
    v_mfma_f32_16x16x32_bf16 v[36:39], a[224:227], v[124:127], 0
    s_add_u32 s58, s70, 49152
    v_mfma_f32_16x16x32_bf16 v[52:55], a[228:231], v[124:127], 0
    buffer_load_dwordx4 v[116:119], v23, s[24:27], s58 offen offset:2048 sc1
    v_mfma_f32_16x16x32_bf16 v[68:71], a[232:235], v[124:127], v[68:71]
    v_mfma_f32_16x16x32_bf16 v[84:87], a[236:239], v[124:127], v[84:87]
    v_mfma_f32_16x16x32_bf16 v[100:103], v[192:195], v[124:127], v[100:103]
    s_waitcnt vmcnt(9)
    v_mfma_f32_16x16x32_bf16 v[40:43], a[224:227], v[128:131], 0
    s_add_u32 s58, s70, 0
    v_mfma_f32_16x16x32_bf16 v[56:59], a[228:231], v[128:131], 0
    buffer_load_dwordx4 v[120:123], v23, s[24:27], s58 offen offset:3072 sc1
    v_mfma_f32_16x16x32_bf16 v[72:75], a[232:235], v[128:131], v[72:75]
    v_mfma_f32_16x16x32_bf16 v[88:91], a[236:239], v[128:131], v[88:91]
    v_mfma_f32_16x16x32_bf16 v[104:107], v[192:195], v[128:131], v[104:107]
    s_waitcnt vmcnt(9)
    v_mfma_f32_16x16x32_bf16 v[44:47], a[224:227], v[132:135], 0
    s_add_u32 s58, s70, 16384
    v_mfma_f32_16x16x32_bf16 v[60:63], a[228:231], v[132:135], 0
    buffer_load_dwordx4 v[124:127], v23, s[24:27], s58 offen offset:3072 sc1
    v_mfma_f32_16x16x32_bf16 v[76:79], a[232:235], v[132:135], v[76:79]
    v_mfma_f32_16x16x32_bf16 v[92:95], a[236:239], v[132:135], v[92:95]
    v_mfma_f32_16x16x32_bf16 v[108:111], v[192:195], v[132:135], v[108:111]
    ds_read_b64_tr_b16 a[224:225], v4 offset:16384
    ds_read_b64_tr_b16 a[226:227], v4 offset:16896
    ds_read_b64_tr_b16 a[228:229], v5 offset:16384
    ds_read_b64_tr_b16 a[230:231], v5 offset:16896
    s_waitcnt vmcnt(9)
    s_waitcnt lgkmcnt(4)
    v_mfma_f32_16x16x32_bf16 v[32:35], a[240:243], v[136:139], v[32:35]
    s_add_u32 s58, s70, 32768
    v_mfma_f32_16x16x32_bf16 v[48:51], a[244:247], v[136:139], v[48:51]
    buffer_load_dwordx4 v[128:131], v23, s[24:27], s58 offen offset:3072 sc1
    v_mfma_f32_16x16x32_bf16 v[64:67], a[248:251], v[136:139], v[64:67]
    v_mfma_f32_16x16x32_bf16 v[80:83], a[252:255], v[136:139], v[80:83]
    v_mfma_f32_16x16x32_bf16 v[96:99], v[196:199], v[136:139], v[96:99]
    ds_read_b64_tr_b16 a[232:233], v4 offset:16640
    ds_read_b64_tr_b16 a[234:235], v4 offset:17152
    ds_read_b64_tr_b16 a[236:237], v5 offset:16640
    ds_read_b64_tr_b16 a[238:239], v5 offset:17152
    s_waitcnt vmcnt(9)
    v_mfma_f32_16x16x32_bf16 v[36:39], a[240:243], v[140:143], v[36:39]
    s_add_u32 s58, s70, 49152
    v_mfma_f32_16x16x32_bf16 v[52:55], a[244:247], v[140:143], v[52:55]
    buffer_load_dwordx4 v[132:135], v23, s[24:27], s58 offen offset:3072 sc1
    v_mfma_f32_16x16x32_bf16 v[68:71], a[248:251], v[140:143], v[68:71]
    v_mfma_f32_16x16x32_bf16 v[84:87], a[252:255], v[140:143], v[84:87]
    v_mfma_f32_16x16x32_bf16 v[100:103], v[196:199], v[140:143], v[100:103]
    s_waitcnt vmcnt(9)
    v_mfma_f32_16x16x32_bf16 v[40:43], a[240:243], v[144:147], v[40:43]
    s_xor_b32 s66, s44, 1
    s_lshl2_add_u32 s66, s49, s66
    s_mul_i32 s66, s66, 58624
    s_add_u32 s66, s66, s69
    s_add_u32 s58, s66, s76
    v_mfma_f32_16x16x32_bf16 v[56:59], a[244:247], v[144:147], v[56:59]
    buffer_load_dwordx4 v[136:139], v23, s[24:27], s58 offen offset:0 sc1
    v_mfma_f32_16x16x32_bf16 v[72:75], a[248:251], v[144:147], v[72:75]
    v_mfma_f32_16x16x32_bf16 v[88:91], a[252:255], v[144:147], v[88:91]
    v_mfma_f32_16x16x32_bf16 v[104:107], v[196:199], v[144:147], v[104:107]
    s_waitcnt vmcnt(9)
    v_mfma_f32_16x16x32_bf16 v[44:47], a[240:243], v[148:151], v[44:47]
    v_mfma_f32_16x16x32_bf16 v[60:63], a[244:247], v[148:151], v[60:63]
    buffer_load_dwordx4 v[140:143], v23, s[24:27], s58 offen offset:1024 sc1
    v_mfma_f32_16x16x32_bf16 v[76:79], a[248:251], v[148:151], v[76:79]
    v_mfma_f32_16x16x32_bf16 v[92:95], a[252:255], v[148:151], v[92:95]
    v_mfma_f32_16x16x32_bf16 v[108:111], v[196:199], v[148:151], v[108:111]
    ds_read_b64_tr_b16 a[240:241], v4 offset:32768
    ds_read_b64_tr_b16 a[242:243], v4 offset:33280
    ds_read_b64_tr_b16 a[244:245], v5 offset:32768
    ds_read_b64_tr_b16 a[246:247], v5 offset:33280
    s_waitcnt vmcnt(9)
    s_waitcnt lgkmcnt(4)
    v_mfma_f32_16x16x32_bf16 v[32:35], a[224:227], v[152:155], v[32:35]
    s_add_u32 s58, s66, s77
    v_mfma_f32_16x16x32_bf16 v[48:51], a[228:231], v[152:155], v[48:51]
    buffer_load_dwordx4 v[144:147], v23, s[24:27], s58 offen offset:0 sc1
    v_mfma_f32_16x16x32_bf16 v[64:67], a[232:235], v[152:155], v[64:67]
    v_mfma_f32_16x16x32_bf16 v[80:83], a[236:239], v[152:155], v[80:83]
    v_mfma_f32_16x16x32_bf16 v[96:99], v[200:203], v[152:155], v[96:99]
    ds_read_b64_tr_b16 a[248:249], v4 offset:33024
    ds_read_b64_tr_b16 a[250:251], v4 offset:33536
    ds_read_b64_tr_b16 a[252:253], v5 offset:33024
    ds_read_b64_tr_b16 a[254:255], v5 offset:33536
    s_waitcnt vmcnt(9)
    v_mfma_f32_16x16x32_bf16 v[36:39], a[224:227], v[156:159], v[36:39]
    v_mfma_f32_16x16x32_bf16 v[52:55], a[228:231], v[156:159], v[52:55]
    buffer_load_dwordx4 v[148:151], v23, s[24:27], s58 offen offset:1024 sc1
    v_mfma_f32_16x16x32_bf16 v[68:71], a[232:235], v[156:159], v[68:71]
    v_mfma_f32_16x16x32_bf16 v[84:87], a[236:239], v[156:159], v[84:87]
    v_mfma_f32_16x16x32_bf16 v[100:103], v[200:203], v[156:159], v[100:103]
    s_waitcnt vmcnt(9)
    v_mfma_f32_16x16x32_bf16 v[40:43], a[224:227], v[112:115], v[40:43]
    s_add_u32 s58, s66, s78
    v_mfma_f32_16x16x32_bf16 v[56:59], a[228:231], v[112:115], v[56:59]
    buffer_load_dwordx4 v[152:155], v23, s[24:27], s58 offen offset:0 sc1
    v_mfma_f32_16x16x32_bf16 v[72:75], a[232:235], v[112:115], v[72:75]
    v_mfma_f32_16x16x32_bf16 v[88:91], a[236:239], v[112:115], v[88:91]
    v_mfma_f32_16x16x32_bf16 v[104:107], v[200:203], v[112:115], v[104:107]
    s_waitcnt vmcnt(9)
    v_mfma_f32_16x16x32_bf16 v[44:47], a[224:227], v[116:119], v[44:47]
    v_mfma_f32_16x16x32_bf16 v[60:63], a[228:231], v[116:119], v[60:63]
    buffer_load_dwordx4 v[156:159], v23, s[24:27], s58 offen offset:1024 sc1
    v_mfma_f32_16x16x32_bf16 v[76:79], a[232:235], v[116:119], v[76:79]
    v_mfma_f32_16x16x32_bf16 v[92:95], a[236:239], v[116:119], v[92:95]
    v_mfma_f32_16x16x32_bf16 v[108:111], v[200:203], v[116:119], v[108:111]
    s_waitcnt vmcnt(9)
    s_waitcnt lgkmcnt(0)
    v_mfma_f32_16x16x32_bf16 v[32:35], a[240:243], v[120:123], v[32:35]
    s_add_u32 s58, s66, s79
    v_mfma_f32_16x16x32_bf16 v[48:51], a[244:247], v[120:123], v[48:51]
    buffer_load_dwordx4 v[112:115], v23, s[24:27], s58 offen offset:0 sc1
    v_mfma_f32_16x16x32_bf16 v[64:67], a[248:251], v[120:123], v[64:67]
    v_mfma_f32_16x16x32_bf16 v[80:83], a[252:255], v[120:123], v[80:83]
    v_mfma_f32_16x16x32_bf16 v[96:99], v[204:207], v[120:123], v[96:99]
    s_waitcnt vmcnt(9)
    v_mfma_f32_16x16x32_bf16 v[36:39], a[240:243], v[124:127], v[36:39]
    v_mfma_f32_16x16x32_bf16 v[52:55], a[244:247], v[124:127], v[52:55]
    buffer_load_dwordx4 v[116:119], v23, s[24:27], s58 offen offset:1024 sc1
    v_mfma_f32_16x16x32_bf16 v[68:71], a[248:251], v[124:127], v[68:71]
    v_mfma_f32_16x16x32_bf16 v[84:87], a[252:255], v[124:127], v[84:87]
    v_mfma_f32_16x16x32_bf16 v[100:103], v[204:207], v[124:127], v[100:103]
    s_waitcnt vmcnt(9)
    v_mfma_f32_16x16x32_bf16 v[40:43], a[240:243], v[128:131], v[40:43]
    s_add_u32 s58, s66, s80
    v_mfma_f32_16x16x32_bf16 v[56:59], a[244:247], v[128:131], v[56:59]
    buffer_load_dwordx4 v[120:123], v23, s[24:27], s58 offen offset:0 sc1
    v_mfma_f32_16x16x32_bf16 v[72:75], a[248:251], v[128:131], v[72:75]
    v_mfma_f32_16x16x32_bf16 v[88:91], a[252:255], v[128:131], v[88:91]
    v_mfma_f32_16x16x32_bf16 v[104:107], v[204:207], v[128:131], v[104:107]
    s_waitcnt vmcnt(9)
    v_mfma_f32_16x16x32_bf16 v[44:47], a[240:243], v[132:135], v[44:47]
    v_mfma_f32_16x16x32_bf16 v[60:63], a[244:247], v[132:135], v[60:63]
    buffer_load_dwordx4 v[124:127], v23, s[24:27], s58 offen offset:1024 sc1
    v_mfma_f32_16x16x32_bf16 v[76:79], a[248:251], v[132:135], v[76:79]
    v_mfma_f32_16x16x32_bf16 v[92:95], a[252:255], v[132:135], v[92:95]
    v_mfma_f32_16x16x32_bf16 v[108:111], v[204:207], v[132:135], v[108:111]
    s_waitcnt vmcnt(9)
    v_mfma_f32_16x16x32_bf16 v[48:51], v[136:139], a[0:3], v[48:51]
    s_add_u32 s58, s66, s81
    v_mfma_f32_16x16x32_bf16 v[52:55], v[136:139], a[4:7], v[52:55]
    buffer_load_dwordx4 v[128:131], v23, s[24:27], s58 offen offset:0 sc1
    v_mfma_f32_16x16x32_bf16 v[56:59], v[136:139], a[8:11], v[56:59]
    v_mfma_f32_16x16x32_bf16 v[60:63], v[136:139], a[12:15], v[60:63]
    s_waitcnt vmcnt(9)
    v_mfma_f32_16x16x32_bf16 v[48:51], v[140:143], a[16:19], v[48:51]
    v_mfma_f32_16x16x32_bf16 v[52:55], v[140:143], a[20:23], v[52:55]
    buffer_load_dwordx4 v[132:135], v23, s[24:27], s58 offen offset:1024 sc1
    v_mfma_f32_16x16x32_bf16 v[56:59], v[140:143], a[24:27], v[56:59]
    v_mfma_f32_16x16x32_bf16 v[60:63], v[140:143], a[28:31], v[60:63]
    s_waitcnt vmcnt(9)
    v_mfma_f32_16x16x32_bf16 v[48:51], v[144:147], a[32:35], v[48:51]
    s_add_u32 s58, s66, s82
    v_mfma_f32_16x16x32_bf16 v[52:55], v[144:147], a[36:39], v[52:55]
    buffer_load_dwordx4 v[136:139], v23, s[24:27], s58 offen offset:0 sc1
    v_mfma_f32_16x16x32_bf16 v[56:59], v[144:147], a[40:43], v[56:59]
    ds_write_b128 v242, v[96:99] offset:0
    v_mfma_f32_16x16x32_bf16 v[60:63], v[144:147], a[44:47], v[60:63]
    s_waitcnt vmcnt(9)
    v_mfma_f32_16x16x32_bf16 v[48:51], v[148:151], a[48:51], v[48:51]
    v_mfma_f32_16x16x32_bf16 v[52:55], v[148:151], a[52:55], v[52:55]
    buffer_load_dwordx4 v[140:143], v23, s[24:27], s58 offen offset:1024 sc1
    v_mfma_f32_16x16x32_bf16 v[56:59], v[148:151], a[56:59], v[56:59]
    ds_write_b128 v242, v[100:103] offset:1024
    v_mfma_f32_16x16x32_bf16 v[60:63], v[148:151], a[60:63], v[60:63]
    s_waitcnt vmcnt(9)
    v_mfma_f32_16x16x32_bf16 v[48:51], v[152:155], a[64:67], v[48:51]
    s_xor_b32 s66, s44, 0
    s_lshl2_add_u32 s66, s49, s66
    s_mul_i32 s66, s66, 58624
    s_add_u32 s66, s66, s69
    s_add_u32 s58, s66, s76
    v_mfma_f32_16x16x32_bf16 v[52:55], v[152:155], a[68:71], v[52:55]
    buffer_load_dwordx4 v[144:147], v23, s[24:27], s58 offen offset:0 sc1
    v_mfma_f32_16x16x32_bf16 v[56:59], v[152:155], a[72:75], v[56:59]
    ds_write_b128 v242, v[104:107] offset:2048
    v_mfma_f32_16x16x32_bf16 v[60:63], v[152:155], a[76:79], v[60:63]
    s_waitcnt vmcnt(9)
    v_mfma_f32_16x16x32_bf16 v[48:51], v[156:159], a[80:83], v[48:51]
    v_mfma_f32_16x16x32_bf16 v[52:55], v[156:159], a[84:87], v[52:55]
    buffer_load_dwordx4 v[148:151], v23, s[24:27], s58 offen offset:1024 sc1
    v_mfma_f32_16x16x32_bf16 v[56:59], v[156:159], a[88:91], v[56:59]
    ds_write_b128 v242, v[108:111] offset:3072
    v_mfma_f32_16x16x32_bf16 v[60:63], v[156:159], a[92:95], v[60:63]
    s_waitcnt vmcnt(9)
    v_mfma_f32_16x16x32_bf16 v[48:51], v[112:115], a[96:99], v[48:51]
    s_add_u32 s58, s66, s77
    v_mfma_f32_16x16x32_bf16 v[52:55], v[112:115], a[100:103], v[52:55]
    buffer_load_dwordx4 v[152:155], v23, s[24:27], s58 offen offset:0 sc1
    v_mfma_f32_16x16x32_bf16 v[56:59], v[112:115], a[104:107], v[56:59]
    ds_write_b128 v241, v[80:83] offset:0
    v_mfma_f32_16x16x32_bf16 v[60:63], v[112:115], a[108:111], v[60:63]
    s_waitcnt vmcnt(9)
    v_mfma_f32_16x16x32_bf16 v[48:51], v[116:119], a[112:115], v[48:51]
    v_mfma_f32_16x16x32_bf16 v[52:55], v[116:119], a[116:119], v[52:55]
    buffer_load_dwordx4 v[156:159], v23, s[24:27], s58 offen offset:1024 sc1
    v_mfma_f32_16x16x32_bf16 v[56:59], v[116:119], a[120:123], v[56:59]
    ds_write_b128 v241, v[84:87] offset:16384
    v_mfma_f32_16x16x32_bf16 v[60:63], v[116:119], a[124:127], v[60:63]
    s_waitcnt vmcnt(9)
    v_mfma_f32_16x16x32_bf16 v[48:51], v[120:123], a[128:131], v[48:51]
    s_add_u32 s58, s66, s78
    v_mfma_f32_16x16x32_bf16 v[52:55], v[120:123], a[132:135], v[52:55]
    buffer_load_dwordx4 v[112:115], v23, s[24:27], s58 offen offset:0 sc1
    v_mfma_f32_16x16x32_bf16 v[56:59], v[120:123], a[136:139], v[56:59]
    ds_write_b128 v241, v[88:91] offset:32768
    v_mfma_f32_16x16x32_bf16 v[60:63], v[120:123], a[140:143], v[60:63]
    s_waitcnt vmcnt(9)
    v_mfma_f32_16x16x32_bf16 v[48:51], v[124:127], a[144:147], v[48:51]
    v_mfma_f32_16x16x32_bf16 v[52:55], v[124:127], a[148:151], v[52:55]
    buffer_load_dwordx4 v[116:119], v23, s[24:27], s58 offen offset:1024 sc1
    v_mfma_f32_16x16x32_bf16 v[56:59], v[124:127], a[152:155], v[56:59]
    ds_write_b128 v241, v[92:95] offset:49152
    v_mfma_f32_16x16x32_bf16 v[60:63], v[124:127], a[156:159], v[60:63]
    s_waitcnt vmcnt(9)
    v_mfma_f32_16x16x32_bf16 v[48:51], v[128:131], a[160:163], v[48:51]
    s_add_u32 s58, s66, s79
    v_mfma_f32_16x16x32_bf16 v[52:55], v[128:131], a[164:167], v[52:55]
    buffer_load_dwordx4 v[120:123], v23, s[24:27], s58 offen offset:0 sc1
    v_mfma_f32_16x16x32_bf16 v[56:59], v[128:131], a[168:171], v[56:59]
    ds_write_b128 v240, v[64:67] offset:0
    v_mfma_f32_16x16x32_bf16 v[60:63], v[128:131], a[172:175], v[60:63]
    s_waitcnt vmcnt(9)
    v_mfma_f32_16x16x32_bf16 v[48:51], v[132:135], a[176:179], v[48:51]
    v_mfma_f32_16x16x32_bf16 v[52:55], v[132:135], a[180:183], v[52:55]
    buffer_load_dwordx4 v[124:127], v23, s[24:27], s58 offen offset:1024 sc1
    v_mfma_f32_16x16x32_bf16 v[56:59], v[132:135], a[184:187], v[56:59]
    ds_write_b128 v240, v[68:71] offset:16384
    v_mfma_f32_16x16x32_bf16 v[60:63], v[132:135], a[188:191], v[60:63]
    s_waitcnt vmcnt(9)
    v_mfma_f32_16x16x32_bf16 v[48:51], v[136:139], a[192:195], v[48:51]
    s_add_u32 s58, s66, s80
    v_mfma_f32_16x16x32_bf16 v[52:55], v[136:139], a[196:199], v[52:55]
    buffer_load_dwordx4 v[128:131], v23, s[24:27], s58 offen offset:0 sc1
    v_mfma_f32_16x16x32_bf16 v[56:59], v[136:139], a[200:203], v[56:59]
    ds_write_b128 v240, v[72:75] offset:32768
    v_mfma_f32_16x16x32_bf16 v[60:63], v[136:139], a[204:207], v[60:63]
    s_waitcnt vmcnt(9)
    v_mfma_f32_16x16x32_bf16 v[48:51], v[140:143], a[208:211], v[48:51]
    v_mfma_f32_16x16x32_bf16 v[52:55], v[140:143], a[212:215], v[52:55]
    buffer_load_dwordx4 v[132:135], v23, s[24:27], s58 offen offset:1024 sc1
    v_mfma_f32_16x16x32_bf16 v[56:59], v[140:143], a[216:219], v[56:59]
    ds_write_b128 v240, v[76:79] offset:49152
    v_mfma_f32_16x16x32_bf16 v[60:63], v[140:143], a[220:223], v[60:63]
    s_waitcnt vmcnt(9)
    v_mfma_f32_16x16x32_bf16 v[32:35], v[144:147], a[0:3], v[32:35]
    s_add_u32 s58, s66, s81
    v_mfma_f32_16x16x32_bf16 v[36:39], v[144:147], a[4:7], v[36:39]
    buffer_load_dwordx4 v[136:139], v23, s[24:27], s58 offen offset:0 sc1
    v_mfma_f32_16x16x32_bf16 v[40:43], v[144:147], a[8:11], v[40:43]
    v_mfma_f32_16x16x32_bf16 v[44:47], v[144:147], a[12:15], v[44:47]
    s_waitcnt vmcnt(9)
    v_mfma_f32_16x16x32_bf16 v[32:35], v[148:151], a[16:19], v[32:35]
    v_mfma_f32_16x16x32_bf16 v[36:39], v[148:151], a[20:23], v[36:39]
    buffer_load_dwordx4 v[140:143], v23, s[24:27], s58 offen offset:1024 sc1
    v_mfma_f32_16x16x32_bf16 v[40:43], v[148:151], a[24:27], v[40:43]
    ds_write_b128 v239, v[48:51] offset:0
    v_mfma_f32_16x16x32_bf16 v[44:47], v[148:151], a[28:31], v[44:47]
    ds_write_b128 v239, v[52:55] offset:16384
    s_waitcnt vmcnt(9)
    v_mfma_f32_16x16x32_bf16 v[32:35], v[152:155], a[32:35], v[32:35]
    s_add_u32 s58, s66, s82
    v_mfma_f32_16x16x32_bf16 v[36:39], v[152:155], a[36:39], v[36:39]
    buffer_load_dwordx4 v[144:147], v23, s[24:27], s58 offen offset:0 sc1
    v_mfma_f32_16x16x32_bf16 v[40:43], v[152:155], a[40:43], v[40:43]
    ds_write_b128 v239, v[56:59] offset:32768
    v_mfma_f32_16x16x32_bf16 v[44:47], v[152:155], a[44:47], v[44:47]
    ds_write_b128 v239, v[60:63] offset:49152
    s_waitcnt vmcnt(9)
    v_mfma_f32_16x16x32_bf16 v[32:35], v[156:159], a[48:51], v[32:35]
    v_mfma_f32_16x16x32_bf16 v[36:39], v[156:159], a[52:55], v[36:39]
    buffer_load_dwordx4 v[148:151], v23, s[24:27], s58 offen offset:1024 sc1
    v_mfma_f32_16x16x32_bf16 v[40:43], v[156:159], a[56:59], v[40:43]
    v_mfma_f32_16x16x32_bf16 v[44:47], v[156:159], a[60:63], v[44:47]
    s_waitcnt vmcnt(9)
    v_mfma_f32_16x16x32_bf16 v[32:35], v[112:115], a[64:67], v[32:35]
    v_mfma_f32_16x16x32_bf16 v[36:39], v[112:115], a[68:71], v[36:39]
    v_mfma_f32_16x16x32_bf16 v[40:43], v[112:115], a[72:75], v[40:43]
    v_mfma_f32_16x16x32_bf16 v[44:47], v[112:115], a[76:79], v[44:47]
    s_waitcnt vmcnt(8)
    v_mfma_f32_16x16x32_bf16 v[32:35], v[116:119], a[80:83], v[32:35]
    s_waitcnt lgkmcnt(0)
    s_barrier
    v_mfma_f32_16x16x32_bf16 v[36:39], v[116:119], a[84:87], v[36:39]
    v_mfma_f32_16x16x32_bf16 v[40:43], v[116:119], a[88:91], v[40:43]
    v_mfma_f32_16x16x32_bf16 v[44:47], v[116:119], a[92:95], v[44:47]
    s_waitcnt vmcnt(7)
    v_mfma_f32_16x16x32_bf16 v[32:35], v[120:123], a[96:99], v[32:35]
    ds_read_b128 v[160:163], v252 offset:0
    v_mfma_f32_16x16x32_bf16 v[36:39], v[120:123], a[100:103], v[36:39]
    ds_read_b128 v[164:167], v252 offset:4096
    v_mfma_f32_16x16x32_bf16 v[40:43], v[120:123], a[104:107], v[40:43]
    ds_read_b128 v[168:171], v252 offset:8192
    v_mfma_f32_16x16x32_bf16 v[44:47], v[120:123], a[108:111], v[44:47]
    ds_read_b128 v[172:175], v252 offset:12288
    s_waitcnt vmcnt(6)
    v_mfma_f32_16x16x32_bf16 v[32:35], v[124:127], a[112:115], v[32:35]
    ds_read_b128 v[48:51], v246 offset:0
    v_mfma_f32_16x16x32_bf16 v[36:39], v[124:127], a[116:119], v[36:39]
    ds_read_b128 v[64:67], v248 offset:0
    v_mfma_f32_16x16x32_bf16 v[40:43], v[124:127], a[120:123], v[40:43]
    ds_read_b128 v[80:83], v250 offset:0
    v_mfma_f32_16x16x32_bf16 v[44:47], v[124:127], a[124:127], v[44:47]
    ds_read_b128 v[52:55], v247 offset:0
    s_waitcnt vmcnt(5)
    v_mfma_f32_16x16x32_bf16 v[32:35], v[128:131], a[128:131], v[32:35]
    ds_read_b128 v[68:71], v249 offset:0
    v_mfma_f32_16x16x32_bf16 v[36:39], v[128:131], a[132:135], v[36:39]
    ds_read_b128 v[84:87], v251 offset:0
    v_mfma_f32_16x16x32_bf16 v[40:43], v[128:131], a[136:139], v[40:43]
    ds_read_b128 v[56:59], v246 offset:32768
    v_mfma_f32_16x16x32_bf16 v[44:47], v[128:131], a[140:143], v[44:47]
    ds_read_b128 v[72:75], v248 offset:32768
    s_waitcnt vmcnt(4)
    v_mfma_f32_16x16x32_bf16 v[32:35], v[132:135], a[144:147], v[32:35]
    ds_read_b128 v[88:91], v250 offset:32768
    v_mfma_f32_16x16x32_bf16 v[36:39], v[132:135], a[148:151], v[36:39]
    ds_read_b128 v[60:63], v247 offset:32768
    v_mfma_f32_16x16x32_bf16 v[40:43], v[132:135], a[152:155], v[40:43]
    ds_read_b128 v[76:79], v249 offset:32768
    v_mfma_f32_16x16x32_bf16 v[44:47], v[132:135], a[156:159], v[44:47]
    ds_read_b128 v[92:95], v251 offset:32768
    s_waitcnt vmcnt(3)
    v_mfma_f32_16x16x32_bf16 v[32:35], v[136:139], a[160:163], v[32:35]
    s_waitcnt lgkmcnt(12)
    v_add_f32 v232, v232, v160
    v_mfma_f32_16x16x32_bf16 v[36:39], v[136:139], a[164:167], v[36:39]
    v_add_f32 v233, v233, v161
    v_mfma_f32_16x16x32_bf16 v[40:43], v[136:139], a[168:171], v[40:43]
    v_add_f32 v234, v234, v162
    v_mfma_f32_16x16x32_bf16 v[44:47], v[136:139], a[172:175], v[44:47]
    v_add_f32 v235, v235, v163
    s_waitcnt vmcnt(2)
    v_mfma_f32_16x16x32_bf16 v[32:35], v[140:143], a[176:179], v[32:35]
    v_add_f32 v232, v232, v164
    v_add_f32 v233, v233, v165
    v_mfma_f32_16x16x32_bf16 v[36:39], v[140:143], a[180:183], v[36:39]
    v_add_f32 v234, v234, v166
    v_mfma_f32_16x16x32_bf16 v[40:43], v[140:143], a[184:187], v[40:43]
    v_add_f32 v235, v235, v167
    v_mfma_f32_16x16x32_bf16 v[44:47], v[140:143], a[188:191], v[44:47]
    v_add_f32 v232, v232, v168
    s_waitcnt vmcnt(1)
    v_mfma_f32_16x16x32_bf16 v[32:35], v[144:147], a[192:195], v[32:35]
    v_add_f32 v233, v233, v169
    v_add_f32 v234, v234, v170
    v_mfma_f32_16x16x32_bf16 v[36:39], v[144:147], a[196:199], v[36:39]
    v_add_f32 v235, v235, v171
    v_mfma_f32_16x16x32_bf16 v[40:43], v[144:147], a[200:203], v[40:43]
    v_add_f32 v232, v232, v172
    v_mfma_f32_16x16x32_bf16 v[44:47], v[144:147], a[204:207], v[44:47]
    v_add_f32 v233, v233, v173
    s_waitcnt vmcnt(0)
    v_mfma_f32_16x16x32_bf16 v[32:35], v[148:151], a[208:211], v[32:35]
    v_add_f32 v234, v234, v174
    v_mfma_f32_16x16x32_bf16 v[36:39], v[148:151], a[212:215], v[36:39]
    v_add_f32 v235, v235, v175
    v_mfma_f32_16x16x32_bf16 v[40:43], v[148:151], a[216:219], v[40:43]
    v_cvt_pk_bf16_f32 v226, v232, v233
    v_cvt_pk_bf16_f32 v227, v234, v235
    v_mfma_f32_16x16x32_bf16 v[44:47], v[148:151], a[220:223], v[44:47]
    s_waitcnt lgkmcnt(0)
    buffer_store_dwordx2 v[226:227], v26, s[28:31], s73 offen
    v_pk_add_f32 v[176:177], v[176:177], v[48:49]
    v_pk_add_f32 v[178:179], v[178:179], v[50:51]
    v_pk_add_f32 v[180:181], v[180:181], v[52:53]
    v_pk_add_f32 v[182:183], v[182:183], v[54:55]
    v_pk_add_f32 v[184:185], v[184:185], v[56:57]
    v_pk_add_f32 v[186:187], v[186:187], v[58:59]
    ds_write_b128 v238, v[32:35] offset:0
    ds_write_b128 v238, v[36:39] offset:16384
    ds_write_b128 v238, v[40:43] offset:32768
    ds_write_b128 v238, v[44:47] offset:49152
    v_pk_add_f32 v[188:189], v[188:189], v[60:61]
    v_pk_add_f32 v[190:191], v[190:191], v[62:63]
    v_pk_add_f32 v[176:177], v[176:177], v[64:65]
    v_pk_add_f32 v[178:179], v[178:179], v[66:67]
    v_pk_add_f32 v[180:181], v[180:181], v[68:69]
    v_pk_add_f32 v[182:183], v[182:183], v[70:71]
    v_pk_add_f32 v[184:185], v[184:185], v[72:73]
    v_pk_add_f32 v[186:187], v[186:187], v[74:75]
    v_pk_add_f32 v[188:189], v[188:189], v[76:77]
    v_pk_add_f32 v[190:191], v[190:191], v[78:79]
    v_pk_add_f32 v[176:177], v[176:177], v[80:81]
    v_pk_add_f32 v[178:179], v[178:179], v[82:83]
    v_pk_add_f32 v[180:181], v[180:181], v[84:85]
    v_pk_add_f32 v[182:183], v[182:183], v[86:87]
    v_pk_add_f32 v[184:185], v[184:185], v[88:89]
    v_pk_add_f32 v[186:187], v[186:187], v[90:91]
    v_pk_add_f32 v[188:189], v[188:189], v[92:93]
    v_pk_add_f32 v[190:191], v[190:191], v[94:95]
    s_waitcnt lgkmcnt(0)
    s_barrier
    ds_read_b128 v[160:163], v244 offset:0
    ds_read_b128 v[164:167], v245 offset:0
    ds_read_b128 v[168:171], v244 offset:32768
    ds_read_b128 v[172:175], v245 offset:32768
    s_waitcnt lgkmcnt(2)
    v_pk_add_f32 v[176:177], v[176:177], v[160:161]
    v_pk_add_f32 v[178:179], v[178:179], v[162:163]
    v_pk_add_f32 v[180:181], v[180:181], v[164:165]
    v_pk_add_f32 v[182:183], v[182:183], v[166:167]
    v_cvt_pk_bf16_f32 v216, v176, v177
    v_cvt_pk_bf16_f32 v217, v178, v179
    v_cvt_pk_bf16_f32 v218, v180, v181
    v_cvt_pk_bf16_f32 v219, v182, v183
    buffer_store_dwordx4 v[216:219], v22, s[28:31], s71 offen
    s_waitcnt lgkmcnt(0)
    v_pk_add_f32 v[184:185], v[184:185], v[168:169]
    v_pk_add_f32 v[186:187], v[186:187], v[170:171]
    v_pk_add_f32 v[188:189], v[188:189], v[172:173]
    v_pk_add_f32 v[190:191], v[190:191], v[174:175]
    v_cvt_pk_bf16_f32 v220, v184, v185
    v_cvt_pk_bf16_f32 v221, v186, v187
    v_cvt_pk_bf16_f32 v222, v188, v189
    v_cvt_pk_bf16_f32 v223, v190, v191
    buffer_store_dwordx4 v[220:223], v22, s[28:31], s72 offen
L_end:
    s_endpgm
L_p2_alt:
    s_add_u32 s57, s57, 27648
    buffer_load_dwordx4 v10, s[16:19], s57 offen offset:2048 lds
    s_add_u32 s57, s57, 27648
    buffer_load_dwordx4 v11, s[16:19], s57 offen offset:3072 lds
    s_xor_b32 s66, s44, 3
    s_lshl2_add_u32 s66, s51, s66
    s_mul_i32 s66, s66, 66816
    s_lshl2_add_u32 s66, s52, s66
    s_lshl_b32 s86, s65, 10
    s_add_u32 s58, s86, s66
    buffer_load_dwordx4 v[128:131], v23, s[24:27], s58 offen offset:0 sc1
    s_add_u32 s86, s86, 1024
    s_and_b32 s86, s86, 16383
    s_add_u32 s58, s86, s66
    buffer_load_dwordx4 v[132:135], v23, s[24:27], s58 offen offset:0 sc1
    s_add_u32 s86, s86, 1024
    s_and_b32 s86, s86, 16383
    s_add_u32 s58, s86, s66
    buffer_load_dwordx4 v[136:139], v23, s[24:27], s58 offen offset:0 sc1
    s_add_u32 s86, s86, 1024
    s_and_b32 s86, s86, 16383
    s_add_u32 s58, s86, s66
    buffer_load_dwordx4 v[140:143], v23, s[24:27], s58 offen offset:0 sc1
    s_add_u32 s86, s86, 1024
    s_and_b32 s86, s86, 16383
    s_add_u32 s58, s86, s66
    buffer_load_dwordx4 v[144:147], v23, s[24:27], s58 offen offset:0 sc1
    s_add_u32 s86, s86, 1024
    s_and_b32 s86, s86, 16383
    s_add_u32 s58, s86, s66
    buffer_load_dwordx4 v[148:151], v23, s[24:27], s58 offen offset:0 sc1
    s_add_u32 s86, s86, 1024
    s_and_b32 s86, s86, 16383
    s_add_u32 s58, s86, s66
    buffer_load_dwordx4 v[152:155], v23, s[24:27], s58 offen offset:0 sc1
    s_add_u32 s86, s86, 1024
    s_and_b32 s86, s86, 16383
    s_add_u32 s58, s86, s66
    buffer_load_dwordx4 v[156:159], v23, s[24:27], s58 offen offset:0 sc1
    s_add_u32 s86, s86, 1024
    s_and_b32 s86, s86, 16383
    s_add_u32 s58, s86, s66
    buffer_load_dwordx4 v[112:115], v23, s[24:27], s58 offen offset:0 sc1
    s_add_u32 s86, s86, 1024
    s_and_b32 s86, s86, 16383
    s_add_u32 s58, s86, s66
    buffer_load_dwordx4 v[116:119], v23, s[24:27], s58 offen offset:0 sc1
    s_waitcnt vmcnt(18)
    ds_read_b64_tr_b16 a[208:209], v4 offset:32768
    ds_read_b64_tr_b16 a[210:211], v4 offset:33280
    ds_read_b64_tr_b16 a[212:213], v5 offset:32768
    ds_read_b64_tr_b16 a[214:215], v5 offset:33280
    ds_read_b64_tr_b16 a[216:217], v4 offset:33024
    ds_read_b64_tr_b16 a[218:219], v4 offset:33536
    ds_read_b64_tr_b16 a[220:221], v5 offset:33024
    ds_read_b64_tr_b16 a[222:223], v5 offset:33536
    s_waitcnt vmcnt(14)
    ds_read_b64_tr_b16 a[224:225], v2 offset:0
    ds_read_b64_tr_b16 a[226:227], v2 offset:512
    ds_read_b64_tr_b16 a[228:229], v3 offset:0
    ds_read_b64_tr_b16 a[230:231], v3 offset:512
    ds_read_b64_tr_b16 a[232:233], v2 offset:256
    ds_read_b64_tr_b16 a[234:235], v2 offset:768
    ds_read_b64_tr_b16 a[236:237], v3 offset:256
    ds_read_b64_tr_b16 a[238:239], v3 offset:768
    s_waitcnt vmcnt(10)
    ds_read_b64_tr_b16 a[240:241], v2 offset:16384
    ds_read_b64_tr_b16 a[242:243], v2 offset:16896
    ds_read_b64_tr_b16 a[244:245], v3 offset:16384
    ds_read_b64_tr_b16 a[246:247], v3 offset:16896
    ds_read_b64_tr_b16 a[248:249], v2 offset:16640
    ds_read_b64_tr_b16 a[250:251], v2 offset:17152
    ds_read_b64_tr_b16 a[252:253], v3 offset:16640
    ds_read_b64_tr_b16 a[254:255], v3 offset:17152
    s_waitcnt lgkmcnt(0)
    s_branch L_p2_join
L_p3_alt:
    s_xor_b32 s66, s44, 3
    s_lshl2_add_u32 s66, s49, s66
    s_mul_i32 s66, s66, 58624
    s_add_u32 s66, s66, s69
    s_add_u32 s58, s66, s76
    buffer_load_dwordx4 v[152:155], v23, s[24:27], s58 offen offset:0 sc1
    buffer_load_dwordx4 v[156:159], v23, s[24:27], s58 offen offset:1024 sc1
    s_add_u32 s58, s66, s77
    buffer_load_dwordx4 v[112:115], v23, s[24:27], s58 offen offset:0 sc1
    buffer_load_dwordx4 v[116:119], v23, s[24:27], s58 offen offset:1024 sc1
    s_add_u32 s58, s66, s78
    buffer_load_dwordx4 v[120:123], v23, s[24:27], s58 offen offset:0 sc1
    buffer_load_dwordx4 v[124:127], v23, s[24:27], s58 offen offset:1024 sc1
    s_add_u32 s58, s66, s79
    buffer_load_dwordx4 v[128:131], v23, s[24:27], s58 offen offset:0 sc1
    buffer_load_dwordx4 v[132:135], v23, s[24:27], s58 offen offset:1024 sc1
    s_add_u32 s58, s66, s80
    buffer_load_dwordx4 v[136:139], v23, s[24:27], s58 offen offset:0 sc1
    buffer_load_dwordx4 v[140:143], v23, s[24:27], s58 offen offset:1024 sc1
    s_waitcnt vmcnt(18)
    ds_read_b64_tr_b16 a[240:241], v4 offset:0
    ds_read_b64_tr_b16 a[242:243], v4 offset:512
    ds_read_b64_tr_b16 a[244:245], v5 offset:0
    ds_read_b64_tr_b16 a[246:247], v5 offset:512
    ds_read_b64_tr_b16 a[248:249], v4 offset:256
    ds_read_b64_tr_b16 a[250:251], v4 offset:768
    ds_read_b64_tr_b16 a[252:253], v5 offset:256
    ds_read_b64_tr_b16 a[254:255], v5 offset:768
    s_waitcnt vmcnt(10) lgkmcnt(0)
    s_branch L_p3_join
L_help:
    s_sub_u32 s55, s46, 21
    v_lshlrev_b32 v217, 7, v1
    v_lshrrev_b32 v218, 2, v1
    v_lshlrev_b32 v218, 12, v218
    v_lshl_add_u32 v218, v210, 7, v218
    buffer_load_dword v108, v217, s[32:35], 0 offen
    s_mul_i32 s54, s44, 28
    s_add_u32 s54, s54, s55
    s_add_u32 s54, s54, 0
    s_lshl_b32 s54, s54, 16
    s_lshl_b32 s56, s45, 9
    s_add_u32 s54, s54, s56
    buffer_load_dword v108, v218, s[20:23], s54 offen
    s_add_u32 s54, s54, 196608
    buffer_load_dword v108, v218, s[20:23], s54 offen
    s_add_u32 s54, s54, 196608
    buffer_load_dword v108, v218, s[20:23], s54 offen
    s_add_u32 s54, s54, 196608
    buffer_load_dword v108, v218, s[20:23], s54 offen
    s_add_u32 s54, s54, 196608
    buffer_load_dword v108, v218, s[20:23], s54 offen
    s_add_u32 s54, s54, 196608
    buffer_load_dword v108, v218, s[20:23], s54 offen
    s_add_u32 s54, s54, 196608
    s_mul_i32 s56, s55, 20480
    s_sub_u32 s54, s54, s56
    v_min_u32 v218, 45055, v218
    buffer_load_dword v108, v218, s[20:23], s54 offen
    s_add_u32 s54, s54, 196608
    buffer_load_dword v108, v217, s[36:39], 0 offen
    s_waitcnt vmcnt(0) lgkmcnt(0)
    s_lshr_b32 s53, s46, 2
    s_and_b32 s89, s46, 3
    s_bfe_u32 s54, s46, 0x20001
    s_and_b32 s55, s46, 1
    s_add_u32 s55, s55, 4
    s_cmp_lt_u32 s46, 16
    s_cselect_b32 s53, s53, s54
    s_cselect_b32 s89, s89, s55
    s_mul_i32 s49, s53, 2
    s_add_u32 s49, s49, s89
    s_sub_u32 s54, s49, 6
    s_min_u32 s49, s49, s54
    s_lshl2_add_u32 s48, s45, s53
    s_mul_i32 s53, s44, 1835008
    s_lshl_b32 s74, s48, 7
    s_add_u32 s53, s53, s74
    v_lshlrev_b32 v217, 5, v212
    v_xor_b32 v217, v217, v214
    v_lshlrev_b32 v12, 12, v213
    v_add3_u32 v12, v12, v217, s53
    s_mul_i32 s53, s44, 100352
    s_lshl_b32 s54, s49, 7
    s_add_u32 s55, s53, s54
    s_lshl_b32 s56, s44, 5
    v_xor_b32 v217, s56, v214
    v_mul_u32_u24 v13, 896, v213
    v_add3_u32 v13, v13, v217, s55
    v_xor_b32 v14, 32, v13
    s_mul_i32 s73, s48, 57344
    s_add_u32 s71, s73, s54
    s_add_u32 s72, s71, 28672
    v_lshrrev_b32 v217, 1, v1
    v_mul_u32_u24 v15, 896, v217
    v_and_b32 v217, 1, v1
    v_lshl_add_u32 v15, v217, 4, v15
    v_add_u32 v15, s53, v15
    s_lshl_b32 s54, s89, 5
    s_add_u32 s54, s54, 768
    s_add_u32 s68, s89, 24
    s_mul_i32 s68, s68, 58624
    s_mul_i32 s69, s44, 14336
    s_add_u32 s69, s69, 2097152
    s_add_u32 s68, s68, s69
    s_add_u32 s73, s73, s54
    s_mov_b32 s76, 0
    s_add_u32 s77, s76, 2048
    s_cmp_eq_u32 s77, 14336
    s_cselect_b32 s77, 0, s77
    s_add_u32 s78, s77, 2048
    s_cmp_eq_u32 s78, 14336
    s_cselect_b32 s78, 0, s78
    s_add_u32 s79, s78, 2048
    s_cmp_eq_u32 s79, 14336
    s_cselect_b32 s79, 0, s79
    s_add_u32 s80, s79, 2048
    s_cmp_eq_u32 s80, 14336
    s_cselect_b32 s80, 0, s80
    s_add_u32 s81, s80, 2048
    s_cmp_eq_u32 s81, 14336
    s_cselect_b32 s81, 0, s81
    s_add_u32 s82, s81, 2048
    s_cmp_eq_u32 s82, 14336
    s_cselect_b32 s82, 0, s82
    s_cmp_lt_u32 s89, 4
    s_cselect_b32 s75, s54, 2130706432
    s_cselect_b32 s68, s68, 2130706432
    s_cselect_b32 s73, s73, 2130706432
    v_lshl_add_u32 v217, v208, 3, v209
    v_lshlrev_b32 v16, 5, v217
    v_lshl_add_u32 v16, v210, 3, v16
    v_add_u32 v16, s52, v16
    v_and_b32 v217, 7, v1
    v_min_u32 v218, 6, v217
    s_mul_i32 s54, s44, 7
    v_add_u32 v218, s54, v218
    v_mul_u32_u24 v219, 2, v218
    v_add_u32 v219, s89, v219
    v_mul_u32_u24 v220, 43, v219
    v_lshrrev_b32 v220, 8, v220
    v_mul_u32_u24 v220, 6, v220
    v_sub_u32 v219, v219, v220
    v_subrev_u32 v219, s49, v219
    v_bfe_u32 v220, v1, 3, 1
    v_mul_i32_i24 v219, v219, v220
    v_add_u32 v219, s49, v219
    v_lshl_add_u32 v218, v219, 5, v218
    v_lshlrev_b32 v20, 7, v218
    v_add_u32 v20, 12713984, v20
    s_lshr_b32 s53, s48, 1
    s_lshl4_add_u32 s53, s44, s53
    s_lshl_b32 s53, s53, 7
    s_add_u32 s53, s53, 12779520
    v_mov_b32 v21, s53
    s_lshl_b32 s70, s48, 16
    s_add_u32 s70, s70, s52
    s_add_u32 s70, s70, 4194304
    v_lshrrev_b32 v218, 3, v0
    v_mul_u32_u24 v22, 896, v218
    v_lshl_add_u32 v22, v217, 4, v22
    v_lshlrev_b32 v25, 1, v218
    v_lshrrev_b32 v219, 4, v218
    v_lshlrev_b32 v244, 14, v219
    v_lshrrev_b32 v219, 1, v217
    v_lshl_add_u32 v244, v219, 12, v244
    v_and_b32 v219, 15, v218
    v_lshl_add_u32 v244, v219, 8, v244
    v_bfe_u32 v219, v218, 1, 1
    v_lshl_add_u32 v244, v219, 7, v244
    v_and_b32 v219, 7, v218
    v_xor_b32 v219, v219, v217
    v_lshl_add_u32 v244, v219, 4, v244
    v_xor_b32 v245, 128, v244
    v_xor_b32 v246, 4096, v244
    v_xor_b32 v247, 4224, v244
    v_xor_b32 v248, 8192, v244
    v_xor_b32 v249, 8320, v244
    v_xor_b32 v250, 12288, v244
    v_xor_b32 v251, 12416, v244
    v_lshrrev_b32 v218, 2, v0
    v_mul_u32_u24 v26, 896, v218
    v_lshl_add_u32 v26, v210, 3, v26
    v_lshlrev_b32 v27, 1, v218
    v_bfe_u32 v219, v218, 1, 2
    v_xor_b32 v219, v219, v210
    v_lshlrev_b32 v252, 6, v218
    v_lshl_add_u32 v252, v219, 4, v252
    v_add_u32 v252, 65536, v252
    v_bfe_u32 v219, v1, 1, 2
    v_xor_b32 v219, v219, v208
    v_lshlrev_b32 v242, 6, v211
    v_lshl_add_u32 v242, v219, 4, v242
    s_add_u32 s53, s52, 65536
    v_add_u32 v242, s53, v242
    v_xor_b32 v218, v217, v212
    v_lshlrev_b32 v238, 4, v218
    v_xor_b32 v238, s56, v238
    v_bfe_u32 v219, v1, 1, 1
    v_xor_b32 v219, v219, v215
    v_lshl_add_u32 v238, v219, 7, v238
    v_lshl_add_u32 v238, v211, 8, v238
    v_add_u32 v238, s52, v238
    v_xor_b32 v239, 32, v238
    v_xor_b32 v240, 64, v238
    v_xor_b32 v241, 96, v238
    buffer_load_dwordx4 v[216:219], v22, s[4:7], s71 offen
    buffer_load_dwordx4 v[220:223], v22, s[4:7], s72 offen
    buffer_load_dwordx2 v[226:227], v26, s[4:7], s73 offen
    buffer_load_ushort v224, v25, s[36:39], s74 offen
    buffer_load_ushort v225, v25, s[36:39], s74 offen offset:64
    buffer_load_ushort v228, v27, s[36:39], s74 offen
    s_add_u32 m0, s52, 81920
    s_lshl_b32 s57, s76, 7
    buffer_load_dwordx4 v12, s[20:23], s57 offen offset:0 lds
    s_add_u32 s57, s57, 31744
    buffer_load_dwordx4 v12, s[20:23], s57 offen offset:1024 lds
    s_add_u32 s57, s57, 31744
    buffer_load_dwordx4 v12, s[20:23], s57 offen offset:2048 lds
    s_add_u32 s57, s57, 31744
    buffer_load_dwordx4 v12, s[20:23], s57 offen offset:3072 lds
    s_add_u32 m0, s52, 98304
    s_lshl_b32 s57, s76, 7
    s_add_u32 s57, s57, 131072
    buffer_load_dwordx4 v12, s[20:23], s57 offen offset:0 lds
    s_add_u32 s57, s57, 31744
    buffer_load_dwordx4 v12, s[20:23], s57 offen offset:1024 lds
    s_add_u32 s57, s57, 31744
    buffer_load_dwordx4 v12, s[20:23], s57 offen offset:2048 lds
    s_add_u32 s57, s57, 31744
    buffer_load_dwordx4 v12, s[20:23], s57 offen offset:3072 lds
    s_add_u32 m0, s52, 114688
    s_lshl_b32 s57, s77, 7
    buffer_load_dwordx4 v12, s[20:23], s57 offen offset:0 lds
    s_add_u32 s57, s57, 31744
    buffer_load_dwordx4 v12, s[20:23], s57 offen offset:1024 lds
    s_add_u32 s57, s57, 31744
    buffer_load_dwordx4 v12, s[20:23], s57 offen offset:2048 lds
    s_add_u32 s57, s57, 31744
    buffer_load_dwordx4 v12, s[20:23], s57 offen offset:3072 lds
    s_add_u32 m0, s52, 131072
    s_lshl_b32 s57, s77, 7
    s_add_u32 s57, s57, 131072
    buffer_load_dwordx4 v12, s[20:23], s57 offen offset:0 lds
    s_add_u32 s57, s57, 31744
    buffer_load_dwordx4 v12, s[20:23], s57 offen offset:1024 lds
    s_waitcnt vmcnt(10)
    ds_read_b64_tr_b16 a[0:1], v6 offset:32768
    ds_read_b64_tr_b16 a[2:3], v6 offset:34816
    ds_read_b64_tr_b16 a[4:5], v7 offset:32768
    ds_read_b64_tr_b16 a[6:7], v7 offset:34816
    ds_read_b64_tr_b16 a[8:9], v6 offset:33024
    ds_read_b64_tr_b16 a[10:11], v6 offset:35072
    ds_read_b64_tr_b16 a[12:13], v7 offset:33024
    ds_read_b64_tr_b16 a[14:15], v7 offset:35072
    s_add_u32 s57, s57, 31744
    buffer_load_dwordx4 v12, s[20:23], s57 offen offset:2048 lds
    s_add_u32 s57, s57, 31744
    buffer_load_dwordx4 v12, s[20:23], s57 offen offset:3072 lds
    s_add_u32 m0, s52, 147456
    s_lshl_b32 s57, s78, 7
    buffer_load_dwordx4 v12, s[20:23], s57 offen offset:0 lds
    s_add_u32 s57, s57, 31744
    buffer_load_dwordx4 v12, s[20:23], s57 offen offset:1024 lds
    s_waitcnt vmcnt(10)
    ds_read_b64_tr_b16 a[16:17], v6 offset:49152
    ds_read_b64_tr_b16 a[18:19], v6 offset:51200
    ds_read_b64_tr_b16 a[20:21], v7 offset:49152
    ds_read_b64_tr_b16 a[22:23], v7 offset:51200
    s_add_u32 s57, s57, 31744
    buffer_load_dwordx4 v12, s[20:23], s57 offen offset:2048 lds
    ds_read_b64_tr_b16 a[24:25], v6 offset:49408
    ds_read_b64_tr_b16 a[26:27], v6 offset:51456
    ds_read_b64_tr_b16 a[28:29], v7 offset:49408
    ds_read_b64_tr_b16 a[30:31], v7 offset:51456
    s_add_u32 s57, s57, 31744
    buffer_load_dwordx4 v12, s[20:23], s57 offen offset:3072 lds
    s_add_u32 m0, s52, 49152
    s_lshl_b32 s57, s78, 7
    s_add_u32 s57, s57, 131072
    buffer_load_dwordx4 v12, s[20:23], s57 offen offset:0 lds
    s_add_u32 s57, s57, 31744
    buffer_load_dwordx4 v12, s[20:23], s57 offen offset:1024 lds
    s_waitcnt vmcnt(10)
    ds_read_b64_tr_b16 a[32:33], v8 offset:0
    ds_read_b64_tr_b16 a[34:35], v8 offset:2048
    ds_read_b64_tr_b16 a[36:37], v9 offset:0
    ds_read_b64_tr_b16 a[38:39], v9 offset:2048
    s_add_u32 s57, s57, 31744
    buffer_load_dwordx4 v12, s[20:23], s57 offen offset:2048 lds
    ds_read_b64_tr_b16 a[40:41], v8 offset:256
    ds_read_b64_tr_b16 a[42:43], v8 offset:2304
    ds_read_b64_tr_b16 a[44:45], v9 offset:256
    ds_read_b64_tr_b16 a[46:47], v9 offset:2304
    s_add_u32 s57, s57, 31744
    buffer_load_dwordx4 v12, s[20:23], s57 offen offset:3072 lds
    s_waitcnt vmcnt(0) lgkmcnt(0)
    s_branch L_p3join
L_role_a:
    v_lshrrev_b32 v112, 4, v1
    v_bfe_u32 v113, v1, 2, 2
    v_and_b32 v114, 3, v1
    v_and_b32 v115, 15, v1
    v_lshrrev_b32 v116, 5, v1
    s_lshr_b32 s48, s45, 1
    s_and_b32 s53, s45, 1
    s_lshl3_add_u32 s49, s53, s46
    s_sub_u32 s49, s49, 24
    s_lshl_b32 s90, s44, 11
    s_and_b32 s53, s44, 1
    s_lshl_b32 s53, s53, 1
    v_lshlrev_b32 v117, 2, v112
    v_sub_u32 v117, v115, v117
    v_and_b32 v117, 15, v117
    v_xor_b32 v117, s53, v117
    v_mul_u32_u24 v2, 2688, v112
    v_lshl_add_u32 v2, v117, 4, v2
    s_mul_i32 s53, s44, 21504
    s_mul_i32 s54, s48, 224
    s_andn2_b32 s54, s54, 63
    s_add_u32 s53, s53, s54
    v_add_u32 v2, s53, v2
    s_add_u32 m0, s90, 65536
    s_mov_b32 s57, 896
    buffer_load_dwordx4 v2, s[8:11], s57 offen offset:0 lds
    s_mov_b32 s57, 10624
    buffer_load_dwordx4 v2, s[8:11], s57 offen offset:1024 lds
    s_add_u32 m0, s90, 73728
    s_mov_b32 s57, 86912
    buffer_load_dwordx4 v2, s[8:11], s57 offen offset:0 lds
    s_mov_b32 s57, 96640
    buffer_load_dwordx4 v2, s[8:11], s57 offen offset:1024 lds
    v_mul_u32_u24 v109, 960, v25
    v_lshl_add_u32 v109, v26, 4, v109
    v_mul_u32_u24 v110, 960, v113
    v_lshl_add_u32 v110, v112, 5, v110
    v_lshl_add_u32 v110, v114, 3, v110
    s_lshl_b32 s53, s44, 7
    v_add_u32 v110, s53, v110
    v_mul_u32_u24 v111, 66816, v112
    v_lshl_add_u32 v111, v115, 4, v111
    s_mul_i32 s63, s44, 267264
    s_lshl_b32 s53, s2, 8
    s_add_u32 s63, s63, s53
    s_add_u32 s64, s63, 1069056
    s_cmp_eq_u32 s44, 3
    s_cselect_b32 s64, 2130706432, s64
    s_mov_b32 s62, 0x3f803f80
    s_mov_b32 s61, 0xffff0000
    s_mov_b32 s66, 6291456
    v_mov_b32 v96, 0
    v_mov_b32 v97, 0
    v_and_b32 v117, 1, v112
    v_lshlrev_b32 v117, 5, v117
    s_mul_i32 s53, s44, 56
    s_and_b32 s54, s48, 1
    s_lshl_b32 s54, s54, 5
    s_add_u32 s53, s53, s54
    v_lshlrev_b32 v118, 11, v112
    v_lshl_add_u32 v118, v113, 8, v118
    v_add_u32 v118, 65536, v118
    v_lshl_add_u32 v119, v114, 3, s53
    v_add_u32 v119, 0, v119
    v_xor_b32 v119, v119, v117
    v_lshl_add_u32 v119, v113, 6, v119
    v_and_b32 v119, 255, v119
    v_add_u32 v6, v118, v119
    v_add_u32 v10, 49152, v6
    v_subrev_u32 v120, 65536, v6
    v_lshl_add_u32 v119, v114, 3, s53
    v_add_u32 v119, 32, v119
    v_xor_b32 v119, v119, v117
    v_lshl_add_u32 v119, v113, 6, v119
    v_and_b32 v119, 255, v119
    v_add_u32 v7, v118, v119
    v_add_u32 v11, 49152, v7
    v_subrev_u32 v121, 65536, v7
    v_lshl_add_u32 v119, v114, 4, s53
    v_add_u32 v119, 0, v119
    v_xor_b32 v119, v119, v117
    v_lshl_add_u32 v119, v113, 6, v119
    v_and_b32 v119, 255, v119
    v_add_u32 v8, v118, v119
    v_add_u32 v12, 49152, v8
    v_subrev_u32 v122, 65536, v8
    v_lshl_add_u32 v119, v114, 4, s53
    v_add_u32 v119, 8, v119
    v_xor_b32 v119, v119, v117
    v_lshl_add_u32 v119, v113, 6, v119
    v_and_b32 v119, 255, v119
    v_add_u32 v9, v118, v119
    v_add_u32 v13, 49152, v9
    v_subrev_u32 v123, 65536, v9
    s_waitcnt vmcnt(7)
    v_dot2c_f32_bf16 v96, s62, v32
    v_dot2c_f32_bf16 v97, v32, v32
    v_lshlrev_b32 v40, 16, v32
    v_and_b32 v41, s61, v32
    v_dot2c_f32_bf16 v96, s62, v33
    v_dot2c_f32_bf16 v97, v33, v33
    v_lshlrev_b32 v42, 16, v33
    v_and_b32 v43, s61, v33
    v_dot2c_f32_bf16 v96, s62, v34
    v_dot2c_f32_bf16 v97, v34, v34
    v_lshlrev_b32 v44, 16, v34
    v_and_b32 v45, s61, v34
    v_dot2c_f32_bf16 v96, s62, v35
    v_dot2c_f32_bf16 v97, v35, v35
    v_lshlrev_b32 v46, 16, v35
    v_and_b32 v47, s61, v35
    s_waitcnt vmcnt(6)
    v_dot2c_f32_bf16 v96, s62, v36
    v_dot2c_f32_bf16 v97, v36, v36
    v_lshlrev_b32 v48, 16, v36
    v_and_b32 v49, s61, v36
    v_dot2c_f32_bf16 v96, s62, v37
    v_dot2c_f32_bf16 v97, v37, v37
    v_lshlrev_b32 v50, 16, v37
    v_and_b32 v51, s61, v37
    v_dot2c_f32_bf16 v96, s62, v38
    v_dot2c_f32_bf16 v97, v38, v38
    v_lshlrev_b32 v52, 16, v38
    v_and_b32 v53, s61, v38
    v_dot2c_f32_bf16 v96, s62, v39
    v_dot2c_f32_bf16 v97, v39, v39
    v_lshlrev_b32 v54, 16, v39
    v_and_b32 v55, s61, v39
    buffer_load_dword v29, off, s[40:43], 0 sc1
    v_add_f32_dpp v96, v96, v96 quad_perm:[1,0,3,2] row_mask:0xf bank_mask:0xf
    v_add_f32_dpp v97, v97, v97 quad_perm:[1,0,3,2] row_mask:0xf bank_mask:0xf
    s_nop 0
    v_add_f32_dpp v96, v96, v96 quad_perm:[2,3,0,1] row_mask:0xf bank_mask:0xf
    v_add_f32_dpp v97, v97, v97 quad_perm:[2,3,0,1] row_mask:0xf bank_mask:0xf
    s_nop 0
    v_add_f32_dpp v96, v96, v96 row_half_mirror row_mask:0xf bank_mask:0xf
    v_add_f32_dpp v97, v97, v97 row_half_mirror row_mask:0xf bank_mask:0xf
    s_nop 0
    v_add_f32_dpp v96, v96, v96 row_mirror row_mask:0xf bank_mask:0xf
    v_add_f32_dpp v97, v97, v97 row_mirror row_mask:0xf bank_mask:0xf
    v_mov_b32 v98, v96
    v_mov_b32 v99, v97
    s_nop 0
    v_permlane16_swap_b32 v96, v98
    v_permlane16_swap_b32 v97, v99
    v_add_f32 v96, v96, v98
    v_add_f32 v97, v97, v99
    v_mul_f32 v98, 0x3b124925, v96
    v_mul_f32 v99, 0x3b124925, v97
    v_fma_f32 v99, -v98, v98, v99
    v_max_f32 v99, 0, v99
    v_cvt_pk_bf16_f32 v100, 0, v99
    v_add_f32 v100, 0x3727c5ac, v100
    v_cvt_pk_bf16_f32 v100, 0, v100
    v_sqrt_f32 v100, v100
    s_nop 0
    v_cvt_pk_bf16_f32 v100, 0, v100
    v_rcp_f32 v100, v100
    s_nop 0
    v_mul_f32 v99, v99, v100
    v_mul_f32 v102, v98, v100
    v_mul_f32 v99, v99, v100
    v_cvt_pk_bf16_f32 v104, 0, v99
    v_add_f32 v104, 0x3727c5ac, v104
    v_cvt_pk_bf16_f32 v104, 0, v104
    v_sqrt_f32 v104, v104
    s_nop 0
    v_cvt_pk_bf16_f32 v104, 0, v104
    v_rcp_f32 v104, v104
    s_nop 0
    v_mul_f32 v104, v104, v100
    v_mul_f32 v106, v98, v104
    v_pk_fma_f32 v[56:57], v[40:41], v[104:105], v[106:107] op_sel_hi:[1,0,0] neg_lo:[0,0,1] neg_hi:[0,0,1]
    v_pk_fma_f32 v[58:59], v[42:43], v[104:105], v[106:107] op_sel_hi:[1,0,0] neg_lo:[0,0,1] neg_hi:[0,0,1]
    v_pk_fma_f32 v[60:61], v[44:45], v[104:105], v[106:107] op_sel_hi:[1,0,0] neg_lo:[0,0,1] neg_hi:[0,0,1]
    v_pk_fma_f32 v[62:63], v[46:47], v[104:105], v[106:107] op_sel_hi:[1,0,0] neg_lo:[0,0,1] neg_hi:[0,0,1]
    v_pk_fma_f32 v[64:65], v[48:49], v[104:105], v[106:107] op_sel_hi:[1,0,0] neg_lo:[0,0,1] neg_hi:[0,0,1]
    v_pk_fma_f32 v[66:67], v[50:51], v[104:105], v[106:107] op_sel_hi:[1,0,0] neg_lo:[0,0,1] neg_hi:[0,0,1]
    v_pk_fma_f32 v[68:69], v[52:53], v[104:105], v[106:107] op_sel_hi:[1,0,0] neg_lo:[0,0,1] neg_hi:[0,0,1]
    v_pk_fma_f32 v[70:71], v[54:55], v[104:105], v[106:107] op_sel_hi:[1,0,0] neg_lo:[0,0,1] neg_hi:[0,0,1]
    v_cvt_pk_bf16_f32 v80, v56, v57
    v_cvt_pk_bf16_f32 v81, v58, v59
    v_cvt_pk_bf16_f32 v82, v60, v61
    v_cvt_pk_bf16_f32 v83, v62, v63
    v_cvt_pk_bf16_f32 v84, v64, v65
    v_cvt_pk_bf16_f32 v85, v66, v67
    v_cvt_pk_bf16_f32 v86, v68, v69
    v_cvt_pk_bf16_f32 v87, v70, v71
    ds_write_b128 v109, v[80:83] offset:49152
    ds_write_b128 v109, v[84:87] offset:49600
    v_pk_fma_f32 v[40:41], v[40:41], v[100:101], v[102:103] op_sel_hi:[1,0,0] neg_lo:[0,0,1] neg_hi:[0,0,1]
    v_pk_fma_f32 v[42:43], v[42:43], v[100:101], v[102:103] op_sel_hi:[1,0,0] neg_lo:[0,0,1] neg_hi:[0,0,1]
    v_pk_fma_f32 v[44:45], v[44:45], v[100:101], v[102:103] op_sel_hi:[1,0,0] neg_lo:[0,0,1] neg_hi:[0,0,1]
    v_pk_fma_f32 v[46:47], v[46:47], v[100:101], v[102:103] op_sel_hi:[1,0,0] neg_lo:[0,0,1] neg_hi:[0,0,1]
    v_pk_fma_f32 v[48:49], v[48:49], v[100:101], v[102:103] op_sel_hi:[1,0,0] neg_lo:[0,0,1] neg_hi:[0,0,1]
    v_pk_fma_f32 v[50:51], v[50:51], v[100:101], v[102:103] op_sel_hi:[1,0,0] neg_lo:[0,0,1] neg_hi:[0,0,1]
    v_pk_fma_f32 v[52:53], v[52:53], v[100:101], v[102:103] op_sel_hi:[1,0,0] neg_lo:[0,0,1] neg_hi:[0,0,1]
    v_pk_fma_f32 v[54:55], v[54:55], v[100:101], v[102:103] op_sel_hi:[1,0,0] neg_lo:[0,0,1] neg_hi:[0,0,1]
    v_cvt_pk_bf16_f32 v72, v40, v41
    v_cvt_pk_bf16_f32 v73, v42, v43
    v_cvt_pk_bf16_f32 v74, v44, v45
    v_cvt_pk_bf16_f32 v75, v46, v47
    v_cvt_pk_bf16_f32 v76, v48, v49
    v_cvt_pk_bf16_f32 v77, v50, v51
    v_cvt_pk_bf16_f32 v78, v52, v53
    v_cvt_pk_bf16_f32 v79, v54, v55
    s_waitcnt lgkmcnt(0)
    s_barrier
    ds_read_b64_tr_b16 v[88:89], v110 offset:49152
    ds_read_b64_tr_b16 v[90:91], v110 offset:52992
    ds_read_b64_tr_b16 v[92:93], v110 offset:49664
    ds_read_b64_tr_b16 v[94:95], v110 offset:53504
    buffer_store_dwordx4 v[72:75], v24, s[24:27], s66 offen offset:0 sc1
    buffer_store_dwordx4 v[76:79], v24, s[24:27], s66 offen offset:448 sc1
    s_waitcnt lgkmcnt(2)
    buffer_store_dwordx4 v[88:91], v111, s[24:27], s63 offen sc1
    s_waitcnt lgkmcnt(0)
    buffer_store_dwordx4 v[92:95], v111, s[24:27], s64 offen sc1
    s_add_u32 m0, s90, 81920
    s_mov_b32 s57, 172928
    buffer_load_dwordx4 v2, s[8:11], s57 offen offset:0 lds
    v_lshrrev_b32 v119, 3, v1
    v_mul_u32_u24 v3, 896, v119
    v_xor_b32 v118, v119, v1
    v_and_b32 v118, 6, v118
    v_and_or_b32 v118, v1, 1, v118
    v_lshl_add_u32 v3, v118, 4, v3
    v_and_b32 v118, 6, v1
    v_xor_b32 v118, v118, v112
    s_mov_b32 s57, 182656
    buffer_load_dwordx4 v2, s[8:11], s57 offen offset:1024 lds
    v_lshlrev_b32 v4, 7, v115
    v_lshl_add_u32 v4, v118, 4, v4
    v_xor_b32 v25, 64, v4
    s_lshl_b32 s53, s49, 4
    s_sub_u32 s53, s53, 2
    v_min_u32 v117, 17, v1
    v_add_u32 v117, s53, v117
    v_max_i32 v117, 0, v117
    v_lshlrev_b32 v19, 5, v117
    v_add_u32 v19, 12582912, v19
    v_and_b32 v117, 1, v115
    v_cmp_eq_u32 s[76:77], 1, v117
    v_lshl_add_u32 v117, v112, 2, v117
    v_cmp_le_u32 s[78:79], v117, v115
    v_add_u32 v117, 2, v117
    v_cmp_le_u32 s[80:81], v117, v115
    s_add_u32 m0, s90, 90112
    s_mov_b32 s57, 258944
    buffer_load_dwordx4 v2, s[8:11], s57 offen offset:0 lds
    v_cmp_eq_u32 s[82:83], 3, v112
    v_mov_b32 v117, 0xffff
    v_mov_b32 v118, 0xffff0000
    v_cndmask_b32 v117, v117, v118, s[76:77]
    v_cndmask_b32 v14, v117, 0, s[78:79]
    v_cndmask_b32 v15, v117, 0, s[80:81]
    v_cndmask_b32 v16, 0, v117, s[78:79]
    v_cndmask_b32 v17, 0, v117, s[80:81]
    s_mov_b32 s91, 0x3e8b97f6
    v_mov_b32 v18, 0xf149f2ca
    s_lshl_b32 s53, s49, 3
    s_mul_i32 s72, s53, 14336
    s_add_u32 s72, s72, 6291456
    s_lshl_b32 s74, s53, 14
    s_lshl2_add_u32 s54, s48, s44
    s_lshl_b32 s54, s54, 10
    s_mov_b32 s57, 268672
    buffer_load_dwordx4 v2, s[8:11], s57 offen offset:1024 lds
    s_add_u32 s74, s74, s54
    s_add_u32 s74, s74, 4194304
    s_lshl2_add_u32 s53, s44, 0
    s_lshl_b32 s54, s44, 8
    s_add_u32 s54, s54, 0
    s_cmp_lt_u32 s53, 14
    s_cselect_b32 s68, s54, 2130706432
    s_lshl2_add_u32 s53, s44, 1
    s_lshl_b32 s54, s44, 8
    s_add_u32 s54, s54, 6144
    s_cmp_lt_u32 s53, 14
    s_cselect_b32 s69, s54, 2130706432
    s_lshl2_add_u32 s53, s44, 2
    s_lshl_b32 s54, s44, 8
    s_add_u32 s54, s54, -1920
    s_cmp_lt_u32 s53, 14
    s_cselect_b32 s70, s54, 2130706432
    s_lshl2_add_u32 s53, s44, 3
    s_lshl_b32 s54, s44, 8
    s_add_u32 s54, s54, 4224
    s_cmp_lt_u32 s53, 14
    s_cselect_b32 s71, s54, 2130706432
    s_cmp_eq_u32 s49, 0
    s_cselect_b64 s[84:85], -1, 0
    s_andn2_b64 s[86:87], s[84:85], s[80:81]
    s_andn2_b64 s[84:85], s[84:85], s[78:79]
    s_and_b32 s53, s46, 7
    s_mul_i32 s54, s44, 28
    s_add_u32 s54, s54, s53
    s_add_u32 s54, s54, 20
    s_lshl_b32 s73, s54, 16
    s_lshl_b32 s54, s45, 9
    s_add_u32 s73, s73, s54
    s_lshl3_add_u32 s75, s44, s53
    s_lshl_b32 s75, s75, 13
    v_lshrrev_b32 v5, 2, v1
    v_lshlrev_b32 v5, 12, v5
    v_lshl_add_u32 v5, v114, 7, v5
    v_lshlrev_b32 v20, 7, v1
    s_add_u32 m0, s90, 98304
    s_mov_b32 s57, 344960
    buffer_load_dwordx4 v2, s[8:11], s57 offen offset:0 lds
    s_mov_b32 s57, 354688
    buffer_load_dwordx4 v2, s[8:11], s57 offen offset:1024 lds
    s_add_u32 m0, s90, 106496
    s_mov_b32 s57, 430976
    buffer_load_dwordx4 v2, s[8:11], s57 offen offset:0 lds
    s_mov_b32 s57, 440704
    buffer_load_dwordx4 v2, s[8:11], s57 offen offset:1024 lds
    s_add_u32 m0, s90, 114688
    s_mov_b32 s57, 516992
    buffer_load_dwordx4 v2, s[8:11], s57 offen offset:0 lds
    s_mov_b32 s57, 526720
    buffer_load_dwordx4 v2, s[8:11], s57 offen offset:1024 lds
    s_add_u32 m0, s90, 122880
    s_mov_b32 s57, 603008
    buffer_load_dwordx4 v2, s[8:11], s57 offen offset:0 lds
    s_mov_b32 s57, 612736
    buffer_load_dwordx4 v2, s[8:11], s57 offen offset:1024 lds
    s_add_u32 m0, s90, 131072
    s_mov_b32 s57, 689024
    buffer_load_dwordx4 v2, s[8:11], s57 offen offset:0 lds
    s_mov_b32 s57, 698752
    buffer_load_dwordx4 v2, s[8:11], s57 offen offset:1024 lds
    s_add_u32 m0, s90, 139264
    s_mov_b32 s57, 775040
    buffer_load_dwordx4 v2, s[8:11], s57 offen offset:0 lds
    s_mov_b32 s57, 784768
    buffer_load_dwordx4 v2, s[8:11], s57 offen offset:1024 lds
    s_add_u32 m0, s90, 147456
    s_mov_b32 s57, 861056
    buffer_load_dwordx4 v2, s[8:11], s57 offen offset:0 lds
    s_mov_b32 s57, 870784
    buffer_load_dwordx4 v2, s[8:11], s57 offen offset:1024 lds
    s_add_u32 m0, s90, 155648
    s_mov_b32 s57, 947072
    buffer_load_dwordx4 v2, s[8:11], s57 offen offset:0 lds
    s_mov_b32 s57, 956800
    buffer_load_dwordx4 v2, s[8:11], s57 offen offset:1024 lds
    s_waitcnt vmcnt(20)
    v_cmp_eq_u32 vcc, 0, v29
    s_nop 0
    s_cbranch_vccz L_ok12
    s_mov_b32 s59, 20000
L_spin11:
    s_sleep 2
    buffer_load_dword v29, off, s[40:43], 0 sc1
    s_waitcnt vmcnt(0)
    v_cmp_eq_u32 vcc, 0, v29
    s_nop 0
    s_cbranch_vccz L_ok12
    s_sub_u32 s59, s59, 1
    s_cbranch_scc0 L_spin11
L_ok12:
    v_readfirstlane_b32 s47, v29
    s_barrier
    s_cmp_lg_u32 s44, 0
    s_cbranch_scc1 L_nopub13
    s_lshl_b32 s60, s2, 5
    s_add_u32 s60, s60, 12582912
    v_mov_b32 v30, s47
    s_mov_b64 exec, 1
    buffer_store_dword v30, off, s[24:27], s60 sc1
    s_mov_b64 exec, -1
L_nopub13:
    s_waitcnt vmcnt(18)
    s_barrier
    s_add_u32 m0, s90, 0
    s_mov_b32 s57, 1033088
    buffer_load_dwordx4 v2, s[8:11], s57 offen offset:0 lds
    s_mov_b32 s57, 1042816
    buffer_load_dwordx4 v2, s[8:11], s57 offen offset:1024 lds
    ds_read_b64_tr_b16 a[8:9], v6 offset:0
    ds_read_b64_tr_b16 a[10:11], v6 offset:1024
    ds_read_b64_tr_b16 a[12:13], v7 offset:0
    ds_read_b64_tr_b16 a[14:15], v7 offset:1024
    s_add_u32 m0, s90, 8192
    s_mov_b32 s57, 1119104
    buffer_load_dwordx4 v2, s[8:11], s57 offen offset:0 lds
    s_mov_b32 s57, 1128832
    buffer_load_dwordx4 v2, s[8:11], s57 offen offset:1024 lds
    ds_read_b64_tr_b16 a[32:33], v6 offset:8192
    ds_read_b64_tr_b16 a[34:35], v6 offset:9216
    ds_read_b64_tr_b16 a[36:37], v7 offset:8192
    ds_read_b64_tr_b16 a[38:39], v7 offset:9216
    s_add_u32 m0, s90, 16384
    s_mov_b32 s57, 1792
    buffer_load_dwordx4 v2, s[8:11], s57 offen offset:0 lds
    s_mov_b32 s57, 11520
    buffer_load_dwordx4 v2, s[8:11], s57 offen offset:1024 lds
    ds_read_b64_tr_b16 a[56:57], v6 offset:16384
    ds_read_b64_tr_b16 a[58:59], v6 offset:17408
    ds_read_b64_tr_b16 a[60:61], v7 offset:16384
    ds_read_b64_tr_b16 a[62:63], v7 offset:17408
    s_waitcnt vmcnt(18)
    s_waitcnt lgkmcnt(0)
    s_barrier
    s_add_u32 m0, s90, 24576
    s_mov_b32 s57, 87808
    buffer_load_dwordx4 v2, s[8:11], s57 offen offset:0 lds
    s_mov_b32 s57, 97536
    buffer_load_dwordx4 v2, s[8:11], s57 offen offset:1024 lds
    ds_read_b64_tr_b16 a[80:81], v6 offset:24576
    ds_read_b64_tr_b16 a[82:83], v6 offset:25600
    ds_read_b64_tr_b16 a[84:85], v7 offset:24576
    ds_read_b64_tr_b16 a[86:87], v7 offset:25600
    s_add_u32 m0, s90, 32768
    s_mov_b32 s57, 173824
    buffer_load_dwordx4 v2, s[8:11], s57 offen offset:0 lds
    s_mov_b32 s57, 183552
    buffer_load_dwordx4 v2, s[8:11], s57 offen offset:1024 lds
    ds_read_b64_tr_b16 a[104:105], v6 offset:32768
    ds_read_b64_tr_b16 a[106:107], v6 offset:33792
    ds_read_b64_tr_b16 a[108:109], v7 offset:32768
    ds_read_b64_tr_b16 a[110:111], v7 offset:33792
    s_add_u32 m0, s90, 40960
    s_mov_b32 s57, 259840
    buffer_load_dwordx4 v2, s[8:11], s57 offen offset:0 lds
    s_mov_b32 s57, 269568
    buffer_load_dwordx4 v2, s[8:11], s57 offen offset:1024 lds
    ds_read_b64_tr_b16 a[128:129], v6 offset:40960
    ds_read_b64_tr_b16 a[130:131], v6 offset:41984
    ds_read_b64_tr_b16 a[132:133], v7 offset:40960
    ds_read_b64_tr_b16 a[134:135], v7 offset:41984
    s_waitcnt vmcnt(18)
    s_waitcnt lgkmcnt(0)
    s_barrier
    s_add_u32 m0, s90, 65536
    s_mov_b32 s57, 345856
    buffer_load_dwordx4 v2, s[8:11], s57 offen offset:0 lds
    s_mov_b32 s57, 355584
    buffer_load_dwordx4 v2, s[8:11], s57 offen offset:1024 lds
    ds_read_b64_tr_b16 a[152:153], v10 offset:0
    ds_read_b64_tr_b16 a[154:155], v10 offset:1024
    ds_read_b64_tr_b16 a[156:157], v11 offset:0
    ds_read_b64_tr_b16 a[158:159], v11 offset:1024
    s_add_u32 m0, s90, 73728
    s_mov_b32 s57, 431872
    buffer_load_dwordx4 v2, s[8:11], s57 offen offset:0 lds
    s_mov_b32 s57, 441600
    buffer_load_dwordx4 v2, s[8:11], s57 offen offset:1024 lds
    ds_read_b64_tr_b16 a[176:177], v10 offset:8192
    ds_read_b64_tr_b16 a[178:179], v10 offset:9216
    ds_read_b64_tr_b16 a[180:181], v11 offset:8192
    ds_read_b64_tr_b16 a[182:183], v11 offset:9216
    s_add_u32 m0, s90, 81920
    s_mov_b32 s57, 517888
    buffer_load_dwordx4 v2, s[8:11], s57 offen offset:0 lds
    s_mov_b32 s57, 527616
    buffer_load_dwordx4 v2, s[8:11], s57 offen offset:1024 lds
    ds_read_b64_tr_b16 a[200:201], v10 offset:16384
    ds_read_b64_tr_b16 a[202:203], v10 offset:17408
    ds_read_b64_tr_b16 a[204:205], v11 offset:16384
    ds_read_b64_tr_b16 a[206:207], v11 offset:17408
    s_waitcnt vmcnt(18)
    s_waitcnt lgkmcnt(0)
    s_barrier
    ds_read_b64_tr_b16 a[224:225], v10 offset:24576
    ds_read_b64_tr_b16 a[226:227], v10 offset:25600
    ds_read_b64_tr_b16 a[228:229], v11 offset:24576
    ds_read_b64_tr_b16 a[230:231], v11 offset:25600
    ds_read_b64_tr_b16 a[248:249], v10 offset:32768
    ds_read_b64_tr_b16 a[250:251], v10 offset:33792
    ds_read_b64_tr_b16 a[252:253], v11 offset:32768
    ds_read_b64_tr_b16 a[254:255], v11 offset:33792
    buffer_load_dword v21, v19, s[24:27], 0 offen sc1
    ds_read_b64_tr_b16 v[192:193], v10 offset:40960
    ds_read_b64_tr_b16 v[194:195], v10 offset:41984
    ds_read_b64_tr_b16 v[196:197], v11 offset:40960
    ds_read_b64_tr_b16 v[198:199], v11 offset:41984
    s_add_u32 m0, s90, 90112
    s_mov_b32 s57, 603904
    buffer_load_dwordx4 v2, s[8:11], s57 offen offset:0 lds
    s_waitcnt vmcnt(14)
    s_waitcnt lgkmcnt(0)
    s_barrier
    ds_read_b64_tr_b16 v[216:217], v120 offset:0
    ds_read_b64_tr_b16 v[218:219], v120 offset:1024
    ds_read_b64_tr_b16 v[220:221], v121 offset:0
    ds_read_b64_tr_b16 v[222:223], v121 offset:1024
    ds_read_b64_tr_b16 v[240:241], v120 offset:8192
    ds_read_b64_tr_b16 v[242:243], v120 offset:9216
    ds_read_b64_tr_b16 v[244:245], v121 offset:8192
    ds_read_b64_tr_b16 v[246:247], v121 offset:9216
    ds_read_b64_tr_b16 a[16:17], v122 offset:16384
    ds_read_b64_tr_b16 a[18:19], v122 offset:17408
    ds_read_b64_tr_b16 a[20:21], v123 offset:16384
    ds_read_b64_tr_b16 a[22:23], v123 offset:17408
    s_mov_b32 s57, 613632
    buffer_load_dwordx4 v2, s[8:11], s57 offen offset:1024 lds
    s_add_u32 m0, s90, 98304
    s_mov_b32 s57, 689920
    buffer_load_dwordx4 v2, s[8:11], s57 offen offset:0 lds
    s_mov_b32 s57, 699648
    buffer_load_dwordx4 v2, s[8:11], s57 offen offset:1024 lds
    s_add_u32 m0, s90, 106496
    s_mov_b32 s57, 775936
    buffer_load_dwordx4 v2, s[8:11], s57 offen offset:0 lds
    s_waitcnt vmcnt(12)
    s_waitcnt lgkmcnt(0)
    s_barrier
    ds_read_b64_tr_b16 a[40:41], v122 offset:24576
    ds_read_b64_tr_b16 a[42:43], v122 offset:25600
    ds_read_b64_tr_b16 a[44:45], v123 offset:24576
    ds_read_b64_tr_b16 a[46:47], v123 offset:25600
    ds_read_b64_tr_b16 a[64:65], v122 offset:32768
    ds_read_b64_tr_b16 a[66:67], v122 offset:33792
    ds_read_b64_tr_b16 a[68:69], v123 offset:32768
    ds_read_b64_tr_b16 a[70:71], v123 offset:33792
    ds_read_b64_tr_b16 a[88:89], v122 offset:40960
    ds_read_b64_tr_b16 a[90:91], v122 offset:41984
    ds_read_b64_tr_b16 a[92:93], v123 offset:40960
    ds_read_b64_tr_b16 a[94:95], v123 offset:41984
    s_mov_b32 s57, 785664
    buffer_load_dwordx4 v2, s[8:11], s57 offen offset:1024 lds
    s_waitcnt vmcnt(7)
    s_waitcnt lgkmcnt(0)
    s_barrier
    ds_read_b64_tr_b16 a[112:113], v8 offset:0
    ds_read_b64_tr_b16 a[114:115], v8 offset:1024
    ds_read_b64_tr_b16 a[116:117], v9 offset:0
    ds_read_b64_tr_b16 a[118:119], v9 offset:1024
    ds_read_b64_tr_b16 a[136:137], v8 offset:8192
    ds_read_b64_tr_b16 a[138:139], v8 offset:9216
    ds_read_b64_tr_b16 a[140:141], v9 offset:8192
    ds_read_b64_tr_b16 a[142:143], v9 offset:9216
    ds_read_b64_tr_b16 a[160:161], v8 offset:16384
    ds_read_b64_tr_b16 a[162:163], v8 offset:17408
    ds_read_b64_tr_b16 a[164:165], v9 offset:16384
    ds_read_b64_tr_b16 a[166:167], v9 offset:17408
    s_waitcnt vmcnt(6)
    v_cmp_ne_u32 vcc, s47, v21
    s_nop 0
    s_cbranch_vccz L_ok15
    s_mov_b32 s59, 20000
L_spin14:
    s_sleep 2
    buffer_load_dword v21, v19, s[24:27], 0 offen sc1
    s_waitcnt vmcnt(0)
    v_cmp_ne_u32 vcc, s47, v21
    s_nop 0
    s_cbranch_vccz L_ok15
    s_sub_u32 s59, s59, 1
    s_cbranch_scc0 L_spin14
L_ok15:
    s_add_u32 m0, s52, 0
    s_sub_u32 s58, s72, 14336
    s_max_u32 s58, s58, 6291456
    s_add_u32 s57, s58, s68
    buffer_load_dwordx4 v3, s[24:27], s57 offen offset:0 sc1 lds
    s_add_u32 s57, s58, s69
    buffer_load_dwordx4 v3, s[24:27], s57 offen offset:1024 sc1 lds
    s_add_u32 s57, s58, s70
    buffer_load_dwordx4 v3, s[24:27], s57 offen offset:2048 sc1 lds
    s_add_u32 s57, s58, s71
    buffer_load_dwordx4 v3, s[24:27], s57 offen offset:3072 sc1 lds
    s_add_u32 m0, s52, 16384
    s_add_u32 s58, s72, 0
    s_add_u32 s57, s58, s68
    buffer_load_dwordx4 v3, s[24:27], s57 offen offset:0 sc1 lds
    s_add_u32 s57, s58, s69
    buffer_load_dwordx4 v3, s[24:27], s57 offen offset:1024 sc1 lds
    s_add_u32 s57, s58, s70
    buffer_load_dwordx4 v3, s[24:27], s57 offen offset:2048 sc1 lds
    s_add_u32 s57, s58, s71
    buffer_load_dwordx4 v3, s[24:27], s57 offen offset:3072 sc1 lds
    s_add_u32 m0, s90, 114688
    s_mov_b32 s57, 861952
    buffer_load_dwordx4 v2, s[8:11], s57 offen offset:0 lds
    s_mov_b32 s57, 871680
    buffer_load_dwordx4 v2, s[8:11], s57 offen offset:1024 lds
    s_add_u32 m0, s90, 122880
    s_mov_b32 s57, 947968
    buffer_load_dwordx4 v2, s[8:11], s57 offen offset:0 lds
    s_mov_b32 s57, 957696
    buffer_load_dwordx4 v2, s[8:11], s57 offen offset:1024 lds
    s_add_u32 m0, s90, 131072
    s_mov_b32 s57, 1033984
    buffer_load_dwordx4 v2, s[8:11], s57 offen offset:0 lds
    s_mov_b32 s57, 1043712
    buffer_load_dwordx4 v2, s[8:11], s57 offen offset:1024 lds
    s_add_u32 m0, s52, 32768
    s_add_u32 s58, s72, 14336
    s_add_u32 s57, s58, s68
    buffer_load_dwordx4 v3, s[24:27], s57 offen offset:0 sc1 lds
    s_add_u32 s57, s58, s69
    buffer_load_dwordx4 v3, s[24:27], s57 offen offset:1024 sc1 lds
    s_waitcnt vmcnt(12)
    s_waitcnt lgkmcnt(0)
    s_barrier
    ds_read_b128 v[120:123], v4 offset:0
    ds_read_b128 v[124:127], v25 offset:0
    ds_read_b128 v[128:131], v4 offset:2048
    ds_read_b128 v[132:135], v25 offset:2048
    ds_read_b128 v[136:139], v4 offset:4096
    ds_read_b128 v[140:143], v25 offset:4096
    ds_read_b128 v[144:147], v4 offset:6144
    ds_read_b128 v[148:151], v25 offset:6144
    ds_read_b128 v[152:155], v4 offset:8192
    ds_read_b128 v[156:159], v25 offset:8192
    ds_read_b128 v[160:163], v4 offset:10240
    ds_read_b128 v[164:167], v25 offset:10240
    ds_read_b128 v[168:171], v4 offset:12288
    ds_read_b128 v[172:175], v25 offset:12288
    s_waitcnt lgkmcnt(11)
    v_mfma_f32_16x16x32_bf16 v[96:99], a[8:11], v[120:123], 0
    s_add_u32 s57, s58, s70
    ds_read_b64_tr_b16 a[184:185], v8 offset:24576
    v_mfma_f32_16x16x32_bf16 v[96:99], a[32:35], v[124:127], v[96:99]
    buffer_load_dwordx4 v3, s[24:27], s57 offen offset:2048 sc1 lds
    v_mfma_f32_16x16x32_bf16 v[96:99], a[56:59], v[128:131], v[96:99]
    ds_read_b64_tr_b16 a[186:187], v8 offset:25600
    ds_read_b64_tr_b16 a[188:189], v9 offset:24576
    s_waitcnt lgkmcnt(11)
    v_mfma_f32_16x16x32_bf16 v[96:99], a[80:83], v[132:135], v[96:99]
    ds_read_b64_tr_b16 a[190:191], v9 offset:25600
    ds_read_b64_tr_b16 a[208:209], v8 offset:32768
    v_mfma_f32_16x16x32_bf16 v[96:99], a[104:107], v[136:139], v[96:99]
    s_add_u32 s57, s58, s71
    ds_read_b64_tr_b16 a[210:211], v8 offset:33792
    v_mfma_f32_16x16x32_bf16 v[96:99], a[128:131], v[140:143], v[96:99]
    buffer_load_dwordx4 v3, s[24:27], s57 offen offset:3072 sc1 lds
    s_waitcnt lgkmcnt(11)
    v_mfma_f32_16x16x32_bf16 v[96:99], a[152:155], v[144:147], v[96:99]
    ds_read_b64_tr_b16 a[212:213], v9 offset:32768
    ds_read_b64_tr_b16 a[214:215], v9 offset:33792
    v_mfma_f32_16x16x32_bf16 v[96:99], a[176:179], v[148:151], v[96:99]
    ds_read_b64_tr_b16 a[232:233], v8 offset:40960
    ds_read_b64_tr_b16 a[234:235], v8 offset:41984
    v_mfma_f32_16x16x32_bf16 v[96:99], a[200:203], v[152:155], v[96:99]
    s_add_u32 m0, s90, 139264
    s_mov_b32 s57, 1120000
    ds_read_b64_tr_b16 a[236:237], v9 offset:40960
    s_waitcnt lgkmcnt(13)
    v_mfma_f32_16x16x32_bf16 v[96:99], a[224:227], v[156:159], v[96:99]
    buffer_load_dwordx4 v2, s[8:11], s57 offen offset:0 lds
    v_mfma_f32_16x16x32_bf16 v[96:99], a[248:251], v[160:163], v[96:99]
    ds_read_b64_tr_b16 a[238:239], v9 offset:41984
    v_mfma_f32_16x16x32_bf16 v[96:99], v[192:195], v[164:167], v[96:99]
    s_waitcnt lgkmcnt(12)
    v_mfma_f32_16x16x32_bf16 v[96:99], v[216:219], v[168:171], v[96:99]
    s_mov_b32 s57, 1129728
    v_mfma_f32_16x16x32_bf16 v[96:99], v[240:243], v[172:175], v[96:99]
    buffer_load_dwordx4 v2, s[8:11], s57 offen offset:1024 lds
    s_waitcnt vmcnt(12)
    s_barrier
    v_mfma_f32_16x16x32_bf16 v[100:103], a[12:15], v[120:123], 0
    ds_read_b128 v[120:123], v4 offset:16384
    v_mfma_f32_16x16x32_bf16 v[100:103], a[36:39], v[124:127], v[100:103]
    ds_read_b128 v[124:127], v25 offset:16384
    v_mfma_f32_16x16x32_bf16 v[100:103], a[60:63], v[128:131], v[100:103]
    ds_read_b128 v[128:131], v4 offset:18432
    s_add_u32 m0, s90, 147456
    s_mov_b32 s57, 0
    v_mfma_f32_16x16x32_bf16 v[100:103], a[84:87], v[132:135], v[100:103]
    ds_read_b128 v[132:135], v25 offset:18432
    buffer_load_dwordx4 v2, s[8:11], s57 offen offset:0 lds
    v_mfma_f32_16x16x32_bf16 v[100:103], a[108:111], v[136:139], v[100:103]
    ds_read_b128 v[136:139], v4 offset:20480
    v_mfma_f32_16x16x32_bf16 v[100:103], a[132:135], v[140:143], v[100:103]
    ds_read_b128 v[140:143], v25 offset:20480
    v_mfma_f32_16x16x32_bf16 v[100:103], a[156:159], v[144:147], v[100:103]
    ds_read_b128 v[144:147], v4 offset:22528
    s_mov_b32 s57, 9728
    v_mfma_f32_16x16x32_bf16 v[100:103], a[180:183], v[148:151], v[100:103]
    ds_read_b128 v[148:151], v25 offset:22528
    buffer_load_dwordx4 v2, s[8:11], s57 offen offset:1024 lds
    v_mfma_f32_16x16x32_bf16 v[100:103], a[204:207], v[152:155], v[100:103]
    ds_read_b128 v[152:155], v4 offset:24576
    v_cvt_pk_bf16_f32 v52, v96, v97
    v_mfma_f32_16x16x32_bf16 v[100:103], a[228:231], v[156:159], v[100:103]
    ds_read_b128 v[156:159], v25 offset:24576
    v_cvt_pk_bf16_f32 v53, v98, v99
    v_mfma_f32_16x16x32_bf16 v[100:103], a[252:255], v[160:163], v[100:103]
    ds_read_b128 v[160:163], v4 offset:26624
    s_add_u32 m0, s90, 155648
    s_mov_b32 s57, 86016
    v_mfma_f32_16x16x32_bf16 v[100:103], v[196:199], v[164:167], v[100:103]
    ds_read_b128 v[164:167], v25 offset:26624
    buffer_load_dwordx4 v2, s[8:11], s57 offen offset:0 lds
    v_mfma_f32_16x16x32_bf16 v[100:103], v[220:223], v[168:171], v[100:103]
    ds_read_b128 v[168:171], v4 offset:28672
    v_mfma_f32_16x16x32_bf16 v[100:103], v[244:247], v[172:175], v[100:103]
    ds_read_b128 v[172:175], v25 offset:28672
    s_waitcnt lgkmcnt(11)
    v_mfma_f32_16x16x32_bf16 v[104:107], a[8:11], v[120:123], 0
    s_mov_b32 s57, 95744
    v_mfma_f32_16x16x32_bf16 v[104:107], a[32:35], v[124:127], v[104:107]
    buffer_load_dwordx4 v2, s[8:11], s57 offen offset:1024 lds
    v_mfma_f32_16x16x32_bf16 v[104:107], a[56:59], v[128:131], v[104:107]
    s_waitcnt lgkmcnt(8)
    v_mfma_f32_16x16x32_bf16 v[104:107], a[80:83], v[132:135], v[104:107]
    s_waitcnt vmcnt(10)
    s_barrier
    v_mfma_f32_16x16x32_bf16 v[104:107], a[104:107], v[136:139], v[104:107]
    s_add_u32 m0, s90, 65536
    s_mov_b32 s57, 172032
    ds_read_b64_tr_b16 v[176:177], v12 offset:0
    v_mfma_f32_16x16x32_bf16 v[104:107], a[128:131], v[140:143], v[104:107]
    buffer_load_dwordx4 v2, s[8:11], s57 offen offset:0 lds
    s_waitcnt lgkmcnt(6)
    v_mfma_f32_16x16x32_bf16 v[104:107], a[152:155], v[144:147], v[104:107]
    v_cvt_pk_bf16_f32 v54, v100, v101
    v_cvt_pk_bf16_f32 v55, v102, v103
    v_mfma_f32_16x16x32_bf16 v[104:107], a[176:179], v[148:151], v[104:107]
    v_cndmask_b32 v54, v54, 0, s[82:83]
    v_cndmask_b32 v55, v55, 0, s[82:83]
    v_mfma_f32_16x16x32_bf16 v[104:107], a[200:203], v[152:155], v[104:107]
    s_mov_b32 s57, 181760
    ds_read_b64_tr_b16 v[178:179], v12 offset:1024
    s_waitcnt lgkmcnt(4)
    v_mfma_f32_16x16x32_bf16 v[104:107], a[224:227], v[156:159], v[104:107]
    buffer_load_dwordx4 v2, s[8:11], s57 offen offset:1024 lds
    v_mfma_f32_16x16x32_bf16 v[104:107], a[248:251], v[160:163], v[104:107]
    ds_read_b64_tr_b16 v[180:181], v13 offset:0
    ds_read_b64_tr_b16 v[182:183], v13 offset:1024
    v_mfma_f32_16x16x32_bf16 v[104:107], v[192:195], v[164:167], v[104:107]
    ds_read_b64_tr_b16 v[200:201], v12 offset:8192
    ds_read_b64_tr_b16 v[202:203], v12 offset:9216
    s_waitcnt lgkmcnt(6)
    v_mfma_f32_16x16x32_bf16 v[104:107], v[216:219], v[168:171], v[104:107]
    s_add_u32 m0, s90, 73728
    s_mov_b32 s57, 258048
    ds_read_b64_tr_b16 v[204:205], v13 offset:8192
    v_mfma_f32_16x16x32_bf16 v[104:107], v[240:243], v[172:175], v[104:107]
    buffer_load_dwordx4 v2, s[8:11], s57 offen offset:0 lds
    s_waitcnt vmcnt(9)
    s_barrier
    v_mfma_f32_16x16x32_bf16 v[108:111], a[12:15], v[120:123], 0
    ds_read_b128 v[120:123], v4 offset:32768
    ds_read_b64_tr_b16 v[206:207], v13 offset:9216
    v_mfma_f32_16x16x32_bf16 v[108:111], a[36:39], v[124:127], v[108:111]
    ds_read_b128 v[124:127], v25 offset:32768
    ds_read_b64_tr_b16 v[224:225], v12 offset:16384
    v_mfma_f32_16x16x32_bf16 v[108:111], a[60:63], v[128:131], v[108:111]
    ds_read_b128 v[128:131], v4 offset:34816
    s_mov_b32 s57, 267776
    v_mfma_f32_16x16x32_bf16 v[108:111], a[84:87], v[132:135], v[108:111]
    ds_read_b128 v[132:135], v25 offset:34816
    buffer_load_dwordx4 v2, s[8:11], s57 offen offset:1024 lds
    v_mfma_f32_16x16x32_bf16 v[108:111], a[108:111], v[136:139], v[108:111]
    ds_read_b128 v[136:139], v4 offset:36864
    ds_read_b64_tr_b16 v[226:227], v12 offset:17408
    v_mfma_f32_16x16x32_bf16 v[108:111], a[132:135], v[140:143], v[108:111]
    ds_read_b128 v[140:143], v25 offset:36864
    ds_read_b64_tr_b16 v[228:229], v13 offset:16384
    v_mfma_f32_16x16x32_bf16 v[108:111], a[156:159], v[144:147], v[108:111]
    ds_read_b128 v[144:147], v4 offset:38912
    s_add_u32 m0, s90, 81920
    s_mov_b32 s57, 344064
    v_mfma_f32_16x16x32_bf16 v[108:111], a[180:183], v[148:151], v[108:111]
    ds_read_b128 v[148:151], v25 offset:38912
    buffer_load_dwordx4 v2, s[8:11], s57 offen offset:0 lds
    v_mfma_f32_16x16x32_bf16 v[108:111], a[204:207], v[152:155], v[108:111]
    ds_read_b128 v[152:155], v4 offset:40960
    v_cvt_pk_bf16_f32 v56, v104, v105
    v_mfma_f32_16x16x32_bf16 v[108:111], a[228:231], v[156:159], v[108:111]
    ds_read_b128 v[156:159], v25 offset:40960
    v_cvt_pk_bf16_f32 v57, v106, v107
    v_mfma_f32_16x16x32_bf16 v[108:111], a[252:255], v[160:163], v[108:111]
    ds_read_b128 v[160:163], v4 offset:43008
    s_mov_b32 s57, 353792
    v_mfma_f32_16x16x32_bf16 v[108:111], v[196:199], v[164:167], v[108:111]
    ds_read_b128 v[164:167], v25 offset:43008
    buffer_load_dwordx4 v2, s[8:11], s57 offen offset:1024 lds
    v_mfma_f32_16x16x32_bf16 v[108:111], v[220:223], v[168:171], v[108:111]
    ds_read_b128 v[168:171], v4 offset:45056
    ds_read_b64_tr_b16 v[230:231], v13 offset:17408
    v_mfma_f32_16x16x32_bf16 v[108:111], v[244:247], v[172:175], v[108:111]
    ds_read_b128 v[172:175], v25 offset:45056
    s_waitcnt lgkmcnt(14)
    v_mfma_f32_16x16x32_bf16 v[112:115], a[8:11], v[120:123], 0
    s_add_u32 m0, s90, 90112
    s_mov_b32 s57, 430080
    v_mfma_f32_16x16x32_bf16 v[112:115], a[32:35], v[124:127], v[112:115]
    buffer_load_dwordx4 v2, s[8:11], s57 offen offset:0 lds
    v_mfma_f32_16x16x32_bf16 v[112:115], a[56:59], v[128:131], v[112:115]
    s_waitcnt lgkmcnt(10)
    v_mfma_f32_16x16x32_bf16 v[112:115], a[80:83], v[132:135], v[112:115]
    v_mfma_f32_16x16x32_bf16 v[112:115], a[104:107], v[136:139], v[112:115]
    s_mov_b32 s57, 439808
    v_mfma_f32_16x16x32_bf16 v[112:115], a[128:131], v[140:143], v[112:115]
    buffer_load_dwordx4 v2, s[8:11], s57 offen offset:1024 lds
    s_waitcnt lgkmcnt(6)
    v_mfma_f32_16x16x32_bf16 v[112:115], a[152:155], v[144:147], v[112:115]
    v_cvt_pk_bf16_f32 v58, v108, v109
    v_cvt_pk_bf16_f32 v59, v110, v111
    v_mfma_f32_16x16x32_bf16 v[112:115], a[176:179], v[148:151], v[112:115]
    v_cndmask_b32 v58, v58, 0, s[82:83]
    v_cndmask_b32 v59, v59, 0, s[82:83]
    v_mfma_f32_16x16x32_bf16 v[112:115], a[200:203], v[152:155], v[112:115]
    s_add_u32 m0, s90, 98304
    s_mov_b32 s57, 516096
    s_waitcnt lgkmcnt(3)
    v_mfma_f32_16x16x32_bf16 v[112:115], a[224:227], v[156:159], v[112:115]
    buffer_load_dwordx4 v2, s[8:11], s57 offen offset:0 lds
    v_mfma_f32_16x16x32_bf16 v[112:115], a[248:251], v[160:163], v[112:115]
    v_mfma_f32_16x16x32_bf16 v[112:115], v[192:195], v[164:167], v[112:115]
    s_waitcnt lgkmcnt(0)
    v_mfma_f32_16x16x32_bf16 v[112:115], v[216:219], v[168:171], v[112:115]
    s_mov_b32 s57, 525824
    v_mfma_f32_16x16x32_bf16 v[112:115], v[240:243], v[172:175], v[112:115]
    buffer_load_dwordx4 v2, s[8:11], s57 offen offset:1024 lds
    v_mfma_f32_16x16x32_bf16 v[116:119], a[12:15], v[120:123], 0
    v_mfma_f32_16x16x32_bf16 v[116:119], a[36:39], v[124:127], v[116:119]
    s_waitcnt vmcnt(10)
    s_barrier
    v_mfma_f32_16x16x32_bf16 v[116:119], a[60:63], v[128:131], v[116:119]
    s_add_u32 m0, s90, 106496
    s_mov_b32 s57, 602112
    ds_read_b64_tr_b16 v[248:249], v12 offset:24576
    v_mfma_f32_16x16x32_bf16 v[116:119], a[84:87], v[132:135], v[116:119]
    buffer_load_dwordx4 v2, s[8:11], s57 offen offset:0 lds
    v_mfma_f32_16x16x32_bf16 v[116:119], a[108:111], v[136:139], v[116:119]
    ds_read_b64_tr_b16 v[250:251], v12 offset:25600
    ds_read_b64_tr_b16 v[252:253], v13 offset:24576
    v_mfma_f32_16x16x32_bf16 v[116:119], a[132:135], v[140:143], v[116:119]
    ds_read_b64_tr_b16 v[254:255], v13 offset:25600
    ds_read_b64_tr_b16 a[0:1], v10 offset:32768
    v_mfma_f32_16x16x32_bf16 v[116:119], a[156:159], v[144:147], v[116:119]
    s_mov_b32 s57, 611840
    v_cvt_pk_bf16_f32 v60, v112, v113
    v_mfma_f32_16x16x32_bf16 v[116:119], a[180:183], v[148:151], v[116:119]
    buffer_load_dwordx4 v2, s[8:11], s57 offen offset:1024 lds
    v_mfma_f32_16x16x32_bf16 v[116:119], a[204:207], v[152:155], v[116:119]
    v_cvt_pk_bf16_f32 v61, v114, v115
    ds_read_b64_tr_b16 a[2:3], v10 offset:33792
    v_mfma_f32_16x16x32_bf16 v[116:119], a[228:231], v[156:159], v[116:119]
    ds_read_b64_tr_b16 a[4:5], v11 offset:32768
    ds_read_b64_tr_b16 a[6:7], v11 offset:33792
    v_mfma_f32_16x16x32_bf16 v[116:119], a[252:255], v[160:163], v[116:119]
    s_add_u32 m0, s90, 114688
    s_mov_b32 s57, 688128
    ds_read_b64_tr_b16 a[24:25], v10 offset:40960
    v_mfma_f32_16x16x32_bf16 v[116:119], v[196:199], v[164:167], v[116:119]
    buffer_load_dwordx4 v2, s[8:11], s57 offen offset:0 lds
    v_mfma_f32_16x16x32_bf16 v[116:119], v[220:223], v[168:171], v[116:119]
    ds_read_b64_tr_b16 a[26:27], v10 offset:41984
    ds_read_b64_tr_b16 a[28:29], v11 offset:40960
    v_mfma_f32_16x16x32_bf16 v[116:119], v[244:247], v[172:175], v[116:119]
    ds_read_b64_tr_b16 a[30:31], v11 offset:41984
    s_waitcnt lgkmcnt(0)
    v_mfma_f32_16x16x32_bf16 v[96:99], v[120:123], a[16:19], 0
    s_mov_b32 s57, 697856
    v_mfma_f32_16x16x32_bf16 v[96:99], v[124:127], a[40:43], v[96:99]
    buffer_load_dwordx4 v2, s[8:11], s57 offen offset:1024 lds
    v_mfma_f32_16x16x32_bf16 v[96:99], v[128:131], a[64:67], v[96:99]
    v_mfma_f32_16x16x32_bf16 v[96:99], v[132:135], a[88:91], v[96:99]
    v_mfma_f32_16x16x32_bf16 v[96:99], v[136:139], a[112:115], v[96:99]
    s_add_u32 m0, s90, 122880
    s_mov_b32 s57, 774144
    v_mfma_f32_16x16x32_bf16 v[96:99], v[140:143], a[136:139], v[96:99]
    buffer_load_dwordx4 v2, s[8:11], s57 offen offset:0 lds
    v_mfma_f32_16x16x32_bf16 v[96:99], v[144:147], a[160:163], v[96:99]
    v_cvt_pk_bf16_f32 v62, v116, v117
    v_cvt_pk_bf16_f32 v63, v118, v119
    v_mfma_f32_16x16x32_bf16 v[96:99], v[148:151], a[184:187], v[96:99]
    v_cndmask_b32 v62, v62, 0, s[82:83]
    v_cndmask_b32 v63, v63, 0, s[82:83]
    v_mfma_f32_16x16x32_bf16 v[96:99], v[152:155], a[208:211], v[96:99]
    s_mov_b32 s57, 783872
    v_mfma_f32_16x16x32_bf16 v[96:99], v[156:159], a[232:235], v[96:99]
    buffer_load_dwordx4 v2, s[8:11], s57 offen offset:1024 lds
    v_mfma_f32_16x16x32_bf16 v[96:99], v[160:163], v[176:179], v[96:99]
    v_mfma_f32_16x16x32_bf16 v[96:99], v[164:167], v[200:203], v[96:99]
    s_waitcnt vmcnt(10)
    s_barrier
    v_mfma_f32_16x16x32_bf16 v[96:99], v[168:171], v[224:227], v[96:99]
    s_add_u32 m0, s90, 131072
    s_mov_b32 s57, 860160
    ds_read_b64_tr_b16 a[48:49], v6 offset:0
    v_mfma_f32_16x16x32_bf16 v[96:99], v[172:175], v[248:251], v[96:99]
    buffer_load_dwordx4 v2, s[8:11], s57 offen offset:0 lds
    v_mfma_f32_16x16x32_bf16 v[100:103], v[120:123], a[20:23], 0
    ds_read_b128 v[120:123], v4 offset:16384
    ds_read_b64_tr_b16 a[50:51], v6 offset:1024
    v_mfma_f32_16x16x32_bf16 v[100:103], v[124:127], a[44:47], v[100:103]
    ds_read_b128 v[124:127], v25 offset:16384
    ds_read_b64_tr_b16 a[52:53], v7 offset:0
    v_mfma_f32_16x16x32_bf16 v[100:103], v[128:131], a[68:71], v[100:103]
    ds_read_b128 v[128:131], v4 offset:18432
    s_mov_b32 s57, 869888
    v_mfma_f32_16x16x32_bf16 v[100:103], v[132:135], a[92:95], v[100:103]
    ds_read_b128 v[132:135], v25 offset:18432
    buffer_load_dwordx4 v2, s[8:11], s57 offen offset:1024 lds
    v_mfma_f32_16x16x32_bf16 v[100:103], v[136:139], a[116:119], v[100:103]
    ds_read_b128 v[136:139], v4 offset:20480
    ds_read_b64_tr_b16 a[54:55], v7 offset:1024
    v_mfma_f32_16x16x32_bf16 v[100:103], v[140:143], a[140:143], v[100:103]
    ds_read_b128 v[140:143], v25 offset:20480
    ds_read_b64_tr_b16 a[72:73], v6 offset:8192
    v_mfma_f32_16x16x32_bf16 v[100:103], v[144:147], a[164:167], v[100:103]
    ds_read_b128 v[144:147], v4 offset:22528
    s_add_u32 m0, s90, 139264
    s_mov_b32 s57, 946176
    v_mfma_f32_16x16x32_bf16 v[100:103], v[148:151], a[188:191], v[100:103]
    ds_read_b128 v[148:151], v25 offset:22528
    buffer_load_dwordx4 v2, s[8:11], s57 offen offset:0 lds
    v_mfma_f32_16x16x32_bf16 v[100:103], v[152:155], a[212:215], v[100:103]
    ds_read_b128 v[152:155], v4 offset:24576
    v_cvt_pk_bf16_f32 v36, v96, v97
    v_mfma_f32_16x16x32_bf16 v[100:103], v[156:159], a[236:239], v[100:103]
    ds_read_b128 v[156:159], v25 offset:24576
    v_cvt_pk_bf16_f32 v37, v98, v99
    v_mfma_f32_16x16x32_bf16 v[100:103], v[160:163], v[180:183], v[100:103]
    ds_read_b128 v[160:163], v4 offset:26624
    s_mov_b32 s57, 955904
    v_mfma_f32_16x16x32_bf16 v[100:103], v[164:167], v[204:207], v[100:103]
    ds_read_b128 v[164:167], v25 offset:26624
    buffer_load_dwordx4 v2, s[8:11], s57 offen offset:1024 lds
    v_mfma_f32_16x16x32_bf16 v[100:103], v[168:171], v[228:231], v[100:103]
    ds_read_b128 v[168:171], v4 offset:28672
    ds_read_b64_tr_b16 a[74:75], v6 offset:9216
    v_mfma_f32_16x16x32_bf16 v[100:103], v[172:175], v[252:255], v[100:103]
    ds_read_b128 v[172:175], v25 offset:28672
    ds_read_b64_tr_b16 a[76:77], v7 offset:8192
    s_waitcnt lgkmcnt(15)
    v_mfma_f32_16x16x32_bf16 v[104:107], v[120:123], a[16:19], 0
    s_add_u32 m0, s90, 147456
    s_mov_b32 s57, 1032192
    ds_read_b64_tr_b16 a[78:79], v7 offset:9216
    v_mfma_f32_16x16x32_bf16 v[104:107], v[124:127], a[40:43], v[104:107]
    buffer_load_dwordx4 v2, s[8:11], s57 offen offset:0 lds
    v_mfma_f32_16x16x32_bf16 v[104:107], v[128:131], a[64:67], v[104:107]
    ds_read_b64_tr_b16 a[96:97], v6 offset:16384
    ds_read_b64_tr_b16 a[98:99], v6 offset:17408
    s_waitcnt lgkmcnt(14)
    v_mfma_f32_16x16x32_bf16 v[104:107], v[132:135], a[88:91], v[104:107]
    ds_read_b64_tr_b16 a[100:101], v7 offset:16384
    ds_read_b64_tr_b16 a[102:103], v7 offset:17408
    v_mfma_f32_16x16x32_bf16 v[104:107], v[136:139], a[112:115], v[104:107]
    s_mov_b32 s57, 1041920
    v_mfma_f32_16x16x32_bf16 v[104:107], v[140:143], a[136:139], v[104:107]
    buffer_load_dwordx4 v2, s[8:11], s57 offen offset:1024 lds
    s_waitcnt lgkmcnt(12)
    v_mfma_f32_16x16x32_bf16 v[104:107], v[144:147], a[160:163], v[104:107]
    v_cvt_pk_bf16_f32 v46, v100, v101
    v_cvt_pk_bf16_f32 v47, v102, v103
    v_mfma_f32_16x16x32_bf16 v[104:107], v[148:151], a[184:187], v[104:107]
    s_waitcnt vmcnt(10)
    s_waitcnt lgkmcnt(0)
    s_barrier
    v_mfma_f32_16x16x32_bf16 v[104:107], v[152:155], a[208:211], v[104:107]
    s_add_u32 m0, s90, 155648
    s_mov_b32 s57, 1118208
    ds_read_b64_tr_b16 a[120:121], v6 offset:24576
    v_mfma_f32_16x16x32_bf16 v[104:107], v[156:159], a[232:235], v[104:107]
    buffer_load_dwordx4 v2, s[8:11], s57 offen offset:0 lds
    v_mfma_f32_16x16x32_bf16 v[104:107], v[160:163], v[176:179], v[104:107]
    ds_read_b64_tr_b16 a[122:123], v6 offset:25600
    ds_read_b64_tr_b16 a[124:125], v7 offset:24576
    v_mfma_f32_16x16x32_bf16 v[104:107], v[164:167], v[200:203], v[104:107]
    ds_read_b64_tr_b16 a[126:127], v7 offset:25600
    ds_read_b64_tr_b16 a[144:145], v6 offset:32768
    v_mfma_f32_16x16x32_bf16 v[104:107], v[168:171], v[224:227], v[104:107]
    s_mov_b32 s57, 1127936
    ds_read_b64_tr_b16 a[146:147], v6 offset:33792
    v_mfma_f32_16x16x32_bf16 v[104:107], v[172:175], v[248:251], v[104:107]
    buffer_load_dwordx4 v2, s[8:11], s57 offen offset:1024 lds
    v_mfma_f32_16x16x32_bf16 v[108:111], v[120:123], a[20:23], 0
    ds_read_b128 v[120:123], v4 offset:0
    ds_read_b64_tr_b16 a[148:149], v7 offset:32768
    v_mfma_f32_16x16x32_bf16 v[108:111], v[124:127], a[44:47], v[108:111]
    ds_read_b128 v[124:127], v25 offset:0
    ds_read_b64_tr_b16 a[150:151], v7 offset:33792
    v_mfma_f32_16x16x32_bf16 v[108:111], v[128:131], a[68:71], v[108:111]
    ds_read_b128 v[128:131], v4 offset:2048
    s_add_u32 m0, s52, 49152
    s_add_u32 s58, s72, 28672
    s_add_u32 s57, s58, s68
    v_mfma_f32_16x16x32_bf16 v[108:111], v[132:135], a[92:95], v[108:111]
    ds_read_b128 v[132:135], v25 offset:2048
    buffer_load_dwordx4 v3, s[24:27], s57 offen offset:0 sc1 lds
    v_mfma_f32_16x16x32_bf16 v[108:111], v[136:139], a[116:119], v[108:111]
    ds_read_b128 v[136:139], v4 offset:4096
    ds_read_b64_tr_b16 a[168:169], v6 offset:40960
    v_mfma_f32_16x16x32_bf16 v[108:111], v[140:143], a[140:143], v[108:111]
    ds_read_b128 v[140:143], v25 offset:4096
    ds_read_b64_tr_b16 a[170:171], v6 offset:41984
    v_mfma_f32_16x16x32_bf16 v[108:111], v[144:147], a[164:167], v[108:111]
    ds_read_b128 v[144:147], v4 offset:6144
    s_add_u32 s57, s58, s69
    v_mfma_f32_16x16x32_bf16 v[108:111], v[148:151], a[188:191], v[108:111]
    ds_read_b128 v[148:151], v25 offset:6144
    buffer_load_dwordx4 v3, s[24:27], s57 offen offset:1024 sc1 lds
    v_mfma_f32_16x16x32_bf16 v[108:111], v[152:155], a[212:215], v[108:111]
    ds_read_b128 v[152:155], v4 offset:8192
    v_cvt_pk_bf16_f32 v34, v104, v105
    v_mfma_f32_16x16x32_bf16 v[108:111], v[156:159], a[236:239], v[108:111]
    ds_read_b128 v[156:159], v25 offset:8192
    v_cvt_pk_bf16_f32 v35, v106, v107
    v_mfma_f32_16x16x32_bf16 v[108:111], v[160:163], v[180:183], v[108:111]
    ds_read_b128 v[160:163], v4 offset:10240
    s_add_u32 s57, s58, s70
    v_mfma_f32_16x16x32_bf16 v[108:111], v[164:167], v[204:207], v[108:111]
    ds_read_b128 v[164:167], v25 offset:10240
    buffer_load_dwordx4 v3, s[24:27], s57 offen offset:2048 sc1 lds
    v_mfma_f32_16x16x32_bf16 v[108:111], v[168:171], v[228:231], v[108:111]
    ds_read_b128 v[168:171], v4 offset:12288
    ds_read_b64_tr_b16 a[172:173], v7 offset:40960
    v_mfma_f32_16x16x32_bf16 v[108:111], v[172:175], v[252:255], v[108:111]
    ds_read_b128 v[172:175], v25 offset:12288
    ds_read_b64_tr_b16 a[174:175], v7 offset:41984
    s_waitcnt lgkmcnt(15)
    v_mfma_f32_16x16x32_bf16 v[112:115], v[120:123], a[16:19], 0
    s_add_u32 s57, s58, s71
    v_mfma_f32_16x16x32_bf16 v[112:115], v[124:127], a[40:43], v[112:115]
    buffer_load_dwordx4 v3, s[24:27], s57 offen offset:3072 sc1 lds
    v_mfma_f32_16x16x32_bf16 v[112:115], v[128:131], a[64:67], v[112:115]
    s_waitcnt lgkmcnt(11)
    v_mfma_f32_16x16x32_bf16 v[112:115], v[132:135], a[88:91], v[112:115]
    s_waitcnt vmcnt(10)
    s_waitcnt lgkmcnt(0)
    s_barrier
    v_mfma_f32_16x16x32_bf16 v[112:115], v[136:139], a[112:115], v[112:115]
    ds_read_b64_tr_b16 a[192:193], v10 offset:0
    ds_read_b64_tr_b16 a[194:195], v10 offset:1024
    v_mfma_f32_16x16x32_bf16 v[112:115], v[140:143], a[136:139], v[112:115]
    ds_read_b64_tr_b16 a[196:197], v11 offset:0
    ds_read_b64_tr_b16 a[198:199], v11 offset:1024
    v_mfma_f32_16x16x32_bf16 v[112:115], v[144:147], a[160:163], v[112:115]
    v_cvt_pk_bf16_f32 v44, v108, v109
    v_cvt_pk_bf16_f32 v45, v110, v111
    v_mfma_f32_16x16x32_bf16 v[112:115], v[148:151], a[184:187], v[112:115]
    ds_read_b64_tr_b16 a[216:217], v10 offset:8192
    ds_read_b64_tr_b16 a[218:219], v10 offset:9216
    v_mfma_f32_16x16x32_bf16 v[112:115], v[152:155], a[208:211], v[112:115]
    ds_read_b64_tr_b16 a[220:221], v11 offset:8192
    ds_read_b64_tr_b16 a[222:223], v11 offset:9216
    v_mfma_f32_16x16x32_bf16 v[112:115], v[156:159], a[232:235], v[112:115]
    ds_read_b64_tr_b16 a[240:241], v10 offset:16384
    ds_read_b64_tr_b16 a[242:243], v10 offset:17408
    v_mfma_f32_16x16x32_bf16 v[112:115], v[160:163], v[176:179], v[112:115]
    ds_read_b64_tr_b16 a[244:245], v11 offset:16384
    ds_read_b64_tr_b16 a[246:247], v11 offset:17408
    v_mfma_f32_16x16x32_bf16 v[112:115], v[164:167], v[200:203], v[112:115]
    v_mfma_f32_16x16x32_bf16 v[112:115], v[168:171], v[224:227], v[112:115]
    v_mfma_f32_16x16x32_bf16 v[112:115], v[172:175], v[248:251], v[112:115]
    v_mfma_f32_16x16x32_bf16 v[116:119], v[120:123], a[20:23], 0
    ds_read_b128 v[120:123], v4 offset:16384
    v_mfma_f32_16x16x32_bf16 v[116:119], v[124:127], a[44:47], v[116:119]
    ds_read_b128 v[124:127], v25 offset:16384
    v_mfma_f32_16x16x32_bf16 v[116:119], v[128:131], a[68:71], v[116:119]
    ds_read_b128 v[128:131], v4 offset:18432
    v_mfma_f32_16x16x32_bf16 v[116:119], v[132:135], a[92:95], v[116:119]
    ds_read_b128 v[132:135], v25 offset:18432
    v_mfma_f32_16x16x32_bf16 v[116:119], v[136:139], a[116:119], v[116:119]
    ds_read_b128 v[136:139], v4 offset:20480
    v_mfma_f32_16x16x32_bf16 v[116:119], v[140:143], a[140:143], v[116:119]
    ds_read_b128 v[140:143], v25 offset:20480
    v_mfma_f32_16x16x32_bf16 v[116:119], v[144:147], a[164:167], v[116:119]
    ds_read_b128 v[144:147], v4 offset:22528
    v_cvt_pk_bf16_f32 v32, v112, v113
    v_mfma_f32_16x16x32_bf16 v[116:119], v[148:151], a[188:191], v[116:119]
    ds_read_b128 v[148:151], v25 offset:22528
    v_cvt_pk_bf16_f32 v33, v114, v115
    v_mfma_f32_16x16x32_bf16 v[116:119], v[152:155], a[212:215], v[116:119]
    ds_read_b128 v[152:155], v4 offset:24576
    v_mfma_f32_16x16x32_bf16 v[116:119], v[156:159], a[236:239], v[116:119]
    ds_read_b128 v[156:159], v25 offset:24576
    v_mfma_f32_16x16x32_bf16 v[116:119], v[160:163], v[180:183], v[116:119]
    ds_read_b128 v[160:163], v4 offset:26624
    v_mfma_f32_16x16x32_bf16 v[116:119], v[164:167], v[204:207], v[116:119]
    ds_read_b128 v[164:167], v25 offset:26624
    v_mfma_f32_16x16x32_bf16 v[116:119], v[168:171], v[228:231], v[116:119]
    ds_read_b128 v[168:171], v4 offset:28672
    v_mfma_f32_16x16x32_bf16 v[116:119], v[172:175], v[252:255], v[116:119]
    ds_read_b128 v[172:175], v25 offset:28672
    s_waitcnt vmcnt(4)
    s_waitcnt lgkmcnt(14)
    s_barrier
    ds_read_b64_tr_b16 v[184:185], v10 offset:24576
    ds_read_b64_tr_b16 v[186:187], v10 offset:25600
    ds_read_b64_tr_b16 v[188:189], v11 offset:24576
    ds_read_b64_tr_b16 v[190:191], v11 offset:25600
    ds_read_b64_tr_b16 v[208:209], v10 offset:32768
    ds_read_b64_tr_b16 v[210:211], v10 offset:33792
    ds_read_b64_tr_b16 v[212:213], v11 offset:32768
    ds_read_b64_tr_b16 v[214:215], v11 offset:33792
    ds_read_b64_tr_b16 v[232:233], v10 offset:40960
    ds_read_b64_tr_b16 v[234:235], v10 offset:41984
    ds_read_b64_tr_b16 v[236:237], v11 offset:40960
    ds_read_b64_tr_b16 v[238:239], v11 offset:41984
    s_waitcnt lgkmcnt(0)
    v_mfma_f32_16x16x32_bf16 v[96:99], a[0:3], v[120:123], 0
    v_mfma_f32_16x16x32_bf16 v[96:99], a[24:27], v[124:127], v[96:99]
    v_mfma_f32_16x16x32_bf16 v[96:99], a[48:51], v[128:131], v[96:99]
    v_mfma_f32_16x16x32_bf16 v[96:99], a[72:75], v[132:135], v[96:99]
    v_mfma_f32_16x16x32_bf16 v[96:99], a[96:99], v[136:139], v[96:99]
    v_mfma_f32_16x16x32_bf16 v[96:99], a[120:123], v[140:143], v[96:99]
    v_mfma_f32_16x16x32_bf16 v[96:99], a[144:147], v[144:147], v[96:99]
    v_cvt_pk_bf16_f32 v42, v116, v117
    v_cvt_pk_bf16_f32 v43, v118, v119
    v_mfma_f32_16x16x32_bf16 v[96:99], a[168:171], v[148:151], v[96:99]
    v_mfma_f32_16x16x32_bf16 v[96:99], a[192:195], v[152:155], v[96:99]
    v_mfma_f32_16x16x32_bf16 v[96:99], a[216:219], v[156:159], v[96:99]
    v_mfma_f32_16x16x32_bf16 v[96:99], a[240:243], v[160:163], v[96:99]
    v_mfma_f32_16x16x32_bf16 v[96:99], v[184:187], v[164:167], v[96:99]
    s_barrier
    v_mfma_f32_16x16x32_bf16 v[96:99], v[208:211], v[168:171], v[96:99]
    s_add_u32 m0, s52, 65536
    s_add_u32 s58, s72, 43008
    s_add_u32 s57, s58, s68
    v_mfma_f32_16x16x32_bf16 v[96:99], v[232:235], v[172:175], v[96:99]
    buffer_load_dwordx4 v3, s[24:27], s57 offen offset:0 sc1 lds
    v_mfma_f32_16x16x32_bf16 v[100:103], a[4:7], v[120:123], 0
    ds_read_b128 v[120:123], v4 offset:32768
    v_mfma_f32_16x16x32_bf16 v[100:103], a[28:31], v[124:127], v[100:103]
    ds_read_b128 v[124:127], v25 offset:32768
    v_mfma_f32_16x16x32_bf16 v[100:103], a[52:55], v[128:131], v[100:103]
    ds_read_b128 v[128:131], v4 offset:34816
    v_mfma_f32_16x16x32_bf16 v[100:103], a[76:79], v[132:135], v[100:103]
    ds_read_b128 v[132:135], v25 offset:34816
    v_mfma_f32_16x16x32_bf16 v[100:103], a[100:103], v[136:139], v[100:103]
    ds_read_b128 v[136:139], v4 offset:36864
    s_add_u32 s57, s58, s69
    v_mfma_f32_16x16x32_bf16 v[100:103], a[124:127], v[140:143], v[100:103]
    ds_read_b128 v[140:143], v25 offset:36864
    buffer_load_dwordx4 v3, s[24:27], s57 offen offset:1024 sc1 lds
    v_mfma_f32_16x16x32_bf16 v[100:103], a[148:151], v[144:147], v[100:103]
    ds_read_b128 v[144:147], v4 offset:38912
    v_cvt_pk_bf16_f32 v68, v96, v97
    v_mfma_f32_16x16x32_bf16 v[100:103], a[172:175], v[148:151], v[100:103]
    ds_read_b128 v[148:151], v25 offset:38912
    v_cvt_pk_bf16_f32 v69, v98, v99
    v_mfma_f32_16x16x32_bf16 v[100:103], a[196:199], v[152:155], v[100:103]
    ds_read_b128 v[152:155], v4 offset:40960
    v_mfma_f32_16x16x32_bf16 v[100:103], a[220:223], v[156:159], v[100:103]
    ds_read_b128 v[156:159], v25 offset:40960
    v_mfma_f32_16x16x32_bf16 v[100:103], a[244:247], v[160:163], v[100:103]
    ds_read_b128 v[160:163], v4 offset:43008
    s_add_u32 s57, s58, s70
    v_mfma_f32_16x16x32_bf16 v[100:103], v[188:191], v[164:167], v[100:103]
    ds_read_b128 v[164:167], v25 offset:43008
    buffer_load_dwordx4 v3, s[24:27], s57 offen offset:2048 sc1 lds
    v_mfma_f32_16x16x32_bf16 v[100:103], v[212:215], v[168:171], v[100:103]
    ds_read_b128 v[168:171], v4 offset:45056
    v_mfma_f32_16x16x32_bf16 v[100:103], v[236:239], v[172:175], v[100:103]
    ds_read_b128 v[172:175], v25 offset:45056
    s_waitcnt lgkmcnt(11)
    v_mfma_f32_16x16x32_bf16 v[104:107], a[0:3], v[120:123], 0
    v_mfma_f32_16x16x32_bf16 v[104:107], a[24:27], v[124:127], v[104:107]
    v_mfma_f32_16x16x32_bf16 v[104:107], a[48:51], v[128:131], v[104:107]
    s_add_u32 s57, s58, s71
    s_waitcnt lgkmcnt(8)
    v_mfma_f32_16x16x32_bf16 v[104:107], a[72:75], v[132:135], v[104:107]
    buffer_load_dwordx4 v3, s[24:27], s57 offen offset:3072 sc1 lds
    v_mfma_f32_16x16x32_bf16 v[104:107], a[96:99], v[136:139], v[104:107]
    v_mfma_f32_16x16x32_bf16 v[104:107], a[120:123], v[140:143], v[104:107]
    s_waitcnt lgkmcnt(5)
    v_mfma_f32_16x16x32_bf16 v[104:107], a[144:147], v[144:147], v[104:107]
    v_cvt_pk_bf16_f32 v70, v100, v101
    v_cvt_pk_bf16_f32 v71, v102, v103
    v_mfma_f32_16x16x32_bf16 v[104:107], a[168:171], v[148:151], v[104:107]
    v_cndmask_b32 v70, v70, 0, s[82:83]
    v_cndmask_b32 v71, v71, 0, s[82:83]
    v_mfma_f32_16x16x32_bf16 v[104:107], a[192:195], v[152:155], v[104:107]
    s_add_u32 m0, s52, 81920
    s_add_u32 s58, s72, 57344
    s_add_u32 s57, s58, s68
    s_waitcnt lgkmcnt(2)
    v_mfma_f32_16x16x32_bf16 v[104:107], a[216:219], v[156:159], v[104:107]
    buffer_load_dwordx4 v3, s[24:27], s57 offen offset:0 sc1 lds
    v_mfma_f32_16x16x32_bf16 v[104:107], a[240:243], v[160:163], v[104:107]
    v_mfma_f32_16x16x32_bf16 v[72:75], v[52:55], v[68:71], 0
    v_mfma_f32_16x16x32_bf16 v[104:107], v[184:187], v[164:167], v[104:107]
    v_mfma_f32_16x16x32_bf16 v[76:79], v[56:59], v[68:71], 0
    s_waitcnt lgkmcnt(0)
    v_mfma_f32_16x16x32_bf16 v[104:107], v[208:211], v[168:171], v[104:107]
    v_mfma_f32_16x16x32_bf16 v[104:107], v[232:235], v[172:175], v[104:107]
    s_waitcnt vmcnt(5)
    s_barrier
    v_mfma_f32_16x16x32_bf16 v[108:111], a[4:7], v[120:123], 0
    ds_read_b128 v[120:123], v4 offset:49152
    s_add_u32 s57, s58, s69
    v_mfma_f32_16x16x32_bf16 v[108:111], a[28:31], v[124:127], v[108:111]
    ds_read_b128 v[124:127], v25 offset:49152
    buffer_load_dwordx4 v3, s[24:27], s57 offen offset:1024 sc1 lds
    v_mfma_f32_16x16x32_bf16 v[108:111], a[52:55], v[128:131], v[108:111]
    ds_read_b128 v[128:131], v4 offset:51200
    v_cndmask_b32 v26, v72, v73, s[76:77]
    v_mfma_f32_16x16x32_bf16 v[108:111], a[76:79], v[132:135], v[108:111]
    ds_read_b128 v[132:135], v25 offset:51200
    v_cndmask_b32 v27, v74, v75, s[76:77]
    v_mfma_f32_16x16x32_bf16 v[108:111], a[100:103], v[136:139], v[108:111]
    ds_read_b128 v[136:139], v4 offset:53248
    v_cndmask_b32 v28, v76, v77, s[76:77]
    v_mfma_f32_16x16x32_bf16 v[108:111], a[124:127], v[140:143], v[108:111]
    ds_read_b128 v[140:143], v25 offset:53248
    v_cndmask_b32 v29, v78, v79, s[76:77]
    v_mfma_f32_16x16x32_bf16 v[108:111], a[148:151], v[144:147], v[108:111]
    ds_read_b128 v[144:147], v4 offset:55296
    s_add_u32 s57, s58, s70
    v_mfma_f32_16x16x32_bf16 v[108:111], a[172:175], v[148:151], v[108:111]
    ds_read_b128 v[148:151], v25 offset:55296
    buffer_load_dwordx4 v3, s[24:27], s57 offen offset:2048 sc1 lds
    v_mfma_f32_16x16x32_bf16 v[108:111], a[196:199], v[152:155], v[108:111]
    ds_read_b128 v[152:155], v4 offset:57344
    v_cvt_pk_bf16_f32 v64, v104, v105
    v_mfma_f32_16x16x32_bf16 v[108:111], a[220:223], v[156:159], v[108:111]
    ds_read_b128 v[156:159], v25 offset:57344
    v_cvt_pk_bf16_f32 v65, v106, v107
    v_mfma_f32_16x16x32_bf16 v[108:111], a[244:247], v[160:163], v[108:111]
    ds_read_b128 v[160:163], v4 offset:59392
    v_cndmask_b32 v26, v26, v28, s[78:79]
    v_mfma_f32_16x16x32_bf16 v[108:111], v[188:191], v[164:167], v[108:111]
    ds_read_b128 v[164:167], v25 offset:59392
    v_cndmask_b32 v27, v27, v29, s[80:81]
    v_mfma_f32_16x16x32_bf16 v[108:111], v[212:215], v[168:171], v[108:111]
    ds_read_b128 v[168:171], v4 offset:61440
    s_add_u32 s57, s58, s71
    v_mfma_f32_16x16x32_bf16 v[108:111], v[236:239], v[172:175], v[108:111]
    ds_read_b128 v[172:175], v25 offset:61440
    buffer_load_dwordx4 v3, s[24:27], s57 offen offset:3072 sc1 lds
    s_waitcnt lgkmcnt(11)
    v_mfma_f32_16x16x32_bf16 v[112:115], a[8:11], v[120:123], 0
    v_cndmask_b32 v26, v26, v18, s[84:85]
    v_cndmask_b32 v27, v27, v18, s[86:87]
    v_mfma_f32_16x16x32_bf16 v[112:115], a[32:35], v[124:127], v[112:115]
    v_max_f32 v28, v26, v27
    v_mov_b32 v29, v28
    v_mfma_f32_16x16x32_bf16 v[112:115], a[56:59], v[128:131], v[112:115]
    s_waitcnt lgkmcnt(8)
    v_mfma_f32_16x16x32_bf16 v[112:115], a[80:83], v[132:135], v[112:115]
    v_permlane16_swap_b32 v28, v29
    v_max_f32 v28, v28, v29
    v_mfma_f32_16x16x32_bf16 v[112:115], a[104:107], v[136:139], v[112:115]
    s_add_u32 m0, s52, 98304
    s_add_u32 s58, s72, 71680
    s_add_u32 s57, s58, s68
    v_mov_b32 v29, v28
    v_mfma_f32_16x16x32_bf16 v[112:115], a[128:131], v[140:143], v[112:115]
    buffer_load_dwordx4 v3, s[24:27], s57 offen offset:0 sc1 lds
    s_waitcnt lgkmcnt(5)
    v_mfma_f32_16x16x32_bf16 v[112:115], a[152:155], v[144:147], v[112:115]
    v_cvt_pk_bf16_f32 v66, v108, v109
    v_cvt_pk_bf16_f32 v67, v110, v111
    v_mfma_f32_16x16x32_bf16 v[112:115], a[176:179], v[148:151], v[112:115]
    v_cndmask_b32 v66, v66, 0, s[82:83]
    v_cndmask_b32 v67, v67, 0, s[82:83]
    v_mfma_f32_16x16x32_bf16 v[112:115], a[200:203], v[152:155], v[112:115]
    v_permlane32_swap_b32 v28, v29
    v_max_f32 v28, v28, v29
    s_waitcnt lgkmcnt(2)
    v_mfma_f32_16x16x32_bf16 v[112:115], a[224:227], v[156:159], v[112:115]
    v_sub_f32 v26, v26, v28
    v_sub_f32 v27, v27, v28
    v_mfma_f32_16x16x32_bf16 v[112:115], a[248:251], v[160:163], v[112:115]
    s_add_u32 s57, s58, s69
    v_mul_f32 v26, s91, v26
    v_mfma_f32_16x16x32_bf16 v[112:115], v[192:195], v[164:167], v[112:115]
    buffer_load_dwordx4 v3, s[24:27], s57 offen offset:1024 sc1 lds
    s_waitcnt lgkmcnt(0)
    v_mfma_f32_16x16x32_bf16 v[112:115], v[216:219], v[168:171], v[112:115]
    v_mul_f32 v27, s91, v27
    v_exp_f32 v26, v26
    v_mfma_f32_16x16x32_bf16 v[112:115], v[240:243], v[172:175], v[112:115]
    v_exp_f32 v27, v27
    v_mfma_f32_16x16x32_bf16 v[116:119], a[12:15], v[120:123], 0
    v_add_f32 v28, v26, v27
    v_mov_b32 v29, v28
    v_mfma_f32_16x16x32_bf16 v[116:119], a[36:39], v[124:127], v[116:119]
    v_mfma_f32_16x16x32_bf16 v[116:119], a[60:63], v[128:131], v[116:119]
    s_add_u32 s57, s58, s70
    v_permlane16_swap_b32 v28, v29
    v_mfma_f32_16x16x32_bf16 v[116:119], a[84:87], v[132:135], v[116:119]
    buffer_load_dwordx4 v3, s[24:27], s57 offen offset:2048 sc1 lds
    v_mfma_f32_16x16x32_bf16 v[116:119], a[108:111], v[136:139], v[116:119]
    v_add_f32 v28, v28, v29
    v_mov_b32 v29, v28
    v_mfma_f32_16x16x32_bf16 v[116:119], a[132:135], v[140:143], v[116:119]
    v_mfma_f32_16x16x32_bf16 v[116:119], a[156:159], v[144:147], v[116:119]
    v_cvt_pk_bf16_f32 v52, v112, v113
    v_cvt_pk_bf16_f32 v53, v114, v115
    v_mfma_f32_16x16x32_bf16 v[116:119], a[180:183], v[148:151], v[116:119]
    v_permlane32_swap_b32 v28, v29
    v_add_f32 v28, v28, v29
    v_mfma_f32_16x16x32_bf16 v[116:119], a[204:207], v[152:155], v[116:119]
    s_add_u32 s57, s58, s71
    v_rcp_f32 v28, v28
    v_mfma_f32_16x16x32_bf16 v[116:119], a[228:231], v[156:159], v[116:119]
    buffer_load_dwordx4 v3, s[24:27], s57 offen offset:3072 sc1 lds
    v_mfma_f32_16x16x32_bf16 v[116:119], a[252:255], v[160:163], v[116:119]
    v_mul_f32 v26, v26, v28
    v_mul_f32 v27, v27, v28
    v_mfma_f32_16x16x32_bf16 v[116:119], v[196:199], v[164:167], v[116:119]
    v_cvt_pk_bf16_f32 v26, v26, v26
    v_cvt_pk_bf16_f32 v27, v27, v27
    v_mfma_f32_16x16x32_bf16 v[116:119], v[220:223], v[168:171], v[116:119]
    v_and_b32 v80, v26, v14
    v_and_b32 v81, v27, v15
    v_mfma_f32_16x16x32_bf16 v[116:119], v[244:247], v[172:175], v[116:119]
    v_and_b32 v82, v26, v16
    v_and_b32 v83, v27, v17
    v_mfma_f32_16x16x32_bf16 v[96:99], v[120:123], a[16:19], 0
    s_add_u32 m0, s52, 114688
    s_add_u32 s58, s72, 86016
    s_add_u32 s57, s58, s68
    v_mfma_f32_16x16x32_bf16 v[96:99], v[124:127], a[40:43], v[96:99]
    buffer_load_dwordx4 v3, s[24:27], s57 offen offset:0 sc1 lds
    v_mfma_f32_16x16x32_bf16 v[96:99], v[128:131], a[64:67], v[96:99]
    v_mfma_f32_16x16x32_bf16 v[72:75], v[32:35], v[80:83], 0
    v_mfma_f32_16x16x32_bf16 v[96:99], v[132:135], a[88:91], v[96:99]
    v_mfma_f32_16x16x32_bf16 v[76:79], v[42:45], v[80:83], 0
    v_mfma_f32_16x16x32_bf16 v[96:99], v[136:139], a[112:115], v[96:99]
    s_add_u32 s53, s74, 0
    v_mfma_f32_16x16x32_bf16 v[96:99], v[140:143], a[136:139], v[96:99]
    v_mfma_f32_16x16x32_bf16 v[96:99], v[144:147], a[160:163], v[96:99]
    s_add_u32 s57, s58, s69
    v_cvt_pk_bf16_f32 v54, v116, v117
    v_mfma_f32_16x16x32_bf16 v[96:99], v[148:151], a[184:187], v[96:99]
    buffer_load_dwordx4 v3, s[24:27], s57 offen offset:1024 sc1 lds
    v_mfma_f32_16x16x32_bf16 v[96:99], v[152:155], a[208:211], v[96:99]
    v_cvt_pk_bf16_f32 v55, v118, v119
    v_cndmask_b32 v54, v54, 0, s[82:83]
    v_mfma_f32_16x16x32_bf16 v[96:99], v[156:159], a[232:235], v[96:99]
    v_cndmask_b32 v55, v55, 0, s[82:83]
    v_cvt_pk_bf16_f32 v84, v72, v73
    v_mfma_f32_16x16x32_bf16 v[96:99], v[160:163], v[176:179], v[96:99]
    v_cvt_pk_bf16_f32 v85, v74, v75
    v_cvt_pk_bf16_f32 v86, v76, v77
    v_mfma_f32_16x16x32_bf16 v[96:99], v[164:167], v[200:203], v[96:99]
    v_cvt_pk_bf16_f32 v87, v78, v79
    v_cndmask_b32 v86, v86, 0, s[82:83]
    v_mfma_f32_16x16x32_bf16 v[96:99], v[168:171], v[224:227], v[96:99]
    s_add_u32 s57, s58, s70
    v_cndmask_b32 v87, v87, 0, s[82:83]
    v_mfma_f32_16x16x32_bf16 v[96:99], v[172:175], v[248:251], v[96:99]
    buffer_load_dwordx4 v3, s[24:27], s57 offen offset:2048 sc1 lds
    v_mfma_f32_16x16x32_bf16 v[100:103], v[120:123], a[20:23], 0
    buffer_store_dwordx4 v[84:87], v23, s[24:27], s53 offen sc1
    v_mfma_f32_16x16x32_bf16 v[100:103], v[124:127], a[44:47], v[100:103]
    v_mfma_f32_16x16x32_bf16 v[100:103], v[128:131], a[68:71], v[100:103]
    v_mfma_f32_16x16x32_bf16 v[72:75], v[56:59], v[64:67], 0
    v_mfma_f32_16x16x32_bf16 v[100:103], v[132:135], a[92:95], v[100:103]
    v_mfma_f32_16x16x32_bf16 v[76:79], v[60:63], v[64:67], 0
    v_mfma_f32_16x16x32_bf16 v[100:103], v[136:139], a[116:119], v[100:103]
    s_add_u32 s57, s58, s71
    v_mfma_f32_16x16x32_bf16 v[100:103], v[140:143], a[140:143], v[100:103]
    buffer_load_dwordx4 v3, s[24:27], s57 offen offset:3072 sc1 lds
    v_mfma_f32_16x16x32_bf16 v[100:103], v[144:147], a[164:167], v[100:103]
    v_cvt_pk_bf16_f32 v38, v96, v97
    v_cvt_pk_bf16_f32 v39, v98, v99
    v_mfma_f32_16x16x32_bf16 v[100:103], v[148:151], a[188:191], v[100:103]
    v_mfma_f32_16x16x32_bf16 v[100:103], v[152:155], a[212:215], v[100:103]
    v_cndmask_b32 v26, v72, v73, s[76:77]
    v_cndmask_b32 v27, v74, v75, s[76:77]
    v_mfma_f32_16x16x32_bf16 v[100:103], v[156:159], a[236:239], v[100:103]
    v_cndmask_b32 v28, v76, v77, s[76:77]
    v_cndmask_b32 v29, v78, v79, s[76:77]
    v_mfma_f32_16x16x32_bf16 v[100:103], v[160:163], v[180:183], v[100:103]
    s_add_u32 m0, s52, 131072
    s_add_u32 s58, s72, 100352
    s_add_u32 s57, s58, s68
    v_cndmask_b32 v26, v26, v28, s[78:79]
    v_mfma_f32_16x16x32_bf16 v[100:103], v[164:167], v[204:207], v[100:103]
    buffer_load_dwordx4 v3, s[24:27], s57 offen offset:0 sc1 lds
    v_mfma_f32_16x16x32_bf16 v[100:103], v[168:171], v[228:231], v[100:103]
    v_cndmask_b32 v27, v27, v29, s[80:81]
    v_max_f32 v28, v26, v27
    v_mfma_f32_16x16x32_bf16 v[100:103], v[172:175], v[252:255], v[100:103]
    v_mov_b32 v29, v28
    v_mfma_f32_16x16x32_bf16 v[104:107], a[0:3], v[120:123], 0
    v_mfma_f32_16x16x32_bf16 v[104:107], a[24:27], v[124:127], v[104:107]
    v_permlane16_swap_b32 v28, v29
    v_max_f32 v28, v28, v29
    v_mfma_f32_16x16x32_bf16 v[104:107], a[48:51], v[128:131], v[104:107]
    s_add_u32 s57, s58, s69
    v_mov_b32 v29, v28
    v_mfma_f32_16x16x32_bf16 v[104:107], a[72:75], v[132:135], v[104:107]
    buffer_load_dwordx4 v3, s[24:27], s57 offen offset:1024 sc1 lds
    v_mfma_f32_16x16x32_bf16 v[104:107], a[96:99], v[136:139], v[104:107]
    v_permlane32_swap_b32 v28, v29
    v_max_f32 v28, v28, v29
    v_mfma_f32_16x16x32_bf16 v[104:107], a[120:123], v[140:143], v[104:107]
    v_sub_f32 v26, v26, v28
    v_sub_f32 v27, v27, v28
    v_mfma_f32_16x16x32_bf16 v[104:107], a[144:147], v[144:147], v[104:107]
    v_cvt_pk_bf16_f32 v48, v100, v101
    v_cvt_pk_bf16_f32 v49, v102, v103
    v_mfma_f32_16x16x32_bf16 v[104:107], a[168:171], v[148:151], v[104:107]
    v_mul_f32 v26, s91, v26
    v_mul_f32 v27, s91, v27
    v_mfma_f32_16x16x32_bf16 v[104:107], a[192:195], v[152:155], v[104:107]
    s_add_u32 s57, s58, s70
    v_exp_f32 v26, v26
    v_mfma_f32_16x16x32_bf16 v[104:107], a[216:219], v[156:159], v[104:107]
    buffer_load_dwordx4 v3, s[24:27], s57 offen offset:2048 sc1 lds
    v_mfma_f32_16x16x32_bf16 v[104:107], a[240:243], v[160:163], v[104:107]
    v_exp_f32 v27, v27
    v_mfma_f32_16x16x32_bf16 v[104:107], v[184:187], v[164:167], v[104:107]
    v_add_f32 v28, v26, v27
    v_mov_b32 v29, v28
    v_mfma_f32_16x16x32_bf16 v[104:107], v[208:211], v[168:171], v[104:107]
    v_mfma_f32_16x16x32_bf16 v[104:107], v[232:235], v[172:175], v[104:107]
    v_permlane16_swap_b32 v28, v29
    v_add_f32 v28, v28, v29
    s_waitcnt vmcnt(8)
    s_barrier
    v_mfma_f32_16x16x32_bf16 v[108:111], a[4:7], v[120:123], 0
    v_add_u32 v4, 65536, v4
    v_add_u32 v25, 65536, v25
    ds_read_b128 v[120:123], v4 offset:0
    s_add_u32 s57, s58, s71
    v_mfma_f32_16x16x32_bf16 v[108:111], a[28:31], v[124:127], v[108:111]
    ds_read_b128 v[124:127], v25 offset:0
    buffer_load_dwordx4 v3, s[24:27], s57 offen offset:3072 sc1 lds
    v_mfma_f32_16x16x32_bf16 v[108:111], a[52:55], v[128:131], v[108:111]
    ds_read_b128 v[128:131], v4 offset:2048
    v_mov_b32 v29, v28
    v_mfma_f32_16x16x32_bf16 v[108:111], a[76:79], v[132:135], v[108:111]
    ds_read_b128 v[132:135], v25 offset:2048
    v_mfma_f32_16x16x32_bf16 v[108:111], a[100:103], v[136:139], v[108:111]
    ds_read_b128 v[136:139], v4 offset:4096
    v_permlane32_swap_b32 v28, v29
    v_mfma_f32_16x16x32_bf16 v[108:111], a[124:127], v[140:143], v[108:111]
    ds_read_b128 v[140:143], v25 offset:4096
    v_add_f32 v28, v28, v29
    v_mfma_f32_16x16x32_bf16 v[108:111], a[148:151], v[144:147], v[108:111]
    ds_read_b128 v[144:147], v4 offset:6144
    s_add_u32 s57, s73, 0
    v_mfma_f32_16x16x32_bf16 v[108:111], a[172:175], v[148:151], v[108:111]
    ds_read_b128 v[148:151], v25 offset:6144
    buffer_load_dword v22, v5, s[20:23], s57 offen
    v_mfma_f32_16x16x32_bf16 v[108:111], a[196:199], v[152:155], v[108:111]
    ds_read_b128 v[152:155], v4 offset:8192
    v_cvt_pk_bf16_f32 v68, v104, v105
    v_mfma_f32_16x16x32_bf16 v[108:111], a[220:223], v[156:159], v[108:111]
    ds_read_b128 v[156:159], v25 offset:8192
    v_cvt_pk_bf16_f32 v69, v106, v107
    v_mfma_f32_16x16x32_bf16 v[108:111], a[244:247], v[160:163], v[108:111]
    ds_read_b128 v[160:163], v4 offset:10240
    v_rcp_f32 v28, v28
    v_mfma_f32_16x16x32_bf16 v[108:111], v[188:191], v[164:167], v[108:111]
    ds_read_b128 v[164:167], v25 offset:10240
    v_mul_f32 v26, v26, v28
    v_mfma_f32_16x16x32_bf16 v[108:111], v[212:215], v[168:171], v[108:111]
    ds_read_b128 v[168:171], v4 offset:12288
    v_mul_f32 v27, v27, v28
    v_mfma_f32_16x16x32_bf16 v[108:111], v[236:239], v[172:175], v[108:111]
    ds_read_b128 v[172:175], v25 offset:12288
    v_cvt_pk_bf16_f32 v26, v26, v26
    s_waitcnt lgkmcnt(11)
    v_mfma_f32_16x16x32_bf16 v[112:115], a[8:11], v[120:123], 0
    v_cvt_pk_bf16_f32 v27, v27, v27
    v_and_b32 v80, v26, v14
    v_mfma_f32_16x16x32_bf16 v[112:115], a[32:35], v[124:127], v[112:115]
    v_and_b32 v81, v27, v15
    v_and_b32 v82, v26, v16
    v_mfma_f32_16x16x32_bf16 v[112:115], a[56:59], v[128:131], v[112:115]
    v_and_b32 v83, v27, v17
    s_waitcnt lgkmcnt(8)
    v_mfma_f32_16x16x32_bf16 v[112:115], a[80:83], v[132:135], v[112:115]
    v_mfma_f32_16x16x32_bf16 v[112:115], a[104:107], v[136:139], v[112:115]
    v_mfma_f32_16x16x32_bf16 v[72:75], v[34:37], v[80:83], 0
    v_mfma_f32_16x16x32_bf16 v[112:115], a[128:131], v[140:143], v[112:115]
    v_mfma_f32_16x16x32_bf16 v[76:79], v[44:47], v[80:83], 0
    s_waitcnt lgkmcnt(5)
    v_mfma_f32_16x16x32_bf16 v[112:115], a[152:155], v[144:147], v[112:115]
    v_cvt_pk_bf16_f32 v70, v108, v109
    v_cvt_pk_bf16_f32 v71, v110, v111
    v_mfma_f32_16x16x32_bf16 v[112:115], a[176:179], v[148:151], v[112:115]
    v_cndmask_b32 v70, v70, 0, s[82:83]
    v_cndmask_b32 v71, v71, 0, s[82:83]
    v_mfma_f32_16x16x32_bf16 v[112:115], a[200:203], v[152:155], v[112:115]
    s_add_u32 s53, s74, 16384
    s_waitcnt lgkmcnt(2)
    v_mfma_f32_16x16x32_bf16 v[112:115], a[224:227], v[156:159], v[112:115]
    v_mfma_f32_16x16x32_bf16 v[112:115], a[248:251], v[160:163], v[112:115]
    v_mfma_f32_16x16x32_bf16 v[112:115], v[192:195], v[164:167], v[112:115]
    s_waitcnt lgkmcnt(0)
    v_mfma_f32_16x16x32_bf16 v[112:115], v[216:219], v[168:171], v[112:115]
    v_mfma_f32_16x16x32_bf16 v[112:115], v[240:243], v[172:175], v[112:115]
    v_cvt_pk_bf16_f32 v84, v72, v73
    v_cvt_pk_bf16_f32 v85, v74, v75
    v_mfma_f32_16x16x32_bf16 v[116:119], a[12:15], v[120:123], 0
    v_cvt_pk_bf16_f32 v86, v76, v77
    v_cvt_pk_bf16_f32 v87, v78, v79
    v_mfma_f32_16x16x32_bf16 v[116:119], a[36:39], v[124:127], v[116:119]
    v_cndmask_b32 v86, v86, 0, s[82:83]
    v_cndmask_b32 v87, v87, 0, s[82:83]
    v_mfma_f32_16x16x32_bf16 v[116:119], a[60:63], v[128:131], v[116:119]
    buffer_store_dwordx4 v[84:87], v23, s[24:27], s53 offen sc1
    v_mfma_f32_16x16x32_bf16 v[116:119], a[84:87], v[132:135], v[116:119]
    v_mfma_f32_16x16x32_bf16 v[116:119], a[108:111], v[136:139], v[116:119]
    v_mfma_f32_16x16x32_bf16 v[72:75], v[60:63], v[68:71], 0
    v_mfma_f32_16x16x32_bf16 v[116:119], a[132:135], v[140:143], v[116:119]
    v_mfma_f32_16x16x32_bf16 v[76:79], v[52:55], v[68:71], 0
    v_mfma_f32_16x16x32_bf16 v[116:119], a[156:159], v[144:147], v[116:119]
    v_cvt_pk_bf16_f32 v56, v112, v113
    v_cvt_pk_bf16_f32 v57, v114, v115
    v_mfma_f32_16x16x32_bf16 v[116:119], a[180:183], v[148:151], v[116:119]
    v_mfma_f32_16x16x32_bf16 v[116:119], a[204:207], v[152:155], v[116:119]
    v_mfma_f32_16x16x32_bf16 v[116:119], a[228:231], v[156:159], v[116:119]
    v_mfma_f32_16x16x32_bf16 v[116:119], a[252:255], v[160:163], v[116:119]
    v_cndmask_b32 v26, v72, v73, s[76:77]
    v_cndmask_b32 v27, v74, v75, s[76:77]
    v_mfma_f32_16x16x32_bf16 v[116:119], v[196:199], v[164:167], v[116:119]
    v_cndmask_b32 v28, v76, v77, s[76:77]
    v_cndmask_b32 v29, v78, v79, s[76:77]
    v_mfma_f32_16x16x32_bf16 v[116:119], v[220:223], v[168:171], v[116:119]
    v_cndmask_b32 v26, v26, v28, s[78:79]
    v_cndmask_b32 v27, v27, v29, s[80:81]
    v_mfma_f32_16x16x32_bf16 v[116:119], v[244:247], v[172:175], v[116:119]
    v_max_f32 v28, v26, v27
    v_mov_b32 v29, v28
    v_mfma_f32_16x16x32_bf16 v[96:99], v[120:123], a[16:19], 0
    v_mfma_f32_16x16x32_bf16 v[96:99], v[124:127], a[40:43], v[96:99]
    v_permlane16_swap_b32 v28, v29
    v_max_f32 v28, v28, v29
    v_mfma_f32_16x16x32_bf16 v[96:99], v[128:131], a[64:67], v[96:99]
    v_mov_b32 v29, v28
    v_mfma_f32_16x16x32_bf16 v[96:99], v[132:135], a[88:91], v[96:99]
    v_mfma_f32_16x16x32_bf16 v[96:99], v[136:139], a[112:115], v[96:99]
    v_permlane32_swap_b32 v28, v29
    v_max_f32 v28, v28, v29
    v_mfma_f32_16x16x32_bf16 v[96:99], v[140:143], a[136:139], v[96:99]
    v_sub_f32 v26, v26, v28
    v_sub_f32 v27, v27, v28
    v_mfma_f32_16x16x32_bf16 v[96:99], v[144:147], a[160:163], v[96:99]
    v_cvt_pk_bf16_f32 v58, v116, v117
    v_cvt_pk_bf16_f32 v59, v118, v119
    v_mfma_f32_16x16x32_bf16 v[96:99], v[148:151], a[184:187], v[96:99]
    v_cndmask_b32 v58, v58, 0, s[82:83]
    v_cndmask_b32 v59, v59, 0, s[82:83]
    v_mfma_f32_16x16x32_bf16 v[96:99], v[152:155], a[208:211], v[96:99]
    v_mul_f32 v26, s91, v26
    v_mul_f32 v27, s91, v27
    v_mfma_f32_16x16x32_bf16 v[96:99], v[156:159], a[232:235], v[96:99]
    v_exp_f32 v26, v26
    v_mfma_f32_16x16x32_bf16 v[96:99], v[160:163], v[176:179], v[96:99]
    v_exp_f32 v27, v27
    v_mfma_f32_16x16x32_bf16 v[96:99], v[164:167], v[200:203], v[96:99]
    v_add_f32 v28, v26, v27
    v_mov_b32 v29, v28
    v_mfma_f32_16x16x32_bf16 v[96:99], v[168:171], v[224:227], v[96:99]
    v_mfma_f32_16x16x32_bf16 v[96:99], v[172:175], v[248:251], v[96:99]
    v_permlane16_swap_b32 v28, v29
    v_add_f32 v28, v28, v29
    v_mfma_f32_16x16x32_bf16 v[100:103], v[120:123], a[20:23], 0
    v_mov_b32 v29, v28
    v_mfma_f32_16x16x32_bf16 v[100:103], v[124:127], a[44:47], v[100:103]
    v_mfma_f32_16x16x32_bf16 v[100:103], v[128:131], a[68:71], v[100:103]
    v_permlane32_swap_b32 v28, v29
    v_add_f32 v28, v28, v29
    v_mfma_f32_16x16x32_bf16 v[100:103], v[132:135], a[92:95], v[100:103]
    v_rcp_f32 v28, v28
    v_mfma_f32_16x16x32_bf16 v[100:103], v[136:139], a[116:119], v[100:103]
    v_mul_f32 v26, v26, v28
    v_mul_f32 v27, v27, v28
    v_mfma_f32_16x16x32_bf16 v[100:103], v[140:143], a[140:143], v[100:103]
    v_cvt_pk_bf16_f32 v26, v26, v26
    v_cvt_pk_bf16_f32 v27, v27, v27
    v_mfma_f32_16x16x32_bf16 v[100:103], v[144:147], a[164:167], v[100:103]
    v_cvt_pk_bf16_f32 v40, v96, v97
    v_cvt_pk_bf16_f32 v41, v98, v99
    v_mfma_f32_16x16x32_bf16 v[100:103], v[148:151], a[188:191], v[100:103]
    v_cvt_pk_bf16_f32 v32, v96, v97
    v_cvt_pk_bf16_f32 v33, v98, v99
    v_mfma_f32_16x16x32_bf16 v[100:103], v[152:155], a[212:215], v[100:103]
    v_and_b32 v80, v26, v14
    v_and_b32 v81, v27, v15
    v_mfma_f32_16x16x32_bf16 v[100:103], v[156:159], a[236:239], v[100:103]
    v_and_b32 v82, v26, v16
    v_and_b32 v83, v27, v17
    v_mfma_f32_16x16x32_bf16 v[100:103], v[160:163], v[180:183], v[100:103]
    v_mfma_f32_16x16x32_bf16 v[100:103], v[164:167], v[204:207], v[100:103]
    v_mfma_f32_16x16x32_bf16 v[72:75], v[36:39], v[80:83], 0
    v_mfma_f32_16x16x32_bf16 v[100:103], v[168:171], v[228:231], v[100:103]
    v_mfma_f32_16x16x32_bf16 v[76:79], v[46:49], v[80:83], 0
    v_mfma_f32_16x16x32_bf16 v[100:103], v[172:175], v[252:255], v[100:103]
    s_add_u32 s53, s74, 32768
    v_mfma_f32_16x16x32_bf16 v[104:107], a[0:3], v[120:123], 0
    v_mfma_f32_16x16x32_bf16 v[104:107], a[24:27], v[124:127], v[104:107]
    v_mfma_f32_16x16x32_bf16 v[104:107], a[48:51], v[128:131], v[104:107]
    v_mfma_f32_16x16x32_bf16 v[104:107], a[72:75], v[132:135], v[104:107]
    v_mfma_f32_16x16x32_bf16 v[104:107], a[96:99], v[136:139], v[104:107]
    v_cvt_pk_bf16_f32 v84, v72, v73
    v_cvt_pk_bf16_f32 v85, v74, v75
    v_mfma_f32_16x16x32_bf16 v[104:107], a[120:123], v[140:143], v[104:107]
    v_cvt_pk_bf16_f32 v86, v76, v77
    v_cvt_pk_bf16_f32 v87, v78, v79
    v_mfma_f32_16x16x32_bf16 v[104:107], a[144:147], v[144:147], v[104:107]
    v_cvt_pk_bf16_f32 v50, v100, v101
    v_cvt_pk_bf16_f32 v51, v102, v103
    v_mfma_f32_16x16x32_bf16 v[104:107], a[168:171], v[148:151], v[104:107]
    v_cvt_pk_bf16_f32 v42, v100, v101
    v_cvt_pk_bf16_f32 v43, v102, v103
    v_mfma_f32_16x16x32_bf16 v[104:107], a[192:195], v[152:155], v[104:107]
    v_cndmask_b32 v86, v86, 0, s[82:83]
    v_cndmask_b32 v87, v87, 0, s[82:83]
    v_mfma_f32_16x16x32_bf16 v[104:107], a[216:219], v[156:159], v[104:107]
    buffer_store_dwordx4 v[84:87], v23, s[24:27], s53 offen sc1
    v_mfma_f32_16x16x32_bf16 v[104:107], a[240:243], v[160:163], v[104:107]
    v_mfma_f32_16x16x32_bf16 v[104:107], v[184:187], v[164:167], v[104:107]
    v_mfma_f32_16x16x32_bf16 v[104:107], v[208:211], v[168:171], v[104:107]
    v_mfma_f32_16x16x32_bf16 v[104:107], v[232:235], v[172:175], v[104:107]
    v_mfma_f32_16x16x32_bf16 v[108:111], a[4:7], v[120:123], 0
    ds_read_b128 v[120:123], v4 offset:16384
    v_mfma_f32_16x16x32_bf16 v[108:111], a[28:31], v[124:127], v[108:111]
    ds_read_b128 v[124:127], v25 offset:16384
    v_mfma_f32_16x16x32_bf16 v[108:111], a[52:55], v[128:131], v[108:111]
    ds_read_b128 v[128:131], v4 offset:18432
    v_mfma_f32_16x16x32_bf16 v[108:111], a[76:79], v[132:135], v[108:111]
    ds_read_b128 v[132:135], v25 offset:18432
    v_mfma_f32_16x16x32_bf16 v[108:111], a[100:103], v[136:139], v[108:111]
    ds_read_b128 v[136:139], v4 offset:20480
    v_mfma_f32_16x16x32_bf16 v[108:111], a[124:127], v[140:143], v[108:111]
    ds_read_b128 v[140:143], v25 offset:20480
    v_mfma_f32_16x16x32_bf16 v[108:111], a[148:151], v[144:147], v[108:111]
    ds_read_b128 v[144:147], v4 offset:22528
    v_cvt_pk_bf16_f32 v64, v104, v105
    v_mfma_f32_16x16x32_bf16 v[108:111], a[172:175], v[148:151], v[108:111]
    ds_read_b128 v[148:151], v25 offset:22528
    v_cvt_pk_bf16_f32 v65, v106, v107
    v_mfma_f32_16x16x32_bf16 v[108:111], a[196:199], v[152:155], v[108:111]
    ds_read_b128 v[152:155], v4 offset:24576
    v_mfma_f32_16x16x32_bf16 v[108:111], a[220:223], v[156:159], v[108:111]
    ds_read_b128 v[156:159], v25 offset:24576
    v_mfma_f32_16x16x32_bf16 v[108:111], a[244:247], v[160:163], v[108:111]
    ds_read_b128 v[160:163], v4 offset:26624
    v_mfma_f32_16x16x32_bf16 v[108:111], v[188:191], v[164:167], v[108:111]
    ds_read_b128 v[164:167], v25 offset:26624
    v_mfma_f32_16x16x32_bf16 v[108:111], v[212:215], v[168:171], v[108:111]
    ds_read_b128 v[168:171], v4 offset:28672
    v_mfma_f32_16x16x32_bf16 v[108:111], v[236:239], v[172:175], v[108:111]
    ds_read_b128 v[172:175], v25 offset:28672
    s_waitcnt lgkmcnt(11)
    v_mfma_f32_16x16x32_bf16 v[112:115], a[8:11], v[120:123], 0
    v_mfma_f32_16x16x32_bf16 v[112:115], a[32:35], v[124:127], v[112:115]
    v_mfma_f32_16x16x32_bf16 v[112:115], a[56:59], v[128:131], v[112:115]
    s_waitcnt lgkmcnt(8)
    v_mfma_f32_16x16x32_bf16 v[112:115], a[80:83], v[132:135], v[112:115]
    v_mfma_f32_16x16x32_bf16 v[112:115], a[104:107], v[136:139], v[112:115]
    v_mfma_f32_16x16x32_bf16 v[112:115], a[128:131], v[140:143], v[112:115]
    s_waitcnt lgkmcnt(5)
    v_mfma_f32_16x16x32_bf16 v[112:115], a[152:155], v[144:147], v[112:115]
    v_cvt_pk_bf16_f32 v66, v108, v109
    v_cvt_pk_bf16_f32 v67, v110, v111
    v_mfma_f32_16x16x32_bf16 v[112:115], a[176:179], v[148:151], v[112:115]
    v_cndmask_b32 v66, v66, 0, s[82:83]
    v_cndmask_b32 v67, v67, 0, s[82:83]
    v_mfma_f32_16x16x32_bf16 v[112:115], a[200:203], v[152:155], v[112:115]
    s_waitcnt lgkmcnt(2)
    v_mfma_f32_16x16x32_bf16 v[112:115], a[224:227], v[156:159], v[112:115]
    v_mfma_f32_16x16x32_bf16 v[72:75], v[52:55], v[64:67], 0
    v_mfma_f32_16x16x32_bf16 v[112:115], a[248:251], v[160:163], v[112:115]
    v_mfma_f32_16x16x32_bf16 v[76:79], v[56:59], v[64:67], 0
    v_mfma_f32_16x16x32_bf16 v[112:115], v[192:195], v[164:167], v[112:115]
    s_waitcnt lgkmcnt(0)
    v_mfma_f32_16x16x32_bf16 v[112:115], v[216:219], v[168:171], v[112:115]
    v_mfma_f32_16x16x32_bf16 v[112:115], v[240:243], v[172:175], v[112:115]
    v_mfma_f32_16x16x32_bf16 v[116:119], a[12:15], v[120:123], 0
    v_mfma_f32_16x16x32_bf16 v[116:119], a[36:39], v[124:127], v[116:119]
    v_cndmask_b32 v26, v72, v73, s[76:77]
    v_cndmask_b32 v27, v74, v75, s[76:77]
    v_mfma_f32_16x16x32_bf16 v[116:119], a[60:63], v[128:131], v[116:119]
    v_cndmask_b32 v28, v76, v77, s[76:77]
    v_cndmask_b32 v29, v78, v79, s[76:77]
    v_mfma_f32_16x16x32_bf16 v[116:119], a[84:87], v[132:135], v[116:119]
    v_cndmask_b32 v26, v26, v28, s[78:79]
    v_cndmask_b32 v27, v27, v29, s[80:81]
    v_mfma_f32_16x16x32_bf16 v[116:119], a[108:111], v[136:139], v[116:119]
    v_max_f32 v28, v26, v27
    v_mov_b32 v29, v28
    v_mfma_f32_16x16x32_bf16 v[116:119], a[132:135], v[140:143], v[116:119]
    v_mfma_f32_16x16x32_bf16 v[116:119], a[156:159], v[144:147], v[116:119]
    v_cvt_pk_bf16_f32 v60, v112, v113
    v_cvt_pk_bf16_f32 v61, v114, v115
    v_mfma_f32_16x16x32_bf16 v[116:119], a[180:183], v[148:151], v[116:119]
    v_permlane16_swap_b32 v28, v29
    v_max_f32 v28, v28, v29
    v_mfma_f32_16x16x32_bf16 v[116:119], a[204:207], v[152:155], v[116:119]
    v_mov_b32 v29, v28
    v_mfma_f32_16x16x32_bf16 v[116:119], a[228:231], v[156:159], v[116:119]
    v_mfma_f32_16x16x32_bf16 v[116:119], a[252:255], v[160:163], v[116:119]
    v_permlane32_swap_b32 v28, v29
    v_max_f32 v28, v28, v29
    v_mfma_f32_16x16x32_bf16 v[116:119], v[196:199], v[164:167], v[116:119]
    v_sub_f32 v26, v26, v28
    v_sub_f32 v27, v27, v28
    v_mfma_f32_16x16x32_bf16 v[116:119], v[220:223], v[168:171], v[116:119]
    v_mul_f32 v26, s91, v26
    v_mul_f32 v27, s91, v27
    v_mfma_f32_16x16x32_bf16 v[116:119], v[244:247], v[172:175], v[116:119]
    v_exp_f32 v26, v26
    v_mfma_f32_16x16x32_bf16 v[96:99], v[120:123], a[16:19], 0
    v_exp_f32 v27, v27
    v_mfma_f32_16x16x32_bf16 v[96:99], v[124:127], a[40:43], v[96:99]
    v_add_f32 v28, v26, v27
    v_mov_b32 v29, v28
    v_mfma_f32_16x16x32_bf16 v[96:99], v[128:131], a[64:67], v[96:99]
    v_mfma_f32_16x16x32_bf16 v[96:99], v[132:135], a[88:91], v[96:99]
    v_permlane16_swap_b32 v28, v29
    v_add_f32 v28, v28, v29
    v_mfma_f32_16x16x32_bf16 v[96:99], v[136:139], a[112:115], v[96:99]
    v_mov_b32 v29, v28
    v_mfma_f32_16x16x32_bf16 v[96:99], v[140:143], a[136:139], v[96:99]
    v_mfma_f32_16x16x32_bf16 v[96:99], v[144:147], a[160:163], v[96:99]
    v_cvt_pk_bf16_f32 v62, v116, v117
    v_cvt_pk_bf16_f32 v63, v118, v119
    v_mfma_f32_16x16x32_bf16 v[96:99], v[148:151], a[184:187], v[96:99]
    v_cndmask_b32 v62, v62, 0, s[82:83]
    v_cndmask_b32 v63, v63, 0, s[82:83]
    v_mfma_f32_16x16x32_bf16 v[96:99], v[152:155], a[208:211], v[96:99]
    v_permlane32_swap_b32 v28, v29
    v_add_f32 v28, v28, v29
    v_mfma_f32_16x16x32_bf16 v[96:99], v[156:159], a[232:235], v[96:99]
    v_rcp_f32 v28, v28
    v_mfma_f32_16x16x32_bf16 v[96:99], v[160:163], v[176:179], v[96:99]
    v_mul_f32 v26, v26, v28
    v_mul_f32 v27, v27, v28
    v_mfma_f32_16x16x32_bf16 v[96:99], v[164:167], v[200:203], v[96:99]
    v_cvt_pk_bf16_f32 v26, v26, v26
    v_cvt_pk_bf16_f32 v27, v27, v27
    v_mfma_f32_16x16x32_bf16 v[96:99], v[168:171], v[224:227], v[96:99]
    v_and_b32 v80, v26, v14
    v_and_b32 v81, v27, v15
    v_mfma_f32_16x16x32_bf16 v[96:99], v[172:175], v[248:251], v[96:99]
    v_and_b32 v82, v26, v16
    v_and_b32 v83, v27, v17
    v_mfma_f32_16x16x32_bf16 v[100:103], v[120:123], a[20:23], 0
    v_mfma_f32_16x16x32_bf16 v[100:103], v[124:127], a[44:47], v[100:103]
    v_mfma_f32_16x16x32_bf16 v[72:75], v[38:41], v[80:83], 0
    v_mfma_f32_16x16x32_bf16 v[100:103], v[128:131], a[68:71], v[100:103]
    v_mfma_f32_16x16x32_bf16 v[76:79], v[48:51], v[80:83], 0
    v_mfma_f32_16x16x32_bf16 v[100:103], v[132:135], a[92:95], v[100:103]
    s_add_u32 s53, s74, 49152
    v_mfma_f32_16x16x32_bf16 v[100:103], v[136:139], a[116:119], v[100:103]
    v_mfma_f32_16x16x32_bf16 v[100:103], v[140:143], a[140:143], v[100:103]
    v_mfma_f32_16x16x32_bf16 v[100:103], v[144:147], a[164:167], v[100:103]
    v_cvt_pk_bf16_f32 v34, v96, v97
    v_cvt_pk_bf16_f32 v35, v98, v99
    v_mfma_f32_16x16x32_bf16 v[100:103], v[148:151], a[188:191], v[100:103]
    v_mfma_f32_16x16x32_bf16 v[100:103], v[152:155], a[212:215], v[100:103]
    v_cvt_pk_bf16_f32 v84, v72, v73
    v_cvt_pk_bf16_f32 v85, v74, v75
    v_mfma_f32_16x16x32_bf16 v[100:103], v[156:159], a[236:239], v[100:103]
    v_cvt_pk_bf16_f32 v86, v76, v77
    v_cvt_pk_bf16_f32 v87, v78, v79
    v_mfma_f32_16x16x32_bf16 v[100:103], v[160:163], v[180:183], v[100:103]
    v_cndmask_b32 v86, v86, 0, s[82:83]
    v_cndmask_b32 v87, v87, 0, s[82:83]
    v_mfma_f32_16x16x32_bf16 v[100:103], v[164:167], v[204:207], v[100:103]
    buffer_store_dwordx4 v[84:87], v23, s[24:27], s53 offen sc1
    v_mfma_f32_16x16x32_bf16 v[100:103], v[168:171], v[228:231], v[100:103]
    v_mfma_f32_16x16x32_bf16 v[100:103], v[172:175], v[252:255], v[100:103]
    v_mfma_f32_16x16x32_bf16 v[104:107], a[0:3], v[120:123], 0
    v_mfma_f32_16x16x32_bf16 v[104:107], a[24:27], v[124:127], v[104:107]
    v_mfma_f32_16x16x32_bf16 v[104:107], a[48:51], v[128:131], v[104:107]
    v_mfma_f32_16x16x32_bf16 v[104:107], a[72:75], v[132:135], v[104:107]
    v_mfma_f32_16x16x32_bf16 v[104:107], a[96:99], v[136:139], v[104:107]
    v_mfma_f32_16x16x32_bf16 v[104:107], a[120:123], v[140:143], v[104:107]
    v_mfma_f32_16x16x32_bf16 v[104:107], a[144:147], v[144:147], v[104:107]
    s_nop 0
    v_cvt_pk_bf16_f32 v44, v100, v101
    v_cvt_pk_bf16_f32 v45, v102, v103
    v_mfma_f32_16x16x32_bf16 v[104:107], a[168:171], v[148:151], v[104:107]
    v_mfma_f32_16x16x32_bf16 v[104:107], a[192:195], v[152:155], v[104:107]
    v_mfma_f32_16x16x32_bf16 v[104:107], a[216:219], v[156:159], v[104:107]
    v_mfma_f32_16x16x32_bf16 v[104:107], a[240:243], v[160:163], v[104:107]
    v_mfma_f32_16x16x32_bf16 v[104:107], v[184:187], v[164:167], v[104:107]
    v_mfma_f32_16x16x32_bf16 v[104:107], v[208:211], v[168:171], v[104:107]
    v_mfma_f32_16x16x32_bf16 v[104:107], v[232:235], v[172:175], v[104:107]
    v_mfma_f32_16x16x32_bf16 v[108:111], a[4:7], v[120:123], 0
    ds_read_b128 v[120:123], v4 offset:32768
    v_mfma_f32_16x16x32_bf16 v[108:111], a[28:31], v[124:127], v[108:111]
    ds_read_b128 v[124:127], v25 offset:32768
    v_mfma_f32_16x16x32_bf16 v[108:111], a[52:55], v[128:131], v[108:111]
    ds_read_b128 v[128:131], v4 offset:34816
    v_mfma_f32_16x16x32_bf16 v[108:111], a[76:79], v[132:135], v[108:111]
    ds_read_b128 v[132:135], v25 offset:34816
    v_mfma_f32_16x16x32_bf16 v[108:111], a[100:103], v[136:139], v[108:111]
    ds_read_b128 v[136:139], v4 offset:36864
    v_mfma_f32_16x16x32_bf16 v[108:111], a[124:127], v[140:143], v[108:111]
    ds_read_b128 v[140:143], v25 offset:36864
    v_mfma_f32_16x16x32_bf16 v[108:111], a[148:151], v[144:147], v[108:111]
    ds_read_b128 v[144:147], v4 offset:38912
    v_cvt_pk_bf16_f32 v68, v104, v105
    v_mfma_f32_16x16x32_bf16 v[108:111], a[172:175], v[148:151], v[108:111]
    ds_read_b128 v[148:151], v25 offset:38912
    v_cvt_pk_bf16_f32 v69, v106, v107
    v_mfma_f32_16x16x32_bf16 v[108:111], a[196:199], v[152:155], v[108:111]
    ds_read_b128 v[152:155], v4 offset:40960
    v_mfma_f32_16x16x32_bf16 v[108:111], a[220:223], v[156:159], v[108:111]
    ds_read_b128 v[156:159], v25 offset:40960
    v_mfma_f32_16x16x32_bf16 v[108:111], a[244:247], v[160:163], v[108:111]
    ds_read_b128 v[160:163], v4 offset:43008
    v_mfma_f32_16x16x32_bf16 v[108:111], v[188:191], v[164:167], v[108:111]
    ds_read_b128 v[164:167], v25 offset:43008
    v_mfma_f32_16x16x32_bf16 v[108:111], v[212:215], v[168:171], v[108:111]
    ds_read_b128 v[168:171], v4 offset:45056
    v_mfma_f32_16x16x32_bf16 v[108:111], v[236:239], v[172:175], v[108:111]
    ds_read_b128 v[172:175], v25 offset:45056
    s_waitcnt lgkmcnt(11)
    v_mfma_f32_16x16x32_bf16 v[112:115], a[8:11], v[120:123], 0
    v_mfma_f32_16x16x32_bf16 v[112:115], a[32:35], v[124:127], v[112:115]
    v_mfma_f32_16x16x32_bf16 v[112:115], a[56:59], v[128:131], v[112:115]
    s_waitcnt lgkmcnt(8)
    v_mfma_f32_16x16x32_bf16 v[112:115], a[80:83], v[132:135], v[112:115]
    v_mfma_f32_16x16x32_bf16 v[112:115], a[104:107], v[136:139], v[112:115]
    v_mfma_f32_16x16x32_bf16 v[112:115], a[128:131], v[140:143], v[112:115]
    s_waitcnt lgkmcnt(5)
    v_mfma_f32_16x16x32_bf16 v[112:115], a[152:155], v[144:147], v[112:115]
    v_cvt_pk_bf16_f32 v70, v108, v109
    v_cvt_pk_bf16_f32 v71, v110, v111
    v_mfma_f32_16x16x32_bf16 v[112:115], a[176:179], v[148:151], v[112:115]
    v_cndmask_b32 v70, v70, 0, s[82:83]
    v_cndmask_b32 v71, v71, 0, s[82:83]
    v_mfma_f32_16x16x32_bf16 v[112:115], a[200:203], v[152:155], v[112:115]
    s_waitcnt lgkmcnt(2)
    v_mfma_f32_16x16x32_bf16 v[112:115], a[224:227], v[156:159], v[112:115]
    v_mfma_f32_16x16x32_bf16 v[72:75], v[56:59], v[68:71], 0
    v_mfma_f32_16x16x32_bf16 v[112:115], a[248:251], v[160:163], v[112:115]
    v_mfma_f32_16x16x32_bf16 v[76:79], v[60:63], v[68:71], 0
    v_mfma_f32_16x16x32_bf16 v[112:115], v[192:195], v[164:167], v[112:115]
    s_waitcnt lgkmcnt(0)
    v_mfma_f32_16x16x32_bf16 v[112:115], v[216:219], v[168:171], v[112:115]
    v_mfma_f32_16x16x32_bf16 v[112:115], v[240:243], v[172:175], v[112:115]
    v_mfma_f32_16x16x32_bf16 v[116:119], a[12:15], v[120:123], 0
    v_mfma_f32_16x16x32_bf16 v[116:119], a[36:39], v[124:127], v[116:119]
    v_cndmask_b32 v26, v72, v73, s[76:77]
    v_cndmask_b32 v27, v74, v75, s[76:77]
    v_mfma_f32_16x16x32_bf16 v[116:119], a[60:63], v[128:131], v[116:119]
    v_cndmask_b32 v28, v76, v77, s[76:77]
    v_cndmask_b32 v29, v78, v79, s[76:77]
    v_mfma_f32_16x16x32_bf16 v[116:119], a[84:87], v[132:135], v[116:119]
    v_cndmask_b32 v26, v26, v28, s[78:79]
    v_cndmask_b32 v27, v27, v29, s[80:81]
    v_mfma_f32_16x16x32_bf16 v[116:119], a[108:111], v[136:139], v[116:119]
    v_max_f32 v28, v26, v27
    v_mov_b32 v29, v28
    v_mfma_f32_16x16x32_bf16 v[116:119], a[132:135], v[140:143], v[116:119]
    v_mfma_f32_16x16x32_bf16 v[116:119], a[156:159], v[144:147], v[116:119]
    v_cvt_pk_bf16_f32 v52, v112, v113
    v_cvt_pk_bf16_f32 v53, v114, v115
    v_mfma_f32_16x16x32_bf16 v[116:119], a[180:183], v[148:151], v[116:119]
    v_permlane16_swap_b32 v28, v29
    v_max_f32 v28, v28, v29
    v_mfma_f32_16x16x32_bf16 v[116:119], a[204:207], v[152:155], v[116:119]
    v_mov_b32 v29, v28
    v_mfma_f32_16x16x32_bf16 v[116:119], a[228:231], v[156:159], v[116:119]
    v_mfma_f32_16x16x32_bf16 v[116:119], a[252:255], v[160:163], v[116:119]
    v_permlane32_swap_b32 v28, v29
    v_max_f32 v28, v28, v29
    v_mfma_f32_16x16x32_bf16 v[116:119], v[196:199], v[164:167], v[116:119]
    v_sub_f32 v26, v26, v28
    v_sub_f32 v27, v27, v28
    v_mfma_f32_16x16x32_bf16 v[116:119], v[220:223], v[168:171], v[116:119]
    v_mul_f32 v26, s91, v26
    v_mul_f32 v27, s91, v27
    v_mfma_f32_16x16x32_bf16 v[116:119], v[244:247], v[172:175], v[116:119]
    v_exp_f32 v26, v26
    v_mfma_f32_16x16x32_bf16 v[96:99], v[120:123], a[16:19], 0
    v_exp_f32 v27, v27
    v_mfma_f32_16x16x32_bf16 v[96:99], v[124:127], a[40:43], v[96:99]
    v_add_f32 v28, v26, v27
    v_mov_b32 v29, v28
    v_mfma_f32_16x16x32_bf16 v[96:99], v[128:131], a[64:67], v[96:99]
    v_mfma_f32_16x16x32_bf16 v[96:99], v[132:135], a[88:91], v[96:99]
    v_permlane16_swap_b32 v28, v29
    v_add_f32 v28, v28, v29
    v_mfma_f32_16x16x32_bf16 v[96:99], v[136:139], a[112:115], v[96:99]
    v_mov_b32 v29, v28
    v_mfma_f32_16x16x32_bf16 v[96:99], v[140:143], a[136:139], v[96:99]
    v_mfma_f32_16x16x32_bf16 v[96:99], v[144:147], a[160:163], v[96:99]
    v_cvt_pk_bf16_f32 v54, v116, v117
    v_cvt_pk_bf16_f32 v55, v118, v119
    v_mfma_f32_16x16x32_bf16 v[96:99], v[148:151], a[184:187], v[96:99]
    v_cndmask_b32 v54, v54, 0, s[82:83]
    v_cndmask_b32 v55, v55, 0, s[82:83]
    v_mfma_f32_16x16x32_bf16 v[96:99], v[152:155], a[208:211], v[96:99]
    v_permlane32_swap_b32 v28, v29
    v_add_f32 v28, v28, v29
    v_mfma_f32_16x16x32_bf16 v[96:99], v[156:159], a[232:235], v[96:99]
    v_rcp_f32 v28, v28
    v_mfma_f32_16x16x32_bf16 v[96:99], v[160:163], v[176:179], v[96:99]
    v_mul_f32 v26, v26, v28
    v_mul_f32 v27, v27, v28
    v_mfma_f32_16x16x32_bf16 v[96:99], v[164:167], v[200:203], v[96:99]
    v_cvt_pk_bf16_f32 v26, v26, v26
    v_cvt_pk_bf16_f32 v27, v27, v27
    v_mfma_f32_16x16x32_bf16 v[96:99], v[168:171], v[224:227], v[96:99]
    v_and_b32 v80, v26, v14
    v_and_b32 v81, v27, v15
    v_mfma_f32_16x16x32_bf16 v[96:99], v[172:175], v[248:251], v[96:99]
    v_and_b32 v82, v26, v16
    v_and_b32 v83, v27, v17
    v_mfma_f32_16x16x32_bf16 v[100:103], v[120:123], a[20:23], 0
    v_mfma_f32_16x16x32_bf16 v[100:103], v[124:127], a[44:47], v[100:103]
    v_mfma_f32_16x16x32_bf16 v[72:75], v[32:35], v[80:83], 0
    v_mfma_f32_16x16x32_bf16 v[100:103], v[128:131], a[68:71], v[100:103]
    v_mfma_f32_16x16x32_bf16 v[76:79], v[42:45], v[80:83], 0
    v_mfma_f32_16x16x32_bf16 v[100:103], v[132:135], a[92:95], v[100:103]
    s_add_u32 s53, s74, 65536
    v_mfma_f32_16x16x32_bf16 v[100:103], v[136:139], a[116:119], v[100:103]
    v_mfma_f32_16x16x32_bf16 v[100:103], v[140:143], a[140:143], v[100:103]
    v_mfma_f32_16x16x32_bf16 v[100:103], v[144:147], a[164:167], v[100:103]
    v_cvt_pk_bf16_f32 v36, v96, v97
    v_cvt_pk_bf16_f32 v37, v98, v99
    v_mfma_f32_16x16x32_bf16 v[100:103], v[148:151], a[188:191], v[100:103]
    v_mfma_f32_16x16x32_bf16 v[100:103], v[152:155], a[212:215], v[100:103]
    v_cvt_pk_bf16_f32 v84, v72, v73
    v_cvt_pk_bf16_f32 v85, v74, v75
    v_mfma_f32_16x16x32_bf16 v[100:103], v[156:159], a[236:239], v[100:103]
    v_cvt_pk_bf16_f32 v86, v76, v77
    v_cvt_pk_bf16_f32 v87, v78, v79
    v_mfma_f32_16x16x32_bf16 v[100:103], v[160:163], v[180:183], v[100:103]
    v_cndmask_b32 v86, v86, 0, s[82:83]
    v_cndmask_b32 v87, v87, 0, s[82:83]
    v_mfma_f32_16x16x32_bf16 v[100:103], v[164:167], v[204:207], v[100:103]
    buffer_store_dwordx4 v[84:87], v23, s[24:27], s53 offen sc1
    v_mfma_f32_16x16x32_bf16 v[100:103], v[168:171], v[228:231], v[100:103]
    v_mfma_f32_16x16x32_bf16 v[100:103], v[172:175], v[252:255], v[100:103]
    v_mfma_f32_16x16x32_bf16 v[104:107], a[0:3], v[120:123], 0
    v_mfma_f32_16x16x32_bf16 v[104:107], a[24:27], v[124:127], v[104:107]
    v_mfma_f32_16x16x32_bf16 v[104:107], a[48:51], v[128:131], v[104:107]
    v_mfma_f32_16x16x32_bf16 v[104:107], a[72:75], v[132:135], v[104:107]
    v_mfma_f32_16x16x32_bf16 v[104:107], a[96:99], v[136:139], v[104:107]
    v_mfma_f32_16x16x32_bf16 v[104:107], a[120:123], v[140:143], v[104:107]
    v_mfma_f32_16x16x32_bf16 v[104:107], a[144:147], v[144:147], v[104:107]
    s_nop 0
    v_cvt_pk_bf16_f32 v46, v100, v101
    v_cvt_pk_bf16_f32 v47, v102, v103
    v_mfma_f32_16x16x32_bf16 v[104:107], a[168:171], v[148:151], v[104:107]
    v_mfma_f32_16x16x32_bf16 v[104:107], a[192:195], v[152:155], v[104:107]
    v_mfma_f32_16x16x32_bf16 v[104:107], a[216:219], v[156:159], v[104:107]
    v_mfma_f32_16x16x32_bf16 v[104:107], a[240:243], v[160:163], v[104:107]
    v_mfma_f32_16x16x32_bf16 v[104:107], v[184:187], v[164:167], v[104:107]
    v_mfma_f32_16x16x32_bf16 v[104:107], v[208:211], v[168:171], v[104:107]
    v_mfma_f32_16x16x32_bf16 v[104:107], v[232:235], v[172:175], v[104:107]
    s_waitcnt vmcnt(5)
    s_barrier
    v_mfma_f32_16x16x32_bf16 v[108:111], a[4:7], v[120:123], 0
    ds_read_b128 v[120:123], v4 offset:49152
    v_mfma_f32_16x16x32_bf16 v[108:111], a[28:31], v[124:127], v[108:111]
    ds_read_b128 v[124:127], v25 offset:49152
    v_mfma_f32_16x16x32_bf16 v[108:111], a[52:55], v[128:131], v[108:111]
    ds_read_b128 v[128:131], v4 offset:51200
    v_mfma_f32_16x16x32_bf16 v[108:111], a[76:79], v[132:135], v[108:111]
    ds_read_b128 v[132:135], v25 offset:51200
    v_mfma_f32_16x16x32_bf16 v[108:111], a[100:103], v[136:139], v[108:111]
    ds_read_b128 v[136:139], v4 offset:53248
    v_mfma_f32_16x16x32_bf16 v[108:111], a[124:127], v[140:143], v[108:111]
    ds_read_b128 v[140:143], v25 offset:53248
    v_mfma_f32_16x16x32_bf16 v[108:111], a[148:151], v[144:147], v[108:111]
    ds_read_b128 v[144:147], v4 offset:55296
    v_cvt_pk_bf16_f32 v64, v104, v105
    v_mfma_f32_16x16x32_bf16 v[108:111], a[172:175], v[148:151], v[108:111]
    ds_read_b128 v[148:151], v25 offset:55296
    v_cvt_pk_bf16_f32 v65, v106, v107
    v_mfma_f32_16x16x32_bf16 v[108:111], a[196:199], v[152:155], v[108:111]
    ds_read_b128 v[152:155], v4 offset:57344
    v_mfma_f32_16x16x32_bf16 v[108:111], a[220:223], v[156:159], v[108:111]
    ds_read_b128 v[156:159], v25 offset:57344
    v_mfma_f32_16x16x32_bf16 v[108:111], a[244:247], v[160:163], v[108:111]
    ds_read_b128 v[160:163], v4 offset:59392
    v_mfma_f32_16x16x32_bf16 v[108:111], v[188:191], v[164:167], v[108:111]
    ds_read_b128 v[164:167], v25 offset:59392
    v_mfma_f32_16x16x32_bf16 v[108:111], v[212:215], v[168:171], v[108:111]
    ds_read_b128 v[168:171], v4 offset:61440
    v_mfma_f32_16x16x32_bf16 v[108:111], v[236:239], v[172:175], v[108:111]
    ds_read_b128 v[172:175], v25 offset:61440
    s_waitcnt lgkmcnt(11)
    v_mfma_f32_16x16x32_bf16 v[112:115], a[8:11], v[120:123], 0
    v_mfma_f32_16x16x32_bf16 v[112:115], a[32:35], v[124:127], v[112:115]
    v_mfma_f32_16x16x32_bf16 v[112:115], a[56:59], v[128:131], v[112:115]
    s_waitcnt lgkmcnt(8)
    v_mfma_f32_16x16x32_bf16 v[112:115], a[80:83], v[132:135], v[112:115]
    v_mfma_f32_16x16x32_bf16 v[112:115], a[104:107], v[136:139], v[112:115]
    v_mfma_f32_16x16x32_bf16 v[112:115], a[128:131], v[140:143], v[112:115]
    s_waitcnt lgkmcnt(5)
    v_mfma_f32_16x16x32_bf16 v[112:115], a[152:155], v[144:147], v[112:115]
    v_cvt_pk_bf16_f32 v66, v108, v109
    v_cvt_pk_bf16_f32 v67, v110, v111
    v_mfma_f32_16x16x32_bf16 v[112:115], a[176:179], v[148:151], v[112:115]
    v_cndmask_b32 v66, v66, 0, s[82:83]
    v_cndmask_b32 v67, v67, 0, s[82:83]
    v_mfma_f32_16x16x32_bf16 v[112:115], a[200:203], v[152:155], v[112:115]
    s_waitcnt lgkmcnt(2)
    v_mfma_f32_16x16x32_bf16 v[112:115], a[224:227], v[156:159], v[112:115]
    v_mfma_f32_16x16x32_bf16 v[72:75], v[60:63], v[64:67], 0
    v_mfma_f32_16x16x32_bf16 v[112:115], a[248:251], v[160:163], v[112:115]
    v_mfma_f32_16x16x32_bf16 v[76:79], v[52:55], v[64:67], 0
    v_mfma_f32_16x16x32_bf16 v[112:115], v[192:195], v[164:167], v[112:115]
    s_waitcnt lgkmcnt(0)
    v_mfma_f32_16x16x32_bf16 v[112:115], v[216:219], v[168:171], v[112:115]
    v_mfma_f32_16x16x32_bf16 v[112:115], v[240:243], v[172:175], v[112:115]
    v_mfma_f32_16x16x32_bf16 v[116:119], a[12:15], v[120:123], 0
    v_mfma_f32_16x16x32_bf16 v[116:119], a[36:39], v[124:127], v[116:119]
    v_cndmask_b32 v26, v72, v73, s[76:77]
    v_cndmask_b32 v27, v74, v75, s[76:77]
    v_mfma_f32_16x16x32_bf16 v[116:119], a[60:63], v[128:131], v[116:119]
    v_cndmask_b32 v28, v76, v77, s[76:77]
    v_cndmask_b32 v29, v78, v79, s[76:77]
    v_mfma_f32_16x16x32_bf16 v[116:119], a[84:87], v[132:135], v[116:119]
    v_cndmask_b32 v26, v26, v28, s[78:79]
    v_cndmask_b32 v27, v27, v29, s[80:81]
    v_mfma_f32_16x16x32_bf16 v[116:119], a[108:111], v[136:139], v[116:119]
    v_max_f32 v28, v26, v27
    v_mov_b32 v29, v28
    v_mfma_f32_16x16x32_bf16 v[116:119], a[132:135], v[140:143], v[116:119]
    v_mfma_f32_16x16x32_bf16 v[116:119], a[156:159], v[144:147], v[116:119]
    v_cvt_pk_bf16_f32 v56, v112, v113
    v_cvt_pk_bf16_f32 v57, v114, v115
    v_mfma_f32_16x16x32_bf16 v[116:119], a[180:183], v[148:151], v[116:119]
    v_permlane16_swap_b32 v28, v29
    v_max_f32 v28, v28, v29
    v_mfma_f32_16x16x32_bf16 v[116:119], a[204:207], v[152:155], v[116:119]
    v_mov_b32 v29, v28
    v_mfma_f32_16x16x32_bf16 v[116:119], a[228:231], v[156:159], v[116:119]
    v_mfma_f32_16x16x32_bf16 v[116:119], a[252:255], v[160:163], v[116:119]
    v_permlane32_swap_b32 v28, v29
    v_max_f32 v28, v28, v29
    v_mfma_f32_16x16x32_bf16 v[116:119], v[196:199], v[164:167], v[116:119]
    v_sub_f32 v26, v26, v28
    v_sub_f32 v27, v27, v28
    v_mfma_f32_16x16x32_bf16 v[116:119], v[220:223], v[168:171], v[116:119]
    v_mul_f32 v26, s91, v26
    v_mul_f32 v27, s91, v27
    v_mfma_f32_16x16x32_bf16 v[116:119], v[244:247], v[172:175], v[116:119]
    v_exp_f32 v26, v26
    v_mfma_f32_16x16x32_bf16 v[96:99], v[120:123], a[16:19], 0
    v_exp_f32 v27, v27
    v_mfma_f32_16x16x32_bf16 v[96:99], v[124:127], a[40:43], v[96:99]
    v_add_f32 v28, v26, v27
    v_mov_b32 v29, v28
    v_mfma_f32_16x16x32_bf16 v[96:99], v[128:131], a[64:67], v[96:99]
    v_mfma_f32_16x16x32_bf16 v[96:99], v[132:135], a[88:91], v[96:99]
    v_permlane16_swap_b32 v28, v29
    v_add_f32 v28, v28, v29
    v_mfma_f32_16x16x32_bf16 v[96:99], v[136:139], a[112:115], v[96:99]
    v_mov_b32 v29, v28
    v_mfma_f32_16x16x32_bf16 v[96:99], v[140:143], a[136:139], v[96:99]
    v_mfma_f32_16x16x32_bf16 v[96:99], v[144:147], a[160:163], v[96:99]
    v_cvt_pk_bf16_f32 v58, v116, v117
    v_cvt_pk_bf16_f32 v59, v118, v119
    v_mfma_f32_16x16x32_bf16 v[96:99], v[148:151], a[184:187], v[96:99]
    v_cndmask_b32 v58, v58, 0, s[82:83]
    v_cndmask_b32 v59, v59, 0, s[82:83]
    v_mfma_f32_16x16x32_bf16 v[96:99], v[152:155], a[208:211], v[96:99]
    v_permlane32_swap_b32 v28, v29
    v_add_f32 v28, v28, v29
    v_mfma_f32_16x16x32_bf16 v[96:99], v[156:159], a[232:235], v[96:99]
    v_rcp_f32 v28, v28
    v_mfma_f32_16x16x32_bf16 v[96:99], v[160:163], v[176:179], v[96:99]
    v_mul_f32 v26, v26, v28
    v_mul_f32 v27, v27, v28
    v_mfma_f32_16x16x32_bf16 v[96:99], v[164:167], v[200:203], v[96:99]
    v_cvt_pk_bf16_f32 v26, v26, v26
    v_cvt_pk_bf16_f32 v27, v27, v27
    v_mfma_f32_16x16x32_bf16 v[96:99], v[168:171], v[224:227], v[96:99]
    v_and_b32 v80, v26, v14
    v_and_b32 v81, v27, v15
    v_mfma_f32_16x16x32_bf16 v[96:99], v[172:175], v[248:251], v[96:99]
    v_and_b32 v82, v26, v16
    v_and_b32 v83, v27, v17
    v_mfma_f32_16x16x32_bf16 v[100:103], v[120:123], a[20:23], 0
    v_mfma_f32_16x16x32_bf16 v[100:103], v[124:127], a[44:47], v[100:103]
    v_mfma_f32_16x16x32_bf16 v[72:75], v[34:37], v[80:83], 0
    v_mfma_f32_16x16x32_bf16 v[100:103], v[128:131], a[68:71], v[100:103]
    v_mfma_f32_16x16x32_bf16 v[76:79], v[44:47], v[80:83], 0
    v_mfma_f32_16x16x32_bf16 v[100:103], v[132:135], a[92:95], v[100:103]
    s_add_u32 s53, s74, 81920
    v_mfma_f32_16x16x32_bf16 v[100:103], v[136:139], a[116:119], v[100:103]
    v_mfma_f32_16x16x32_bf16 v[100:103], v[140:143], a[140:143], v[100:103]
    v_mfma_f32_16x16x32_bf16 v[100:103], v[144:147], a[164:167], v[100:103]
    v_cvt_pk_bf16_f32 v38, v96, v97
    v_cvt_pk_bf16_f32 v39, v98, v99
    v_mfma_f32_16x16x32_bf16 v[100:103], v[148:151], a[188:191], v[100:103]
    v_mfma_f32_16x16x32_bf16 v[100:103], v[152:155], a[212:215], v[100:103]
    v_cvt_pk_bf16_f32 v84, v72, v73
    v_cvt_pk_bf16_f32 v85, v74, v75
    v_mfma_f32_16x16x32_bf16 v[100:103], v[156:159], a[236:239], v[100:103]
    v_cvt_pk_bf16_f32 v86, v76, v77
    v_cvt_pk_bf16_f32 v87, v78, v79
    v_mfma_f32_16x16x32_bf16 v[100:103], v[160:163], v[180:183], v[100:103]
    v_cndmask_b32 v86, v86, 0, s[82:83]
    v_cndmask_b32 v87, v87, 0, s[82:83]
    v_mfma_f32_16x16x32_bf16 v[100:103], v[164:167], v[204:207], v[100:103]
    buffer_store_dwordx4 v[84:87], v23, s[24:27], s53 offen sc1
    v_mfma_f32_16x16x32_bf16 v[100:103], v[168:171], v[228:231], v[100:103]
    v_mfma_f32_16x16x32_bf16 v[100:103], v[172:175], v[252:255], v[100:103]
    v_mfma_f32_16x16x32_bf16 v[104:107], a[0:3], v[120:123], 0
    v_mfma_f32_16x16x32_bf16 v[104:107], a[24:27], v[124:127], v[104:107]
    v_mfma_f32_16x16x32_bf16 v[104:107], a[48:51], v[128:131], v[104:107]
    v_mfma_f32_16x16x32_bf16 v[104:107], a[72:75], v[132:135], v[104:107]
    v_mfma_f32_16x16x32_bf16 v[104:107], a[96:99], v[136:139], v[104:107]
    v_mfma_f32_16x16x32_bf16 v[104:107], a[120:123], v[140:143], v[104:107]
    v_mfma_f32_16x16x32_bf16 v[104:107], a[144:147], v[144:147], v[104:107]
    s_nop 0
    v_cvt_pk_bf16_f32 v48, v100, v101
    v_cvt_pk_bf16_f32 v49, v102, v103
    v_mfma_f32_16x16x32_bf16 v[104:107], a[168:171], v[148:151], v[104:107]
    v_mfma_f32_16x16x32_bf16 v[104:107], a[192:195], v[152:155], v[104:107]
    v_mfma_f32_16x16x32_bf16 v[104:107], a[216:219], v[156:159], v[104:107]
    v_mfma_f32_16x16x32_bf16 v[104:107], a[240:243], v[160:163], v[104:107]
    v_mfma_f32_16x16x32_bf16 v[104:107], v[184:187], v[164:167], v[104:107]
    v_mfma_f32_16x16x32_bf16 v[104:107], v[208:211], v[168:171], v[104:107]
    v_mfma_f32_16x16x32_bf16 v[104:107], v[232:235], v[172:175], v[104:107]
    v_mfma_f32_16x16x32_bf16 v[108:111], a[4:7], v[120:123], 0
    v_add_u32 v4, 65536, v4
    v_add_u32 v25, 65536, v25
    ds_read_b128 v[120:123], v4 offset:0
    v_mfma_f32_16x16x32_bf16 v[108:111], a[28:31], v[124:127], v[108:111]
    ds_read_b128 v[124:127], v25 offset:0
    v_mfma_f32_16x16x32_bf16 v[108:111], a[52:55], v[128:131], v[108:111]
    ds_read_b128 v[128:131], v4 offset:2048
    v_mfma_f32_16x16x32_bf16 v[108:111], a[76:79], v[132:135], v[108:111]
    ds_read_b128 v[132:135], v25 offset:2048
    v_mfma_f32_16x16x32_bf16 v[108:111], a[100:103], v[136:139], v[108:111]
    ds_read_b128 v[136:139], v4 offset:4096
    v_mfma_f32_16x16x32_bf16 v[108:111], a[124:127], v[140:143], v[108:111]
    ds_read_b128 v[140:143], v25 offset:4096
    v_mfma_f32_16x16x32_bf16 v[108:111], a[148:151], v[144:147], v[108:111]
    ds_read_b128 v[144:147], v4 offset:6144
    v_cvt_pk_bf16_f32 v68, v104, v105
    v_mfma_f32_16x16x32_bf16 v[108:111], a[172:175], v[148:151], v[108:111]
    ds_read_b128 v[148:151], v25 offset:6144
    v_cvt_pk_bf16_f32 v69, v106, v107
    v_mfma_f32_16x16x32_bf16 v[108:111], a[196:199], v[152:155], v[108:111]
    ds_read_b128 v[152:155], v4 offset:8192
    v_mfma_f32_16x16x32_bf16 v[108:111], a[220:223], v[156:159], v[108:111]
    ds_read_b128 v[156:159], v25 offset:8192
    v_mfma_f32_16x16x32_bf16 v[108:111], a[244:247], v[160:163], v[108:111]
    ds_read_b128 v[160:163], v4 offset:10240
    v_mfma_f32_16x16x32_bf16 v[108:111], v[188:191], v[164:167], v[108:111]
    ds_read_b128 v[164:167], v25 offset:10240
    v_mfma_f32_16x16x32_bf16 v[108:111], v[212:215], v[168:171], v[108:111]
    ds_read_b128 v[168:171], v4 offset:12288
    v_mfma_f32_16x16x32_bf16 v[108:111], v[236:239], v[172:175], v[108:111]
    ds_read_b128 v[172:175], v25 offset:12288
    s_waitcnt lgkmcnt(11)
    v_mfma_f32_16x16x32_bf16 v[112:115], a[0:3], v[120:123], 0
    v_mfma_f32_16x16x32_bf16 v[112:115], a[24:27], v[124:127], v[112:115]
    v_mfma_f32_16x16x32_bf16 v[112:115], a[48:51], v[128:131], v[112:115]
    s_waitcnt lgkmcnt(8)
    v_mfma_f32_16x16x32_bf16 v[112:115], a[72:75], v[132:135], v[112:115]
    v_mfma_f32_16x16x32_bf16 v[112:115], a[96:99], v[136:139], v[112:115]
    v_mfma_f32_16x16x32_bf16 v[112:115], a[120:123], v[140:143], v[112:115]
    s_waitcnt lgkmcnt(5)
    v_mfma_f32_16x16x32_bf16 v[112:115], a[144:147], v[144:147], v[112:115]
    v_cvt_pk_bf16_f32 v70, v108, v109
    v_cvt_pk_bf16_f32 v71, v110, v111
    v_mfma_f32_16x16x32_bf16 v[112:115], a[168:171], v[148:151], v[112:115]
    v_cndmask_b32 v70, v70, 0, s[82:83]
    v_cndmask_b32 v71, v71, 0, s[82:83]
    v_mfma_f32_16x16x32_bf16 v[112:115], a[192:195], v[152:155], v[112:115]
    s_waitcnt lgkmcnt(2)
    v_mfma_f32_16x16x32_bf16 v[112:115], a[216:219], v[156:159], v[112:115]
    v_mfma_f32_16x16x32_bf16 v[72:75], v[52:55], v[68:71], 0
    v_mfma_f32_16x16x32_bf16 v[112:115], a[240:243], v[160:163], v[112:115]
    v_mfma_f32_16x16x32_bf16 v[76:79], v[56:59], v[68:71], 0
    v_mfma_f32_16x16x32_bf16 v[112:115], v[184:187], v[164:167], v[112:115]
    s_waitcnt lgkmcnt(0)
    v_mfma_f32_16x16x32_bf16 v[112:115], v[208:211], v[168:171], v[112:115]
    v_mfma_f32_16x16x32_bf16 v[112:115], v[232:235], v[172:175], v[112:115]
    v_mfma_f32_16x16x32_bf16 v[116:119], a[4:7], v[120:123], 0
    v_mfma_f32_16x16x32_bf16 v[116:119], a[28:31], v[124:127], v[116:119]
    v_cndmask_b32 v26, v72, v73, s[76:77]
    v_cndmask_b32 v27, v74, v75, s[76:77]
    v_mfma_f32_16x16x32_bf16 v[116:119], a[52:55], v[128:131], v[116:119]
    v_cndmask_b32 v28, v76, v77, s[76:77]
    v_cndmask_b32 v29, v78, v79, s[76:77]
    v_mfma_f32_16x16x32_bf16 v[116:119], a[76:79], v[132:135], v[116:119]
    v_cndmask_b32 v26, v26, v28, s[78:79]
    v_cndmask_b32 v27, v27, v29, s[80:81]
    v_mfma_f32_16x16x32_bf16 v[116:119], a[100:103], v[136:139], v[116:119]
    v_max_f32 v28, v26, v27
    v_mov_b32 v29, v28
    v_mfma_f32_16x16x32_bf16 v[116:119], a[124:127], v[140:143], v[116:119]
    v_mfma_f32_16x16x32_bf16 v[116:119], a[148:151], v[144:147], v[116:119]
    v_cvt_pk_bf16_f32 v64, v112, v113
    v_cvt_pk_bf16_f32 v65, v114, v115
    v_mfma_f32_16x16x32_bf16 v[116:119], a[172:175], v[148:151], v[116:119]
    v_permlane16_swap_b32 v28, v29
    v_max_f32 v28, v28, v29
    v_mfma_f32_16x16x32_bf16 v[116:119], a[196:199], v[152:155], v[116:119]
    v_mov_b32 v29, v28
    v_mfma_f32_16x16x32_bf16 v[116:119], a[220:223], v[156:159], v[116:119]
    v_mfma_f32_16x16x32_bf16 v[116:119], a[244:247], v[160:163], v[116:119]
    v_permlane32_swap_b32 v28, v29
    v_max_f32 v28, v28, v29
    v_mfma_f32_16x16x32_bf16 v[116:119], v[188:191], v[164:167], v[116:119]
    v_sub_f32 v26, v26, v28
    v_sub_f32 v27, v27, v28
    v_mfma_f32_16x16x32_bf16 v[116:119], v[212:215], v[168:171], v[116:119]
    v_mul_f32 v26, s91, v26
    v_mul_f32 v27, s91, v27
    v_mfma_f32_16x16x32_bf16 v[116:119], v[236:239], v[172:175], v[116:119]
    v_exp_f32 v26, v26
    v_mfma_f32_16x16x32_bf16 v[96:99], a[8:11], v[120:123], 0
    v_exp_f32 v27, v27
    v_mfma_f32_16x16x32_bf16 v[96:99], a[32:35], v[124:127], v[96:99]
    v_add_f32 v28, v26, v27
    v_mov_b32 v29, v28
    v_mfma_f32_16x16x32_bf16 v[96:99], a[56:59], v[128:131], v[96:99]
    v_mfma_f32_16x16x32_bf16 v[96:99], a[80:83], v[132:135], v[96:99]
    v_permlane16_swap_b32 v28, v29
    v_add_f32 v28, v28, v29
    v_mfma_f32_16x16x32_bf16 v[96:99], a[104:107], v[136:139], v[96:99]
    v_mov_b32 v29, v28
    v_mfma_f32_16x16x32_bf16 v[96:99], a[128:131], v[140:143], v[96:99]
    v_mfma_f32_16x16x32_bf16 v[96:99], a[152:155], v[144:147], v[96:99]
    v_cvt_pk_bf16_f32 v66, v116, v117
    v_cvt_pk_bf16_f32 v67, v118, v119
    v_mfma_f32_16x16x32_bf16 v[96:99], a[176:179], v[148:151], v[96:99]
    v_cndmask_b32 v66, v66, 0, s[82:83]
    v_cndmask_b32 v67, v67, 0, s[82:83]
    v_mfma_f32_16x16x32_bf16 v[96:99], a[200:203], v[152:155], v[96:99]
    v_permlane32_swap_b32 v28, v29
    v_add_f32 v28, v28, v29
    v_mfma_f32_16x16x32_bf16 v[96:99], a[224:227], v[156:159], v[96:99]
    v_rcp_f32 v28, v28
    v_mfma_f32_16x16x32_bf16 v[96:99], a[248:251], v[160:163], v[96:99]
    v_mul_f32 v26, v26, v28
    v_mul_f32 v27, v27, v28
    v_mfma_f32_16x16x32_bf16 v[96:99], v[192:195], v[164:167], v[96:99]
    v_cvt_pk_bf16_f32 v26, v26, v26
    v_cvt_pk_bf16_f32 v27, v27, v27
    v_mfma_f32_16x16x32_bf16 v[96:99], v[216:219], v[168:171], v[96:99]
    v_and_b32 v80, v26, v14
    v_and_b32 v81, v27, v15
    v_mfma_f32_16x16x32_bf16 v[96:99], v[240:243], v[172:175], v[96:99]
    v_and_b32 v82, v26, v16
    v_and_b32 v83, v27, v17
    v_mfma_f32_16x16x32_bf16 v[100:103], a[12:15], v[120:123], 0
    v_mfma_f32_16x16x32_bf16 v[100:103], a[36:39], v[124:127], v[100:103]
    v_mfma_f32_16x16x32_bf16 v[72:75], v[36:39], v[80:83], 0
    v_mfma_f32_16x16x32_bf16 v[100:103], a[60:63], v[128:131], v[100:103]
    v_mfma_f32_16x16x32_bf16 v[76:79], v[46:49], v[80:83], 0
    v_mfma_f32_16x16x32_bf16 v[100:103], a[84:87], v[132:135], v[100:103]
    s_add_u32 s53, s74, 98304
    v_mfma_f32_16x16x32_bf16 v[100:103], a[108:111], v[136:139], v[100:103]
    v_mfma_f32_16x16x32_bf16 v[100:103], a[132:135], v[140:143], v[100:103]
    v_mfma_f32_16x16x32_bf16 v[100:103], a[156:159], v[144:147], v[100:103]
    v_cvt_pk_bf16_f32 v60, v96, v97
    v_cvt_pk_bf16_f32 v61, v98, v99
    v_mfma_f32_16x16x32_bf16 v[100:103], a[180:183], v[148:151], v[100:103]
    v_mfma_f32_16x16x32_bf16 v[100:103], a[204:207], v[152:155], v[100:103]
    v_cvt_pk_bf16_f32 v84, v72, v73
    v_cvt_pk_bf16_f32 v85, v74, v75
    v_mfma_f32_16x16x32_bf16 v[100:103], a[228:231], v[156:159], v[100:103]
    v_cvt_pk_bf16_f32 v86, v76, v77
    v_cvt_pk_bf16_f32 v87, v78, v79
    v_mfma_f32_16x16x32_bf16 v[100:103], a[252:255], v[160:163], v[100:103]
    v_cndmask_b32 v86, v86, 0, s[82:83]
    v_cndmask_b32 v87, v87, 0, s[82:83]
    v_mfma_f32_16x16x32_bf16 v[100:103], v[196:199], v[164:167], v[100:103]
    buffer_store_dwordx4 v[84:87], v23, s[24:27], s53 offen sc1
    v_mfma_f32_16x16x32_bf16 v[100:103], v[220:223], v[168:171], v[100:103]
    v_mfma_f32_16x16x32_bf16 v[100:103], v[244:247], v[172:175], v[100:103]
    v_mfma_f32_16x16x32_bf16 v[104:107], v[120:123], a[16:19], 0
    v_mfma_f32_16x16x32_bf16 v[104:107], v[124:127], a[40:43], v[104:107]
    v_mfma_f32_16x16x32_bf16 v[104:107], v[128:131], a[64:67], v[104:107]
    v_mfma_f32_16x16x32_bf16 v[104:107], v[132:135], a[88:91], v[104:107]
    v_mfma_f32_16x16x32_bf16 v[104:107], v[136:139], a[112:115], v[104:107]
    v_mfma_f32_16x16x32_bf16 v[104:107], v[140:143], a[136:139], v[104:107]
    v_mfma_f32_16x16x32_bf16 v[104:107], v[144:147], a[160:163], v[104:107]
    s_nop 0
    v_cvt_pk_bf16_f32 v62, v100, v101
    v_cvt_pk_bf16_f32 v63, v102, v103
    v_mfma_f32_16x16x32_bf16 v[104:107], v[148:151], a[184:187], v[104:107]
    v_cndmask_b32 v62, v62, 0, s[82:83]
    v_cndmask_b32 v63, v63, 0, s[82:83]
    v_mfma_f32_16x16x32_bf16 v[104:107], v[152:155], a[208:211], v[104:107]
    v_mfma_f32_16x16x32_bf16 v[104:107], v[156:159], a[232:235], v[104:107]
    v_mfma_f32_16x16x32_bf16 v[72:75], v[56:59], v[64:67], 0
    v_mfma_f32_16x16x32_bf16 v[104:107], v[160:163], v[176:179], v[104:107]
    v_mfma_f32_16x16x32_bf16 v[76:79], v[60:63], v[64:67], 0
    v_mfma_f32_16x16x32_bf16 v[104:107], v[164:167], v[200:203], v[104:107]
    v_mfma_f32_16x16x32_bf16 v[104:107], v[168:171], v[224:227], v[104:107]
    v_mfma_f32_16x16x32_bf16 v[104:107], v[172:175], v[248:251], v[104:107]
    v_mfma_f32_16x16x32_bf16 v[108:111], v[120:123], a[20:23], 0
    v_mfma_f32_16x16x32_bf16 v[108:111], v[124:127], a[44:47], v[108:111]
    s_nop 0
    v_cndmask_b32 v26, v72, v73, s[76:77]
    v_cndmask_b32 v27, v74, v75, s[76:77]
    v_mfma_f32_16x16x32_bf16 v[108:111], v[128:131], a[68:71], v[108:111]
    v_cndmask_b32 v28, v76, v77, s[76:77]
    v_cndmask_b32 v29, v78, v79, s[76:77]
    v_mfma_f32_16x16x32_bf16 v[108:111], v[132:135], a[92:95], v[108:111]
    v_cndmask_b32 v26, v26, v28, s[78:79]
    v_cndmask_b32 v27, v27, v29, s[80:81]
    v_mfma_f32_16x16x32_bf16 v[108:111], v[136:139], a[116:119], v[108:111]
    v_max_f32 v28, v26, v27
    v_mov_b32 v29, v28
    v_mfma_f32_16x16x32_bf16 v[108:111], v[140:143], a[140:143], v[108:111]
    v_mfma_f32_16x16x32_bf16 v[108:111], v[144:147], a[164:167], v[108:111]
    v_cvt_pk_bf16_f32 v40, v104, v105
    v_cvt_pk_bf16_f32 v41, v106, v107
    v_mfma_f32_16x16x32_bf16 v[108:111], v[148:151], a[188:191], v[108:111]
    v_permlane16_swap_b32 v28, v29
    v_max_f32 v28, v28, v29
    v_mfma_f32_16x16x32_bf16 v[108:111], v[152:155], a[212:215], v[108:111]
    v_mov_b32 v29, v28
    v_mfma_f32_16x16x32_bf16 v[108:111], v[156:159], a[236:239], v[108:111]
    v_mfma_f32_16x16x32_bf16 v[108:111], v[160:163], v[180:183], v[108:111]
    v_permlane32_swap_b32 v28, v29
    v_max_f32 v28, v28, v29
    v_mfma_f32_16x16x32_bf16 v[108:111], v[164:167], v[204:207], v[108:111]
    v_sub_f32 v26, v26, v28
    v_sub_f32 v27, v27, v28
    v_mfma_f32_16x16x32_bf16 v[108:111], v[168:171], v[228:231], v[108:111]
    v_mul_f32 v26, s91, v26
    v_mul_f32 v27, s91, v27
    v_mfma_f32_16x16x32_bf16 v[108:111], v[172:175], v[252:255], v[108:111]
    v_exp_f32 v26, v26
    s_nop 6
    v_cvt_pk_bf16_f32 v50, v108, v109
    v_cvt_pk_bf16_f32 v51, v110, v111
    v_exp_f32 v27, v27
    s_nop 0
    v_add_f32 v28, v26, v27
    v_mov_b32 v29, v28
    s_nop 1
    v_permlane16_swap_b32 v28, v29
    v_add_f32 v28, v28, v29
    v_mov_b32 v29, v28
    s_nop 1
    v_permlane32_swap_b32 v28, v29
    v_add_f32 v28, v28, v29
    v_rcp_f32 v28, v28
    s_nop 0
    v_mul_f32 v26, v26, v28
    v_mul_f32 v27, v27, v28
    v_cvt_pk_bf16_f32 v26, v26, v26
    v_cvt_pk_bf16_f32 v27, v27, v27
    v_and_b32 v80, v26, v14
    v_and_b32 v81, v27, v15
    v_and_b32 v82, v26, v16
    v_and_b32 v83, v27, v17
    s_nop 1
    v_mfma_f32_16x16x32_bf16 v[72:75], v[38:41], v[80:83], 0
    v_mfma_f32_16x16x32_bf16 v[76:79], v[48:51], v[80:83], 0
    s_add_u32 s53, s74, 114688
    s_nop 5
    v_cvt_pk_bf16_f32 v84, v72, v73
    v_cvt_pk_bf16_f32 v85, v74, v75
    v_cvt_pk_bf16_f32 v86, v76, v77
    v_cvt_pk_bf16_f32 v87, v78, v79
    v_cndmask_b32 v86, v86, 0, s[82:83]
    v_cndmask_b32 v87, v87, 0, s[82:83]
    buffer_store_dwordx4 v[84:87], v23, s[24:27], s53 offen sc1
    s_waitcnt vmcnt(0) lgkmcnt(0)
    s_barrier
    s_cmp_lg_u32 s44, 0
    s_cbranch_scc1 L_nopub16
    s_lshl_b32 s60, s48, 4
    s_add_u32 s60, s60, s49
    s_lshl_b32 s60, s60, 7
    s_add_u32 s60, s60, 12779520
    v_mov_b32 v30, s47
    s_mov_b64 exec, 1
    buffer_store_dword v30, off, s[24:27], s60 sc1
    s_mov_b64 exec, -1
L_nopub16:
    s_endpgm
L_codeend:
.section .rodata,"a"
.p2align 6
.amdhsa_kernel parallel_sum__sliding_local_dilated__mixer_token_mlp__prompt_kernel
  .amdhsa_next_free_vgpr 512
  .amdhsa_next_free_sgpr 102
  .amdhsa_accum_offset 256
  .amdhsa_group_segment_fixed_size 0
  .amdhsa_kernarg_size 88
  .amdhsa_user_sgpr_count 2
  .amdhsa_user_sgpr_kernarg_segment_ptr 1
  .amdhsa_system_sgpr_workgroup_id_x 1
  .amdhsa_float_denorm_mode_32 3
.end_amdhsa_kernel
```

```asm
; @launch grid=(256,1,1) block=(256,1,1) lds=163840
.amdgcn_target "amdgcn-amd-amdhsa--gfx950"
.text
.globl parallel_sum__sliding_local_dilated__mixer_token_mlp__prompt_kernel
.p2align 8
.type parallel_sum__sliding_local_dilated__mixer_token_mlp__prompt_kernel,@function
parallel_sum__sliding_local_dilated__mixer_token_mlp__prompt_kernel:
    s_cmp_ge_u32 s2, 256
    s_cbranch_scc1 L_end
    s_load_dwordx2 s[4:5], s[0:1], 0
    s_load_dwordx16 s[76:91], s[0:1], 0
    s_load_dwordx4 s[92:95], s[0:1], 64
    s_load_dwordx2 s[24:25], s[0:1], 80
    s_lshr_b32 s46, s2, 3
    s_getpc_b64 s[98:99]
L_pc:
    s_mul_i32 s53, s46, 1408
    v_lshrrev_b32 v26, 4, v0
    v_min_u32 v26, 10, v26
    v_lshl_add_u32 v26, v26, 7, s53
    v_lshrrev_b32 v25, 5, v0
    v_min_u32 v26, L_codeend-L_pc-4, v26
    v_mov_b32 v29, s99
    v_add_co_u32 v28, vcc, s98, v26
    s_nop 1
    v_addc_co_u32 v29, vcc, 0, v29, vcc
    global_load_dword v108, v[28:29], off
    v_and_b32 v26, 31, v0
    v_mul_u32_u24 v24, 896, v25
    v_lshl_add_u32 v24, v26, 4, v24
    s_mul_i32 s53, s2, 7168
    v_add_u32 v24, s53, v24
    v_cmp_gt_u32 vcc, 28, v26
    v_mov_b32 v27, 2130706432
    s_mov_b32 s6, 1835008
    s_mov_b32 s7, 0x20000
    v_cndmask_b32 v24, v27, v24, vcc
    v_lshrrev_b32 v27, 6, v0
    v_and_b32 v1, 63, v0
    s_waitcnt lgkmcnt(0)
    buffer_load_dwordx4 v[32:35], v24, s[4:7], 0 offen
    buffer_load_dwordx4 v[36:39], v24, s[4:7], 0 offen offset:448
    v_readfirstlane_b32 s44, v27
    s_and_b32 s45, s2, 7
    s_mov_b64 s[8:9], s[78:79]
    s_mov_b32 s10, 1204224
    s_mov_b32 s11, s7
    s_lshr_b32 s53, s45, 1
    s_add_u32 s54, s53, 1
    s_bfe_u32 s54, s54, 0x10001
    s_add_u32 s54, s54, 1
    s_mul_i32 s53, s53, 224
    s_andn2_b32 s53, s53, 127
    s_sub_u32 s55, s46, 3
    s_cmp_lt_u32 s46, 24
    s_cselect_b32 s55, 31, s55
    s_cmp_lt_u32 s46, 21
    s_cselect_b32 s55, s46, s55
    s_mul_i32 s55, s55, 43008
    s_add_u32 s53, s53, s55
    v_and_b32 v27, 3, v0
    v_min_u32 v27, s54, v27
    v_bfe_u32 v28, v0, 2, 2
    v_min_u32 v28, 2, v28
    v_mul_u32_u24 v28, 7, v28
    v_add_u32 v27, v27, v28
    v_lshrrev_b32 v28, 4, v0
    v_min_u32 v28, 15, v28
    v_mul_u32_u24 v28, 21, v28
    v_add_lshl_u32 v27, v27, v28, 7
    buffer_load_dword v108, v27, s[8:11], s53 offen
    s_mov_b64 s[40:41], s[94:95]
    s_mov_b32 s42, 256
    s_mov_b32 s43, s7
    s_or_b32 s53, s2, s44
    s_cbranch_scc1 L_nononce
    s_memrealtime s[98:99]
    s_waitcnt lgkmcnt(0)
    s_or_b32 s98, s98, 1
    v_mov_b32 v28, s98
    s_mov_b64 exec, 1
    buffer_store_dword v28, off, s[40:43], 0 sc1
    s_mov_b64 exec, -1
L_nononce:
    s_mov_b64 s[16:17], s[84:85]
    s_mov_b32 s18, 7340032
    s_mov_b32 s19, s7
    s_mov_b32 s26, 16777216
    s_mov_b32 s27, s7
    s_mov_b64 s[20:21], s[88:89]
    s_mov_b32 s22, 7340032
    s_mov_b32 s23, s7
    s_mov_b64 s[12:13], s[80:81]
    s_mov_b32 s14, 401408
    s_mov_b32 s15, s7
    v_lshrrev_b32 v27, 4, v0
    v_min_u32 v27, 12, v27
    v_lshlrev_b32 v27, 7, v27
    s_mul_i32 s53, s2, 1664
    buffer_load_dword v108, v27, s[12:15], s53 offen
    s_mov_b64 s[28:29], s[92:93]
    s_mov_b32 s30, 1835008
    s_mov_b32 s31, s7
    s_mov_b64 s[32:33], s[86:87]
    s_mov_b32 s34, 3584
    s_mov_b32 s35, s7
    s_mov_b64 s[36:37], s[90:91]
    s_mov_b32 s38, 4096
    s_mov_b32 s39, s7
    s_lshl_b32 s52, s44, 12
    v_lshlrev_b32 v23, 4, v1
    s_cmp_ge_u32 s46, 24
    s_cbranch_scc1 L_role_a
    v_lshrrev_b32 v208, 4, v1
    v_bfe_u32 v209, v1, 2, 2
    v_and_b32 v210, 3, v1
    v_and_b32 v211, 15, v1
    v_lshrrev_b32 v212, 5, v1
    s_mul_i32 s55, s45, 3
    s_max_u32 s55, s55, 1
    s_add_u32 s55, s55, s46
    s_sub_u32 s55, s55, 1
    s_sub_u32 s56, s55, 21
    s_min_u32 s55, s55, s56
    s_and_b32 s54, s45, 1
    s_mul_i32 s54, s54, 24
    s_sub_u32 s54, s46, s54
    s_cmp_ge_u32 s46, 21
    s_cselect_b32 s54, s54, s55
    s_mul_i32 s53, s45, 21
    s_add_u32 s53, s53, s54
    s_mul_i32 s50, s53, 171
    s_lshr_b32 s50, s50, 10
    s_mul_i32 s54, s50, 6
    s_sub_u32 s88, s53, s54
    s_mul_i32 s51, s50, 2
    s_add_u32 s51, s51, s88
    s_mul_i32 s54, s51, 43
    s_lshr_b32 s54, s54, 8
    s_mul_i32 s54, s54, 6
    s_sub_u32 s51, s51, s54
    s_mul_i32 s65, s51, 13
    s_add_u32 s65, s65, 2
    s_mul_i32 s65, s65, 171
    s_lshr_b32 s65, s65, 10
    v_lshl_add_u32 v213, v212, 2, v209
    v_and_b32 v215, 1, v208
    v_lshlrev_b32 v214, 4, v210
    v_lshl_add_u32 v214, v215, 6, v214
    s_mul_i32 s53, s44, 1835008
    s_lshl_b32 s54, s50, 7
    s_add_u32 s53, s53, s54
    v_mul_u32_u24 v10, 3584, v213
    v_add3_u32 v10, v10, v214, s53
    v_xor_b32 v11, 32, v10
    s_cmp_ge_u32 s46, 21
    s_cbranch_scc1 L_help
    s_add_u32 m0, s52, 49152
    s_add_u32 s57, s65, 0
    s_sub_u32 s3, s57, 13
    s_min_u32 s57, s57, s3
    s_mul_i32 s57, s57, 114688
    buffer_load_dwordx4 v10, s[16:19], s57 offen offset:0 lds
    s_add_u32 s57, s57, 27648
    buffer_load_dwordx4 v11, s[16:19], s57 offen offset:1024 lds
    v_mul_u32_u24 v109, 960, v25
    v_lshl_add_u32 v109, v26, 4, v109
    v_mul_u32_u24 v110, 960, v209
    v_lshl_add_u32 v110, v208, 5, v110
    v_lshl_add_u32 v110, v210, 3, v110
    s_lshl_b32 s53, s44, 7
    v_add_u32 v110, s53, v110
    v_mul_u32_u24 v111, 66816, v208
    v_lshl_add_u32 v111, v211, 4, v111
    s_mul_i32 s63, s44, 267264
    s_lshl_b32 s53, s2, 8
    s_add_u32 s63, s63, s53
    s_add_u32 s64, s63, 1069056
    s_cmp_eq_u32 s44, 3
    s_cselect_b32 s64, 2130706432, s64
    s_mov_b32 s62, 0x3f803f80
    s_mov_b32 s61, 0xffff0000
    s_mov_b32 s66, 6291456
    v_mov_b32 v96, 0
    v_mov_b32 v97, 0
    v_lshlrev_b32 v216, 6, v209
    v_lshl_add_u32 v216, v210, 3, v216
    v_lshl_add_u32 v216, v215, 5, v216
    s_add_u32 s53, s52, 49152
    v_lshl_add_u32 v2, v208, 10, v216
    v_add_u32 v2, s53, v2
    v_xor_b32 v3, 32, v2
    v_add_u32 v4, 65536, v2
    v_add_u32 v5, 65536, v3
    v_lshl_add_u32 v6, v208, 9, v216
    v_add_u32 v6, s53, v6
    v_xor_b32 v7, 32, v6
    v_add_u32 v8, 65536, v6
    v_add_u32 v9, 65536, v7
    s_waitcnt vmcnt(5)
    v_dot2c_f32_bf16 v96, s62, v32
    v_dot2c_f32_bf16 v97, v32, v32
    v_lshlrev_b32 v40, 16, v32
    v_and_b32 v41, s61, v32
    v_dot2c_f32_bf16 v96, s62, v33
    v_dot2c_f32_bf16 v97, v33, v33
    v_lshlrev_b32 v42, 16, v33
    v_and_b32 v43, s61, v33
    v_dot2c_f32_bf16 v96, s62, v34
    v_dot2c_f32_bf16 v97, v34, v34
    v_lshlrev_b32 v44, 16, v34
    v_and_b32 v45, s61, v34
    v_dot2c_f32_bf16 v96, s62, v35
    v_dot2c_f32_bf16 v97, v35, v35
    v_lshlrev_b32 v46, 16, v35
    v_and_b32 v47, s61, v35
    s_waitcnt vmcnt(4)
    v_dot2c_f32_bf16 v96, s62, v36
    v_dot2c_f32_bf16 v97, v36, v36
    v_lshlrev_b32 v48, 16, v36
    v_and_b32 v49, s61, v36
    v_dot2c_f32_bf16 v96, s62, v37
    v_dot2c_f32_bf16 v97, v37, v37
    v_lshlrev_b32 v50, 16, v37
    v_and_b32 v51, s61, v37
    v_dot2c_f32_bf16 v96, s62, v38
    v_dot2c_f32_bf16 v97, v38, v38
    v_lshlrev_b32 v52, 16, v38
    v_and_b32 v53, s61, v38
    v_dot2c_f32_bf16 v96, s62, v39
    v_dot2c_f32_bf16 v97, v39, v39
    v_lshlrev_b32 v54, 16, v39
    v_and_b32 v55, s61, v39
    buffer_load_dword v29, off, s[40:43], 0 sc1
    v_add_f32_dpp v96, v96, v96 quad_perm:[1,0,3,2] row_mask:0xf bank_mask:0xf
    v_add_f32_dpp v97, v97, v97 quad_perm:[1,0,3,2] row_mask:0xf bank_mask:0xf
    s_nop 0
    v_add_f32_dpp v96, v96, v96 quad_perm:[2,3,0,1] row_mask:0xf bank_mask:0xf
    v_add_f32_dpp v97, v97, v97 quad_perm:[2,3,0,1] row_mask:0xf bank_mask:0xf
    s_nop 0
    v_add_f32_dpp v96, v96, v96 row_half_mirror row_mask:0xf bank_mask:0xf
    v_add_f32_dpp v97, v97, v97 row_half_mirror row_mask:0xf bank_mask:0xf
    s_nop 0
    v_add_f32_dpp v96, v96, v96 row_mirror row_mask:0xf bank_mask:0xf
    v_add_f32_dpp v97, v97, v97 row_mirror row_mask:0xf bank_mask:0xf
    v_mov_b32 v98, v96
    v_mov_b32 v99, v97
    s_nop 0
    v_permlane16_swap_b32 v96, v98
    v_permlane16_swap_b32 v97, v99
    v_add_f32 v96, v96, v98
    v_add_f32 v97, v97, v99
    v_mul_f32 v98, 0x3b124925, v96
    v_mul_f32 v99, 0x3b124925, v97
    v_fma_f32 v99, -v98, v98, v99
    v_max_f32 v99, 0, v99
    v_cvt_pk_bf16_f32 v100, 0, v99
    v_add_f32 v100, 0x3727c5ac, v100
    v_cvt_pk_bf16_f32 v100, 0, v100
    v_sqrt_f32 v100, v100
    s_nop 0
    v_cvt_pk_bf16_f32 v100, 0, v100
    v_rcp_f32 v100, v100
    s_nop 0
    v_mul_f32 v99, v99, v100
    v_mul_f32 v102, v98, v100
    v_mul_f32 v99, v99, v100
    v_cvt_pk_bf16_f32 v104, 0, v99
    v_add_f32 v104, 0x3727c5ac, v104
    v_cvt_pk_bf16_f32 v104, 0, v104
    v_sqrt_f32 v104, v104
    s_nop 0
    v_cvt_pk_bf16_f32 v104, 0, v104
    v_rcp_f32 v104, v104
    s_nop 0
    v_mul_f32 v104, v104, v100
    v_mul_f32 v106, v98, v104
    v_pk_fma_f32 v[56:57], v[40:41], v[104:105], v[106:107] op_sel_hi:[1,0,0] neg_lo:[0,0,1] neg_hi:[0,0,1]
    v_pk_fma_f32 v[58:59], v[42:43], v[104:105], v[106:107] op_sel_hi:[1,0,0] neg_lo:[0,0,1] neg_hi:[0,0,1]
    v_pk_fma_f32 v[60:61], v[44:45], v[104:105], v[106:107] op_sel_hi:[1,0,0] neg_lo:[0,0,1] neg_hi:[0,0,1]
    v_pk_fma_f32 v[62:63], v[46:47], v[104:105], v[106:107] op_sel_hi:[1,0,0] neg_lo:[0,0,1] neg_hi:[0,0,1]
    v_pk_fma_f32 v[64:65], v[48:49], v[104:105], v[106:107] op_sel_hi:[1,0,0] neg_lo:[0,0,1] neg_hi:[0,0,1]
    v_pk_fma_f32 v[66:67], v[50:51], v[104:105], v[106:107] op_sel_hi:[1,0,0] neg_lo:[0,0,1] neg_hi:[0,0,1]
    v_pk_fma_f32 v[68:69], v[52:53], v[104:105], v[106:107] op_sel_hi:[1,0,0] neg_lo:[0,0,1] neg_hi:[0,0,1]
    v_pk_fma_f32 v[70:71], v[54:55], v[104:105], v[106:107] op_sel_hi:[1,0,0] neg_lo:[0,0,1] neg_hi:[0,0,1]
    v_cvt_pk_bf16_f32 v80, v56, v57
    v_cvt_pk_bf16_f32 v81, v58, v59
    v_cvt_pk_bf16_f32 v82, v60, v61
    v_cvt_pk_bf16_f32 v83, v62, v63
    v_cvt_pk_bf16_f32 v84, v64, v65
    v_cvt_pk_bf16_f32 v85, v66, v67
    v_cvt_pk_bf16_f32 v86, v68, v69
    v_cvt_pk_bf16_f32 v87, v70, v71
    ds_write_b128 v109, v[80:83] offset:0
    ds_write_b128 v109, v[84:87] offset:448
    v_pk_fma_f32 v[40:41], v[40:41], v[100:101], v[102:103] op_sel_hi:[1,0,0] neg_lo:[0,0,1] neg_hi:[0,0,1]
    v_pk_fma_f32 v[42:43], v[42:43], v[100:101], v[102:103] op_sel_hi:[1,0,0] neg_lo:[0,0,1] neg_hi:[0,0,1]
    v_pk_fma_f32 v[44:45], v[44:45], v[100:101], v[102:103] op_sel_hi:[1,0,0] neg_lo:[0,0,1] neg_hi:[0,0,1]
    v_pk_fma_f32 v[46:47], v[46:47], v[100:101], v[102:103] op_sel_hi:[1,0,0] neg_lo:[0,0,1] neg_hi:[0,0,1]
    v_pk_fma_f32 v[48:49], v[48:49], v[100:101], v[102:103] op_sel_hi:[1,0,0] neg_lo:[0,0,1] neg_hi:[0,0,1]
    v_pk_fma_f32 v[50:51], v[50:51], v[100:101], v[102:103] op_sel_hi:[1,0,0] neg_lo:[0,0,1] neg_hi:[0,0,1]
    v_pk_fma_f32 v[52:53], v[52:53], v[100:101], v[102:103] op_sel_hi:[1,0,0] neg_lo:[0,0,1] neg_hi:[0,0,1]
    v_pk_fma_f32 v[54:55], v[54:55], v[100:101], v[102:103] op_sel_hi:[1,0,0] neg_lo:[0,0,1] neg_hi:[0,0,1]
    v_cvt_pk_bf16_f32 v72, v40, v41
    v_cvt_pk_bf16_f32 v73, v42, v43
    v_cvt_pk_bf16_f32 v74, v44, v45
    v_cvt_pk_bf16_f32 v75, v46, v47
    v_cvt_pk_bf16_f32 v76, v48, v49
    v_cvt_pk_bf16_f32 v77, v50, v51
    v_cvt_pk_bf16_f32 v78, v52, v53
    v_cvt_pk_bf16_f32 v79, v54, v55
    s_waitcnt lgkmcnt(0)
    s_barrier
    ds_read_b64_tr_b16 v[88:89], v110 offset:0
    ds_read_b64_tr_b16 v[90:91], v110 offset:3840
    ds_read_b64_tr_b16 v[92:93], v110 offset:512
    ds_read_b64_tr_b16 v[94:95], v110 offset:4352
    buffer_store_dwordx4 v[72:75], v24, s[24:27], s66 offen offset:0 sc1
    buffer_store_dwordx4 v[76:79], v24, s[24:27], s66 offen offset:448 sc1
    s_waitcnt lgkmcnt(2)
    buffer_store_dwordx4 v[88:91], v111, s[24:27], s63 offen sc1
    s_waitcnt lgkmcnt(0)
    buffer_store_dwordx4 v[92:95], v111, s[24:27], s64 offen sc1
    s_add_u32 s57, s57, 27648
    buffer_load_dwordx4 v10, s[16:19], s57 offen offset:2048 lds
    s_add_u32 s57, s57, 27648
    buffer_load_dwordx4 v11, s[16:19], s57 offen offset:3072 lds
    s_add_u32 m0, s52, 65536
    s_add_u32 s57, s65, 1
    s_sub_u32 s3, s57, 13
    s_min_u32 s57, s57, s3
    s_mul_i32 s57, s57, 114688
    buffer_load_dwordx4 v10, s[16:19], s57 offen offset:0 lds
    s_add_u32 s57, s57, 27648
    buffer_load_dwordx4 v11, s[16:19], s57 offen offset:1024 lds
    s_add_u32 s57, s57, 27648
    buffer_load_dwordx4 v10, s[16:19], s57 offen offset:2048 lds
    s_add_u32 s57, s57, 27648
    buffer_load_dwordx4 v11, s[16:19], s57 offen offset:3072 lds
    s_waitcnt vmcnt(6)
    v_cmp_eq_u32 vcc, 0, v29
    s_nop 0
    s_cbranch_vccz L_ok2
    s_mov_b32 s59, 20000
L_spin1:
    s_sleep 2
    buffer_load_dword v29, off, s[40:43], 0 sc1
    s_waitcnt vmcnt(0)
    v_cmp_eq_u32 vcc, 0, v29
    s_nop 0
    s_cbranch_vccz L_ok2
    s_sub_u32 s59, s59, 1
    s_cbranch_scc0 L_spin1
L_ok2:
    v_readfirstlane_b32 s47, v29
    s_barrier
    s_cmp_lg_u32 s44, 0
    s_cbranch_scc1 L_nopub3
    s_lshl_b32 s60, s2, 5
    s_add_u32 s60, s60, 12582912
    v_mov_b32 v30, s47
    s_mov_b64 exec, 1
    buffer_store_dword v30, off, s[24:27], s60 sc1
    s_mov_b64 exec, -1
L_nopub3:
    s_lshl_b32 s53, s44, 11
    s_add_u32 s53, s53, 12582912
    v_lshl_add_u32 v18, v1, 5, s53
    s_lshl_b32 s53, s50, 7
    s_add_u32 m0, s52, 81920
    s_add_u32 s57, s65, 2
    s_sub_u32 s3, s57, 13
    s_min_u32 s57, s57, s3
    s_mul_i32 s57, s57, 114688
    buffer_load_dwordx4 v10, s[16:19], s57 offen offset:0 lds
    v_lshl_add_u32 v19, v208, 3, s53
    s_lshl2_add_u32 s67, s51, s44
    s_mul_i32 s67, s67, 58624
    s_lshl_b32 s53, s50, 11
    s_add_u32 s57, s57, 27648
    buffer_load_dwordx4 v11, s[16:19], s57 offen offset:1024 lds
    s_add_u32 s67, s67, s53
    s_add_u32 s67, s67, 2097152
    v_mov_b32 v236, 0xbdd2d3e8
    v_mov_b32 v237, 0xc0135761
    s_add_u32 s57, s57, 27648
    buffer_load_dwordx4 v10, s[16:19], s57 offen offset:2048 lds
    s_add_u32 s54, s88, 24
    s_mul_i32 s84, s54, 66816
    s_lshl2_add_u32 s84, s52, s84
    s_mul_i32 s83, s54, 58624
    s_add_u32 s83, s83, s53
    s_and_b32 s54, s44, 1
    s_lshl_b32 s54, s54, 10
    s_add_u32 s83, s83, s54
    s_add_u32 s57, s57, 27648
    buffer_load_dwordx4 v11, s[16:19], s57 offen offset:3072 lds
    s_add_u32 s83, s83, 2097152
    s_lshl1_add_u32 s54, s54, 49152
    v_add_u32 v243, s54, v23
    s_add_u32 m0, s52, 98304
    s_add_u32 s57, s65, 3
    s_sub_u32 s3, s57, 13
    s_min_u32 s57, s57, s3
    s_mul_i32 s57, s57, 114688
    buffer_load_dwordx4 v10, s[16:19], s57 offen offset:0 lds
    s_cmp_lt_u32 s88, 4
    s_cselect_b32 s84, s84, 2130706432
    s_cselect_b32 s83, s83, 2130706432
    s_cmp_lt_u32 s44, 2
    s_cselect_b32 s83, s83, 2130706432
    s_cmp_eq_u32 s44, 0
    s_cselect_b32 s85, 1.0, 0
    s_mul_i32 s53, s45, 7
    s_lshr_b32 s53, s53, 1
    s_sub_u32 s53, s50, s53
    s_lshl1_add_u32 s53, s53, s88
    s_sub_u32 s53, s53, 4
    s_mul_i32 s54, s44, 28
    s_add_u32 s54, s54, s53
    s_lshl_b32 s87, s54, 16
    s_lshl_b32 s54, s45, 9
    s_add_u32 s87, s87, s54
    s_cmp_ge_u32 s88, 4
    s_cselect_b32 s87, s87, 2130706432
    v_lshrrev_b32 v254, 2, v1
    v_lshlrev_b32 v254, 12, v254
    v_lshl_add_u32 v254, v210, 7, v254
    s_add_u32 s57, s57, 27648
    buffer_load_dwordx4 v11, s[16:19], s57 offen offset:1024 lds
    s_waitcnt vmcnt(10)
    ds_read_b64_tr_b16 a[0:1], v2 offset:0
    ds_read_b64_tr_b16 a[2:3], v2 offset:512
    ds_read_b64_tr_b16 a[4:5], v3 offset:0
    ds_read_b64_tr_b16 a[6:7], v3 offset:512
    s_add_u32 s57, s57, 27648
    buffer_load_dwordx4 v10, s[16:19], s57 offen offset:2048 lds
    ds_read_b64_tr_b16 a[8:9], v2 offset:256
    ds_read_b64_tr_b16 a[10:11], v2 offset:768
    ds_read_b64_tr_b16 a[12:13], v3 offset:256
    ds_read_b64_tr_b16 a[14:15], v3 offset:768
    s_add_u32 s57, s57, 27648
    buffer_load_dwordx4 v11, s[16:19], s57 offen offset:3072 lds
    s_lshr_b32 s53, s46, 2
    s_and_b32 s89, s46, 3
    s_bfe_u32 s54, s46, 0x20001
    s_and_b32 s55, s46, 1
    s_add_u32 s55, s55, 4
    s_cmp_lt_u32 s46, 16
    s_cselect_b32 s53, s53, s54
    s_cselect_b32 s89, s89, s55
    s_mul_i32 s49, s53, 2
    s_add_u32 s49, s49, s89
    s_sub_u32 s54, s49, 6
    s_min_u32 s49, s49, s54
    s_add_u32 m0, s52, 114688
    s_add_u32 s57, s65, 4
    s_sub_u32 s3, s57, 13
    s_min_u32 s57, s57, s3
    s_mul_i32 s57, s57, 114688
    buffer_load_dwordx4 v10, s[16:19], s57 offen offset:0 lds
    s_lshl2_add_u32 s48, s45, s53
    s_mul_i32 s53, s44, 1835008
    s_lshl_b32 s74, s48, 7
    s_add_u32 s53, s53, s74
    s_add_u32 s57, s57, 27648
    buffer_load_dwordx4 v11, s[16:19], s57 offen offset:1024 lds
    s_waitcnt vmcnt(10)
    ds_read_b64_tr_b16 a[16:17], v2 offset:16384
    ds_read_b64_tr_b16 a[18:19], v2 offset:16896
    ds_read_b64_tr_b16 a[20:21], v3 offset:16384
    ds_read_b64_tr_b16 a[22:23], v3 offset:16896
    s_add_u32 s57, s57, 27648
    buffer_load_dwordx4 v10, s[16:19], s57 offen offset:2048 lds
    ds_read_b64_tr_b16 a[24:25], v2 offset:16640
    ds_read_b64_tr_b16 a[26:27], v2 offset:17152
    ds_read_b64_tr_b16 a[28:29], v3 offset:16640
    ds_read_b64_tr_b16 a[30:31], v3 offset:17152
    s_lshl_b32 s56, s44, 5
    v_lshlrev_b32 v217, 5, v212
    v_xor_b32 v217, v217, v214
    v_xor_b32 v217, s56, v217
    s_add_u32 s57, s57, 27648
    buffer_load_dwordx4 v11, s[16:19], s57 offen offset:3072 lds
    s_add_u32 s74, s74, s56
    v_lshlrev_b32 v12, 12, v213
    v_add3_u32 v12, v12, v217, s53
    s_mul_i32 s53, s44, 100352
    s_add_u32 m0, s52, 131072
    s_add_u32 s57, s65, 5
    s_sub_u32 s3, s57, 13
    s_min_u32 s57, s57, s3
    s_mul_i32 s57, s57, 114688
    buffer_load_dwordx4 v10, s[16:19], s57 offen offset:0 lds
    s_lshl_b32 s54, s49, 7
    s_add_u32 s55, s53, s54
    v_mul_u32_u24 v13, 896, v213
    v_add3_u32 v13, v13, v214, s55
    s_add_u32 s57, s57, 27648
    buffer_load_dwordx4 v11, s[16:19], s57 offen offset:1024 lds
    s_waitcnt vmcnt(10)
    ds_read_b64_tr_b16 a[32:33], v2 offset:32768
    ds_read_b64_tr_b16 a[34:35], v2 offset:33280
    ds_read_b64_tr_b16 a[36:37], v3 offset:32768
    ds_read_b64_tr_b16 a[38:39], v3 offset:33280
    v_xor_b32 v14, 32, v13
    s_mul_i32 s73, s48, 57344
    s_add_u32 s71, s73, s54
    s_mul_i32 s55, s44, 14336
    ds_read_b64_tr_b16 a[40:41], v2 offset:33024
    ds_read_b64_tr_b16 a[42:43], v2 offset:33536
    ds_read_b64_tr_b16 a[44:45], v3 offset:33024
    ds_read_b64_tr_b16 a[46:47], v3 offset:33536
    s_add_u32 s57, s57, 27648
    buffer_load_dwordx4 v10, s[16:19], s57 offen offset:2048 lds
    s_add_u32 s71, s71, s55
    s_add_u32 s72, s71, 7168
    v_bfe_u32 v217, v1, 1, 2
    v_lshl_add_u32 v217, v212, 2, v217
    s_add_u32 s57, s57, 27648
    buffer_load_dwordx4 v11, s[16:19], s57 offen offset:3072 lds
    v_and_b32 v218, 24, v1
    v_add_u32 v217, v217, v218
    v_mul_u32_u24 v15, 896, v217
    v_and_b32 v217, 1, v1
    s_add_u32 m0, s52, 147456
    s_add_u32 s57, s65, 6
    s_sub_u32 s3, s57, 13
    s_min_u32 s57, s57, s3
    s_mul_i32 s57, s57, 114688
    buffer_load_dwordx4 v10, s[16:19], s57 offen offset:0 lds
    v_lshl_add_u32 v15, v217, 4, v15
    v_add_u32 v15, s53, v15
    s_lshl_b32 s54, s89, 5
    s_add_u32 s54, s54, 768
    s_add_u32 s68, s89, 24
    s_mul_i32 s68, s68, 58624
    s_mul_i32 s69, s44, 14336
    s_add_u32 s69, s69, 2097152
    s_add_u32 s57, s57, 27648
    buffer_load_dwordx4 v11, s[16:19], s57 offen offset:1024 lds
    s_waitcnt vmcnt(10)
    ds_read_b64_tr_b16 a[48:49], v2 offset:49152
    ds_read_b64_tr_b16 a[50:51], v2 offset:49664
    ds_read_b64_tr_b16 a[52:53], v3 offset:49152
    ds_read_b64_tr_b16 a[54:55], v3 offset:49664
    s_add_u32 s57, s57, 27648
    buffer_load_dwordx4 v10, s[16:19], s57 offen offset:2048 lds
    ds_read_b64_tr_b16 a[56:57], v2 offset:49408
    ds_read_b64_tr_b16 a[58:59], v2 offset:49920
    ds_read_b64_tr_b16 a[60:61], v3 offset:49408
    ds_read_b64_tr_b16 a[62:63], v3 offset:49920
    s_add_u32 s57, s57, 27648
    buffer_load_dwordx4 v11, s[16:19], s57 offen offset:3072 lds
    s_add_u32 s68, s68, s69
    s_mul_i32 s55, s49, 234496
    s_add_u32 s69, s69, s55
    s_add_u32 s73, s73, s54
    s_mov_b32 s76, 0
    s_add_u32 s77, s76, 2048
    s_cmp_eq_u32 s77, 14336
    s_cselect_b32 s77, 0, s77
    s_add_u32 s78, s77, 2048
    s_cmp_eq_u32 s78, 14336
    s_cselect_b32 s78, 0, s78
    s_add_u32 s79, s78, 2048
    s_cmp_eq_u32 s79, 14336
    s_cselect_b32 s79, 0, s79
    s_add_u32 s80, s79, 2048
    s_cmp_eq_u32 s80, 14336
    s_cselect_b32 s80, 0, s80
    s_add_u32 s81, s80, 2048
    s_cmp_eq_u32 s81, 14336
    s_cselect_b32 s81, 0, s81
    s_add_u32 s82, s81, 2048
    s_cmp_eq_u32 s82, 14336
    s_cselect_b32 s82, 0, s82
    s_waitcnt lgkmcnt(15)
    s_add_u32 m0, s52, 49152
    s_add_u32 s57, s65, 7
    s_sub_u32 s3, s57, 13
    s_min_u32 s57, s57, s3
    s_mul_i32 s57, s57, 114688
    buffer_load_dwordx4 v10, s[16:19], s57 offen offset:0 lds
    s_cmp_lt_u32 s89, 4
    s_cselect_b32 s75, s54, 2130706432
    s_cselect_b32 s68, s68, 2130706432
    s_cselect_b32 s73, s73, 2130706432
    s_add_u32 s57, s57, 27648
    buffer_load_dwordx4 v11, s[16:19], s57 offen offset:1024 lds
    s_waitcnt vmcnt(10)
    ds_read_b64_tr_b16 a[64:65], v4 offset:0
    ds_read_b64_tr_b16 a[66:67], v4 offset:512
    ds_read_b64_tr_b16 a[68:69], v5 offset:0
    ds_read_b64_tr_b16 a[70:71], v5 offset:512
    s_add_u32 s57, s57, 27648
    buffer_load_dwordx4 v10, s[16:19], s57 offen offset:2048 lds
    ds_read_b64_tr_b16 a[72:73], v4 offset:256
    ds_read_b64_tr_b16 a[74:75], v4 offset:768
    ds_read_b64_tr_b16 a[76:77], v5 offset:256
    ds_read_b64_tr_b16 a[78:79], v5 offset:768
    v_lshlrev_b32 v16, 3, v1
    v_add_u32 v16, 81920, v16
    v_and_b32 v217, 7, v1
    v_min_u32 v218, 6, v217
    s_add_u32 s57, s57, 27648
    buffer_load_dwordx4 v11, s[16:19], s57 offen offset:3072 lds
    s_mul_i32 s54, s44, 7
    v_add_u32 v218, s54, v218
    v_mul_u32_u24 v219, 2, v218
    v_add_u32 v219, s89, v219
    s_add_u32 m0, s52, 65536
    s_add_u32 s57, s65, 8
    s_sub_u32 s3, s57, 13
    s_min_u32 s57, s57, s3
    s_mul_i32 s57, s57, 114688
    buffer_load_dwordx4 v10, s[16:19], s57 offen offset:0 lds
    v_mul_u32_u24 v220, 43, v219
    v_lshrrev_b32 v220, 8, v220
    v_mul_u32_u24 v220, 6, v220
    v_sub_u32 v219, v219, v220
    s_add_u32 s57, s57, 27648
    buffer_load_dwordx4 v11, s[16:19], s57 offen offset:1024 lds
    s_waitcnt vmcnt(10)
    ds_read_b64_tr_b16 a[80:81], v4 offset:16384
    ds_read_b64_tr_b16 a[82:83], v4 offset:16896
    ds_read_b64_tr_b16 a[84:85], v5 offset:16384
    ds_read_b64_tr_b16 a[86:87], v5 offset:16896
    v_subrev_u32 v219, s49, v219
    v_bfe_u32 v220, v1, 3, 1
    v_mul_i32_i24 v219, v219, v220
    v_add_u32 v219, s49, v219
    ds_read_b64_tr_b16 a[88:89], v4 offset:16640
    ds_read_b64_tr_b16 a[90:91], v4 offset:17152
    ds_read_b64_tr_b16 a[92:93], v5 offset:16640
    ds_read_b64_tr_b16 a[94:95], v5 offset:17152
    s_add_u32 s57, s57, 27648
    buffer_load_dwordx4 v10, s[16:19], s57 offen offset:2048 lds
    v_lshl_add_u32 v218, v219, 5, v218
    v_lshlrev_b32 v20, 7, v218
    v_add_u32 v20, 12713984, v20
    s_lshr_b32 s53, s48, 1
    s_add_u32 s57, s57, 27648
    buffer_load_dwordx4 v11, s[16:19], s57 offen offset:3072 lds
    s_lshl_b32 s53, s53, 7
    s_add_u32 s53, s53, 12779520
    v_lshl_add_u32 v21, v210, 11, s53
    s_lshl_b32 s70, s48, 16
    s_waitcnt lgkmcnt(15)
    s_add_u32 m0, s52, 81920
    s_add_u32 s57, s65, 9
    s_sub_u32 s3, s57, 13
    s_min_u32 s57, s57, s3
    s_mul_i32 s57, s57, 114688
    buffer_load_dwordx4 v10, s[16:19], s57 offen offset:0 lds
    s_lshl2_add_u32 s70, s52, s70
    s_add_u32 s70, s70, 4194304
    v_lshrrev_b32 v218, 3, v1
    v_mul_u32_u24 v22, 896, v218
    v_lshl_add_u32 v22, v217, 4, v22
    v_lshlrev_b32 v25, 1, v211
    s_add_u32 s53, s52, 65536
    v_lshl_add_u32 v244, v218, 8, s53
    s_add_u32 s57, s57, 27648
    buffer_load_dwordx4 v11, s[16:19], s57 offen offset:1024 lds
    s_waitcnt vmcnt(10)
    ds_read_b64_tr_b16 a[96:97], v4 offset:32768
    ds_read_b64_tr_b16 a[98:99], v4 offset:33280
    ds_read_b64_tr_b16 a[100:101], v5 offset:32768
    ds_read_b64_tr_b16 a[102:103], v5 offset:33280
    s_add_u32 s57, s57, 27648
    buffer_load_dwordx4 v10, s[16:19], s57 offen offset:2048 lds
    ds_read_b64_tr_b16 a[104:105], v4 offset:33024
    ds_read_b64_tr_b16 a[106:107], v4 offset:33536
    ds_read_b64_tr_b16 a[108:109], v5 offset:33024
    ds_read_b64_tr_b16 a[110:111], v5 offset:33536
    s_add_u32 s57, s57, 27648
    buffer_load_dwordx4 v11, s[16:19], s57 offen offset:3072 lds
    v_bfe_u32 v219, v218, 1, 1
    v_lshl_add_u32 v244, v219, 7, v244
    v_xor_b32 v219, v218, v217
    v_lshl_add_u32 v244, v219, 4, v244
    v_xor_b32 v245, 128, v244
    v_xor_b32 v218, v217, v212
    v_lshl_add_u32 v238, v218, 4, s53
    v_bfe_u32 v219, v1, 1, 1
    buffer_load_dwordx2 v[224:225], v19, s[32:35], 0 offen offset:0
    v_xor_b32 v219, v219, v215
    v_lshl_add_u32 v238, v219, 7, v238
    v_lshl_add_u32 v238, v211, 8, v238
    v_lshrrev_b32 v218, 2, v0
    buffer_load_dwordx2 v[226:227], v19, s[32:35], 0 offen offset:32
    s_waitcnt vmcnt(10)
    ds_read_b64_tr_b16 a[112:113], v2 offset:0
    ds_read_b64_tr_b16 a[114:115], v2 offset:512
    ds_read_b64_tr_b16 a[116:117], v3 offset:0
    ds_read_b64_tr_b16 a[118:119], v3 offset:512
    buffer_load_dwordx2 v[228:229], v19, s[32:35], 0 offen offset:64
    ds_read_b64_tr_b16 a[120:121], v2 offset:256
    ds_read_b64_tr_b16 a[122:123], v2 offset:768
    ds_read_b64_tr_b16 a[124:125], v3 offset:256
    ds_read_b64_tr_b16 a[126:127], v3 offset:768
    buffer_load_dwordx2 v[230:231], v19, s[32:35], 0 offen offset:96
    v_mul_u32_u24 v26, 896, v218
    v_lshl_add_u32 v26, v210, 3, v26
    s_add_u32 s53, s52, 52224
    v_lshrrev_b32 v218, 2, v1
    s_add_u32 m0, s52, 98304
    s_add_u32 s57, s65, 10
    s_sub_u32 s3, s57, 13
    s_min_u32 s57, s57, s3
    s_mul_i32 s57, s57, 114688
    buffer_load_dwordx4 v10, s[16:19], s57 offen offset:0 lds
    v_bfe_u32 v219, v218, 1, 2
    v_xor_b32 v219, v219, v210
    v_lshl_add_u32 v252, v218, 6, s53
    v_lshl_add_u32 v252, v219, 4, v252
    v_bfe_u32 v219, v1, 1, 2
    v_xor_b32 v219, v219, v208
    v_lshl_add_u32 v242, v211, 6, s53
    v_lshl_add_u32 v242, v219, 4, v242
    s_add_u32 s57, s57, 27648
    buffer_load_dwordx4 v11, s[16:19], s57 offen offset:1024 lds
    s_waitcnt vmcnt(10)
    ds_read_b64_tr_b16 a[128:129], v2 offset:16384
    ds_read_b64_tr_b16 a[130:131], v2 offset:16896
    ds_read_b64_tr_b16 a[132:133], v3 offset:16384
    ds_read_b64_tr_b16 a[134:135], v3 offset:16896
    s_add_u32 s57, s57, 27648
    buffer_load_dwordx4 v10, s[16:19], s57 offen offset:2048 lds
    ds_read_b64_tr_b16 a[136:137], v2 offset:16640
    ds_read_b64_tr_b16 a[138:139], v2 offset:17152
    ds_read_b64_tr_b16 a[140:141], v3 offset:16640
    ds_read_b64_tr_b16 a[142:143], v3 offset:17152
    s_add_u32 s57, s57, 27648
    buffer_load_dwordx4 v11, s[16:19], s57 offen offset:3072 lds
    s_sub_u32 s53, 49152, s52
    v_add_u32 v246, s53, v2
    v_add_u32 v247, s53, v3
    v_add_u32 v232, s52, v23
    v_xor_b32 v233, 4096, v232
    v_xor_b32 v234, 8192, v232
    v_xor_b32 v235, 12288, v232
    v_xor_b32 v239, 32, v238
    s_waitcnt lgkmcnt(15)
    s_add_u32 m0, s52, 114688
    s_add_u32 s57, s65, 11
    s_sub_u32 s3, s57, 13
    s_min_u32 s57, s57, s3
    s_mul_i32 s57, s57, 114688
    buffer_load_dwordx4 v10, s[16:19], s57 offen offset:0 lds
    v_xor_b32 v240, 64, v238
    v_xor_b32 v241, 96, v238
    s_add_u32 s57, s57, 27648
    buffer_load_dwordx4 v11, s[16:19], s57 offen offset:1024 lds
    s_waitcnt vmcnt(10)
    ds_read_b64_tr_b16 a[144:145], v2 offset:32768
    ds_read_b64_tr_b16 a[146:147], v2 offset:33280
    ds_read_b64_tr_b16 a[148:149], v3 offset:32768
    ds_read_b64_tr_b16 a[150:151], v3 offset:33280
    s_add_u32 s57, s57, 27648
    buffer_load_dwordx4 v10, s[16:19], s57 offen offset:2048 lds
    ds_read_b64_tr_b16 a[152:153], v2 offset:33024
    ds_read_b64_tr_b16 a[154:155], v2 offset:33536
    ds_read_b64_tr_b16 a[156:157], v3 offset:33024
    ds_read_b64_tr_b16 a[158:159], v3 offset:33536
    s_add_u32 s57, s57, 27648
    buffer_load_dwordx4 v11, s[16:19], s57 offen offset:3072 lds
    s_add_u32 m0, s52, 131072
    s_add_u32 s57, s65, 12
    s_sub_u32 s3, s57, 13
    s_min_u32 s57, s57, s3
    s_mul_i32 s57, s57, 114688
    buffer_load_dwordx4 v10, s[16:19], s57 offen offset:0 lds
    s_add_u32 s57, s57, 27648
    buffer_load_dwordx4 v11, s[16:19], s57 offen offset:1024 lds
    s_waitcnt vmcnt(10)
    v_lshlrev_b32 v32, 16, v224
    v_and_b32 v33, s61, v224
    v_lshlrev_b32 v34, 16, v225
    v_and_b32 v35, s61, v225
    v_lshlrev_b32 v36, 16, v226
    v_and_b32 v37, s61, v226
    v_lshlrev_b32 v38, 16, v227
    v_and_b32 v39, s61, v227
    s_add_u32 s57, s57, 27648
    buffer_load_dwordx4 v10, s[16:19], s57 offen offset:2048 lds
    v_lshlrev_b32 v40, 16, v228
    v_and_b32 v41, s61, v228
    v_lshlrev_b32 v42, 16, v229
    v_and_b32 v43, s61, v229
    s_add_u32 s57, s57, 27648
    buffer_load_dwordx4 v11, s[16:19], s57 offen offset:3072 lds
    v_lshlrev_b32 v44, 16, v230
    v_and_b32 v45, s61, v230
    v_lshlrev_b32 v46, 16, v231
    v_and_b32 v47, s61, v231
    buffer_load_dword v17, v18, s[24:27], 0 offen sc1
    v_mul_f32 v96, s85, v32
    v_mul_f32 v97, s85, v33
    v_mul_f32 v98, s85, v34
    v_mul_f32 v99, s85, v35
    v_mul_f32 v100, s85, v36
    v_mul_f32 v101, s85, v37
    v_mul_f32 v102, s85, v38
    v_mul_f32 v103, s85, v39
    s_add_u32 m0, s52, 147456
    s_mov_b32 s57, 1490944
    buffer_load_dwordx4 v10, s[16:19], s57 offen offset:0 lds
    s_waitcnt vmcnt(10)
    ds_read_b64_tr_b16 a[160:161], v2 offset:49152
    ds_read_b64_tr_b16 a[162:163], v2 offset:49664
    ds_read_b64_tr_b16 a[164:165], v3 offset:49152
    ds_read_b64_tr_b16 a[166:167], v3 offset:49664
    v_mul_f32 v104, s85, v40
    v_mul_f32 v105, s85, v41
    v_mul_f32 v106, s85, v42
    v_mul_f32 v107, s85, v43
    ds_read_b64_tr_b16 a[168:169], v2 offset:49408
    ds_read_b64_tr_b16 a[170:171], v2 offset:49920
    ds_read_b64_tr_b16 a[172:173], v3 offset:49408
    ds_read_b64_tr_b16 a[174:175], v3 offset:49920
    s_add_u32 s57, s57, 27648
    buffer_load_dwordx4 v11, s[16:19], s57 offen offset:1024 lds
    v_mul_f32 v108, s85, v44
    v_mul_f32 v109, s85, v45
    v_mul_f32 v110, s85, v46
    v_mul_f32 v111, s85, v47
    s_add_u32 s57, s57, 27648
    buffer_load_dwordx4 v10, s[16:19], s57 offen offset:2048 lds
    s_add_u32 s57, s57, 27648
    buffer_load_dwordx4 v11, s[16:19], s57 offen offset:3072 lds
    s_waitcnt lgkmcnt(15)
    s_add_u32 m0, s52, 49152
    s_mov_b32 s57, 1605632
    buffer_load_dwordx4 v10, s[16:19], s57 offen offset:0 lds
    s_waitcnt vmcnt(10)
    ds_read_b64_tr_b16 a[176:177], v4 offset:0
    ds_read_b64_tr_b16 a[178:179], v4 offset:512
    ds_read_b64_tr_b16 a[180:181], v5 offset:0
    ds_read_b64_tr_b16 a[182:183], v5 offset:512
    s_add_u32 s57, s57, 27648
    buffer_load_dwordx4 v11, s[16:19], s57 offen offset:1024 lds
    ds_read_b64_tr_b16 a[184:185], v4 offset:256
    ds_read_b64_tr_b16 a[186:187], v4 offset:768
    ds_read_b64_tr_b16 a[188:189], v5 offset:256
    ds_read_b64_tr_b16 a[190:191], v5 offset:768
    s_add_u32 s57, s57, 27648
    buffer_load_dwordx4 v10, s[16:19], s57 offen offset:2048 lds
    s_add_u32 s57, s57, 27648
    buffer_load_dwordx4 v11, s[16:19], s57 offen offset:3072 lds
    s_add_u32 m0, s52, 65536
    s_mov_b32 s57, 1720320
    buffer_load_dwordx4 v10, s[16:19], s57 offen offset:0 lds
    s_waitcnt vmcnt(10)
    ds_read_b64_tr_b16 a[192:193], v4 offset:16384
    ds_read_b64_tr_b16 a[194:195], v4 offset:16896
    ds_read_b64_tr_b16 a[196:197], v5 offset:16384
    ds_read_b64_tr_b16 a[198:199], v5 offset:16896
    s_add_u32 s57, s57, 27648
    buffer_load_dwordx4 v11, s[16:19], s57 offen offset:1024 lds
    ds_read_b64_tr_b16 a[200:201], v4 offset:16640
    ds_read_b64_tr_b16 a[202:203], v4 offset:17152
    ds_read_b64_tr_b16 a[204:205], v5 offset:16640
    ds_read_b64_tr_b16 a[206:207], v5 offset:17152
    s_waitcnt vmcnt(10)
    v_cmp_ne_u32 vcc, s47, v17
    s_nop 0
    s_cbranch_vccz L_ok5
    s_mov_b32 s59, 20000
L_spin4:
    s_sleep 2
    buffer_load_dword v17, v18, s[24:27], 0 offen sc1
    s_waitcnt vmcnt(0)
    v_cmp_ne_u32 vcc, s47, v17
    s_nop 0
    s_cbranch_vccz L_ok5
    s_sub_u32 s59, s59, 1
    s_cbranch_scc0 L_spin4
L_ok5:
    s_cmp_ge_u32 s88, 4
    s_cbranch_scc1 L_p2_alt
    s_add_u32 s57, s57, 27648
    buffer_load_dwordx4 v10, s[16:19], s57 offen offset:2048 lds
    s_add_u32 s57, s57, 27648
    buffer_load_dwordx4 v11, s[16:19], s57 offen offset:3072 lds
    s_mov_b32 s66, s84
    s_lshl_b32 s86, s65, 10
    s_add_u32 s58, s86, s66
    s_add_u32 s86, s66, 13312
    buffer_load_dwordx4 v[112:115], v23, s[24:27], s58 offen offset:0 sc1
    s_add_u32 s58, s58, 1024
    s_cmp_eq_u32 s58, s86
    s_cselect_b32 s58, s66, s58
    buffer_load_dwordx4 v[116:119], v23, s[24:27], s58 offen offset:0 sc1
    s_waitcnt vmcnt(10)
    ds_read_b64_tr_b16 a[208:209], v4 offset:32768
    ds_read_b64_tr_b16 a[210:211], v4 offset:33280
    ds_read_b64_tr_b16 a[212:213], v5 offset:32768
    ds_read_b64_tr_b16 a[214:215], v5 offset:33280
    s_add_u32 s58, s58, 1024
    s_cmp_eq_u32 s58, s86
    s_cselect_b32 s58, s66, s58
    buffer_load_dwordx4 v[120:123], v23, s[24:27], s58 offen offset:0 sc1
    ds_read_b64_tr_b16 a[216:217], v4 offset:33024
    ds_read_b64_tr_b16 a[218:219], v4 offset:33536
    ds_read_b64_tr_b16 a[220:221], v5 offset:33024
    ds_read_b64_tr_b16 a[222:223], v5 offset:33536
    s_add_u32 s58, s58, 1024
    s_cmp_eq_u32 s58, s86
    s_cselect_b32 s58, s66, s58
    buffer_load_dwordx4 v[124:127], v23, s[24:27], s58 offen offset:0 sc1
    s_add_u32 s58, s58, 1024
    s_cmp_eq_u32 s58, s86
    s_cselect_b32 s58, s66, s58
    buffer_load_dwordx4 v[128:131], v23, s[24:27], s58 offen offset:0 sc1
    s_add_u32 s58, s58, 1024
    s_cmp_eq_u32 s58, s86
    s_cselect_b32 s58, s66, s58
    buffer_load_dwordx4 v[132:135], v23, s[24:27], s58 offen offset:0 sc1
    s_waitcnt vmcnt(10)
    ds_read_b64_tr_b16 a[224:225], v2 offset:0
    ds_read_b64_tr_b16 a[226:227], v2 offset:512
    ds_read_b64_tr_b16 a[228:229], v3 offset:0
    ds_read_b64_tr_b16 a[230:231], v3 offset:512
    s_add_u32 s58, s58, 1024
    s_cmp_eq_u32 s58, s86
    s_cselect_b32 s58, s66, s58
    buffer_load_dwordx4 v[136:139], v23, s[24:27], s58 offen offset:0 sc1
    ds_read_b64_tr_b16 a[232:233], v2 offset:256
    ds_read_b64_tr_b16 a[234:235], v2 offset:768
    ds_read_b64_tr_b16 a[236:237], v3 offset:256
    ds_read_b64_tr_b16 a[238:239], v3 offset:768
    s_add_u32 s58, s58, 1024
    s_cmp_eq_u32 s58, s86
    s_cselect_b32 s58, s66, s58
    buffer_load_dwordx4 v[140:143], v23, s[24:27], s58 offen offset:0 sc1
    s_add_u32 s58, s58, 1024
    s_cmp_eq_u32 s58, s86
    s_cselect_b32 s58, s66, s58
    buffer_load_dwordx4 v[144:147], v23, s[24:27], s58 offen offset:0 sc1
    s_add_u32 s58, s58, 1024
    s_cmp_eq_u32 s58, s86
    s_cselect_b32 s58, s66, s58
    buffer_load_dwordx4 v[148:151], v23, s[24:27], s58 offen offset:0 sc1
    s_waitcnt vmcnt(10)
    ds_read_b64_tr_b16 a[240:241], v2 offset:16384
    ds_read_b64_tr_b16 a[242:243], v2 offset:16896
    ds_read_b64_tr_b16 a[244:245], v3 offset:16384
    ds_read_b64_tr_b16 a[246:247], v3 offset:16896
    s_waitcnt vmcnt(9)
    v_mfma_f32_16x16x32_bf16 v[96:99], a[0:3], v[112:115], v[96:99]
    s_add_u32 s58, s58, 1024
    s_cmp_eq_u32 s58, s86
    s_cselect_b32 s58, s66, s58
    v_mfma_f32_16x16x32_bf16 v[100:103], a[4:7], v[112:115], v[100:103]
    buffer_load_dwordx4 v[152:155], v23, s[24:27], s58 offen offset:0 sc1
    v_mfma_f32_16x16x32_bf16 v[104:107], a[8:11], v[112:115], v[104:107]
    v_mfma_f32_16x16x32_bf16 v[108:111], a[12:15], v[112:115], v[108:111]
    ds_read_b64_tr_b16 a[248:249], v2 offset:16640
    ds_read_b64_tr_b16 a[250:251], v2 offset:17152
    ds_read_b64_tr_b16 a[252:253], v3 offset:16640
    ds_read_b64_tr_b16 a[254:255], v3 offset:17152
    s_waitcnt vmcnt(9)
    v_mfma_f32_16x16x32_bf16 v[96:99], a[16:19], v[116:119], v[96:99]
    s_add_u32 s58, s58, 1024
    s_cmp_eq_u32 s58, s86
    s_cselect_b32 s58, s66, s58
    v_mfma_f32_16x16x32_bf16 v[100:103], a[20:23], v[116:119], v[100:103]
    buffer_load_dwordx4 v[156:159], v23, s[24:27], s58 offen offset:0 sc1
    v_mfma_f32_16x16x32_bf16 v[104:107], a[24:27], v[116:119], v[104:107]
    v_mfma_f32_16x16x32_bf16 v[108:111], a[28:31], v[116:119], v[108:111]
    s_waitcnt vmcnt(9)
    v_mfma_f32_16x16x32_bf16 v[96:99], a[32:35], v[120:123], v[96:99]
    s_add_u32 s58, s58, 1024
    s_cmp_eq_u32 s58, s86
    s_cselect_b32 s58, s66, s58
    v_mfma_f32_16x16x32_bf16 v[100:103], a[36:39], v[120:123], v[100:103]
    buffer_load_dwordx4 v[112:115], v23, s[24:27], s58 offen offset:0 sc1
    v_mfma_f32_16x16x32_bf16 v[104:107], a[40:43], v[120:123], v[104:107]
    v_mfma_f32_16x16x32_bf16 v[108:111], a[44:47], v[120:123], v[108:111]
    s_waitcnt vmcnt(9)
    v_mfma_f32_16x16x32_bf16 v[96:99], a[48:51], v[124:127], v[96:99]
    s_add_u32 s58, s66, 13312
    v_mfma_f32_16x16x32_bf16 v[100:103], a[52:55], v[124:127], v[100:103]
    buffer_load_dwordx4 v[116:119], v23, s[24:27], s58 offen offset:0 sc1
    v_mfma_f32_16x16x32_bf16 v[104:107], a[56:59], v[124:127], v[104:107]
    v_mfma_f32_16x16x32_bf16 v[108:111], a[60:63], v[124:127], v[108:111]
    s_waitcnt vmcnt(9)
    v_mfma_f32_16x16x32_bf16 v[96:99], a[64:67], v[128:131], v[96:99]
    s_add_u32 s58, s66, 14336
    v_mfma_f32_16x16x32_bf16 v[100:103], a[68:71], v[128:131], v[100:103]
    buffer_load_dwordx4 v[120:123], v23, s[24:27], s58 offen offset:0 sc1
    v_mfma_f32_16x16x32_bf16 v[104:107], a[72:75], v[128:131], v[104:107]
    v_mfma_f32_16x16x32_bf16 v[108:111], a[76:79], v[128:131], v[108:111]
    s_waitcnt vmcnt(9)
    v_mfma_f32_16x16x32_bf16 v[96:99], a[80:83], v[132:135], v[96:99]
    s_add_u32 s58, s66, 15360
    v_mfma_f32_16x16x32_bf16 v[100:103], a[84:87], v[132:135], v[100:103]
    buffer_load_dwordx4 v[124:127], v23, s[24:27], s58 offen offset:0 sc1
    v_mfma_f32_16x16x32_bf16 v[104:107], a[88:91], v[132:135], v[104:107]
    v_mfma_f32_16x16x32_bf16 v[108:111], a[92:95], v[132:135], v[108:111]
    s_waitcnt vmcnt(9)
    v_mfma_f32_16x16x32_bf16 v[96:99], a[96:99], v[136:139], v[96:99]
    s_xor_b32 s66, s44, 3
    s_lshl2_add_u32 s66, s51, s66
    s_mul_i32 s66, s66, 66816
    s_lshl2_add_u32 s66, s52, s66
    s_lshl_b32 s86, s65, 10
    s_add_u32 s58, s86, s66
    s_add_u32 s86, s66, 13312
    v_mfma_f32_16x16x32_bf16 v[100:103], a[100:103], v[136:139], v[100:103]
    buffer_load_dwordx4 v[128:131], v23, s[24:27], s58 offen offset:0 sc1
    v_mfma_f32_16x16x32_bf16 v[104:107], a[104:107], v[136:139], v[104:107]
    v_mfma_f32_16x16x32_bf16 v[108:111], a[108:111], v[136:139], v[108:111]
    s_waitcnt vmcnt(9)
    v_mfma_f32_16x16x32_bf16 v[96:99], a[112:115], v[140:143], v[96:99]
    s_add_u32 s58, s58, 1024
    s_cmp_eq_u32 s58, s86
    s_cselect_b32 s58, s66, s58
    v_mfma_f32_16x16x32_bf16 v[100:103], a[116:119], v[140:143], v[100:103]
    buffer_load_dwordx4 v[132:135], v23, s[24:27], s58 offen offset:0 sc1
    v_mfma_f32_16x16x32_bf16 v[104:107], a[120:123], v[140:143], v[104:107]
    v_mfma_f32_16x16x32_bf16 v[108:111], a[124:127], v[140:143], v[108:111]
    s_waitcnt vmcnt(9)
    v_mfma_f32_16x16x32_bf16 v[96:99], a[128:131], v[144:147], v[96:99]
    s_add_u32 s58, s58, 1024
    s_cmp_eq_u32 s58, s86
    s_cselect_b32 s58, s66, s58
    v_mfma_f32_16x16x32_bf16 v[100:103], a[132:135], v[144:147], v[100:103]
    buffer_load_dwordx4 v[136:139], v23, s[24:27], s58 offen offset:0 sc1
    v_mfma_f32_16x16x32_bf16 v[104:107], a[136:139], v[144:147], v[104:107]
    v_mfma_f32_16x16x32_bf16 v[108:111], a[140:143], v[144:147], v[108:111]
    s_waitcnt vmcnt(9)
    s_waitcnt lgkmcnt(15)
    v_mfma_f32_16x16x32_bf16 v[96:99], a[144:147], v[148:151], v[96:99]
    s_add_u32 s58, s58, 1024
    s_cmp_eq_u32 s58, s86
    s_cselect_b32 s58, s66, s58
    v_mfma_f32_16x16x32_bf16 v[100:103], a[148:151], v[148:151], v[100:103]
    buffer_load_dwordx4 v[140:143], v23, s[24:27], s58 offen offset:0 sc1
    v_mfma_f32_16x16x32_bf16 v[104:107], a[152:155], v[148:151], v[104:107]
    v_mfma_f32_16x16x32_bf16 v[108:111], a[156:159], v[148:151], v[108:111]
    s_waitcnt vmcnt(9)
    v_mfma_f32_16x16x32_bf16 v[96:99], a[160:163], v[152:155], v[96:99]
    s_add_u32 s58, s58, 1024
    s_cmp_eq_u32 s58, s86
    s_cselect_b32 s58, s66, s58
    v_mfma_f32_16x16x32_bf16 v[100:103], a[164:167], v[152:155], v[100:103]
    buffer_load_dwordx4 v[144:147], v23, s[24:27], s58 offen offset:0 sc1
    v_mfma_f32_16x16x32_bf16 v[104:107], a[168:171], v[152:155], v[104:107]
    v_mfma_f32_16x16x32_bf16 v[108:111], a[172:175], v[152:155], v[108:111]
    s_waitcnt vmcnt(9)
    v_mfma_f32_16x16x32_bf16 v[96:99], a[176:179], v[156:159], v[96:99]
    s_add_u32 s58, s58, 1024
    s_cmp_eq_u32 s58, s86
    s_cselect_b32 s58, s66, s58
    v_mfma_f32_16x16x32_bf16 v[100:103], a[180:183], v[156:159], v[100:103]
    buffer_load_dwordx4 v[148:151], v23, s[24:27], s58 offen offset:0 sc1
    v_mfma_f32_16x16x32_bf16 v[104:107], a[184:187], v[156:159], v[104:107]
    v_mfma_f32_16x16x32_bf16 v[108:111], a[188:191], v[156:159], v[108:111]
    s_waitcnt vmcnt(9)
    v_mfma_f32_16x16x32_bf16 v[96:99], a[192:195], v[112:115], v[96:99]
    s_add_u32 s58, s58, 1024
    s_cmp_eq_u32 s58, s86
    s_cselect_b32 s58, s66, s58
    v_mfma_f32_16x16x32_bf16 v[100:103], a[196:199], v[112:115], v[100:103]
    buffer_load_dwordx4 v[152:155], v23, s[24:27], s58 offen offset:0 sc1
    v_mfma_f32_16x16x32_bf16 v[104:107], a[200:203], v[112:115], v[104:107]
    v_mfma_f32_16x16x32_bf16 v[108:111], a[204:207], v[112:115], v[108:111]
    s_waitcnt vmcnt(9)
    v_mfma_f32_16x16x32_bf16 v[96:99], a[208:211], v[116:119], v[96:99]
    s_add_u32 s58, s58, 1024
    s_cmp_eq_u32 s58, s86
    s_cselect_b32 s58, s66, s58
    v_mfma_f32_16x16x32_bf16 v[100:103], a[212:215], v[116:119], v[100:103]
    buffer_load_dwordx4 v[156:159], v23, s[24:27], s58 offen offset:0 sc1
    v_mfma_f32_16x16x32_bf16 v[104:107], a[216:219], v[116:119], v[104:107]
    v_mfma_f32_16x16x32_bf16 v[108:111], a[220:223], v[116:119], v[108:111]
    s_waitcnt vmcnt(9)
    s_waitcnt lgkmcnt(8)
    v_mfma_f32_16x16x32_bf16 v[96:99], a[224:227], v[120:123], v[96:99]
    s_add_u32 s58, s58, 1024
    s_cmp_eq_u32 s58, s86
    s_cselect_b32 s58, s66, s58
    v_mfma_f32_16x16x32_bf16 v[100:103], a[228:231], v[120:123], v[100:103]
    buffer_load_dwordx4 v[112:115], v23, s[24:27], s58 offen offset:0 sc1
    v_mfma_f32_16x16x32_bf16 v[104:107], a[232:235], v[120:123], v[104:107]
    v_mfma_f32_16x16x32_bf16 v[108:111], a[236:239], v[120:123], v[108:111]
    s_waitcnt vmcnt(9)
    s_waitcnt lgkmcnt(0)
    v_mfma_f32_16x16x32_bf16 v[96:99], a[240:243], v[124:127], v[96:99]
    s_add_u32 s58, s58, 1024
    s_cmp_eq_u32 s58, s86
    s_cselect_b32 s58, s66, s58
    v_mfma_f32_16x16x32_bf16 v[100:103], a[244:247], v[124:127], v[100:103]
    buffer_load_dwordx4 v[116:119], v23, s[24:27], s58 offen offset:0 sc1
    v_mfma_f32_16x16x32_bf16 v[104:107], a[248:251], v[124:127], v[104:107]
    v_mfma_f32_16x16x32_bf16 v[108:111], a[252:255], v[124:127], v[108:111]
L_p2_join:
    s_waitcnt vmcnt(9)
    v_mfma_f32_16x16x32_bf16 v[80:83], a[0:3], v[128:131], 0
    s_add_u32 s58, s58, 1024
    s_cmp_eq_u32 s58, s86
    s_cselect_b32 s58, s66, s58
    v_mfma_f32_16x16x32_bf16 v[84:87], a[4:7], v[128:131], 0
    buffer_load_dwordx4 v[120:123], v23, s[24:27], s58 offen offset:0 sc1
    v_mfma_f32_16x16x32_bf16 v[88:91], a[8:11], v[128:131], 0
    v_mfma_f32_16x16x32_bf16 v[92:95], a[12:15], v[128:131], 0
    s_waitcnt vmcnt(9)
    v_mfma_f32_16x16x32_bf16 v[80:83], a[16:19], v[132:135], v[80:83]
    s_add_u32 s58, s58, 1024
    s_cmp_eq_u32 s58, s86
    s_cselect_b32 s58, s66, s58
    v_mfma_f32_16x16x32_bf16 v[84:87], a[20:23], v[132:135], v[84:87]
    buffer_load_dwordx4 v[124:127], v23, s[24:27], s58 offen offset:0 sc1
    v_mfma_f32_16x16x32_bf16 v[88:91], a[24:27], v[132:135], v[88:91]
    ds_write_b128 v232, v[96:99] offset:49152
    v_mfma_f32_16x16x32_bf16 v[92:95], a[28:31], v[132:135], v[92:95]
    s_waitcnt vmcnt(9)
    v_mfma_f32_16x16x32_bf16 v[80:83], a[32:35], v[136:139], v[80:83]
    s_add_u32 s58, s58, 1024
    s_cmp_eq_u32 s58, s86
    s_cselect_b32 s58, s66, s58
    v_mfma_f32_16x16x32_bf16 v[84:87], a[36:39], v[136:139], v[84:87]
    buffer_load_dwordx4 v[128:131], v23, s[24:27], s58 offen offset:0 sc1
    v_mfma_f32_16x16x32_bf16 v[88:91], a[40:43], v[136:139], v[88:91]
    ds_write_b128 v232, v[100:103] offset:50176
    v_mfma_f32_16x16x32_bf16 v[92:95], a[44:47], v[136:139], v[92:95]
    s_waitcnt vmcnt(9)
    v_mfma_f32_16x16x32_bf16 v[80:83], a[48:51], v[140:143], v[80:83]
    s_add_u32 s58, s66, 13312
    v_mfma_f32_16x16x32_bf16 v[84:87], a[52:55], v[140:143], v[84:87]
    buffer_load_dwordx4 v[132:135], v23, s[24:27], s58 offen offset:0 sc1
    v_mfma_f32_16x16x32_bf16 v[88:91], a[56:59], v[140:143], v[88:91]
    ds_write_b128 v232, v[104:107] offset:51200
    v_mfma_f32_16x16x32_bf16 v[92:95], a[60:63], v[140:143], v[92:95]
    s_waitcnt vmcnt(9)
    v_mfma_f32_16x16x32_bf16 v[80:83], a[64:67], v[144:147], v[80:83]
    s_add_u32 s58, s66, 14336
    v_mfma_f32_16x16x32_bf16 v[84:87], a[68:71], v[144:147], v[84:87]
    buffer_load_dwordx4 v[136:139], v23, s[24:27], s58 offen offset:0 sc1
    v_mfma_f32_16x16x32_bf16 v[88:91], a[72:75], v[144:147], v[88:91]
    ds_write_b128 v232, v[108:111] offset:52224
    v_mfma_f32_16x16x32_bf16 v[92:95], a[76:79], v[144:147], v[92:95]
    s_waitcnt vmcnt(9)
    v_mfma_f32_16x16x32_bf16 v[80:83], a[80:83], v[148:151], v[80:83]
    s_add_u32 s58, s66, 15360
    v_mfma_f32_16x16x32_bf16 v[84:87], a[84:87], v[148:151], v[84:87]
    buffer_load_dwordx4 v[140:143], v23, s[24:27], s58 offen offset:0 sc1
    v_mfma_f32_16x16x32_bf16 v[88:91], a[88:91], v[148:151], v[88:91]
    v_mfma_f32_16x16x32_bf16 v[92:95], a[92:95], v[148:151], v[92:95]
    s_waitcnt vmcnt(9)
    v_mfma_f32_16x16x32_bf16 v[80:83], a[96:99], v[152:155], v[80:83]
    s_xor_b32 s66, s44, 2
    s_lshl2_add_u32 s66, s51, s66
    s_mul_i32 s66, s66, 66816
    s_lshl2_add_u32 s66, s52, s66
    s_lshl_b32 s86, s65, 10
    s_add_u32 s58, s86, s66
    s_add_u32 s86, s66, 13312
    v_mfma_f32_16x16x32_bf16 v[84:87], a[100:103], v[152:155], v[84:87]
    buffer_load_dwordx4 v[144:147], v23, s[24:27], s58 offen offset:0 sc1
    v_mfma_f32_16x16x32_bf16 v[88:91], a[104:107], v[152:155], v[88:91]
    v_mfma_f32_16x16x32_bf16 v[92:95], a[108:111], v[152:155], v[92:95]
    s_waitcnt vmcnt(9)
    v_mfma_f32_16x16x32_bf16 v[80:83], a[112:115], v[156:159], v[80:83]
    s_add_u32 s58, s58, 1024
    s_cmp_eq_u32 s58, s86
    s_cselect_b32 s58, s66, s58
    v_mfma_f32_16x16x32_bf16 v[84:87], a[116:119], v[156:159], v[84:87]
    buffer_load_dwordx4 v[148:151], v23, s[24:27], s58 offen offset:0 sc1
    v_mfma_f32_16x16x32_bf16 v[88:91], a[120:123], v[156:159], v[88:91]
    s_waitcnt lgkmcnt(0)
    s_barrier
    v_mfma_f32_16x16x32_bf16 v[92:95], a[124:127], v[156:159], v[92:95]
    s_waitcnt vmcnt(9)
    v_mfma_f32_16x16x32_bf16 v[80:83], a[128:131], v[112:115], v[80:83]
    s_add_u32 s58, s58, 1024
    s_cmp_eq_u32 s58, s86
    s_cselect_b32 s58, s66, s58
    v_mfma_f32_16x16x32_bf16 v[84:87], a[132:135], v[112:115], v[84:87]
    buffer_load_dwordx4 v[152:155], v23, s[24:27], s58 offen offset:0 sc1
    v_mfma_f32_16x16x32_bf16 v[88:91], a[136:139], v[112:115], v[88:91]
    ds_read_b128 v[160:163], v243 offset:0
    ds_read_b128 v[164:167], v243 offset:1024
    v_mfma_f32_16x16x32_bf16 v[92:95], a[140:143], v[112:115], v[92:95]
    ds_read_b128 v[168:171], v243 offset:4096
    s_waitcnt vmcnt(9)
    v_mfma_f32_16x16x32_bf16 v[80:83], a[144:147], v[116:119], v[80:83]
    s_add_u32 s58, s58, 1024
    s_cmp_eq_u32 s58, s86
    s_cselect_b32 s58, s66, s58
    v_mfma_f32_16x16x32_bf16 v[84:87], a[148:151], v[116:119], v[84:87]
    buffer_load_dwordx4 v[156:159], v23, s[24:27], s58 offen offset:0 sc1
    v_mfma_f32_16x16x32_bf16 v[88:91], a[152:155], v[116:119], v[88:91]
    ds_read_b128 v[172:175], v243 offset:5120
    ds_read_b128 v[176:179], v243 offset:8192
    v_mfma_f32_16x16x32_bf16 v[92:95], a[156:159], v[116:119], v[92:95]
    ds_read_b128 v[180:183], v243 offset:9216
    s_waitcnt vmcnt(9)
    v_mfma_f32_16x16x32_bf16 v[80:83], a[160:163], v[120:123], v[80:83]
    s_add_u32 s58, s58, 1024
    s_cmp_eq_u32 s58, s86
    s_cselect_b32 s58, s66, s58
    v_mfma_f32_16x16x32_bf16 v[84:87], a[164:167], v[120:123], v[84:87]
    buffer_load_dwordx4 v[112:115], v23, s[24:27], s58 offen offset:0 sc1
    v_mfma_f32_16x16x32_bf16 v[88:91], a[168:171], v[120:123], v[88:91]
    ds_read_b128 v[184:187], v243 offset:12288
    v_mfma_f32_16x16x32_bf16 v[92:95], a[172:175], v[120:123], v[92:95]
    ds_read_b128 v[188:191], v243 offset:13312
    s_waitcnt vmcnt(9)
    v_mfma_f32_16x16x32_bf16 v[80:83], a[176:179], v[124:127], v[80:83]
    s_add_u32 s58, s58, 1024
    s_cmp_eq_u32 s58, s86
    s_cselect_b32 s58, s66, s58
    v_mfma_f32_16x16x32_bf16 v[84:87], a[180:183], v[124:127], v[84:87]
    buffer_load_dwordx4 v[116:119], v23, s[24:27], s58 offen offset:0 sc1
    v_mfma_f32_16x16x32_bf16 v[88:91], a[184:187], v[124:127], v[88:91]
    v_mfma_f32_16x16x32_bf16 v[92:95], a[188:191], v[124:127], v[92:95]
    s_waitcnt vmcnt(9)
    v_mfma_f32_16x16x32_bf16 v[80:83], a[192:195], v[128:131], v[80:83]
    s_add_u32 s58, s58, 1024
    s_cmp_eq_u32 s58, s86
    s_cselect_b32 s58, s66, s58
    v_mfma_f32_16x16x32_bf16 v[84:87], a[196:199], v[128:131], v[84:87]
    buffer_load_dwordx4 v[120:123], v23, s[24:27], s58 offen offset:0 sc1
    v_mfma_f32_16x16x32_bf16 v[88:91], a[200:203], v[128:131], v[88:91]
    s_waitcnt lgkmcnt(0)
    v_add_f32 v160, v160, v168
    v_mfma_f32_16x16x32_bf16 v[92:95], a[204:207], v[128:131], v[92:95]
    v_add_f32 v161, v161, v169
    s_waitcnt vmcnt(9)
    v_mfma_f32_16x16x32_bf16 v[80:83], a[208:211], v[132:135], v[80:83]
    s_add_u32 s58, s58, 1024
    s_cmp_eq_u32 s58, s86
    s_cselect_b32 s58, s66, s58
    v_mfma_f32_16x16x32_bf16 v[84:87], a[212:215], v[132:135], v[84:87]
    buffer_load_dwordx4 v[124:127], v23, s[24:27], s58 offen offset:0 sc1
    v_mfma_f32_16x16x32_bf16 v[88:91], a[216:219], v[132:135], v[88:91]
    v_add_f32 v162, v162, v170
    v_add_f32 v163, v163, v171
    v_mfma_f32_16x16x32_bf16 v[92:95], a[220:223], v[132:135], v[92:95]
    v_add_f32 v164, v164, v172
    s_waitcnt vmcnt(9)
    v_mfma_f32_16x16x32_bf16 v[80:83], a[224:227], v[136:139], v[80:83]
    s_add_u32 s58, s58, 1024
    s_cmp_eq_u32 s58, s86
    s_cselect_b32 s58, s66, s58
    v_mfma_f32_16x16x32_bf16 v[84:87], a[228:231], v[136:139], v[84:87]
    buffer_load_dwordx4 v[128:131], v23, s[24:27], s58 offen offset:0 sc1
    v_mfma_f32_16x16x32_bf16 v[88:91], a[232:235], v[136:139], v[88:91]
    v_add_f32 v165, v165, v173
    v_add_f32 v166, v166, v174
    v_mfma_f32_16x16x32_bf16 v[92:95], a[236:239], v[136:139], v[92:95]
    v_add_f32 v167, v167, v175
    s_waitcnt vmcnt(9)
    v_mfma_f32_16x16x32_bf16 v[80:83], a[240:243], v[140:143], v[80:83]
    s_add_u32 s58, s58, 1024
    s_cmp_eq_u32 s58, s86
    s_cselect_b32 s58, s66, s58
    v_mfma_f32_16x16x32_bf16 v[84:87], a[244:247], v[140:143], v[84:87]
    buffer_load_dwordx4 v[132:135], v23, s[24:27], s58 offen offset:0 sc1
    v_mfma_f32_16x16x32_bf16 v[88:91], a[248:251], v[140:143], v[88:91]
    v_add_f32 v160, v160, v176
    v_add_f32 v161, v161, v177
    v_mfma_f32_16x16x32_bf16 v[92:95], a[252:255], v[140:143], v[92:95]
    v_add_f32 v162, v162, v178
    s_waitcnt vmcnt(9)
    v_mfma_f32_16x16x32_bf16 v[64:67], a[0:3], v[144:147], 0
    s_add_u32 s58, s58, 1024
    s_cmp_eq_u32 s58, s86
    s_cselect_b32 s58, s66, s58
    v_mfma_f32_16x16x32_bf16 v[68:71], a[4:7], v[144:147], 0
    buffer_load_dwordx4 v[136:139], v23, s[24:27], s58 offen offset:0 sc1
    v_mfma_f32_16x16x32_bf16 v[72:75], a[8:11], v[144:147], 0
    v_mfma_f32_16x16x32_bf16 v[76:79], a[12:15], v[144:147], 0
    s_waitcnt vmcnt(9)
    v_mfma_f32_16x16x32_bf16 v[64:67], a[16:19], v[148:151], v[64:67]
    s_add_u32 s58, s58, 1024
    s_cmp_eq_u32 s58, s86
    s_cselect_b32 s58, s66, s58
    v_mfma_f32_16x16x32_bf16 v[68:71], a[20:23], v[148:151], v[68:71]
    buffer_load_dwordx4 v[140:143], v23, s[24:27], s58 offen offset:0 sc1
    v_mfma_f32_16x16x32_bf16 v[72:75], a[24:27], v[148:151], v[72:75]
    ds_write_b128 v232, v[80:83] offset:32768
    v_mfma_f32_16x16x32_bf16 v[76:79], a[28:31], v[148:151], v[76:79]
    s_waitcnt vmcnt(9)
    v_mfma_f32_16x16x32_bf16 v[64:67], a[32:35], v[152:155], v[64:67]
    s_add_u32 s58, s58, 1024
    s_cmp_eq_u32 s58, s86
    s_cselect_b32 s58, s66, s58
    v_mfma_f32_16x16x32_bf16 v[68:71], a[36:39], v[152:155], v[68:71]
    buffer_load_dwordx4 v[144:147], v23, s[24:27], s58 offen offset:0 sc1
    v_mfma_f32_16x16x32_bf16 v[72:75], a[40:43], v[152:155], v[72:75]
    ds_write_b128 v232, v[84:87] offset:33792
    v_mfma_f32_16x16x32_bf16 v[76:79], a[44:47], v[152:155], v[76:79]
    s_waitcnt vmcnt(9)
    v_mfma_f32_16x16x32_bf16 v[64:67], a[48:51], v[156:159], v[64:67]
    s_add_u32 s58, s66, 13312
    ds_write_b128 v232, v[88:91] offset:34816
    v_mfma_f32_16x16x32_bf16 v[68:71], a[52:55], v[156:159], v[68:71]
    buffer_load_dwordx4 v[148:151], v23, s[24:27], s58 offen offset:0 sc1
    v_mfma_f32_16x16x32_bf16 v[72:75], a[56:59], v[156:159], v[72:75]
    v_add_f32 v163, v163, v179
    v_add_f32 v164, v164, v180
    v_mfma_f32_16x16x32_bf16 v[76:79], a[60:63], v[156:159], v[76:79]
    v_add_f32 v165, v165, v181
    s_waitcnt vmcnt(9)
    v_mfma_f32_16x16x32_bf16 v[64:67], a[64:67], v[112:115], v[64:67]
    s_add_u32 s58, s66, 14336
    ds_write_b128 v232, v[92:95] offset:35840
    v_mfma_f32_16x16x32_bf16 v[68:71], a[68:71], v[112:115], v[68:71]
    buffer_load_dwordx4 v[152:155], v23, s[24:27], s58 offen offset:0 sc1
    v_mfma_f32_16x16x32_bf16 v[72:75], a[72:75], v[112:115], v[72:75]
    v_add_f32 v166, v166, v182
    v_add_f32 v167, v167, v183
    v_mfma_f32_16x16x32_bf16 v[76:79], a[76:79], v[112:115], v[76:79]
    v_add_f32 v160, v160, v184
    s_waitcnt vmcnt(9)
    v_mfma_f32_16x16x32_bf16 v[64:67], a[80:83], v[116:119], v[64:67]
    s_add_u32 s58, s66, 15360
    v_mfma_f32_16x16x32_bf16 v[68:71], a[84:87], v[116:119], v[68:71]
    buffer_load_dwordx4 v[156:159], v23, s[24:27], s58 offen offset:0 sc1
    v_mfma_f32_16x16x32_bf16 v[72:75], a[88:91], v[116:119], v[72:75]
    v_add_f32 v161, v161, v185
    v_add_f32 v162, v162, v186
    v_mfma_f32_16x16x32_bf16 v[76:79], a[92:95], v[116:119], v[76:79]
    v_add_f32 v163, v163, v187
    s_waitcnt vmcnt(9)
    v_mfma_f32_16x16x32_bf16 v[64:67], a[96:99], v[120:123], v[64:67]
    s_xor_b32 s66, s44, 1
    s_lshl2_add_u32 s66, s51, s66
    s_mul_i32 s66, s66, 66816
    s_lshl2_add_u32 s66, s52, s66
    s_lshl_b32 s86, s65, 10
    s_add_u32 s58, s86, s66
    s_add_u32 s86, s66, 13312
    v_mfma_f32_16x16x32_bf16 v[68:71], a[100:103], v[120:123], v[68:71]
    buffer_load_dwordx4 v[112:115], v23, s[24:27], s58 offen offset:0 sc1
    v_mfma_f32_16x16x32_bf16 v[72:75], a[104:107], v[120:123], v[72:75]
    v_add_f32 v164, v164, v188
    v_add_f32 v165, v165, v189
    v_mfma_f32_16x16x32_bf16 v[76:79], a[108:111], v[120:123], v[76:79]
    v_add_f32 v166, v166, v190
    s_waitcnt vmcnt(9)
    v_mfma_f32_16x16x32_bf16 v[64:67], a[112:115], v[124:127], v[64:67]
    s_add_u32 s58, s58, 1024
    s_cmp_eq_u32 s58, s86
    s_cselect_b32 s58, s66, s58
    v_mfma_f32_16x16x32_bf16 v[68:71], a[116:119], v[124:127], v[68:71]
    buffer_load_dwordx4 v[116:119], v23, s[24:27], s58 offen offset:0 sc1
    v_mfma_f32_16x16x32_bf16 v[72:75], a[120:123], v[124:127], v[72:75]
    v_add_f32 v167, v167, v191
    v_mul_f32 v192, v160, v160
    v_mfma_f32_16x16x32_bf16 v[76:79], a[124:127], v[124:127], v[76:79]
    v_mul_f32 v193, v161, v161
    s_waitcnt vmcnt(9)
    v_mfma_f32_16x16x32_bf16 v[64:67], a[128:131], v[128:131], v[64:67]
    s_add_u32 s58, s58, 1024
    s_cmp_eq_u32 s58, s86
    s_cselect_b32 s58, s66, s58
    v_mfma_f32_16x16x32_bf16 v[68:71], a[132:135], v[128:131], v[68:71]
    buffer_load_dwordx4 v[120:123], v23, s[24:27], s58 offen offset:0 sc1
    v_mfma_f32_16x16x32_bf16 v[72:75], a[136:139], v[128:131], v[72:75]
    v_mul_f32 v194, v162, v162
    v_mul_f32 v195, v163, v163
    v_mfma_f32_16x16x32_bf16 v[76:79], a[140:143], v[128:131], v[76:79]
    v_mul_f32 v196, v164, v164
    s_waitcnt vmcnt(9)
    v_mfma_f32_16x16x32_bf16 v[64:67], a[144:147], v[132:135], v[64:67]
    s_add_u32 s58, s58, 1024
    s_cmp_eq_u32 s58, s86
    s_cselect_b32 s58, s66, s58
    v_mfma_f32_16x16x32_bf16 v[68:71], a[148:151], v[132:135], v[68:71]
    buffer_load_dwordx4 v[124:127], v23, s[24:27], s58 offen offset:0 sc1
    v_mfma_f32_16x16x32_bf16 v[72:75], a[152:155], v[132:135], v[72:75]
    v_mul_f32 v197, v165, v165
    v_mul_f32 v198, v166, v166
    v_mfma_f32_16x16x32_bf16 v[76:79], a[156:159], v[132:135], v[76:79]
    v_mul_f32 v199, v167, v167
    s_waitcnt vmcnt(9)
    v_mfma_f32_16x16x32_bf16 v[64:67], a[160:163], v[136:139], v[64:67]
    s_add_u32 s58, s58, 1024
    s_cmp_eq_u32 s58, s86
    s_cselect_b32 s58, s66, s58
    v_mfma_f32_16x16x32_bf16 v[68:71], a[164:167], v[136:139], v[68:71]
    buffer_load_dwordx4 v[128:131], v23, s[24:27], s58 offen offset:0 sc1
    v_mfma_f32_16x16x32_bf16 v[72:75], a[168:171], v[136:139], v[72:75]
    v_fma_f32 v192, v192, v236, v237
    v_fma_f32 v193, v193, v236, v237
    v_mfma_f32_16x16x32_bf16 v[76:79], a[172:175], v[136:139], v[76:79]
    v_fma_f32 v194, v194, v236, v237
    s_waitcnt vmcnt(9)
    v_mfma_f32_16x16x32_bf16 v[64:67], a[176:179], v[140:143], v[64:67]
    s_add_u32 s58, s58, 1024
    s_cmp_eq_u32 s58, s86
    s_cselect_b32 s58, s66, s58
    v_mfma_f32_16x16x32_bf16 v[68:71], a[180:183], v[140:143], v[68:71]
    buffer_load_dwordx4 v[132:135], v23, s[24:27], s58 offen offset:0 sc1
    v_mfma_f32_16x16x32_bf16 v[72:75], a[184:187], v[140:143], v[72:75]
    v_fma_f32 v195, v195, v236, v237
    v_fma_f32 v196, v196, v236, v237
    v_mfma_f32_16x16x32_bf16 v[76:79], a[188:191], v[140:143], v[76:79]
    v_fma_f32 v197, v197, v236, v237
    s_waitcnt vmcnt(9)
    v_mfma_f32_16x16x32_bf16 v[64:67], a[192:195], v[144:147], v[64:67]
    s_add_u32 s58, s58, 1024
    s_cmp_eq_u32 s58, s86
    s_cselect_b32 s58, s66, s58
    v_mfma_f32_16x16x32_bf16 v[68:71], a[196:199], v[144:147], v[68:71]
    buffer_load_dwordx4 v[136:139], v23, s[24:27], s58 offen offset:0 sc1
    v_mfma_f32_16x16x32_bf16 v[72:75], a[200:203], v[144:147], v[72:75]
    v_fma_f32 v198, v198, v236, v237
    v_fma_f32 v199, v199, v236, v237
    v_mfma_f32_16x16x32_bf16 v[76:79], a[204:207], v[144:147], v[76:79]
    v_mul_f32 v192, v192, v160
    s_waitcnt vmcnt(9)
    v_mfma_f32_16x16x32_bf16 v[64:67], a[208:211], v[148:151], v[64:67]
    s_add_u32 s58, s58, 1024
    s_cmp_eq_u32 s58, s86
    s_cselect_b32 s58, s66, s58
    v_mfma_f32_16x16x32_bf16 v[68:71], a[212:215], v[148:151], v[68:71]
    buffer_load_dwordx4 v[140:143], v23, s[24:27], s58 offen offset:0 sc1
    v_mfma_f32_16x16x32_bf16 v[72:75], a[216:219], v[148:151], v[72:75]
    v_mul_f32 v193, v193, v161
    v_mul_f32 v194, v194, v162
    v_mfma_f32_16x16x32_bf16 v[76:79], a[220:223], v[148:151], v[76:79]
    v_mul_f32 v195, v195, v163
    s_waitcnt vmcnt(9)
    v_mfma_f32_16x16x32_bf16 v[64:67], a[224:227], v[152:155], v[64:67]
    s_add_u32 s58, s58, 1024
    s_cmp_eq_u32 s58, s86
    s_cselect_b32 s58, s66, s58
    v_mfma_f32_16x16x32_bf16 v[68:71], a[228:231], v[152:155], v[68:71]
    buffer_load_dwordx4 v[144:147], v23, s[24:27], s58 offen offset:0 sc1
    v_mfma_f32_16x16x32_bf16 v[72:75], a[232:235], v[152:155], v[72:75]
    v_mul_f32 v196, v196, v164
    v_mul_f32 v197, v197, v165
    v_mfma_f32_16x16x32_bf16 v[76:79], a[236:239], v[152:155], v[76:79]
    v_mul_f32 v198, v198, v166
    s_waitcnt vmcnt(9)
    v_mfma_f32_16x16x32_bf16 v[64:67], a[240:243], v[156:159], v[64:67]
    s_add_u32 s58, s58, 1024
    s_cmp_eq_u32 s58, s86
    s_cselect_b32 s58, s66, s58
    v_mfma_f32_16x16x32_bf16 v[68:71], a[244:247], v[156:159], v[68:71]
    buffer_load_dwordx4 v[148:151], v23, s[24:27], s58 offen offset:0 sc1
    v_mfma_f32_16x16x32_bf16 v[72:75], a[248:251], v[156:159], v[72:75]
    v_mul_f32 v199, v199, v167
    v_mfma_f32_16x16x32_bf16 v[76:79], a[252:255], v[156:159], v[76:79]
    s_waitcnt vmcnt(9)
    v_mfma_f32_16x16x32_bf16 v[48:51], a[0:3], v[112:115], 0
    s_add_u32 s58, s58, 1024
    s_cmp_eq_u32 s58, s86
    s_cselect_b32 s58, s66, s58
    v_mfma_f32_16x16x32_bf16 v[52:55], a[4:7], v[112:115], 0
    buffer_load_dwordx4 v[152:155], v23, s[24:27], s58 offen offset:0 sc1
    v_mfma_f32_16x16x32_bf16 v[56:59], a[8:11], v[112:115], 0
    v_mfma_f32_16x16x32_bf16 v[60:63], a[12:15], v[112:115], 0
    s_waitcnt vmcnt(9)
    v_mfma_f32_16x16x32_bf16 v[48:51], a[16:19], v[116:119], v[48:51]
    s_add_u32 s58, s58, 1024
    s_cmp_eq_u32 s58, s86
    s_cselect_b32 s58, s66, s58
    v_mfma_f32_16x16x32_bf16 v[52:55], a[20:23], v[116:119], v[52:55]
    buffer_load_dwordx4 v[156:159], v23, s[24:27], s58 offen offset:0 sc1
    v_mfma_f32_16x16x32_bf16 v[56:59], a[24:27], v[116:119], v[56:59]
    ds_write_b128 v232, v[64:67] offset:16384
    v_mfma_f32_16x16x32_bf16 v[60:63], a[28:31], v[116:119], v[60:63]
    s_waitcnt vmcnt(9)
    v_mfma_f32_16x16x32_bf16 v[48:51], a[32:35], v[120:123], v[48:51]
    s_add_u32 s58, s58, 1024
    s_cmp_eq_u32 s58, s86
    s_cselect_b32 s58, s66, s58
    v_mfma_f32_16x16x32_bf16 v[52:55], a[36:39], v[120:123], v[52:55]
    buffer_load_dwordx4 v[112:115], v23, s[24:27], s58 offen offset:0 sc1
    v_mfma_f32_16x16x32_bf16 v[56:59], a[40:43], v[120:123], v[56:59]
    ds_write_b128 v232, v[68:71] offset:17408
    v_mfma_f32_16x16x32_bf16 v[60:63], a[44:47], v[120:123], v[60:63]
    s_waitcnt vmcnt(9)
    v_mfma_f32_16x16x32_bf16 v[48:51], a[48:51], v[124:127], v[48:51]
    s_add_u32 s58, s66, 13312
    ds_write_b128 v232, v[72:75] offset:18432
    v_mfma_f32_16x16x32_bf16 v[52:55], a[52:55], v[124:127], v[52:55]
    buffer_load_dwordx4 v[116:119], v23, s[24:27], s58 offen offset:0 sc1
    v_mfma_f32_16x16x32_bf16 v[56:59], a[56:59], v[124:127], v[56:59]
    v_exp_f32 v192, v192
    v_exp_f32 v193, v193
    v_mfma_f32_16x16x32_bf16 v[60:63], a[60:63], v[124:127], v[60:63]
    v_exp_f32 v194, v194
    s_waitcnt vmcnt(9)
    v_mfma_f32_16x16x32_bf16 v[48:51], a[64:67], v[128:131], v[48:51]
    s_add_u32 s58, s66, 14336
    ds_write_b128 v232, v[76:79] offset:19456
    v_mfma_f32_16x16x32_bf16 v[52:55], a[68:71], v[128:131], v[52:55]
    buffer_load_dwordx4 v[120:123], v23, s[24:27], s58 offen offset:0 sc1
    v_mfma_f32_16x16x32_bf16 v[56:59], a[72:75], v[128:131], v[56:59]
    v_exp_f32 v195, v195
    v_exp_f32 v196, v196
    v_mfma_f32_16x16x32_bf16 v[60:63], a[76:79], v[128:131], v[60:63]
    v_exp_f32 v197, v197
    s_waitcnt vmcnt(9)
    v_mfma_f32_16x16x32_bf16 v[48:51], a[80:83], v[132:135], v[48:51]
    s_add_u32 s58, s66, 15360
    v_mfma_f32_16x16x32_bf16 v[52:55], a[84:87], v[132:135], v[52:55]
    buffer_load_dwordx4 v[124:127], v23, s[24:27], s58 offen offset:0 sc1
    v_mfma_f32_16x16x32_bf16 v[56:59], a[88:91], v[132:135], v[56:59]
    v_exp_f32 v198, v198
    v_exp_f32 v199, v199
    v_mfma_f32_16x16x32_bf16 v[60:63], a[92:95], v[132:135], v[60:63]
    v_add_f32 v192, 1.0, v192
    s_waitcnt vmcnt(9)
    v_mfma_f32_16x16x32_bf16 v[48:51], a[96:99], v[136:139], v[48:51]
    s_xor_b32 s66, s44, 0
    s_lshl2_add_u32 s66, s51, s66
    s_mul_i32 s66, s66, 66816
    s_lshl2_add_u32 s66, s52, s66
    s_lshl_b32 s86, s65, 10
    s_add_u32 s58, s86, s66
    s_add_u32 s86, s66, 13312
    v_mfma_f32_16x16x32_bf16 v[52:55], a[100:103], v[136:139], v[52:55]
    buffer_load_dwordx4 v[128:131], v23, s[24:27], s58 offen offset:0 sc1
    v_mfma_f32_16x16x32_bf16 v[56:59], a[104:107], v[136:139], v[56:59]
    v_add_f32 v193, 1.0, v193
    v_add_f32 v194, 1.0, v194
    v_mfma_f32_16x16x32_bf16 v[60:63], a[108:111], v[136:139], v[60:63]
    v_add_f32 v195, 1.0, v195
    s_waitcnt vmcnt(9)
    v_mfma_f32_16x16x32_bf16 v[48:51], a[112:115], v[140:143], v[48:51]
    s_add_u32 s58, s58, 1024
    s_cmp_eq_u32 s58, s86
    s_cselect_b32 s58, s66, s58
    v_mfma_f32_16x16x32_bf16 v[52:55], a[116:119], v[140:143], v[52:55]
    buffer_load_dwordx4 v[132:135], v23, s[24:27], s58 offen offset:0 sc1
    v_mfma_f32_16x16x32_bf16 v[56:59], a[120:123], v[140:143], v[56:59]
    v_add_f32 v196, 1.0, v196
    v_add_f32 v197, 1.0, v197
    v_mfma_f32_16x16x32_bf16 v[60:63], a[124:127], v[140:143], v[60:63]
    v_add_f32 v198, 1.0, v198
    s_waitcnt vmcnt(9)
    v_mfma_f32_16x16x32_bf16 v[48:51], a[128:131], v[144:147], v[48:51]
    s_add_u32 s58, s58, 1024
    s_cmp_eq_u32 s58, s86
    s_cselect_b32 s58, s66, s58
    v_mfma_f32_16x16x32_bf16 v[52:55], a[132:135], v[144:147], v[52:55]
    buffer_load_dwordx4 v[136:139], v23, s[24:27], s58 offen offset:0 sc1
    v_mfma_f32_16x16x32_bf16 v[56:59], a[136:139], v[144:147], v[56:59]
    v_add_f32 v199, 1.0, v199
    v_rcp_f32 v192, v192
    v_mfma_f32_16x16x32_bf16 v[60:63], a[140:143], v[144:147], v[60:63]
    v_rcp_f32 v193, v193
    s_waitcnt vmcnt(9)
    v_mfma_f32_16x16x32_bf16 v[48:51], a[144:147], v[148:151], v[48:51]
    s_add_u32 s58, s58, 1024
    s_cmp_eq_u32 s58, s86
    s_cselect_b32 s58, s66, s58
    v_mfma_f32_16x16x32_bf16 v[52:55], a[148:151], v[148:151], v[52:55]
    buffer_load_dwordx4 v[140:143], v23, s[24:27], s58 offen offset:0 sc1
    v_mfma_f32_16x16x32_bf16 v[56:59], a[152:155], v[148:151], v[56:59]
    v_rcp_f32 v194, v194
    v_rcp_f32 v195, v195
    v_mfma_f32_16x16x32_bf16 v[60:63], a[156:159], v[148:151], v[60:63]
    v_rcp_f32 v196, v196
    s_waitcnt vmcnt(9)
    v_mfma_f32_16x16x32_bf16 v[48:51], a[160:163], v[152:155], v[48:51]
    s_add_u32 s58, s58, 1024
    s_cmp_eq_u32 s58, s86
    s_cselect_b32 s58, s66, s58
    v_mfma_f32_16x16x32_bf16 v[52:55], a[164:167], v[152:155], v[52:55]
    buffer_load_dwordx4 v[144:147], v23, s[24:27], s58 offen offset:0 sc1
    v_mfma_f32_16x16x32_bf16 v[56:59], a[168:171], v[152:155], v[56:59]
    v_rcp_f32 v197, v197
    v_rcp_f32 v198, v198
    v_mfma_f32_16x16x32_bf16 v[60:63], a[172:175], v[152:155], v[60:63]
    v_rcp_f32 v199, v199
    s_waitcnt vmcnt(9)
    v_mfma_f32_16x16x32_bf16 v[48:51], a[176:179], v[156:159], v[48:51]
    s_add_u32 s58, s58, 1024
    s_cmp_eq_u32 s58, s86
    s_cselect_b32 s58, s66, s58
    v_mfma_f32_16x16x32_bf16 v[52:55], a[180:183], v[156:159], v[52:55]
    buffer_load_dwordx4 v[148:151], v23, s[24:27], s58 offen offset:0 sc1
    v_mfma_f32_16x16x32_bf16 v[56:59], a[184:187], v[156:159], v[56:59]
    v_mul_f32 v192, v192, v160
    v_mul_f32 v193, v193, v161
    v_mfma_f32_16x16x32_bf16 v[60:63], a[188:191], v[156:159], v[60:63]
    v_mul_f32 v194, v194, v162
    s_waitcnt vmcnt(9)
    v_mfma_f32_16x16x32_bf16 v[48:51], a[192:195], v[112:115], v[48:51]
    s_add_u32 s58, s58, 1024
    s_cmp_eq_u32 s58, s86
    s_cselect_b32 s58, s66, s58
    v_mfma_f32_16x16x32_bf16 v[52:55], a[196:199], v[112:115], v[52:55]
    buffer_load_dwordx4 v[152:155], v23, s[24:27], s58 offen offset:0 sc1
    v_mfma_f32_16x16x32_bf16 v[56:59], a[200:203], v[112:115], v[56:59]
    v_mul_f32 v195, v195, v163
    v_mul_f32 v196, v196, v164
    v_mfma_f32_16x16x32_bf16 v[60:63], a[204:207], v[112:115], v[60:63]
    v_mul_f32 v197, v197, v165
    s_waitcnt vmcnt(9)
    v_mfma_f32_16x16x32_bf16 v[48:51], a[208:211], v[116:119], v[48:51]
    s_add_u32 s58, s58, 1024
    s_cmp_eq_u32 s58, s86
    s_cselect_b32 s58, s66, s58
    v_mfma_f32_16x16x32_bf16 v[52:55], a[212:215], v[116:119], v[52:55]
    buffer_load_dwordx4 v[156:159], v23, s[24:27], s58 offen offset:0 sc1
    v_mfma_f32_16x16x32_bf16 v[56:59], a[216:219], v[116:119], v[56:59]
    v_mul_f32 v198, v198, v166
    v_mul_f32 v199, v199, v167
    v_mfma_f32_16x16x32_bf16 v[60:63], a[220:223], v[116:119], v[60:63]
    v_cvt_pk_bf16_f32 v96, v192, v193
    s_waitcnt vmcnt(9)
    v_mfma_f32_16x16x32_bf16 v[48:51], a[224:227], v[120:123], v[48:51]
    s_add_u32 s58, s58, 1024
    s_cmp_eq_u32 s58, s86
    s_cselect_b32 s58, s66, s58
    v_mfma_f32_16x16x32_bf16 v[52:55], a[228:231], v[120:123], v[52:55]
    buffer_load_dwordx4 v[112:115], v23, s[24:27], s58 offen offset:0 sc1
    v_mfma_f32_16x16x32_bf16 v[56:59], a[232:235], v[120:123], v[56:59]
    v_cvt_pk_bf16_f32 v97, v194, v195
    v_cvt_pk_bf16_f32 v98, v196, v197
    v_mfma_f32_16x16x32_bf16 v[60:63], a[236:239], v[120:123], v[60:63]
    v_cvt_pk_bf16_f32 v99, v198, v199
    s_waitcnt vmcnt(9)
    v_mfma_f32_16x16x32_bf16 v[48:51], a[240:243], v[124:127], v[48:51]
    s_add_u32 s58, s58, 1024
    s_cmp_eq_u32 s58, s86
    s_cselect_b32 s58, s66, s58
    v_mfma_f32_16x16x32_bf16 v[52:55], a[244:247], v[124:127], v[52:55]
    buffer_load_dwordx4 v[116:119], v23, s[24:27], s58 offen offset:0 sc1
    v_mfma_f32_16x16x32_bf16 v[56:59], a[248:251], v[124:127], v[56:59]
    v_mfma_f32_16x16x32_bf16 v[60:63], a[252:255], v[124:127], v[60:63]
    s_waitcnt vmcnt(9)
    v_mfma_f32_16x16x32_bf16 v[32:35], a[0:3], v[128:131], v[32:35]
    s_add_u32 s58, s58, 1024
    s_cmp_eq_u32 s58, s86
    s_cselect_b32 s58, s66, s58
    v_mfma_f32_16x16x32_bf16 v[36:39], a[4:7], v[128:131], v[36:39]
    buffer_load_dwordx4 v[120:123], v23, s[24:27], s58 offen offset:0 sc1
    v_mfma_f32_16x16x32_bf16 v[40:43], a[8:11], v[128:131], v[40:43]
    v_mfma_f32_16x16x32_bf16 v[44:47], a[12:15], v[128:131], v[44:47]
    s_waitcnt vmcnt(9)
    v_mfma_f32_16x16x32_bf16 v[32:35], a[16:19], v[132:135], v[32:35]
    s_add_u32 s58, s58, 1024
    s_cmp_eq_u32 s58, s86
    s_cselect_b32 s58, s66, s58
    v_mfma_f32_16x16x32_bf16 v[36:39], a[20:23], v[132:135], v[36:39]
    buffer_load_dwordx4 v[124:127], v23, s[24:27], s58 offen offset:0 sc1
    v_mfma_f32_16x16x32_bf16 v[40:43], a[24:27], v[132:135], v[40:43]
    ds_write_b128 v232, v[48:51] offset:0
    v_mfma_f32_16x16x32_bf16 v[44:47], a[28:31], v[132:135], v[44:47]
    ds_write_b128 v232, v[52:55] offset:1024
    s_waitcnt vmcnt(9)
    v_mfma_f32_16x16x32_bf16 v[32:35], a[32:35], v[136:139], v[32:35]
    s_add_u32 s58, s58, 1024
    s_cmp_eq_u32 s58, s86
    s_cselect_b32 s58, s66, s58
    v_mfma_f32_16x16x32_bf16 v[36:39], a[36:39], v[136:139], v[36:39]
    buffer_load_dwordx4 v[128:131], v23, s[24:27], s58 offen offset:0 sc1
    v_mfma_f32_16x16x32_bf16 v[40:43], a[40:43], v[136:139], v[40:43]
    ds_write_b128 v232, v[56:59] offset:2048
    v_mfma_f32_16x16x32_bf16 v[44:47], a[44:47], v[136:139], v[44:47]
    ds_write_b128 v232, v[60:63] offset:3072
    s_waitcnt vmcnt(9)
    v_mfma_f32_16x16x32_bf16 v[32:35], a[48:51], v[140:143], v[32:35]
    s_add_u32 s58, s66, 13312
    v_mfma_f32_16x16x32_bf16 v[36:39], a[52:55], v[140:143], v[36:39]
    buffer_load_dwordx4 v[132:135], v23, s[24:27], s58 offen offset:0 sc1
    v_mfma_f32_16x16x32_bf16 v[40:43], a[56:59], v[140:143], v[40:43]
    v_mfma_f32_16x16x32_bf16 v[44:47], a[60:63], v[140:143], v[44:47]
    s_waitcnt vmcnt(9)
    v_mfma_f32_16x16x32_bf16 v[32:35], a[64:67], v[144:147], v[32:35]
    s_add_u32 s58, s66, 14336
    v_mfma_f32_16x16x32_bf16 v[36:39], a[68:71], v[144:147], v[36:39]
    buffer_load_dwordx4 v[136:139], v23, s[24:27], s58 offen offset:0 sc1
    v_mfma_f32_16x16x32_bf16 v[40:43], a[72:75], v[144:147], v[40:43]
    v_mfma_f32_16x16x32_bf16 v[44:47], a[76:79], v[144:147], v[44:47]
    s_waitcnt vmcnt(9)
    v_mfma_f32_16x16x32_bf16 v[32:35], a[80:83], v[148:151], v[32:35]
    s_add_u32 s58, s66, 15360
    v_mfma_f32_16x16x32_bf16 v[36:39], a[84:87], v[148:151], v[36:39]
    buffer_load_dwordx4 v[140:143], v23, s[24:27], s58 offen offset:0 sc1
    v_mfma_f32_16x16x32_bf16 v[40:43], a[88:91], v[148:151], v[40:43]
    s_waitcnt lgkmcnt(0)
    s_barrier
    v_mfma_f32_16x16x32_bf16 v[44:47], a[92:95], v[148:151], v[44:47]
    buffer_load_dwordx4 v[216:219], v22, s[4:7], s71 offen
    s_waitcnt vmcnt(10)
    v_mfma_f32_16x16x32_bf16 v[32:35], a[96:99], v[152:155], v[32:35]
    ds_read_b128 v[160:163], v233 offset:0
    v_mfma_f32_16x16x32_bf16 v[36:39], a[100:103], v[152:155], v[36:39]
    ds_read_b128 v[176:179], v234 offset:16384
    v_mfma_f32_16x16x32_bf16 v[40:43], a[104:107], v[152:155], v[40:43]
    ds_read_b128 v[192:195], v235 offset:32768
    v_mfma_f32_16x16x32_bf16 v[44:47], a[108:111], v[152:155], v[44:47]
    buffer_load_dwordx4 v[220:223], v22, s[4:7], s72 offen
    s_waitcnt vmcnt(10)
    v_mfma_f32_16x16x32_bf16 v[32:35], a[112:115], v[156:159], v[32:35]
    ds_read_b128 v[164:167], v233 offset:1024
    v_mfma_f32_16x16x32_bf16 v[36:39], a[116:119], v[156:159], v[36:39]
    ds_read_b128 v[180:183], v234 offset:17408
    v_mfma_f32_16x16x32_bf16 v[40:43], a[120:123], v[156:159], v[40:43]
    ds_read_b128 v[196:199], v235 offset:33792
    v_mfma_f32_16x16x32_bf16 v[44:47], a[124:127], v[156:159], v[44:47]
    buffer_load_dwordx2 v[224:225], v26, s[4:7], s73 offen
    s_waitcnt vmcnt(10)
    v_mfma_f32_16x16x32_bf16 v[32:35], a[128:131], v[112:115], v[32:35]
    ds_read_b128 v[168:171], v233 offset:2048
    v_mfma_f32_16x16x32_bf16 v[36:39], a[132:135], v[112:115], v[36:39]
    ds_read_b128 v[184:187], v234 offset:18432
    v_mfma_f32_16x16x32_bf16 v[40:43], a[136:139], v[112:115], v[40:43]
    ds_read_b128 v[200:203], v235 offset:34816
    v_mfma_f32_16x16x32_bf16 v[44:47], a[140:143], v[112:115], v[44:47]
    buffer_load_ushort v228, v25, s[36:39], s74 offen
    s_waitcnt vmcnt(10)
    v_mfma_f32_16x16x32_bf16 v[32:35], a[144:147], v[116:119], v[32:35]
    ds_read_b128 v[172:175], v233 offset:3072
    v_mfma_f32_16x16x32_bf16 v[36:39], a[148:151], v[116:119], v[36:39]
    ds_read_b128 v[188:191], v234 offset:19456
    v_mfma_f32_16x16x32_bf16 v[40:43], a[152:155], v[116:119], v[40:43]
    ds_read_b128 v[204:207], v235 offset:35840
    v_mfma_f32_16x16x32_bf16 v[44:47], a[156:159], v[116:119], v[44:47]
    s_add_u32 m0, s52, 81920
    s_lshl_b32 s57, s76, 7
    buffer_load_dwordx4 v12, s[20:23], s57 offen offset:0 lds
    s_waitcnt vmcnt(10)
    v_mfma_f32_16x16x32_bf16 v[32:35], a[160:163], v[120:123], v[32:35]
    v_mfma_f32_16x16x32_bf16 v[36:39], a[164:167], v[120:123], v[36:39]
    v_mfma_f32_16x16x32_bf16 v[40:43], a[168:171], v[120:123], v[40:43]
    v_mfma_f32_16x16x32_bf16 v[44:47], a[172:175], v[120:123], v[44:47]
    s_add_u32 s57, s57, 31744
    buffer_load_dwordx4 v12, s[20:23], s57 offen offset:1024 lds
    s_waitcnt vmcnt(10)
    v_mfma_f32_16x16x32_bf16 v[32:35], a[176:179], v[124:127], v[32:35]
    s_waitcnt lgkmcnt(9)
    v_mfma_f32_16x16x32_bf16 v[36:39], a[180:183], v[124:127], v[36:39]
    v_add_f32 v160, v160, v176
    v_mfma_f32_16x16x32_bf16 v[40:43], a[184:187], v[124:127], v[40:43]
    v_add_f32 v161, v161, v177
    v_mfma_f32_16x16x32_bf16 v[44:47], a[188:191], v[124:127], v[44:47]
    v_add_f32 v162, v162, v178
    s_add_u32 s57, s57, 31744
    buffer_load_dwordx4 v12, s[20:23], s57 offen offset:2048 lds
    s_waitcnt vmcnt(10)
    v_mfma_f32_16x16x32_bf16 v[32:35], a[192:195], v[128:131], v[32:35]
    v_add_f32 v163, v163, v179
    v_mfma_f32_16x16x32_bf16 v[36:39], a[196:199], v[128:131], v[36:39]
    s_waitcnt lgkmcnt(6)
    v_mfma_f32_16x16x32_bf16 v[40:43], a[200:203], v[128:131], v[40:43]
    v_add_f32 v164, v164, v180
    v_mfma_f32_16x16x32_bf16 v[44:47], a[204:207], v[128:131], v[44:47]
    v_add_f32 v165, v165, v181
    s_add_u32 s57, s57, 31744
    buffer_load_dwordx4 v12, s[20:23], s57 offen offset:3072 lds
    s_waitcnt vmcnt(10)
    v_mfma_f32_16x16x32_bf16 v[32:35], a[208:211], v[132:135], v[32:35]
    v_add_f32 v166, v166, v182
    v_mfma_f32_16x16x32_bf16 v[36:39], a[212:215], v[132:135], v[36:39]
    v_add_f32 v167, v167, v183
    v_mfma_f32_16x16x32_bf16 v[40:43], a[216:219], v[132:135], v[40:43]
    s_waitcnt lgkmcnt(3)
    v_mfma_f32_16x16x32_bf16 v[44:47], a[220:223], v[132:135], v[44:47]
    v_add_f32 v168, v168, v184
    s_add_u32 m0, s52, 98304
    s_lshl_b32 s57, s76, 7
    s_add_u32 s57, s57, 131072
    buffer_load_dwordx4 v12, s[20:23], s57 offen offset:0 lds
    s_waitcnt vmcnt(10)
    v_mfma_f32_16x16x32_bf16 v[32:35], a[224:227], v[136:139], v[32:35]
    v_add_f32 v169, v169, v185
    v_mfma_f32_16x16x32_bf16 v[36:39], a[228:231], v[136:139], v[36:39]
    v_add_f32 v170, v170, v186
    v_mfma_f32_16x16x32_bf16 v[40:43], a[232:235], v[136:139], v[40:43]
    v_add_f32 v171, v171, v187
    v_mfma_f32_16x16x32_bf16 v[44:47], a[236:239], v[136:139], v[44:47]
    s_waitcnt lgkmcnt(0)
    s_add_u32 s57, s57, 31744
    buffer_load_dwordx4 v12, s[20:23], s57 offen offset:1024 lds
    s_waitcnt vmcnt(10)
    v_mfma_f32_16x16x32_bf16 v[32:35], a[240:243], v[140:143], v[32:35]
    v_add_f32 v172, v172, v188
    v_mfma_f32_16x16x32_bf16 v[36:39], a[244:247], v[140:143], v[36:39]
    v_add_f32 v173, v173, v189
    v_mfma_f32_16x16x32_bf16 v[40:43], a[248:251], v[140:143], v[40:43]
    v_add_f32 v174, v174, v190
    v_mfma_f32_16x16x32_bf16 v[44:47], a[252:255], v[140:143], v[44:47]
    v_add_f32 v175, v175, v191
    v_pk_add_f32 v[160:161], v[160:161], v[192:193]
    v_pk_add_f32 v[162:163], v[162:163], v[194:195]
    v_pk_add_f32 v[164:165], v[164:165], v[196:197]
    v_pk_add_f32 v[166:167], v[166:167], v[198:199]
    v_pk_add_f32 v[168:169], v[168:169], v[200:201]
    v_pk_add_f32 v[170:171], v[170:171], v[202:203]
    v_pk_add_f32 v[172:173], v[172:173], v[204:205]
    v_pk_add_f32 v[174:175], v[174:175], v[206:207]
    buffer_store_dwordx4 v[96:99], v23, s[24:27], s83 offen sc1
    s_add_u32 s57, s57, 31744
    buffer_load_dwordx4 v12, s[20:23], s57 offen offset:2048 lds
    v_pk_add_f32 v[32:33], v[32:33], v[160:161]
    v_pk_add_f32 v[34:35], v[34:35], v[162:163]
    v_pk_add_f32 v[36:37], v[36:37], v[164:165]
    v_pk_add_f32 v[38:39], v[38:39], v[166:167]
    v_pk_mul_f32 v[48:49], v[32:33], v[32:33]
    v_pk_mul_f32 v[50:51], v[34:35], v[34:35]
    v_pk_mul_f32 v[52:53], v[36:37], v[36:37]
    v_pk_mul_f32 v[54:55], v[38:39], v[38:39]
    s_add_u32 s57, s57, 31744
    buffer_load_dwordx4 v12, s[20:23], s57 offen offset:3072 lds
    v_pk_fma_f32 v[48:49], v[48:49], v[236:237], v[236:237] op_sel:[0,0,1] op_sel_hi:[1,0,1]
    v_pk_fma_f32 v[50:51], v[50:51], v[236:237], v[236:237] op_sel:[0,0,1] op_sel_hi:[1,0,1]
    v_pk_fma_f32 v[52:53], v[52:53], v[236:237], v[236:237] op_sel:[0,0,1] op_sel_hi:[1,0,1]
    v_pk_fma_f32 v[54:55], v[54:55], v[236:237], v[236:237] op_sel:[0,0,1] op_sel_hi:[1,0,1]
    v_pk_mul_f32 v[48:49], v[48:49], v[32:33]
    v_pk_mul_f32 v[50:51], v[50:51], v[34:35]
    v_pk_mul_f32 v[52:53], v[52:53], v[36:37]
    v_pk_mul_f32 v[54:55], v[54:55], v[38:39]
    s_add_u32 m0, s52, 114688
    s_lshl_b32 s57, s77, 7
    buffer_load_dwordx4 v12, s[20:23], s57 offen offset:0 lds
    v_exp_f32 v48, v48
    v_exp_f32 v49, v49
    v_exp_f32 v50, v50
    v_exp_f32 v51, v51
    v_exp_f32 v52, v52
    v_exp_f32 v53, v53
    v_exp_f32 v54, v54
    v_exp_f32 v55, v55
    v_pk_add_f32 v[48:49], v[48:49], 1.0 op_sel_hi:[1,0]
    v_pk_add_f32 v[50:51], v[50:51], 1.0 op_sel_hi:[1,0]
    v_pk_add_f32 v[52:53], v[52:53], 1.0 op_sel_hi:[1,0]
    v_pk_add_f32 v[54:55], v[54:55], 1.0 op_sel_hi:[1,0]
    s_add_u32 s57, s57, 31744
    buffer_load_dwordx4 v12, s[20:23], s57 offen offset:1024 lds
    v_rcp_f32 v48, v48
    v_rcp_f32 v49, v49
    v_rcp_f32 v50, v50
    v_rcp_f32 v51, v51
    v_rcp_f32 v52, v52
    v_rcp_f32 v53, v53
    v_rcp_f32 v54, v54
    v_rcp_f32 v55, v55
    s_add_u32 s57, s57, 31744
    buffer_load_dwordx4 v12, s[20:23], s57 offen offset:2048 lds
    v_pk_mul_f32 v[48:49], v[48:49], v[32:33]
    v_pk_mul_f32 v[50:51], v[50:51], v[34:35]
    v_pk_mul_f32 v[52:53], v[52:53], v[36:37]
    v_pk_mul_f32 v[54:55], v[54:55], v[38:39]
    v_cvt_pk_bf16_f32 v56, v48, v49
    v_cvt_pk_bf16_f32 v57, v50, v51
    v_cvt_pk_bf16_f32 v58, v52, v53
    v_cvt_pk_bf16_f32 v59, v54, v55
    buffer_store_dwordx4 v[56:59], v23, s[24:27], s67 offen offset:0 sc1
    v_pk_add_f32 v[40:41], v[40:41], v[168:169]
    v_pk_add_f32 v[42:43], v[42:43], v[170:171]
    v_pk_add_f32 v[44:45], v[44:45], v[172:173]
    v_pk_add_f32 v[46:47], v[46:47], v[174:175]
    s_add_u32 s57, s57, 31744
    buffer_load_dwordx4 v12, s[20:23], s57 offen offset:3072 lds
    v_pk_mul_f32 v[48:49], v[40:41], v[40:41]
    v_pk_mul_f32 v[50:51], v[42:43], v[42:43]
    v_pk_mul_f32 v[52:53], v[44:45], v[44:45]
    v_pk_mul_f32 v[54:55], v[46:47], v[46:47]
    v_pk_fma_f32 v[48:49], v[48:49], v[236:237], v[236:237] op_sel:[0,0,1] op_sel_hi:[1,0,1]
    v_pk_fma_f32 v[50:51], v[50:51], v[236:237], v[236:237] op_sel:[0,0,1] op_sel_hi:[1,0,1]
    v_pk_fma_f32 v[52:53], v[52:53], v[236:237], v[236:237] op_sel:[0,0,1] op_sel_hi:[1,0,1]
    v_pk_fma_f32 v[54:55], v[54:55], v[236:237], v[236:237] op_sel:[0,0,1] op_sel_hi:[1,0,1]
    s_add_u32 m0, s52, 131072
    s_lshl_b32 s57, s77, 7
    s_add_u32 s57, s57, 131072
    buffer_load_dwordx4 v12, s[20:23], s57 offen offset:0 lds
    v_pk_mul_f32 v[48:49], v[48:49], v[40:41]
    v_pk_mul_f32 v[50:51], v[50:51], v[42:43]
    v_pk_mul_f32 v[52:53], v[52:53], v[44:45]
    v_pk_mul_f32 v[54:55], v[54:55], v[46:47]
    v_exp_f32 v48, v48
    v_exp_f32 v49, v49
    v_exp_f32 v50, v50
    v_exp_f32 v51, v51
    v_exp_f32 v52, v52
    v_exp_f32 v53, v53
    v_exp_f32 v54, v54
    v_exp_f32 v55, v55
    s_add_u32 s57, s57, 31744
    buffer_load_dwordx4 v12, s[20:23], s57 offen offset:1024 lds
    s_waitcnt vmcnt(12)
    ds_read_b64_tr_b16 a[0:1], v6 offset:32768
    ds_read_b64_tr_b16 a[2:3], v6 offset:34816
    ds_read_b64_tr_b16 a[4:5], v7 offset:32768
    ds_read_b64_tr_b16 a[6:7], v7 offset:34816
    v_pk_add_f32 v[48:49], v[48:49], 1.0 op_sel_hi:[1,0]
    v_pk_add_f32 v[50:51], v[50:51], 1.0 op_sel_hi:[1,0]
    v_pk_add_f32 v[52:53], v[52:53], 1.0 op_sel_hi:[1,0]
    v_pk_add_f32 v[54:55], v[54:55], 1.0 op_sel_hi:[1,0]
    ds_read_b64_tr_b16 a[8:9], v6 offset:33024
    ds_read_b64_tr_b16 a[10:11], v6 offset:35072
    ds_read_b64_tr_b16 a[12:13], v7 offset:33024
    ds_read_b64_tr_b16 a[14:15], v7 offset:35072
    s_add_u32 s57, s57, 31744
    buffer_load_dwordx4 v12, s[20:23], s57 offen offset:2048 lds
    v_rcp_f32 v48, v48
    v_rcp_f32 v49, v49
    v_rcp_f32 v50, v50
    v_rcp_f32 v51, v51
    v_rcp_f32 v52, v52
    v_rcp_f32 v53, v53
    v_rcp_f32 v54, v54
    v_rcp_f32 v55, v55
    s_add_u32 s57, s57, 31744
    buffer_load_dwordx4 v12, s[20:23], s57 offen offset:3072 lds
    v_pk_mul_f32 v[48:49], v[48:49], v[40:41]
    v_pk_mul_f32 v[50:51], v[50:51], v[42:43]
    v_pk_mul_f32 v[52:53], v[52:53], v[44:45]
    v_pk_mul_f32 v[54:55], v[54:55], v[46:47]
    v_cvt_pk_bf16_f32 v60, v48, v49
    v_cvt_pk_bf16_f32 v61, v50, v51
    v_cvt_pk_bf16_f32 v62, v52, v53
    v_cvt_pk_bf16_f32 v63, v54, v55
    buffer_store_dwordx4 v[60:63], v23, s[24:27], s67 offen offset:1024 sc1
    s_add_u32 m0, s52, 147456
    s_lshl_b32 s57, s78, 7
    buffer_load_dwordx4 v12, s[20:23], s57 offen offset:0 lds
    s_add_u32 s57, s57, 31744
    buffer_load_dwordx4 v12, s[20:23], s57 offen offset:1024 lds
    s_waitcnt vmcnt(12)
    ds_read_b64_tr_b16 a[16:17], v6 offset:49152
    ds_read_b64_tr_b16 a[18:19], v6 offset:51200
    ds_read_b64_tr_b16 a[20:21], v7 offset:49152
    ds_read_b64_tr_b16 a[22:23], v7 offset:51200
    s_add_u32 s57, s57, 31744
    buffer_load_dwordx4 v12, s[20:23], s57 offen offset:2048 lds
    ds_read_b64_tr_b16 a[24:25], v6 offset:49408
    ds_read_b64_tr_b16 a[26:27], v6 offset:51456
    ds_read_b64_tr_b16 a[28:29], v7 offset:49408
    ds_read_b64_tr_b16 a[30:31], v7 offset:51456
    s_add_u32 s57, s57, 31744
    buffer_load_dwordx4 v12, s[20:23], s57 offen offset:3072 lds
    s_add_u32 m0, s52, 49152
    s_lshl_b32 s57, s78, 7
    s_add_u32 s57, s57, 131072
    buffer_load_dwordx4 v12, s[20:23], s57 offen offset:0 lds
    s_add_u32 s57, s57, 31744
    buffer_load_dwordx4 v12, s[20:23], s57 offen offset:1024 lds
    s_waitcnt vmcnt(11)
    ds_read_b64_tr_b16 a[32:33], v8 offset:0
    ds_read_b64_tr_b16 a[34:35], v8 offset:2048
    ds_read_b64_tr_b16 a[36:37], v9 offset:0
    ds_read_b64_tr_b16 a[38:39], v9 offset:2048
    s_add_u32 s57, s57, 31744
    buffer_load_dwordx4 v12, s[20:23], s57 offen offset:2048 lds
    ds_read_b64_tr_b16 a[40:41], v8 offset:256
    ds_read_b64_tr_b16 a[42:43], v8 offset:2304
    ds_read_b64_tr_b16 a[44:45], v9 offset:256
    ds_read_b64_tr_b16 a[46:47], v9 offset:2304
    s_add_u32 s57, s57, 31744
    buffer_load_dwordx4 v12, s[20:23], s57 offen offset:3072 lds
    s_add_u32 m0, s52, 65536
    s_lshl_b32 s57, s79, 7
    buffer_load_dwordx4 v12, s[20:23], s57 offen offset:0 lds
    s_add_u32 s57, s57, 31744
    buffer_load_dwordx4 v12, s[20:23], s57 offen offset:1024 lds
    s_waitcnt vmcnt(11)
    ds_read_b64_tr_b16 a[48:49], v8 offset:16384
    ds_read_b64_tr_b16 a[50:51], v8 offset:18432
    ds_read_b64_tr_b16 a[52:53], v9 offset:16384
    ds_read_b64_tr_b16 a[54:55], v9 offset:18432
    s_add_u32 s57, s57, 31744
    buffer_load_dwordx4 v12, s[20:23], s57 offen offset:2048 lds
    ds_read_b64_tr_b16 a[56:57], v8 offset:16640
    ds_read_b64_tr_b16 a[58:59], v8 offset:18688
    ds_read_b64_tr_b16 a[60:61], v9 offset:16640
    ds_read_b64_tr_b16 a[62:63], v9 offset:18688
    s_waitcnt vmcnt(11)
    s_barrier
    s_cmp_lg_u32 s44, 0
    s_cbranch_scc1 L_nopub6
    s_lshl_b32 s60, s51, 5
    s_add_u32 s60, s60, s50
    s_lshl_b32 s60, s60, 7
    s_add_u32 s60, s60, 12713984
    v_mov_b32 v30, s47
    s_mov_b64 exec, 1
    buffer_store_dword v30, off, s[24:27], s60 sc1
    s_mov_b64 exec, -1
L_nopub6:
L_p3join:
    s_add_u32 s57, s57, 31744
    buffer_load_dwordx4 v12, s[20:23], s57 offen offset:3072 lds
    v_lshlrev_b32 v176, 16, v216
    v_and_b32 v177, s61, v216
    v_lshlrev_b32 v178, 16, v217
    v_and_b32 v179, s61, v217
    s_waitcnt lgkmcnt(15)
    s_add_u32 m0, s52, 81920
    s_lshl_b32 s57, s79, 7
    s_add_u32 s57, s57, 131072
    buffer_load_dwordx4 v12, s[20:23], s57 offen offset:0 lds
    v_lshlrev_b32 v180, 16, v218
    v_and_b32 v181, s61, v218
    v_lshlrev_b32 v182, 16, v219
    v_and_b32 v183, s61, v219
    s_add_u32 s57, s57, 31744
    buffer_load_dwordx4 v12, s[20:23], s57 offen offset:1024 lds
    s_waitcnt vmcnt(10)
    ds_read_b64_tr_b16 a[64:65], v8 offset:32768
    ds_read_b64_tr_b16 a[66:67], v8 offset:34816
    ds_read_b64_tr_b16 a[68:69], v9 offset:32768
    ds_read_b64_tr_b16 a[70:71], v9 offset:34816
    v_lshlrev_b32 v184, 16, v220
    v_and_b32 v185, s61, v220
    v_lshlrev_b32 v186, 16, v221
    v_and_b32 v187, s61, v221
    ds_read_b64_tr_b16 a[72:73], v8 offset:33024
    ds_read_b64_tr_b16 a[74:75], v8 offset:35072
    ds_read_b64_tr_b16 a[76:77], v9 offset:33024
    ds_read_b64_tr_b16 a[78:79], v9 offset:35072
    s_add_u32 s57, s57, 31744
    buffer_load_dwordx4 v12, s[20:23], s57 offen offset:2048 lds
    v_lshlrev_b32 v188, 16, v222
    v_and_b32 v189, s61, v222
    v_lshlrev_b32 v190, 16, v223
    v_and_b32 v191, s61, v223
    s_add_u32 s57, s57, 31744
    buffer_load_dwordx4 v12, s[20:23], s57 offen offset:3072 lds
    v_lshlrev_b32 v248, 16, v224
    v_and_b32 v249, s61, v224
    v_lshlrev_b32 v250, 16, v225
    v_and_b32 v251, s61, v225
    s_add_u32 m0, s52, 98304
    s_lshl_b32 s57, s80, 7
    buffer_load_dwordx4 v12, s[20:23], s57 offen offset:0 lds
    v_lshlrev_b32 v231, 16, v228
    v_lshlrev_b32 v230, 16, v228
    v_lshlrev_b32 v229, 16, v228
    v_lshlrev_b32 v228, 16, v228
    s_add_u32 s57, s57, 31744
    buffer_load_dwordx4 v12, s[20:23], s57 offen offset:1024 lds
    s_waitcnt vmcnt(10)
    ds_read_b64_tr_b16 a[80:81], v6 offset:0
    ds_read_b64_tr_b16 a[82:83], v6 offset:2048
    ds_read_b64_tr_b16 a[84:85], v7 offset:0
    ds_read_b64_tr_b16 a[86:87], v7 offset:2048
    s_add_u32 s57, s57, 31744
    buffer_load_dwordx4 v12, s[20:23], s57 offen offset:2048 lds
    ds_read_b64_tr_b16 a[88:89], v6 offset:256
    ds_read_b64_tr_b16 a[90:91], v6 offset:2304
    ds_read_b64_tr_b16 a[92:93], v7 offset:256
    ds_read_b64_tr_b16 a[94:95], v7 offset:2304
    s_add_u32 s57, s57, 31744
    buffer_load_dwordx4 v12, s[20:23], s57 offen offset:3072 lds
    s_waitcnt lgkmcnt(15)
    s_add_u32 m0, s52, 114688
    s_lshl_b32 s57, s80, 7
    s_add_u32 s57, s57, 131072
    buffer_load_dwordx4 v12, s[20:23], s57 offen offset:0 lds
    s_add_u32 s57, s57, 31744
    buffer_load_dwordx4 v12, s[20:23], s57 offen offset:1024 lds
    s_waitcnt vmcnt(10)
    ds_read_b64_tr_b16 a[96:97], v6 offset:16384
    ds_read_b64_tr_b16 a[98:99], v6 offset:18432
    ds_read_b64_tr_b16 a[100:101], v7 offset:16384
    ds_read_b64_tr_b16 a[102:103], v7 offset:18432
    s_add_u32 s57, s57, 31744
    buffer_load_dwordx4 v12, s[20:23], s57 offen offset:2048 lds
    ds_read_b64_tr_b16 a[104:105], v6 offset:16640
    ds_read_b64_tr_b16 a[106:107], v6 offset:18688
    ds_read_b64_tr_b16 a[108:109], v7 offset:16640
    ds_read_b64_tr_b16 a[110:111], v7 offset:18688
    s_add_u32 s57, s57, 31744
    buffer_load_dwordx4 v12, s[20:23], s57 offen offset:3072 lds
    s_add_u32 m0, s52, 131072
    s_lshl_b32 s57, s81, 7
    buffer_load_dwordx4 v12, s[20:23], s57 offen offset:0 lds
    s_add_u32 s57, s57, 31744
    buffer_load_dwordx4 v12, s[20:23], s57 offen offset:1024 lds
    s_waitcnt vmcnt(10)
    ds_read_b64_tr_b16 a[112:113], v6 offset:32768
    ds_read_b64_tr_b16 a[114:115], v6 offset:34816
    ds_read_b64_tr_b16 a[116:117], v7 offset:32768
    ds_read_b64_tr_b16 a[118:119], v7 offset:34816
    s_add_u32 s57, s57, 31744
    buffer_load_dwordx4 v12, s[20:23], s57 offen offset:2048 lds
    ds_read_b64_tr_b16 a[120:121], v6 offset:33024
    ds_read_b64_tr_b16 a[122:123], v6 offset:35072
    ds_read_b64_tr_b16 a[124:125], v7 offset:33024
    ds_read_b64_tr_b16 a[126:127], v7 offset:35072
    s_add_u32 s57, s57, 31744
    buffer_load_dwordx4 v12, s[20:23], s57 offen offset:3072 lds
    s_waitcnt lgkmcnt(15)
    s_add_u32 m0, s52, 147456
    s_lshl_b32 s57, s81, 7
    s_add_u32 s57, s57, 131072
    buffer_load_dwordx4 v12, s[20:23], s57 offen offset:0 lds
    s_add_u32 s57, s57, 31744
    buffer_load_dwordx4 v12, s[20:23], s57 offen offset:1024 lds
    s_waitcnt vmcnt(10)
    ds_read_b64_tr_b16 a[128:129], v6 offset:49152
    ds_read_b64_tr_b16 a[130:131], v6 offset:51200
    ds_read_b64_tr_b16 a[132:133], v7 offset:49152
    ds_read_b64_tr_b16 a[134:135], v7 offset:51200
    s_add_u32 s57, s57, 31744
    buffer_load_dwordx4 v12, s[20:23], s57 offen offset:2048 lds
    ds_read_b64_tr_b16 a[136:137], v6 offset:49408
    ds_read_b64_tr_b16 a[138:139], v6 offset:51456
    ds_read_b64_tr_b16 a[140:141], v7 offset:49408
    ds_read_b64_tr_b16 a[142:143], v7 offset:51456
    s_add_u32 s57, s57, 31744
    buffer_load_dwordx4 v12, s[20:23], s57 offen offset:3072 lds
    s_add_u32 m0, s52, 49152
    s_lshl_b32 s57, s82, 7
    buffer_load_dwordx4 v12, s[20:23], s57 offen offset:0 lds
    s_add_u32 s57, s57, 31744
    buffer_load_dwordx4 v12, s[20:23], s57 offen offset:1024 lds
    s_waitcnt vmcnt(10)
    ds_read_b64_tr_b16 a[144:145], v8 offset:0
    ds_read_b64_tr_b16 a[146:147], v8 offset:2048
    ds_read_b64_tr_b16 a[148:149], v9 offset:0
    ds_read_b64_tr_b16 a[150:151], v9 offset:2048
    s_add_u32 s57, s57, 31744
    buffer_load_dwordx4 v12, s[20:23], s57 offen offset:2048 lds
    ds_read_b64_tr_b16 a[152:153], v8 offset:256
    ds_read_b64_tr_b16 a[154:155], v8 offset:2304
    ds_read_b64_tr_b16 a[156:157], v9 offset:256
    ds_read_b64_tr_b16 a[158:159], v9 offset:2304
    s_add_u32 s57, s57, 31744
    buffer_load_dwordx4 v12, s[20:23], s57 offen offset:3072 lds
    s_waitcnt lgkmcnt(15)
    s_add_u32 m0, s52, 65536
    s_lshl_b32 s57, s82, 7
    s_add_u32 s57, s57, 131072
    buffer_load_dwordx4 v12, s[20:23], s57 offen offset:0 lds
    s_add_u32 s57, s57, 31744
    buffer_load_dwordx4 v12, s[20:23], s57 offen offset:1024 lds
    s_waitcnt vmcnt(10)
    ds_read_b64_tr_b16 a[160:161], v8 offset:16384
    ds_read_b64_tr_b16 a[162:163], v8 offset:18432
    ds_read_b64_tr_b16 a[164:165], v9 offset:16384
    ds_read_b64_tr_b16 a[166:167], v9 offset:18432
    s_add_u32 s57, s57, 31744
    buffer_load_dwordx4 v12, s[20:23], s57 offen offset:2048 lds
    ds_read_b64_tr_b16 a[168:169], v8 offset:16640
    ds_read_b64_tr_b16 a[170:171], v8 offset:18688
    ds_read_b64_tr_b16 a[172:173], v9 offset:16640
    ds_read_b64_tr_b16 a[174:175], v9 offset:18688
    s_add_u32 s57, s57, 31744
    buffer_load_dwordx4 v12, s[20:23], s57 offen offset:3072 lds
    s_add_u32 m0, s52, 81920
    s_mov_b32 s57, s75
    buffer_load_dwordx4 v15, s[12:15], s57 offen offset:0 lds
    s_add_u32 s57, s57, 24064
    buffer_load_dwordx4 v15, s[12:15], s57 offen offset:1024 lds
    s_waitcnt vmcnt(10)
    ds_read_b64_tr_b16 a[176:177], v8 offset:32768
    ds_read_b64_tr_b16 a[178:179], v8 offset:34816
    ds_read_b64_tr_b16 a[180:181], v9 offset:32768
    ds_read_b64_tr_b16 a[182:183], v9 offset:34816
    s_add_u32 s57, s57, 24064
    buffer_load_dwordx4 v15, s[12:15], s57 offen offset:2048 lds
    ds_read_b64_tr_b16 a[184:185], v8 offset:33024
    ds_read_b64_tr_b16 a[186:187], v8 offset:35072
    ds_read_b64_tr_b16 a[188:189], v9 offset:33024
    ds_read_b64_tr_b16 a[190:191], v9 offset:35072
    s_add_u32 s57, s57, 24064
    buffer_load_dwordx4 v15, s[12:15], s57 offen offset:3072 lds
    s_waitcnt lgkmcnt(15)
    s_add_u32 m0, s52, 98304
    s_mov_b32 s57, 0
    buffer_load_dwordx4 v13, s[12:15], s57 offen offset:0 lds
    s_add_u32 s57, s57, 6144
    buffer_load_dwordx4 v14, s[12:15], s57 offen offset:1024 lds
    s_waitcnt vmcnt(10)
    ds_read_b64_tr_b16 a[192:193], v6 offset:0
    ds_read_b64_tr_b16 a[194:195], v6 offset:2048
    ds_read_b64_tr_b16 a[196:197], v7 offset:0
    ds_read_b64_tr_b16 a[198:199], v7 offset:2048
    s_add_u32 s57, s57, 6144
    buffer_load_dwordx4 v13, s[12:15], s57 offen offset:2048 lds
    ds_read_b64_tr_b16 a[200:201], v6 offset:256
    ds_read_b64_tr_b16 a[202:203], v6 offset:2304
    ds_read_b64_tr_b16 a[204:205], v7 offset:256
    ds_read_b64_tr_b16 a[206:207], v7 offset:2304
    s_add_u32 s57, s57, 6144
    buffer_load_dwordx4 v14, s[12:15], s57 offen offset:3072 lds
    s_add_u32 m0, s52, 114688
    s_mov_b32 s57, 25088
    buffer_load_dwordx4 v13, s[12:15], s57 offen offset:0 lds
    s_add_u32 s57, s57, 6144
    buffer_load_dwordx4 v14, s[12:15], s57 offen offset:1024 lds
    s_waitcnt vmcnt(10)
    ds_read_b64_tr_b16 a[208:209], v6 offset:16384
    ds_read_b64_tr_b16 a[210:211], v6 offset:18432
    ds_read_b64_tr_b16 a[212:213], v7 offset:16384
    ds_read_b64_tr_b16 a[214:215], v7 offset:18432
    buffer_load_dword v17, v20, s[24:27], 0 offen sc1
    ds_read_b64_tr_b16 a[216:217], v6 offset:16640
    ds_read_b64_tr_b16 a[218:219], v6 offset:18688
    ds_read_b64_tr_b16 a[220:221], v7 offset:16640
    ds_read_b64_tr_b16 a[222:223], v7 offset:18688
    s_add_u32 s57, s57, 6144
    buffer_load_dwordx4 v13, s[12:15], s57 offen offset:2048 lds
    s_add_u32 s57, s57, 6144
    buffer_load_dwordx4 v14, s[12:15], s57 offen offset:3072 lds
    s_waitcnt lgkmcnt(15)
    s_add_u32 m0, s52, 131072
    s_mov_b32 s57, 50176
    buffer_load_dwordx4 v13, s[12:15], s57 offen offset:0 lds
    s_add_u32 s57, s57, 6144
    buffer_load_dwordx4 v14, s[12:15], s57 offen offset:1024 lds
    s_add_u32 s57, s57, 6144
    buffer_load_dwordx4 v13, s[12:15], s57 offen offset:2048 lds
    s_add_u32 s57, s57, 6144
    buffer_load_dwordx4 v14, s[12:15], s57 offen offset:3072 lds
    s_add_u32 m0, s52, 147456
    s_mov_b32 s57, 75264
    buffer_load_dwordx4 v13, s[12:15], s57 offen offset:0 lds
    s_add_u32 s57, s57, 6144
    buffer_load_dwordx4 v14, s[12:15], s57 offen offset:1024 lds
    s_add_u32 s57, s57, 6144
    buffer_load_dwordx4 v13, s[12:15], s57 offen offset:2048 lds
    s_add_u32 s57, s57, 6144
    buffer_load_dwordx4 v14, s[12:15], s57 offen offset:3072 lds
    s_waitcnt vmcnt(10)
    v_cmp_ne_u32 vcc, s47, v17
    s_nop 0
    s_cbranch_vccz L_ok8
    s_mov_b32 s59, 20000
L_spin7:
    s_sleep 2
    buffer_load_dword v17, v20, s[24:27], 0 offen sc1
    s_waitcnt vmcnt(0)
    v_cmp_ne_u32 vcc, s47, v17
    s_nop 0
    s_cbranch_vccz L_ok8
    s_sub_u32 s59, s59, 1
    s_cbranch_scc0 L_spin7
L_ok8:
    s_cmp_ge_u32 s89, 4
    s_cbranch_scc1 L_p3_alt
    s_mov_b32 s66, s68
    s_add_u32 s58, s66, s76
    buffer_load_dwordx4 v[144:147], v23, s[24:27], s58 offen offset:0 sc1
    buffer_load_dwordx4 v[148:151], v23, s[24:27], s58 offen offset:1024 sc1
    s_add_u32 s58, s66, s77
    buffer_load_dwordx4 v[152:155], v23, s[24:27], s58 offen offset:0 sc1
    buffer_load_dwordx4 v[156:159], v23, s[24:27], s58 offen offset:1024 sc1
    s_add_u32 s58, s66, s78
    buffer_load_dwordx4 v[112:115], v23, s[24:27], s58 offen offset:0 sc1
    buffer_load_dwordx4 v[116:119], v23, s[24:27], s58 offen offset:1024 sc1
    s_add_u32 s58, s66, s79
    buffer_load_dwordx4 v[120:123], v23, s[24:27], s58 offen offset:0 sc1
    buffer_load_dwordx4 v[124:127], v23, s[24:27], s58 offen offset:1024 sc1
    s_add_u32 s58, s66, s80
    buffer_load_dwordx4 v[128:131], v23, s[24:27], s58 offen offset:0 sc1
    buffer_load_dwordx4 v[132:135], v23, s[24:27], s58 offen offset:1024 sc1
    s_waitcnt vmcnt(9)
    v_mfma_f32_16x16x32_bf16 v[96:99], v[144:147], a[0:3], v[228:231]
    s_add_u32 s58, s66, s81
    v_mfma_f32_16x16x32_bf16 v[100:103], v[144:147], a[4:7], 0
    buffer_load_dwordx4 v[136:139], v23, s[24:27], s58 offen offset:0 sc1
    v_mfma_f32_16x16x32_bf16 v[104:107], v[144:147], a[8:11], 0
    v_mfma_f32_16x16x32_bf16 v[108:111], v[144:147], a[12:15], 0
    s_waitcnt vmcnt(9)
    v_mfma_f32_16x16x32_bf16 v[96:99], v[148:151], a[16:19], v[96:99]
    v_mfma_f32_16x16x32_bf16 v[100:103], v[148:151], a[20:23], v[100:103]
    buffer_load_dwordx4 v[140:143], v23, s[24:27], s58 offen offset:1024 sc1
    v_mfma_f32_16x16x32_bf16 v[104:107], v[148:151], a[24:27], v[104:107]
    v_mfma_f32_16x16x32_bf16 v[108:111], v[148:151], a[28:31], v[108:111]
    s_waitcnt vmcnt(9)
    v_mfma_f32_16x16x32_bf16 v[96:99], v[152:155], a[32:35], v[96:99]
    s_add_u32 s58, s66, s82
    v_mfma_f32_16x16x32_bf16 v[100:103], v[152:155], a[36:39], v[100:103]
    buffer_load_dwordx4 v[144:147], v23, s[24:27], s58 offen offset:0 sc1
    v_mfma_f32_16x16x32_bf16 v[104:107], v[152:155], a[40:43], v[104:107]
    v_mfma_f32_16x16x32_bf16 v[108:111], v[152:155], a[44:47], v[108:111]
    s_waitcnt vmcnt(9)
    v_mfma_f32_16x16x32_bf16 v[96:99], v[156:159], a[48:51], v[96:99]
    v_mfma_f32_16x16x32_bf16 v[100:103], v[156:159], a[52:55], v[100:103]
    buffer_load_dwordx4 v[148:151], v23, s[24:27], s58 offen offset:1024 sc1
    v_mfma_f32_16x16x32_bf16 v[104:107], v[156:159], a[56:59], v[104:107]
    v_mfma_f32_16x16x32_bf16 v[108:111], v[156:159], a[60:63], v[108:111]
    s_waitcnt vmcnt(9)
    v_mfma_f32_16x16x32_bf16 v[96:99], v[112:115], a[64:67], v[96:99]
    s_add_u32 s66, s69, 175872
    s_add_u32 s58, s66, s76
    v_mfma_f32_16x16x32_bf16 v[100:103], v[112:115], a[68:71], v[100:103]
    buffer_load_dwordx4 v[152:155], v23, s[24:27], s58 offen offset:0 sc1
    v_mfma_f32_16x16x32_bf16 v[104:107], v[112:115], a[72:75], v[104:107]
    v_mfma_f32_16x16x32_bf16 v[108:111], v[112:115], a[76:79], v[108:111]
    s_waitcnt vmcnt(9)
    v_mfma_f32_16x16x32_bf16 v[96:99], v[116:119], a[80:83], v[96:99]
    v_mfma_f32_16x16x32_bf16 v[100:103], v[116:119], a[84:87], v[100:103]
    buffer_load_dwordx4 v[156:159], v23, s[24:27], s58 offen offset:1024 sc1
    v_mfma_f32_16x16x32_bf16 v[104:107], v[116:119], a[88:91], v[104:107]
    v_mfma_f32_16x16x32_bf16 v[108:111], v[116:119], a[92:95], v[108:111]
    s_waitcnt vmcnt(9)
    v_mfma_f32_16x16x32_bf16 v[96:99], v[120:123], a[96:99], v[96:99]
    s_add_u32 s58, s66, s77
    v_mfma_f32_16x16x32_bf16 v[100:103], v[120:123], a[100:103], v[100:103]
    buffer_load_dwordx4 v[112:115], v23, s[24:27], s58 offen offset:0 sc1
    v_mfma_f32_16x16x32_bf16 v[104:107], v[120:123], a[104:107], v[104:107]
    v_mfma_f32_16x16x32_bf16 v[108:111], v[120:123], a[108:111], v[108:111]
    s_waitcnt vmcnt(9)
    v_mfma_f32_16x16x32_bf16 v[96:99], v[124:127], a[112:115], v[96:99]
    v_mfma_f32_16x16x32_bf16 v[100:103], v[124:127], a[116:119], v[100:103]
    buffer_load_dwordx4 v[116:119], v23, s[24:27], s58 offen offset:1024 sc1
    v_mfma_f32_16x16x32_bf16 v[104:107], v[124:127], a[120:123], v[104:107]
    v_mfma_f32_16x16x32_bf16 v[108:111], v[124:127], a[124:127], v[108:111]
    s_waitcnt vmcnt(9)
    v_mfma_f32_16x16x32_bf16 v[96:99], v[128:131], a[128:131], v[96:99]
    s_add_u32 s58, s66, s78
    v_mfma_f32_16x16x32_bf16 v[100:103], v[128:131], a[132:135], v[100:103]
    buffer_load_dwordx4 v[120:123], v23, s[24:27], s58 offen offset:0 sc1
    v_mfma_f32_16x16x32_bf16 v[104:107], v[128:131], a[136:139], v[104:107]
    v_mfma_f32_16x16x32_bf16 v[108:111], v[128:131], a[140:143], v[108:111]
    s_waitcnt vmcnt(9)
    v_mfma_f32_16x16x32_bf16 v[96:99], v[132:135], a[144:147], v[96:99]
    v_mfma_f32_16x16x32_bf16 v[100:103], v[132:135], a[148:151], v[100:103]
    buffer_load_dwordx4 v[124:127], v23, s[24:27], s58 offen offset:1024 sc1
    v_mfma_f32_16x16x32_bf16 v[104:107], v[132:135], a[152:155], v[104:107]
    v_mfma_f32_16x16x32_bf16 v[108:111], v[132:135], a[156:159], v[108:111]
    s_waitcnt vmcnt(9)
    v_mfma_f32_16x16x32_bf16 v[96:99], v[136:139], a[160:163], v[96:99]
    s_add_u32 s58, s66, s79
    v_mfma_f32_16x16x32_bf16 v[100:103], v[136:139], a[164:167], v[100:103]
    buffer_load_dwordx4 v[128:131], v23, s[24:27], s58 offen offset:0 sc1
    v_mfma_f32_16x16x32_bf16 v[104:107], v[136:139], a[168:171], v[104:107]
    v_mfma_f32_16x16x32_bf16 v[108:111], v[136:139], a[172:175], v[108:111]
    s_waitcnt vmcnt(9)
    v_mfma_f32_16x16x32_bf16 v[96:99], v[140:143], a[176:179], v[96:99]
    v_mfma_f32_16x16x32_bf16 v[100:103], v[140:143], a[180:183], v[100:103]
    buffer_load_dwordx4 v[132:135], v23, s[24:27], s58 offen offset:1024 sc1
    v_mfma_f32_16x16x32_bf16 v[104:107], v[140:143], a[184:187], v[104:107]
    v_mfma_f32_16x16x32_bf16 v[108:111], v[140:143], a[188:191], v[108:111]
    s_waitcnt vmcnt(9)
    s_waitcnt lgkmcnt(8)
    v_mfma_f32_16x16x32_bf16 v[96:99], v[144:147], a[192:195], v[96:99]
    s_add_u32 s58, s66, s80
    v_mfma_f32_16x16x32_bf16 v[100:103], v[144:147], a[196:199], v[100:103]
    buffer_load_dwordx4 v[136:139], v23, s[24:27], s58 offen offset:0 sc1
    v_mfma_f32_16x16x32_bf16 v[104:107], v[144:147], a[200:203], v[104:107]
    v_mfma_f32_16x16x32_bf16 v[108:111], v[144:147], a[204:207], v[108:111]
    s_waitcnt vmcnt(9)
    s_waitcnt lgkmcnt(0)
    v_mfma_f32_16x16x32_bf16 v[96:99], v[148:151], a[208:211], v[96:99]
    v_mfma_f32_16x16x32_bf16 v[100:103], v[148:151], a[212:215], v[100:103]
    buffer_load_dwordx4 v[140:143], v23, s[24:27], s58 offen offset:1024 sc1
    v_mfma_f32_16x16x32_bf16 v[104:107], v[148:151], a[216:219], v[104:107]
    v_mfma_f32_16x16x32_bf16 v[108:111], v[148:151], a[220:223], v[108:111]
L_p3_join:
    s_waitcnt vmcnt(9)
    v_mfma_f32_16x16x32_bf16 v[80:83], v[152:155], a[0:3], v[228:231]
    s_add_u32 s58, s66, s81
    v_mfma_f32_16x16x32_bf16 v[84:87], v[152:155], a[4:7], 0
    buffer_load_dwordx4 v[144:147], v23, s[24:27], s58 offen offset:0 sc1
    v_mfma_f32_16x16x32_bf16 v[88:91], v[152:155], a[8:11], 0
    v_mfma_f32_16x16x32_bf16 v[92:95], v[152:155], a[12:15], 0
    s_waitcnt vmcnt(9)
    v_mfma_f32_16x16x32_bf16 v[80:83], v[156:159], a[16:19], v[80:83]
    v_mfma_f32_16x16x32_bf16 v[84:87], v[156:159], a[20:23], v[84:87]
    buffer_load_dwordx4 v[148:151], v23, s[24:27], s58 offen offset:1024 sc1
    v_mfma_f32_16x16x32_bf16 v[88:91], v[156:159], a[24:27], v[88:91]
    ds_write_b128 v232, v[100:103] offset:3072
    v_mfma_f32_16x16x32_bf16 v[92:95], v[156:159], a[28:31], v[92:95]
    s_waitcnt vmcnt(9)
    v_mfma_f32_16x16x32_bf16 v[80:83], v[112:115], a[32:35], v[80:83]
    s_add_u32 s58, s66, s82
    v_mfma_f32_16x16x32_bf16 v[84:87], v[112:115], a[36:39], v[84:87]
    buffer_load_dwordx4 v[152:155], v23, s[24:27], s58 offen offset:0 sc1
    v_mfma_f32_16x16x32_bf16 v[88:91], v[112:115], a[40:43], v[88:91]
    ds_write_b128 v232, v[104:107] offset:19456
    v_mfma_f32_16x16x32_bf16 v[92:95], v[112:115], a[44:47], v[92:95]
    s_waitcnt vmcnt(9)
    v_mfma_f32_16x16x32_bf16 v[80:83], v[116:119], a[48:51], v[80:83]
    v_mfma_f32_16x16x32_bf16 v[84:87], v[116:119], a[52:55], v[84:87]
    buffer_load_dwordx4 v[156:159], v23, s[24:27], s58 offen offset:1024 sc1
    v_mfma_f32_16x16x32_bf16 v[88:91], v[116:119], a[56:59], v[88:91]
    ds_write_b128 v232, v[108:111] offset:35840
    v_mfma_f32_16x16x32_bf16 v[92:95], v[116:119], a[60:63], v[92:95]
    s_waitcnt vmcnt(9)
    v_mfma_f32_16x16x32_bf16 v[80:83], v[120:123], a[64:67], v[80:83]
    s_add_u32 s66, s69, 117248
    s_add_u32 s58, s66, s76
    v_mfma_f32_16x16x32_bf16 v[84:87], v[120:123], a[68:71], v[84:87]
    buffer_load_dwordx4 v[112:115], v23, s[24:27], s58 offen offset:0 sc1
    v_mfma_f32_16x16x32_bf16 v[88:91], v[120:123], a[72:75], v[88:91]
    v_mfma_f32_16x16x32_bf16 v[92:95], v[120:123], a[76:79], v[92:95]
    s_waitcnt vmcnt(9)
    v_mfma_f32_16x16x32_bf16 v[80:83], v[124:127], a[80:83], v[80:83]
    v_mfma_f32_16x16x32_bf16 v[84:87], v[124:127], a[84:87], v[84:87]
    buffer_load_dwordx4 v[116:119], v23, s[24:27], s58 offen offset:1024 sc1
    v_mfma_f32_16x16x32_bf16 v[88:91], v[124:127], a[88:91], v[88:91]
    s_waitcnt lgkmcnt(0)
    s_barrier
    v_mfma_f32_16x16x32_bf16 v[92:95], v[124:127], a[92:95], v[92:95]
    s_waitcnt vmcnt(9)
    v_mfma_f32_16x16x32_bf16 v[80:83], v[128:131], a[96:99], v[80:83]
    s_add_u32 s58, s66, s77
    v_mfma_f32_16x16x32_bf16 v[84:87], v[128:131], a[100:103], v[84:87]
    buffer_load_dwordx4 v[120:123], v23, s[24:27], s58 offen offset:0 sc1
    v_mfma_f32_16x16x32_bf16 v[88:91], v[128:131], a[104:107], v[88:91]
    ds_read_b128 v[100:103], v233 offset:3072
    ds_read_b128 v[104:107], v234 offset:19456
    v_mfma_f32_16x16x32_bf16 v[92:95], v[128:131], a[108:111], v[92:95]
    ds_read_b128 v[108:111], v235 offset:35840
    s_waitcnt vmcnt(9)
    v_mfma_f32_16x16x32_bf16 v[80:83], v[132:135], a[112:115], v[80:83]
    v_mfma_f32_16x16x32_bf16 v[84:87], v[132:135], a[116:119], v[84:87]
    buffer_load_dwordx4 v[124:127], v23, s[24:27], s58 offen offset:1024 sc1
    v_mfma_f32_16x16x32_bf16 v[88:91], v[132:135], a[120:123], v[88:91]
    ds_read_b64_tr_b16 v[160:161], v16 offset:0
    v_mfma_f32_16x16x32_bf16 v[92:95], v[132:135], a[124:127], v[92:95]
    ds_read_b64_tr_b16 v[162:163], v16 offset:512
    s_waitcnt vmcnt(9)
    v_mfma_f32_16x16x32_bf16 v[80:83], v[136:139], a[128:131], v[80:83]
    s_add_u32 s58, s66, s78
    s_waitcnt lgkmcnt(2)
    v_mfma_f32_16x16x32_bf16 v[84:87], v[136:139], a[132:135], v[84:87]
    buffer_load_dwordx4 v[128:131], v23, s[24:27], s58 offen offset:0 sc1
    v_mfma_f32_16x16x32_bf16 v[88:91], v[136:139], a[136:139], v[88:91]
    v_add_f32 v96, v96, v100
    v_add_f32 v97, v97, v101
    ds_read_b64_tr_b16 v[164:165], v16 offset:1024
    v_mfma_f32_16x16x32_bf16 v[92:95], v[136:139], a[140:143], v[92:95]
    ds_read_b64_tr_b16 v[166:167], v16 offset:1536
    s_waitcnt vmcnt(9)
    v_mfma_f32_16x16x32_bf16 v[80:83], v[140:143], a[144:147], v[80:83]
    v_add_f32 v98, v98, v102
    v_mfma_f32_16x16x32_bf16 v[84:87], v[140:143], a[148:151], v[84:87]
    buffer_load_dwordx4 v[132:135], v23, s[24:27], s58 offen offset:1024 sc1
    v_mfma_f32_16x16x32_bf16 v[88:91], v[140:143], a[152:155], v[88:91]
    v_add_f32 v99, v99, v103
    v_add_f32 v96, v96, v104
    ds_read_b64_tr_b16 v[168:169], v16 offset:2048
    v_mfma_f32_16x16x32_bf16 v[92:95], v[140:143], a[156:159], v[92:95]
    ds_read_b64_tr_b16 v[170:171], v16 offset:2560
    s_waitcnt vmcnt(9)
    v_mfma_f32_16x16x32_bf16 v[80:83], v[144:147], a[160:163], v[80:83]
    s_add_u32 s58, s66, s79
    v_add_f32 v97, v97, v105
    v_mfma_f32_16x16x32_bf16 v[84:87], v[144:147], a[164:167], v[84:87]
    buffer_load_dwordx4 v[136:139], v23, s[24:27], s58 offen offset:0 sc1
    v_mfma_f32_16x16x32_bf16 v[88:91], v[144:147], a[168:171], v[88:91]
    v_add_f32 v98, v98, v106
    v_add_f32 v99, v99, v107
    ds_read_b64_tr_b16 v[172:173], v16 offset:3072
    v_mfma_f32_16x16x32_bf16 v[92:95], v[144:147], a[172:175], v[92:95]
    ds_read_b64_tr_b16 v[174:175], v16 offset:3584
    s_waitcnt vmcnt(9)
    v_mfma_f32_16x16x32_bf16 v[80:83], v[148:151], a[176:179], v[80:83]
    v_mfma_f32_16x16x32_bf16 v[84:87], v[148:151], a[180:183], v[84:87]
    buffer_load_dwordx4 v[140:143], v23, s[24:27], s58 offen offset:1024 sc1
    v_mfma_f32_16x16x32_bf16 v[88:91], v[148:151], a[184:187], v[88:91]
    v_add_f32 v96, v96, v108
    v_add_f32 v97, v97, v109
    v_mfma_f32_16x16x32_bf16 v[92:95], v[148:151], a[188:191], v[92:95]
    v_add_f32 v98, v98, v110
    s_waitcnt vmcnt(9)
    v_mfma_f32_16x16x32_bf16 v[80:83], v[152:155], a[192:195], v[80:83]
    s_add_u32 s58, s66, s80
    v_mfma_f32_16x16x32_bf16 v[84:87], v[152:155], a[196:199], v[84:87]
    buffer_load_dwordx4 v[144:147], v23, s[24:27], s58 offen offset:0 sc1
    v_mfma_f32_16x16x32_bf16 v[88:91], v[152:155], a[200:203], v[88:91]
    v_add_f32 v99, v99, v111
    v_mfma_f32_16x16x32_bf16 v[92:95], v[152:155], a[204:207], v[92:95]
    s_waitcnt vmcnt(9)
    v_mfma_f32_16x16x32_bf16 v[80:83], v[156:159], a[208:211], v[80:83]
    v_mfma_f32_16x16x32_bf16 v[84:87], v[156:159], a[212:215], v[84:87]
    buffer_load_dwordx4 v[148:151], v23, s[24:27], s58 offen offset:1024 sc1
    v_mfma_f32_16x16x32_bf16 v[88:91], v[156:159], a[216:219], v[88:91]
    v_mfma_f32_16x16x32_bf16 v[92:95], v[156:159], a[220:223], v[92:95]
    s_waitcnt vmcnt(9)
    v_mfma_f32_16x16x32_bf16 v[64:67], v[112:115], a[0:3], v[228:231]
    s_add_u32 s58, s66, s81
    v_mfma_f32_16x16x32_bf16 v[68:71], v[112:115], a[4:7], 0
    buffer_load_dwordx4 v[152:155], v23, s[24:27], s58 offen offset:0 sc1
    v_mfma_f32_16x16x32_bf16 v[72:75], v[112:115], a[8:11], 0
    ds_read_b64_tr_b16 v[192:193], v16 offset:4096
    v_mfma_f32_16x16x32_bf16 v[76:79], v[112:115], a[12:15], 0
    ds_read_b64_tr_b16 v[194:195], v16 offset:4608
    s_waitcnt vmcnt(9)
    v_mfma_f32_16x16x32_bf16 v[64:67], v[116:119], a[16:19], v[64:67]
    v_mfma_f32_16x16x32_bf16 v[68:71], v[116:119], a[20:23], v[68:71]
    buffer_load_dwordx4 v[156:159], v23, s[24:27], s58 offen offset:1024 sc1
    v_mfma_f32_16x16x32_bf16 v[72:75], v[116:119], a[24:27], v[72:75]
    ds_read_b64_tr_b16 v[196:197], v16 offset:5120
    ds_read_b64_tr_b16 v[198:199], v16 offset:5632
    v_mfma_f32_16x16x32_bf16 v[76:79], v[116:119], a[28:31], v[76:79]
    ds_write_b128 v232, v[84:87] offset:49152
    s_waitcnt vmcnt(9)
    v_mfma_f32_16x16x32_bf16 v[64:67], v[120:123], a[32:35], v[64:67]
    s_add_u32 s58, s66, s82
    v_mfma_f32_16x16x32_bf16 v[68:71], v[120:123], a[36:39], v[68:71]
    buffer_load_dwordx4 v[112:115], v23, s[24:27], s58 offen offset:0 sc1
    v_mfma_f32_16x16x32_bf16 v[72:75], v[120:123], a[40:43], v[72:75]
    ds_read_b64_tr_b16 v[200:201], v16 offset:6144
    ds_read_b64_tr_b16 v[202:203], v16 offset:6656
    v_mfma_f32_16x16x32_bf16 v[76:79], v[120:123], a[44:47], v[76:79]
    ds_write_b128 v232, v[88:91] offset:50176
    s_waitcnt vmcnt(9)
    v_mfma_f32_16x16x32_bf16 v[64:67], v[124:127], a[48:51], v[64:67]
    v_mfma_f32_16x16x32_bf16 v[68:71], v[124:127], a[52:55], v[68:71]
    buffer_load_dwordx4 v[116:119], v23, s[24:27], s58 offen offset:1024 sc1
    v_mfma_f32_16x16x32_bf16 v[72:75], v[124:127], a[56:59], v[72:75]
    ds_read_b64_tr_b16 v[204:205], v16 offset:7168
    ds_read_b64_tr_b16 v[206:207], v16 offset:7680
    v_mfma_f32_16x16x32_bf16 v[76:79], v[124:127], a[60:63], v[76:79]
    ds_write_b128 v232, v[92:95] offset:51200
    s_waitcnt vmcnt(9)
    v_mfma_f32_16x16x32_bf16 v[64:67], v[128:131], a[64:67], v[64:67]
    s_add_u32 s66, s69, 58624
    s_add_u32 s58, s66, s76
    v_mfma_f32_16x16x32_bf16 v[68:71], v[128:131], a[68:71], v[68:71]
    buffer_load_dwordx4 v[120:123], v23, s[24:27], s58 offen offset:0 sc1
    v_mfma_f32_16x16x32_bf16 v[72:75], v[128:131], a[72:75], v[72:75]
    ds_read_b64_tr_b16 v[100:101], v16 offset:8192
    v_mfma_f32_16x16x32_bf16 v[76:79], v[128:131], a[76:79], v[76:79]
    ds_read_b64_tr_b16 v[102:103], v16 offset:8704
    s_waitcnt vmcnt(9)
    v_mfma_f32_16x16x32_bf16 v[64:67], v[132:135], a[80:83], v[64:67]
    v_mfma_f32_16x16x32_bf16 v[68:71], v[132:135], a[84:87], v[68:71]
    buffer_load_dwordx4 v[124:127], v23, s[24:27], s58 offen offset:1024 sc1
    v_mfma_f32_16x16x32_bf16 v[72:75], v[132:135], a[88:91], v[72:75]
    s_waitcnt lgkmcnt(2)
    s_barrier
    v_mfma_f32_16x16x32_bf16 v[76:79], v[132:135], a[92:95], v[76:79]
    s_waitcnt vmcnt(9)
    v_mfma_f32_16x16x32_bf16 v[64:67], v[136:139], a[96:99], v[64:67]
    s_add_u32 s58, s66, s77
    v_mfma_f32_16x16x32_bf16 v[68:71], v[136:139], a[100:103], v[68:71]
    buffer_load_dwordx4 v[128:131], v23, s[24:27], s58 offen offset:0 sc1
    v_mfma_f32_16x16x32_bf16 v[72:75], v[136:139], a[104:107], v[72:75]
    ds_read_b128 v[84:87], v233 offset:49152
    ds_read_b128 v[88:91], v234 offset:50176
    v_mfma_f32_16x16x32_bf16 v[76:79], v[136:139], a[108:111], v[76:79]
    ds_read_b128 v[92:95], v235 offset:51200
    s_waitcnt vmcnt(9)
    v_mfma_f32_16x16x32_bf16 v[64:67], v[140:143], a[112:115], v[64:67]
    v_mfma_f32_16x16x32_bf16 v[68:71], v[140:143], a[116:119], v[68:71]
    buffer_load_dwordx4 v[132:135], v23, s[24:27], s58 offen offset:1024 sc1
    v_mfma_f32_16x16x32_bf16 v[72:75], v[140:143], a[120:123], v[72:75]
    ds_read_b64_tr_b16 a[224:225], v246 offset:0
    v_mfma_f32_16x16x32_bf16 v[76:79], v[140:143], a[124:127], v[76:79]
    ds_read_b64_tr_b16 a[226:227], v246 offset:512
    s_waitcnt vmcnt(9)
    v_mfma_f32_16x16x32_bf16 v[64:67], v[144:147], a[128:131], v[64:67]
    s_add_u32 s58, s66, s78
    s_waitcnt lgkmcnt(2)
    v_mfma_f32_16x16x32_bf16 v[68:71], v[144:147], a[132:135], v[68:71]
    buffer_load_dwordx4 v[136:139], v23, s[24:27], s58 offen offset:0 sc1
    v_mfma_f32_16x16x32_bf16 v[72:75], v[144:147], a[136:139], v[72:75]
    v_add_f32 v80, v80, v84
    v_add_f32 v81, v81, v85
    ds_read_b64_tr_b16 a[228:229], v247 offset:0
    v_mfma_f32_16x16x32_bf16 v[76:79], v[144:147], a[140:143], v[76:79]
    ds_read_b64_tr_b16 a[230:231], v247 offset:512
    s_waitcnt vmcnt(9)
    v_mfma_f32_16x16x32_bf16 v[64:67], v[148:151], a[144:147], v[64:67]
    v_add_f32 v82, v82, v86
    v_mfma_f32_16x16x32_bf16 v[68:71], v[148:151], a[148:151], v[68:71]
    buffer_load_dwordx4 v[140:143], v23, s[24:27], s58 offen offset:1024 sc1
    v_mfma_f32_16x16x32_bf16 v[72:75], v[148:151], a[152:155], v[72:75]
    v_add_f32 v83, v83, v87
    v_add_f32 v80, v80, v88
    ds_read_b64_tr_b16 a[232:233], v246 offset:256
    v_mfma_f32_16x16x32_bf16 v[76:79], v[148:151], a[156:159], v[76:79]
    ds_read_b64_tr_b16 a[234:235], v246 offset:768
    s_waitcnt vmcnt(9)
    v_mfma_f32_16x16x32_bf16 v[64:67], v[152:155], a[160:163], v[64:67]
    s_add_u32 s58, s66, s79
    v_add_f32 v81, v81, v89
    v_mfma_f32_16x16x32_bf16 v[68:71], v[152:155], a[164:167], v[68:71]
    buffer_load_dwordx4 v[144:147], v23, s[24:27], s58 offen offset:0 sc1
    v_mfma_f32_16x16x32_bf16 v[72:75], v[152:155], a[168:171], v[72:75]
    v_add_f32 v82, v82, v90
    v_add_f32 v83, v83, v91
    ds_read_b64_tr_b16 a[236:237], v247 offset:256
    v_mfma_f32_16x16x32_bf16 v[76:79], v[152:155], a[172:175], v[76:79]
    ds_read_b64_tr_b16 a[238:239], v247 offset:768
    s_waitcnt vmcnt(9)
    v_mfma_f32_16x16x32_bf16 v[64:67], v[156:159], a[176:179], v[64:67]
    v_mfma_f32_16x16x32_bf16 v[68:71], v[156:159], a[180:183], v[68:71]
    buffer_load_dwordx4 v[148:151], v23, s[24:27], s58 offen offset:1024 sc1
    v_mfma_f32_16x16x32_bf16 v[72:75], v[156:159], a[184:187], v[72:75]
    v_add_f32 v80, v80, v92
    v_add_f32 v81, v81, v93
    v_mfma_f32_16x16x32_bf16 v[76:79], v[156:159], a[188:191], v[76:79]
    v_add_f32 v82, v82, v94
    s_waitcnt vmcnt(9)
    v_mfma_f32_16x16x32_bf16 v[64:67], v[112:115], a[192:195], v[64:67]
    s_add_u32 s58, s66, s80
    v_mfma_f32_16x16x32_bf16 v[68:71], v[112:115], a[196:199], v[68:71]
    buffer_load_dwordx4 v[152:155], v23, s[24:27], s58 offen offset:0 sc1
    v_mfma_f32_16x16x32_bf16 v[72:75], v[112:115], a[200:203], v[72:75]
    v_add_f32 v83, v83, v95
    v_mfma_f32_16x16x32_bf16 v[76:79], v[112:115], a[204:207], v[76:79]
    s_waitcnt vmcnt(9)
    v_mfma_f32_16x16x32_bf16 v[64:67], v[116:119], a[208:211], v[64:67]
    v_mfma_f32_16x16x32_bf16 v[68:71], v[116:119], a[212:215], v[68:71]
    buffer_load_dwordx4 v[156:159], v23, s[24:27], s58 offen offset:1024 sc1
    v_mfma_f32_16x16x32_bf16 v[72:75], v[116:119], a[216:219], v[72:75]
    v_mfma_f32_16x16x32_bf16 v[76:79], v[116:119], a[220:223], v[76:79]
    s_waitcnt vmcnt(9)
    v_mfma_f32_16x16x32_bf16 v[48:51], v[120:123], a[0:3], v[228:231]
    s_add_u32 s58, s66, s81
    v_mfma_f32_16x16x32_bf16 v[52:55], v[120:123], a[4:7], 0
    buffer_load_dwordx4 v[112:115], v23, s[24:27], s58 offen offset:0 sc1
    v_mfma_f32_16x16x32_bf16 v[56:59], v[120:123], a[8:11], 0
    ds_read_b64_tr_b16 v[104:105], v16 offset:9216
    v_mfma_f32_16x16x32_bf16 v[60:63], v[120:123], a[12:15], 0
    ds_read_b64_tr_b16 v[106:107], v16 offset:9728
    s_waitcnt vmcnt(9)
    v_mfma_f32_16x16x32_bf16 v[48:51], v[124:127], a[16:19], v[48:51]
    v_mfma_f32_16x16x32_bf16 v[52:55], v[124:127], a[20:23], v[52:55]
    buffer_load_dwordx4 v[116:119], v23, s[24:27], s58 offen offset:1024 sc1
    v_mfma_f32_16x16x32_bf16 v[56:59], v[124:127], a[24:27], v[56:59]
    ds_read_b64_tr_b16 v[108:109], v16 offset:10240
    ds_read_b64_tr_b16 v[110:111], v16 offset:10752
    v_mfma_f32_16x16x32_bf16 v[60:63], v[124:127], a[28:31], v[60:63]
    ds_write_b128 v232, v[68:71] offset:32768
    s_waitcnt vmcnt(9)
    v_mfma_f32_16x16x32_bf16 v[48:51], v[128:131], a[32:35], v[48:51]
    s_add_u32 s58, s66, s82
    v_mfma_f32_16x16x32_bf16 v[52:55], v[128:131], a[36:39], v[52:55]
    buffer_load_dwordx4 v[120:123], v23, s[24:27], s58 offen offset:0 sc1
    v_mfma_f32_16x16x32_bf16 v[56:59], v[128:131], a[40:43], v[56:59]
    ds_read_b64_tr_b16 v[84:85], v16 offset:11264
    ds_read_b64_tr_b16 v[86:87], v16 offset:11776
    v_mfma_f32_16x16x32_bf16 v[60:63], v[128:131], a[44:47], v[60:63]
    ds_write_b128 v232, v[72:75] offset:33792
    s_waitcnt vmcnt(9)
    v_mfma_f32_16x16x32_bf16 v[48:51], v[132:135], a[48:51], v[48:51]
    v_mfma_f32_16x16x32_bf16 v[52:55], v[132:135], a[52:55], v[52:55]
    buffer_load_dwordx4 v[124:127], v23, s[24:27], s58 offen offset:1024 sc1
    v_mfma_f32_16x16x32_bf16 v[56:59], v[132:135], a[56:59], v[56:59]
    ds_read_b64_tr_b16 v[88:89], v16 offset:12288
    ds_read_b64_tr_b16 v[90:91], v16 offset:12800
    v_mfma_f32_16x16x32_bf16 v[60:63], v[132:135], a[60:63], v[60:63]
    ds_write_b128 v232, v[76:79] offset:34816
    s_waitcnt vmcnt(9)
    v_mfma_f32_16x16x32_bf16 v[48:51], v[136:139], a[64:67], v[48:51]
    s_add_u32 s66, s69, 0
    s_add_u32 s58, s66, s76
    v_mfma_f32_16x16x32_bf16 v[52:55], v[136:139], a[68:71], v[52:55]
    buffer_load_dwordx4 v[128:131], v23, s[24:27], s58 offen offset:0 sc1
    v_mfma_f32_16x16x32_bf16 v[56:59], v[136:139], a[72:75], v[56:59]
    ds_read_b64_tr_b16 v[92:93], v16 offset:13312
    v_mfma_f32_16x16x32_bf16 v[60:63], v[136:139], a[76:79], v[60:63]
    ds_read_b64_tr_b16 v[94:95], v16 offset:13824
    s_waitcnt vmcnt(9)
    v_mfma_f32_16x16x32_bf16 v[48:51], v[140:143], a[80:83], v[48:51]
    v_mfma_f32_16x16x32_bf16 v[52:55], v[140:143], a[84:87], v[52:55]
    buffer_load_dwordx4 v[132:135], v23, s[24:27], s58 offen offset:1024 sc1
    v_mfma_f32_16x16x32_bf16 v[56:59], v[140:143], a[88:91], v[56:59]
    s_waitcnt lgkmcnt(2)
    s_barrier
    v_mfma_f32_16x16x32_bf16 v[60:63], v[140:143], a[92:95], v[60:63]
    s_waitcnt vmcnt(9)
    v_mfma_f32_16x16x32_bf16 v[48:51], v[144:147], a[96:99], v[48:51]
    s_add_u32 s58, s66, s77
    v_mfma_f32_16x16x32_bf16 v[52:55], v[144:147], a[100:103], v[52:55]
    buffer_load_dwordx4 v[136:139], v23, s[24:27], s58 offen offset:0 sc1
    v_mfma_f32_16x16x32_bf16 v[56:59], v[144:147], a[104:107], v[56:59]
    ds_read_b128 v[68:71], v233 offset:32768
    ds_read_b128 v[72:75], v234 offset:33792
    v_mfma_f32_16x16x32_bf16 v[60:63], v[144:147], a[108:111], v[60:63]
    ds_read_b128 v[76:79], v235 offset:34816
    s_waitcnt vmcnt(9)
    v_mfma_f32_16x16x32_bf16 v[48:51], v[148:151], a[112:115], v[48:51]
    v_mfma_f32_16x16x32_bf16 v[52:55], v[148:151], a[116:119], v[52:55]
    buffer_load_dwordx4 v[140:143], v23, s[24:27], s58 offen offset:1024 sc1
    v_mfma_f32_16x16x32_bf16 v[56:59], v[148:151], a[120:123], v[56:59]
    ds_read_b64_tr_b16 a[240:241], v246 offset:16384
    v_mfma_f32_16x16x32_bf16 v[60:63], v[148:151], a[124:127], v[60:63]
    ds_read_b64_tr_b16 a[242:243], v246 offset:16896
    buffer_load_dword v19, v21, s[24:27], 0 offen sc1
    s_waitcnt vmcnt(10)
    v_mfma_f32_16x16x32_bf16 v[48:51], v[152:155], a[128:131], v[48:51]
    s_waitcnt lgkmcnt(2)
    v_add_f32 v64, v64, v68
    v_mfma_f32_16x16x32_bf16 v[52:55], v[152:155], a[132:135], v[52:55]
    v_add_f32 v65, v65, v69
    v_mfma_f32_16x16x32_bf16 v[56:59], v[152:155], a[136:139], v[56:59]
    ds_read_b64_tr_b16 a[244:245], v247 offset:16384
    v_mfma_f32_16x16x32_bf16 v[60:63], v[152:155], a[140:143], v[60:63]
    ds_read_b64_tr_b16 a[246:247], v247 offset:16896
    s_waitcnt vmcnt(9)
    v_mfma_f32_16x16x32_bf16 v[48:51], v[156:159], a[144:147], v[48:51]
    s_add_u32 s58, s66, s78
    v_add_f32 v66, v66, v70
    v_mfma_f32_16x16x32_bf16 v[52:55], v[156:159], a[148:151], v[52:55]
    buffer_load_dwordx4 v[144:147], v23, s[24:27], s58 offen offset:0 sc1
    v_mfma_f32_16x16x32_bf16 v[56:59], v[156:159], a[152:155], v[56:59]
    v_add_f32 v67, v67, v71
    v_add_f32 v64, v64, v72
    ds_read_b64_tr_b16 a[248:249], v246 offset:16640
    v_mfma_f32_16x16x32_bf16 v[60:63], v[156:159], a[156:159], v[60:63]
    ds_read_b64_tr_b16 a[250:251], v246 offset:17152
    s_waitcnt vmcnt(9)
    v_mfma_f32_16x16x32_bf16 v[48:51], v[112:115], a[160:163], v[48:51]
    v_add_f32 v65, v65, v73
    v_mfma_f32_16x16x32_bf16 v[52:55], v[112:115], a[164:167], v[52:55]
    buffer_load_dwordx4 v[148:151], v23, s[24:27], s58 offen offset:1024 sc1
    v_mfma_f32_16x16x32_bf16 v[56:59], v[112:115], a[168:171], v[56:59]
    v_add_f32 v66, v66, v74
    v_add_f32 v67, v67, v75
    ds_read_b64_tr_b16 a[252:253], v247 offset:16640
    v_mfma_f32_16x16x32_bf16 v[60:63], v[112:115], a[172:175], v[60:63]
    ds_read_b64_tr_b16 a[254:255], v247 offset:17152
    s_waitcnt vmcnt(9)
    v_mfma_f32_16x16x32_bf16 v[48:51], v[116:119], a[176:179], v[48:51]
    s_add_u32 s58, s66, s79
    v_mfma_f32_16x16x32_bf16 v[52:55], v[116:119], a[180:183], v[52:55]
    buffer_load_dwordx4 v[152:155], v23, s[24:27], s58 offen offset:0 sc1
    v_mfma_f32_16x16x32_bf16 v[56:59], v[116:119], a[184:187], v[56:59]
    v_add_f32 v64, v64, v76
    v_add_f32 v65, v65, v77
    v_mfma_f32_16x16x32_bf16 v[60:63], v[116:119], a[188:191], v[60:63]
    v_add_f32 v66, v66, v78
    s_waitcnt vmcnt(9)
    v_mfma_f32_16x16x32_bf16 v[48:51], v[120:123], a[192:195], v[48:51]
    v_mfma_f32_16x16x32_bf16 v[52:55], v[120:123], a[196:199], v[52:55]
    buffer_load_dwordx4 v[156:159], v23, s[24:27], s58 offen offset:1024 sc1
    v_mfma_f32_16x16x32_bf16 v[56:59], v[120:123], a[200:203], v[56:59]
    v_add_f32 v67, v67, v79
    v_mfma_f32_16x16x32_bf16 v[60:63], v[120:123], a[204:207], v[60:63]
    s_waitcnt vmcnt(9)
    v_mfma_f32_16x16x32_bf16 v[48:51], v[124:127], a[208:211], v[48:51]
    s_add_u32 s58, s66, s80
    v_mfma_f32_16x16x32_bf16 v[52:55], v[124:127], a[212:215], v[52:55]
    buffer_load_dwordx4 v[112:115], v23, s[24:27], s58 offen offset:0 sc1
    v_mfma_f32_16x16x32_bf16 v[56:59], v[124:127], a[216:219], v[56:59]
    v_mfma_f32_16x16x32_bf16 v[60:63], v[124:127], a[220:223], v[60:63]
    s_waitcnt vmcnt(9)
    v_mfma_f32_16x16x32_bf16 v[32:35], v[128:131], a[0:3], v[228:231]
    ds_read_b64_tr_b16 v[68:69], v16 offset:14336
    v_mfma_f32_16x16x32_bf16 v[36:39], v[128:131], a[4:7], 0
    buffer_load_dwordx4 v[116:119], v23, s[24:27], s58 offen offset:1024 sc1
    v_mfma_f32_16x16x32_bf16 v[40:43], v[128:131], a[8:11], 0
    ds_read_b64_tr_b16 v[70:71], v16 offset:14848
    ds_read_b64_tr_b16 v[72:73], v16 offset:15360
    v_mfma_f32_16x16x32_bf16 v[44:47], v[128:131], a[12:15], 0
    ds_read_b64_tr_b16 v[74:75], v16 offset:15872
    s_waitcnt vmcnt(9)
    v_mfma_f32_16x16x32_bf16 v[32:35], v[132:135], a[16:19], v[32:35]
    s_add_u32 s58, s66, s81
    ds_write_b128 v232, v[52:55] offset:16384
    v_mfma_f32_16x16x32_bf16 v[36:39], v[132:135], a[20:23], v[36:39]
    buffer_load_dwordx4 v[120:123], v23, s[24:27], s58 offen offset:0 sc1
    v_mfma_f32_16x16x32_bf16 v[40:43], v[132:135], a[24:27], v[40:43]
    ds_read_b64_tr_b16 a[0:1], v246 offset:32768
    ds_read_b64_tr_b16 a[2:3], v246 offset:33280
    ds_read_b64_tr_b16 a[4:5], v247 offset:32768
    v_mfma_f32_16x16x32_bf16 v[44:47], v[132:135], a[28:31], v[44:47]
    ds_read_b64_tr_b16 a[6:7], v247 offset:33280
    s_waitcnt vmcnt(9)
    v_mfma_f32_16x16x32_bf16 v[32:35], v[136:139], a[32:35], v[32:35]
    ds_write_b128 v232, v[56:59] offset:17408
    v_mfma_f32_16x16x32_bf16 v[36:39], v[136:139], a[36:39], v[36:39]
    buffer_load_dwordx4 v[124:127], v23, s[24:27], s58 offen offset:1024 sc1
    v_mfma_f32_16x16x32_bf16 v[40:43], v[136:139], a[40:43], v[40:43]
    ds_read_b64_tr_b16 a[8:9], v246 offset:33024
    ds_read_b64_tr_b16 a[10:11], v246 offset:33536
    ds_read_b64_tr_b16 a[12:13], v247 offset:33024
    v_mfma_f32_16x16x32_bf16 v[44:47], v[136:139], a[44:47], v[44:47]
    ds_read_b64_tr_b16 a[14:15], v247 offset:33536
    s_waitcnt vmcnt(9)
    v_mfma_f32_16x16x32_bf16 v[32:35], v[140:143], a[48:51], v[32:35]
    s_add_u32 s58, s66, s82
    ds_write_b128 v232, v[60:63] offset:18432
    v_mfma_f32_16x16x32_bf16 v[36:39], v[140:143], a[52:55], v[36:39]
    buffer_load_dwordx4 v[128:131], v23, s[24:27], s58 offen offset:0 sc1
    v_mfma_f32_16x16x32_bf16 v[40:43], v[140:143], a[56:59], v[40:43]
    ds_read_b64_tr_b16 a[16:17], v246 offset:49152
    ds_read_b64_tr_b16 a[18:19], v246 offset:49664
    ds_read_b64_tr_b16 a[20:21], v247 offset:49152
    v_mfma_f32_16x16x32_bf16 v[44:47], v[140:143], a[60:63], v[44:47]
    ds_read_b64_tr_b16 a[22:23], v247 offset:49664
    buffer_load_dwordx4 v[132:135], v23, s[24:27], s58 offen offset:1024 sc1
    s_waitcnt vmcnt(10)
    v_cmp_ne_u32 vcc, s47, v19
    s_nop 0
    s_cbranch_vccz L_ok10
    s_mov_b32 s59, 20000
L_spin9:
    s_sleep 2
    buffer_load_dword v19, v21, s[24:27], 0 offen sc1
    s_waitcnt vmcnt(0)
    v_cmp_ne_u32 vcc, s47, v19
    s_nop 0
    s_cbranch_vccz L_ok10
    s_sub_u32 s59, s59, 1
    s_cbranch_scc0 L_spin9
L_ok10:
    s_waitcnt vmcnt(9)
    v_mfma_f32_16x16x32_bf16 v[32:35], v[144:147], a[64:67], v[32:35]
    s_add_u32 s58, s70, 0
    ds_read_b64_tr_b16 a[24:25], v246 offset:49408
    v_mfma_f32_16x16x32_bf16 v[36:39], v[144:147], a[68:71], v[36:39]
    buffer_load_dwordx4 v[136:139], v23, s[24:27], s58 offen offset:0 sc1
    v_mfma_f32_16x16x32_bf16 v[40:43], v[144:147], a[72:75], v[40:43]
    ds_read_b64_tr_b16 a[26:27], v246 offset:49920
    ds_read_b64_tr_b16 a[28:29], v247 offset:49408
    v_mfma_f32_16x16x32_bf16 v[44:47], v[144:147], a[76:79], v[44:47]
    ds_read_b64_tr_b16 a[30:31], v247 offset:49920
    s_waitcnt vmcnt(9)
    v_mfma_f32_16x16x32_bf16 v[32:35], v[148:151], a[80:83], v[32:35]
    ds_read_b64_tr_b16 a[32:33], v246 offset:4096
    v_mfma_f32_16x16x32_bf16 v[36:39], v[148:151], a[84:87], v[36:39]
    buffer_load_dwordx4 v[140:143], v23, s[24:27], s58 offen offset:1024 sc1
    v_mfma_f32_16x16x32_bf16 v[40:43], v[148:151], a[88:91], v[40:43]
    ds_read_b64_tr_b16 a[34:35], v246 offset:4608
    ds_read_b64_tr_b16 a[36:37], v247 offset:4096
    v_mfma_f32_16x16x32_bf16 v[44:47], v[148:151], a[92:95], v[44:47]
    ds_read_b64_tr_b16 a[38:39], v247 offset:4608
    s_waitcnt vmcnt(9)
    v_mfma_f32_16x16x32_bf16 v[32:35], v[152:155], a[96:99], v[32:35]
    ds_read_b64_tr_b16 a[40:41], v246 offset:4352
    v_mfma_f32_16x16x32_bf16 v[36:39], v[152:155], a[100:103], v[36:39]
    buffer_load_dwordx4 v[144:147], v23, s[24:27], s58 offen offset:2048 sc1
    v_mfma_f32_16x16x32_bf16 v[40:43], v[152:155], a[104:107], v[40:43]
    ds_read_b64_tr_b16 a[42:43], v246 offset:4864
    ds_read_b64_tr_b16 a[44:45], v247 offset:4352
    v_mfma_f32_16x16x32_bf16 v[44:47], v[152:155], a[108:111], v[44:47]
    ds_read_b64_tr_b16 a[46:47], v247 offset:4864
    s_waitcnt vmcnt(9)
    v_mfma_f32_16x16x32_bf16 v[32:35], v[156:159], a[112:115], v[32:35]
    ds_read_b64_tr_b16 a[48:49], v246 offset:20480
    v_mfma_f32_16x16x32_bf16 v[36:39], v[156:159], a[116:119], v[36:39]
    buffer_load_dwordx4 v[148:151], v23, s[24:27], s58 offen offset:3072 sc1
    v_mfma_f32_16x16x32_bf16 v[40:43], v[156:159], a[120:123], v[40:43]
    ds_read_b64_tr_b16 a[50:51], v246 offset:20992
    ds_read_b64_tr_b16 a[52:53], v247 offset:20480
    v_mfma_f32_16x16x32_bf16 v[44:47], v[156:159], a[124:127], v[44:47]
    ds_read_b64_tr_b16 a[54:55], v247 offset:20992
    s_waitcnt vmcnt(9)
    v_mfma_f32_16x16x32_bf16 v[32:35], v[112:115], a[128:131], v[32:35]
    s_add_u32 s58, s70, 4096
    ds_read_b64_tr_b16 a[56:57], v246 offset:20736
    v_mfma_f32_16x16x32_bf16 v[36:39], v[112:115], a[132:135], v[36:39]
    buffer_load_dwordx4 v[152:155], v23, s[24:27], s58 offen offset:0 sc1
    v_mfma_f32_16x16x32_bf16 v[40:43], v[112:115], a[136:139], v[40:43]
    ds_read_b64_tr_b16 a[58:59], v246 offset:21248
    ds_read_b64_tr_b16 a[60:61], v247 offset:20736
    v_mfma_f32_16x16x32_bf16 v[44:47], v[112:115], a[140:143], v[44:47]
    ds_read_b64_tr_b16 a[62:63], v247 offset:21248
    s_waitcnt vmcnt(9)
    v_mfma_f32_16x16x32_bf16 v[32:35], v[116:119], a[144:147], v[32:35]
    ds_read_b64_tr_b16 a[64:65], v246 offset:36864
    v_mfma_f32_16x16x32_bf16 v[36:39], v[116:119], a[148:151], v[36:39]
    buffer_load_dwordx4 v[156:159], v23, s[24:27], s58 offen offset:1024 sc1
    v_mfma_f32_16x16x32_bf16 v[40:43], v[116:119], a[152:155], v[40:43]
    ds_read_b64_tr_b16 a[66:67], v246 offset:37376
    ds_read_b64_tr_b16 a[68:69], v247 offset:36864
    v_mfma_f32_16x16x32_bf16 v[44:47], v[116:119], a[156:159], v[44:47]
    ds_read_b64_tr_b16 a[70:71], v247 offset:37376
    s_waitcnt vmcnt(9)
    v_mfma_f32_16x16x32_bf16 v[32:35], v[120:123], a[160:163], v[32:35]
    ds_read_b64_tr_b16 a[72:73], v246 offset:37120
    v_mfma_f32_16x16x32_bf16 v[36:39], v[120:123], a[164:167], v[36:39]
    buffer_load_dwordx4 v[112:115], v23, s[24:27], s58 offen offset:2048 sc1
    v_mfma_f32_16x16x32_bf16 v[40:43], v[120:123], a[168:171], v[40:43]
    ds_read_b64_tr_b16 a[74:75], v246 offset:37632
    ds_read_b64_tr_b16 a[76:77], v247 offset:37120
    v_mfma_f32_16x16x32_bf16 v[44:47], v[120:123], a[172:175], v[44:47]
    ds_read_b64_tr_b16 a[78:79], v247 offset:37632
    s_waitcnt vmcnt(9)
    v_mfma_f32_16x16x32_bf16 v[32:35], v[124:127], a[176:179], v[32:35]
    ds_read_b64_tr_b16 a[80:81], v246 offset:53248
    v_mfma_f32_16x16x32_bf16 v[36:39], v[124:127], a[180:183], v[36:39]
    buffer_load_dwordx4 v[116:119], v23, s[24:27], s58 offen offset:3072 sc1
    v_mfma_f32_16x16x32_bf16 v[40:43], v[124:127], a[184:187], v[40:43]
    ds_read_b64_tr_b16 a[82:83], v246 offset:53760
    ds_read_b64_tr_b16 a[84:85], v247 offset:53248
    v_mfma_f32_16x16x32_bf16 v[44:47], v[124:127], a[188:191], v[44:47]
    ds_read_b64_tr_b16 a[86:87], v247 offset:53760
    s_waitcnt vmcnt(9)
    v_mfma_f32_16x16x32_bf16 v[32:35], v[128:131], a[192:195], v[32:35]
    s_add_u32 s58, s70, 8192
    ds_read_b64_tr_b16 a[88:89], v246 offset:53504
    v_mfma_f32_16x16x32_bf16 v[36:39], v[128:131], a[196:199], v[36:39]
    buffer_load_dwordx4 v[120:123], v23, s[24:27], s58 offen offset:0 sc1
    v_mfma_f32_16x16x32_bf16 v[40:43], v[128:131], a[200:203], v[40:43]
    ds_read_b64_tr_b16 a[90:91], v246 offset:54016
    ds_read_b64_tr_b16 a[92:93], v247 offset:53504
    v_mfma_f32_16x16x32_bf16 v[44:47], v[128:131], a[204:207], v[44:47]
    ds_read_b64_tr_b16 a[94:95], v247 offset:54016
    s_waitcnt vmcnt(9)
    v_mfma_f32_16x16x32_bf16 v[32:35], v[132:135], a[208:211], v[32:35]
    ds_read_b64_tr_b16 a[96:97], v246 offset:8192
    v_mfma_f32_16x16x32_bf16 v[36:39], v[132:135], a[212:215], v[36:39]
    buffer_load_dwordx4 v[124:127], v23, s[24:27], s58 offen offset:1024 sc1
    v_mfma_f32_16x16x32_bf16 v[40:43], v[132:135], a[216:219], v[40:43]
    ds_read_b64_tr_b16 a[98:99], v246 offset:8704
    ds_read_b64_tr_b16 a[100:101], v247 offset:8192
    v_mfma_f32_16x16x32_bf16 v[44:47], v[132:135], a[220:223], v[44:47]
    ds_read_b64_tr_b16 a[102:103], v247 offset:8704
    s_waitcnt vmcnt(9)
    v_mfma_f32_16x16x32_bf16 v[32:35], a[224:227], v[136:139], v[32:35]
    ds_read_b64_tr_b16 a[104:105], v246 offset:8448
    v_mfma_f32_16x16x32_bf16 v[48:51], a[228:231], v[136:139], v[48:51]
    buffer_load_dwordx4 v[128:131], v23, s[24:27], s58 offen offset:2048 sc1
    v_mfma_f32_16x16x32_bf16 v[64:67], a[232:235], v[136:139], v[64:67]
    ds_read_b64_tr_b16 a[106:107], v246 offset:8960
    ds_read_b64_tr_b16 a[108:109], v247 offset:8448
    v_mfma_f32_16x16x32_bf16 v[80:83], a[236:239], v[136:139], v[80:83]
    ds_read_b64_tr_b16 a[110:111], v247 offset:8960
    ds_read_b64_tr_b16 a[112:113], v246 offset:24576
    v_mfma_f32_16x16x32_bf16 v[96:99], v[160:163], v[136:139], v[96:99]
    ds_read_b64_tr_b16 a[114:115], v246 offset:25088
    s_waitcnt lgkmcnt(15)
    s_waitcnt vmcnt(9)
    v_mfma_f32_16x16x32_bf16 v[32:35], a[240:243], v[140:143], v[32:35]
    ds_read_b64_tr_b16 a[116:117], v247 offset:24576
    v_mfma_f32_16x16x32_bf16 v[48:51], a[244:247], v[140:143], v[48:51]
    buffer_load_dwordx4 v[132:135], v23, s[24:27], s58 offen offset:3072 sc1
    v_mfma_f32_16x16x32_bf16 v[64:67], a[248:251], v[140:143], v[64:67]
    ds_read_b64_tr_b16 a[118:119], v247 offset:25088
    ds_read_b64_tr_b16 a[120:121], v246 offset:24832
    v_mfma_f32_16x16x32_bf16 v[80:83], a[252:255], v[140:143], v[80:83]
    ds_read_b64_tr_b16 a[122:123], v246 offset:25344
    ds_read_b64_tr_b16 a[124:125], v247 offset:24832
    v_mfma_f32_16x16x32_bf16 v[96:99], v[164:167], v[140:143], v[96:99]
    ds_write_b128 v232, v[36:39] offset:0
    s_waitcnt vmcnt(9)
    v_mfma_f32_16x16x32_bf16 v[32:35], a[0:3], v[144:147], v[32:35]
    s_add_u32 s58, s70, 12288
    ds_read_b64_tr_b16 a[126:127], v247 offset:25344
    v_mfma_f32_16x16x32_bf16 v[48:51], a[4:7], v[144:147], v[48:51]
    buffer_load_dwordx4 v[136:139], v23, s[24:27], s58 offen offset:0 sc1
    v_mfma_f32_16x16x32_bf16 v[64:67], a[8:11], v[144:147], v[64:67]
    ds_read_b64_tr_b16 a[128:129], v246 offset:40960
    ds_read_b64_tr_b16 a[130:131], v246 offset:41472
    v_mfma_f32_16x16x32_bf16 v[80:83], a[12:15], v[144:147], v[80:83]
    ds_read_b64_tr_b16 a[132:133], v247 offset:40960
    ds_read_b64_tr_b16 a[134:135], v247 offset:41472
    v_mfma_f32_16x16x32_bf16 v[96:99], v[168:171], v[144:147], v[96:99]
    ds_write_b128 v232, v[40:43] offset:1024
    s_waitcnt vmcnt(9)
    v_mfma_f32_16x16x32_bf16 v[32:35], a[16:19], v[148:151], v[32:35]
    ds_read_b64_tr_b16 a[136:137], v246 offset:41216
    v_mfma_f32_16x16x32_bf16 v[48:51], a[20:23], v[148:151], v[48:51]
    buffer_load_dwordx4 v[140:143], v23, s[24:27], s58 offen offset:1024 sc1
    v_mfma_f32_16x16x32_bf16 v[64:67], a[24:27], v[148:151], v[64:67]
    ds_read_b64_tr_b16 a[138:139], v246 offset:41728
    ds_read_b64_tr_b16 a[140:141], v247 offset:41216
    v_mfma_f32_16x16x32_bf16 v[80:83], a[28:31], v[148:151], v[80:83]
    ds_read_b64_tr_b16 a[142:143], v247 offset:41728
    ds_read_b64_tr_b16 a[144:145], v246 offset:57344
    v_mfma_f32_16x16x32_bf16 v[96:99], v[172:175], v[148:151], v[96:99]
    ds_write_b128 v232, v[44:47] offset:2048
    s_waitcnt vmcnt(9)
    v_mfma_f32_16x16x32_bf16 v[32:35], a[32:35], v[152:155], v[32:35]
    ds_read_b64_tr_b16 a[146:147], v246 offset:57856
    v_mfma_f32_16x16x32_bf16 v[48:51], a[36:39], v[152:155], v[48:51]
    buffer_load_dwordx4 v[144:147], v23, s[24:27], s58 offen offset:2048 sc1
    v_mfma_f32_16x16x32_bf16 v[64:67], a[40:43], v[152:155], v[64:67]
    ds_read_b64_tr_b16 a[148:149], v247 offset:57344
    ds_read_b64_tr_b16 a[150:151], v247 offset:57856
    v_mfma_f32_16x16x32_bf16 v[80:83], a[44:47], v[152:155], v[80:83]
    ds_read_b64_tr_b16 a[152:153], v246 offset:57600
    ds_read_b64_tr_b16 a[154:155], v246 offset:58112
    v_mfma_f32_16x16x32_bf16 v[96:99], v[192:195], v[152:155], v[96:99]
    ds_read_b64_tr_b16 a[156:157], v247 offset:57600
    s_waitcnt vmcnt(9)
    v_mfma_f32_16x16x32_bf16 v[32:35], a[48:51], v[156:159], v[32:35]
    ds_read_b64_tr_b16 a[158:159], v247 offset:58112
    v_mfma_f32_16x16x32_bf16 v[48:51], a[52:55], v[156:159], v[48:51]
    buffer_load_dwordx4 v[148:151], v23, s[24:27], s58 offen offset:3072 sc1
    v_mfma_f32_16x16x32_bf16 v[64:67], a[56:59], v[156:159], v[64:67]
    ds_read_b64_tr_b16 a[160:161], v246 offset:12288
    ds_read_b64_tr_b16 a[162:163], v246 offset:12800
    v_mfma_f32_16x16x32_bf16 v[80:83], a[60:63], v[156:159], v[80:83]
    ds_read_b64_tr_b16 a[164:165], v247 offset:12288
    ds_read_b64_tr_b16 a[166:167], v247 offset:12800
    v_mfma_f32_16x16x32_bf16 v[96:99], v[196:199], v[156:159], v[96:99]
    ds_read_b64_tr_b16 a[168:169], v246 offset:12544
    s_waitcnt vmcnt(9)
    v_mfma_f32_16x16x32_bf16 v[32:35], a[64:67], v[112:115], v[32:35]
    ds_read_b64_tr_b16 a[170:171], v246 offset:13056
    ds_read_b64_tr_b16 a[172:173], v247 offset:12544
    v_mfma_f32_16x16x32_bf16 v[48:51], a[68:71], v[112:115], v[48:51]
    ds_read_b64_tr_b16 a[174:175], v247 offset:13056
    v_mfma_f32_16x16x32_bf16 v[64:67], a[72:75], v[112:115], v[64:67]
    ds_read_b64_tr_b16 a[176:177], v246 offset:28672
    v_mfma_f32_16x16x32_bf16 v[80:83], a[76:79], v[112:115], v[80:83]
    ds_read_b64_tr_b16 a[178:179], v246 offset:29184
    v_mfma_f32_16x16x32_bf16 v[96:99], v[200:203], v[112:115], v[96:99]
    s_waitcnt lgkmcnt(15)
    s_barrier
    s_waitcnt vmcnt(8)
    v_mfma_f32_16x16x32_bf16 v[32:35], a[80:83], v[116:119], v[32:35]
    ds_read_b64_tr_b16 a[180:181], v247 offset:28672
    ds_read_b64_tr_b16 a[182:183], v247 offset:29184
    v_mfma_f32_16x16x32_bf16 v[48:51], a[84:87], v[116:119], v[48:51]
    ds_read_b64_tr_b16 a[184:185], v246 offset:28928
    ds_read_b64_tr_b16 a[186:187], v246 offset:29440
    v_mfma_f32_16x16x32_bf16 v[64:67], a[88:91], v[116:119], v[64:67]
    ds_read_b64_tr_b16 a[188:189], v247 offset:28928
    ds_read_b128 v[52:55], v233 offset:16384
    v_mfma_f32_16x16x32_bf16 v[80:83], a[92:95], v[116:119], v[80:83]
    ds_read_b128 v[56:59], v234 offset:17408
    v_mfma_f32_16x16x32_bf16 v[96:99], v[204:207], v[116:119], v[96:99]
    ds_read_b128 v[60:63], v235 offset:18432
    s_waitcnt vmcnt(7)
    v_mfma_f32_16x16x32_bf16 v[32:35], a[96:99], v[120:123], v[32:35]
    ds_read_b64_tr_b16 a[190:191], v247 offset:29440
    ds_read_b64_tr_b16 a[192:193], v246 offset:45056
    v_mfma_f32_16x16x32_bf16 v[48:51], a[100:103], v[120:123], v[48:51]
    ds_read_b64_tr_b16 a[194:195], v246 offset:45568
    ds_read_b64_tr_b16 a[196:197], v247 offset:45056
    v_mfma_f32_16x16x32_bf16 v[64:67], a[104:107], v[120:123], v[64:67]
    ds_read_b64_tr_b16 a[198:199], v247 offset:45568
    ds_read_b128 v[36:39], v233 offset:0
    v_mfma_f32_16x16x32_bf16 v[80:83], a[108:111], v[120:123], v[80:83]
    ds_read_b128 v[40:43], v234 offset:1024
    v_mfma_f32_16x16x32_bf16 v[96:99], v[100:103], v[120:123], v[96:99]
    ds_read_b128 v[44:47], v235 offset:2048
    s_waitcnt vmcnt(6)
    v_mfma_f32_16x16x32_bf16 v[32:35], a[112:115], v[124:127], v[32:35]
    ds_read_b64_tr_b16 a[200:201], v246 offset:45312
    ds_read_b64_tr_b16 a[202:203], v246 offset:45824
    v_mfma_f32_16x16x32_bf16 v[48:51], a[116:119], v[124:127], v[48:51]
    ds_read_b64_tr_b16 a[204:205], v247 offset:45312
    v_mfma_f32_16x16x32_bf16 v[64:67], a[120:123], v[124:127], v[64:67]
    ds_read_b64_tr_b16 a[206:207], v247 offset:45824
    v_mfma_f32_16x16x32_bf16 v[80:83], a[124:127], v[124:127], v[80:83]
    ds_read_b64_tr_b16 a[208:209], v246 offset:61440
    v_mfma_f32_16x16x32_bf16 v[96:99], v[104:107], v[124:127], v[96:99]
    ds_read_b64_tr_b16 a[210:211], v246 offset:61952
    s_waitcnt vmcnt(5)
    v_mfma_f32_16x16x32_bf16 v[32:35], a[128:131], v[128:131], v[32:35]
    ds_read_b64_tr_b16 a[212:213], v247 offset:61440
    ds_read_b64_tr_b16 a[214:215], v247 offset:61952
    v_mfma_f32_16x16x32_bf16 v[48:51], a[132:135], v[128:131], v[48:51]
    ds_read_b64_tr_b16 a[216:217], v246 offset:61696
    v_mfma_f32_16x16x32_bf16 v[64:67], a[136:139], v[128:131], v[64:67]
    ds_read_b64_tr_b16 a[218:219], v246 offset:62208
    v_mfma_f32_16x16x32_bf16 v[80:83], a[140:143], v[128:131], v[80:83]
    ds_read_b64_tr_b16 a[220:221], v247 offset:61696
    v_mfma_f32_16x16x32_bf16 v[96:99], v[108:111], v[128:131], v[96:99]
    ds_read_b64_tr_b16 a[222:223], v247 offset:62208
    s_waitcnt lgkmcnt(15)
    s_waitcnt vmcnt(4)
    v_mfma_f32_16x16x32_bf16 v[32:35], a[144:147], v[132:135], v[32:35]
    v_mfma_f32_16x16x32_bf16 v[48:51], a[148:151], v[132:135], v[48:51]
    v_add_f32 v52, v52, v56
    v_mfma_f32_16x16x32_bf16 v[64:67], a[152:155], v[132:135], v[64:67]
    v_add_f32 v53, v53, v57
    v_mfma_f32_16x16x32_bf16 v[80:83], a[156:159], v[132:135], v[80:83]
    v_add_f32 v54, v54, v58
    v_mfma_f32_16x16x32_bf16 v[96:99], v[84:87], v[132:135], v[96:99]
    s_waitcnt vmcnt(3)
    v_mfma_f32_16x16x32_bf16 v[32:35], a[160:163], v[136:139], v[32:35]
    v_add_f32 v55, v55, v59
    v_mfma_f32_16x16x32_bf16 v[48:51], a[164:167], v[136:139], v[48:51]
    v_add_f32 v52, v52, v60
    v_mfma_f32_16x16x32_bf16 v[64:67], a[168:171], v[136:139], v[64:67]
    v_add_f32 v53, v53, v61
    v_mfma_f32_16x16x32_bf16 v[80:83], a[172:175], v[136:139], v[80:83]
    v_add_f32 v54, v54, v62
    v_mfma_f32_16x16x32_bf16 v[96:99], v[88:91], v[136:139], v[96:99]
    s_waitcnt vmcnt(2)
    v_mfma_f32_16x16x32_bf16 v[32:35], a[176:179], v[140:143], v[32:35]
    v_add_f32 v55, v55, v63
    v_mfma_f32_16x16x32_bf16 v[48:51], a[180:183], v[140:143], v[48:51]
    s_waitcnt lgkmcnt(12)
    v_mfma_f32_16x16x32_bf16 v[64:67], a[184:187], v[140:143], v[64:67]
    v_add_f32 v36, v36, v40
    v_mfma_f32_16x16x32_bf16 v[80:83], a[188:191], v[140:143], v[80:83]
    v_add_f32 v37, v37, v41
    v_mfma_f32_16x16x32_bf16 v[96:99], v[92:95], v[140:143], v[96:99]
    s_waitcnt lgkmcnt(8)
    s_waitcnt vmcnt(1)
    v_mfma_f32_16x16x32_bf16 v[32:35], a[192:195], v[144:147], v[32:35]
    v_add_f32 v38, v38, v42
    v_mfma_f32_16x16x32_bf16 v[48:51], a[196:199], v[144:147], v[48:51]
    v_add_f32 v39, v39, v43
    v_mfma_f32_16x16x32_bf16 v[64:67], a[200:203], v[144:147], v[64:67]
    v_add_f32 v36, v36, v44
    v_mfma_f32_16x16x32_bf16 v[80:83], a[204:207], v[144:147], v[80:83]
    v_add_f32 v37, v37, v45
    v_mfma_f32_16x16x32_bf16 v[96:99], v[68:71], v[144:147], v[96:99]
    s_waitcnt lgkmcnt(0)
    s_waitcnt vmcnt(0)
    v_mfma_f32_16x16x32_bf16 v[32:35], a[208:211], v[148:151], v[32:35]
    v_add_f32 v38, v38, v46
    v_mfma_f32_16x16x32_bf16 v[48:51], a[212:215], v[148:151], v[48:51]
    v_add_f32 v39, v39, v47
    v_mfma_f32_16x16x32_bf16 v[64:67], a[216:219], v[148:151], v[64:67]
    v_mfma_f32_16x16x32_bf16 v[80:83], a[220:223], v[148:151], v[80:83]
    v_mfma_f32_16x16x32_bf16 v[96:99], v[72:75], v[148:151], v[96:99]
    s_nop 1
    v_pk_add_f32 v[32:33], v[32:33], v[36:37]
    v_pk_add_f32 v[34:35], v[34:35], v[38:39]
    v_pk_add_f32 v[48:49], v[48:49], v[52:53]
    v_pk_add_f32 v[50:51], v[50:51], v[54:55]
    ds_write_b128 v238, v[32:35]
    ds_write_b128 v239, v[48:51]
    ds_write_b128 v240, v[64:67]
    ds_write_b128 v241, v[80:83]
    ds_read_b128 v[160:163], v244 offset:0
    ds_read_b128 v[164:167], v245 offset:0
    ds_read_b128 v[168:171], v244 offset:2048
    ds_read_b128 v[172:175], v245 offset:2048
    ds_write_b128 v242, v[96:99]
    ds_read_b128 v[192:195], v252
    s_waitcnt lgkmcnt(4)
    v_pk_add_f32 v[176:177], v[176:177], v[160:161]
    v_pk_add_f32 v[178:179], v[178:179], v[162:163]
    v_pk_add_f32 v[180:181], v[180:181], v[164:165]
    v_pk_add_f32 v[182:183], v[182:183], v[166:167]
    v_cvt_pk_bf16_f32 v216, v176, v177
    v_cvt_pk_bf16_f32 v217, v178, v179
    v_cvt_pk_bf16_f32 v218, v180, v181
    v_cvt_pk_bf16_f32 v219, v182, v183
    buffer_store_dwordx4 v[216:219], v22, s[28:31], s71 offen
    s_waitcnt lgkmcnt(2)
    v_pk_add_f32 v[184:185], v[184:185], v[168:169]
    v_pk_add_f32 v[186:187], v[186:187], v[170:171]
    v_pk_add_f32 v[188:189], v[188:189], v[172:173]
    v_pk_add_f32 v[190:191], v[190:191], v[174:175]
    v_cvt_pk_bf16_f32 v220, v184, v185
    v_cvt_pk_bf16_f32 v221, v186, v187
    v_cvt_pk_bf16_f32 v222, v188, v189
    v_cvt_pk_bf16_f32 v223, v190, v191
    buffer_store_dwordx4 v[220:223], v22, s[28:31], s72 offen
    s_waitcnt lgkmcnt(0)
    v_pk_add_f32 v[248:249], v[248:249], v[192:193]
    v_pk_add_f32 v[250:251], v[250:251], v[194:195]
    v_cvt_pk_bf16_f32 v224, v248, v249
    v_cvt_pk_bf16_f32 v225, v250, v251
    buffer_store_dwordx2 v[224:225], v26, s[28:31], s73 offen
L_end:
    s_endpgm
L_p2_alt:
    s_add_u32 s57, s57, 27648
    buffer_load_dwordx4 v10, s[16:19], s57 offen offset:2048 lds
    s_add_u32 s57, s57, 27648
    buffer_load_dwordx4 v11, s[16:19], s57 offen offset:3072 lds
    s_xor_b32 s66, s44, 3
    s_lshl2_add_u32 s66, s51, s66
    s_mul_i32 s66, s66, 66816
    s_lshl2_add_u32 s66, s52, s66
    s_lshl_b32 s86, s65, 10
    s_add_u32 s58, s86, s66
    s_add_u32 s86, s66, 13312
    buffer_load_dwordx4 v[128:131], v23, s[24:27], s58 offen offset:0 sc1
    s_add_u32 s58, s58, 1024
    s_cmp_eq_u32 s58, s86
    s_cselect_b32 s58, s66, s58
    buffer_load_dwordx4 v[132:135], v23, s[24:27], s58 offen offset:0 sc1
    s_add_u32 s58, s58, 1024
    s_cmp_eq_u32 s58, s86
    s_cselect_b32 s58, s66, s58
    buffer_load_dwordx4 v[136:139], v23, s[24:27], s58 offen offset:0 sc1
    s_add_u32 s58, s58, 1024
    s_cmp_eq_u32 s58, s86
    s_cselect_b32 s58, s66, s58
    buffer_load_dwordx4 v[140:143], v23, s[24:27], s58 offen offset:0 sc1
    s_add_u32 s58, s58, 1024
    s_cmp_eq_u32 s58, s86
    s_cselect_b32 s58, s66, s58
    buffer_load_dwordx4 v[144:147], v23, s[24:27], s58 offen offset:0 sc1
    s_add_u32 s58, s58, 1024
    s_cmp_eq_u32 s58, s86
    s_cselect_b32 s58, s66, s58
    buffer_load_dwordx4 v[148:151], v23, s[24:27], s58 offen offset:0 sc1
    s_add_u32 s58, s58, 1024
    s_cmp_eq_u32 s58, s86
    s_cselect_b32 s58, s66, s58
    buffer_load_dwordx4 v[152:155], v23, s[24:27], s58 offen offset:0 sc1
    s_add_u32 s58, s58, 1024
    s_cmp_eq_u32 s58, s86
    s_cselect_b32 s58, s66, s58
    buffer_load_dwordx4 v[156:159], v23, s[24:27], s58 offen offset:0 sc1
    s_add_u32 s58, s58, 1024
    s_cmp_eq_u32 s58, s86
    s_cselect_b32 s58, s66, s58
    buffer_load_dwordx4 v[112:115], v23, s[24:27], s58 offen offset:0 sc1
    s_add_u32 s58, s58, 1024
    s_cmp_eq_u32 s58, s86
    s_cselect_b32 s58, s66, s58
    buffer_load_dwordx4 v[116:119], v23, s[24:27], s58 offen offset:0 sc1
    s_waitcnt vmcnt(18)
    ds_read_b64_tr_b16 a[208:209], v4 offset:32768
    ds_read_b64_tr_b16 a[210:211], v4 offset:33280
    ds_read_b64_tr_b16 a[212:213], v5 offset:32768
    ds_read_b64_tr_b16 a[214:215], v5 offset:33280
    ds_read_b64_tr_b16 a[216:217], v4 offset:33024
    ds_read_b64_tr_b16 a[218:219], v4 offset:33536
    ds_read_b64_tr_b16 a[220:221], v5 offset:33024
    ds_read_b64_tr_b16 a[222:223], v5 offset:33536
    s_waitcnt vmcnt(14)
    ds_read_b64_tr_b16 a[224:225], v2 offset:0
    ds_read_b64_tr_b16 a[226:227], v2 offset:512
    ds_read_b64_tr_b16 a[228:229], v3 offset:0
    ds_read_b64_tr_b16 a[230:231], v3 offset:512
    ds_read_b64_tr_b16 a[232:233], v2 offset:256
    ds_read_b64_tr_b16 a[234:235], v2 offset:768
    ds_read_b64_tr_b16 a[236:237], v3 offset:256
    ds_read_b64_tr_b16 a[238:239], v3 offset:768
    s_waitcnt vmcnt(10)
    ds_read_b64_tr_b16 a[240:241], v2 offset:16384
    ds_read_b64_tr_b16 a[242:243], v2 offset:16896
    ds_read_b64_tr_b16 a[244:245], v3 offset:16384
    ds_read_b64_tr_b16 a[246:247], v3 offset:16896
    ds_read_b64_tr_b16 a[248:249], v2 offset:16640
    ds_read_b64_tr_b16 a[250:251], v2 offset:17152
    ds_read_b64_tr_b16 a[252:253], v3 offset:16640
    ds_read_b64_tr_b16 a[254:255], v3 offset:17152
    s_waitcnt lgkmcnt(0)
    s_branch L_p2_join
L_p3_alt:
    s_add_u32 s66, s69, 175872
    s_add_u32 s58, s66, s76
    buffer_load_dwordx4 v[152:155], v23, s[24:27], s58 offen offset:0 sc1
    buffer_load_dwordx4 v[156:159], v23, s[24:27], s58 offen offset:1024 sc1
    s_add_u32 s58, s66, s77
    buffer_load_dwordx4 v[112:115], v23, s[24:27], s58 offen offset:0 sc1
    buffer_load_dwordx4 v[116:119], v23, s[24:27], s58 offen offset:1024 sc1
    s_add_u32 s58, s66, s78
    buffer_load_dwordx4 v[120:123], v23, s[24:27], s58 offen offset:0 sc1
    buffer_load_dwordx4 v[124:127], v23, s[24:27], s58 offen offset:1024 sc1
    s_add_u32 s58, s66, s79
    buffer_load_dwordx4 v[128:131], v23, s[24:27], s58 offen offset:0 sc1
    buffer_load_dwordx4 v[132:135], v23, s[24:27], s58 offen offset:1024 sc1
    s_add_u32 s58, s66, s80
    buffer_load_dwordx4 v[136:139], v23, s[24:27], s58 offen offset:0 sc1
    buffer_load_dwordx4 v[140:143], v23, s[24:27], s58 offen offset:1024 sc1
    s_waitcnt vmcnt(10) lgkmcnt(0)
    s_branch L_p3_join
L_help:
    s_sub_u32 s55, s46, 21
    v_lshlrev_b32 v217, 7, v1
    v_lshrrev_b32 v218, 2, v1
    v_lshlrev_b32 v218, 12, v218
    v_lshl_add_u32 v218, v210, 7, v218
    v_mul_u32_u24 v220, 3584, v1
    s_lshl4_add_u32 s54, s44, s65
    s_mul_i32 s54, s54, 114688
    s_lshl_b32 s56, s50, 7
    s_add_u32 s54, s54, s56
    buffer_load_dword v108, v220, s[16:19], s54 offen
    v_mul_u32_u24 v109, 960, v25
    v_lshl_add_u32 v109, v26, 4, v109
    v_mul_u32_u24 v110, 960, v209
    v_lshl_add_u32 v110, v208, 5, v110
    v_lshl_add_u32 v110, v210, 3, v110
    s_lshl_b32 s53, s44, 7
    v_add_u32 v110, s53, v110
    v_mul_u32_u24 v111, 66816, v208
    v_lshl_add_u32 v111, v211, 4, v111
    s_mul_i32 s63, s44, 267264
    s_lshl_b32 s53, s2, 8
    s_add_u32 s63, s63, s53
    s_add_u32 s64, s63, 1069056
    s_cmp_eq_u32 s44, 3
    s_cselect_b32 s64, 2130706432, s64
    s_mov_b32 s62, 0x3f803f80
    s_mov_b32 s61, 0xffff0000
    s_mov_b32 s66, 6291456
    v_mov_b32 v96, 0
    v_mov_b32 v97, 0
    s_waitcnt vmcnt(4)
    v_dot2c_f32_bf16 v96, s62, v32
    v_dot2c_f32_bf16 v97, v32, v32
    v_lshlrev_b32 v40, 16, v32
    v_and_b32 v41, s61, v32
    v_dot2c_f32_bf16 v96, s62, v33
    v_dot2c_f32_bf16 v97, v33, v33
    v_lshlrev_b32 v42, 16, v33
    v_and_b32 v43, s61, v33
    v_dot2c_f32_bf16 v96, s62, v34
    v_dot2c_f32_bf16 v97, v34, v34
    v_lshlrev_b32 v44, 16, v34
    v_and_b32 v45, s61, v34
    v_dot2c_f32_bf16 v96, s62, v35
    v_dot2c_f32_bf16 v97, v35, v35
    v_lshlrev_b32 v46, 16, v35
    v_and_b32 v47, s61, v35
    s_waitcnt vmcnt(3)
    v_dot2c_f32_bf16 v96, s62, v36
    v_dot2c_f32_bf16 v97, v36, v36
    v_lshlrev_b32 v48, 16, v36
    v_and_b32 v49, s61, v36
    v_dot2c_f32_bf16 v96, s62, v37
    v_dot2c_f32_bf16 v97, v37, v37
    v_lshlrev_b32 v50, 16, v37
    v_and_b32 v51, s61, v37
    v_dot2c_f32_bf16 v96, s62, v38
    v_dot2c_f32_bf16 v97, v38, v38
    v_lshlrev_b32 v52, 16, v38
    v_and_b32 v53, s61, v38
    v_dot2c_f32_bf16 v96, s62, v39
    v_dot2c_f32_bf16 v97, v39, v39
    v_lshlrev_b32 v54, 16, v39
    v_and_b32 v55, s61, v39
    buffer_load_dword v29, off, s[40:43], 0 sc1
    v_add_f32_dpp v96, v96, v96 quad_perm:[1,0,3,2] row_mask:0xf bank_mask:0xf
    v_add_f32_dpp v97, v97, v97 quad_perm:[1,0,3,2] row_mask:0xf bank_mask:0xf
    s_nop 0
    v_add_f32_dpp v96, v96, v96 quad_perm:[2,3,0,1] row_mask:0xf bank_mask:0xf
    v_add_f32_dpp v97, v97, v97 quad_perm:[2,3,0,1] row_mask:0xf bank_mask:0xf
    s_nop 0
    v_add_f32_dpp v96, v96, v96 row_half_mirror row_mask:0xf bank_mask:0xf
    v_add_f32_dpp v97, v97, v97 row_half_mirror row_mask:0xf bank_mask:0xf
    s_nop 0
    v_add_f32_dpp v96, v96, v96 row_mirror row_mask:0xf bank_mask:0xf
    v_add_f32_dpp v97, v97, v97 row_mirror row_mask:0xf bank_mask:0xf
    v_mov_b32 v98, v96
    v_mov_b32 v99, v97
    s_nop 0
    v_permlane16_swap_b32 v96, v98
    v_permlane16_swap_b32 v97, v99
    v_add_f32 v96, v96, v98
    v_add_f32 v97, v97, v99
    v_mul_f32 v98, 0x3b124925, v96
    v_mul_f32 v99, 0x3b124925, v97
    v_fma_f32 v99, -v98, v98, v99
    v_max_f32 v99, 0, v99
    v_cvt_pk_bf16_f32 v100, 0, v99
    v_add_f32 v100, 0x3727c5ac, v100
    v_cvt_pk_bf16_f32 v100, 0, v100
    v_sqrt_f32 v100, v100
    s_nop 0
    v_cvt_pk_bf16_f32 v100, 0, v100
    v_rcp_f32 v100, v100
    s_nop 0
    v_mul_f32 v99, v99, v100
    v_mul_f32 v102, v98, v100
    v_mul_f32 v99, v99, v100
    v_cvt_pk_bf16_f32 v104, 0, v99
    v_add_f32 v104, 0x3727c5ac, v104
    v_cvt_pk_bf16_f32 v104, 0, v104
    v_sqrt_f32 v104, v104
    s_nop 0
    v_cvt_pk_bf16_f32 v104, 0, v104
    v_rcp_f32 v104, v104
    s_nop 0
    v_mul_f32 v104, v104, v100
    v_mul_f32 v106, v98, v104
    v_pk_fma_f32 v[56:57], v[40:41], v[104:105], v[106:107] op_sel_hi:[1,0,0] neg_lo:[0,0,1] neg_hi:[0,0,1]
    v_pk_fma_f32 v[58:59], v[42:43], v[104:105], v[106:107] op_sel_hi:[1,0,0] neg_lo:[0,0,1] neg_hi:[0,0,1]
    v_pk_fma_f32 v[60:61], v[44:45], v[104:105], v[106:107] op_sel_hi:[1,0,0] neg_lo:[0,0,1] neg_hi:[0,0,1]
    v_pk_fma_f32 v[62:63], v[46:47], v[104:105], v[106:107] op_sel_hi:[1,0,0] neg_lo:[0,0,1] neg_hi:[0,0,1]
    v_pk_fma_f32 v[64:65], v[48:49], v[104:105], v[106:107] op_sel_hi:[1,0,0] neg_lo:[0,0,1] neg_hi:[0,0,1]
    v_pk_fma_f32 v[66:67], v[50:51], v[104:105], v[106:107] op_sel_hi:[1,0,0] neg_lo:[0,0,1] neg_hi:[0,0,1]
    v_pk_fma_f32 v[68:69], v[52:53], v[104:105], v[106:107] op_sel_hi:[1,0,0] neg_lo:[0,0,1] neg_hi:[0,0,1]
    v_pk_fma_f32 v[70:71], v[54:55], v[104:105], v[106:107] op_sel_hi:[1,0,0] neg_lo:[0,0,1] neg_hi:[0,0,1]
    v_cvt_pk_bf16_f32 v80, v56, v57
    v_cvt_pk_bf16_f32 v81, v58, v59
    v_cvt_pk_bf16_f32 v82, v60, v61
    v_cvt_pk_bf16_f32 v83, v62, v63
    v_cvt_pk_bf16_f32 v84, v64, v65
    v_cvt_pk_bf16_f32 v85, v66, v67
    v_cvt_pk_bf16_f32 v86, v68, v69
    v_cvt_pk_bf16_f32 v87, v70, v71
    ds_write_b128 v109, v[80:83] offset:0
    ds_write_b128 v109, v[84:87] offset:448
    v_pk_fma_f32 v[40:41], v[40:41], v[100:101], v[102:103] op_sel_hi:[1,0,0] neg_lo:[0,0,1] neg_hi:[0,0,1]
    v_pk_fma_f32 v[42:43], v[42:43], v[100:101], v[102:103] op_sel_hi:[1,0,0] neg_lo:[0,0,1] neg_hi:[0,0,1]
    v_pk_fma_f32 v[44:45], v[44:45], v[100:101], v[102:103] op_sel_hi:[1,0,0] neg_lo:[0,0,1] neg_hi:[0,0,1]
    v_pk_fma_f32 v[46:47], v[46:47], v[100:101], v[102:103] op_sel_hi:[1,0,0] neg_lo:[0,0,1] neg_hi:[0,0,1]
    v_pk_fma_f32 v[48:49], v[48:49], v[100:101], v[102:103] op_sel_hi:[1,0,0] neg_lo:[0,0,1] neg_hi:[0,0,1]
    v_pk_fma_f32 v[50:51], v[50:51], v[100:101], v[102:103] op_sel_hi:[1,0,0] neg_lo:[0,0,1] neg_hi:[0,0,1]
    v_pk_fma_f32 v[52:53], v[52:53], v[100:101], v[102:103] op_sel_hi:[1,0,0] neg_lo:[0,0,1] neg_hi:[0,0,1]
    v_pk_fma_f32 v[54:55], v[54:55], v[100:101], v[102:103] op_sel_hi:[1,0,0] neg_lo:[0,0,1] neg_hi:[0,0,1]
    v_cvt_pk_bf16_f32 v72, v40, v41
    v_cvt_pk_bf16_f32 v73, v42, v43
    v_cvt_pk_bf16_f32 v74, v44, v45
    v_cvt_pk_bf16_f32 v75, v46, v47
    v_cvt_pk_bf16_f32 v76, v48, v49
    v_cvt_pk_bf16_f32 v77, v50, v51
    v_cvt_pk_bf16_f32 v78, v52, v53
    v_cvt_pk_bf16_f32 v79, v54, v55
    s_waitcnt lgkmcnt(0)
    s_barrier
    ds_read_b64_tr_b16 v[88:89], v110 offset:0
    ds_read_b64_tr_b16 v[90:91], v110 offset:3840
    ds_read_b64_tr_b16 v[92:93], v110 offset:512
    ds_read_b64_tr_b16 v[94:95], v110 offset:4352
    buffer_store_dwordx4 v[72:75], v24, s[24:27], s66 offen offset:0 sc1
    buffer_store_dwordx4 v[76:79], v24, s[24:27], s66 offen offset:448 sc1
    s_waitcnt lgkmcnt(2)
    buffer_store_dwordx4 v[88:91], v111, s[24:27], s63 offen sc1
    s_waitcnt lgkmcnt(0)
    buffer_store_dwordx4 v[92:95], v111, s[24:27], s64 offen sc1
    v_min_u32 v220, 111104, v220
    s_add_u32 s54, s54, 229376
    buffer_load_dword v108, v220, s[16:19], s54 offen
    s_waitcnt vmcnt(1)
    v_cmp_eq_u32 vcc, 0, v29
    s_nop 0
    s_cbranch_vccz L_ok12
    s_mov_b32 s59, 20000
L_spin11:
    s_sleep 2
    buffer_load_dword v29, off, s[40:43], 0 sc1
    s_waitcnt vmcnt(0)
    v_cmp_eq_u32 vcc, 0, v29
    s_nop 0
    s_cbranch_vccz L_ok12
    s_sub_u32 s59, s59, 1
    s_cbranch_scc0 L_spin11
L_ok12:
    v_readfirstlane_b32 s47, v29
    s_barrier
    s_cmp_lg_u32 s44, 0
    s_cbranch_scc1 L_nopub13
    s_lshl_b32 s60, s2, 5
    s_add_u32 s60, s60, 12582912
    v_mov_b32 v30, s47
    s_mov_b64 exec, 1
    buffer_store_dword v30, off, s[24:27], s60 sc1
    s_mov_b64 exec, -1
L_nopub13:
    buffer_load_dword v108, v217, s[32:35], 0 offen
    v_lshrrev_b32 v219, 2, v1
    v_min_u32 v219, 15, v219
    v_mul_u32_u24 v219, 3584, v219
    v_lshl_add_u32 v219, v210, 7, v219
    s_mul_i32 s54, s55, 16
    s_lshl_b32 s56, s44, 9
    s_add_u32 s54, s54, s56
    s_add_u32 s54, s54, 416
    s_mul_i32 s54, s54, 3584
    s_mul_i32 s56, s45, 7
    s_lshr_b32 s56, s56, 1
    s_lshl_b32 s56, s56, 7
    s_add_u32 s54, s54, s56
    buffer_load_dword v108, v219, s[16:19], s54 offen
    s_add_u32 s54, s54, 172032
    buffer_load_dword v108, v219, s[16:19], s54 offen
    s_add_u32 s54, s54, 172032
    s_mul_i32 s54, s44, 28
    s_add_u32 s54, s54, s55
    s_add_u32 s54, s54, 0
    s_lshl_b32 s54, s54, 16
    s_lshl_b32 s56, s45, 9
    s_add_u32 s54, s54, s56
    buffer_load_dword v108, v218, s[20:23], s54 offen
    s_add_u32 s54, s54, 196608
    buffer_load_dword v108, v218, s[20:23], s54 offen
    s_add_u32 s54, s54, 196608
    buffer_load_dword v108, v218, s[20:23], s54 offen
    s_add_u32 s54, s54, 196608
    buffer_load_dword v108, v218, s[20:23], s54 offen
    s_add_u32 s54, s54, 196608
    buffer_load_dword v108, v217, s[36:39], 0 offen
    s_waitcnt vmcnt(0) lgkmcnt(0)
    v_lshlrev_b32 v216, 6, v209
    v_lshl_add_u32 v216, v210, 3, v216
    v_lshl_add_u32 v216, v215, 5, v216
    s_add_u32 s53, s52, 49152
    v_lshl_add_u32 v2, v208, 10, v216
    v_add_u32 v2, s53, v2
    v_xor_b32 v3, 32, v2
    v_add_u32 v4, 65536, v2
    v_add_u32 v5, 65536, v3
    v_lshl_add_u32 v6, v208, 9, v216
    v_add_u32 v6, s53, v6
    v_xor_b32 v7, 32, v6
    v_add_u32 v8, 65536, v6
    v_add_u32 v9, 65536, v7
    s_lshr_b32 s53, s46, 2
    s_and_b32 s89, s46, 3
    s_bfe_u32 s54, s46, 0x20001
    s_and_b32 s55, s46, 1
    s_add_u32 s55, s55, 4
    s_cmp_lt_u32 s46, 16
    s_cselect_b32 s53, s53, s54
    s_cselect_b32 s89, s89, s55
    s_mul_i32 s49, s53, 2
    s_add_u32 s49, s49, s89
    s_sub_u32 s54, s49, 6
    s_min_u32 s49, s49, s54
    s_lshl2_add_u32 s48, s45, s53
    s_mul_i32 s53, s44, 1835008
    s_lshl_b32 s74, s48, 7
    s_add_u32 s53, s53, s74
    s_lshl_b32 s56, s44, 5
    v_lshlrev_b32 v217, 5, v212
    v_xor_b32 v217, v217, v214
    v_xor_b32 v217, s56, v217
    s_add_u32 s74, s74, s56
    v_lshlrev_b32 v12, 12, v213
    v_add3_u32 v12, v12, v217, s53
    s_mul_i32 s53, s44, 100352
    s_lshl_b32 s54, s49, 7
    s_add_u32 s55, s53, s54
    v_mul_u32_u24 v13, 896, v213
    v_add3_u32 v13, v13, v214, s55
    v_xor_b32 v14, 32, v13
    s_mul_i32 s73, s48, 57344
    s_add_u32 s71, s73, s54
    s_mul_i32 s55, s44, 14336
    s_add_u32 s71, s71, s55
    s_add_u32 s72, s71, 7168
    v_bfe_u32 v217, v1, 1, 2
    v_lshl_add_u32 v217, v212, 2, v217
    v_and_b32 v218, 24, v1
    v_add_u32 v217, v217, v218
    v_mul_u32_u24 v15, 896, v217
    v_and_b32 v217, 1, v1
    v_lshl_add_u32 v15, v217, 4, v15
    v_add_u32 v15, s53, v15
    s_lshl_b32 s54, s89, 5
    s_add_u32 s54, s54, 768
    s_add_u32 s68, s89, 24
    s_mul_i32 s68, s68, 58624
    s_mul_i32 s69, s44, 14336
    s_add_u32 s69, s69, 2097152
    s_add_u32 s68, s68, s69
    s_mul_i32 s55, s49, 234496
    s_add_u32 s69, s69, s55
    s_add_u32 s73, s73, s54
    s_mov_b32 s76, 0
    s_add_u32 s77, s76, 2048
    s_cmp_eq_u32 s77, 14336
    s_cselect_b32 s77, 0, s77
    s_add_u32 s78, s77, 2048
    s_cmp_eq_u32 s78, 14336
    s_cselect_b32 s78, 0, s78
    s_add_u32 s79, s78, 2048
    s_cmp_eq_u32 s79, 14336
    s_cselect_b32 s79, 0, s79
    s_add_u32 s80, s79, 2048
    s_cmp_eq_u32 s80, 14336
    s_cselect_b32 s80, 0, s80
    s_add_u32 s81, s80, 2048
    s_cmp_eq_u32 s81, 14336
    s_cselect_b32 s81, 0, s81
    s_add_u32 s82, s81, 2048
    s_cmp_eq_u32 s82, 14336
    s_cselect_b32 s82, 0, s82
    s_cmp_lt_u32 s89, 4
    s_cselect_b32 s75, s54, 2130706432
    s_cselect_b32 s68, s68, 2130706432
    s_cselect_b32 s73, s73, 2130706432
    v_lshlrev_b32 v16, 3, v1
    v_add_u32 v16, 81920, v16
    v_and_b32 v217, 7, v1
    v_min_u32 v218, 6, v217
    s_mul_i32 s54, s44, 7
    v_add_u32 v218, s54, v218
    v_mul_u32_u24 v219, 2, v218
    v_add_u32 v219, s89, v219
    v_mul_u32_u24 v220, 43, v219
    v_lshrrev_b32 v220, 8, v220
    v_mul_u32_u24 v220, 6, v220
    v_sub_u32 v219, v219, v220
    v_subrev_u32 v219, s49, v219
    v_bfe_u32 v220, v1, 3, 1
    v_mul_i32_i24 v219, v219, v220
    v_add_u32 v219, s49, v219
    v_lshl_add_u32 v218, v219, 5, v218
    v_lshlrev_b32 v20, 7, v218
    v_add_u32 v20, 12713984, v20
    s_lshr_b32 s53, s48, 1
    s_lshl_b32 s53, s53, 7
    s_add_u32 s53, s53, 12779520
    v_lshl_add_u32 v21, v210, 11, s53
    s_lshl_b32 s70, s48, 16
    s_lshl2_add_u32 s70, s52, s70
    s_add_u32 s70, s70, 4194304
    v_lshrrev_b32 v218, 3, v1
    v_mul_u32_u24 v22, 896, v218
    v_lshl_add_u32 v22, v217, 4, v22
    v_lshlrev_b32 v25, 1, v211
    s_add_u32 s53, s52, 65536
    v_lshl_add_u32 v244, v218, 8, s53
    v_bfe_u32 v219, v218, 1, 1
    v_lshl_add_u32 v244, v219, 7, v244
    v_xor_b32 v219, v218, v217
    v_lshl_add_u32 v244, v219, 4, v244
    v_xor_b32 v245, 128, v244
    v_xor_b32 v218, v217, v212
    v_lshl_add_u32 v238, v218, 4, s53
    v_bfe_u32 v219, v1, 1, 1
    v_xor_b32 v219, v219, v215
    v_lshl_add_u32 v238, v219, 7, v238
    v_lshl_add_u32 v238, v211, 8, v238
    v_lshrrev_b32 v218, 2, v0
    v_mul_u32_u24 v26, 896, v218
    v_lshl_add_u32 v26, v210, 3, v26
    s_add_u32 s53, s52, 52224
    v_lshrrev_b32 v218, 2, v1
    v_bfe_u32 v219, v218, 1, 2
    v_xor_b32 v219, v219, v210
    v_lshl_add_u32 v252, v218, 6, s53
    v_lshl_add_u32 v252, v219, 4, v252
    v_bfe_u32 v219, v1, 1, 2
    v_xor_b32 v219, v219, v208
    v_lshl_add_u32 v242, v211, 6, s53
    v_lshl_add_u32 v242, v219, 4, v242
    s_sub_u32 s53, 49152, s52
    v_add_u32 v246, s53, v2
    v_add_u32 v247, s53, v3
    v_add_u32 v232, s52, v23
    v_xor_b32 v233, 4096, v232
    v_xor_b32 v234, 8192, v232
    v_xor_b32 v235, 12288, v232
    v_xor_b32 v239, 32, v238
    v_xor_b32 v240, 64, v238
    v_xor_b32 v241, 96, v238
    buffer_load_dwordx4 v[216:219], v22, s[4:7], s71 offen
    buffer_load_dwordx4 v[220:223], v22, s[4:7], s72 offen
    buffer_load_dwordx2 v[224:225], v26, s[4:7], s73 offen
    buffer_load_ushort v228, v25, s[36:39], s74 offen
    s_add_u32 m0, s52, 81920
    s_lshl_b32 s57, s76, 7
    buffer_load_dwordx4 v12, s[20:23], s57 offen offset:0 lds
    s_add_u32 s57, s57, 31744
    buffer_load_dwordx4 v12, s[20:23], s57 offen offset:1024 lds
    s_add_u32 s57, s57, 31744
    buffer_load_dwordx4 v12, s[20:23], s57 offen offset:2048 lds
    s_add_u32 s57, s57, 31744
    buffer_load_dwordx4 v12, s[20:23], s57 offen offset:3072 lds
    s_add_u32 m0, s52, 98304
    s_lshl_b32 s57, s76, 7
    s_add_u32 s57, s57, 131072
    buffer_load_dwordx4 v12, s[20:23], s57 offen offset:0 lds
    s_add_u32 s57, s57, 31744
    buffer_load_dwordx4 v12, s[20:23], s57 offen offset:1024 lds
    s_add_u32 s57, s57, 31744
    buffer_load_dwordx4 v12, s[20:23], s57 offen offset:2048 lds
    s_add_u32 s57, s57, 31744
    buffer_load_dwordx4 v12, s[20:23], s57 offen offset:3072 lds
    s_add_u32 m0, s52, 114688
    s_lshl_b32 s57, s77, 7
    buffer_load_dwordx4 v12, s[20:23], s57 offen offset:0 lds
    s_add_u32 s57, s57, 31744
    buffer_load_dwordx4 v12, s[20:23], s57 offen offset:1024 lds
    s_add_u32 s57, s57, 31744
    buffer_load_dwordx4 v12, s[20:23], s57 offen offset:2048 lds
    s_add_u32 s57, s57, 31744
    buffer_load_dwordx4 v12, s[20:23], s57 offen offset:3072 lds
    s_add_u32 m0, s52, 131072
    s_lshl_b32 s57, s77, 7
    s_add_u32 s57, s57, 131072
    buffer_load_dwordx4 v12, s[20:23], s57 offen offset:0 lds
    s_add_u32 s57, s57, 31744
    buffer_load_dwordx4 v12, s[20:23], s57 offen offset:1024 lds
    s_waitcnt vmcnt(10)
    ds_read_b64_tr_b16 a[0:1], v6 offset:32768
    ds_read_b64_tr_b16 a[2:3], v6 offset:34816
    ds_read_b64_tr_b16 a[4:5], v7 offset:32768
    ds_read_b64_tr_b16 a[6:7], v7 offset:34816
    ds_read_b64_tr_b16 a[8:9], v6 offset:33024
    ds_read_b64_tr_b16 a[10:11], v6 offset:35072
    ds_read_b64_tr_b16 a[12:13], v7 offset:33024
    ds_read_b64_tr_b16 a[14:15], v7 offset:35072
    s_add_u32 s57, s57, 31744
    buffer_load_dwordx4 v12, s[20:23], s57 offen offset:2048 lds
    s_add_u32 s57, s57, 31744
    buffer_load_dwordx4 v12, s[20:23], s57 offen offset:3072 lds
    s_add_u32 m0, s52, 147456
    s_lshl_b32 s57, s78, 7
    buffer_load_dwordx4 v12, s[20:23], s57 offen offset:0 lds
    s_add_u32 s57, s57, 31744
    buffer_load_dwordx4 v12, s[20:23], s57 offen offset:1024 lds
    s_waitcnt vmcnt(10)
    ds_read_b64_tr_b16 a[16:17], v6 offset:49152
    ds_read_b64_tr_b16 a[18:19], v6 offset:51200
    ds_read_b64_tr_b16 a[20:21], v7 offset:49152
    ds_read_b64_tr_b16 a[22:23], v7 offset:51200
    s_add_u32 s57, s57, 31744
    buffer_load_dwordx4 v12, s[20:23], s57 offen offset:2048 lds
    ds_read_b64_tr_b16 a[24:25], v6 offset:49408
    ds_read_b64_tr_b16 a[26:27], v6 offset:51456
    ds_read_b64_tr_b16 a[28:29], v7 offset:49408
    ds_read_b64_tr_b16 a[30:31], v7 offset:51456
    s_add_u32 s57, s57, 31744
    buffer_load_dwordx4 v12, s[20:23], s57 offen offset:3072 lds
    s_add_u32 m0, s52, 49152
    s_lshl_b32 s57, s78, 7
    s_add_u32 s57, s57, 131072
    buffer_load_dwordx4 v12, s[20:23], s57 offen offset:0 lds
    s_add_u32 s57, s57, 31744
    buffer_load_dwordx4 v12, s[20:23], s57 offen offset:1024 lds
    s_waitcnt vmcnt(10)
    ds_read_b64_tr_b16 a[32:33], v8 offset:0
    ds_read_b64_tr_b16 a[34:35], v8 offset:2048
    ds_read_b64_tr_b16 a[36:37], v9 offset:0
    ds_read_b64_tr_b16 a[38:39], v9 offset:2048
    s_add_u32 s57, s57, 31744
    buffer_load_dwordx4 v12, s[20:23], s57 offen offset:2048 lds
    ds_read_b64_tr_b16 a[40:41], v8 offset:256
    ds_read_b64_tr_b16 a[42:43], v8 offset:2304
    ds_read_b64_tr_b16 a[44:45], v9 offset:256
    ds_read_b64_tr_b16 a[46:47], v9 offset:2304
    s_add_u32 s57, s57, 31744
    buffer_load_dwordx4 v12, s[20:23], s57 offen offset:3072 lds
    s_add_u32 m0, s52, 65536
    s_lshl_b32 s57, s79, 7
    buffer_load_dwordx4 v12, s[20:23], s57 offen offset:0 lds
    s_add_u32 s57, s57, 31744
    buffer_load_dwordx4 v12, s[20:23], s57 offen offset:1024 lds
    s_waitcnt vmcnt(10)
    ds_read_b64_tr_b16 a[48:49], v8 offset:16384
    ds_read_b64_tr_b16 a[50:51], v8 offset:18432
    ds_read_b64_tr_b16 a[52:53], v9 offset:16384
    ds_read_b64_tr_b16 a[54:55], v9 offset:18432
    s_add_u32 s57, s57, 31744
    buffer_load_dwordx4 v12, s[20:23], s57 offen offset:2048 lds
    ds_read_b64_tr_b16 a[56:57], v8 offset:16640
    ds_read_b64_tr_b16 a[58:59], v8 offset:18688
    ds_read_b64_tr_b16 a[60:61], v9 offset:16640
    ds_read_b64_tr_b16 a[62:63], v9 offset:18688
    s_waitcnt vmcnt(0) lgkmcnt(0)
    s_branch L_p3join
L_role_a:
    v_lshrrev_b32 v112, 4, v1
    v_bfe_u32 v113, v1, 2, 2
    v_and_b32 v114, 3, v1
    v_and_b32 v115, 15, v1
    v_lshrrev_b32 v116, 5, v1
    s_lshr_b32 s48, s45, 1
    s_and_b32 s53, s45, 1
    s_lshl3_add_u32 s49, s53, s46
    s_sub_u32 s49, s49, 24
    s_lshl_b32 s90, s44, 11
    s_and_b32 s53, s44, 1
    s_lshl_b32 s53, s53, 1
    v_lshlrev_b32 v117, 2, v112
    v_sub_u32 v117, v115, v117
    v_and_b32 v117, 15, v117
    v_xor_b32 v117, s53, v117
    v_mul_u32_u24 v2, 2688, v112
    v_lshl_add_u32 v2, v117, 4, v2
    s_mul_i32 s53, s44, 21504
    s_mul_i32 s54, s48, 224
    s_andn2_b32 s54, s54, 63
    s_add_u32 s53, s53, s54
    v_add_u32 v2, s53, v2
    s_add_u32 m0, s90, 65536
    s_mov_b32 s57, 896
    buffer_load_dwordx4 v2, s[8:11], s57 offen offset:0 lds
    s_mov_b32 s57, 10624
    buffer_load_dwordx4 v2, s[8:11], s57 offen offset:1024 lds
    s_add_u32 m0, s90, 73728
    s_mov_b32 s57, 86912
    buffer_load_dwordx4 v2, s[8:11], s57 offen offset:0 lds
    s_mov_b32 s57, 96640
    buffer_load_dwordx4 v2, s[8:11], s57 offen offset:1024 lds
    v_mul_u32_u24 v109, 960, v25
    v_lshl_add_u32 v109, v26, 4, v109
    v_mul_u32_u24 v110, 960, v113
    v_lshl_add_u32 v110, v112, 5, v110
    v_lshl_add_u32 v110, v114, 3, v110
    s_lshl_b32 s53, s44, 7
    v_add_u32 v110, s53, v110
    v_mul_u32_u24 v111, 66816, v112
    v_lshl_add_u32 v111, v115, 4, v111
    s_mul_i32 s63, s44, 267264
    s_lshl_b32 s53, s2, 8
    s_add_u32 s63, s63, s53
    s_add_u32 s64, s63, 1069056
    s_cmp_eq_u32 s44, 3
    s_cselect_b32 s64, 2130706432, s64
    s_mov_b32 s62, 0x3f803f80
    s_mov_b32 s61, 0xffff0000
    s_mov_b32 s66, 6291456
    v_mov_b32 v96, 0
    v_mov_b32 v97, 0
    v_and_b32 v117, 1, v112
    v_lshlrev_b32 v117, 5, v117
    s_mul_i32 s53, s44, 56
    s_and_b32 s54, s48, 1
    s_lshl_b32 s54, s54, 5
    s_add_u32 s53, s53, s54
    v_lshlrev_b32 v118, 11, v112
    v_lshl_add_u32 v118, v113, 8, v118
    v_add_u32 v118, 65536, v118
    v_lshl_add_u32 v119, v114, 3, s53
    v_add_u32 v119, 0, v119
    v_xor_b32 v119, v119, v117
    v_lshl_add_u32 v119, v113, 6, v119
    v_and_b32 v119, 255, v119
    v_add_u32 v6, v118, v119
    v_add_u32 v10, 49152, v6
    v_subrev_u32 v120, 65536, v6
    v_lshl_add_u32 v119, v114, 3, s53
    v_add_u32 v119, 32, v119
    v_xor_b32 v119, v119, v117
    v_lshl_add_u32 v119, v113, 6, v119
    v_and_b32 v119, 255, v119
    v_add_u32 v7, v118, v119
    v_add_u32 v11, 49152, v7
    v_subrev_u32 v121, 65536, v7
    v_lshl_add_u32 v119, v114, 4, s53
    v_add_u32 v119, 0, v119
    v_xor_b32 v119, v119, v117
    v_lshl_add_u32 v119, v113, 6, v119
    v_and_b32 v119, 255, v119
    v_add_u32 v8, v118, v119
    v_add_u32 v12, 49152, v8
    v_subrev_u32 v122, 65536, v8
    v_lshl_add_u32 v119, v114, 4, s53
    v_add_u32 v119, 8, v119
    v_xor_b32 v119, v119, v117
    v_lshl_add_u32 v119, v113, 6, v119
    v_and_b32 v119, 255, v119
    v_add_u32 v9, v118, v119
    v_add_u32 v13, 49152, v9
    v_subrev_u32 v123, 65536, v9
    s_waitcnt vmcnt(7)
    v_dot2c_f32_bf16 v96, s62, v32
    v_dot2c_f32_bf16 v97, v32, v32
    v_lshlrev_b32 v40, 16, v32
    v_and_b32 v41, s61, v32
    v_dot2c_f32_bf16 v96, s62, v33
    v_dot2c_f32_bf16 v97, v33, v33
    v_lshlrev_b32 v42, 16, v33
    v_and_b32 v43, s61, v33
    v_dot2c_f32_bf16 v96, s62, v34
    v_dot2c_f32_bf16 v97, v34, v34
    v_lshlrev_b32 v44, 16, v34
    v_and_b32 v45, s61, v34
    v_dot2c_f32_bf16 v96, s62, v35
    v_dot2c_f32_bf16 v97, v35, v35
    v_lshlrev_b32 v46, 16, v35
    v_and_b32 v47, s61, v35
    s_waitcnt vmcnt(6)
    v_dot2c_f32_bf16 v96, s62, v36
    v_dot2c_f32_bf16 v97, v36, v36
    v_lshlrev_b32 v48, 16, v36
    v_and_b32 v49, s61, v36
    v_dot2c_f32_bf16 v96, s62, v37
    v_dot2c_f32_bf16 v97, v37, v37
    v_lshlrev_b32 v50, 16, v37
    v_and_b32 v51, s61, v37
    v_dot2c_f32_bf16 v96, s62, v38
    v_dot2c_f32_bf16 v97, v38, v38
    v_lshlrev_b32 v52, 16, v38
    v_and_b32 v53, s61, v38
    v_dot2c_f32_bf16 v96, s62, v39
    v_dot2c_f32_bf16 v97, v39, v39
    v_lshlrev_b32 v54, 16, v39
    v_and_b32 v55, s61, v39
    buffer_load_dword v29, off, s[40:43], 0 sc1
    v_add_f32_dpp v96, v96, v96 quad_perm:[1,0,3,2] row_mask:0xf bank_mask:0xf
    v_add_f32_dpp v97, v97, v97 quad_perm:[1,0,3,2] row_mask:0xf bank_mask:0xf
    s_nop 0
    v_add_f32_dpp v96, v96, v96 quad_perm:[2,3,0,1] row_mask:0xf bank_mask:0xf
    v_add_f32_dpp v97, v97, v97 quad_perm:[2,3,0,1] row_mask:0xf bank_mask:0xf
    s_nop 0
    v_add_f32_dpp v96, v96, v96 row_half_mirror row_mask:0xf bank_mask:0xf
    v_add_f32_dpp v97, v97, v97 row_half_mirror row_mask:0xf bank_mask:0xf
    s_nop 0
    v_add_f32_dpp v96, v96, v96 row_mirror row_mask:0xf bank_mask:0xf
    v_add_f32_dpp v97, v97, v97 row_mirror row_mask:0xf bank_mask:0xf
    v_mov_b32 v98, v96
    v_mov_b32 v99, v97
    s_nop 0
    v_permlane16_swap_b32 v96, v98
    v_permlane16_swap_b32 v97, v99
    v_add_f32 v96, v96, v98
    v_add_f32 v97, v97, v99
    v_mul_f32 v98, 0x3b124925, v96
    v_mul_f32 v99, 0x3b124925, v97
    v_fma_f32 v99, -v98, v98, v99
    v_max_f32 v99, 0, v99
    v_cvt_pk_bf16_f32 v100, 0, v99
    v_add_f32 v100, 0x3727c5ac, v100
    v_cvt_pk_bf16_f32 v100, 0, v100
    v_sqrt_f32 v100, v100
    s_nop 0
    v_cvt_pk_bf16_f32 v100, 0, v100
    v_rcp_f32 v100, v100
    s_nop 0
    v_mul_f32 v99, v99, v100
    v_mul_f32 v102, v98, v100
    v_mul_f32 v99, v99, v100
    v_cvt_pk_bf16_f32 v104, 0, v99
    v_add_f32 v104, 0x3727c5ac, v104
    v_cvt_pk_bf16_f32 v104, 0, v104
    v_sqrt_f32 v104, v104
    s_nop 0
    v_cvt_pk_bf16_f32 v104, 0, v104
    v_rcp_f32 v104, v104
    s_nop 0
    v_mul_f32 v104, v104, v100
    v_mul_f32 v106, v98, v104
    v_pk_fma_f32 v[56:57], v[40:41], v[104:105], v[106:107] op_sel_hi:[1,0,0] neg_lo:[0,0,1] neg_hi:[0,0,1]
    v_pk_fma_f32 v[58:59], v[42:43], v[104:105], v[106:107] op_sel_hi:[1,0,0] neg_lo:[0,0,1] neg_hi:[0,0,1]
    v_pk_fma_f32 v[60:61], v[44:45], v[104:105], v[106:107] op_sel_hi:[1,0,0] neg_lo:[0,0,1] neg_hi:[0,0,1]
    v_pk_fma_f32 v[62:63], v[46:47], v[104:105], v[106:107] op_sel_hi:[1,0,0] neg_lo:[0,0,1] neg_hi:[0,0,1]
    v_pk_fma_f32 v[64:65], v[48:49], v[104:105], v[106:107] op_sel_hi:[1,0,0] neg_lo:[0,0,1] neg_hi:[0,0,1]
    v_pk_fma_f32 v[66:67], v[50:51], v[104:105], v[106:107] op_sel_hi:[1,0,0] neg_lo:[0,0,1] neg_hi:[0,0,1]
    v_pk_fma_f32 v[68:69], v[52:53], v[104:105], v[106:107] op_sel_hi:[1,0,0] neg_lo:[0,0,1] neg_hi:[0,0,1]
    v_pk_fma_f32 v[70:71], v[54:55], v[104:105], v[106:107] op_sel_hi:[1,0,0] neg_lo:[0,0,1] neg_hi:[0,0,1]
    v_cvt_pk_bf16_f32 v80, v56, v57
    v_cvt_pk_bf16_f32 v81, v58, v59
    v_cvt_pk_bf16_f32 v82, v60, v61
    v_cvt_pk_bf16_f32 v83, v62, v63
    v_cvt_pk_bf16_f32 v84, v64, v65
    v_cvt_pk_bf16_f32 v85, v66, v67
    v_cvt_pk_bf16_f32 v86, v68, v69
    v_cvt_pk_bf16_f32 v87, v70, v71
    ds_write_b128 v109, v[80:83] offset:49152
    ds_write_b128 v109, v[84:87] offset:49600
    v_pk_fma_f32 v[40:41], v[40:41], v[100:101], v[102:103] op_sel_hi:[1,0,0] neg_lo:[0,0,1] neg_hi:[0,0,1]
    v_pk_fma_f32 v[42:43], v[42:43], v[100:101], v[102:103] op_sel_hi:[1,0,0] neg_lo:[0,0,1] neg_hi:[0,0,1]
    v_pk_fma_f32 v[44:45], v[44:45], v[100:101], v[102:103] op_sel_hi:[1,0,0] neg_lo:[0,0,1] neg_hi:[0,0,1]
    v_pk_fma_f32 v[46:47], v[46:47], v[100:101], v[102:103] op_sel_hi:[1,0,0] neg_lo:[0,0,1] neg_hi:[0,0,1]
    v_pk_fma_f32 v[48:49], v[48:49], v[100:101], v[102:103] op_sel_hi:[1,0,0] neg_lo:[0,0,1] neg_hi:[0,0,1]
    v_pk_fma_f32 v[50:51], v[50:51], v[100:101], v[102:103] op_sel_hi:[1,0,0] neg_lo:[0,0,1] neg_hi:[0,0,1]
    v_pk_fma_f32 v[52:53], v[52:53], v[100:101], v[102:103] op_sel_hi:[1,0,0] neg_lo:[0,0,1] neg_hi:[0,0,1]
    v_pk_fma_f32 v[54:55], v[54:55], v[100:101], v[102:103] op_sel_hi:[1,0,0] neg_lo:[0,0,1] neg_hi:[0,0,1]
    v_cvt_pk_bf16_f32 v72, v40, v41
    v_cvt_pk_bf16_f32 v73, v42, v43
    v_cvt_pk_bf16_f32 v74, v44, v45
    v_cvt_pk_bf16_f32 v75, v46, v47
    v_cvt_pk_bf16_f32 v76, v48, v49
    v_cvt_pk_bf16_f32 v77, v50, v51
    v_cvt_pk_bf16_f32 v78, v52, v53
    v_cvt_pk_bf16_f32 v79, v54, v55
    s_waitcnt lgkmcnt(0)
    s_barrier
    ds_read_b64_tr_b16 v[88:89], v110 offset:49152
    ds_read_b64_tr_b16 v[90:91], v110 offset:52992
    ds_read_b64_tr_b16 v[92:93], v110 offset:49664
    ds_read_b64_tr_b16 v[94:95], v110 offset:53504
    buffer_store_dwordx4 v[72:75], v24, s[24:27], s66 offen offset:0 sc1
    buffer_store_dwordx4 v[76:79], v24, s[24:27], s66 offen offset:448 sc1
    s_waitcnt lgkmcnt(2)
    buffer_store_dwordx4 v[88:91], v111, s[24:27], s63 offen sc1
    s_waitcnt lgkmcnt(0)
    buffer_store_dwordx4 v[92:95], v111, s[24:27], s64 offen sc1
    s_add_u32 m0, s90, 81920
    s_mov_b32 s57, 172928
    buffer_load_dwordx4 v2, s[8:11], s57 offen offset:0 lds
    v_lshrrev_b32 v119, 3, v1
    v_mul_u32_u24 v3, 896, v119
    v_xor_b32 v118, v119, v1
    v_and_b32 v118, 6, v118
    v_and_or_b32 v118, v1, 1, v118
    v_lshl_add_u32 v3, v118, 4, v3
    v_and_b32 v118, 6, v1
    v_xor_b32 v118, v118, v112
    s_mov_b32 s57, 182656
    buffer_load_dwordx4 v2, s[8:11], s57 offen offset:1024 lds
    v_lshlrev_b32 v4, 7, v115
    v_lshl_add_u32 v4, v118, 4, v4
    v_xor_b32 v25, 64, v4
    s_lshl_b32 s53, s49, 4
    s_sub_u32 s53, s53, 2
    v_min_u32 v117, 17, v1
    v_add_u32 v117, s53, v117
    v_max_i32 v117, 0, v117
    v_lshlrev_b32 v19, 5, v117
    v_add_u32 v19, 12582912, v19
    v_and_b32 v117, 1, v115
    v_cmp_eq_u32 s[76:77], 1, v117
    v_lshl_add_u32 v117, v112, 2, v117
    v_cmp_le_u32 s[78:79], v117, v115
    v_add_u32 v117, 2, v117
    v_cmp_le_u32 s[80:81], v117, v115
    s_add_u32 m0, s90, 90112
    s_mov_b32 s57, 258944
    buffer_load_dwordx4 v2, s[8:11], s57 offen offset:0 lds
    v_cmp_eq_u32 s[82:83], 3, v112
    v_mov_b32 v117, 0xffff
    v_mov_b32 v118, 0xffff0000
    v_cndmask_b32 v117, v117, v118, s[76:77]
    v_cndmask_b32 v14, v117, 0, s[78:79]
    v_cndmask_b32 v15, v117, 0, s[80:81]
    v_cndmask_b32 v16, 0, v117, s[78:79]
    v_cndmask_b32 v17, 0, v117, s[80:81]
    s_mov_b32 s91, 0x3e8b97f6
    v_mov_b32 v18, 0xf149f2ca
    s_lshl_b32 s53, s49, 3
    s_mul_i32 s72, s53, 14336
    s_add_u32 s72, s72, 6291456
    s_lshl_b32 s74, s53, 14
    s_lshl2_add_u32 s54, s48, s44
    s_lshl_b32 s54, s54, 10
    s_mov_b32 s57, 268672
    buffer_load_dwordx4 v2, s[8:11], s57 offen offset:1024 lds
    s_add_u32 s74, s74, s54
    s_add_u32 s74, s74, 4194304
    s_lshl2_add_u32 s53, s44, 0
    s_lshl_b32 s54, s44, 8
    s_add_u32 s54, s54, 0
    s_cmp_lt_u32 s53, 14
    s_cselect_b32 s68, s54, 2130706432
    s_lshl2_add_u32 s53, s44, 1
    s_lshl_b32 s54, s44, 8
    s_add_u32 s54, s54, 6144
    s_cmp_lt_u32 s53, 14
    s_cselect_b32 s69, s54, 2130706432
    s_lshl2_add_u32 s53, s44, 2
    s_lshl_b32 s54, s44, 8
    s_add_u32 s54, s54, -1920
    s_cmp_lt_u32 s53, 14
    s_cselect_b32 s70, s54, 2130706432
    s_lshl2_add_u32 s53, s44, 3
    s_lshl_b32 s54, s44, 8
    s_add_u32 s54, s54, 4224
    s_cmp_lt_u32 s53, 14
    s_cselect_b32 s71, s54, 2130706432
    s_cmp_eq_u32 s49, 0
    s_cselect_b64 s[84:85], -1, 0
    s_andn2_b64 s[86:87], s[84:85], s[80:81]
    s_andn2_b64 s[84:85], s[84:85], s[78:79]
    s_and_b32 s53, s46, 7
    s_mul_i32 s54, s44, 28
    s_add_u32 s54, s54, s53
    s_add_u32 s54, s54, 12
    s_lshl_b32 s73, s54, 16
    s_lshl_b32 s54, s45, 9
    s_add_u32 s73, s73, s54
    s_lshl3_add_u32 s75, s44, s53
    s_lshl_b32 s75, s75, 13
    v_lshrrev_b32 v5, 2, v1
    v_lshlrev_b32 v5, 12, v5
    v_lshl_add_u32 v5, v114, 7, v5
    v_lshlrev_b32 v20, 7, v1
    s_add_u32 m0, s90, 98304
    s_mov_b32 s57, 344960
    buffer_load_dwordx4 v2, s[8:11], s57 offen offset:0 lds
    s_mov_b32 s57, 354688
    buffer_load_dwordx4 v2, s[8:11], s57 offen offset:1024 lds
    s_add_u32 m0, s90, 106496
    s_mov_b32 s57, 430976
    buffer_load_dwordx4 v2, s[8:11], s57 offen offset:0 lds
    s_mov_b32 s57, 440704
    buffer_load_dwordx4 v2, s[8:11], s57 offen offset:1024 lds
    s_add_u32 m0, s90, 114688
    s_mov_b32 s57, 516992
    buffer_load_dwordx4 v2, s[8:11], s57 offen offset:0 lds
    s_mov_b32 s57, 526720
    buffer_load_dwordx4 v2, s[8:11], s57 offen offset:1024 lds
    s_add_u32 m0, s90, 122880
    s_mov_b32 s57, 603008
    buffer_load_dwordx4 v2, s[8:11], s57 offen offset:0 lds
    s_mov_b32 s57, 612736
    buffer_load_dwordx4 v2, s[8:11], s57 offen offset:1024 lds
    s_add_u32 m0, s90, 131072
    s_mov_b32 s57, 689024
    buffer_load_dwordx4 v2, s[8:11], s57 offen offset:0 lds
    s_mov_b32 s57, 698752
    buffer_load_dwordx4 v2, s[8:11], s57 offen offset:1024 lds
    s_add_u32 m0, s90, 139264
    s_mov_b32 s57, 775040
    buffer_load_dwordx4 v2, s[8:11], s57 offen offset:0 lds
    s_mov_b32 s57, 784768
    buffer_load_dwordx4 v2, s[8:11], s57 offen offset:1024 lds
    s_add_u32 m0, s90, 147456
    s_mov_b32 s57, 861056
    buffer_load_dwordx4 v2, s[8:11], s57 offen offset:0 lds
    s_mov_b32 s57, 870784
    buffer_load_dwordx4 v2, s[8:11], s57 offen offset:1024 lds
    s_add_u32 m0, s90, 155648
    s_mov_b32 s57, 947072
    buffer_load_dwordx4 v2, s[8:11], s57 offen offset:0 lds
    s_mov_b32 s57, 956800
    buffer_load_dwordx4 v2, s[8:11], s57 offen offset:1024 lds
    s_waitcnt vmcnt(20)
    v_cmp_eq_u32 vcc, 0, v29
    s_nop 0
    s_cbranch_vccz L_ok15
    s_mov_b32 s59, 20000
L_spin14:
    s_sleep 2
    buffer_load_dword v29, off, s[40:43], 0 sc1
    s_waitcnt vmcnt(0)
    v_cmp_eq_u32 vcc, 0, v29
    s_nop 0
    s_cbranch_vccz L_ok15
    s_sub_u32 s59, s59, 1
    s_cbranch_scc0 L_spin14
L_ok15:
    v_readfirstlane_b32 s47, v29
    s_barrier
    s_cmp_lg_u32 s44, 0
    s_cbranch_scc1 L_nopub16
    s_lshl_b32 s60, s2, 5
    s_add_u32 s60, s60, 12582912
    v_mov_b32 v30, s47
    s_mov_b64 exec, 1
    buffer_store_dword v30, off, s[24:27], s60 sc1
    s_mov_b64 exec, -1
L_nopub16:
    s_waitcnt vmcnt(18)
    s_barrier
    s_add_u32 m0, s90, 0
    s_mov_b32 s57, 1033088
    buffer_load_dwordx4 v2, s[8:11], s57 offen offset:0 lds
    s_mov_b32 s57, 1042816
    buffer_load_dwordx4 v2, s[8:11], s57 offen offset:1024 lds
    ds_read_b64_tr_b16 a[8:9], v6 offset:0
    ds_read_b64_tr_b16 a[10:11], v6 offset:1024
    ds_read_b64_tr_b16 a[12:13], v7 offset:0
    ds_read_b64_tr_b16 a[14:15], v7 offset:1024
    s_add_u32 m0, s90, 8192
    s_mov_b32 s57, 1119104
    buffer_load_dwordx4 v2, s[8:11], s57 offen offset:0 lds
    s_mov_b32 s57, 1128832
    buffer_load_dwordx4 v2, s[8:11], s57 offen offset:1024 lds
    ds_read_b64_tr_b16 a[32:33], v6 offset:8192
    ds_read_b64_tr_b16 a[34:35], v6 offset:9216
    ds_read_b64_tr_b16 a[36:37], v7 offset:8192
    ds_read_b64_tr_b16 a[38:39], v7 offset:9216
    s_add_u32 m0, s90, 16384
    s_mov_b32 s57, 1792
    buffer_load_dwordx4 v2, s[8:11], s57 offen offset:0 lds
    s_mov_b32 s57, 11520
    buffer_load_dwordx4 v2, s[8:11], s57 offen offset:1024 lds
    ds_read_b64_tr_b16 a[56:57], v6 offset:16384
    ds_read_b64_tr_b16 a[58:59], v6 offset:17408
    ds_read_b64_tr_b16 a[60:61], v7 offset:16384
    ds_read_b64_tr_b16 a[62:63], v7 offset:17408
    s_waitcnt vmcnt(18)
    s_waitcnt lgkmcnt(0)
    s_barrier
    s_add_u32 m0, s90, 24576
    s_mov_b32 s57, 87808
    buffer_load_dwordx4 v2, s[8:11], s57 offen offset:0 lds
    s_mov_b32 s57, 97536
    buffer_load_dwordx4 v2, s[8:11], s57 offen offset:1024 lds
    ds_read_b64_tr_b16 a[80:81], v6 offset:24576
    ds_read_b64_tr_b16 a[82:83], v6 offset:25600
    ds_read_b64_tr_b16 a[84:85], v7 offset:24576
    ds_read_b64_tr_b16 a[86:87], v7 offset:25600
    s_add_u32 m0, s90, 32768
    s_mov_b32 s57, 173824
    buffer_load_dwordx4 v2, s[8:11], s57 offen offset:0 lds
    s_mov_b32 s57, 183552
    buffer_load_dwordx4 v2, s[8:11], s57 offen offset:1024 lds
    ds_read_b64_tr_b16 a[104:105], v6 offset:32768
    ds_read_b64_tr_b16 a[106:107], v6 offset:33792
    ds_read_b64_tr_b16 a[108:109], v7 offset:32768
    ds_read_b64_tr_b16 a[110:111], v7 offset:33792
    s_add_u32 m0, s90, 40960
    s_mov_b32 s57, 259840
    buffer_load_dwordx4 v2, s[8:11], s57 offen offset:0 lds
    s_mov_b32 s57, 269568
    buffer_load_dwordx4 v2, s[8:11], s57 offen offset:1024 lds
    ds_read_b64_tr_b16 a[128:129], v6 offset:40960
    ds_read_b64_tr_b16 a[130:131], v6 offset:41984
    ds_read_b64_tr_b16 a[132:133], v7 offset:40960
    ds_read_b64_tr_b16 a[134:135], v7 offset:41984
    s_waitcnt vmcnt(18)
    s_waitcnt lgkmcnt(0)
    s_barrier
    s_add_u32 m0, s90, 65536
    s_mov_b32 s57, 345856
    buffer_load_dwordx4 v2, s[8:11], s57 offen offset:0 lds
    s_mov_b32 s57, 355584
    buffer_load_dwordx4 v2, s[8:11], s57 offen offset:1024 lds
    ds_read_b64_tr_b16 a[152:153], v10 offset:0
    ds_read_b64_tr_b16 a[154:155], v10 offset:1024
    ds_read_b64_tr_b16 a[156:157], v11 offset:0
    ds_read_b64_tr_b16 a[158:159], v11 offset:1024
    s_add_u32 m0, s90, 73728
    s_mov_b32 s57, 431872
    buffer_load_dwordx4 v2, s[8:11], s57 offen offset:0 lds
    s_mov_b32 s57, 441600
    buffer_load_dwordx4 v2, s[8:11], s57 offen offset:1024 lds
    ds_read_b64_tr_b16 a[176:177], v10 offset:8192
    ds_read_b64_tr_b16 a[178:179], v10 offset:9216
    ds_read_b64_tr_b16 a[180:181], v11 offset:8192
    ds_read_b64_tr_b16 a[182:183], v11 offset:9216
    s_add_u32 m0, s90, 81920
    s_mov_b32 s57, 517888
    buffer_load_dwordx4 v2, s[8:11], s57 offen offset:0 lds
    s_mov_b32 s57, 527616
    buffer_load_dwordx4 v2, s[8:11], s57 offen offset:1024 lds
    ds_read_b64_tr_b16 a[200:201], v10 offset:16384
    ds_read_b64_tr_b16 a[202:203], v10 offset:17408
    ds_read_b64_tr_b16 a[204:205], v11 offset:16384
    ds_read_b64_tr_b16 a[206:207], v11 offset:17408
    s_waitcnt vmcnt(18)
    s_waitcnt lgkmcnt(0)
    s_barrier
    ds_read_b64_tr_b16 a[224:225], v10 offset:24576
    ds_read_b64_tr_b16 a[226:227], v10 offset:25600
    ds_read_b64_tr_b16 a[228:229], v11 offset:24576
    ds_read_b64_tr_b16 a[230:231], v11 offset:25600
    ds_read_b64_tr_b16 a[248:249], v10 offset:32768
    ds_read_b64_tr_b16 a[250:251], v10 offset:33792
    ds_read_b64_tr_b16 a[252:253], v11 offset:32768
    ds_read_b64_tr_b16 a[254:255], v11 offset:33792
    buffer_load_dword v21, v19, s[24:27], 0 offen sc1
    ds_read_b64_tr_b16 v[192:193], v10 offset:40960
    ds_read_b64_tr_b16 v[194:195], v10 offset:41984
    ds_read_b64_tr_b16 v[196:197], v11 offset:40960
    ds_read_b64_tr_b16 v[198:199], v11 offset:41984
    s_add_u32 m0, s90, 90112
    s_mov_b32 s57, 603904
    buffer_load_dwordx4 v2, s[8:11], s57 offen offset:0 lds
    s_waitcnt vmcnt(14)
    s_waitcnt lgkmcnt(0)
    s_barrier
    ds_read_b64_tr_b16 v[216:217], v120 offset:0
    ds_read_b64_tr_b16 v[218:219], v120 offset:1024
    ds_read_b64_tr_b16 v[220:221], v121 offset:0
    ds_read_b64_tr_b16 v[222:223], v121 offset:1024
    ds_read_b64_tr_b16 v[240:241], v120 offset:8192
    ds_read_b64_tr_b16 v[242:243], v120 offset:9216
    ds_read_b64_tr_b16 v[244:245], v121 offset:8192
    ds_read_b64_tr_b16 v[246:247], v121 offset:9216
    ds_read_b64_tr_b16 a[16:17], v122 offset:16384
    ds_read_b64_tr_b16 a[18:19], v122 offset:17408
    ds_read_b64_tr_b16 a[20:21], v123 offset:16384
    ds_read_b64_tr_b16 a[22:23], v123 offset:17408
    s_mov_b32 s57, 613632
    buffer_load_dwordx4 v2, s[8:11], s57 offen offset:1024 lds
    s_add_u32 m0, s90, 98304
    s_mov_b32 s57, 689920
    buffer_load_dwordx4 v2, s[8:11], s57 offen offset:0 lds
    s_mov_b32 s57, 699648
    buffer_load_dwordx4 v2, s[8:11], s57 offen offset:1024 lds
    s_add_u32 m0, s90, 106496
    s_mov_b32 s57, 775936
    buffer_load_dwordx4 v2, s[8:11], s57 offen offset:0 lds
    s_waitcnt vmcnt(12)
    s_waitcnt lgkmcnt(0)
    s_barrier
    ds_read_b64_tr_b16 a[40:41], v122 offset:24576
    ds_read_b64_tr_b16 a[42:43], v122 offset:25600
    ds_read_b64_tr_b16 a[44:45], v123 offset:24576
    ds_read_b64_tr_b16 a[46:47], v123 offset:25600
    ds_read_b64_tr_b16 a[64:65], v122 offset:32768
    ds_read_b64_tr_b16 a[66:67], v122 offset:33792
    ds_read_b64_tr_b16 a[68:69], v123 offset:32768
    ds_read_b64_tr_b16 a[70:71], v123 offset:33792
    ds_read_b64_tr_b16 a[88:89], v122 offset:40960
    ds_read_b64_tr_b16 a[90:91], v122 offset:41984
    ds_read_b64_tr_b16 a[92:93], v123 offset:40960
    ds_read_b64_tr_b16 a[94:95], v123 offset:41984
    s_mov_b32 s57, 785664
    buffer_load_dwordx4 v2, s[8:11], s57 offen offset:1024 lds
    s_waitcnt vmcnt(7)
    s_waitcnt lgkmcnt(0)
    s_barrier
    ds_read_b64_tr_b16 a[112:113], v8 offset:0
    ds_read_b64_tr_b16 a[114:115], v8 offset:1024
    ds_read_b64_tr_b16 a[116:117], v9 offset:0
    ds_read_b64_tr_b16 a[118:119], v9 offset:1024
    ds_read_b64_tr_b16 a[136:137], v8 offset:8192
    ds_read_b64_tr_b16 a[138:139], v8 offset:9216
    ds_read_b64_tr_b16 a[140:141], v9 offset:8192
    ds_read_b64_tr_b16 a[142:143], v9 offset:9216
    ds_read_b64_tr_b16 a[160:161], v8 offset:16384
    ds_read_b64_tr_b16 a[162:163], v8 offset:17408
    ds_read_b64_tr_b16 a[164:165], v9 offset:16384
    ds_read_b64_tr_b16 a[166:167], v9 offset:17408
    s_waitcnt vmcnt(6)
    v_cmp_ne_u32 vcc, s47, v21
    s_nop 0
    s_cbranch_vccz L_ok18
    s_mov_b32 s59, 20000
L_spin17:
    s_sleep 2
    buffer_load_dword v21, v19, s[24:27], 0 offen sc1
    s_waitcnt vmcnt(0)
    v_cmp_ne_u32 vcc, s47, v21
    s_nop 0
    s_cbranch_vccz L_ok18
    s_sub_u32 s59, s59, 1
    s_cbranch_scc0 L_spin17
L_ok18:
    s_add_u32 m0, s52, 0
    s_sub_u32 s58, s72, 14336
    s_max_u32 s58, s58, 6291456
    s_add_u32 s57, s58, s68
    buffer_load_dwordx4 v3, s[24:27], s57 offen offset:0 sc1 lds
    s_add_u32 s57, s58, s69
    buffer_load_dwordx4 v3, s[24:27], s57 offen offset:1024 sc1 lds
    s_add_u32 s57, s58, s70
    buffer_load_dwordx4 v3, s[24:27], s57 offen offset:2048 sc1 lds
    s_add_u32 s57, s58, s71
    buffer_load_dwordx4 v3, s[24:27], s57 offen offset:3072 sc1 lds
    s_add_u32 m0, s52, 16384
    s_add_u32 s58, s72, 0
    s_add_u32 s57, s58, s68
    buffer_load_dwordx4 v3, s[24:27], s57 offen offset:0 sc1 lds
    s_add_u32 s57, s58, s69
    buffer_load_dwordx4 v3, s[24:27], s57 offen offset:1024 sc1 lds
    s_add_u32 s57, s58, s70
    buffer_load_dwordx4 v3, s[24:27], s57 offen offset:2048 sc1 lds
    s_add_u32 s57, s58, s71
    buffer_load_dwordx4 v3, s[24:27], s57 offen offset:3072 sc1 lds
    s_add_u32 m0, s90, 114688
    s_mov_b32 s57, 861952
    buffer_load_dwordx4 v2, s[8:11], s57 offen offset:0 lds
    s_mov_b32 s57, 871680
    buffer_load_dwordx4 v2, s[8:11], s57 offen offset:1024 lds
    s_add_u32 m0, s90, 122880
    s_mov_b32 s57, 947968
    buffer_load_dwordx4 v2, s[8:11], s57 offen offset:0 lds
    s_mov_b32 s57, 957696
    buffer_load_dwordx4 v2, s[8:11], s57 offen offset:1024 lds
    s_add_u32 m0, s90, 131072
    s_mov_b32 s57, 1033984
    buffer_load_dwordx4 v2, s[8:11], s57 offen offset:0 lds
    s_mov_b32 s57, 1043712
    buffer_load_dwordx4 v2, s[8:11], s57 offen offset:1024 lds
    s_add_u32 m0, s52, 32768
    s_add_u32 s58, s72, 14336
    s_add_u32 s57, s58, s68
    buffer_load_dwordx4 v3, s[24:27], s57 offen offset:0 sc1 lds
    s_add_u32 s57, s58, s69
    buffer_load_dwordx4 v3, s[24:27], s57 offen offset:1024 sc1 lds
    s_waitcnt vmcnt(12)
    s_waitcnt lgkmcnt(0)
    s_barrier
    ds_read_b128 v[120:123], v4 offset:0
    ds_read_b128 v[124:127], v25 offset:0
    ds_read_b128 v[128:131], v4 offset:2048
    ds_read_b128 v[132:135], v25 offset:2048
    ds_read_b128 v[136:139], v4 offset:4096
    ds_read_b128 v[140:143], v25 offset:4096
    ds_read_b128 v[144:147], v4 offset:6144
    ds_read_b128 v[148:151], v25 offset:6144
    ds_read_b128 v[152:155], v4 offset:8192
    ds_read_b128 v[156:159], v25 offset:8192
    ds_read_b128 v[160:163], v4 offset:10240
    ds_read_b128 v[164:167], v25 offset:10240
    ds_read_b128 v[168:171], v4 offset:12288
    ds_read_b128 v[172:175], v25 offset:12288
    s_waitcnt lgkmcnt(11)
    v_mfma_f32_16x16x32_bf16 v[96:99], a[8:11], v[120:123], 0
    s_add_u32 s57, s58, s70
    ds_read_b64_tr_b16 a[184:185], v8 offset:24576
    v_mfma_f32_16x16x32_bf16 v[96:99], a[32:35], v[124:127], v[96:99]
    buffer_load_dwordx4 v3, s[24:27], s57 offen offset:2048 sc1 lds
    v_mfma_f32_16x16x32_bf16 v[96:99], a[56:59], v[128:131], v[96:99]
    ds_read_b64_tr_b16 a[186:187], v8 offset:25600
    ds_read_b64_tr_b16 a[188:189], v9 offset:24576
    s_waitcnt lgkmcnt(11)
    v_mfma_f32_16x16x32_bf16 v[96:99], a[80:83], v[132:135], v[96:99]
    ds_read_b64_tr_b16 a[190:191], v9 offset:25600
    ds_read_b64_tr_b16 a[208:209], v8 offset:32768
    v_mfma_f32_16x16x32_bf16 v[96:99], a[104:107], v[136:139], v[96:99]
    s_add_u32 s57, s58, s71
    ds_read_b64_tr_b16 a[210:211], v8 offset:33792
    v_mfma_f32_16x16x32_bf16 v[96:99], a[128:131], v[140:143], v[96:99]
    buffer_load_dwordx4 v3, s[24:27], s57 offen offset:3072 sc1 lds
    s_waitcnt lgkmcnt(11)
    v_mfma_f32_16x16x32_bf16 v[96:99], a[152:155], v[144:147], v[96:99]
    ds_read_b64_tr_b16 a[212:213], v9 offset:32768
    ds_read_b64_tr_b16 a[214:215], v9 offset:33792
    v_mfma_f32_16x16x32_bf16 v[96:99], a[176:179], v[148:151], v[96:99]
    ds_read_b64_tr_b16 a[232:233], v8 offset:40960
    ds_read_b64_tr_b16 a[234:235], v8 offset:41984
    v_mfma_f32_16x16x32_bf16 v[96:99], a[200:203], v[152:155], v[96:99]
    s_add_u32 m0, s90, 139264
    s_mov_b32 s57, 1120000
    ds_read_b64_tr_b16 a[236:237], v9 offset:40960
    s_waitcnt lgkmcnt(13)
    v_mfma_f32_16x16x32_bf16 v[96:99], a[224:227], v[156:159], v[96:99]
    buffer_load_dwordx4 v2, s[8:11], s57 offen offset:0 lds
    v_mfma_f32_16x16x32_bf16 v[96:99], a[248:251], v[160:163], v[96:99]
    ds_read_b64_tr_b16 a[238:239], v9 offset:41984
    v_mfma_f32_16x16x32_bf16 v[96:99], v[192:195], v[164:167], v[96:99]
    s_waitcnt lgkmcnt(12)
    v_mfma_f32_16x16x32_bf16 v[96:99], v[216:219], v[168:171], v[96:99]
    s_mov_b32 s57, 1129728
    v_mfma_f32_16x16x32_bf16 v[96:99], v[240:243], v[172:175], v[96:99]
    buffer_load_dwordx4 v2, s[8:11], s57 offen offset:1024 lds
    s_waitcnt vmcnt(12)
    s_barrier
    v_mfma_f32_16x16x32_bf16 v[100:103], a[12:15], v[120:123], 0
    ds_read_b128 v[120:123], v4 offset:16384
    v_mfma_f32_16x16x32_bf16 v[100:103], a[36:39], v[124:127], v[100:103]
    ds_read_b128 v[124:127], v25 offset:16384
    v_mfma_f32_16x16x32_bf16 v[100:103], a[60:63], v[128:131], v[100:103]
    ds_read_b128 v[128:131], v4 offset:18432
    s_add_u32 m0, s90, 147456
    s_mov_b32 s57, 0
    v_mfma_f32_16x16x32_bf16 v[100:103], a[84:87], v[132:135], v[100:103]
    ds_read_b128 v[132:135], v25 offset:18432
    buffer_load_dwordx4 v2, s[8:11], s57 offen offset:0 lds
    v_mfma_f32_16x16x32_bf16 v[100:103], a[108:111], v[136:139], v[100:103]
    ds_read_b128 v[136:139], v4 offset:20480
    v_mfma_f32_16x16x32_bf16 v[100:103], a[132:135], v[140:143], v[100:103]
    ds_read_b128 v[140:143], v25 offset:20480
    v_mfma_f32_16x16x32_bf16 v[100:103], a[156:159], v[144:147], v[100:103]
    ds_read_b128 v[144:147], v4 offset:22528
    s_mov_b32 s57, 9728
    v_mfma_f32_16x16x32_bf16 v[100:103], a[180:183], v[148:151], v[100:103]
    ds_read_b128 v[148:151], v25 offset:22528
    buffer_load_dwordx4 v2, s[8:11], s57 offen offset:1024 lds
    v_mfma_f32_16x16x32_bf16 v[100:103], a[204:207], v[152:155], v[100:103]
    ds_read_b128 v[152:155], v4 offset:24576
    v_cvt_pk_bf16_f32 v52, v96, v97
    v_mfma_f32_16x16x32_bf16 v[100:103], a[228:231], v[156:159], v[100:103]
    ds_read_b128 v[156:159], v25 offset:24576
    v_cvt_pk_bf16_f32 v53, v98, v99
    v_mfma_f32_16x16x32_bf16 v[100:103], a[252:255], v[160:163], v[100:103]
    ds_read_b128 v[160:163], v4 offset:26624
    s_add_u32 m0, s90, 155648
    s_mov_b32 s57, 86016
    v_mfma_f32_16x16x32_bf16 v[100:103], v[196:199], v[164:167], v[100:103]
    ds_read_b128 v[164:167], v25 offset:26624
    buffer_load_dwordx4 v2, s[8:11], s57 offen offset:0 lds
    v_mfma_f32_16x16x32_bf16 v[100:103], v[220:223], v[168:171], v[100:103]
    ds_read_b128 v[168:171], v4 offset:28672
    v_mfma_f32_16x16x32_bf16 v[100:103], v[244:247], v[172:175], v[100:103]
    ds_read_b128 v[172:175], v25 offset:28672
    s_waitcnt lgkmcnt(11)
    v_mfma_f32_16x16x32_bf16 v[104:107], a[8:11], v[120:123], 0
    s_mov_b32 s57, 95744
    v_mfma_f32_16x16x32_bf16 v[104:107], a[32:35], v[124:127], v[104:107]
    buffer_load_dwordx4 v2, s[8:11], s57 offen offset:1024 lds
    v_mfma_f32_16x16x32_bf16 v[104:107], a[56:59], v[128:131], v[104:107]
    s_waitcnt lgkmcnt(8)
    v_mfma_f32_16x16x32_bf16 v[104:107], a[80:83], v[132:135], v[104:107]
    s_waitcnt vmcnt(10)
    s_barrier
    v_mfma_f32_16x16x32_bf16 v[104:107], a[104:107], v[136:139], v[104:107]
    s_add_u32 m0, s90, 65536
    s_mov_b32 s57, 172032
    ds_read_b64_tr_b16 v[176:177], v12 offset:0
    v_mfma_f32_16x16x32_bf16 v[104:107], a[128:131], v[140:143], v[104:107]
    buffer_load_dwordx4 v2, s[8:11], s57 offen offset:0 lds
    s_waitcnt lgkmcnt(6)
    v_mfma_f32_16x16x32_bf16 v[104:107], a[152:155], v[144:147], v[104:107]
    v_cvt_pk_bf16_f32 v54, v100, v101
    v_cvt_pk_bf16_f32 v55, v102, v103
    v_mfma_f32_16x16x32_bf16 v[104:107], a[176:179], v[148:151], v[104:107]
    v_cndmask_b32 v54, v54, 0, s[82:83]
    v_cndmask_b32 v55, v55, 0, s[82:83]
    v_mfma_f32_16x16x32_bf16 v[104:107], a[200:203], v[152:155], v[104:107]
    s_mov_b32 s57, 181760
    ds_read_b64_tr_b16 v[178:179], v12 offset:1024
    s_waitcnt lgkmcnt(4)
    v_mfma_f32_16x16x32_bf16 v[104:107], a[224:227], v[156:159], v[104:107]
    buffer_load_dwordx4 v2, s[8:11], s57 offen offset:1024 lds
    v_mfma_f32_16x16x32_bf16 v[104:107], a[248:251], v[160:163], v[104:107]
    ds_read_b64_tr_b16 v[180:181], v13 offset:0
    ds_read_b64_tr_b16 v[182:183], v13 offset:1024
    v_mfma_f32_16x16x32_bf16 v[104:107], v[192:195], v[164:167], v[104:107]
    ds_read_b64_tr_b16 v[200:201], v12 offset:8192
    ds_read_b64_tr_b16 v[202:203], v12 offset:9216
    s_waitcnt lgkmcnt(6)
    v_mfma_f32_16x16x32_bf16 v[104:107], v[216:219], v[168:171], v[104:107]
    s_add_u32 m0, s90, 73728
    s_mov_b32 s57, 258048
    ds_read_b64_tr_b16 v[204:205], v13 offset:8192
    v_mfma_f32_16x16x32_bf16 v[104:107], v[240:243], v[172:175], v[104:107]
    buffer_load_dwordx4 v2, s[8:11], s57 offen offset:0 lds
    s_waitcnt vmcnt(9)
    s_barrier
    v_mfma_f32_16x16x32_bf16 v[108:111], a[12:15], v[120:123], 0
    ds_read_b128 v[120:123], v4 offset:32768
    ds_read_b64_tr_b16 v[206:207], v13 offset:9216
    v_mfma_f32_16x16x32_bf16 v[108:111], a[36:39], v[124:127], v[108:111]
    ds_read_b128 v[124:127], v25 offset:32768
    ds_read_b64_tr_b16 v[224:225], v12 offset:16384
    v_mfma_f32_16x16x32_bf16 v[108:111], a[60:63], v[128:131], v[108:111]
    ds_read_b128 v[128:131], v4 offset:34816
    s_mov_b32 s57, 267776
    v_mfma_f32_16x16x32_bf16 v[108:111], a[84:87], v[132:135], v[108:111]
    ds_read_b128 v[132:135], v25 offset:34816
    buffer_load_dwordx4 v2, s[8:11], s57 offen offset:1024 lds
    v_mfma_f32_16x16x32_bf16 v[108:111], a[108:111], v[136:139], v[108:111]
    ds_read_b128 v[136:139], v4 offset:36864
    ds_read_b64_tr_b16 v[226:227], v12 offset:17408
    v_mfma_f32_16x16x32_bf16 v[108:111], a[132:135], v[140:143], v[108:111]
    ds_read_b128 v[140:143], v25 offset:36864
    ds_read_b64_tr_b16 v[228:229], v13 offset:16384
    v_mfma_f32_16x16x32_bf16 v[108:111], a[156:159], v[144:147], v[108:111]
    ds_read_b128 v[144:147], v4 offset:38912
    s_add_u32 m0, s90, 81920
    s_mov_b32 s57, 344064
    v_mfma_f32_16x16x32_bf16 v[108:111], a[180:183], v[148:151], v[108:111]
    ds_read_b128 v[148:151], v25 offset:38912
    buffer_load_dwordx4 v2, s[8:11], s57 offen offset:0 lds
    v_mfma_f32_16x16x32_bf16 v[108:111], a[204:207], v[152:155], v[108:111]
    ds_read_b128 v[152:155], v4 offset:40960
    v_cvt_pk_bf16_f32 v56, v104, v105
    v_mfma_f32_16x16x32_bf16 v[108:111], a[228:231], v[156:159], v[108:111]
    ds_read_b128 v[156:159], v25 offset:40960
    v_cvt_pk_bf16_f32 v57, v106, v107
    v_mfma_f32_16x16x32_bf16 v[108:111], a[252:255], v[160:163], v[108:111]
    ds_read_b128 v[160:163], v4 offset:43008
    s_mov_b32 s57, 353792
    v_mfma_f32_16x16x32_bf16 v[108:111], v[196:199], v[164:167], v[108:111]
    ds_read_b128 v[164:167], v25 offset:43008
    buffer_load_dwordx4 v2, s[8:11], s57 offen offset:1024 lds
    v_mfma_f32_16x16x32_bf16 v[108:111], v[220:223], v[168:171], v[108:111]
    ds_read_b128 v[168:171], v4 offset:45056
    ds_read_b64_tr_b16 v[230:231], v13 offset:17408
    v_mfma_f32_16x16x32_bf16 v[108:111], v[244:247], v[172:175], v[108:111]
    ds_read_b128 v[172:175], v25 offset:45056
    s_waitcnt lgkmcnt(14)
    v_mfma_f32_16x16x32_bf16 v[112:115], a[8:11], v[120:123], 0
    s_add_u32 m0, s90, 90112
    s_mov_b32 s57, 430080
    v_mfma_f32_16x16x32_bf16 v[112:115], a[32:35], v[124:127], v[112:115]
    buffer_load_dwordx4 v2, s[8:11], s57 offen offset:0 lds
    v_mfma_f32_16x16x32_bf16 v[112:115], a[56:59], v[128:131], v[112:115]
    s_waitcnt lgkmcnt(10)
    v_mfma_f32_16x16x32_bf16 v[112:115], a[80:83], v[132:135], v[112:115]
    v_mfma_f32_16x16x32_bf16 v[112:115], a[104:107], v[136:139], v[112:115]
    s_mov_b32 s57, 439808
    v_mfma_f32_16x16x32_bf16 v[112:115], a[128:131], v[140:143], v[112:115]
    buffer_load_dwordx4 v2, s[8:11], s57 offen offset:1024 lds
    s_waitcnt lgkmcnt(6)
    v_mfma_f32_16x16x32_bf16 v[112:115], a[152:155], v[144:147], v[112:115]
    v_cvt_pk_bf16_f32 v58, v108, v109
    v_cvt_pk_bf16_f32 v59, v110, v111
    v_mfma_f32_16x16x32_bf16 v[112:115], a[176:179], v[148:151], v[112:115]
    v_cndmask_b32 v58, v58, 0, s[82:83]
    v_cndmask_b32 v59, v59, 0, s[82:83]
    v_mfma_f32_16x16x32_bf16 v[112:115], a[200:203], v[152:155], v[112:115]
    s_add_u32 m0, s90, 98304
    s_mov_b32 s57, 516096
    s_waitcnt lgkmcnt(3)
    v_mfma_f32_16x16x32_bf16 v[112:115], a[224:227], v[156:159], v[112:115]
    buffer_load_dwordx4 v2, s[8:11], s57 offen offset:0 lds
    v_mfma_f32_16x16x32_bf16 v[112:115], a[248:251], v[160:163], v[112:115]
    v_mfma_f32_16x16x32_bf16 v[112:115], v[192:195], v[164:167], v[112:115]
    s_waitcnt lgkmcnt(0)
    v_mfma_f32_16x16x32_bf16 v[112:115], v[216:219], v[168:171], v[112:115]
    s_mov_b32 s57, 525824
    v_mfma_f32_16x16x32_bf16 v[112:115], v[240:243], v[172:175], v[112:115]
    buffer_load_dwordx4 v2, s[8:11], s57 offen offset:1024 lds
    v_mfma_f32_16x16x32_bf16 v[116:119], a[12:15], v[120:123], 0
    v_mfma_f32_16x16x32_bf16 v[116:119], a[36:39], v[124:127], v[116:119]
    s_waitcnt vmcnt(10)
    s_barrier
    v_mfma_f32_16x16x32_bf16 v[116:119], a[60:63], v[128:131], v[116:119]
    s_add_u32 m0, s90, 106496
    s_mov_b32 s57, 602112
    ds_read_b64_tr_b16 v[248:249], v12 offset:24576
    v_mfma_f32_16x16x32_bf16 v[116:119], a[84:87], v[132:135], v[116:119]
    buffer_load_dwordx4 v2, s[8:11], s57 offen offset:0 lds
    v_mfma_f32_16x16x32_bf16 v[116:119], a[108:111], v[136:139], v[116:119]
    ds_read_b64_tr_b16 v[250:251], v12 offset:25600
    ds_read_b64_tr_b16 v[252:253], v13 offset:24576
    v_mfma_f32_16x16x32_bf16 v[116:119], a[132:135], v[140:143], v[116:119]
    ds_read_b64_tr_b16 v[254:255], v13 offset:25600
    ds_read_b64_tr_b16 a[0:1], v10 offset:32768
    v_mfma_f32_16x16x32_bf16 v[116:119], a[156:159], v[144:147], v[116:119]
    s_mov_b32 s57, 611840
    v_cvt_pk_bf16_f32 v60, v112, v113
    v_mfma_f32_16x16x32_bf16 v[116:119], a[180:183], v[148:151], v[116:119]
    buffer_load_dwordx4 v2, s[8:11], s57 offen offset:1024 lds
    v_mfma_f32_16x16x32_bf16 v[116:119], a[204:207], v[152:155], v[116:119]
    v_cvt_pk_bf16_f32 v61, v114, v115
    ds_read_b64_tr_b16 a[2:3], v10 offset:33792
    v_mfma_f32_16x16x32_bf16 v[116:119], a[228:231], v[156:159], v[116:119]
    ds_read_b64_tr_b16 a[4:5], v11 offset:32768
    ds_read_b64_tr_b16 a[6:7], v11 offset:33792
    v_mfma_f32_16x16x32_bf16 v[116:119], a[252:255], v[160:163], v[116:119]
    s_add_u32 m0, s90, 114688
    s_mov_b32 s57, 688128
    ds_read_b64_tr_b16 a[24:25], v10 offset:40960
    v_mfma_f32_16x16x32_bf16 v[116:119], v[196:199], v[164:167], v[116:119]
    buffer_load_dwordx4 v2, s[8:11], s57 offen offset:0 lds
    v_mfma_f32_16x16x32_bf16 v[116:119], v[220:223], v[168:171], v[116:119]
    ds_read_b64_tr_b16 a[26:27], v10 offset:41984
    ds_read_b64_tr_b16 a[28:29], v11 offset:40960
    v_mfma_f32_16x16x32_bf16 v[116:119], v[244:247], v[172:175], v[116:119]
    ds_read_b64_tr_b16 a[30:31], v11 offset:41984
    s_waitcnt lgkmcnt(0)
    v_mfma_f32_16x16x32_bf16 v[96:99], v[120:123], a[16:19], 0
    s_mov_b32 s57, 697856
    v_mfma_f32_16x16x32_bf16 v[96:99], v[124:127], a[40:43], v[96:99]
    buffer_load_dwordx4 v2, s[8:11], s57 offen offset:1024 lds
    v_mfma_f32_16x16x32_bf16 v[96:99], v[128:131], a[64:67], v[96:99]
    v_mfma_f32_16x16x32_bf16 v[96:99], v[132:135], a[88:91], v[96:99]
    v_mfma_f32_16x16x32_bf16 v[96:99], v[136:139], a[112:115], v[96:99]
    s_add_u32 m0, s90, 122880
    s_mov_b32 s57, 774144
    v_mfma_f32_16x16x32_bf16 v[96:99], v[140:143], a[136:139], v[96:99]
    buffer_load_dwordx4 v2, s[8:11], s57 offen offset:0 lds
    v_mfma_f32_16x16x32_bf16 v[96:99], v[144:147], a[160:163], v[96:99]
    v_cvt_pk_bf16_f32 v62, v116, v117
    v_cvt_pk_bf16_f32 v63, v118, v119
    v_mfma_f32_16x16x32_bf16 v[96:99], v[148:151], a[184:187], v[96:99]
    v_cndmask_b32 v62, v62, 0, s[82:83]
    v_cndmask_b32 v63, v63, 0, s[82:83]
    v_mfma_f32_16x16x32_bf16 v[96:99], v[152:155], a[208:211], v[96:99]
    s_mov_b32 s57, 783872
    v_mfma_f32_16x16x32_bf16 v[96:99], v[156:159], a[232:235], v[96:99]
    buffer_load_dwordx4 v2, s[8:11], s57 offen offset:1024 lds
    v_mfma_f32_16x16x32_bf16 v[96:99], v[160:163], v[176:179], v[96:99]
    v_mfma_f32_16x16x32_bf16 v[96:99], v[164:167], v[200:203], v[96:99]
    s_waitcnt vmcnt(10)
    s_barrier
    v_mfma_f32_16x16x32_bf16 v[96:99], v[168:171], v[224:227], v[96:99]
    s_add_u32 m0, s90, 131072
    s_mov_b32 s57, 860160
    ds_read_b64_tr_b16 a[48:49], v6 offset:0
    v_mfma_f32_16x16x32_bf16 v[96:99], v[172:175], v[248:251], v[96:99]
    buffer_load_dwordx4 v2, s[8:11], s57 offen offset:0 lds
    v_mfma_f32_16x16x32_bf16 v[100:103], v[120:123], a[20:23], 0
    ds_read_b128 v[120:123], v4 offset:16384
    ds_read_b64_tr_b16 a[50:51], v6 offset:1024
    v_mfma_f32_16x16x32_bf16 v[100:103], v[124:127], a[44:47], v[100:103]
    ds_read_b128 v[124:127], v25 offset:16384
    ds_read_b64_tr_b16 a[52:53], v7 offset:0
    v_mfma_f32_16x16x32_bf16 v[100:103], v[128:131], a[68:71], v[100:103]
    ds_read_b128 v[128:131], v4 offset:18432
    s_mov_b32 s57, 869888
    v_mfma_f32_16x16x32_bf16 v[100:103], v[132:135], a[92:95], v[100:103]
    ds_read_b128 v[132:135], v25 offset:18432
    buffer_load_dwordx4 v2, s[8:11], s57 offen offset:1024 lds
    v_mfma_f32_16x16x32_bf16 v[100:103], v[136:139], a[116:119], v[100:103]
    ds_read_b128 v[136:139], v4 offset:20480
    ds_read_b64_tr_b16 a[54:55], v7 offset:1024
    v_mfma_f32_16x16x32_bf16 v[100:103], v[140:143], a[140:143], v[100:103]
    ds_read_b128 v[140:143], v25 offset:20480
    ds_read_b64_tr_b16 a[72:73], v6 offset:8192
    v_mfma_f32_16x16x32_bf16 v[100:103], v[144:147], a[164:167], v[100:103]
    ds_read_b128 v[144:147], v4 offset:22528
    s_add_u32 m0, s90, 139264
    s_mov_b32 s57, 946176
    v_mfma_f32_16x16x32_bf16 v[100:103], v[148:151], a[188:191], v[100:103]
    ds_read_b128 v[148:151], v25 offset:22528
    buffer_load_dwordx4 v2, s[8:11], s57 offen offset:0 lds
    v_mfma_f32_16x16x32_bf16 v[100:103], v[152:155], a[212:215], v[100:103]
    ds_read_b128 v[152:155], v4 offset:24576
    v_cvt_pk_bf16_f32 v36, v96, v97
    v_mfma_f32_16x16x32_bf16 v[100:103], v[156:159], a[236:239], v[100:103]
    ds_read_b128 v[156:159], v25 offset:24576
    v_cvt_pk_bf16_f32 v37, v98, v99
    v_mfma_f32_16x16x32_bf16 v[100:103], v[160:163], v[180:183], v[100:103]
    ds_read_b128 v[160:163], v4 offset:26624
    s_mov_b32 s57, 955904
    v_mfma_f32_16x16x32_bf16 v[100:103], v[164:167], v[204:207], v[100:103]
    ds_read_b128 v[164:167], v25 offset:26624
    buffer_load_dwordx4 v2, s[8:11], s57 offen offset:1024 lds
    v_mfma_f32_16x16x32_bf16 v[100:103], v[168:171], v[228:231], v[100:103]
    ds_read_b128 v[168:171], v4 offset:28672
    ds_read_b64_tr_b16 a[74:75], v6 offset:9216
    v_mfma_f32_16x16x32_bf16 v[100:103], v[172:175], v[252:255], v[100:103]
    ds_read_b128 v[172:175], v25 offset:28672
    ds_read_b64_tr_b16 a[76:77], v7 offset:8192
    s_waitcnt lgkmcnt(15)
    v_mfma_f32_16x16x32_bf16 v[104:107], v[120:123], a[16:19], 0
    s_add_u32 m0, s90, 147456
    s_mov_b32 s57, 1032192
    ds_read_b64_tr_b16 a[78:79], v7 offset:9216
    v_mfma_f32_16x16x32_bf16 v[104:107], v[124:127], a[40:43], v[104:107]
    buffer_load_dwordx4 v2, s[8:11], s57 offen offset:0 lds
    v_mfma_f32_16x16x32_bf16 v[104:107], v[128:131], a[64:67], v[104:107]
    ds_read_b64_tr_b16 a[96:97], v6 offset:16384
    ds_read_b64_tr_b16 a[98:99], v6 offset:17408
    s_waitcnt lgkmcnt(14)
    v_mfma_f32_16x16x32_bf16 v[104:107], v[132:135], a[88:91], v[104:107]
    ds_read_b64_tr_b16 a[100:101], v7 offset:16384
    ds_read_b64_tr_b16 a[102:103], v7 offset:17408
    v_mfma_f32_16x16x32_bf16 v[104:107], v[136:139], a[112:115], v[104:107]
    s_mov_b32 s57, 1041920
    v_mfma_f32_16x16x32_bf16 v[104:107], v[140:143], a[136:139], v[104:107]
    buffer_load_dwordx4 v2, s[8:11], s57 offen offset:1024 lds
    s_waitcnt lgkmcnt(12)
    v_mfma_f32_16x16x32_bf16 v[104:107], v[144:147], a[160:163], v[104:107]
    v_cvt_pk_bf16_f32 v46, v100, v101
    v_cvt_pk_bf16_f32 v47, v102, v103
    v_mfma_f32_16x16x32_bf16 v[104:107], v[148:151], a[184:187], v[104:107]
    s_waitcnt vmcnt(10)
    s_waitcnt lgkmcnt(0)
    s_barrier
    v_mfma_f32_16x16x32_bf16 v[104:107], v[152:155], a[208:211], v[104:107]
    s_add_u32 m0, s90, 155648
    s_mov_b32 s57, 1118208
    ds_read_b64_tr_b16 a[120:121], v6 offset:24576
    v_mfma_f32_16x16x32_bf16 v[104:107], v[156:159], a[232:235], v[104:107]
    buffer_load_dwordx4 v2, s[8:11], s57 offen offset:0 lds
    v_mfma_f32_16x16x32_bf16 v[104:107], v[160:163], v[176:179], v[104:107]
    ds_read_b64_tr_b16 a[122:123], v6 offset:25600
    ds_read_b64_tr_b16 a[124:125], v7 offset:24576
    v_mfma_f32_16x16x32_bf16 v[104:107], v[164:167], v[200:203], v[104:107]
    ds_read_b64_tr_b16 a[126:127], v7 offset:25600
    ds_read_b64_tr_b16 a[144:145], v6 offset:32768
    v_mfma_f32_16x16x32_bf16 v[104:107], v[168:171], v[224:227], v[104:107]
    s_mov_b32 s57, 1127936
    ds_read_b64_tr_b16 a[146:147], v6 offset:33792
    v_mfma_f32_16x16x32_bf16 v[104:107], v[172:175], v[248:251], v[104:107]
    buffer_load_dwordx4 v2, s[8:11], s57 offen offset:1024 lds
    v_mfma_f32_16x16x32_bf16 v[108:111], v[120:123], a[20:23], 0
    ds_read_b128 v[120:123], v4 offset:0
    ds_read_b64_tr_b16 a[148:149], v7 offset:32768
    v_mfma_f32_16x16x32_bf16 v[108:111], v[124:127], a[44:47], v[108:111]
    ds_read_b128 v[124:127], v25 offset:0
    ds_read_b64_tr_b16 a[150:151], v7 offset:33792
    v_mfma_f32_16x16x32_bf16 v[108:111], v[128:131], a[68:71], v[108:111]
    ds_read_b128 v[128:131], v4 offset:2048
    s_add_u32 m0, s52, 49152
    s_add_u32 s58, s72, 28672
    s_add_u32 s57, s58, s68
    v_mfma_f32_16x16x32_bf16 v[108:111], v[132:135], a[92:95], v[108:111]
    ds_read_b128 v[132:135], v25 offset:2048
    buffer_load_dwordx4 v3, s[24:27], s57 offen offset:0 sc1 lds
    v_mfma_f32_16x16x32_bf16 v[108:111], v[136:139], a[116:119], v[108:111]
    ds_read_b128 v[136:139], v4 offset:4096
    ds_read_b64_tr_b16 a[168:169], v6 offset:40960
    v_mfma_f32_16x16x32_bf16 v[108:111], v[140:143], a[140:143], v[108:111]
    ds_read_b128 v[140:143], v25 offset:4096
    ds_read_b64_tr_b16 a[170:171], v6 offset:41984
    v_mfma_f32_16x16x32_bf16 v[108:111], v[144:147], a[164:167], v[108:111]
    ds_read_b128 v[144:147], v4 offset:6144
    s_add_u32 s57, s58, s69
    v_mfma_f32_16x16x32_bf16 v[108:111], v[148:151], a[188:191], v[108:111]
    ds_read_b128 v[148:151], v25 offset:6144
    buffer_load_dwordx4 v3, s[24:27], s57 offen offset:1024 sc1 lds
    v_mfma_f32_16x16x32_bf16 v[108:111], v[152:155], a[212:215], v[108:111]
    ds_read_b128 v[152:155], v4 offset:8192
    v_cvt_pk_bf16_f32 v34, v104, v105
    v_mfma_f32_16x16x32_bf16 v[108:111], v[156:159], a[236:239], v[108:111]
    ds_read_b128 v[156:159], v25 offset:8192
    v_cvt_pk_bf16_f32 v35, v106, v107
    v_mfma_f32_16x16x32_bf16 v[108:111], v[160:163], v[180:183], v[108:111]
    ds_read_b128 v[160:163], v4 offset:10240
    s_add_u32 s57, s58, s70
    v_mfma_f32_16x16x32_bf16 v[108:111], v[164:167], v[204:207], v[108:111]
    ds_read_b128 v[164:167], v25 offset:10240
    buffer_load_dwordx4 v3, s[24:27], s57 offen offset:2048 sc1 lds
    v_mfma_f32_16x16x32_bf16 v[108:111], v[168:171], v[228:231], v[108:111]
    ds_read_b128 v[168:171], v4 offset:12288
    ds_read_b64_tr_b16 a[172:173], v7 offset:40960
    v_mfma_f32_16x16x32_bf16 v[108:111], v[172:175], v[252:255], v[108:111]
    ds_read_b128 v[172:175], v25 offset:12288
    ds_read_b64_tr_b16 a[174:175], v7 offset:41984
    s_waitcnt lgkmcnt(15)
    v_mfma_f32_16x16x32_bf16 v[112:115], v[120:123], a[16:19], 0
    s_add_u32 s57, s58, s71
    v_mfma_f32_16x16x32_bf16 v[112:115], v[124:127], a[40:43], v[112:115]
    buffer_load_dwordx4 v3, s[24:27], s57 offen offset:3072 sc1 lds
    v_mfma_f32_16x16x32_bf16 v[112:115], v[128:131], a[64:67], v[112:115]
    s_waitcnt lgkmcnt(11)
    v_mfma_f32_16x16x32_bf16 v[112:115], v[132:135], a[88:91], v[112:115]
    s_waitcnt vmcnt(10)
    s_waitcnt lgkmcnt(0)
    s_barrier
    v_mfma_f32_16x16x32_bf16 v[112:115], v[136:139], a[112:115], v[112:115]
    ds_read_b64_tr_b16 a[192:193], v10 offset:0
    ds_read_b64_tr_b16 a[194:195], v10 offset:1024
    v_mfma_f32_16x16x32_bf16 v[112:115], v[140:143], a[136:139], v[112:115]
    ds_read_b64_tr_b16 a[196:197], v11 offset:0
    ds_read_b64_tr_b16 a[198:199], v11 offset:1024
    v_mfma_f32_16x16x32_bf16 v[112:115], v[144:147], a[160:163], v[112:115]
    v_cvt_pk_bf16_f32 v44, v108, v109
    v_cvt_pk_bf16_f32 v45, v110, v111
    v_mfma_f32_16x16x32_bf16 v[112:115], v[148:151], a[184:187], v[112:115]
    ds_read_b64_tr_b16 a[216:217], v10 offset:8192
    ds_read_b64_tr_b16 a[218:219], v10 offset:9216
    v_mfma_f32_16x16x32_bf16 v[112:115], v[152:155], a[208:211], v[112:115]
    ds_read_b64_tr_b16 a[220:221], v11 offset:8192
    ds_read_b64_tr_b16 a[222:223], v11 offset:9216
    v_mfma_f32_16x16x32_bf16 v[112:115], v[156:159], a[232:235], v[112:115]
    ds_read_b64_tr_b16 a[240:241], v10 offset:16384
    ds_read_b64_tr_b16 a[242:243], v10 offset:17408
    v_mfma_f32_16x16x32_bf16 v[112:115], v[160:163], v[176:179], v[112:115]
    ds_read_b64_tr_b16 a[244:245], v11 offset:16384
    ds_read_b64_tr_b16 a[246:247], v11 offset:17408
    v_mfma_f32_16x16x32_bf16 v[112:115], v[164:167], v[200:203], v[112:115]
    v_mfma_f32_16x16x32_bf16 v[112:115], v[168:171], v[224:227], v[112:115]
    v_mfma_f32_16x16x32_bf16 v[112:115], v[172:175], v[248:251], v[112:115]
    v_mfma_f32_16x16x32_bf16 v[116:119], v[120:123], a[20:23], 0
    ds_read_b128 v[120:123], v4 offset:16384
    v_mfma_f32_16x16x32_bf16 v[116:119], v[124:127], a[44:47], v[116:119]
    ds_read_b128 v[124:127], v25 offset:16384
    v_mfma_f32_16x16x32_bf16 v[116:119], v[128:131], a[68:71], v[116:119]
    ds_read_b128 v[128:131], v4 offset:18432
    v_mfma_f32_16x16x32_bf16 v[116:119], v[132:135], a[92:95], v[116:119]
    ds_read_b128 v[132:135], v25 offset:18432
    v_mfma_f32_16x16x32_bf16 v[116:119], v[136:139], a[116:119], v[116:119]
    ds_read_b128 v[136:139], v4 offset:20480
    v_mfma_f32_16x16x32_bf16 v[116:119], v[140:143], a[140:143], v[116:119]
    ds_read_b128 v[140:143], v25 offset:20480
    v_mfma_f32_16x16x32_bf16 v[116:119], v[144:147], a[164:167], v[116:119]
    ds_read_b128 v[144:147], v4 offset:22528
    v_cvt_pk_bf16_f32 v32, v112, v113
    v_mfma_f32_16x16x32_bf16 v[116:119], v[148:151], a[188:191], v[116:119]
    ds_read_b128 v[148:151], v25 offset:22528
    v_cvt_pk_bf16_f32 v33, v114, v115
    v_mfma_f32_16x16x32_bf16 v[116:119], v[152:155], a[212:215], v[116:119]
    ds_read_b128 v[152:155], v4 offset:24576
    v_mfma_f32_16x16x32_bf16 v[116:119], v[156:159], a[236:239], v[116:119]
    ds_read_b128 v[156:159], v25 offset:24576
    v_mfma_f32_16x16x32_bf16 v[116:119], v[160:163], v[180:183], v[116:119]
    ds_read_b128 v[160:163], v4 offset:26624
    v_mfma_f32_16x16x32_bf16 v[116:119], v[164:167], v[204:207], v[116:119]
    ds_read_b128 v[164:167], v25 offset:26624
    v_mfma_f32_16x16x32_bf16 v[116:119], v[168:171], v[228:231], v[116:119]
    ds_read_b128 v[168:171], v4 offset:28672
    v_mfma_f32_16x16x32_bf16 v[116:119], v[172:175], v[252:255], v[116:119]
    ds_read_b128 v[172:175], v25 offset:28672
    s_waitcnt vmcnt(4)
    s_waitcnt lgkmcnt(14)
    s_barrier
    ds_read_b64_tr_b16 v[184:185], v10 offset:24576
    ds_read_b64_tr_b16 v[186:187], v10 offset:25600
    ds_read_b64_tr_b16 v[188:189], v11 offset:24576
    ds_read_b64_tr_b16 v[190:191], v11 offset:25600
    ds_read_b64_tr_b16 v[208:209], v10 offset:32768
    ds_read_b64_tr_b16 v[210:211], v10 offset:33792
    ds_read_b64_tr_b16 v[212:213], v11 offset:32768
    ds_read_b64_tr_b16 v[214:215], v11 offset:33792
    ds_read_b64_tr_b16 v[232:233], v10 offset:40960
    ds_read_b64_tr_b16 v[234:235], v10 offset:41984
    ds_read_b64_tr_b16 v[236:237], v11 offset:40960
    ds_read_b64_tr_b16 v[238:239], v11 offset:41984
    s_waitcnt lgkmcnt(0)
    v_mfma_f32_16x16x32_bf16 v[96:99], a[0:3], v[120:123], 0
    v_mfma_f32_16x16x32_bf16 v[96:99], a[24:27], v[124:127], v[96:99]
    v_mfma_f32_16x16x32_bf16 v[96:99], a[48:51], v[128:131], v[96:99]
    v_mfma_f32_16x16x32_bf16 v[96:99], a[72:75], v[132:135], v[96:99]
    v_mfma_f32_16x16x32_bf16 v[96:99], a[96:99], v[136:139], v[96:99]
    v_mfma_f32_16x16x32_bf16 v[96:99], a[120:123], v[140:143], v[96:99]
    v_mfma_f32_16x16x32_bf16 v[96:99], a[144:147], v[144:147], v[96:99]
    v_cvt_pk_bf16_f32 v42, v116, v117
    v_cvt_pk_bf16_f32 v43, v118, v119
    v_mfma_f32_16x16x32_bf16 v[96:99], a[168:171], v[148:151], v[96:99]
    v_mfma_f32_16x16x32_bf16 v[96:99], a[192:195], v[152:155], v[96:99]
    v_mfma_f32_16x16x32_bf16 v[96:99], a[216:219], v[156:159], v[96:99]
    v_mfma_f32_16x16x32_bf16 v[96:99], a[240:243], v[160:163], v[96:99]
    v_mfma_f32_16x16x32_bf16 v[96:99], v[184:187], v[164:167], v[96:99]
    s_barrier
    v_mfma_f32_16x16x32_bf16 v[96:99], v[208:211], v[168:171], v[96:99]
    s_add_u32 m0, s52, 65536
    s_add_u32 s58, s72, 43008
    s_add_u32 s57, s58, s68
    v_mfma_f32_16x16x32_bf16 v[96:99], v[232:235], v[172:175], v[96:99]
    buffer_load_dwordx4 v3, s[24:27], s57 offen offset:0 sc1 lds
    v_mfma_f32_16x16x32_bf16 v[100:103], a[4:7], v[120:123], 0
    ds_read_b128 v[120:123], v4 offset:32768
    v_mfma_f32_16x16x32_bf16 v[100:103], a[28:31], v[124:127], v[100:103]
    ds_read_b128 v[124:127], v25 offset:32768
    v_mfma_f32_16x16x32_bf16 v[100:103], a[52:55], v[128:131], v[100:103]
    ds_read_b128 v[128:131], v4 offset:34816
    v_mfma_f32_16x16x32_bf16 v[100:103], a[76:79], v[132:135], v[100:103]
    ds_read_b128 v[132:135], v25 offset:34816
    v_mfma_f32_16x16x32_bf16 v[100:103], a[100:103], v[136:139], v[100:103]
    ds_read_b128 v[136:139], v4 offset:36864
    s_add_u32 s57, s58, s69
    v_mfma_f32_16x16x32_bf16 v[100:103], a[124:127], v[140:143], v[100:103]
    ds_read_b128 v[140:143], v25 offset:36864
    buffer_load_dwordx4 v3, s[24:27], s57 offen offset:1024 sc1 lds
    v_mfma_f32_16x16x32_bf16 v[100:103], a[148:151], v[144:147], v[100:103]
    ds_read_b128 v[144:147], v4 offset:38912
    v_cvt_pk_bf16_f32 v68, v96, v97
    v_mfma_f32_16x16x32_bf16 v[100:103], a[172:175], v[148:151], v[100:103]
    ds_read_b128 v[148:151], v25 offset:38912
    v_cvt_pk_bf16_f32 v69, v98, v99
    v_mfma_f32_16x16x32_bf16 v[100:103], a[196:199], v[152:155], v[100:103]
    ds_read_b128 v[152:155], v4 offset:40960
    v_mfma_f32_16x16x32_bf16 v[100:103], a[220:223], v[156:159], v[100:103]
    ds_read_b128 v[156:159], v25 offset:40960
    v_mfma_f32_16x16x32_bf16 v[100:103], a[244:247], v[160:163], v[100:103]
    ds_read_b128 v[160:163], v4 offset:43008
    s_add_u32 s57, s58, s70
    v_mfma_f32_16x16x32_bf16 v[100:103], v[188:191], v[164:167], v[100:103]
    ds_read_b128 v[164:167], v25 offset:43008
    buffer_load_dwordx4 v3, s[24:27], s57 offen offset:2048 sc1 lds
    v_mfma_f32_16x16x32_bf16 v[100:103], v[212:215], v[168:171], v[100:103]
    ds_read_b128 v[168:171], v4 offset:45056
    v_mfma_f32_16x16x32_bf16 v[100:103], v[236:239], v[172:175], v[100:103]
    ds_read_b128 v[172:175], v25 offset:45056
    s_waitcnt lgkmcnt(11)
    v_mfma_f32_16x16x32_bf16 v[104:107], a[0:3], v[120:123], 0
    v_mfma_f32_16x16x32_bf16 v[104:107], a[24:27], v[124:127], v[104:107]
    v_mfma_f32_16x16x32_bf16 v[104:107], a[48:51], v[128:131], v[104:107]
    s_add_u32 s57, s58, s71
    s_waitcnt lgkmcnt(8)
    v_mfma_f32_16x16x32_bf16 v[104:107], a[72:75], v[132:135], v[104:107]
    buffer_load_dwordx4 v3, s[24:27], s57 offen offset:3072 sc1 lds
    v_mfma_f32_16x16x32_bf16 v[104:107], a[96:99], v[136:139], v[104:107]
    v_mfma_f32_16x16x32_bf16 v[104:107], a[120:123], v[140:143], v[104:107]
    s_waitcnt lgkmcnt(5)
    v_mfma_f32_16x16x32_bf16 v[104:107], a[144:147], v[144:147], v[104:107]
    v_cvt_pk_bf16_f32 v70, v100, v101
    v_cvt_pk_bf16_f32 v71, v102, v103
    v_mfma_f32_16x16x32_bf16 v[104:107], a[168:171], v[148:151], v[104:107]
    v_cndmask_b32 v70, v70, 0, s[82:83]
    v_cndmask_b32 v71, v71, 0, s[82:83]
    v_mfma_f32_16x16x32_bf16 v[104:107], a[192:195], v[152:155], v[104:107]
    s_add_u32 m0, s52, 81920
    s_add_u32 s58, s72, 57344
    s_add_u32 s57, s58, s68
    s_waitcnt lgkmcnt(2)
    v_mfma_f32_16x16x32_bf16 v[104:107], a[216:219], v[156:159], v[104:107]
    buffer_load_dwordx4 v3, s[24:27], s57 offen offset:0 sc1 lds
    v_mfma_f32_16x16x32_bf16 v[104:107], a[240:243], v[160:163], v[104:107]
    v_mfma_f32_16x16x32_bf16 v[72:75], v[52:55], v[68:71], 0
    v_mfma_f32_16x16x32_bf16 v[104:107], v[184:187], v[164:167], v[104:107]
    v_mfma_f32_16x16x32_bf16 v[76:79], v[56:59], v[68:71], 0
    s_waitcnt lgkmcnt(0)
    v_mfma_f32_16x16x32_bf16 v[104:107], v[208:211], v[168:171], v[104:107]
    v_mfma_f32_16x16x32_bf16 v[104:107], v[232:235], v[172:175], v[104:107]
    s_waitcnt vmcnt(5)
    s_barrier
    v_mfma_f32_16x16x32_bf16 v[108:111], a[4:7], v[120:123], 0
    ds_read_b128 v[120:123], v4 offset:49152
    s_add_u32 s57, s58, s69
    v_mfma_f32_16x16x32_bf16 v[108:111], a[28:31], v[124:127], v[108:111]
    ds_read_b128 v[124:127], v25 offset:49152
    buffer_load_dwordx4 v3, s[24:27], s57 offen offset:1024 sc1 lds
    v_mfma_f32_16x16x32_bf16 v[108:111], a[52:55], v[128:131], v[108:111]
    ds_read_b128 v[128:131], v4 offset:51200
    v_cndmask_b32 v26, v72, v73, s[76:77]
    v_mfma_f32_16x16x32_bf16 v[108:111], a[76:79], v[132:135], v[108:111]
    ds_read_b128 v[132:135], v25 offset:51200
    v_cndmask_b32 v27, v74, v75, s[76:77]
    v_mfma_f32_16x16x32_bf16 v[108:111], a[100:103], v[136:139], v[108:111]
    ds_read_b128 v[136:139], v4 offset:53248
    v_cndmask_b32 v28, v76, v77, s[76:77]
    v_mfma_f32_16x16x32_bf16 v[108:111], a[124:127], v[140:143], v[108:111]
    ds_read_b128 v[140:143], v25 offset:53248
    v_cndmask_b32 v29, v78, v79, s[76:77]
    v_mfma_f32_16x16x32_bf16 v[108:111], a[148:151], v[144:147], v[108:111]
    ds_read_b128 v[144:147], v4 offset:55296
    s_add_u32 s57, s58, s70
    v_mfma_f32_16x16x32_bf16 v[108:111], a[172:175], v[148:151], v[108:111]
    ds_read_b128 v[148:151], v25 offset:55296
    buffer_load_dwordx4 v3, s[24:27], s57 offen offset:2048 sc1 lds
    v_mfma_f32_16x16x32_bf16 v[108:111], a[196:199], v[152:155], v[108:111]
    ds_read_b128 v[152:155], v4 offset:57344
    v_cvt_pk_bf16_f32 v64, v104, v105
    v_mfma_f32_16x16x32_bf16 v[108:111], a[220:223], v[156:159], v[108:111]
    ds_read_b128 v[156:159], v25 offset:57344
    v_cvt_pk_bf16_f32 v65, v106, v107
    v_mfma_f32_16x16x32_bf16 v[108:111], a[244:247], v[160:163], v[108:111]
    ds_read_b128 v[160:163], v4 offset:59392
    v_cndmask_b32 v26, v26, v28, s[78:79]
    v_mfma_f32_16x16x32_bf16 v[108:111], v[188:191], v[164:167], v[108:111]
    ds_read_b128 v[164:167], v25 offset:59392
    v_cndmask_b32 v27, v27, v29, s[80:81]
    v_mfma_f32_16x16x32_bf16 v[108:111], v[212:215], v[168:171], v[108:111]
    ds_read_b128 v[168:171], v4 offset:61440
    s_add_u32 s57, s58, s71
    v_mfma_f32_16x16x32_bf16 v[108:111], v[236:239], v[172:175], v[108:111]
    ds_read_b128 v[172:175], v25 offset:61440
    buffer_load_dwordx4 v3, s[24:27], s57 offen offset:3072 sc1 lds
    s_waitcnt lgkmcnt(11)
    v_mfma_f32_16x16x32_bf16 v[112:115], a[8:11], v[120:123], 0
    v_cndmask_b32 v26, v26, v18, s[84:85]
    v_cndmask_b32 v27, v27, v18, s[86:87]
    v_mfma_f32_16x16x32_bf16 v[112:115], a[32:35], v[124:127], v[112:115]
    v_max_f32 v28, v26, v27
    v_mov_b32 v29, v28
    v_mfma_f32_16x16x32_bf16 v[112:115], a[56:59], v[128:131], v[112:115]
    s_waitcnt lgkmcnt(8)
    v_mfma_f32_16x16x32_bf16 v[112:115], a[80:83], v[132:135], v[112:115]
    v_permlane16_swap_b32 v28, v29
    v_max_f32 v28, v28, v29
    v_mfma_f32_16x16x32_bf16 v[112:115], a[104:107], v[136:139], v[112:115]
    s_add_u32 m0, s52, 98304
    s_add_u32 s58, s72, 71680
    s_add_u32 s57, s58, s68
    v_mov_b32 v29, v28
    v_mfma_f32_16x16x32_bf16 v[112:115], a[128:131], v[140:143], v[112:115]
    buffer_load_dwordx4 v3, s[24:27], s57 offen offset:0 sc1 lds
    s_waitcnt lgkmcnt(5)
    v_mfma_f32_16x16x32_bf16 v[112:115], a[152:155], v[144:147], v[112:115]
    v_cvt_pk_bf16_f32 v66, v108, v109
    v_cvt_pk_bf16_f32 v67, v110, v111
    v_mfma_f32_16x16x32_bf16 v[112:115], a[176:179], v[148:151], v[112:115]
    v_cndmask_b32 v66, v66, 0, s[82:83]
    v_cndmask_b32 v67, v67, 0, s[82:83]
    v_mfma_f32_16x16x32_bf16 v[112:115], a[200:203], v[152:155], v[112:115]
    v_permlane32_swap_b32 v28, v29
    v_max_f32 v28, v28, v29
    s_waitcnt lgkmcnt(2)
    v_mfma_f32_16x16x32_bf16 v[112:115], a[224:227], v[156:159], v[112:115]
    v_sub_f32 v26, v26, v28
    v_sub_f32 v27, v27, v28
    v_mfma_f32_16x16x32_bf16 v[112:115], a[248:251], v[160:163], v[112:115]
    s_add_u32 s57, s58, s69
    v_mul_f32 v26, s91, v26
    v_mfma_f32_16x16x32_bf16 v[112:115], v[192:195], v[164:167], v[112:115]
    buffer_load_dwordx4 v3, s[24:27], s57 offen offset:1024 sc1 lds
    s_waitcnt lgkmcnt(0)
    v_mfma_f32_16x16x32_bf16 v[112:115], v[216:219], v[168:171], v[112:115]
    v_mul_f32 v27, s91, v27
    v_exp_f32 v26, v26
    v_mfma_f32_16x16x32_bf16 v[112:115], v[240:243], v[172:175], v[112:115]
    v_exp_f32 v27, v27
    v_mfma_f32_16x16x32_bf16 v[116:119], a[12:15], v[120:123], 0
    v_add_f32 v28, v26, v27
    v_mov_b32 v29, v28
    v_mfma_f32_16x16x32_bf16 v[116:119], a[36:39], v[124:127], v[116:119]
    v_mfma_f32_16x16x32_bf16 v[116:119], a[60:63], v[128:131], v[116:119]
    s_add_u32 s57, s58, s70
    v_permlane16_swap_b32 v28, v29
    v_mfma_f32_16x16x32_bf16 v[116:119], a[84:87], v[132:135], v[116:119]
    buffer_load_dwordx4 v3, s[24:27], s57 offen offset:2048 sc1 lds
    v_mfma_f32_16x16x32_bf16 v[116:119], a[108:111], v[136:139], v[116:119]
    v_add_f32 v28, v28, v29
    v_mov_b32 v29, v28
    v_mfma_f32_16x16x32_bf16 v[116:119], a[132:135], v[140:143], v[116:119]
    v_mfma_f32_16x16x32_bf16 v[116:119], a[156:159], v[144:147], v[116:119]
    v_cvt_pk_bf16_f32 v52, v112, v113
    v_cvt_pk_bf16_f32 v53, v114, v115
    v_mfma_f32_16x16x32_bf16 v[116:119], a[180:183], v[148:151], v[116:119]
    v_permlane32_swap_b32 v28, v29
    v_add_f32 v28, v28, v29
    v_mfma_f32_16x16x32_bf16 v[116:119], a[204:207], v[152:155], v[116:119]
    s_add_u32 s57, s58, s71
    v_rcp_f32 v28, v28
    v_mfma_f32_16x16x32_bf16 v[116:119], a[228:231], v[156:159], v[116:119]
    buffer_load_dwordx4 v3, s[24:27], s57 offen offset:3072 sc1 lds
    v_mfma_f32_16x16x32_bf16 v[116:119], a[252:255], v[160:163], v[116:119]
    v_mul_f32 v26, v26, v28
    v_mul_f32 v27, v27, v28
    v_mfma_f32_16x16x32_bf16 v[116:119], v[196:199], v[164:167], v[116:119]
    v_cvt_pk_bf16_f32 v26, v26, v26
    v_cvt_pk_bf16_f32 v27, v27, v27
    v_mfma_f32_16x16x32_bf16 v[116:119], v[220:223], v[168:171], v[116:119]
    v_and_b32 v80, v26, v14
    v_and_b32 v81, v27, v15
    v_mfma_f32_16x16x32_bf16 v[116:119], v[244:247], v[172:175], v[116:119]
    v_and_b32 v82, v26, v16
    v_and_b32 v83, v27, v17
    v_mfma_f32_16x16x32_bf16 v[96:99], v[120:123], a[16:19], 0
    s_add_u32 m0, s52, 114688
    s_add_u32 s58, s72, 86016
    s_add_u32 s57, s58, s68
    v_mfma_f32_16x16x32_bf16 v[96:99], v[124:127], a[40:43], v[96:99]
    buffer_load_dwordx4 v3, s[24:27], s57 offen offset:0 sc1 lds
    v_mfma_f32_16x16x32_bf16 v[96:99], v[128:131], a[64:67], v[96:99]
    v_mfma_f32_16x16x32_bf16 v[72:75], v[32:35], v[80:83], 0
    v_mfma_f32_16x16x32_bf16 v[96:99], v[132:135], a[88:91], v[96:99]
    v_mfma_f32_16x16x32_bf16 v[76:79], v[42:45], v[80:83], 0
    v_mfma_f32_16x16x32_bf16 v[96:99], v[136:139], a[112:115], v[96:99]
    s_add_u32 s53, s74, 0
    v_mfma_f32_16x16x32_bf16 v[96:99], v[140:143], a[136:139], v[96:99]
    v_mfma_f32_16x16x32_bf16 v[96:99], v[144:147], a[160:163], v[96:99]
    s_add_u32 s57, s58, s69
    v_cvt_pk_bf16_f32 v54, v116, v117
    v_mfma_f32_16x16x32_bf16 v[96:99], v[148:151], a[184:187], v[96:99]
    buffer_load_dwordx4 v3, s[24:27], s57 offen offset:1024 sc1 lds
    v_mfma_f32_16x16x32_bf16 v[96:99], v[152:155], a[208:211], v[96:99]
    v_cvt_pk_bf16_f32 v55, v118, v119
    v_cndmask_b32 v54, v54, 0, s[82:83]
    v_mfma_f32_16x16x32_bf16 v[96:99], v[156:159], a[232:235], v[96:99]
    v_cndmask_b32 v55, v55, 0, s[82:83]
    v_cvt_pk_bf16_f32 v84, v72, v73
    v_mfma_f32_16x16x32_bf16 v[96:99], v[160:163], v[176:179], v[96:99]
    v_cvt_pk_bf16_f32 v85, v74, v75
    v_cvt_pk_bf16_f32 v86, v76, v77
    v_mfma_f32_16x16x32_bf16 v[96:99], v[164:167], v[200:203], v[96:99]
    v_cvt_pk_bf16_f32 v87, v78, v79
    v_cndmask_b32 v86, v86, 0, s[82:83]
    v_mfma_f32_16x16x32_bf16 v[96:99], v[168:171], v[224:227], v[96:99]
    s_add_u32 s57, s58, s70
    v_cndmask_b32 v87, v87, 0, s[82:83]
    v_mfma_f32_16x16x32_bf16 v[96:99], v[172:175], v[248:251], v[96:99]
    buffer_load_dwordx4 v3, s[24:27], s57 offen offset:2048 sc1 lds
    v_mfma_f32_16x16x32_bf16 v[100:103], v[120:123], a[20:23], 0
    buffer_store_dwordx4 v[84:87], v23, s[24:27], s53 offen sc1
    v_mfma_f32_16x16x32_bf16 v[100:103], v[124:127], a[44:47], v[100:103]
    v_mfma_f32_16x16x32_bf16 v[100:103], v[128:131], a[68:71], v[100:103]
    v_mfma_f32_16x16x32_bf16 v[72:75], v[56:59], v[64:67], 0
    v_mfma_f32_16x16x32_bf16 v[100:103], v[132:135], a[92:95], v[100:103]
    v_mfma_f32_16x16x32_bf16 v[76:79], v[60:63], v[64:67], 0
    v_mfma_f32_16x16x32_bf16 v[100:103], v[136:139], a[116:119], v[100:103]
    s_add_u32 s57, s58, s71
    v_mfma_f32_16x16x32_bf16 v[100:103], v[140:143], a[140:143], v[100:103]
    buffer_load_dwordx4 v3, s[24:27], s57 offen offset:3072 sc1 lds
    v_mfma_f32_16x16x32_bf16 v[100:103], v[144:147], a[164:167], v[100:103]
    v_cvt_pk_bf16_f32 v38, v96, v97
    v_cvt_pk_bf16_f32 v39, v98, v99
    v_mfma_f32_16x16x32_bf16 v[100:103], v[148:151], a[188:191], v[100:103]
    v_mfma_f32_16x16x32_bf16 v[100:103], v[152:155], a[212:215], v[100:103]
    v_cndmask_b32 v26, v72, v73, s[76:77]
    v_cndmask_b32 v27, v74, v75, s[76:77]
    v_mfma_f32_16x16x32_bf16 v[100:103], v[156:159], a[236:239], v[100:103]
    v_cndmask_b32 v28, v76, v77, s[76:77]
    v_cndmask_b32 v29, v78, v79, s[76:77]
    v_mfma_f32_16x16x32_bf16 v[100:103], v[160:163], v[180:183], v[100:103]
    s_add_u32 m0, s52, 131072
    s_add_u32 s58, s72, 100352
    s_add_u32 s57, s58, s68
    v_cndmask_b32 v26, v26, v28, s[78:79]
    v_mfma_f32_16x16x32_bf16 v[100:103], v[164:167], v[204:207], v[100:103]
    buffer_load_dwordx4 v3, s[24:27], s57 offen offset:0 sc1 lds
    v_mfma_f32_16x16x32_bf16 v[100:103], v[168:171], v[228:231], v[100:103]
    v_cndmask_b32 v27, v27, v29, s[80:81]
    v_max_f32 v28, v26, v27
    v_mfma_f32_16x16x32_bf16 v[100:103], v[172:175], v[252:255], v[100:103]
    v_mov_b32 v29, v28
    v_mfma_f32_16x16x32_bf16 v[104:107], a[0:3], v[120:123], 0
    v_mfma_f32_16x16x32_bf16 v[104:107], a[24:27], v[124:127], v[104:107]
    v_permlane16_swap_b32 v28, v29
    v_max_f32 v28, v28, v29
    v_mfma_f32_16x16x32_bf16 v[104:107], a[48:51], v[128:131], v[104:107]
    s_add_u32 s57, s58, s69
    v_mov_b32 v29, v28
    v_mfma_f32_16x16x32_bf16 v[104:107], a[72:75], v[132:135], v[104:107]
    buffer_load_dwordx4 v3, s[24:27], s57 offen offset:1024 sc1 lds
    v_mfma_f32_16x16x32_bf16 v[104:107], a[96:99], v[136:139], v[104:107]
    v_permlane32_swap_b32 v28, v29
    v_max_f32 v28, v28, v29
    v_mfma_f32_16x16x32_bf16 v[104:107], a[120:123], v[140:143], v[104:107]
    v_sub_f32 v26, v26, v28
    v_sub_f32 v27, v27, v28
    v_mfma_f32_16x16x32_bf16 v[104:107], a[144:147], v[144:147], v[104:107]
    v_cvt_pk_bf16_f32 v48, v100, v101
    v_cvt_pk_bf16_f32 v49, v102, v103
    v_mfma_f32_16x16x32_bf16 v[104:107], a[168:171], v[148:151], v[104:107]
    v_mul_f32 v26, s91, v26
    v_mul_f32 v27, s91, v27
    v_mfma_f32_16x16x32_bf16 v[104:107], a[192:195], v[152:155], v[104:107]
    s_add_u32 s57, s58, s70
    v_exp_f32 v26, v26
    v_mfma_f32_16x16x32_bf16 v[104:107], a[216:219], v[156:159], v[104:107]
    buffer_load_dwordx4 v3, s[24:27], s57 offen offset:2048 sc1 lds
    v_mfma_f32_16x16x32_bf16 v[104:107], a[240:243], v[160:163], v[104:107]
    v_exp_f32 v27, v27
    v_mfma_f32_16x16x32_bf16 v[104:107], v[184:187], v[164:167], v[104:107]
    v_add_f32 v28, v26, v27
    v_mov_b32 v29, v28
    v_mfma_f32_16x16x32_bf16 v[104:107], v[208:211], v[168:171], v[104:107]
    v_mfma_f32_16x16x32_bf16 v[104:107], v[232:235], v[172:175], v[104:107]
    v_permlane16_swap_b32 v28, v29
    v_add_f32 v28, v28, v29
    s_waitcnt vmcnt(8)
    s_barrier
    v_mfma_f32_16x16x32_bf16 v[108:111], a[4:7], v[120:123], 0
    v_add_u32 v4, 65536, v4
    v_add_u32 v25, 65536, v25
    ds_read_b128 v[120:123], v4 offset:0
    s_add_u32 s57, s58, s71
    v_mfma_f32_16x16x32_bf16 v[108:111], a[28:31], v[124:127], v[108:111]
    ds_read_b128 v[124:127], v25 offset:0
    buffer_load_dwordx4 v3, s[24:27], s57 offen offset:3072 sc1 lds
    v_mfma_f32_16x16x32_bf16 v[108:111], a[52:55], v[128:131], v[108:111]
    ds_read_b128 v[128:131], v4 offset:2048
    v_mov_b32 v29, v28
    v_mfma_f32_16x16x32_bf16 v[108:111], a[76:79], v[132:135], v[108:111]
    ds_read_b128 v[132:135], v25 offset:2048
    v_mfma_f32_16x16x32_bf16 v[108:111], a[100:103], v[136:139], v[108:111]
    ds_read_b128 v[136:139], v4 offset:4096
    v_permlane32_swap_b32 v28, v29
    v_mfma_f32_16x16x32_bf16 v[108:111], a[124:127], v[140:143], v[108:111]
    ds_read_b128 v[140:143], v25 offset:4096
    v_add_f32 v28, v28, v29
    v_mfma_f32_16x16x32_bf16 v[108:111], a[148:151], v[144:147], v[108:111]
    ds_read_b128 v[144:147], v4 offset:6144
    s_add_u32 s57, s73, 0
    v_mfma_f32_16x16x32_bf16 v[108:111], a[172:175], v[148:151], v[108:111]
    ds_read_b128 v[148:151], v25 offset:6144
    buffer_load_dword v22, v5, s[20:23], s57 offen
    v_mfma_f32_16x16x32_bf16 v[108:111], a[196:199], v[152:155], v[108:111]
    ds_read_b128 v[152:155], v4 offset:8192
    v_cvt_pk_bf16_f32 v68, v104, v105
    v_mfma_f32_16x16x32_bf16 v[108:111], a[220:223], v[156:159], v[108:111]
    ds_read_b128 v[156:159], v25 offset:8192
    v_cvt_pk_bf16_f32 v69, v106, v107
    v_mfma_f32_16x16x32_bf16 v[108:111], a[244:247], v[160:163], v[108:111]
    ds_read_b128 v[160:163], v4 offset:10240
    v_rcp_f32 v28, v28
    v_mfma_f32_16x16x32_bf16 v[108:111], v[188:191], v[164:167], v[108:111]
    ds_read_b128 v[164:167], v25 offset:10240
    v_mul_f32 v26, v26, v28
    v_mfma_f32_16x16x32_bf16 v[108:111], v[212:215], v[168:171], v[108:111]
    ds_read_b128 v[168:171], v4 offset:12288
    s_add_u32 s57, s73, 524288
    v_mfma_f32_16x16x32_bf16 v[108:111], v[236:239], v[172:175], v[108:111]
    ds_read_b128 v[172:175], v25 offset:12288
    buffer_load_dword v22, v5, s[20:23], s57 offen
    s_waitcnt lgkmcnt(11)
    v_mfma_f32_16x16x32_bf16 v[112:115], a[8:11], v[120:123], 0
    v_mul_f32 v27, v27, v28
    v_cvt_pk_bf16_f32 v26, v26, v26
    v_mfma_f32_16x16x32_bf16 v[112:115], a[32:35], v[124:127], v[112:115]
    v_cvt_pk_bf16_f32 v27, v27, v27
    v_and_b32 v80, v26, v14
    v_mfma_f32_16x16x32_bf16 v[112:115], a[56:59], v[128:131], v[112:115]
    v_and_b32 v81, v27, v15
    v_and_b32 v82, v26, v16
    s_waitcnt lgkmcnt(8)
    v_mfma_f32_16x16x32_bf16 v[112:115], a[80:83], v[132:135], v[112:115]
    v_and_b32 v83, v27, v17
    v_mfma_f32_16x16x32_bf16 v[112:115], a[104:107], v[136:139], v[112:115]
    v_mfma_f32_16x16x32_bf16 v[112:115], a[128:131], v[140:143], v[112:115]
    v_mfma_f32_16x16x32_bf16 v[72:75], v[34:37], v[80:83], 0
    s_waitcnt lgkmcnt(5)
    v_mfma_f32_16x16x32_bf16 v[112:115], a[152:155], v[144:147], v[112:115]
    v_cvt_pk_bf16_f32 v70, v108, v109
    v_cvt_pk_bf16_f32 v71, v110, v111
    v_mfma_f32_16x16x32_bf16 v[112:115], a[176:179], v[148:151], v[112:115]
    v_cndmask_b32 v70, v70, 0, s[82:83]
    v_cndmask_b32 v71, v71, 0, s[82:83]
    v_mfma_f32_16x16x32_bf16 v[112:115], a[200:203], v[152:155], v[112:115]
    v_mfma_f32_16x16x32_bf16 v[76:79], v[44:47], v[80:83], 0
    s_waitcnt lgkmcnt(2)
    v_mfma_f32_16x16x32_bf16 v[112:115], a[224:227], v[156:159], v[112:115]
    s_add_u32 s53, s74, 16384
    v_mfma_f32_16x16x32_bf16 v[112:115], a[248:251], v[160:163], v[112:115]
    v_mfma_f32_16x16x32_bf16 v[112:115], v[192:195], v[164:167], v[112:115]
    s_waitcnt lgkmcnt(0)
    v_mfma_f32_16x16x32_bf16 v[112:115], v[216:219], v[168:171], v[112:115]
    v_mfma_f32_16x16x32_bf16 v[112:115], v[240:243], v[172:175], v[112:115]
    v_mfma_f32_16x16x32_bf16 v[116:119], a[12:15], v[120:123], 0
    v_cvt_pk_bf16_f32 v84, v72, v73
    v_cvt_pk_bf16_f32 v85, v74, v75
    v_mfma_f32_16x16x32_bf16 v[116:119], a[36:39], v[124:127], v[116:119]
    v_cvt_pk_bf16_f32 v86, v76, v77
    v_cvt_pk_bf16_f32 v87, v78, v79
    v_mfma_f32_16x16x32_bf16 v[116:119], a[60:63], v[128:131], v[116:119]
    v_cndmask_b32 v86, v86, 0, s[82:83]
    v_cndmask_b32 v87, v87, 0, s[82:83]
    v_mfma_f32_16x16x32_bf16 v[116:119], a[84:87], v[132:135], v[116:119]
    buffer_store_dwordx4 v[84:87], v23, s[24:27], s53 offen sc1
    v_mfma_f32_16x16x32_bf16 v[116:119], a[108:111], v[136:139], v[116:119]
    v_mfma_f32_16x16x32_bf16 v[116:119], a[132:135], v[140:143], v[116:119]
    v_mfma_f32_16x16x32_bf16 v[72:75], v[60:63], v[68:71], 0
    v_mfma_f32_16x16x32_bf16 v[116:119], a[156:159], v[144:147], v[116:119]
    v_cvt_pk_bf16_f32 v56, v112, v113
    v_cvt_pk_bf16_f32 v57, v114, v115
    v_mfma_f32_16x16x32_bf16 v[116:119], a[180:183], v[148:151], v[116:119]
    v_mfma_f32_16x16x32_bf16 v[76:79], v[52:55], v[68:71], 0
    v_mfma_f32_16x16x32_bf16 v[116:119], a[204:207], v[152:155], v[116:119]
    v_mfma_f32_16x16x32_bf16 v[116:119], a[228:231], v[156:159], v[116:119]
    v_mfma_f32_16x16x32_bf16 v[116:119], a[252:255], v[160:163], v[116:119]
    v_mfma_f32_16x16x32_bf16 v[116:119], v[196:199], v[164:167], v[116:119]
    v_mfma_f32_16x16x32_bf16 v[116:119], v[220:223], v[168:171], v[116:119]
    v_cndmask_b32 v26, v72, v73, s[76:77]
    v_cndmask_b32 v27, v74, v75, s[76:77]
    v_mfma_f32_16x16x32_bf16 v[116:119], v[244:247], v[172:175], v[116:119]
    v_cndmask_b32 v28, v76, v77, s[76:77]
    v_cndmask_b32 v29, v78, v79, s[76:77]
    v_mfma_f32_16x16x32_bf16 v[96:99], v[120:123], a[16:19], 0
    v_cndmask_b32 v26, v26, v28, s[78:79]
    v_cndmask_b32 v27, v27, v29, s[80:81]
    v_mfma_f32_16x16x32_bf16 v[96:99], v[124:127], a[40:43], v[96:99]
    v_max_f32 v28, v26, v27
    v_mov_b32 v29, v28
    v_mfma_f32_16x16x32_bf16 v[96:99], v[128:131], a[64:67], v[96:99]
    v_mfma_f32_16x16x32_bf16 v[96:99], v[132:135], a[88:91], v[96:99]
    v_permlane16_swap_b32 v28, v29
    v_max_f32 v28, v28, v29
    v_mfma_f32_16x16x32_bf16 v[96:99], v[136:139], a[112:115], v[96:99]
    v_mov_b32 v29, v28
    v_mfma_f32_16x16x32_bf16 v[96:99], v[140:143], a[136:139], v[96:99]
    v_mfma_f32_16x16x32_bf16 v[96:99], v[144:147], a[160:163], v[96:99]
    v_cvt_pk_bf16_f32 v58, v116, v117
    v_cvt_pk_bf16_f32 v59, v118, v119
    v_mfma_f32_16x16x32_bf16 v[96:99], v[148:151], a[184:187], v[96:99]
    v_cndmask_b32 v58, v58, 0, s[82:83]
    v_cndmask_b32 v59, v59, 0, s[82:83]
    v_mfma_f32_16x16x32_bf16 v[96:99], v[152:155], a[208:211], v[96:99]
    v_permlane32_swap_b32 v28, v29
    v_max_f32 v28, v28, v29
    v_mfma_f32_16x16x32_bf16 v[96:99], v[156:159], a[232:235], v[96:99]
    v_sub_f32 v26, v26, v28
    v_sub_f32 v27, v27, v28
    v_mfma_f32_16x16x32_bf16 v[96:99], v[160:163], v[176:179], v[96:99]
    v_mul_f32 v26, s91, v26
    v_mul_f32 v27, s91, v27
    v_mfma_f32_16x16x32_bf16 v[96:99], v[164:167], v[200:203], v[96:99]
    v_exp_f32 v26, v26
    v_mfma_f32_16x16x32_bf16 v[96:99], v[168:171], v[224:227], v[96:99]
    v_exp_f32 v27, v27
    v_mfma_f32_16x16x32_bf16 v[96:99], v[172:175], v[248:251], v[96:99]
    v_add_f32 v28, v26, v27
    v_mov_b32 v29, v28
    v_mfma_f32_16x16x32_bf16 v[100:103], v[120:123], a[20:23], 0
    v_mfma_f32_16x16x32_bf16 v[100:103], v[124:127], a[44:47], v[100:103]
    v_permlane16_swap_b32 v28, v29
    v_add_f32 v28, v28, v29
    v_mfma_f32_16x16x32_bf16 v[100:103], v[128:131], a[68:71], v[100:103]
    v_mov_b32 v29, v28
    v_mfma_f32_16x16x32_bf16 v[100:103], v[132:135], a[92:95], v[100:103]
    v_mfma_f32_16x16x32_bf16 v[100:103], v[136:139], a[116:119], v[100:103]
    v_permlane32_swap_b32 v28, v29
    v_add_f32 v28, v28, v29
    v_mfma_f32_16x16x32_bf16 v[100:103], v[140:143], a[140:143], v[100:103]
    v_rcp_f32 v28, v28
    v_mfma_f32_16x16x32_bf16 v[100:103], v[144:147], a[164:167], v[100:103]
    v_cvt_pk_bf16_f32 v40, v96, v97
    v_cvt_pk_bf16_f32 v41, v98, v99
    v_mfma_f32_16x16x32_bf16 v[100:103], v[148:151], a[188:191], v[100:103]
    v_cvt_pk_bf16_f32 v32, v96, v97
    v_cvt_pk_bf16_f32 v33, v98, v99
    v_mfma_f32_16x16x32_bf16 v[100:103], v[152:155], a[212:215], v[100:103]
    v_mul_f32 v26, v26, v28
    v_mul_f32 v27, v27, v28
    v_mfma_f32_16x16x32_bf16 v[100:103], v[156:159], a[236:239], v[100:103]
    v_cvt_pk_bf16_f32 v26, v26, v26
    v_cvt_pk_bf16_f32 v27, v27, v27
    v_mfma_f32_16x16x32_bf16 v[100:103], v[160:163], v[180:183], v[100:103]
    v_and_b32 v80, v26, v14
    v_and_b32 v81, v27, v15
    v_mfma_f32_16x16x32_bf16 v[100:103], v[164:167], v[204:207], v[100:103]
    v_and_b32 v82, v26, v16
    v_and_b32 v83, v27, v17
    v_mfma_f32_16x16x32_bf16 v[100:103], v[168:171], v[228:231], v[100:103]
    v_mfma_f32_16x16x32_bf16 v[100:103], v[172:175], v[252:255], v[100:103]
    v_mfma_f32_16x16x32_bf16 v[72:75], v[36:39], v[80:83], 0
    v_mfma_f32_16x16x32_bf16 v[104:107], a[0:3], v[120:123], 0
    v_mfma_f32_16x16x32_bf16 v[76:79], v[46:49], v[80:83], 0
    v_mfma_f32_16x16x32_bf16 v[104:107], a[24:27], v[124:127], v[104:107]
    s_add_u32 s53, s74, 32768
    v_mfma_f32_16x16x32_bf16 v[104:107], a[48:51], v[128:131], v[104:107]
    v_mfma_f32_16x16x32_bf16 v[104:107], a[72:75], v[132:135], v[104:107]
    v_mfma_f32_16x16x32_bf16 v[104:107], a[96:99], v[136:139], v[104:107]
    v_mfma_f32_16x16x32_bf16 v[104:107], a[120:123], v[140:143], v[104:107]
    v_mfma_f32_16x16x32_bf16 v[104:107], a[144:147], v[144:147], v[104:107]
    v_cvt_pk_bf16_f32 v50, v100, v101
    v_cvt_pk_bf16_f32 v51, v102, v103
    v_mfma_f32_16x16x32_bf16 v[104:107], a[168:171], v[148:151], v[104:107]
    v_cvt_pk_bf16_f32 v42, v100, v101
    v_cvt_pk_bf16_f32 v43, v102, v103
    v_mfma_f32_16x16x32_bf16 v[104:107], a[192:195], v[152:155], v[104:107]
    v_cvt_pk_bf16_f32 v84, v72, v73
    v_cvt_pk_bf16_f32 v85, v74, v75
    v_mfma_f32_16x16x32_bf16 v[104:107], a[216:219], v[156:159], v[104:107]
    v_cvt_pk_bf16_f32 v86, v76, v77
    v_cvt_pk_bf16_f32 v87, v78, v79
    v_mfma_f32_16x16x32_bf16 v[104:107], a[240:243], v[160:163], v[104:107]
    v_cndmask_b32 v86, v86, 0, s[82:83]
    v_cndmask_b32 v87, v87, 0, s[82:83]
    v_mfma_f32_16x16x32_bf16 v[104:107], v[184:187], v[164:167], v[104:107]
    buffer_store_dwordx4 v[84:87], v23, s[24:27], s53 offen sc1
    v_mfma_f32_16x16x32_bf16 v[104:107], v[208:211], v[168:171], v[104:107]
    v_mfma_f32_16x16x32_bf16 v[104:107], v[232:235], v[172:175], v[104:107]
    v_mfma_f32_16x16x32_bf16 v[108:111], a[4:7], v[120:123], 0
    ds_read_b128 v[120:123], v4 offset:16384
    v_mfma_f32_16x16x32_bf16 v[108:111], a[28:31], v[124:127], v[108:111]
    ds_read_b128 v[124:127], v25 offset:16384
    v_mfma_f32_16x16x32_bf16 v[108:111], a[52:55], v[128:131], v[108:111]
    ds_read_b128 v[128:131], v4 offset:18432
    v_mfma_f32_16x16x32_bf16 v[108:111], a[76:79], v[132:135], v[108:111]
    ds_read_b128 v[132:135], v25 offset:18432
    v_mfma_f32_16x16x32_bf16 v[108:111], a[100:103], v[136:139], v[108:111]
    ds_read_b128 v[136:139], v4 offset:20480
    v_mfma_f32_16x16x32_bf16 v[108:111], a[124:127], v[140:143], v[108:111]
    ds_read_b128 v[140:143], v25 offset:20480
    v_mfma_f32_16x16x32_bf16 v[108:111], a[148:151], v[144:147], v[108:111]
    ds_read_b128 v[144:147], v4 offset:22528
    v_cvt_pk_bf16_f32 v64, v104, v105
    v_mfma_f32_16x16x32_bf16 v[108:111], a[172:175], v[148:151], v[108:111]
    ds_read_b128 v[148:151], v25 offset:22528
    v_cvt_pk_bf16_f32 v65, v106, v107
    v_mfma_f32_16x16x32_bf16 v[108:111], a[196:199], v[152:155], v[108:111]
    ds_read_b128 v[152:155], v4 offset:24576
    v_mfma_f32_16x16x32_bf16 v[108:111], a[220:223], v[156:159], v[108:111]
    ds_read_b128 v[156:159], v25 offset:24576
    v_mfma_f32_16x16x32_bf16 v[108:111], a[244:247], v[160:163], v[108:111]
    ds_read_b128 v[160:163], v4 offset:26624
    v_mfma_f32_16x16x32_bf16 v[108:111], v[188:191], v[164:167], v[108:111]
    ds_read_b128 v[164:167], v25 offset:26624
    v_mfma_f32_16x16x32_bf16 v[108:111], v[212:215], v[168:171], v[108:111]
    ds_read_b128 v[168:171], v4 offset:28672
    v_mfma_f32_16x16x32_bf16 v[108:111], v[236:239], v[172:175], v[108:111]
    ds_read_b128 v[172:175], v25 offset:28672
    s_waitcnt lgkmcnt(11)
    v_mfma_f32_16x16x32_bf16 v[112:115], a[8:11], v[120:123], 0
    v_mfma_f32_16x16x32_bf16 v[112:115], a[32:35], v[124:127], v[112:115]
    v_mfma_f32_16x16x32_bf16 v[112:115], a[56:59], v[128:131], v[112:115]
    s_waitcnt lgkmcnt(8)
    v_mfma_f32_16x16x32_bf16 v[112:115], a[80:83], v[132:135], v[112:115]
    v_mfma_f32_16x16x32_bf16 v[112:115], a[104:107], v[136:139], v[112:115]
    v_mfma_f32_16x16x32_bf16 v[112:115], a[128:131], v[140:143], v[112:115]
    s_waitcnt lgkmcnt(5)
    v_mfma_f32_16x16x32_bf16 v[112:115], a[152:155], v[144:147], v[112:115]
    v_cvt_pk_bf16_f32 v66, v108, v109
    v_cvt_pk_bf16_f32 v67, v110, v111
    v_mfma_f32_16x16x32_bf16 v[112:115], a[176:179], v[148:151], v[112:115]
    v_cndmask_b32 v66, v66, 0, s[82:83]
    v_cndmask_b32 v67, v67, 0, s[82:83]
    v_mfma_f32_16x16x32_bf16 v[112:115], a[200:203], v[152:155], v[112:115]
    s_waitcnt lgkmcnt(2)
    v_mfma_f32_16x16x32_bf16 v[112:115], a[224:227], v[156:159], v[112:115]
    v_mfma_f32_16x16x32_bf16 v[72:75], v[52:55], v[64:67], 0
    v_mfma_f32_16x16x32_bf16 v[112:115], a[248:251], v[160:163], v[112:115]
    v_mfma_f32_16x16x32_bf16 v[76:79], v[56:59], v[64:67], 0
    v_mfma_f32_16x16x32_bf16 v[112:115], v[192:195], v[164:167], v[112:115]
    s_waitcnt lgkmcnt(0)
    v_mfma_f32_16x16x32_bf16 v[112:115], v[216:219], v[168:171], v[112:115]
    v_mfma_f32_16x16x32_bf16 v[112:115], v[240:243], v[172:175], v[112:115]
    v_mfma_f32_16x16x32_bf16 v[116:119], a[12:15], v[120:123], 0
    v_mfma_f32_16x16x32_bf16 v[116:119], a[36:39], v[124:127], v[116:119]
    v_cndmask_b32 v26, v72, v73, s[76:77]
    v_cndmask_b32 v27, v74, v75, s[76:77]
    v_mfma_f32_16x16x32_bf16 v[116:119], a[60:63], v[128:131], v[116:119]
    v_cndmask_b32 v28, v76, v77, s[76:77]
    v_cndmask_b32 v29, v78, v79, s[76:77]
    v_mfma_f32_16x16x32_bf16 v[116:119], a[84:87], v[132:135], v[116:119]
    v_cndmask_b32 v26, v26, v28, s[78:79]
    v_cndmask_b32 v27, v27, v29, s[80:81]
    v_mfma_f32_16x16x32_bf16 v[116:119], a[108:111], v[136:139], v[116:119]
    v_max_f32 v28, v26, v27
    v_mov_b32 v29, v28
    v_mfma_f32_16x16x32_bf16 v[116:119], a[132:135], v[140:143], v[116:119]
    v_mfma_f32_16x16x32_bf16 v[116:119], a[156:159], v[144:147], v[116:119]
    v_cvt_pk_bf16_f32 v60, v112, v113
    v_cvt_pk_bf16_f32 v61, v114, v115
    v_mfma_f32_16x16x32_bf16 v[116:119], a[180:183], v[148:151], v[116:119]
    v_permlane16_swap_b32 v28, v29
    v_max_f32 v28, v28, v29
    v_mfma_f32_16x16x32_bf16 v[116:119], a[204:207], v[152:155], v[116:119]
    v_mov_b32 v29, v28
    v_mfma_f32_16x16x32_bf16 v[116:119], a[228:231], v[156:159], v[116:119]
    v_mfma_f32_16x16x32_bf16 v[116:119], a[252:255], v[160:163], v[116:119]
    v_permlane32_swap_b32 v28, v29
    v_max_f32 v28, v28, v29
    v_mfma_f32_16x16x32_bf16 v[116:119], v[196:199], v[164:167], v[116:119]
    v_sub_f32 v26, v26, v28
    v_sub_f32 v27, v27, v28
    v_mfma_f32_16x16x32_bf16 v[116:119], v[220:223], v[168:171], v[116:119]
    v_mul_f32 v26, s91, v26
    v_mul_f32 v27, s91, v27
    v_mfma_f32_16x16x32_bf16 v[116:119], v[244:247], v[172:175], v[116:119]
    v_exp_f32 v26, v26
    v_mfma_f32_16x16x32_bf16 v[96:99], v[120:123], a[16:19], 0
    v_exp_f32 v27, v27
    v_mfma_f32_16x16x32_bf16 v[96:99], v[124:127], a[40:43], v[96:99]
    v_add_f32 v28, v26, v27
    v_mov_b32 v29, v28
    v_mfma_f32_16x16x32_bf16 v[96:99], v[128:131], a[64:67], v[96:99]
    v_mfma_f32_16x16x32_bf16 v[96:99], v[132:135], a[88:91], v[96:99]
    v_permlane16_swap_b32 v28, v29
    v_add_f32 v28, v28, v29
    v_mfma_f32_16x16x32_bf16 v[96:99], v[136:139], a[112:115], v[96:99]
    v_mov_b32 v29, v28
    v_mfma_f32_16x16x32_bf16 v[96:99], v[140:143], a[136:139], v[96:99]
    v_mfma_f32_16x16x32_bf16 v[96:99], v[144:147], a[160:163], v[96:99]
    v_cvt_pk_bf16_f32 v62, v116, v117
    v_cvt_pk_bf16_f32 v63, v118, v119
    v_mfma_f32_16x16x32_bf16 v[96:99], v[148:151], a[184:187], v[96:99]
    v_cndmask_b32 v62, v62, 0, s[82:83]
    v_cndmask_b32 v63, v63, 0, s[82:83]
    v_mfma_f32_16x16x32_bf16 v[96:99], v[152:155], a[208:211], v[96:99]
    v_permlane32_swap_b32 v28, v29
    v_add_f32 v28, v28, v29
    v_mfma_f32_16x16x32_bf16 v[96:99], v[156:159], a[232:235], v[96:99]
    v_rcp_f32 v28, v28
    v_mfma_f32_16x16x32_bf16 v[96:99], v[160:163], v[176:179], v[96:99]
    v_mul_f32 v26, v26, v28
    v_mul_f32 v27, v27, v28
    v_mfma_f32_16x16x32_bf16 v[96:99], v[164:167], v[200:203], v[96:99]
    v_cvt_pk_bf16_f32 v26, v26, v26
    v_cvt_pk_bf16_f32 v27, v27, v27
    v_mfma_f32_16x16x32_bf16 v[96:99], v[168:171], v[224:227], v[96:99]
    v_and_b32 v80, v26, v14
    v_and_b32 v81, v27, v15
    v_mfma_f32_16x16x32_bf16 v[96:99], v[172:175], v[248:251], v[96:99]
    v_and_b32 v82, v26, v16
    v_and_b32 v83, v27, v17
    v_mfma_f32_16x16x32_bf16 v[100:103], v[120:123], a[20:23], 0
    v_mfma_f32_16x16x32_bf16 v[100:103], v[124:127], a[44:47], v[100:103]
    v_mfma_f32_16x16x32_bf16 v[72:75], v[38:41], v[80:83], 0
    v_mfma_f32_16x16x32_bf16 v[100:103], v[128:131], a[68:71], v[100:103]
    v_mfma_f32_16x16x32_bf16 v[76:79], v[48:51], v[80:83], 0
    v_mfma_f32_16x16x32_bf16 v[100:103], v[132:135], a[92:95], v[100:103]
    s_add_u32 s53, s74, 49152
    v_mfma_f32_16x16x32_bf16 v[100:103], v[136:139], a[116:119], v[100:103]
    v_mfma_f32_16x16x32_bf16 v[100:103], v[140:143], a[140:143], v[100:103]
    v_mfma_f32_16x16x32_bf16 v[100:103], v[144:147], a[164:167], v[100:103]
    v_cvt_pk_bf16_f32 v34, v96, v97
    v_cvt_pk_bf16_f32 v35, v98, v99
    v_mfma_f32_16x16x32_bf16 v[100:103], v[148:151], a[188:191], v[100:103]
    v_mfma_f32_16x16x32_bf16 v[100:103], v[152:155], a[212:215], v[100:103]
    v_cvt_pk_bf16_f32 v84, v72, v73
    v_cvt_pk_bf16_f32 v85, v74, v75
    v_mfma_f32_16x16x32_bf16 v[100:103], v[156:159], a[236:239], v[100:103]
    v_cvt_pk_bf16_f32 v86, v76, v77
    v_cvt_pk_bf16_f32 v87, v78, v79
    v_mfma_f32_16x16x32_bf16 v[100:103], v[160:163], v[180:183], v[100:103]
    v_cndmask_b32 v86, v86, 0, s[82:83]
    v_cndmask_b32 v87, v87, 0, s[82:83]
    v_mfma_f32_16x16x32_bf16 v[100:103], v[164:167], v[204:207], v[100:103]
    buffer_store_dwordx4 v[84:87], v23, s[24:27], s53 offen sc1
    v_mfma_f32_16x16x32_bf16 v[100:103], v[168:171], v[228:231], v[100:103]
    v_mfma_f32_16x16x32_bf16 v[100:103], v[172:175], v[252:255], v[100:103]
    v_mfma_f32_16x16x32_bf16 v[104:107], a[0:3], v[120:123], 0
    v_mfma_f32_16x16x32_bf16 v[104:107], a[24:27], v[124:127], v[104:107]
    v_mfma_f32_16x16x32_bf16 v[104:107], a[48:51], v[128:131], v[104:107]
    v_mfma_f32_16x16x32_bf16 v[104:107], a[72:75], v[132:135], v[104:107]
    v_mfma_f32_16x16x32_bf16 v[104:107], a[96:99], v[136:139], v[104:107]
    v_mfma_f32_16x16x32_bf16 v[104:107], a[120:123], v[140:143], v[104:107]
    v_mfma_f32_16x16x32_bf16 v[104:107], a[144:147], v[144:147], v[104:107]
    s_nop 0
    v_cvt_pk_bf16_f32 v44, v100, v101
    v_cvt_pk_bf16_f32 v45, v102, v103
    v_mfma_f32_16x16x32_bf16 v[104:107], a[168:171], v[148:151], v[104:107]
    v_mfma_f32_16x16x32_bf16 v[104:107], a[192:195], v[152:155], v[104:107]
    v_mfma_f32_16x16x32_bf16 v[104:107], a[216:219], v[156:159], v[104:107]
    v_mfma_f32_16x16x32_bf16 v[104:107], a[240:243], v[160:163], v[104:107]
    v_mfma_f32_16x16x32_bf16 v[104:107], v[184:187], v[164:167], v[104:107]
    v_mfma_f32_16x16x32_bf16 v[104:107], v[208:211], v[168:171], v[104:107]
    v_mfma_f32_16x16x32_bf16 v[104:107], v[232:235], v[172:175], v[104:107]
    v_mfma_f32_16x16x32_bf16 v[108:111], a[4:7], v[120:123], 0
    ds_read_b128 v[120:123], v4 offset:32768
    v_mfma_f32_16x16x32_bf16 v[108:111], a[28:31], v[124:127], v[108:111]
    ds_read_b128 v[124:127], v25 offset:32768
    v_mfma_f32_16x16x32_bf16 v[108:111], a[52:55], v[128:131], v[108:111]
    ds_read_b128 v[128:131], v4 offset:34816
    v_mfma_f32_16x16x32_bf16 v[108:111], a[76:79], v[132:135], v[108:111]
    ds_read_b128 v[132:135], v25 offset:34816
    v_mfma_f32_16x16x32_bf16 v[108:111], a[100:103], v[136:139], v[108:111]
    ds_read_b128 v[136:139], v4 offset:36864
    v_mfma_f32_16x16x32_bf16 v[108:111], a[124:127], v[140:143], v[108:111]
    ds_read_b128 v[140:143], v25 offset:36864
    v_mfma_f32_16x16x32_bf16 v[108:111], a[148:151], v[144:147], v[108:111]
    ds_read_b128 v[144:147], v4 offset:38912
    v_cvt_pk_bf16_f32 v68, v104, v105
    v_mfma_f32_16x16x32_bf16 v[108:111], a[172:175], v[148:151], v[108:111]
    ds_read_b128 v[148:151], v25 offset:38912
    v_cvt_pk_bf16_f32 v69, v106, v107
    v_mfma_f32_16x16x32_bf16 v[108:111], a[196:199], v[152:155], v[108:111]
    ds_read_b128 v[152:155], v4 offset:40960
    v_mfma_f32_16x16x32_bf16 v[108:111], a[220:223], v[156:159], v[108:111]
    ds_read_b128 v[156:159], v25 offset:40960
    v_mfma_f32_16x16x32_bf16 v[108:111], a[244:247], v[160:163], v[108:111]
    ds_read_b128 v[160:163], v4 offset:43008
    v_mfma_f32_16x16x32_bf16 v[108:111], v[188:191], v[164:167], v[108:111]
    ds_read_b128 v[164:167], v25 offset:43008
    v_mfma_f32_16x16x32_bf16 v[108:111], v[212:215], v[168:171], v[108:111]
    ds_read_b128 v[168:171], v4 offset:45056
    v_mfma_f32_16x16x32_bf16 v[108:111], v[236:239], v[172:175], v[108:111]
    ds_read_b128 v[172:175], v25 offset:45056
    s_waitcnt lgkmcnt(11)
    v_mfma_f32_16x16x32_bf16 v[112:115], a[8:11], v[120:123], 0
    v_mfma_f32_16x16x32_bf16 v[112:115], a[32:35], v[124:127], v[112:115]
    v_mfma_f32_16x16x32_bf16 v[112:115], a[56:59], v[128:131], v[112:115]
    s_waitcnt lgkmcnt(8)
    v_mfma_f32_16x16x32_bf16 v[112:115], a[80:83], v[132:135], v[112:115]
    v_mfma_f32_16x16x32_bf16 v[112:115], a[104:107], v[136:139], v[112:115]
    v_mfma_f32_16x16x32_bf16 v[112:115], a[128:131], v[140:143], v[112:115]
    s_waitcnt lgkmcnt(5)
    v_mfma_f32_16x16x32_bf16 v[112:115], a[152:155], v[144:147], v[112:115]
    v_cvt_pk_bf16_f32 v70, v108, v109
    v_cvt_pk_bf16_f32 v71, v110, v111
    v_mfma_f32_16x16x32_bf16 v[112:115], a[176:179], v[148:151], v[112:115]
    v_cndmask_b32 v70, v70, 0, s[82:83]
    v_cndmask_b32 v71, v71, 0, s[82:83]
    v_mfma_f32_16x16x32_bf16 v[112:115], a[200:203], v[152:155], v[112:115]
    s_waitcnt lgkmcnt(2)
    v_mfma_f32_16x16x32_bf16 v[112:115], a[224:227], v[156:159], v[112:115]
    v_mfma_f32_16x16x32_bf16 v[72:75], v[56:59], v[68:71], 0
    v_mfma_f32_16x16x32_bf16 v[112:115], a[248:251], v[160:163], v[112:115]
    v_mfma_f32_16x16x32_bf16 v[76:79], v[60:63], v[68:71], 0
    v_mfma_f32_16x16x32_bf16 v[112:115], v[192:195], v[164:167], v[112:115]
    s_waitcnt lgkmcnt(0)
    v_mfma_f32_16x16x32_bf16 v[112:115], v[216:219], v[168:171], v[112:115]
    v_mfma_f32_16x16x32_bf16 v[112:115], v[240:243], v[172:175], v[112:115]
    v_mfma_f32_16x16x32_bf16 v[116:119], a[12:15], v[120:123], 0
    v_mfma_f32_16x16x32_bf16 v[116:119], a[36:39], v[124:127], v[116:119]
    v_cndmask_b32 v26, v72, v73, s[76:77]
    v_cndmask_b32 v27, v74, v75, s[76:77]
    v_mfma_f32_16x16x32_bf16 v[116:119], a[60:63], v[128:131], v[116:119]
    v_cndmask_b32 v28, v76, v77, s[76:77]
    v_cndmask_b32 v29, v78, v79, s[76:77]
    v_mfma_f32_16x16x32_bf16 v[116:119], a[84:87], v[132:135], v[116:119]
    v_cndmask_b32 v26, v26, v28, s[78:79]
    v_cndmask_b32 v27, v27, v29, s[80:81]
    v_mfma_f32_16x16x32_bf16 v[116:119], a[108:111], v[136:139], v[116:119]
    v_max_f32 v28, v26, v27
    v_mov_b32 v29, v28
    v_mfma_f32_16x16x32_bf16 v[116:119], a[132:135], v[140:143], v[116:119]
    v_mfma_f32_16x16x32_bf16 v[116:119], a[156:159], v[144:147], v[116:119]
    v_cvt_pk_bf16_f32 v52, v112, v113
    v_cvt_pk_bf16_f32 v53, v114, v115
    v_mfma_f32_16x16x32_bf16 v[116:119], a[180:183], v[148:151], v[116:119]
    v_permlane16_swap_b32 v28, v29
    v_max_f32 v28, v28, v29
    v_mfma_f32_16x16x32_bf16 v[116:119], a[204:207], v[152:155], v[116:119]
    v_mov_b32 v29, v28
    v_mfma_f32_16x16x32_bf16 v[116:119], a[228:231], v[156:159], v[116:119]
    v_mfma_f32_16x16x32_bf16 v[116:119], a[252:255], v[160:163], v[116:119]
    v_permlane32_swap_b32 v28, v29
    v_max_f32 v28, v28, v29
    v_mfma_f32_16x16x32_bf16 v[116:119], v[196:199], v[164:167], v[116:119]
    v_sub_f32 v26, v26, v28
    v_sub_f32 v27, v27, v28
    v_mfma_f32_16x16x32_bf16 v[116:119], v[220:223], v[168:171], v[116:119]
    v_mul_f32 v26, s91, v26
    v_mul_f32 v27, s91, v27
    v_mfma_f32_16x16x32_bf16 v[116:119], v[244:247], v[172:175], v[116:119]
    v_exp_f32 v26, v26
    v_mfma_f32_16x16x32_bf16 v[96:99], v[120:123], a[16:19], 0
    v_exp_f32 v27, v27
    v_mfma_f32_16x16x32_bf16 v[96:99], v[124:127], a[40:43], v[96:99]
    v_add_f32 v28, v26, v27
    v_mov_b32 v29, v28
    v_mfma_f32_16x16x32_bf16 v[96:99], v[128:131], a[64:67], v[96:99]
    v_mfma_f32_16x16x32_bf16 v[96:99], v[132:135], a[88:91], v[96:99]
    v_permlane16_swap_b32 v28, v29
    v_add_f32 v28, v28, v29
    v_mfma_f32_16x16x32_bf16 v[96:99], v[136:139], a[112:115], v[96:99]
    v_mov_b32 v29, v28
    v_mfma_f32_16x16x32_bf16 v[96:99], v[140:143], a[136:139], v[96:99]
    v_mfma_f32_16x16x32_bf16 v[96:99], v[144:147], a[160:163], v[96:99]
    v_cvt_pk_bf16_f32 v54, v116, v117
    v_cvt_pk_bf16_f32 v55, v118, v119
    v_mfma_f32_16x16x32_bf16 v[96:99], v[148:151], a[184:187], v[96:99]
    v_cndmask_b32 v54, v54, 0, s[82:83]
    v_cndmask_b32 v55, v55, 0, s[82:83]
    v_mfma_f32_16x16x32_bf16 v[96:99], v[152:155], a[208:211], v[96:99]
    v_permlane32_swap_b32 v28, v29
    v_add_f32 v28, v28, v29
    v_mfma_f32_16x16x32_bf16 v[96:99], v[156:159], a[232:235], v[96:99]
    v_rcp_f32 v28, v28
    v_mfma_f32_16x16x32_bf16 v[96:99], v[160:163], v[176:179], v[96:99]
    v_mul_f32 v26, v26, v28
    v_mul_f32 v27, v27, v28
    v_mfma_f32_16x16x32_bf16 v[96:99], v[164:167], v[200:203], v[96:99]
    v_cvt_pk_bf16_f32 v26, v26, v26
    v_cvt_pk_bf16_f32 v27, v27, v27
    v_mfma_f32_16x16x32_bf16 v[96:99], v[168:171], v[224:227], v[96:99]
    v_and_b32 v80, v26, v14
    v_and_b32 v81, v27, v15
    v_mfma_f32_16x16x32_bf16 v[96:99], v[172:175], v[248:251], v[96:99]
    v_and_b32 v82, v26, v16
    v_and_b32 v83, v27, v17
    v_mfma_f32_16x16x32_bf16 v[100:103], v[120:123], a[20:23], 0
    v_mfma_f32_16x16x32_bf16 v[100:103], v[124:127], a[44:47], v[100:103]
    v_mfma_f32_16x16x32_bf16 v[72:75], v[32:35], v[80:83], 0
    v_mfma_f32_16x16x32_bf16 v[100:103], v[128:131], a[68:71], v[100:103]
    v_mfma_f32_16x16x32_bf16 v[76:79], v[42:45], v[80:83], 0
    v_mfma_f32_16x16x32_bf16 v[100:103], v[132:135], a[92:95], v[100:103]
    s_add_u32 s53, s74, 65536
    v_mfma_f32_16x16x32_bf16 v[100:103], v[136:139], a[116:119], v[100:103]
    v_mfma_f32_16x16x32_bf16 v[100:103], v[140:143], a[140:143], v[100:103]
    v_mfma_f32_16x16x32_bf16 v[100:103], v[144:147], a[164:167], v[100:103]
    v_cvt_pk_bf16_f32 v36, v96, v97
    v_cvt_pk_bf16_f32 v37, v98, v99
    v_mfma_f32_16x16x32_bf16 v[100:103], v[148:151], a[188:191], v[100:103]
    v_mfma_f32_16x16x32_bf16 v[100:103], v[152:155], a[212:215], v[100:103]
    v_cvt_pk_bf16_f32 v84, v72, v73
    v_cvt_pk_bf16_f32 v85, v74, v75
    v_mfma_f32_16x16x32_bf16 v[100:103], v[156:159], a[236:239], v[100:103]
    v_cvt_pk_bf16_f32 v86, v76, v77
    v_cvt_pk_bf16_f32 v87, v78, v79
    v_mfma_f32_16x16x32_bf16 v[100:103], v[160:163], v[180:183], v[100:103]
    v_cndmask_b32 v86, v86, 0, s[82:83]
    v_cndmask_b32 v87, v87, 0, s[82:83]
    v_mfma_f32_16x16x32_bf16 v[100:103], v[164:167], v[204:207], v[100:103]
    buffer_store_dwordx4 v[84:87], v23, s[24:27], s53 offen sc1
    v_mfma_f32_16x16x32_bf16 v[100:103], v[168:171], v[228:231], v[100:103]
    v_mfma_f32_16x16x32_bf16 v[100:103], v[172:175], v[252:255], v[100:103]
    v_mfma_f32_16x16x32_bf16 v[104:107], a[0:3], v[120:123], 0
    v_mfma_f32_16x16x32_bf16 v[104:107], a[24:27], v[124:127], v[104:107]
    v_mfma_f32_16x16x32_bf16 v[104:107], a[48:51], v[128:131], v[104:107]
    v_mfma_f32_16x16x32_bf16 v[104:107], a[72:75], v[132:135], v[104:107]
    v_mfma_f32_16x16x32_bf16 v[104:107], a[96:99], v[136:139], v[104:107]
    v_mfma_f32_16x16x32_bf16 v[104:107], a[120:123], v[140:143], v[104:107]
    v_mfma_f32_16x16x32_bf16 v[104:107], a[144:147], v[144:147], v[104:107]
    s_nop 0
    v_cvt_pk_bf16_f32 v46, v100, v101
    v_cvt_pk_bf16_f32 v47, v102, v103
    v_mfma_f32_16x16x32_bf16 v[104:107], a[168:171], v[148:151], v[104:107]
    v_mfma_f32_16x16x32_bf16 v[104:107], a[192:195], v[152:155], v[104:107]
    v_mfma_f32_16x16x32_bf16 v[104:107], a[216:219], v[156:159], v[104:107]
    v_mfma_f32_16x16x32_bf16 v[104:107], a[240:243], v[160:163], v[104:107]
    v_mfma_f32_16x16x32_bf16 v[104:107], v[184:187], v[164:167], v[104:107]
    v_mfma_f32_16x16x32_bf16 v[104:107], v[208:211], v[168:171], v[104:107]
    v_mfma_f32_16x16x32_bf16 v[104:107], v[232:235], v[172:175], v[104:107]
    s_waitcnt vmcnt(6)
    s_barrier
    v_mfma_f32_16x16x32_bf16 v[108:111], a[4:7], v[120:123], 0
    ds_read_b128 v[120:123], v4 offset:49152
    v_mfma_f32_16x16x32_bf16 v[108:111], a[28:31], v[124:127], v[108:111]
    ds_read_b128 v[124:127], v25 offset:49152
    v_mfma_f32_16x16x32_bf16 v[108:111], a[52:55], v[128:131], v[108:111]
    ds_read_b128 v[128:131], v4 offset:51200
    v_mfma_f32_16x16x32_bf16 v[108:111], a[76:79], v[132:135], v[108:111]
    ds_read_b128 v[132:135], v25 offset:51200
    v_mfma_f32_16x16x32_bf16 v[108:111], a[100:103], v[136:139], v[108:111]
    ds_read_b128 v[136:139], v4 offset:53248
    v_mfma_f32_16x16x32_bf16 v[108:111], a[124:127], v[140:143], v[108:111]
    ds_read_b128 v[140:143], v25 offset:53248
    v_mfma_f32_16x16x32_bf16 v[108:111], a[148:151], v[144:147], v[108:111]
    ds_read_b128 v[144:147], v4 offset:55296
    v_cvt_pk_bf16_f32 v64, v104, v105
    v_mfma_f32_16x16x32_bf16 v[108:111], a[172:175], v[148:151], v[108:111]
    ds_read_b128 v[148:151], v25 offset:55296
    v_cvt_pk_bf16_f32 v65, v106, v107
    v_mfma_f32_16x16x32_bf16 v[108:111], a[196:199], v[152:155], v[108:111]
    ds_read_b128 v[152:155], v4 offset:57344
    v_mfma_f32_16x16x32_bf16 v[108:111], a[220:223], v[156:159], v[108:111]
    ds_read_b128 v[156:159], v25 offset:57344
    v_mfma_f32_16x16x32_bf16 v[108:111], a[244:247], v[160:163], v[108:111]
    ds_read_b128 v[160:163], v4 offset:59392
    v_mfma_f32_16x16x32_bf16 v[108:111], v[188:191], v[164:167], v[108:111]
    ds_read_b128 v[164:167], v25 offset:59392
    v_mfma_f32_16x16x32_bf16 v[108:111], v[212:215], v[168:171], v[108:111]
    ds_read_b128 v[168:171], v4 offset:61440
    v_mfma_f32_16x16x32_bf16 v[108:111], v[236:239], v[172:175], v[108:111]
    ds_read_b128 v[172:175], v25 offset:61440
    s_waitcnt lgkmcnt(11)
    v_mfma_f32_16x16x32_bf16 v[112:115], a[8:11], v[120:123], 0
    v_mfma_f32_16x16x32_bf16 v[112:115], a[32:35], v[124:127], v[112:115]
    v_mfma_f32_16x16x32_bf16 v[112:115], a[56:59], v[128:131], v[112:115]
    s_waitcnt lgkmcnt(8)
    v_mfma_f32_16x16x32_bf16 v[112:115], a[80:83], v[132:135], v[112:115]
    v_mfma_f32_16x16x32_bf16 v[112:115], a[104:107], v[136:139], v[112:115]
    v_mfma_f32_16x16x32_bf16 v[112:115], a[128:131], v[140:143], v[112:115]
    s_waitcnt lgkmcnt(5)
    v_mfma_f32_16x16x32_bf16 v[112:115], a[152:155], v[144:147], v[112:115]
    v_cvt_pk_bf16_f32 v66, v108, v109
    v_cvt_pk_bf16_f32 v67, v110, v111
    v_mfma_f32_16x16x32_bf16 v[112:115], a[176:179], v[148:151], v[112:115]
    v_cndmask_b32 v66, v66, 0, s[82:83]
    v_cndmask_b32 v67, v67, 0, s[82:83]
    v_mfma_f32_16x16x32_bf16 v[112:115], a[200:203], v[152:155], v[112:115]
    s_waitcnt lgkmcnt(2)
    v_mfma_f32_16x16x32_bf16 v[112:115], a[224:227], v[156:159], v[112:115]
    v_mfma_f32_16x16x32_bf16 v[72:75], v[60:63], v[64:67], 0
    v_mfma_f32_16x16x32_bf16 v[112:115], a[248:251], v[160:163], v[112:115]
    v_mfma_f32_16x16x32_bf16 v[76:79], v[52:55], v[64:67], 0
    v_mfma_f32_16x16x32_bf16 v[112:115], v[192:195], v[164:167], v[112:115]
    s_waitcnt lgkmcnt(0)
    v_mfma_f32_16x16x32_bf16 v[112:115], v[216:219], v[168:171], v[112:115]
    v_mfma_f32_16x16x32_bf16 v[112:115], v[240:243], v[172:175], v[112:115]
    v_mfma_f32_16x16x32_bf16 v[116:119], a[12:15], v[120:123], 0
    v_mfma_f32_16x16x32_bf16 v[116:119], a[36:39], v[124:127], v[116:119]
    v_cndmask_b32 v26, v72, v73, s[76:77]
    v_cndmask_b32 v27, v74, v75, s[76:77]
    v_mfma_f32_16x16x32_bf16 v[116:119], a[60:63], v[128:131], v[116:119]
    v_cndmask_b32 v28, v76, v77, s[76:77]
    v_cndmask_b32 v29, v78, v79, s[76:77]
    v_mfma_f32_16x16x32_bf16 v[116:119], a[84:87], v[132:135], v[116:119]
    v_cndmask_b32 v26, v26, v28, s[78:79]
    v_cndmask_b32 v27, v27, v29, s[80:81]
    v_mfma_f32_16x16x32_bf16 v[116:119], a[108:111], v[136:139], v[116:119]
    v_max_f32 v28, v26, v27
    v_mov_b32 v29, v28
    v_mfma_f32_16x16x32_bf16 v[116:119], a[132:135], v[140:143], v[116:119]
    v_mfma_f32_16x16x32_bf16 v[116:119], a[156:159], v[144:147], v[116:119]
    v_cvt_pk_bf16_f32 v56, v112, v113
    v_cvt_pk_bf16_f32 v57, v114, v115
    v_mfma_f32_16x16x32_bf16 v[116:119], a[180:183], v[148:151], v[116:119]
    v_permlane16_swap_b32 v28, v29
    v_max_f32 v28, v28, v29
    v_mfma_f32_16x16x32_bf16 v[116:119], a[204:207], v[152:155], v[116:119]
    v_mov_b32 v29, v28
    v_mfma_f32_16x16x32_bf16 v[116:119], a[228:231], v[156:159], v[116:119]
    v_mfma_f32_16x16x32_bf16 v[116:119], a[252:255], v[160:163], v[116:119]
    v_permlane32_swap_b32 v28, v29
    v_max_f32 v28, v28, v29
    v_mfma_f32_16x16x32_bf16 v[116:119], v[196:199], v[164:167], v[116:119]
    v_sub_f32 v26, v26, v28
    v_sub_f32 v27, v27, v28
    v_mfma_f32_16x16x32_bf16 v[116:119], v[220:223], v[168:171], v[116:119]
    v_mul_f32 v26, s91, v26
    v_mul_f32 v27, s91, v27
    v_mfma_f32_16x16x32_bf16 v[116:119], v[244:247], v[172:175], v[116:119]
    v_exp_f32 v26, v26
    v_mfma_f32_16x16x32_bf16 v[96:99], v[120:123], a[16:19], 0
    v_exp_f32 v27, v27
    v_mfma_f32_16x16x32_bf16 v[96:99], v[124:127], a[40:43], v[96:99]
    v_add_f32 v28, v26, v27
    v_mov_b32 v29, v28
    v_mfma_f32_16x16x32_bf16 v[96:99], v[128:131], a[64:67], v[96:99]
    v_mfma_f32_16x16x32_bf16 v[96:99], v[132:135], a[88:91], v[96:99]
    v_permlane16_swap_b32 v28, v29
    v_add_f32 v28, v28, v29
    v_mfma_f32_16x16x32_bf16 v[96:99], v[136:139], a[112:115], v[96:99]
    v_mov_b32 v29, v28
    v_mfma_f32_16x16x32_bf16 v[96:99], v[140:143], a[136:139], v[96:99]
    v_mfma_f32_16x16x32_bf16 v[96:99], v[144:147], a[160:163], v[96:99]
    v_cvt_pk_bf16_f32 v58, v116, v117
    v_cvt_pk_bf16_f32 v59, v118, v119
    v_mfma_f32_16x16x32_bf16 v[96:99], v[148:151], a[184:187], v[96:99]
    v_cndmask_b32 v58, v58, 0, s[82:83]
    v_cndmask_b32 v59, v59, 0, s[82:83]
    v_mfma_f32_16x16x32_bf16 v[96:99], v[152:155], a[208:211], v[96:99]
    v_permlane32_swap_b32 v28, v29
    v_add_f32 v28, v28, v29
    v_mfma_f32_16x16x32_bf16 v[96:99], v[156:159], a[232:235], v[96:99]
    v_rcp_f32 v28, v28
    v_mfma_f32_16x16x32_bf16 v[96:99], v[160:163], v[176:179], v[96:99]
    v_mul_f32 v26, v26, v28
    v_mul_f32 v27, v27, v28
    v_mfma_f32_16x16x32_bf16 v[96:99], v[164:167], v[200:203], v[96:99]
    v_cvt_pk_bf16_f32 v26, v26, v26
    v_cvt_pk_bf16_f32 v27, v27, v27
    v_mfma_f32_16x16x32_bf16 v[96:99], v[168:171], v[224:227], v[96:99]
    v_and_b32 v80, v26, v14
    v_and_b32 v81, v27, v15
    v_mfma_f32_16x16x32_bf16 v[96:99], v[172:175], v[248:251], v[96:99]
    v_and_b32 v82, v26, v16
    v_and_b32 v83, v27, v17
    v_mfma_f32_16x16x32_bf16 v[100:103], v[120:123], a[20:23], 0
    v_mfma_f32_16x16x32_bf16 v[100:103], v[124:127], a[44:47], v[100:103]
    v_mfma_f32_16x16x32_bf16 v[72:75], v[34:37], v[80:83], 0
    v_mfma_f32_16x16x32_bf16 v[100:103], v[128:131], a[68:71], v[100:103]
    v_mfma_f32_16x16x32_bf16 v[76:79], v[44:47], v[80:83], 0
    v_mfma_f32_16x16x32_bf16 v[100:103], v[132:135], a[92:95], v[100:103]
    s_add_u32 s53, s74, 81920
    v_mfma_f32_16x16x32_bf16 v[100:103], v[136:139], a[116:119], v[100:103]
    v_mfma_f32_16x16x32_bf16 v[100:103], v[140:143], a[140:143], v[100:103]
    v_mfma_f32_16x16x32_bf16 v[100:103], v[144:147], a[164:167], v[100:103]
    v_cvt_pk_bf16_f32 v38, v96, v97
    v_cvt_pk_bf16_f32 v39, v98, v99
    v_mfma_f32_16x16x32_bf16 v[100:103], v[148:151], a[188:191], v[100:103]
    v_mfma_f32_16x16x32_bf16 v[100:103], v[152:155], a[212:215], v[100:103]
    v_cvt_pk_bf16_f32 v84, v72, v73
    v_cvt_pk_bf16_f32 v85, v74, v75
    v_mfma_f32_16x16x32_bf16 v[100:103], v[156:159], a[236:239], v[100:103]
    v_cvt_pk_bf16_f32 v86, v76, v77
    v_cvt_pk_bf16_f32 v87, v78, v79
    v_mfma_f32_16x16x32_bf16 v[100:103], v[160:163], v[180:183], v[100:103]
    v_cndmask_b32 v86, v86, 0, s[82:83]
    v_cndmask_b32 v87, v87, 0, s[82:83]
    v_mfma_f32_16x16x32_bf16 v[100:103], v[164:167], v[204:207], v[100:103]
    buffer_store_dwordx4 v[84:87], v23, s[24:27], s53 offen sc1
    v_mfma_f32_16x16x32_bf16 v[100:103], v[168:171], v[228:231], v[100:103]
    v_mfma_f32_16x16x32_bf16 v[100:103], v[172:175], v[252:255], v[100:103]
    v_mfma_f32_16x16x32_bf16 v[104:107], a[0:3], v[120:123], 0
    v_mfma_f32_16x16x32_bf16 v[104:107], a[24:27], v[124:127], v[104:107]
    v_mfma_f32_16x16x32_bf16 v[104:107], a[48:51], v[128:131], v[104:107]
    v_mfma_f32_16x16x32_bf16 v[104:107], a[72:75], v[132:135], v[104:107]
    v_mfma_f32_16x16x32_bf16 v[104:107], a[96:99], v[136:139], v[104:107]
    v_mfma_f32_16x16x32_bf16 v[104:107], a[120:123], v[140:143], v[104:107]
    v_mfma_f32_16x16x32_bf16 v[104:107], a[144:147], v[144:147], v[104:107]
    s_nop 0
    v_cvt_pk_bf16_f32 v48, v100, v101
    v_cvt_pk_bf16_f32 v49, v102, v103
    v_mfma_f32_16x16x32_bf16 v[104:107], a[168:171], v[148:151], v[104:107]
    v_mfma_f32_16x16x32_bf16 v[104:107], a[192:195], v[152:155], v[104:107]
    v_mfma_f32_16x16x32_bf16 v[104:107], a[216:219], v[156:159], v[104:107]
    v_mfma_f32_16x16x32_bf16 v[104:107], a[240:243], v[160:163], v[104:107]
    v_mfma_f32_16x16x32_bf16 v[104:107], v[184:187], v[164:167], v[104:107]
    v_mfma_f32_16x16x32_bf16 v[104:107], v[208:211], v[168:171], v[104:107]
    v_mfma_f32_16x16x32_bf16 v[104:107], v[232:235], v[172:175], v[104:107]
    v_mfma_f32_16x16x32_bf16 v[108:111], a[4:7], v[120:123], 0
    v_add_u32 v4, 65536, v4
    v_add_u32 v25, 65536, v25
    ds_read_b128 v[120:123], v4 offset:0
    v_mfma_f32_16x16x32_bf16 v[108:111], a[28:31], v[124:127], v[108:111]
    ds_read_b128 v[124:127], v25 offset:0
    v_mfma_f32_16x16x32_bf16 v[108:111], a[52:55], v[128:131], v[108:111]
    ds_read_b128 v[128:131], v4 offset:2048
    v_mfma_f32_16x16x32_bf16 v[108:111], a[76:79], v[132:135], v[108:111]
    ds_read_b128 v[132:135], v25 offset:2048
    v_mfma_f32_16x16x32_bf16 v[108:111], a[100:103], v[136:139], v[108:111]
    ds_read_b128 v[136:139], v4 offset:4096
    v_mfma_f32_16x16x32_bf16 v[108:111], a[124:127], v[140:143], v[108:111]
    ds_read_b128 v[140:143], v25 offset:4096
    v_mfma_f32_16x16x32_bf16 v[108:111], a[148:151], v[144:147], v[108:111]
    ds_read_b128 v[144:147], v4 offset:6144
    v_cvt_pk_bf16_f32 v68, v104, v105
    v_mfma_f32_16x16x32_bf16 v[108:111], a[172:175], v[148:151], v[108:111]
    ds_read_b128 v[148:151], v25 offset:6144
    v_cvt_pk_bf16_f32 v69, v106, v107
    v_mfma_f32_16x16x32_bf16 v[108:111], a[196:199], v[152:155], v[108:111]
    ds_read_b128 v[152:155], v4 offset:8192
    v_mfma_f32_16x16x32_bf16 v[108:111], a[220:223], v[156:159], v[108:111]
    ds_read_b128 v[156:159], v25 offset:8192
    v_mfma_f32_16x16x32_bf16 v[108:111], a[244:247], v[160:163], v[108:111]
    ds_read_b128 v[160:163], v4 offset:10240
    v_mfma_f32_16x16x32_bf16 v[108:111], v[188:191], v[164:167], v[108:111]
    ds_read_b128 v[164:167], v25 offset:10240
    v_mfma_f32_16x16x32_bf16 v[108:111], v[212:215], v[168:171], v[108:111]
    ds_read_b128 v[168:171], v4 offset:12288
    v_mfma_f32_16x16x32_bf16 v[108:111], v[236:239], v[172:175], v[108:111]
    ds_read_b128 v[172:175], v25 offset:12288
    s_waitcnt lgkmcnt(11)
    v_mfma_f32_16x16x32_bf16 v[112:115], a[0:3], v[120:123], 0
    v_mfma_f32_16x16x32_bf16 v[112:115], a[24:27], v[124:127], v[112:115]
    v_mfma_f32_16x16x32_bf16 v[112:115], a[48:51], v[128:131], v[112:115]
    s_waitcnt lgkmcnt(8)
    v_mfma_f32_16x16x32_bf16 v[112:115], a[72:75], v[132:135], v[112:115]
    v_mfma_f32_16x16x32_bf16 v[112:115], a[96:99], v[136:139], v[112:115]
    v_mfma_f32_16x16x32_bf16 v[112:115], a[120:123], v[140:143], v[112:115]
    s_waitcnt lgkmcnt(5)
    v_mfma_f32_16x16x32_bf16 v[112:115], a[144:147], v[144:147], v[112:115]
    v_cvt_pk_bf16_f32 v70, v108, v109
    v_cvt_pk_bf16_f32 v71, v110, v111
    v_mfma_f32_16x16x32_bf16 v[112:115], a[168:171], v[148:151], v[112:115]
    v_cndmask_b32 v70, v70, 0, s[82:83]
    v_cndmask_b32 v71, v71, 0, s[82:83]
    v_mfma_f32_16x16x32_bf16 v[112:115], a[192:195], v[152:155], v[112:115]
    s_waitcnt lgkmcnt(2)
    v_mfma_f32_16x16x32_bf16 v[112:115], a[216:219], v[156:159], v[112:115]
    v_mfma_f32_16x16x32_bf16 v[72:75], v[52:55], v[68:71], 0
    v_mfma_f32_16x16x32_bf16 v[112:115], a[240:243], v[160:163], v[112:115]
    v_mfma_f32_16x16x32_bf16 v[76:79], v[56:59], v[68:71], 0
    v_mfma_f32_16x16x32_bf16 v[112:115], v[184:187], v[164:167], v[112:115]
    s_waitcnt lgkmcnt(0)
    v_mfma_f32_16x16x32_bf16 v[112:115], v[208:211], v[168:171], v[112:115]
    v_mfma_f32_16x16x32_bf16 v[112:115], v[232:235], v[172:175], v[112:115]
    v_mfma_f32_16x16x32_bf16 v[116:119], a[4:7], v[120:123], 0
    v_mfma_f32_16x16x32_bf16 v[116:119], a[28:31], v[124:127], v[116:119]
    v_cndmask_b32 v26, v72, v73, s[76:77]
    v_cndmask_b32 v27, v74, v75, s[76:77]
    v_mfma_f32_16x16x32_bf16 v[116:119], a[52:55], v[128:131], v[116:119]
    v_cndmask_b32 v28, v76, v77, s[76:77]
    v_cndmask_b32 v29, v78, v79, s[76:77]
    v_mfma_f32_16x16x32_bf16 v[116:119], a[76:79], v[132:135], v[116:119]
    v_cndmask_b32 v26, v26, v28, s[78:79]
    v_cndmask_b32 v27, v27, v29, s[80:81]
    v_mfma_f32_16x16x32_bf16 v[116:119], a[100:103], v[136:139], v[116:119]
    v_max_f32 v28, v26, v27
    v_mov_b32 v29, v28
    v_mfma_f32_16x16x32_bf16 v[116:119], a[124:127], v[140:143], v[116:119]
    v_mfma_f32_16x16x32_bf16 v[116:119], a[148:151], v[144:147], v[116:119]
    v_cvt_pk_bf16_f32 v64, v112, v113
    v_cvt_pk_bf16_f32 v65, v114, v115
    v_mfma_f32_16x16x32_bf16 v[116:119], a[172:175], v[148:151], v[116:119]
    v_permlane16_swap_b32 v28, v29
    v_max_f32 v28, v28, v29
    v_mfma_f32_16x16x32_bf16 v[116:119], a[196:199], v[152:155], v[116:119]
    v_mov_b32 v29, v28
    v_mfma_f32_16x16x32_bf16 v[116:119], a[220:223], v[156:159], v[116:119]
    v_mfma_f32_16x16x32_bf16 v[116:119], a[244:247], v[160:163], v[116:119]
    v_permlane32_swap_b32 v28, v29
    v_max_f32 v28, v28, v29
    v_mfma_f32_16x16x32_bf16 v[116:119], v[188:191], v[164:167], v[116:119]
    v_sub_f32 v26, v26, v28
    v_sub_f32 v27, v27, v28
    v_mfma_f32_16x16x32_bf16 v[116:119], v[212:215], v[168:171], v[116:119]
    v_mul_f32 v26, s91, v26
    v_mul_f32 v27, s91, v27
    v_mfma_f32_16x16x32_bf16 v[116:119], v[236:239], v[172:175], v[116:119]
    v_exp_f32 v26, v26
    v_mfma_f32_16x16x32_bf16 v[96:99], a[8:11], v[120:123], 0
    v_exp_f32 v27, v27
    v_mfma_f32_16x16x32_bf16 v[96:99], a[32:35], v[124:127], v[96:99]
    v_add_f32 v28, v26, v27
    v_mov_b32 v29, v28
    v_mfma_f32_16x16x32_bf16 v[96:99], a[56:59], v[128:131], v[96:99]
    v_mfma_f32_16x16x32_bf16 v[96:99], a[80:83], v[132:135], v[96:99]
    v_permlane16_swap_b32 v28, v29
    v_add_f32 v28, v28, v29
    v_mfma_f32_16x16x32_bf16 v[96:99], a[104:107], v[136:139], v[96:99]
    v_mov_b32 v29, v28
    v_mfma_f32_16x16x32_bf16 v[96:99], a[128:131], v[140:143], v[96:99]
    v_mfma_f32_16x16x32_bf16 v[96:99], a[152:155], v[144:147], v[96:99]
    v_cvt_pk_bf16_f32 v66, v116, v117
    v_cvt_pk_bf16_f32 v67, v118, v119
    v_mfma_f32_16x16x32_bf16 v[96:99], a[176:179], v[148:151], v[96:99]
    v_cndmask_b32 v66, v66, 0, s[82:83]
    v_cndmask_b32 v67, v67, 0, s[82:83]
    v_mfma_f32_16x16x32_bf16 v[96:99], a[200:203], v[152:155], v[96:99]
    v_permlane32_swap_b32 v28, v29
    v_add_f32 v28, v28, v29
    v_mfma_f32_16x16x32_bf16 v[96:99], a[224:227], v[156:159], v[96:99]
    v_rcp_f32 v28, v28
    v_mfma_f32_16x16x32_bf16 v[96:99], a[248:251], v[160:163], v[96:99]
    v_mul_f32 v26, v26, v28
    v_mul_f32 v27, v27, v28
    v_mfma_f32_16x16x32_bf16 v[96:99], v[192:195], v[164:167], v[96:99]
    v_cvt_pk_bf16_f32 v26, v26, v26
    v_cvt_pk_bf16_f32 v27, v27, v27
    v_mfma_f32_16x16x32_bf16 v[96:99], v[216:219], v[168:171], v[96:99]
    v_and_b32 v80, v26, v14
    v_and_b32 v81, v27, v15
    v_mfma_f32_16x16x32_bf16 v[96:99], v[240:243], v[172:175], v[96:99]
    v_and_b32 v82, v26, v16
    v_and_b32 v83, v27, v17
    v_mfma_f32_16x16x32_bf16 v[100:103], a[12:15], v[120:123], 0
    v_mfma_f32_16x16x32_bf16 v[100:103], a[36:39], v[124:127], v[100:103]
    v_mfma_f32_16x16x32_bf16 v[72:75], v[36:39], v[80:83], 0
    v_mfma_f32_16x16x32_bf16 v[100:103], a[60:63], v[128:131], v[100:103]
    v_mfma_f32_16x16x32_bf16 v[76:79], v[46:49], v[80:83], 0
    v_mfma_f32_16x16x32_bf16 v[100:103], a[84:87], v[132:135], v[100:103]
    s_add_u32 s53, s74, 98304
    v_mfma_f32_16x16x32_bf16 v[100:103], a[108:111], v[136:139], v[100:103]
    v_mfma_f32_16x16x32_bf16 v[100:103], a[132:135], v[140:143], v[100:103]
    v_mfma_f32_16x16x32_bf16 v[100:103], a[156:159], v[144:147], v[100:103]
    v_cvt_pk_bf16_f32 v60, v96, v97
    v_cvt_pk_bf16_f32 v61, v98, v99
    v_mfma_f32_16x16x32_bf16 v[100:103], a[180:183], v[148:151], v[100:103]
    v_mfma_f32_16x16x32_bf16 v[100:103], a[204:207], v[152:155], v[100:103]
    v_cvt_pk_bf16_f32 v84, v72, v73
    v_cvt_pk_bf16_f32 v85, v74, v75
    v_mfma_f32_16x16x32_bf16 v[100:103], a[228:231], v[156:159], v[100:103]
    v_cvt_pk_bf16_f32 v86, v76, v77
    v_cvt_pk_bf16_f32 v87, v78, v79
    v_mfma_f32_16x16x32_bf16 v[100:103], a[252:255], v[160:163], v[100:103]
    v_cndmask_b32 v86, v86, 0, s[82:83]
    v_cndmask_b32 v87, v87, 0, s[82:83]
    v_mfma_f32_16x16x32_bf16 v[100:103], v[196:199], v[164:167], v[100:103]
    buffer_store_dwordx4 v[84:87], v23, s[24:27], s53 offen sc1
    v_mfma_f32_16x16x32_bf16 v[100:103], v[220:223], v[168:171], v[100:103]
    v_mfma_f32_16x16x32_bf16 v[100:103], v[244:247], v[172:175], v[100:103]
    v_mfma_f32_16x16x32_bf16 v[104:107], v[120:123], a[16:19], 0
    v_mfma_f32_16x16x32_bf16 v[104:107], v[124:127], a[40:43], v[104:107]
    v_mfma_f32_16x16x32_bf16 v[104:107], v[128:131], a[64:67], v[104:107]
    v_mfma_f32_16x16x32_bf16 v[104:107], v[132:135], a[88:91], v[104:107]
    v_mfma_f32_16x16x32_bf16 v[104:107], v[136:139], a[112:115], v[104:107]
    v_mfma_f32_16x16x32_bf16 v[104:107], v[140:143], a[136:139], v[104:107]
    v_mfma_f32_16x16x32_bf16 v[104:107], v[144:147], a[160:163], v[104:107]
    s_nop 0
    v_cvt_pk_bf16_f32 v62, v100, v101
    v_cvt_pk_bf16_f32 v63, v102, v103
    v_mfma_f32_16x16x32_bf16 v[104:107], v[148:151], a[184:187], v[104:107]
    v_cndmask_b32 v62, v62, 0, s[82:83]
    v_cndmask_b32 v63, v63, 0, s[82:83]
    v_mfma_f32_16x16x32_bf16 v[104:107], v[152:155], a[208:211], v[104:107]
    v_mfma_f32_16x16x32_bf16 v[104:107], v[156:159], a[232:235], v[104:107]
    v_mfma_f32_16x16x32_bf16 v[72:75], v[56:59], v[64:67], 0
    v_mfma_f32_16x16x32_bf16 v[104:107], v[160:163], v[176:179], v[104:107]
    v_mfma_f32_16x16x32_bf16 v[76:79], v[60:63], v[64:67], 0
    v_mfma_f32_16x16x32_bf16 v[104:107], v[164:167], v[200:203], v[104:107]
    v_mfma_f32_16x16x32_bf16 v[104:107], v[168:171], v[224:227], v[104:107]
    v_mfma_f32_16x16x32_bf16 v[104:107], v[172:175], v[248:251], v[104:107]
    v_mfma_f32_16x16x32_bf16 v[108:111], v[120:123], a[20:23], 0
    v_mfma_f32_16x16x32_bf16 v[108:111], v[124:127], a[44:47], v[108:111]
    s_nop 0
    v_cndmask_b32 v26, v72, v73, s[76:77]
    v_cndmask_b32 v27, v74, v75, s[76:77]
    v_mfma_f32_16x16x32_bf16 v[108:111], v[128:131], a[68:71], v[108:111]
    v_cndmask_b32 v28, v76, v77, s[76:77]
    v_cndmask_b32 v29, v78, v79, s[76:77]
    v_mfma_f32_16x16x32_bf16 v[108:111], v[132:135], a[92:95], v[108:111]
    v_cndmask_b32 v26, v26, v28, s[78:79]
    v_cndmask_b32 v27, v27, v29, s[80:81]
    v_mfma_f32_16x16x32_bf16 v[108:111], v[136:139], a[116:119], v[108:111]
    v_max_f32 v28, v26, v27
    v_mov_b32 v29, v28
    v_mfma_f32_16x16x32_bf16 v[108:111], v[140:143], a[140:143], v[108:111]
    v_mfma_f32_16x16x32_bf16 v[108:111], v[144:147], a[164:167], v[108:111]
    v_cvt_pk_bf16_f32 v40, v104, v105
    v_cvt_pk_bf16_f32 v41, v106, v107
    v_mfma_f32_16x16x32_bf16 v[108:111], v[148:151], a[188:191], v[108:111]
    v_permlane16_swap_b32 v28, v29
    v_max_f32 v28, v28, v29
    v_mfma_f32_16x16x32_bf16 v[108:111], v[152:155], a[212:215], v[108:111]
    v_mov_b32 v29, v28
    v_mfma_f32_16x16x32_bf16 v[108:111], v[156:159], a[236:239], v[108:111]
    v_mfma_f32_16x16x32_bf16 v[108:111], v[160:163], v[180:183], v[108:111]
    v_permlane32_swap_b32 v28, v29
    v_max_f32 v28, v28, v29
    v_mfma_f32_16x16x32_bf16 v[108:111], v[164:167], v[204:207], v[108:111]
    v_sub_f32 v26, v26, v28
    v_sub_f32 v27, v27, v28
    v_mfma_f32_16x16x32_bf16 v[108:111], v[168:171], v[228:231], v[108:111]
    v_mul_f32 v26, s91, v26
    v_mul_f32 v27, s91, v27
    v_mfma_f32_16x16x32_bf16 v[108:111], v[172:175], v[252:255], v[108:111]
    v_exp_f32 v26, v26
    s_nop 6
    v_cvt_pk_bf16_f32 v50, v108, v109
    v_cvt_pk_bf16_f32 v51, v110, v111
    v_exp_f32 v27, v27
    s_nop 0
    v_add_f32 v28, v26, v27
    v_mov_b32 v29, v28
    s_nop 1
    v_permlane16_swap_b32 v28, v29
    v_add_f32 v28, v28, v29
    v_mov_b32 v29, v28
    s_nop 1
    v_permlane32_swap_b32 v28, v29
    v_add_f32 v28, v28, v29
    v_rcp_f32 v28, v28
    s_nop 0
    v_mul_f32 v26, v26, v28
    v_mul_f32 v27, v27, v28
    v_cvt_pk_bf16_f32 v26, v26, v26
    v_cvt_pk_bf16_f32 v27, v27, v27
    v_and_b32 v80, v26, v14
    v_and_b32 v81, v27, v15
    v_and_b32 v82, v26, v16
    v_and_b32 v83, v27, v17
    s_nop 1
    v_mfma_f32_16x16x32_bf16 v[72:75], v[38:41], v[80:83], 0
    v_mfma_f32_16x16x32_bf16 v[76:79], v[48:51], v[80:83], 0
    s_add_u32 s53, s74, 114688
    s_nop 5
    v_cvt_pk_bf16_f32 v84, v72, v73
    v_cvt_pk_bf16_f32 v85, v74, v75
    v_cvt_pk_bf16_f32 v86, v76, v77
    v_cvt_pk_bf16_f32 v87, v78, v79
    v_cndmask_b32 v86, v86, 0, s[82:83]
    v_cndmask_b32 v87, v87, 0, s[82:83]
    buffer_store_dwordx4 v[84:87], v23, s[24:27], s53 offen sc1
    s_waitcnt vmcnt(0) lgkmcnt(0)
    s_barrier
    s_cmp_lg_u32 s44, 0
    s_cbranch_scc1 L_nopub19
    s_lshl_b32 s60, s48, 4
    s_add_u32 s60, s60, s49
    s_lshl_b32 s60, s60, 7
    s_add_u32 s60, s60, 12779520
    v_mov_b32 v30, s47
    s_mov_b64 exec, 1
    buffer_store_dword v30, off, s[24:27], s60 sc1
    s_mov_b64 exec, -1
L_nopub19:
    s_endpgm
L_codeend:
.section .rodata,"a"
.p2align 6
.amdhsa_kernel parallel_sum__sliding_local_dilated__mixer_token_mlp__prompt_kernel
  .amdhsa_next_free_vgpr 512
  .amdhsa_next_free_sgpr 102
  .amdhsa_accum_offset 256
  .amdhsa_group_segment_fixed_size 0
  .amdhsa_kernarg_size 88
  .amdhsa_user_sgpr_count 2
  .amdhsa_user_sgpr_kernarg_segment_ptr 1
  .amdhsa_system_sgpr_workgroup_id_x 1
  .amdhsa_float_denorm_mode_32 3
.end_amdhsa_kernel
```

```asm
; @launch grid=(256,1,1) block=(256,1,1) lds=163840
.amdgcn_target "amdgcn-amd-amdhsa--gfx950"
.text
.globl parallel_sum__sliding_local_dilated__mixer_token_mlp__prompt_kernel
.p2align 8
.type parallel_sum__sliding_local_dilated__mixer_token_mlp__prompt_kernel,@function
parallel_sum__sliding_local_dilated__mixer_token_mlp__prompt_kernel:
    s_cmp_ge_u32 s2, 256
    s_cbranch_scc1 L_end
    s_load_dwordx2 s[4:5], s[0:1], 0
    s_load_dwordx16 s[76:91], s[0:1], 0
    s_load_dwordx4 s[92:95], s[0:1], 64
    s_load_dwordx2 s[24:25], s[0:1], 80
    s_lshr_b32 s46, s2, 3
    s_getpc_b64 s[98:99]
L_pc:
    s_mul_i32 s53, s46, 1408
    v_lshrrev_b32 v26, 4, v0
    v_min_u32 v26, 10, v26
    v_lshl_add_u32 v26, v26, 7, s53
    v_lshrrev_b32 v25, 5, v0
    v_min_u32 v26, L_codeend-L_pc-4, v26
    v_mov_b32 v29, s99
    v_add_co_u32 v28, vcc, s98, v26
    s_nop 1
    v_addc_co_u32 v29, vcc, 0, v29, vcc
    global_load_dword v108, v[28:29], off
    v_and_b32 v26, 31, v0
    v_mul_u32_u24 v24, 896, v25
    v_lshl_add_u32 v24, v26, 4, v24
    s_mul_i32 s53, s2, 7168
    v_add_u32 v24, s53, v24
    v_cmp_gt_u32 vcc, 28, v26
    v_mov_b32 v27, 2130706432
    s_mov_b32 s6, 1835008
    s_mov_b32 s7, 0x20000
    v_cndmask_b32 v24, v27, v24, vcc
    v_lshrrev_b32 v27, 6, v0
    v_and_b32 v1, 63, v0
    s_waitcnt lgkmcnt(0)
    buffer_load_dwordx4 v[32:35], v24, s[4:7], 0 offen
    buffer_load_dwordx4 v[36:39], v24, s[4:7], 0 offen offset:448
    v_readfirstlane_b32 s44, v27
    s_and_b32 s45, s2, 7
    s_mov_b64 s[8:9], s[78:79]
    s_mov_b32 s10, 1204224
    s_mov_b32 s11, s7
    s_lshr_b32 s53, s45, 1
    s_add_u32 s54, s53, 1
    s_bfe_u32 s54, s54, 0x10001
    s_add_u32 s54, s54, 1
    s_mul_i32 s53, s53, 224
    s_andn2_b32 s53, s53, 127
    s_sub_u32 s55, s46, 3
    s_cmp_lt_u32 s46, 24
    s_cselect_b32 s55, 63, s55
    s_cmp_lt_u32 s46, 21
    s_cselect_b32 s55, s46, s55
    s_mul_i32 s55, s55, 43008
    s_add_u32 s53, s53, s55
    v_and_b32 v27, 3, v0
    v_min_u32 v27, s54, v27
    v_bfe_u32 v28, v0, 2, 2
    v_min_u32 v28, 2, v28
    v_mul_u32_u24 v28, 7, v28
    v_add_u32 v27, v27, v28
    v_lshrrev_b32 v28, 4, v0
    v_min_u32 v28, 15, v28
    v_mul_u32_u24 v28, 21, v28
    v_add_lshl_u32 v27, v27, v28, 7
    buffer_load_dword v108, v27, s[8:11], s53 offen
    s_mov_b64 s[40:41], s[94:95]
    s_mov_b32 s42, 256
    s_mov_b32 s43, s7
    s_or_b32 s53, s2, s44
    s_cbranch_scc1 L_nononce
    s_memrealtime s[98:99]
    s_waitcnt lgkmcnt(0)
    s_or_b32 s98, s98, 1
    v_mov_b32 v28, s98
    s_mov_b64 exec, 1
    buffer_store_dword v28, off, s[40:43], 0 sc1
    s_mov_b64 exec, -1
L_nononce:
    s_mov_b64 s[16:17], s[84:85]
    s_mov_b32 s18, 7340032
    s_mov_b32 s19, s7
    s_mov_b32 s26, 16777216
    s_mov_b32 s27, s7
    s_mov_b64 s[20:21], s[88:89]
    s_mov_b32 s22, 7340032
    s_mov_b32 s23, s7
    s_mov_b64 s[12:13], s[80:81]
    s_mov_b32 s14, 401408
    s_mov_b32 s15, s7
    s_mov_b64 s[28:29], s[92:93]
    s_mov_b32 s30, 1835008
    s_mov_b32 s31, s7
    s_mov_b64 s[32:33], s[86:87]
    s_mov_b32 s34, 3584
    s_mov_b32 s35, s7
    s_mov_b64 s[36:37], s[90:91]
    s_mov_b32 s38, 4096
    s_mov_b32 s39, s7
    s_lshl_b32 s52, s44, 12
    v_lshlrev_b32 v23, 4, v1
    s_cmp_ge_u32 s46, 24
    s_cbranch_scc1 L_role_a
    v_lshrrev_b32 v208, 4, v1
    v_bfe_u32 v209, v1, 2, 2
    v_and_b32 v210, 3, v1
    v_and_b32 v211, 15, v1
    v_lshrrev_b32 v212, 5, v1
    s_mul_i32 s55, s45, 3
    s_max_u32 s55, s55, 1
    s_add_u32 s55, s55, s46
    s_sub_u32 s55, s55, 1
    s_sub_u32 s56, s55, 21
    s_min_u32 s55, s55, s56
    s_and_b32 s54, s45, 1
    s_mul_i32 s54, s54, 24
    s_sub_u32 s54, s46, s54
    s_cmp_ge_u32 s46, 21
    s_cselect_b32 s54, s54, s55
    s_mul_i32 s53, s45, 21
    s_add_u32 s53, s53, s54
    s_mul_i32 s50, s53, 171
    s_lshr_b32 s50, s50, 10
    s_mul_i32 s54, s50, 6
    s_sub_u32 s88, s53, s54
    s_mul_i32 s51, s50, 2
    s_add_u32 s51, s51, s88
    s_mul_i32 s54, s51, 43
    s_lshr_b32 s54, s54, 8
    s_mul_i32 s54, s54, 6
    s_sub_u32 s51, s51, s54
    s_mul_i32 s65, s51, 13
    s_add_u32 s65, s65, 2
    s_mul_i32 s65, s65, 171
    s_lshr_b32 s65, s65, 10
    v_lshl_add_u32 v213, v212, 2, v209
    v_and_b32 v215, 1, v208
    v_lshlrev_b32 v214, 4, v210
    v_lshl_add_u32 v214, v215, 6, v214
    s_mul_i32 s53, s44, 1835008
    s_lshl_b32 s54, s50, 7
    s_add_u32 s53, s53, s54
    v_mul_u32_u24 v10, 3584, v213
    v_add3_u32 v10, v10, v214, s53
    v_xor_b32 v11, 32, v10
    s_cmp_ge_u32 s46, 21
    s_cbranch_scc1 L_help
    s_add_u32 m0, s52, 49152
    s_add_u32 s57, s65, 0
    s_sub_u32 s3, s57, 13
    s_min_u32 s57, s57, s3
    s_mul_i32 s57, s57, 114688
    buffer_load_dwordx4 v10, s[16:19], s57 offen offset:0 lds
    s_add_u32 s57, s57, 27648
    buffer_load_dwordx4 v11, s[16:19], s57 offen offset:1024 lds
    v_mul_u32_u24 v109, 960, v25
    v_lshl_add_u32 v109, v26, 4, v109
    v_mul_u32_u24 v110, 960, v209
    v_lshl_add_u32 v110, v208, 5, v110
    v_lshl_add_u32 v110, v210, 3, v110
    s_lshl_b32 s53, s44, 7
    v_add_u32 v110, s53, v110
    v_mul_u32_u24 v111, 66816, v208
    v_lshl_add_u32 v111, v211, 4, v111
    s_mul_i32 s63, s44, 267264
    s_lshl_b32 s53, s2, 8
    s_add_u32 s63, s63, s53
    s_add_u32 s64, s63, 1069056
    s_cmp_eq_u32 s44, 3
    s_cselect_b32 s64, 2130706432, s64
    s_mov_b32 s62, 0x3f803f80
    s_mov_b32 s61, 0xffff0000
    s_mov_b32 s66, 6291456
    v_mov_b32 v96, 0
    v_mov_b32 v97, 0
    v_lshlrev_b32 v216, 6, v209
    v_lshl_add_u32 v216, v210, 3, v216
    v_lshl_add_u32 v216, v215, 5, v216
    s_add_u32 s53, s52, 49152
    v_lshl_add_u32 v2, v208, 10, v216
    v_add_u32 v2, s53, v2
    v_xor_b32 v3, 32, v2
    v_add_u32 v4, 65536, v2
    v_add_u32 v5, 65536, v3
    v_lshl_add_u32 v6, v208, 9, v216
    v_add_u32 v6, s53, v6
    v_xor_b32 v7, 32, v6
    v_add_u32 v8, 65536, v6
    v_add_u32 v9, 65536, v7
    s_waitcnt vmcnt(4)
    v_dot2c_f32_bf16 v96, s62, v32
    v_dot2c_f32_bf16 v97, v32, v32
    v_lshlrev_b32 v40, 16, v32
    v_and_b32 v41, s61, v32
    v_dot2c_f32_bf16 v96, s62, v33
    v_dot2c_f32_bf16 v97, v33, v33
    v_lshlrev_b32 v42, 16, v33
    v_and_b32 v43, s61, v33
    v_dot2c_f32_bf16 v96, s62, v34
    v_dot2c_f32_bf16 v97, v34, v34
    v_lshlrev_b32 v44, 16, v34
    v_and_b32 v45, s61, v34
    v_dot2c_f32_bf16 v96, s62, v35
    v_dot2c_f32_bf16 v97, v35, v35
    v_lshlrev_b32 v46, 16, v35
    v_and_b32 v47, s61, v35
    s_waitcnt vmcnt(3)
    v_dot2c_f32_bf16 v96, s62, v36
    v_dot2c_f32_bf16 v97, v36, v36
    v_lshlrev_b32 v48, 16, v36
    v_and_b32 v49, s61, v36
    v_dot2c_f32_bf16 v96, s62, v37
    v_dot2c_f32_bf16 v97, v37, v37
    v_lshlrev_b32 v50, 16, v37
    v_and_b32 v51, s61, v37
    v_dot2c_f32_bf16 v96, s62, v38
    v_dot2c_f32_bf16 v97, v38, v38
    v_lshlrev_b32 v52, 16, v38
    v_and_b32 v53, s61, v38
    v_dot2c_f32_bf16 v96, s62, v39
    v_dot2c_f32_bf16 v97, v39, v39
    v_lshlrev_b32 v54, 16, v39
    v_and_b32 v55, s61, v39
    buffer_load_dword v29, off, s[40:43], 0 sc1
    v_add_f32_dpp v96, v96, v96 quad_perm:[1,0,3,2] row_mask:0xf bank_mask:0xf
    v_add_f32_dpp v97, v97, v97 quad_perm:[1,0,3,2] row_mask:0xf bank_mask:0xf
    s_nop 0
    v_add_f32_dpp v96, v96, v96 quad_perm:[2,3,0,1] row_mask:0xf bank_mask:0xf
    v_add_f32_dpp v97, v97, v97 quad_perm:[2,3,0,1] row_mask:0xf bank_mask:0xf
    s_nop 0
    v_add_f32_dpp v96, v96, v96 row_half_mirror row_mask:0xf bank_mask:0xf
    v_add_f32_dpp v97, v97, v97 row_half_mirror row_mask:0xf bank_mask:0xf
    s_nop 0
    v_add_f32_dpp v96, v96, v96 row_mirror row_mask:0xf bank_mask:0xf
    v_add_f32_dpp v97, v97, v97 row_mirror row_mask:0xf bank_mask:0xf
    v_mov_b32 v98, v96
    v_mov_b32 v99, v97
    s_nop 0
    v_permlane16_swap_b32 v96, v98
    v_permlane16_swap_b32 v97, v99
    v_add_f32 v96, v96, v98
    v_add_f32 v97, v97, v99
    v_mul_f32 v98, 0x3b124925, v96
    v_mul_f32 v99, 0x3b124925, v97
    v_fma_f32 v99, -v98, v98, v99
    v_max_f32 v99, 0, v99
    v_cvt_pk_bf16_f32 v100, 0, v99
    v_add_f32 v100, 0x3727c5ac, v100
    v_cvt_pk_bf16_f32 v100, 0, v100
    v_sqrt_f32 v100, v100
    s_nop 0
    v_cvt_pk_bf16_f32 v100, 0, v100
    v_rcp_f32 v100, v100
    s_nop 0
    v_mul_f32 v99, v99, v100
    v_mul_f32 v102, v98, v100
    v_mul_f32 v99, v99, v100
    v_cvt_pk_bf16_f32 v104, 0, v99
    v_add_f32 v104, 0x3727c5ac, v104
    v_cvt_pk_bf16_f32 v104, 0, v104
    v_sqrt_f32 v104, v104
    s_nop 0
    v_cvt_pk_bf16_f32 v104, 0, v104
    v_rcp_f32 v104, v104
    s_nop 0
    v_mul_f32 v104, v104, v100
    v_mul_f32 v106, v98, v104
    v_pk_fma_f32 v[56:57], v[40:41], v[104:105], v[106:107] op_sel_hi:[1,0,0] neg_lo:[0,0,1] neg_hi:[0,0,1]
    v_pk_fma_f32 v[58:59], v[42:43], v[104:105], v[106:107] op_sel_hi:[1,0,0] neg_lo:[0,0,1] neg_hi:[0,0,1]
    v_pk_fma_f32 v[60:61], v[44:45], v[104:105], v[106:107] op_sel_hi:[1,0,0] neg_lo:[0,0,1] neg_hi:[0,0,1]
    v_pk_fma_f32 v[62:63], v[46:47], v[104:105], v[106:107] op_sel_hi:[1,0,0] neg_lo:[0,0,1] neg_hi:[0,0,1]
    v_pk_fma_f32 v[64:65], v[48:49], v[104:105], v[106:107] op_sel_hi:[1,0,0] neg_lo:[0,0,1] neg_hi:[0,0,1]
    v_pk_fma_f32 v[66:67], v[50:51], v[104:105], v[106:107] op_sel_hi:[1,0,0] neg_lo:[0,0,1] neg_hi:[0,0,1]
    v_pk_fma_f32 v[68:69], v[52:53], v[104:105], v[106:107] op_sel_hi:[1,0,0] neg_lo:[0,0,1] neg_hi:[0,0,1]
    v_pk_fma_f32 v[70:71], v[54:55], v[104:105], v[106:107] op_sel_hi:[1,0,0] neg_lo:[0,0,1] neg_hi:[0,0,1]
    v_cvt_pk_bf16_f32 v80, v56, v57
    v_cvt_pk_bf16_f32 v81, v58, v59
    v_cvt_pk_bf16_f32 v82, v60, v61
    v_cvt_pk_bf16_f32 v83, v62, v63
    v_cvt_pk_bf16_f32 v84, v64, v65
    v_cvt_pk_bf16_f32 v85, v66, v67
    v_cvt_pk_bf16_f32 v86, v68, v69
    v_cvt_pk_bf16_f32 v87, v70, v71
    ds_write_b128 v109, v[80:83] offset:0
    ds_write_b128 v109, v[84:87] offset:448
    v_pk_fma_f32 v[40:41], v[40:41], v[100:101], v[102:103] op_sel_hi:[1,0,0] neg_lo:[0,0,1] neg_hi:[0,0,1]
    v_pk_fma_f32 v[42:43], v[42:43], v[100:101], v[102:103] op_sel_hi:[1,0,0] neg_lo:[0,0,1] neg_hi:[0,0,1]
    v_pk_fma_f32 v[44:45], v[44:45], v[100:101], v[102:103] op_sel_hi:[1,0,0] neg_lo:[0,0,1] neg_hi:[0,0,1]
    v_pk_fma_f32 v[46:47], v[46:47], v[100:101], v[102:103] op_sel_hi:[1,0,0] neg_lo:[0,0,1] neg_hi:[0,0,1]
    v_pk_fma_f32 v[48:49], v[48:49], v[100:101], v[102:103] op_sel_hi:[1,0,0] neg_lo:[0,0,1] neg_hi:[0,0,1]
    v_pk_fma_f32 v[50:51], v[50:51], v[100:101], v[102:103] op_sel_hi:[1,0,0] neg_lo:[0,0,1] neg_hi:[0,0,1]
    v_pk_fma_f32 v[52:53], v[52:53], v[100:101], v[102:103] op_sel_hi:[1,0,0] neg_lo:[0,0,1] neg_hi:[0,0,1]
    v_pk_fma_f32 v[54:55], v[54:55], v[100:101], v[102:103] op_sel_hi:[1,0,0] neg_lo:[0,0,1] neg_hi:[0,0,1]
    v_cvt_pk_bf16_f32 v72, v40, v41
    v_cvt_pk_bf16_f32 v73, v42, v43
    v_cvt_pk_bf16_f32 v74, v44, v45
    v_cvt_pk_bf16_f32 v75, v46, v47
    v_cvt_pk_bf16_f32 v76, v48, v49
    v_cvt_pk_bf16_f32 v77, v50, v51
    v_cvt_pk_bf16_f32 v78, v52, v53
    v_cvt_pk_bf16_f32 v79, v54, v55
    s_waitcnt lgkmcnt(0)
    s_barrier
    ds_read_b64_tr_b16 v[88:89], v110 offset:0
    ds_read_b64_tr_b16 v[90:91], v110 offset:3840
    ds_read_b64_tr_b16 v[92:93], v110 offset:512
    ds_read_b64_tr_b16 v[94:95], v110 offset:4352
    buffer_store_dwordx4 v[72:75], v24, s[24:27], s66 offen offset:0 sc1
    buffer_store_dwordx4 v[76:79], v24, s[24:27], s66 offen offset:448 sc1
    s_waitcnt lgkmcnt(2)
    buffer_store_dwordx4 v[88:91], v111, s[24:27], s63 offen sc1
    s_waitcnt lgkmcnt(0)
    buffer_store_dwordx4 v[92:95], v111, s[24:27], s64 offen sc1
    s_add_u32 s57, s57, 27648
    buffer_load_dwordx4 v10, s[16:19], s57 offen offset:2048 lds
    s_add_u32 s57, s57, 27648
    buffer_load_dwordx4 v11, s[16:19], s57 offen offset:3072 lds
    s_add_u32 m0, s52, 65536
    s_add_u32 s57, s65, 1
    s_sub_u32 s3, s57, 13
    s_min_u32 s57, s57, s3
    s_mul_i32 s57, s57, 114688
    buffer_load_dwordx4 v10, s[16:19], s57 offen offset:0 lds
    s_add_u32 s57, s57, 27648
    buffer_load_dwordx4 v11, s[16:19], s57 offen offset:1024 lds
    s_add_u32 s57, s57, 27648
    buffer_load_dwordx4 v10, s[16:19], s57 offen offset:2048 lds
    s_add_u32 s57, s57, 27648
    buffer_load_dwordx4 v11, s[16:19], s57 offen offset:3072 lds
    s_waitcnt vmcnt(6)
    v_cmp_eq_u32 vcc, 0, v29
    s_nop 0
    s_cbranch_vccz L_ok2
    s_mov_b32 s59, 20000
L_spin1:
    buffer_load_dword v29, off, s[40:43], 0 sc1
    s_waitcnt vmcnt(0)
    v_cmp_eq_u32 vcc, 0, v29
    s_nop 0
    s_cbranch_vccz L_ok2
    s_sub_u32 s59, s59, 1
    s_cbranch_scc0 L_spin1
L_ok2:
    v_readfirstlane_b32 s47, v29
    s_barrier
    s_cmp_lg_u32 s44, 0
    s_cbranch_scc1 L_nopub3
    s_lshl_b32 s60, s2, 5
    s_add_u32 s60, s60, 12582912
    v_mov_b32 v30, s47
    s_mov_b64 exec, 1
    buffer_store_dword v30, off, s[24:27], s60 sc1
    s_mov_b64 exec, -1
L_nopub3:
    s_lshl_b32 s53, s44, 11
    s_add_u32 s53, s53, 12582912
    v_lshl_add_u32 v18, v1, 5, s53
    s_lshl_b32 s53, s50, 7
    s_add_u32 m0, s52, 81920
    s_add_u32 s57, s65, 2
    s_sub_u32 s3, s57, 13
    s_min_u32 s57, s57, s3
    s_mul_i32 s57, s57, 114688
    buffer_load_dwordx4 v10, s[16:19], s57 offen offset:0 lds
    v_lshl_add_u32 v19, v208, 3, s53
    s_lshl2_add_u32 s67, s51, s44
    s_mul_i32 s67, s67, 58624
    s_lshl_b32 s53, s50, 11
    s_add_u32 s57, s57, 27648
    buffer_load_dwordx4 v11, s[16:19], s57 offen offset:1024 lds
    s_add_u32 s67, s67, s53
    s_add_u32 s67, s67, 2097152
    v_mov_b32 v236, 0xbdd2d3e8
    v_mov_b32 v237, 0xc0135761
    s_add_u32 s57, s57, 27648
    buffer_load_dwordx4 v10, s[16:19], s57 offen offset:2048 lds
    s_add_u32 s54, s88, 24
    s_mul_i32 s84, s54, 66816
    s_lshl2_add_u32 s84, s52, s84
    s_mul_i32 s83, s54, 58624
    s_add_u32 s83, s83, s53
    s_and_b32 s54, s44, 1
    s_lshl_b32 s54, s54, 10
    s_add_u32 s83, s83, s54
    s_add_u32 s57, s57, 27648
    buffer_load_dwordx4 v11, s[16:19], s57 offen offset:3072 lds
    s_add_u32 s83, s83, 2097152
    s_lshl1_add_u32 s54, s54, 49152
    v_add_u32 v243, s54, v23
    s_add_u32 m0, s52, 98304
    s_add_u32 s57, s65, 3
    s_sub_u32 s3, s57, 13
    s_min_u32 s57, s57, s3
    s_mul_i32 s57, s57, 114688
    buffer_load_dwordx4 v10, s[16:19], s57 offen offset:0 lds
    s_cmp_lt_u32 s88, 4
    s_cselect_b32 s84, s84, 2130706432
    s_cselect_b32 s83, s83, 2130706432
    s_cmp_lt_u32 s44, 2
    s_cselect_b32 s83, s83, 2130706432
    s_cmp_eq_u32 s44, 0
    s_cselect_b32 s85, 1.0, 0
    s_mul_i32 s53, s45, 7
    s_lshr_b32 s53, s53, 1
    s_sub_u32 s53, s50, s53
    s_lshl1_add_u32 s53, s53, s88
    s_sub_u32 s53, s53, 4
    s_mul_i32 s54, s44, 28
    s_add_u32 s54, s54, s53
    s_lshl_b32 s87, s54, 16
    s_lshl_b32 s54, s45, 9
    s_add_u32 s87, s87, s54
    s_cmp_ge_u32 s88, 4
    s_cselect_b32 s87, s87, 2130706432
    v_lshrrev_b32 v254, 2, v1
    v_lshlrev_b32 v254, 12, v254
    v_lshl_add_u32 v254, v210, 7, v254
    s_add_u32 s57, s57, 27648
    buffer_load_dwordx4 v11, s[16:19], s57 offen offset:1024 lds
    s_waitcnt vmcnt(10)
    ds_read_b64_tr_b16 a[0:1], v2 offset:0
    ds_read_b64_tr_b16 a[2:3], v2 offset:512
    ds_read_b64_tr_b16 a[4:5], v3 offset:0
    ds_read_b64_tr_b16 a[6:7], v3 offset:512
    s_add_u32 s57, s57, 27648
    buffer_load_dwordx4 v10, s[16:19], s57 offen offset:2048 lds
    ds_read_b64_tr_b16 a[8:9], v2 offset:256
    ds_read_b64_tr_b16 a[10:11], v2 offset:768
    ds_read_b64_tr_b16 a[12:13], v3 offset:256
    ds_read_b64_tr_b16 a[14:15], v3 offset:768
    s_add_u32 s57, s57, 27648
    buffer_load_dwordx4 v11, s[16:19], s57 offen offset:3072 lds
    s_lshr_b32 s53, s46, 2
    s_and_b32 s89, s46, 3
    s_bfe_u32 s54, s46, 0x20001
    s_and_b32 s55, s46, 1
    s_add_u32 s55, s55, 4
    s_cmp_lt_u32 s46, 16
    s_cselect_b32 s53, s53, s54
    s_cselect_b32 s89, s89, s55
    s_mul_i32 s49, s53, 2
    s_add_u32 s49, s49, s89
    s_sub_u32 s54, s49, 6
    s_min_u32 s49, s49, s54
    s_add_u32 m0, s52, 114688
    s_add_u32 s57, s65, 4
    s_sub_u32 s3, s57, 13
    s_min_u32 s57, s57, s3
    s_mul_i32 s57, s57, 114688
    buffer_load_dwordx4 v10, s[16:19], s57 offen offset:0 lds
    s_lshl2_add_u32 s48, s45, s53
    s_mul_i32 s53, s44, 1835008
    s_lshl_b32 s74, s48, 7
    s_add_u32 s53, s53, s74
    s_add_u32 s57, s57, 27648
    buffer_load_dwordx4 v11, s[16:19], s57 offen offset:1024 lds
    s_waitcnt vmcnt(10)
    ds_read_b64_tr_b16 a[16:17], v2 offset:16384
    ds_read_b64_tr_b16 a[18:19], v2 offset:16896
    ds_read_b64_tr_b16 a[20:21], v3 offset:16384
    ds_read_b64_tr_b16 a[22:23], v3 offset:16896
    s_add_u32 s57, s57, 27648
    buffer_load_dwordx4 v10, s[16:19], s57 offen offset:2048 lds
    ds_read_b64_tr_b16 a[24:25], v2 offset:16640
    ds_read_b64_tr_b16 a[26:27], v2 offset:17152
    ds_read_b64_tr_b16 a[28:29], v3 offset:16640
    ds_read_b64_tr_b16 a[30:31], v3 offset:17152
    s_lshl_b32 s56, s44, 5
    v_lshlrev_b32 v217, 5, v212
    v_xor_b32 v217, v217, v214
    v_xor_b32 v217, s56, v217
    s_add_u32 s57, s57, 27648
    buffer_load_dwordx4 v11, s[16:19], s57 offen offset:3072 lds
    s_add_u32 s74, s74, s56
    v_lshlrev_b32 v12, 12, v213
    v_add3_u32 v12, v12, v217, s53
    s_mul_i32 s53, s44, 100352
    s_add_u32 m0, s52, 131072
    s_add_u32 s57, s65, 5
    s_sub_u32 s3, s57, 13
    s_min_u32 s57, s57, s3
    s_mul_i32 s57, s57, 114688
    buffer_load_dwordx4 v10, s[16:19], s57 offen offset:0 lds
    s_lshl_b32 s54, s49, 7
    s_add_u32 s55, s53, s54
    v_mul_u32_u24 v13, 896, v213
    v_add3_u32 v13, v13, v214, s55
    s_add_u32 s57, s57, 27648
    buffer_load_dwordx4 v11, s[16:19], s57 offen offset:1024 lds
    s_waitcnt vmcnt(10)
    ds_read_b64_tr_b16 a[32:33], v2 offset:32768
    ds_read_b64_tr_b16 a[34:35], v2 offset:33280
    ds_read_b64_tr_b16 a[36:37], v3 offset:32768
    ds_read_b64_tr_b16 a[38:39], v3 offset:33280
    v_xor_b32 v14, 32, v13
    s_mul_i32 s73, s48, 57344
    s_add_u32 s71, s73, s54
    s_mul_i32 s55, s44, 14336
    ds_read_b64_tr_b16 a[40:41], v2 offset:33024
    ds_read_b64_tr_b16 a[42:43], v2 offset:33536
    ds_read_b64_tr_b16 a[44:45], v3 offset:33024
    ds_read_b64_tr_b16 a[46:47], v3 offset:33536
    s_add_u32 s57, s57, 27648
    buffer_load_dwordx4 v10, s[16:19], s57 offen offset:2048 lds
    s_add_u32 s71, s71, s55
    s_add_u32 s72, s71, 7168
    v_bfe_u32 v217, v1, 1, 2
    v_lshl_add_u32 v217, v212, 2, v217
    s_add_u32 s57, s57, 27648
    buffer_load_dwordx4 v11, s[16:19], s57 offen offset:3072 lds
    v_and_b32 v218, 24, v1
    v_add_u32 v217, v217, v218
    v_mul_u32_u24 v15, 896, v217
    v_and_b32 v217, 1, v1
    s_add_u32 m0, s52, 147456
    s_add_u32 s57, s65, 6
    s_sub_u32 s3, s57, 13
    s_min_u32 s57, s57, s3
    s_mul_i32 s57, s57, 114688
    buffer_load_dwordx4 v10, s[16:19], s57 offen offset:0 lds
    v_lshl_add_u32 v15, v217, 4, v15
    v_add_u32 v15, s53, v15
    s_lshl_b32 s54, s89, 5
    s_add_u32 s54, s54, 768
    s_add_u32 s68, s89, 24
    s_mul_i32 s68, s68, 58624
    s_mul_i32 s69, s44, 14336
    s_add_u32 s69, s69, 2097152
    s_add_u32 s57, s57, 27648
    buffer_load_dwordx4 v11, s[16:19], s57 offen offset:1024 lds
    s_waitcnt vmcnt(10)
    ds_read_b64_tr_b16 a[48:49], v2 offset:49152
    ds_read_b64_tr_b16 a[50:51], v2 offset:49664
    ds_read_b64_tr_b16 a[52:53], v3 offset:49152
    ds_read_b64_tr_b16 a[54:55], v3 offset:49664
    s_add_u32 s57, s57, 27648
    buffer_load_dwordx4 v10, s[16:19], s57 offen offset:2048 lds
    ds_read_b64_tr_b16 a[56:57], v2 offset:49408
    ds_read_b64_tr_b16 a[58:59], v2 offset:49920
    ds_read_b64_tr_b16 a[60:61], v3 offset:49408
    ds_read_b64_tr_b16 a[62:63], v3 offset:49920
    s_add_u32 s57, s57, 27648
    buffer_load_dwordx4 v11, s[16:19], s57 offen offset:3072 lds
    s_add_u32 s68, s68, s69
    s_mul_i32 s55, s49, 234496
    s_add_u32 s69, s69, s55
    s_add_u32 s73, s73, s54
    s_mov_b32 s76, 0
    s_add_u32 s77, s76, 2048
    s_cmp_eq_u32 s77, 14336
    s_cselect_b32 s77, 0, s77
    s_add_u32 s78, s77, 2048
    s_cmp_eq_u32 s78, 14336
    s_cselect_b32 s78, 0, s78
    s_add_u32 s79, s78, 2048
    s_cmp_eq_u32 s79, 14336
    s_cselect_b32 s79, 0, s79
    s_add_u32 s80, s79, 2048
    s_cmp_eq_u32 s80, 14336
    s_cselect_b32 s80, 0, s80
    s_add_u32 s81, s80, 2048
    s_cmp_eq_u32 s81, 14336
    s_cselect_b32 s81, 0, s81
    s_add_u32 s82, s81, 2048
    s_cmp_eq_u32 s82, 14336
    s_cselect_b32 s82, 0, s82
    s_waitcnt lgkmcnt(15)
    s_add_u32 m0, s52, 49152
    s_add_u32 s57, s65, 7
    s_sub_u32 s3, s57, 13
    s_min_u32 s57, s57, s3
    s_mul_i32 s57, s57, 114688
    buffer_load_dwordx4 v10, s[16:19], s57 offen offset:0 lds
    s_cmp_lt_u32 s89, 4
    s_cselect_b32 s75, s54, 2130706432
    s_cselect_b32 s68, s68, 2130706432
    s_cselect_b32 s73, s73, 2130706432
    s_add_u32 s57, s57, 27648
    buffer_load_dwordx4 v11, s[16:19], s57 offen offset:1024 lds
    s_waitcnt vmcnt(10)
    ds_read_b64_tr_b16 a[64:65], v4 offset:0
    ds_read_b64_tr_b16 a[66:67], v4 offset:512
    ds_read_b64_tr_b16 a[68:69], v5 offset:0
    ds_read_b64_tr_b16 a[70:71], v5 offset:512
    s_add_u32 s57, s57, 27648
    buffer_load_dwordx4 v10, s[16:19], s57 offen offset:2048 lds
    ds_read_b64_tr_b16 a[72:73], v4 offset:256
    ds_read_b64_tr_b16 a[74:75], v4 offset:768
    ds_read_b64_tr_b16 a[76:77], v5 offset:256
    ds_read_b64_tr_b16 a[78:79], v5 offset:768
    v_lshlrev_b32 v16, 3, v1
    v_add_u32 v16, 81920, v16
    v_and_b32 v217, 7, v1
    v_min_u32 v218, 6, v217
    s_add_u32 s57, s57, 27648
    buffer_load_dwordx4 v11, s[16:19], s57 offen offset:3072 lds
    s_mul_i32 s54, s44, 7
    v_add_u32 v218, s54, v218
    v_mul_u32_u24 v219, 2, v218
    v_add_u32 v219, s89, v219
    s_add_u32 m0, s52, 65536
    s_add_u32 s57, s65, 8
    s_sub_u32 s3, s57, 13
    s_min_u32 s57, s57, s3
    s_mul_i32 s57, s57, 114688
    buffer_load_dwordx4 v10, s[16:19], s57 offen offset:0 lds
    v_mul_u32_u24 v220, 43, v219
    v_lshrrev_b32 v220, 8, v220
    v_mul_u32_u24 v220, 6, v220
    v_sub_u32 v219, v219, v220
    s_add_u32 s57, s57, 27648
    buffer_load_dwordx4 v11, s[16:19], s57 offen offset:1024 lds
    s_waitcnt vmcnt(10)
    ds_read_b64_tr_b16 a[80:81], v4 offset:16384
    ds_read_b64_tr_b16 a[82:83], v4 offset:16896
    ds_read_b64_tr_b16 a[84:85], v5 offset:16384
    ds_read_b64_tr_b16 a[86:87], v5 offset:16896
    v_subrev_u32 v219, s49, v219
    v_bfe_u32 v220, v1, 3, 1
    v_mul_i32_i24 v219, v219, v220
    v_add_u32 v219, s49, v219
    ds_read_b64_tr_b16 a[88:89], v4 offset:16640
    ds_read_b64_tr_b16 a[90:91], v4 offset:17152
    ds_read_b64_tr_b16 a[92:93], v5 offset:16640
    ds_read_b64_tr_b16 a[94:95], v5 offset:17152
    s_add_u32 s57, s57, 27648
    buffer_load_dwordx4 v10, s[16:19], s57 offen offset:2048 lds
    v_lshl_add_u32 v218, v219, 5, v218
    v_lshlrev_b32 v20, 7, v218
    v_add_u32 v20, 12713984, v20
    s_lshr_b32 s53, s48, 1
    s_add_u32 s57, s57, 27648
    buffer_load_dwordx4 v11, s[16:19], s57 offen offset:3072 lds
    s_lshl_b32 s53, s53, 7
    s_add_u32 s53, s53, 12779520
    v_lshl_add_u32 v21, v210, 11, s53
    s_lshl_b32 s70, s48, 16
    s_waitcnt lgkmcnt(15)
    s_add_u32 m0, s52, 81920
    s_add_u32 s57, s65, 9
    s_sub_u32 s3, s57, 13
    s_min_u32 s57, s57, s3
    s_mul_i32 s57, s57, 114688
    buffer_load_dwordx4 v10, s[16:19], s57 offen offset:0 lds
    s_lshl2_add_u32 s70, s52, s70
    s_add_u32 s70, s70, 4194304
    v_lshrrev_b32 v218, 3, v1
    v_mul_u32_u24 v22, 896, v218
    v_lshl_add_u32 v22, v217, 4, v22
    v_lshlrev_b32 v25, 1, v211
    s_add_u32 s53, s52, 65536
    v_lshl_add_u32 v244, v218, 8, s53
    s_add_u32 s57, s57, 27648
    buffer_load_dwordx4 v11, s[16:19], s57 offen offset:1024 lds
    s_waitcnt vmcnt(10)
    ds_read_b64_tr_b16 a[96:97], v4 offset:32768
    ds_read_b64_tr_b16 a[98:99], v4 offset:33280
    ds_read_b64_tr_b16 a[100:101], v5 offset:32768
    ds_read_b64_tr_b16 a[102:103], v5 offset:33280
    s_add_u32 s57, s57, 27648
    buffer_load_dwordx4 v10, s[16:19], s57 offen offset:2048 lds
    ds_read_b64_tr_b16 a[104:105], v4 offset:33024
    ds_read_b64_tr_b16 a[106:107], v4 offset:33536
    ds_read_b64_tr_b16 a[108:109], v5 offset:33024
    ds_read_b64_tr_b16 a[110:111], v5 offset:33536
    s_add_u32 s57, s57, 27648
    buffer_load_dwordx4 v11, s[16:19], s57 offen offset:3072 lds
    v_bfe_u32 v219, v218, 1, 1
    v_lshl_add_u32 v244, v219, 7, v244
    v_xor_b32 v219, v218, v217
    v_lshl_add_u32 v244, v219, 4, v244
    v_xor_b32 v245, 128, v244
    v_xor_b32 v218, v217, v212
    v_lshl_add_u32 v238, v218, 4, s53
    v_bfe_u32 v219, v1, 1, 1
    buffer_load_dwordx2 v[224:225], v19, s[32:35], 0 offen offset:0
    v_xor_b32 v219, v219, v215
    v_lshl_add_u32 v238, v219, 7, v238
    v_lshl_add_u32 v238, v211, 8, v238
    v_lshrrev_b32 v218, 2, v0
    buffer_load_dwordx2 v[226:227], v19, s[32:35], 0 offen offset:32
    s_waitcnt vmcnt(10)
    ds_read_b64_tr_b16 a[112:113], v2 offset:0
    ds_read_b64_tr_b16 a[114:115], v2 offset:512
    ds_read_b64_tr_b16 a[116:117], v3 offset:0
    ds_read_b64_tr_b16 a[118:119], v3 offset:512
    buffer_load_dwordx2 v[228:229], v19, s[32:35], 0 offen offset:64
    ds_read_b64_tr_b16 a[120:121], v2 offset:256
    ds_read_b64_tr_b16 a[122:123], v2 offset:768
    ds_read_b64_tr_b16 a[124:125], v3 offset:256
    ds_read_b64_tr_b16 a[126:127], v3 offset:768
    buffer_load_dwordx2 v[230:231], v19, s[32:35], 0 offen offset:96
    v_mul_u32_u24 v26, 896, v218
    v_lshl_add_u32 v26, v210, 3, v26
    s_add_u32 s53, s52, 52224
    v_lshrrev_b32 v218, 2, v1
    s_add_u32 m0, s52, 98304
    s_add_u32 s57, s65, 10
    s_sub_u32 s3, s57, 13
    s_min_u32 s57, s57, s3
    s_mul_i32 s57, s57, 114688
    buffer_load_dwordx4 v10, s[16:19], s57 offen offset:0 lds
    v_bfe_u32 v219, v218, 1, 2
    v_xor_b32 v219, v219, v210
    v_lshl_add_u32 v252, v218, 6, s53
    v_lshl_add_u32 v252, v219, 4, v252
    v_bfe_u32 v219, v1, 1, 2
    v_xor_b32 v219, v219, v208
    v_lshl_add_u32 v242, v211, 6, s53
    v_lshl_add_u32 v242, v219, 4, v242
    s_add_u32 s57, s57, 27648
    buffer_load_dwordx4 v11, s[16:19], s57 offen offset:1024 lds
    s_waitcnt vmcnt(10)
    ds_read_b64_tr_b16 a[128:129], v2 offset:16384
    ds_read_b64_tr_b16 a[130:131], v2 offset:16896
    ds_read_b64_tr_b16 a[132:133], v3 offset:16384
    ds_read_b64_tr_b16 a[134:135], v3 offset:16896
    s_add_u32 s57, s57, 27648
    buffer_load_dwordx4 v10, s[16:19], s57 offen offset:2048 lds
    ds_read_b64_tr_b16 a[136:137], v2 offset:16640
    ds_read_b64_tr_b16 a[138:139], v2 offset:17152
    ds_read_b64_tr_b16 a[140:141], v3 offset:16640
    ds_read_b64_tr_b16 a[142:143], v3 offset:17152
    s_add_u32 s57, s57, 27648
    buffer_load_dwordx4 v11, s[16:19], s57 offen offset:3072 lds
    s_sub_u32 s53, 49152, s52
    v_add_u32 v246, s53, v2
    v_add_u32 v247, s53, v3
    v_add_u32 v232, s52, v23
    v_xor_b32 v233, 4096, v232
    v_xor_b32 v234, 8192, v232
    v_xor_b32 v235, 12288, v232
    v_xor_b32 v239, 32, v238
    s_waitcnt lgkmcnt(15)
    s_add_u32 m0, s52, 114688
    s_add_u32 s57, s65, 11
    s_sub_u32 s3, s57, 13
    s_min_u32 s57, s57, s3
    s_mul_i32 s57, s57, 114688
    buffer_load_dwordx4 v10, s[16:19], s57 offen offset:0 lds
    v_xor_b32 v240, 64, v238
    v_xor_b32 v241, 96, v238
    s_add_u32 s57, s57, 27648
    buffer_load_dwordx4 v11, s[16:19], s57 offen offset:1024 lds
    s_waitcnt vmcnt(10)
    ds_read_b64_tr_b16 a[144:145], v2 offset:32768
    ds_read_b64_tr_b16 a[146:147], v2 offset:33280
    ds_read_b64_tr_b16 a[148:149], v3 offset:32768
    ds_read_b64_tr_b16 a[150:151], v3 offset:33280
    s_add_u32 s57, s57, 27648
    buffer_load_dwordx4 v10, s[16:19], s57 offen offset:2048 lds
    ds_read_b64_tr_b16 a[152:153], v2 offset:33024
    ds_read_b64_tr_b16 a[154:155], v2 offset:33536
    ds_read_b64_tr_b16 a[156:157], v3 offset:33024
    ds_read_b64_tr_b16 a[158:159], v3 offset:33536
    s_add_u32 s57, s57, 27648
    buffer_load_dwordx4 v11, s[16:19], s57 offen offset:3072 lds
    s_add_u32 m0, s52, 131072
    s_add_u32 s57, s65, 12
    s_sub_u32 s3, s57, 13
    s_min_u32 s57, s57, s3
    s_mul_i32 s57, s57, 114688
    buffer_load_dwordx4 v10, s[16:19], s57 offen offset:0 lds
    s_add_u32 s57, s57, 27648
    buffer_load_dwordx4 v11, s[16:19], s57 offen offset:1024 lds
    s_add_u32 s57, s57, 27648
    buffer_load_dwordx4 v10, s[16:19], s57 offen offset:2048 lds
    s_waitcnt vmcnt(11)
    v_lshlrev_b32 v32, 16, v224
    v_and_b32 v33, s61, v224
    v_lshlrev_b32 v34, 16, v225
    v_and_b32 v35, s61, v225
    v_lshlrev_b32 v36, 16, v226
    v_and_b32 v37, s61, v226
    v_lshlrev_b32 v38, 16, v227
    v_and_b32 v39, s61, v227
    s_add_u32 s57, s57, 27648
    buffer_load_dwordx4 v11, s[16:19], s57 offen offset:3072 lds
    v_lshlrev_b32 v40, 16, v228
    v_and_b32 v41, s61, v228
    v_lshlrev_b32 v42, 16, v229
    v_and_b32 v43, s61, v229
    buffer_load_dword v17, v18, s[24:27], 0 offen sc1
    v_lshlrev_b32 v44, 16, v230
    v_and_b32 v45, s61, v230
    v_lshlrev_b32 v46, 16, v231
    v_and_b32 v47, s61, v231
    v_mul_f32 v96, s85, v32
    v_mul_f32 v97, s85, v33
    v_mul_f32 v98, s85, v34
    v_mul_f32 v99, s85, v35
    s_add_u32 m0, s52, 147456
    s_mov_b32 s57, 1490944
    buffer_load_dwordx4 v10, s[16:19], s57 offen offset:0 lds
    s_waitcnt vmcnt(10)
    ds_read_b64_tr_b16 a[160:161], v2 offset:49152
    ds_read_b64_tr_b16 a[162:163], v2 offset:49664
    ds_read_b64_tr_b16 a[164:165], v3 offset:49152
    ds_read_b64_tr_b16 a[166:167], v3 offset:49664
    v_mul_f32 v100, s85, v36
    v_mul_f32 v101, s85, v37
    v_mul_f32 v102, s85, v38
    v_mul_f32 v103, s85, v39
    ds_read_b64_tr_b16 a[168:169], v2 offset:49408
    ds_read_b64_tr_b16 a[170:171], v2 offset:49920
    ds_read_b64_tr_b16 a[172:173], v3 offset:49408
    ds_read_b64_tr_b16 a[174:175], v3 offset:49920
    s_add_u32 s57, s57, 27648
    buffer_load_dwordx4 v11, s[16:19], s57 offen offset:1024 lds
    v_mul_f32 v104, s85, v40
    v_mul_f32 v105, s85, v41
    v_mul_f32 v106, s85, v42
    v_mul_f32 v107, s85, v43
    s_add_u32 s57, s57, 27648
    buffer_load_dwordx4 v10, s[16:19], s57 offen offset:2048 lds
    v_mul_f32 v108, s85, v44
    v_mul_f32 v109, s85, v45
    v_mul_f32 v110, s85, v46
    v_mul_f32 v111, s85, v47
    s_add_u32 s57, s57, 27648
    buffer_load_dwordx4 v11, s[16:19], s57 offen offset:3072 lds
    s_waitcnt lgkmcnt(15)
    s_add_u32 m0, s52, 49152
    s_mov_b32 s57, 1605632
    buffer_load_dwordx4 v10, s[16:19], s57 offen offset:0 lds
    s_waitcnt vmcnt(10)
    ds_read_b64_tr_b16 a[176:177], v4 offset:0
    ds_read_b64_tr_b16 a[178:179], v4 offset:512
    ds_read_b64_tr_b16 a[180:181], v5 offset:0
    ds_read_b64_tr_b16 a[182:183], v5 offset:512
    s_add_u32 s57, s57, 27648
    buffer_load_dwordx4 v11, s[16:19], s57 offen offset:1024 lds
    ds_read_b64_tr_b16 a[184:185], v4 offset:256
    ds_read_b64_tr_b16 a[186:187], v4 offset:768
    ds_read_b64_tr_b16 a[188:189], v5 offset:256
    ds_read_b64_tr_b16 a[190:191], v5 offset:768
    s_add_u32 s57, s57, 27648
    buffer_load_dwordx4 v10, s[16:19], s57 offen offset:2048 lds
    s_add_u32 s57, s57, 27648
    buffer_load_dwordx4 v11, s[16:19], s57 offen offset:3072 lds
    s_add_u32 m0, s52, 65536
    s_mov_b32 s57, 1720320
    buffer_load_dwordx4 v10, s[16:19], s57 offen offset:0 lds
    s_waitcnt vmcnt(10)
    ds_read_b64_tr_b16 a[192:193], v4 offset:16384
    ds_read_b64_tr_b16 a[194:195], v4 offset:16896
    ds_read_b64_tr_b16 a[196:197], v5 offset:16384
    ds_read_b64_tr_b16 a[198:199], v5 offset:16896
    s_add_u32 s57, s57, 27648
    buffer_load_dwordx4 v11, s[16:19], s57 offen offset:1024 lds
    ds_read_b64_tr_b16 a[200:201], v4 offset:16640
    ds_read_b64_tr_b16 a[202:203], v4 offset:17152
    ds_read_b64_tr_b16 a[204:205], v5 offset:16640
    ds_read_b64_tr_b16 a[206:207], v5 offset:17152
    s_add_u32 s57, s57, 27648
    buffer_load_dwordx4 v10, s[16:19], s57 offen offset:2048 lds
    s_waitcnt vmcnt(11)
    v_cmp_ne_u32 vcc, s47, v17
    s_nop 0
    s_cbranch_vccz L_ok5
    s_mov_b32 s59, 20000
L_spin4:
    buffer_load_dword v17, v18, s[24:27], 0 offen sc1
    s_waitcnt vmcnt(0)
    v_cmp_ne_u32 vcc, s47, v17
    s_nop 0
    s_cbranch_vccz L_ok5
    s_sub_u32 s59, s59, 1
    s_cbranch_scc0 L_spin4
L_ok5:
    s_cmp_ge_u32 s88, 4
    s_cbranch_scc1 L_p2_alt
    s_add_u32 s57, s57, 27648
    buffer_load_dwordx4 v11, s[16:19], s57 offen offset:3072 lds
    s_mov_b32 s66, s84
    s_lshl_b32 s86, s65, 10
    s_add_u32 s58, s86, s66
    s_add_u32 s86, s66, 13312
    buffer_load_dwordx4 v[112:115], v23, s[24:27], s58 offen offset:0 sc1
    s_add_u32 s58, s58, 1024
    s_cmp_eq_u32 s58, s86
    s_cselect_b32 s58, s66, s58
    buffer_load_dwordx4 v[116:119], v23, s[24:27], s58 offen offset:0 sc1
    s_waitcnt vmcnt(10)
    ds_read_b64_tr_b16 a[208:209], v4 offset:32768
    ds_read_b64_tr_b16 a[210:211], v4 offset:33280
    ds_read_b64_tr_b16 a[212:213], v5 offset:32768
    ds_read_b64_tr_b16 a[214:215], v5 offset:33280
    s_add_u32 s58, s58, 1024
    s_cmp_eq_u32 s58, s86
    s_cselect_b32 s58, s66, s58
    buffer_load_dwordx4 v[120:123], v23, s[24:27], s58 offen offset:0 sc1
    ds_read_b64_tr_b16 a[216:217], v4 offset:33024
    ds_read_b64_tr_b16 a[218:219], v4 offset:33536
    ds_read_b64_tr_b16 a[220:221], v5 offset:33024
    ds_read_b64_tr_b16 a[222:223], v5 offset:33536
    s_add_u32 s58, s58, 1024
    s_cmp_eq_u32 s58, s86
    s_cselect_b32 s58, s66, s58
    buffer_load_dwordx4 v[124:127], v23, s[24:27], s58 offen offset:0 sc1
    s_add_u32 s58, s58, 1024
    s_cmp_eq_u32 s58, s86
    s_cselect_b32 s58, s66, s58
    buffer_load_dwordx4 v[128:131], v23, s[24:27], s58 offen offset:0 sc1
    s_add_u32 s58, s58, 1024
    s_cmp_eq_u32 s58, s86
    s_cselect_b32 s58, s66, s58
    buffer_load_dwordx4 v[132:135], v23, s[24:27], s58 offen offset:0 sc1
    s_waitcnt vmcnt(10)
    ds_read_b64_tr_b16 a[224:225], v2 offset:0
    ds_read_b64_tr_b16 a[226:227], v2 offset:512
    ds_read_b64_tr_b16 a[228:229], v3 offset:0
    ds_read_b64_tr_b16 a[230:231], v3 offset:512
    s_add_u32 s58, s58, 1024
    s_cmp_eq_u32 s58, s86
    s_cselect_b32 s58, s66, s58
    buffer_load_dwordx4 v[136:139], v23, s[24:27], s58 offen offset:0 sc1
    ds_read_b64_tr_b16 a[232:233], v2 offset:256
    ds_read_b64_tr_b16 a[234:235], v2 offset:768
    ds_read_b64_tr_b16 a[236:237], v3 offset:256
    ds_read_b64_tr_b16 a[238:239], v3 offset:768
    s_add_u32 s58, s58, 1024
    s_cmp_eq_u32 s58, s86
    s_cselect_b32 s58, s66, s58
    buffer_load_dwordx4 v[140:143], v23, s[24:27], s58 offen offset:0 sc1
    s_add_u32 s58, s58, 1024
    s_cmp_eq_u32 s58, s86
    s_cselect_b32 s58, s66, s58
    buffer_load_dwordx4 v[144:147], v23, s[24:27], s58 offen offset:0 sc1
    s_add_u32 s58, s58, 1024
    s_cmp_eq_u32 s58, s86
    s_cselect_b32 s58, s66, s58
    buffer_load_dwordx4 v[148:151], v23, s[24:27], s58 offen offset:0 sc1
    s_waitcnt vmcnt(10)
    ds_read_b64_tr_b16 a[240:241], v2 offset:16384
    ds_read_b64_tr_b16 a[242:243], v2 offset:16896
    ds_read_b64_tr_b16 a[244:245], v3 offset:16384
    ds_read_b64_tr_b16 a[246:247], v3 offset:16896
    s_add_u32 s58, s58, 1024
    s_cmp_eq_u32 s58, s86
    s_cselect_b32 s58, s66, s58
    buffer_load_dwordx4 v[152:155], v23, s[24:27], s58 offen offset:0 sc1
    ds_read_b64_tr_b16 a[248:249], v2 offset:16640
    ds_read_b64_tr_b16 a[250:251], v2 offset:17152
    ds_read_b64_tr_b16 a[252:253], v3 offset:16640
    ds_read_b64_tr_b16 a[254:255], v3 offset:17152
    s_waitcnt vmcnt(10)
    v_mfma_f32_16x16x32_bf16 v[96:99], a[0:3], v[112:115], v[96:99]
    s_add_u32 s58, s58, 1024
    s_cmp_eq_u32 s58, s86
    s_cselect_b32 s58, s66, s58
    v_mfma_f32_16x16x32_bf16 v[100:103], a[4:7], v[112:115], v[100:103]
    buffer_load_dwordx4 v[156:159], v23, s[24:27], s58 offen offset:0 sc1
    v_mfma_f32_16x16x32_bf16 v[104:107], a[8:11], v[112:115], v[104:107]
    v_mfma_f32_16x16x32_bf16 v[108:111], a[12:15], v[112:115], v[108:111]
    s_waitcnt vmcnt(10)
    v_mfma_f32_16x16x32_bf16 v[96:99], a[16:19], v[116:119], v[96:99]
    s_add_u32 s58, s58, 1024
    s_cmp_eq_u32 s58, s86
    s_cselect_b32 s58, s66, s58
    v_mfma_f32_16x16x32_bf16 v[100:103], a[20:23], v[116:119], v[100:103]
    buffer_load_dwordx4 v[112:115], v23, s[24:27], s58 offen offset:0 sc1
    v_mfma_f32_16x16x32_bf16 v[104:107], a[24:27], v[116:119], v[104:107]
    v_mfma_f32_16x16x32_bf16 v[108:111], a[28:31], v[116:119], v[108:111]
    s_waitcnt vmcnt(10)
    v_mfma_f32_16x16x32_bf16 v[96:99], a[32:35], v[120:123], v[96:99]
    s_add_u32 s58, s66, 13312
    v_mfma_f32_16x16x32_bf16 v[100:103], a[36:39], v[120:123], v[100:103]
    buffer_load_dwordx4 v[116:119], v23, s[24:27], s58 offen offset:0 sc1
    v_mfma_f32_16x16x32_bf16 v[104:107], a[40:43], v[120:123], v[104:107]
    v_mfma_f32_16x16x32_bf16 v[108:111], a[44:47], v[120:123], v[108:111]
    s_waitcnt vmcnt(10)
    v_mfma_f32_16x16x32_bf16 v[96:99], a[48:51], v[124:127], v[96:99]
    s_add_u32 s58, s66, 14336
    v_mfma_f32_16x16x32_bf16 v[100:103], a[52:55], v[124:127], v[100:103]
    buffer_load_dwordx4 v[120:123], v23, s[24:27], s58 offen offset:0 sc1
    v_mfma_f32_16x16x32_bf16 v[104:107], a[56:59], v[124:127], v[104:107]
    v_mfma_f32_16x16x32_bf16 v[108:111], a[60:63], v[124:127], v[108:111]
    s_waitcnt vmcnt(10)
    v_mfma_f32_16x16x32_bf16 v[96:99], a[64:67], v[128:131], v[96:99]
    s_add_u32 s58, s66, 15360
    v_mfma_f32_16x16x32_bf16 v[100:103], a[68:71], v[128:131], v[100:103]
    buffer_load_dwordx4 v[124:127], v23, s[24:27], s58 offen offset:0 sc1
    v_mfma_f32_16x16x32_bf16 v[104:107], a[72:75], v[128:131], v[104:107]
    v_mfma_f32_16x16x32_bf16 v[108:111], a[76:79], v[128:131], v[108:111]
    s_waitcnt vmcnt(10)
    v_mfma_f32_16x16x32_bf16 v[96:99], a[80:83], v[132:135], v[96:99]
    s_xor_b32 s66, s44, 3
    s_lshl2_add_u32 s66, s51, s66
    s_mul_i32 s66, s66, 66816
    s_lshl2_add_u32 s66, s52, s66
    s_lshl_b32 s86, s65, 10
    s_add_u32 s58, s86, s66
    s_add_u32 s86, s66, 13312
    v_mfma_f32_16x16x32_bf16 v[100:103], a[84:87], v[132:135], v[100:103]
    buffer_load_dwordx4 v[128:131], v23, s[24:27], s58 offen offset:0 sc1
    v_mfma_f32_16x16x32_bf16 v[104:107], a[88:91], v[132:135], v[104:107]
    v_mfma_f32_16x16x32_bf16 v[108:111], a[92:95], v[132:135], v[108:111]
    s_waitcnt vmcnt(10)
    v_mfma_f32_16x16x32_bf16 v[96:99], a[96:99], v[136:139], v[96:99]
    s_add_u32 s58, s58, 1024
    s_cmp_eq_u32 s58, s86
    s_cselect_b32 s58, s66, s58
    v_mfma_f32_16x16x32_bf16 v[100:103], a[100:103], v[136:139], v[100:103]
    buffer_load_dwordx4 v[132:135], v23, s[24:27], s58 offen offset:0 sc1
    v_mfma_f32_16x16x32_bf16 v[104:107], a[104:107], v[136:139], v[104:107]
    v_mfma_f32_16x16x32_bf16 v[108:111], a[108:111], v[136:139], v[108:111]
    s_waitcnt vmcnt(10)
    v_mfma_f32_16x16x32_bf16 v[96:99], a[112:115], v[140:143], v[96:99]
    s_add_u32 s58, s58, 1024
    s_cmp_eq_u32 s58, s86
    s_cselect_b32 s58, s66, s58
    v_mfma_f32_16x16x32_bf16 v[100:103], a[116:119], v[140:143], v[100:103]
    buffer_load_dwordx4 v[136:139], v23, s[24:27], s58 offen offset:0 sc1
    v_mfma_f32_16x16x32_bf16 v[104:107], a[120:123], v[140:143], v[104:107]
    v_mfma_f32_16x16x32_bf16 v[108:111], a[124:127], v[140:143], v[108:111]
    s_waitcnt vmcnt(10)
    v_mfma_f32_16x16x32_bf16 v[96:99], a[128:131], v[144:147], v[96:99]
    s_add_u32 s58, s58, 1024
    s_cmp_eq_u32 s58, s86
    s_cselect_b32 s58, s66, s58
    v_mfma_f32_16x16x32_bf16 v[100:103], a[132:135], v[144:147], v[100:103]
    buffer_load_dwordx4 v[140:143], v23, s[24:27], s58 offen offset:0 sc1
    v_mfma_f32_16x16x32_bf16 v[104:107], a[136:139], v[144:147], v[104:107]
    v_mfma_f32_16x16x32_bf16 v[108:111], a[140:143], v[144:147], v[108:111]
    s_waitcnt vmcnt(10)
    s_waitcnt lgkmcnt(15)
    v_mfma_f32_16x16x32_bf16 v[96:99], a[144:147], v[148:151], v[96:99]
    s_add_u32 s58, s58, 1024
    s_cmp_eq_u32 s58, s86
    s_cselect_b32 s58, s66, s58
    v_mfma_f32_16x16x32_bf16 v[100:103], a[148:151], v[148:151], v[100:103]
    buffer_load_dwordx4 v[144:147], v23, s[24:27], s58 offen offset:0 sc1
    v_mfma_f32_16x16x32_bf16 v[104:107], a[152:155], v[148:151], v[104:107]
    v_mfma_f32_16x16x32_bf16 v[108:111], a[156:159], v[148:151], v[108:111]
    s_waitcnt vmcnt(10)
    v_mfma_f32_16x16x32_bf16 v[96:99], a[160:163], v[152:155], v[96:99]
    s_add_u32 s58, s58, 1024
    s_cmp_eq_u32 s58, s86
    s_cselect_b32 s58, s66, s58
    v_mfma_f32_16x16x32_bf16 v[100:103], a[164:167], v[152:155], v[100:103]
    buffer_load_dwordx4 v[148:151], v23, s[24:27], s58 offen offset:0 sc1
    v_mfma_f32_16x16x32_bf16 v[104:107], a[168:171], v[152:155], v[104:107]
    v_mfma_f32_16x16x32_bf16 v[108:111], a[172:175], v[152:155], v[108:111]
    s_waitcnt vmcnt(10)
    v_mfma_f32_16x16x32_bf16 v[96:99], a[176:179], v[156:159], v[96:99]
    s_add_u32 s58, s58, 1024
    s_cmp_eq_u32 s58, s86
    s_cselect_b32 s58, s66, s58
    v_mfma_f32_16x16x32_bf16 v[100:103], a[180:183], v[156:159], v[100:103]
    buffer_load_dwordx4 v[152:155], v23, s[24:27], s58 offen offset:0 sc1
    v_mfma_f32_16x16x32_bf16 v[104:107], a[184:187], v[156:159], v[104:107]
    v_mfma_f32_16x16x32_bf16 v[108:111], a[188:191], v[156:159], v[108:111]
    s_waitcnt vmcnt(10)
    v_mfma_f32_16x16x32_bf16 v[96:99], a[192:195], v[112:115], v[96:99]
    s_add_u32 s58, s58, 1024
    s_cmp_eq_u32 s58, s86
    s_cselect_b32 s58, s66, s58
    v_mfma_f32_16x16x32_bf16 v[100:103], a[196:199], v[112:115], v[100:103]
    buffer_load_dwordx4 v[156:159], v23, s[24:27], s58 offen offset:0 sc1
    v_mfma_f32_16x16x32_bf16 v[104:107], a[200:203], v[112:115], v[104:107]
    v_mfma_f32_16x16x32_bf16 v[108:111], a[204:207], v[112:115], v[108:111]
    s_waitcnt vmcnt(10)
    v_mfma_f32_16x16x32_bf16 v[96:99], a[208:211], v[116:119], v[96:99]
    s_add_u32 s58, s58, 1024
    s_cmp_eq_u32 s58, s86
    s_cselect_b32 s58, s66, s58
    v_mfma_f32_16x16x32_bf16 v[100:103], a[212:215], v[116:119], v[100:103]
    buffer_load_dwordx4 v[112:115], v23, s[24:27], s58 offen offset:0 sc1
    v_mfma_f32_16x16x32_bf16 v[104:107], a[216:219], v[116:119], v[104:107]
    v_mfma_f32_16x16x32_bf16 v[108:111], a[220:223], v[116:119], v[108:111]
    s_waitcnt vmcnt(10)
    s_waitcnt lgkmcnt(8)
    v_mfma_f32_16x16x32_bf16 v[96:99], a[224:227], v[120:123], v[96:99]
    s_add_u32 s58, s58, 1024
    s_cmp_eq_u32 s58, s86
    s_cselect_b32 s58, s66, s58
    v_mfma_f32_16x16x32_bf16 v[100:103], a[228:231], v[120:123], v[100:103]
    buffer_load_dwordx4 v[116:119], v23, s[24:27], s58 offen offset:0 sc1
    v_mfma_f32_16x16x32_bf16 v[104:107], a[232:235], v[120:123], v[104:107]
    v_mfma_f32_16x16x32_bf16 v[108:111], a[236:239], v[120:123], v[108:111]
    s_waitcnt vmcnt(10)
    s_waitcnt lgkmcnt(0)
    v_mfma_f32_16x16x32_bf16 v[96:99], a[240:243], v[124:127], v[96:99]
    s_add_u32 s58, s58, 1024
    s_cmp_eq_u32 s58, s86
    s_cselect_b32 s58, s66, s58
    v_mfma_f32_16x16x32_bf16 v[100:103], a[244:247], v[124:127], v[100:103]
    buffer_load_dwordx4 v[120:123], v23, s[24:27], s58 offen offset:0 sc1
    v_mfma_f32_16x16x32_bf16 v[104:107], a[248:251], v[124:127], v[104:107]
    v_mfma_f32_16x16x32_bf16 v[108:111], a[252:255], v[124:127], v[108:111]
L_p2_join:
    s_waitcnt vmcnt(10)
    v_mfma_f32_16x16x32_bf16 v[80:83], a[0:3], v[128:131], 0
    s_add_u32 s58, s58, 1024
    s_cmp_eq_u32 s58, s86
    s_cselect_b32 s58, s66, s58
    v_mfma_f32_16x16x32_bf16 v[84:87], a[4:7], v[128:131], 0
    buffer_load_dwordx4 v[124:127], v23, s[24:27], s58 offen offset:0 sc1
    v_mfma_f32_16x16x32_bf16 v[88:91], a[8:11], v[128:131], 0
    v_mfma_f32_16x16x32_bf16 v[92:95], a[12:15], v[128:131], 0
    s_waitcnt vmcnt(10)
    v_mfma_f32_16x16x32_bf16 v[80:83], a[16:19], v[132:135], v[80:83]
    s_add_u32 s58, s58, 1024
    s_cmp_eq_u32 s58, s86
    s_cselect_b32 s58, s66, s58
    v_mfma_f32_16x16x32_bf16 v[84:87], a[20:23], v[132:135], v[84:87]
    buffer_load_dwordx4 v[128:131], v23, s[24:27], s58 offen offset:0 sc1
    v_mfma_f32_16x16x32_bf16 v[88:91], a[24:27], v[132:135], v[88:91]
    ds_write_b128 v232, v[96:99] offset:49152
    v_mfma_f32_16x16x32_bf16 v[92:95], a[28:31], v[132:135], v[92:95]
    s_waitcnt vmcnt(10)
    v_mfma_f32_16x16x32_bf16 v[80:83], a[32:35], v[136:139], v[80:83]
    s_add_u32 s58, s66, 13312
    v_mfma_f32_16x16x32_bf16 v[84:87], a[36:39], v[136:139], v[84:87]
    buffer_load_dwordx4 v[132:135], v23, s[24:27], s58 offen offset:0 sc1
    v_mfma_f32_16x16x32_bf16 v[88:91], a[40:43], v[136:139], v[88:91]
    ds_write_b128 v232, v[100:103] offset:50176
    v_mfma_f32_16x16x32_bf16 v[92:95], a[44:47], v[136:139], v[92:95]
    s_waitcnt vmcnt(10)
    v_mfma_f32_16x16x32_bf16 v[80:83], a[48:51], v[140:143], v[80:83]
    s_add_u32 s58, s66, 14336
    v_mfma_f32_16x16x32_bf16 v[84:87], a[52:55], v[140:143], v[84:87]
    buffer_load_dwordx4 v[136:139], v23, s[24:27], s58 offen offset:0 sc1
    v_mfma_f32_16x16x32_bf16 v[88:91], a[56:59], v[140:143], v[88:91]
    ds_write_b128 v232, v[104:107] offset:51200
    v_mfma_f32_16x16x32_bf16 v[92:95], a[60:63], v[140:143], v[92:95]
    s_waitcnt vmcnt(10)
    v_mfma_f32_16x16x32_bf16 v[80:83], a[64:67], v[144:147], v[80:83]
    s_add_u32 s58, s66, 15360
    v_mfma_f32_16x16x32_bf16 v[84:87], a[68:71], v[144:147], v[84:87]
    buffer_load_dwordx4 v[140:143], v23, s[24:27], s58 offen offset:0 sc1
    v_mfma_f32_16x16x32_bf16 v[88:91], a[72:75], v[144:147], v[88:91]
    ds_write_b128 v232, v[108:111] offset:52224
    v_mfma_f32_16x16x32_bf16 v[92:95], a[76:79], v[144:147], v[92:95]
    s_waitcnt vmcnt(10)
    v_mfma_f32_16x16x32_bf16 v[80:83], a[80:83], v[148:151], v[80:83]
    s_xor_b32 s66, s44, 2
    s_lshl2_add_u32 s66, s51, s66
    s_mul_i32 s66, s66, 66816
    s_lshl2_add_u32 s66, s52, s66
    s_lshl_b32 s86, s65, 10
    s_add_u32 s58, s86, s66
    s_add_u32 s86, s66, 13312
    v_mfma_f32_16x16x32_bf16 v[84:87], a[84:87], v[148:151], v[84:87]
    buffer_load_dwordx4 v[144:147], v23, s[24:27], s58 offen offset:0 sc1
    v_mfma_f32_16x16x32_bf16 v[88:91], a[88:91], v[148:151], v[88:91]
    v_mfma_f32_16x16x32_bf16 v[92:95], a[92:95], v[148:151], v[92:95]
    s_waitcnt vmcnt(10)
    v_mfma_f32_16x16x32_bf16 v[80:83], a[96:99], v[152:155], v[80:83]
    s_add_u32 s58, s58, 1024
    s_cmp_eq_u32 s58, s86
    s_cselect_b32 s58, s66, s58
    v_mfma_f32_16x16x32_bf16 v[84:87], a[100:103], v[152:155], v[84:87]
    buffer_load_dwordx4 v[148:151], v23, s[24:27], s58 offen offset:0 sc1
    v_mfma_f32_16x16x32_bf16 v[88:91], a[104:107], v[152:155], v[88:91]
    v_mfma_f32_16x16x32_bf16 v[92:95], a[108:111], v[152:155], v[92:95]
    s_waitcnt vmcnt(10)
    v_mfma_f32_16x16x32_bf16 v[80:83], a[112:115], v[156:159], v[80:83]
    s_add_u32 s58, s58, 1024
    s_cmp_eq_u32 s58, s86
    s_cselect_b32 s58, s66, s58
    v_mfma_f32_16x16x32_bf16 v[84:87], a[116:119], v[156:159], v[84:87]
    buffer_load_dwordx4 v[152:155], v23, s[24:27], s58 offen offset:0 sc1
    v_mfma_f32_16x16x32_bf16 v[88:91], a[120:123], v[156:159], v[88:91]
    s_waitcnt lgkmcnt(0)
    s_barrier
    v_mfma_f32_16x16x32_bf16 v[92:95], a[124:127], v[156:159], v[92:95]
    s_waitcnt vmcnt(10)
    v_mfma_f32_16x16x32_bf16 v[80:83], a[128:131], v[112:115], v[80:83]
    s_add_u32 s58, s58, 1024
    s_cmp_eq_u32 s58, s86
    s_cselect_b32 s58, s66, s58
    v_mfma_f32_16x16x32_bf16 v[84:87], a[132:135], v[112:115], v[84:87]
    buffer_load_dwordx4 v[156:159], v23, s[24:27], s58 offen offset:0 sc1
    v_mfma_f32_16x16x32_bf16 v[88:91], a[136:139], v[112:115], v[88:91]
    ds_read_b128 v[160:163], v243 offset:0
    ds_read_b128 v[164:167], v243 offset:1024
    v_mfma_f32_16x16x32_bf16 v[92:95], a[140:143], v[112:115], v[92:95]
    ds_read_b128 v[168:171], v243 offset:4096
    s_waitcnt vmcnt(10)
    v_mfma_f32_16x16x32_bf16 v[80:83], a[144:147], v[116:119], v[80:83]
    s_add_u32 s58, s58, 1024
    s_cmp_eq_u32 s58, s86
    s_cselect_b32 s58, s66, s58
    v_mfma_f32_16x16x32_bf16 v[84:87], a[148:151], v[116:119], v[84:87]
    buffer_load_dwordx4 v[112:115], v23, s[24:27], s58 offen offset:0 sc1
    v_mfma_f32_16x16x32_bf16 v[88:91], a[152:155], v[116:119], v[88:91]
    ds_read_b128 v[172:175], v243 offset:5120
    ds_read_b128 v[176:179], v243 offset:8192
    v_mfma_f32_16x16x32_bf16 v[92:95], a[156:159], v[116:119], v[92:95]
    ds_read_b128 v[180:183], v243 offset:9216
    s_waitcnt vmcnt(10)
    v_mfma_f32_16x16x32_bf16 v[80:83], a[160:163], v[120:123], v[80:83]
    s_add_u32 s58, s58, 1024
    s_cmp_eq_u32 s58, s86
    s_cselect_b32 s58, s66, s58
    v_mfma_f32_16x16x32_bf16 v[84:87], a[164:167], v[120:123], v[84:87]
    buffer_load_dwordx4 v[116:119], v23, s[24:27], s58 offen offset:0 sc1
    v_mfma_f32_16x16x32_bf16 v[88:91], a[168:171], v[120:123], v[88:91]
    ds_read_b128 v[184:187], v243 offset:12288
    v_mfma_f32_16x16x32_bf16 v[92:95], a[172:175], v[120:123], v[92:95]
    ds_read_b128 v[188:191], v243 offset:13312
    s_waitcnt vmcnt(10)
    v_mfma_f32_16x16x32_bf16 v[80:83], a[176:179], v[124:127], v[80:83]
    s_add_u32 s58, s58, 1024
    s_cmp_eq_u32 s58, s86
    s_cselect_b32 s58, s66, s58
    v_mfma_f32_16x16x32_bf16 v[84:87], a[180:183], v[124:127], v[84:87]
    buffer_load_dwordx4 v[120:123], v23, s[24:27], s58 offen offset:0 sc1
    v_mfma_f32_16x16x32_bf16 v[88:91], a[184:187], v[124:127], v[88:91]
    v_mfma_f32_16x16x32_bf16 v[92:95], a[188:191], v[124:127], v[92:95]
    s_waitcnt vmcnt(10)
    v_mfma_f32_16x16x32_bf16 v[80:83], a[192:195], v[128:131], v[80:83]
    s_add_u32 s58, s58, 1024
    s_cmp_eq_u32 s58, s86
    s_cselect_b32 s58, s66, s58
    v_mfma_f32_16x16x32_bf16 v[84:87], a[196:199], v[128:131], v[84:87]
    buffer_load_dwordx4 v[124:127], v23, s[24:27], s58 offen offset:0 sc1
    v_mfma_f32_16x16x32_bf16 v[88:91], a[200:203], v[128:131], v[88:91]
    s_waitcnt lgkmcnt(0)
    v_add_f32 v160, v160, v168
    v_mfma_f32_16x16x32_bf16 v[92:95], a[204:207], v[128:131], v[92:95]
    v_add_f32 v161, v161, v169
    s_waitcnt vmcnt(10)
    v_mfma_f32_16x16x32_bf16 v[80:83], a[208:211], v[132:135], v[80:83]
    s_add_u32 s58, s58, 1024
    s_cmp_eq_u32 s58, s86
    s_cselect_b32 s58, s66, s58
    v_mfma_f32_16x16x32_bf16 v[84:87], a[212:215], v[132:135], v[84:87]
    buffer_load_dwordx4 v[128:131], v23, s[24:27], s58 offen offset:0 sc1
    v_mfma_f32_16x16x32_bf16 v[88:91], a[216:219], v[132:135], v[88:91]
    v_add_f32 v162, v162, v170
    v_add_f32 v163, v163, v171
    v_mfma_f32_16x16x32_bf16 v[92:95], a[220:223], v[132:135], v[92:95]
    v_add_f32 v164, v164, v172
    s_waitcnt vmcnt(10)
    v_mfma_f32_16x16x32_bf16 v[80:83], a[224:227], v[136:139], v[80:83]
    s_add_u32 s58, s58, 1024
    s_cmp_eq_u32 s58, s86
    s_cselect_b32 s58, s66, s58
    v_mfma_f32_16x16x32_bf16 v[84:87], a[228:231], v[136:139], v[84:87]
    buffer_load_dwordx4 v[132:135], v23, s[24:27], s58 offen offset:0 sc1
    v_mfma_f32_16x16x32_bf16 v[88:91], a[232:235], v[136:139], v[88:91]
    v_add_f32 v165, v165, v173
    v_add_f32 v166, v166, v174
    v_mfma_f32_16x16x32_bf16 v[92:95], a[236:239], v[136:139], v[92:95]
    v_add_f32 v167, v167, v175
    s_waitcnt vmcnt(10)
    v_mfma_f32_16x16x32_bf16 v[80:83], a[240:243], v[140:143], v[80:83]
    s_add_u32 s58, s58, 1024
    s_cmp_eq_u32 s58, s86
    s_cselect_b32 s58, s66, s58
    v_mfma_f32_16x16x32_bf16 v[84:87], a[244:247], v[140:143], v[84:87]
    buffer_load_dwordx4 v[136:139], v23, s[24:27], s58 offen offset:0 sc1
    v_mfma_f32_16x16x32_bf16 v[88:91], a[248:251], v[140:143], v[88:91]
    v_add_f32 v160, v160, v176
    v_add_f32 v161, v161, v177
    v_mfma_f32_16x16x32_bf16 v[92:95], a[252:255], v[140:143], v[92:95]
    v_add_f32 v162, v162, v178
    s_waitcnt vmcnt(10)
    v_mfma_f32_16x16x32_bf16 v[64:67], a[0:3], v[144:147], 0
    s_add_u32 s58, s58, 1024
    s_cmp_eq_u32 s58, s86
    s_cselect_b32 s58, s66, s58
    v_mfma_f32_16x16x32_bf16 v[68:71], a[4:7], v[144:147], 0
    buffer_load_dwordx4 v[140:143], v23, s[24:27], s58 offen offset:0 sc1
    v_mfma_f32_16x16x32_bf16 v[72:75], a[8:11], v[144:147], 0
    v_mfma_f32_16x16x32_bf16 v[76:79], a[12:15], v[144:147], 0
    s_waitcnt vmcnt(10)
    v_mfma_f32_16x16x32_bf16 v[64:67], a[16:19], v[148:151], v[64:67]
    s_add_u32 s58, s58, 1024
    s_cmp_eq_u32 s58, s86
    s_cselect_b32 s58, s66, s58
    v_mfma_f32_16x16x32_bf16 v[68:71], a[20:23], v[148:151], v[68:71]
    buffer_load_dwordx4 v[144:147], v23, s[24:27], s58 offen offset:0 sc1
    v_mfma_f32_16x16x32_bf16 v[72:75], a[24:27], v[148:151], v[72:75]
    ds_write_b128 v232, v[80:83] offset:32768
    v_mfma_f32_16x16x32_bf16 v[76:79], a[28:31], v[148:151], v[76:79]
    s_waitcnt vmcnt(10)
    v_mfma_f32_16x16x32_bf16 v[64:67], a[32:35], v[152:155], v[64:67]
    s_add_u32 s58, s66, 13312
    v_mfma_f32_16x16x32_bf16 v[68:71], a[36:39], v[152:155], v[68:71]
    buffer_load_dwordx4 v[148:151], v23, s[24:27], s58 offen offset:0 sc1
    v_mfma_f32_16x16x32_bf16 v[72:75], a[40:43], v[152:155], v[72:75]
    ds_write_b128 v232, v[84:87] offset:33792
    v_mfma_f32_16x16x32_bf16 v[76:79], a[44:47], v[152:155], v[76:79]
    s_waitcnt vmcnt(10)
    v_mfma_f32_16x16x32_bf16 v[64:67], a[48:51], v[156:159], v[64:67]
    s_add_u32 s58, s66, 14336
    ds_write_b128 v232, v[88:91] offset:34816
    v_mfma_f32_16x16x32_bf16 v[68:71], a[52:55], v[156:159], v[68:71]
    buffer_load_dwordx4 v[152:155], v23, s[24:27], s58 offen offset:0 sc1
    v_mfma_f32_16x16x32_bf16 v[72:75], a[56:59], v[156:159], v[72:75]
    v_add_f32 v163, v163, v179
    v_add_f32 v164, v164, v180
    v_mfma_f32_16x16x32_bf16 v[76:79], a[60:63], v[156:159], v[76:79]
    v_add_f32 v165, v165, v181
    s_waitcnt vmcnt(10)
    v_mfma_f32_16x16x32_bf16 v[64:67], a[64:67], v[112:115], v[64:67]
    s_add_u32 s58, s66, 15360
    ds_write_b128 v232, v[92:95] offset:35840
    v_mfma_f32_16x16x32_bf16 v[68:71], a[68:71], v[112:115], v[68:71]
    buffer_load_dwordx4 v[156:159], v23, s[24:27], s58 offen offset:0 sc1
    v_mfma_f32_16x16x32_bf16 v[72:75], a[72:75], v[112:115], v[72:75]
    v_add_f32 v166, v166, v182
    v_add_f32 v167, v167, v183
    v_mfma_f32_16x16x32_bf16 v[76:79], a[76:79], v[112:115], v[76:79]
    v_add_f32 v160, v160, v184
    s_waitcnt vmcnt(10)
    v_mfma_f32_16x16x32_bf16 v[64:67], a[80:83], v[116:119], v[64:67]
    s_xor_b32 s66, s44, 1
    s_lshl2_add_u32 s66, s51, s66
    s_mul_i32 s66, s66, 66816
    s_lshl2_add_u32 s66, s52, s66
    s_lshl_b32 s86, s65, 10
    s_add_u32 s58, s86, s66
    s_add_u32 s86, s66, 13312
    v_mfma_f32_16x16x32_bf16 v[68:71], a[84:87], v[116:119], v[68:71]
    buffer_load_dwordx4 v[112:115], v23, s[24:27], s58 offen offset:0 sc1
    v_mfma_f32_16x16x32_bf16 v[72:75], a[88:91], v[116:119], v[72:75]
    v_add_f32 v161, v161, v185
    v_add_f32 v162, v162, v186
    v_mfma_f32_16x16x32_bf16 v[76:79], a[92:95], v[116:119], v[76:79]
    v_add_f32 v163, v163, v187
    s_waitcnt vmcnt(10)
    v_mfma_f32_16x16x32_bf16 v[64:67], a[96:99], v[120:123], v[64:67]
    s_add_u32 s58, s58, 1024
    s_cmp_eq_u32 s58, s86
    s_cselect_b32 s58, s66, s58
    v_mfma_f32_16x16x32_bf16 v[68:71], a[100:103], v[120:123], v[68:71]
    buffer_load_dwordx4 v[116:119], v23, s[24:27], s58 offen offset:0 sc1
    v_mfma_f32_16x16x32_bf16 v[72:75], a[104:107], v[120:123], v[72:75]
    v_add_f32 v164, v164, v188
    v_add_f32 v165, v165, v189
    v_mfma_f32_16x16x32_bf16 v[76:79], a[108:111], v[120:123], v[76:79]
    v_add_f32 v166, v166, v190
    s_waitcnt vmcnt(10)
    v_mfma_f32_16x16x32_bf16 v[64:67], a[112:115], v[124:127], v[64:67]
    s_add_u32 s58, s58, 1024
    s_cmp_eq_u32 s58, s86
    s_cselect_b32 s58, s66, s58
    v_mfma_f32_16x16x32_bf16 v[68:71], a[116:119], v[124:127], v[68:71]
    buffer_load_dwordx4 v[120:123], v23, s[24:27], s58 offen offset:0 sc1
    v_mfma_f32_16x16x32_bf16 v[72:75], a[120:123], v[124:127], v[72:75]
    v_add_f32 v167, v167, v191
    v_mul_f32 v192, v160, v160
    v_mfma_f32_16x16x32_bf16 v[76:79], a[124:127], v[124:127], v[76:79]
    v_mul_f32 v193, v161, v161
    s_waitcnt vmcnt(10)
    v_mfma_f32_16x16x32_bf16 v[64:67], a[128:131], v[128:131], v[64:67]
    s_add_u32 s58, s58, 1024
    s_cmp_eq_u32 s58, s86
    s_cselect_b32 s58, s66, s58
    v_mfma_f32_16x16x32_bf16 v[68:71], a[132:135], v[128:131], v[68:71]
    buffer_load_dwordx4 v[124:127], v23, s[24:27], s58 offen offset:0 sc1
    v_mfma_f32_16x16x32_bf16 v[72:75], a[136:139], v[128:131], v[72:75]
    v_mul_f32 v194, v162, v162
    v_mul_f32 v195, v163, v163
    v_mfma_f32_16x16x32_bf16 v[76:79], a[140:143], v[128:131], v[76:79]
    v_mul_f32 v196, v164, v164
    s_waitcnt vmcnt(10)
    v_mfma_f32_16x16x32_bf16 v[64:67], a[144:147], v[132:135], v[64:67]
    s_add_u32 s58, s58, 1024
    s_cmp_eq_u32 s58, s86
    s_cselect_b32 s58, s66, s58
    v_mfma_f32_16x16x32_bf16 v[68:71], a[148:151], v[132:135], v[68:71]
    buffer_load_dwordx4 v[128:131], v23, s[24:27], s58 offen offset:0 sc1
    v_mfma_f32_16x16x32_bf16 v[72:75], a[152:155], v[132:135], v[72:75]
    v_mul_f32 v197, v165, v165
    v_mul_f32 v198, v166, v166
    v_mfma_f32_16x16x32_bf16 v[76:79], a[156:159], v[132:135], v[76:79]
    v_mul_f32 v199, v167, v167
    s_waitcnt vmcnt(10)
    v_mfma_f32_16x16x32_bf16 v[64:67], a[160:163], v[136:139], v[64:67]
    s_add_u32 s58, s58, 1024
    s_cmp_eq_u32 s58, s86
    s_cselect_b32 s58, s66, s58
    v_mfma_f32_16x16x32_bf16 v[68:71], a[164:167], v[136:139], v[68:71]
    buffer_load_dwordx4 v[132:135], v23, s[24:27], s58 offen offset:0 sc1
    v_mfma_f32_16x16x32_bf16 v[72:75], a[168:171], v[136:139], v[72:75]
    v_fma_f32 v192, v192, v236, v237
    v_fma_f32 v193, v193, v236, v237
    v_mfma_f32_16x16x32_bf16 v[76:79], a[172:175], v[136:139], v[76:79]
    v_fma_f32 v194, v194, v236, v237
    s_waitcnt vmcnt(10)
    v_mfma_f32_16x16x32_bf16 v[64:67], a[176:179], v[140:143], v[64:67]
    s_add_u32 s58, s58, 1024
    s_cmp_eq_u32 s58, s86
    s_cselect_b32 s58, s66, s58
    v_mfma_f32_16x16x32_bf16 v[68:71], a[180:183], v[140:143], v[68:71]
    buffer_load_dwordx4 v[136:139], v23, s[24:27], s58 offen offset:0 sc1
    v_mfma_f32_16x16x32_bf16 v[72:75], a[184:187], v[140:143], v[72:75]
    v_fma_f32 v195, v195, v236, v237
    v_fma_f32 v196, v196, v236, v237
    v_mfma_f32_16x16x32_bf16 v[76:79], a[188:191], v[140:143], v[76:79]
    v_fma_f32 v197, v197, v236, v237
    s_waitcnt vmcnt(10)
    v_mfma_f32_16x16x32_bf16 v[64:67], a[192:195], v[144:147], v[64:67]
    s_add_u32 s58, s58, 1024
    s_cmp_eq_u32 s58, s86
    s_cselect_b32 s58, s66, s58
    v_mfma_f32_16x16x32_bf16 v[68:71], a[196:199], v[144:147], v[68:71]
    buffer_load_dwordx4 v[140:143], v23, s[24:27], s58 offen offset:0 sc1
    v_mfma_f32_16x16x32_bf16 v[72:75], a[200:203], v[144:147], v[72:75]
    v_fma_f32 v198, v198, v236, v237
    v_fma_f32 v199, v199, v236, v237
    v_mfma_f32_16x16x32_bf16 v[76:79], a[204:207], v[144:147], v[76:79]
    v_mul_f32 v192, v192, v160
    s_waitcnt vmcnt(10)
    v_mfma_f32_16x16x32_bf16 v[64:67], a[208:211], v[148:151], v[64:67]
    s_add_u32 s58, s58, 1024
    s_cmp_eq_u32 s58, s86
    s_cselect_b32 s58, s66, s58
    v_mfma_f32_16x16x32_bf16 v[68:71], a[212:215], v[148:151], v[68:71]
    buffer_load_dwordx4 v[144:147], v23, s[24:27], s58 offen offset:0 sc1
    v_mfma_f32_16x16x32_bf16 v[72:75], a[216:219], v[148:151], v[72:75]
    v_mul_f32 v193, v193, v161
    v_mul_f32 v194, v194, v162
    v_mfma_f32_16x16x32_bf16 v[76:79], a[220:223], v[148:151], v[76:79]
    v_mul_f32 v195, v195, v163
    s_waitcnt vmcnt(10)
    v_mfma_f32_16x16x32_bf16 v[64:67], a[224:227], v[152:155], v[64:67]
    s_add_u32 s58, s58, 1024
    s_cmp_eq_u32 s58, s86
    s_cselect_b32 s58, s66, s58
    v_mfma_f32_16x16x32_bf16 v[68:71], a[228:231], v[152:155], v[68:71]
    buffer_load_dwordx4 v[148:151], v23, s[24:27], s58 offen offset:0 sc1
    v_mfma_f32_16x16x32_bf16 v[72:75], a[232:235], v[152:155], v[72:75]
    v_mul_f32 v196, v196, v164
    v_mul_f32 v197, v197, v165
    v_mfma_f32_16x16x32_bf16 v[76:79], a[236:239], v[152:155], v[76:79]
    v_mul_f32 v198, v198, v166
    s_waitcnt vmcnt(10)
    v_mfma_f32_16x16x32_bf16 v[64:67], a[240:243], v[156:159], v[64:67]
    s_add_u32 s58, s58, 1024
    s_cmp_eq_u32 s58, s86
    s_cselect_b32 s58, s66, s58
    v_mfma_f32_16x16x32_bf16 v[68:71], a[244:247], v[156:159], v[68:71]
    buffer_load_dwordx4 v[152:155], v23, s[24:27], s58 offen offset:0 sc1
    v_mfma_f32_16x16x32_bf16 v[72:75], a[248:251], v[156:159], v[72:75]
    v_mul_f32 v199, v199, v167
    v_mfma_f32_16x16x32_bf16 v[76:79], a[252:255], v[156:159], v[76:79]
    s_waitcnt vmcnt(10)
    v_mfma_f32_16x16x32_bf16 v[48:51], a[0:3], v[112:115], 0
    s_add_u32 s58, s58, 1024
    s_cmp_eq_u32 s58, s86
    s_cselect_b32 s58, s66, s58
    v_mfma_f32_16x16x32_bf16 v[52:55], a[4:7], v[112:115], 0
    buffer_load_dwordx4 v[156:159], v23, s[24:27], s58 offen offset:0 sc1
    v_mfma_f32_16x16x32_bf16 v[56:59], a[8:11], v[112:115], 0
    v_mfma_f32_16x16x32_bf16 v[60:63], a[12:15], v[112:115], 0
    s_waitcnt vmcnt(10)
    v_mfma_f32_16x16x32_bf16 v[48:51], a[16:19], v[116:119], v[48:51]
    s_add_u32 s58, s58, 1024
    s_cmp_eq_u32 s58, s86
    s_cselect_b32 s58, s66, s58
    v_mfma_f32_16x16x32_bf16 v[52:55], a[20:23], v[116:119], v[52:55]
    buffer_load_dwordx4 v[112:115], v23, s[24:27], s58 offen offset:0 sc1
    v_mfma_f32_16x16x32_bf16 v[56:59], a[24:27], v[116:119], v[56:59]
    ds_write_b128 v232, v[64:67] offset:16384
    v_mfma_f32_16x16x32_bf16 v[60:63], a[28:31], v[116:119], v[60:63]
    s_waitcnt vmcnt(10)
    v_mfma_f32_16x16x32_bf16 v[48:51], a[32:35], v[120:123], v[48:51]
    s_add_u32 s58, s66, 13312
    v_mfma_f32_16x16x32_bf16 v[52:55], a[36:39], v[120:123], v[52:55]
    buffer_load_dwordx4 v[116:119], v23, s[24:27], s58 offen offset:0 sc1
    v_mfma_f32_16x16x32_bf16 v[56:59], a[40:43], v[120:123], v[56:59]
    ds_write_b128 v232, v[68:71] offset:17408
    v_mfma_f32_16x16x32_bf16 v[60:63], a[44:47], v[120:123], v[60:63]
    s_waitcnt vmcnt(10)
    v_mfma_f32_16x16x32_bf16 v[48:51], a[48:51], v[124:127], v[48:51]
    s_add_u32 s58, s66, 14336
    ds_write_b128 v232, v[72:75] offset:18432
    v_mfma_f32_16x16x32_bf16 v[52:55], a[52:55], v[124:127], v[52:55]
    buffer_load_dwordx4 v[120:123], v23, s[24:27], s58 offen offset:0 sc1
    v_mfma_f32_16x16x32_bf16 v[56:59], a[56:59], v[124:127], v[56:59]
    v_exp_f32 v192, v192
    v_exp_f32 v193, v193
    v_mfma_f32_16x16x32_bf16 v[60:63], a[60:63], v[124:127], v[60:63]
    v_exp_f32 v194, v194
    s_waitcnt vmcnt(10)
    v_mfma_f32_16x16x32_bf16 v[48:51], a[64:67], v[128:131], v[48:51]
    s_add_u32 s58, s66, 15360
    ds_write_b128 v232, v[76:79] offset:19456
    v_mfma_f32_16x16x32_bf16 v[52:55], a[68:71], v[128:131], v[52:55]
    buffer_load_dwordx4 v[124:127], v23, s[24:27], s58 offen offset:0 sc1
    v_mfma_f32_16x16x32_bf16 v[56:59], a[72:75], v[128:131], v[56:59]
    v_exp_f32 v195, v195
    v_exp_f32 v196, v196
    v_mfma_f32_16x16x32_bf16 v[60:63], a[76:79], v[128:131], v[60:63]
    v_exp_f32 v197, v197
    s_waitcnt vmcnt(10)
    v_mfma_f32_16x16x32_bf16 v[48:51], a[80:83], v[132:135], v[48:51]
    s_xor_b32 s66, s44, 0
    s_lshl2_add_u32 s66, s51, s66
    s_mul_i32 s66, s66, 66816
    s_lshl2_add_u32 s66, s52, s66
    s_lshl_b32 s86, s65, 10
    s_add_u32 s58, s86, s66
    s_add_u32 s86, s66, 13312
    v_mfma_f32_16x16x32_bf16 v[52:55], a[84:87], v[132:135], v[52:55]
    buffer_load_dwordx4 v[128:131], v23, s[24:27], s58 offen offset:0 sc1
    v_mfma_f32_16x16x32_bf16 v[56:59], a[88:91], v[132:135], v[56:59]
    v_exp_f32 v198, v198
    v_exp_f32 v199, v199
    v_mfma_f32_16x16x32_bf16 v[60:63], a[92:95], v[132:135], v[60:63]
    v_add_f32 v192, 1.0, v192
    s_waitcnt vmcnt(10)
    v_mfma_f32_16x16x32_bf16 v[48:51], a[96:99], v[136:139], v[48:51]
    s_add_u32 s58, s58, 1024
    s_cmp_eq_u32 s58, s86
    s_cselect_b32 s58, s66, s58
    v_mfma_f32_16x16x32_bf16 v[52:55], a[100:103], v[136:139], v[52:55]
    buffer_load_dwordx4 v[132:135], v23, s[24:27], s58 offen offset:0 sc1
    v_mfma_f32_16x16x32_bf16 v[56:59], a[104:107], v[136:139], v[56:59]
    v_add_f32 v193, 1.0, v193
    v_add_f32 v194, 1.0, v194
    v_mfma_f32_16x16x32_bf16 v[60:63], a[108:111], v[136:139], v[60:63]
    v_add_f32 v195, 1.0, v195
    s_waitcnt vmcnt(10)
    v_mfma_f32_16x16x32_bf16 v[48:51], a[112:115], v[140:143], v[48:51]
    s_add_u32 s58, s58, 1024
    s_cmp_eq_u32 s58, s86
    s_cselect_b32 s58, s66, s58
    v_mfma_f32_16x16x32_bf16 v[52:55], a[116:119], v[140:143], v[52:55]
    buffer_load_dwordx4 v[136:139], v23, s[24:27], s58 offen offset:0 sc1
    v_mfma_f32_16x16x32_bf16 v[56:59], a[120:123], v[140:143], v[56:59]
    v_add_f32 v196, 1.0, v196
    v_add_f32 v197, 1.0, v197
    v_mfma_f32_16x16x32_bf16 v[60:63], a[124:127], v[140:143], v[60:63]
    v_add_f32 v198, 1.0, v198
    s_waitcnt vmcnt(10)
    v_mfma_f32_16x16x32_bf16 v[48:51], a[128:131], v[144:147], v[48:51]
    s_add_u32 s58, s58, 1024
    s_cmp_eq_u32 s58, s86
    s_cselect_b32 s58, s66, s58
    v_mfma_f32_16x16x32_bf16 v[52:55], a[132:135], v[144:147], v[52:55]
    buffer_load_dwordx4 v[140:143], v23, s[24:27], s58 offen offset:0 sc1
    v_mfma_f32_16x16x32_bf16 v[56:59], a[136:139], v[144:147], v[56:59]
    v_add_f32 v199, 1.0, v199
    v_rcp_f32 v192, v192
    v_mfma_f32_16x16x32_bf16 v[60:63], a[140:143], v[144:147], v[60:63]
    v_rcp_f32 v193, v193
    s_waitcnt vmcnt(10)
    v_mfma_f32_16x16x32_bf16 v[48:51], a[144:147], v[148:151], v[48:51]
    s_add_u32 s58, s58, 1024
    s_cmp_eq_u32 s58, s86
    s_cselect_b32 s58, s66, s58
    v_mfma_f32_16x16x32_bf16 v[52:55], a[148:151], v[148:151], v[52:55]
    buffer_load_dwordx4 v[144:147], v23, s[24:27], s58 offen offset:0 sc1
    v_mfma_f32_16x16x32_bf16 v[56:59], a[152:155], v[148:151], v[56:59]
    v_rcp_f32 v194, v194
    v_rcp_f32 v195, v195
    v_mfma_f32_16x16x32_bf16 v[60:63], a[156:159], v[148:151], v[60:63]
    v_rcp_f32 v196, v196
    s_waitcnt vmcnt(10)
    v_mfma_f32_16x16x32_bf16 v[48:51], a[160:163], v[152:155], v[48:51]
    s_add_u32 s58, s58, 1024
    s_cmp_eq_u32 s58, s86
    s_cselect_b32 s58, s66, s58
    v_mfma_f32_16x16x32_bf16 v[52:55], a[164:167], v[152:155], v[52:55]
    buffer_load_dwordx4 v[148:151], v23, s[24:27], s58 offen offset:0 sc1
    v_mfma_f32_16x16x32_bf16 v[56:59], a[168:171], v[152:155], v[56:59]
    v_rcp_f32 v197, v197
    v_rcp_f32 v198, v198
    v_mfma_f32_16x16x32_bf16 v[60:63], a[172:175], v[152:155], v[60:63]
    v_rcp_f32 v199, v199
    s_waitcnt vmcnt(10)
    v_mfma_f32_16x16x32_bf16 v[48:51], a[176:179], v[156:159], v[48:51]
    s_add_u32 s58, s58, 1024
    s_cmp_eq_u32 s58, s86
    s_cselect_b32 s58, s66, s58
    v_mfma_f32_16x16x32_bf16 v[52:55], a[180:183], v[156:159], v[52:55]
    buffer_load_dwordx4 v[152:155], v23, s[24:27], s58 offen offset:0 sc1
    v_mfma_f32_16x16x32_bf16 v[56:59], a[184:187], v[156:159], v[56:59]
    v_mul_f32 v192, v192, v160
    v_mul_f32 v193, v193, v161
    v_mfma_f32_16x16x32_bf16 v[60:63], a[188:191], v[156:159], v[60:63]
    v_mul_f32 v194, v194, v162
    s_waitcnt vmcnt(10)
    v_mfma_f32_16x16x32_bf16 v[48:51], a[192:195], v[112:115], v[48:51]
    s_add_u32 s58, s58, 1024
    s_cmp_eq_u32 s58, s86
    s_cselect_b32 s58, s66, s58
    v_mfma_f32_16x16x32_bf16 v[52:55], a[196:199], v[112:115], v[52:55]
    buffer_load_dwordx4 v[156:159], v23, s[24:27], s58 offen offset:0 sc1
    v_mfma_f32_16x16x32_bf16 v[56:59], a[200:203], v[112:115], v[56:59]
    v_mul_f32 v195, v195, v163
    v_mul_f32 v196, v196, v164
    v_mfma_f32_16x16x32_bf16 v[60:63], a[204:207], v[112:115], v[60:63]
    v_mul_f32 v197, v197, v165
    s_waitcnt vmcnt(10)
    v_mfma_f32_16x16x32_bf16 v[48:51], a[208:211], v[116:119], v[48:51]
    s_add_u32 s58, s58, 1024
    s_cmp_eq_u32 s58, s86
    s_cselect_b32 s58, s66, s58
    v_mfma_f32_16x16x32_bf16 v[52:55], a[212:215], v[116:119], v[52:55]
    buffer_load_dwordx4 v[112:115], v23, s[24:27], s58 offen offset:0 sc1
    v_mfma_f32_16x16x32_bf16 v[56:59], a[216:219], v[116:119], v[56:59]
    v_mul_f32 v198, v198, v166
    v_mul_f32 v199, v199, v167
    v_mfma_f32_16x16x32_bf16 v[60:63], a[220:223], v[116:119], v[60:63]
    v_cvt_pk_bf16_f32 v96, v192, v193
    s_waitcnt vmcnt(10)
    v_mfma_f32_16x16x32_bf16 v[48:51], a[224:227], v[120:123], v[48:51]
    s_add_u32 s58, s58, 1024
    s_cmp_eq_u32 s58, s86
    s_cselect_b32 s58, s66, s58
    v_mfma_f32_16x16x32_bf16 v[52:55], a[228:231], v[120:123], v[52:55]
    buffer_load_dwordx4 v[116:119], v23, s[24:27], s58 offen offset:0 sc1
    v_mfma_f32_16x16x32_bf16 v[56:59], a[232:235], v[120:123], v[56:59]
    v_cvt_pk_bf16_f32 v97, v194, v195
    v_cvt_pk_bf16_f32 v98, v196, v197
    v_mfma_f32_16x16x32_bf16 v[60:63], a[236:239], v[120:123], v[60:63]
    v_cvt_pk_bf16_f32 v99, v198, v199
    s_waitcnt vmcnt(10)
    v_mfma_f32_16x16x32_bf16 v[48:51], a[240:243], v[124:127], v[48:51]
    s_add_u32 s58, s58, 1024
    s_cmp_eq_u32 s58, s86
    s_cselect_b32 s58, s66, s58
    v_mfma_f32_16x16x32_bf16 v[52:55], a[244:247], v[124:127], v[52:55]
    buffer_load_dwordx4 v[120:123], v23, s[24:27], s58 offen offset:0 sc1
    v_mfma_f32_16x16x32_bf16 v[56:59], a[248:251], v[124:127], v[56:59]
    v_mfma_f32_16x16x32_bf16 v[60:63], a[252:255], v[124:127], v[60:63]
    s_waitcnt vmcnt(10)
    v_mfma_f32_16x16x32_bf16 v[32:35], a[0:3], v[128:131], v[32:35]
    s_add_u32 s58, s58, 1024
    s_cmp_eq_u32 s58, s86
    s_cselect_b32 s58, s66, s58
    v_mfma_f32_16x16x32_bf16 v[36:39], a[4:7], v[128:131], v[36:39]
    buffer_load_dwordx4 v[124:127], v23, s[24:27], s58 offen offset:0 sc1
    v_mfma_f32_16x16x32_bf16 v[40:43], a[8:11], v[128:131], v[40:43]
    v_mfma_f32_16x16x32_bf16 v[44:47], a[12:15], v[128:131], v[44:47]
    s_waitcnt vmcnt(10)
    v_mfma_f32_16x16x32_bf16 v[32:35], a[16:19], v[132:135], v[32:35]
    s_add_u32 s58, s58, 1024
    s_cmp_eq_u32 s58, s86
    s_cselect_b32 s58, s66, s58
    v_mfma_f32_16x16x32_bf16 v[36:39], a[20:23], v[132:135], v[36:39]
    buffer_load_dwordx4 v[128:131], v23, s[24:27], s58 offen offset:0 sc1
    v_mfma_f32_16x16x32_bf16 v[40:43], a[24:27], v[132:135], v[40:43]
    ds_write_b128 v232, v[48:51] offset:0
    v_mfma_f32_16x16x32_bf16 v[44:47], a[28:31], v[132:135], v[44:47]
    ds_write_b128 v232, v[52:55] offset:1024
    s_waitcnt vmcnt(10)
    v_mfma_f32_16x16x32_bf16 v[32:35], a[32:35], v[136:139], v[32:35]
    s_add_u32 s58, s66, 13312
    v_mfma_f32_16x16x32_bf16 v[36:39], a[36:39], v[136:139], v[36:39]
    buffer_load_dwordx4 v[132:135], v23, s[24:27], s58 offen offset:0 sc1
    v_mfma_f32_16x16x32_bf16 v[40:43], a[40:43], v[136:139], v[40:43]
    ds_write_b128 v232, v[56:59] offset:2048
    v_mfma_f32_16x16x32_bf16 v[44:47], a[44:47], v[136:139], v[44:47]
    ds_write_b128 v232, v[60:63] offset:3072
    s_waitcnt vmcnt(10)
    v_mfma_f32_16x16x32_bf16 v[32:35], a[48:51], v[140:143], v[32:35]
    s_add_u32 s58, s66, 14336
    v_mfma_f32_16x16x32_bf16 v[36:39], a[52:55], v[140:143], v[36:39]
    buffer_load_dwordx4 v[136:139], v23, s[24:27], s58 offen offset:0 sc1
    v_mfma_f32_16x16x32_bf16 v[40:43], a[56:59], v[140:143], v[40:43]
    v_mfma_f32_16x16x32_bf16 v[44:47], a[60:63], v[140:143], v[44:47]
    s_waitcnt vmcnt(10)
    v_mfma_f32_16x16x32_bf16 v[32:35], a[64:67], v[144:147], v[32:35]
    s_add_u32 s58, s66, 15360
    v_mfma_f32_16x16x32_bf16 v[36:39], a[68:71], v[144:147], v[36:39]
    buffer_load_dwordx4 v[140:143], v23, s[24:27], s58 offen offset:0 sc1
    v_mfma_f32_16x16x32_bf16 v[40:43], a[72:75], v[144:147], v[40:43]
    v_mfma_f32_16x16x32_bf16 v[44:47], a[76:79], v[144:147], v[44:47]
    buffer_load_dwordx4 v[216:219], v22, s[4:7], s71 offen
    s_waitcnt vmcnt(11)
    v_mfma_f32_16x16x32_bf16 v[32:35], a[80:83], v[148:151], v[32:35]
    s_waitcnt lgkmcnt(0)
    s_barrier
    v_mfma_f32_16x16x32_bf16 v[36:39], a[84:87], v[148:151], v[36:39]
    v_mfma_f32_16x16x32_bf16 v[40:43], a[88:91], v[148:151], v[40:43]
    v_mfma_f32_16x16x32_bf16 v[44:47], a[92:95], v[148:151], v[44:47]
    buffer_load_dwordx4 v[220:223], v22, s[4:7], s72 offen
    s_waitcnt vmcnt(11)
    v_mfma_f32_16x16x32_bf16 v[32:35], a[96:99], v[152:155], v[32:35]
    ds_read_b128 v[160:163], v233 offset:0
    v_mfma_f32_16x16x32_bf16 v[36:39], a[100:103], v[152:155], v[36:39]
    ds_read_b128 v[176:179], v234 offset:16384
    v_mfma_f32_16x16x32_bf16 v[40:43], a[104:107], v[152:155], v[40:43]
    ds_read_b128 v[192:195], v235 offset:32768
    v_mfma_f32_16x16x32_bf16 v[44:47], a[108:111], v[152:155], v[44:47]
    buffer_load_dwordx2 v[224:225], v26, s[4:7], s73 offen
    s_waitcnt vmcnt(11)
    v_mfma_f32_16x16x32_bf16 v[32:35], a[112:115], v[156:159], v[32:35]
    ds_read_b128 v[164:167], v233 offset:1024
    v_mfma_f32_16x16x32_bf16 v[36:39], a[116:119], v[156:159], v[36:39]
    ds_read_b128 v[180:183], v234 offset:17408
    v_mfma_f32_16x16x32_bf16 v[40:43], a[120:123], v[156:159], v[40:43]
    ds_read_b128 v[196:199], v235 offset:33792
    v_mfma_f32_16x16x32_bf16 v[44:47], a[124:127], v[156:159], v[44:47]
    buffer_load_ushort v228, v25, s[36:39], s74 offen
    s_waitcnt vmcnt(11)
    v_mfma_f32_16x16x32_bf16 v[32:35], a[128:131], v[112:115], v[32:35]
    ds_read_b128 v[168:171], v233 offset:2048
    v_mfma_f32_16x16x32_bf16 v[36:39], a[132:135], v[112:115], v[36:39]
    ds_read_b128 v[184:187], v234 offset:18432
    v_mfma_f32_16x16x32_bf16 v[40:43], a[136:139], v[112:115], v[40:43]
    ds_read_b128 v[200:203], v235 offset:34816
    v_mfma_f32_16x16x32_bf16 v[44:47], a[140:143], v[112:115], v[44:47]
    s_add_u32 m0, s52, 81920
    s_lshl_b32 s57, s76, 7
    buffer_load_dwordx4 v12, s[20:23], s57 offen offset:0 lds
    s_waitcnt vmcnt(11)
    v_mfma_f32_16x16x32_bf16 v[32:35], a[144:147], v[116:119], v[32:35]
    ds_read_b128 v[172:175], v233 offset:3072
    v_mfma_f32_16x16x32_bf16 v[36:39], a[148:151], v[116:119], v[36:39]
    ds_read_b128 v[188:191], v234 offset:19456
    v_mfma_f32_16x16x32_bf16 v[40:43], a[152:155], v[116:119], v[40:43]
    ds_read_b128 v[204:207], v235 offset:35840
    v_mfma_f32_16x16x32_bf16 v[44:47], a[156:159], v[116:119], v[44:47]
    s_add_u32 s57, s57, 31744
    buffer_load_dwordx4 v12, s[20:23], s57 offen offset:1024 lds
    s_waitcnt vmcnt(11)
    v_mfma_f32_16x16x32_bf16 v[32:35], a[160:163], v[120:123], v[32:35]
    v_mfma_f32_16x16x32_bf16 v[36:39], a[164:167], v[120:123], v[36:39]
    v_mfma_f32_16x16x32_bf16 v[40:43], a[168:171], v[120:123], v[40:43]
    v_mfma_f32_16x16x32_bf16 v[44:47], a[172:175], v[120:123], v[44:47]
    s_add_u32 s57, s57, 31744
    buffer_load_dwordx4 v12, s[20:23], s57 offen offset:2048 lds
    s_waitcnt vmcnt(11)
    v_mfma_f32_16x16x32_bf16 v[32:35], a[176:179], v[124:127], v[32:35]
    s_waitcnt lgkmcnt(9)
    v_mfma_f32_16x16x32_bf16 v[36:39], a[180:183], v[124:127], v[36:39]
    v_add_f32 v160, v160, v176
    v_mfma_f32_16x16x32_bf16 v[40:43], a[184:187], v[124:127], v[40:43]
    v_add_f32 v161, v161, v177
    v_mfma_f32_16x16x32_bf16 v[44:47], a[188:191], v[124:127], v[44:47]
    v_add_f32 v162, v162, v178
    s_add_u32 s57, s57, 31744
    buffer_load_dwordx4 v12, s[20:23], s57 offen offset:3072 lds
    s_waitcnt vmcnt(11)
    v_mfma_f32_16x16x32_bf16 v[32:35], a[192:195], v[128:131], v[32:35]
    v_add_f32 v163, v163, v179
    v_mfma_f32_16x16x32_bf16 v[36:39], a[196:199], v[128:131], v[36:39]
    s_waitcnt lgkmcnt(6)
    v_mfma_f32_16x16x32_bf16 v[40:43], a[200:203], v[128:131], v[40:43]
    v_add_f32 v164, v164, v180
    v_mfma_f32_16x16x32_bf16 v[44:47], a[204:207], v[128:131], v[44:47]
    v_add_f32 v165, v165, v181
    s_add_u32 m0, s52, 98304
    s_lshl_b32 s57, s76, 7
    s_add_u32 s57, s57, 131072
    buffer_load_dwordx4 v12, s[20:23], s57 offen offset:0 lds
    s_waitcnt vmcnt(11)
    v_mfma_f32_16x16x32_bf16 v[32:35], a[208:211], v[132:135], v[32:35]
    v_add_f32 v166, v166, v182
    v_mfma_f32_16x16x32_bf16 v[36:39], a[212:215], v[132:135], v[36:39]
    v_add_f32 v167, v167, v183
    v_mfma_f32_16x16x32_bf16 v[40:43], a[216:219], v[132:135], v[40:43]
    s_waitcnt lgkmcnt(3)
    v_mfma_f32_16x16x32_bf16 v[44:47], a[220:223], v[132:135], v[44:47]
    v_add_f32 v168, v168, v184
    s_add_u32 s57, s57, 31744
    buffer_load_dwordx4 v12, s[20:23], s57 offen offset:1024 lds
    s_waitcnt vmcnt(11)
    v_mfma_f32_16x16x32_bf16 v[32:35], a[224:227], v[136:139], v[32:35]
    v_add_f32 v169, v169, v185
    v_mfma_f32_16x16x32_bf16 v[36:39], a[228:231], v[136:139], v[36:39]
    v_add_f32 v170, v170, v186
    v_mfma_f32_16x16x32_bf16 v[40:43], a[232:235], v[136:139], v[40:43]
    v_add_f32 v171, v171, v187
    v_mfma_f32_16x16x32_bf16 v[44:47], a[236:239], v[136:139], v[44:47]
    s_waitcnt lgkmcnt(0)
    s_add_u32 s57, s57, 31744
    buffer_load_dwordx4 v12, s[20:23], s57 offen offset:2048 lds
    s_waitcnt vmcnt(11)
    v_mfma_f32_16x16x32_bf16 v[32:35], a[240:243], v[140:143], v[32:35]
    v_add_f32 v172, v172, v188
    v_mfma_f32_16x16x32_bf16 v[36:39], a[244:247], v[140:143], v[36:39]
    v_add_f32 v173, v173, v189
    v_mfma_f32_16x16x32_bf16 v[40:43], a[248:251], v[140:143], v[40:43]
    v_add_f32 v174, v174, v190
    v_mfma_f32_16x16x32_bf16 v[44:47], a[252:255], v[140:143], v[44:47]
    v_add_f32 v175, v175, v191
    v_pk_add_f32 v[160:161], v[160:161], v[192:193]
    v_pk_add_f32 v[162:163], v[162:163], v[194:195]
    v_pk_add_f32 v[164:165], v[164:165], v[196:197]
    v_pk_add_f32 v[166:167], v[166:167], v[198:199]
    v_pk_add_f32 v[168:169], v[168:169], v[200:201]
    v_pk_add_f32 v[170:171], v[170:171], v[202:203]
    v_pk_add_f32 v[172:173], v[172:173], v[204:205]
    v_pk_add_f32 v[174:175], v[174:175], v[206:207]
    buffer_store_dwordx4 v[96:99], v23, s[24:27], s83 offen sc1
    s_add_u32 s57, s57, 31744
    buffer_load_dwordx4 v12, s[20:23], s57 offen offset:3072 lds
    v_pk_add_f32 v[32:33], v[32:33], v[160:161]
    v_pk_add_f32 v[34:35], v[34:35], v[162:163]
    v_pk_add_f32 v[36:37], v[36:37], v[164:165]
    v_pk_add_f32 v[38:39], v[38:39], v[166:167]
    v_pk_mul_f32 v[48:49], v[32:33], v[32:33]
    v_pk_mul_f32 v[50:51], v[34:35], v[34:35]
    v_pk_mul_f32 v[52:53], v[36:37], v[36:37]
    v_pk_mul_f32 v[54:55], v[38:39], v[38:39]
    s_add_u32 m0, s52, 114688
    s_lshl_b32 s57, s77, 7
    buffer_load_dwordx4 v12, s[20:23], s57 offen offset:0 lds
    v_pk_fma_f32 v[48:49], v[48:49], v[236:237], v[236:237] op_sel:[0,0,1] op_sel_hi:[1,0,1]
    v_pk_fma_f32 v[50:51], v[50:51], v[236:237], v[236:237] op_sel:[0,0,1] op_sel_hi:[1,0,1]
    v_pk_fma_f32 v[52:53], v[52:53], v[236:237], v[236:237] op_sel:[0,0,1] op_sel_hi:[1,0,1]
    v_pk_fma_f32 v[54:55], v[54:55], v[236:237], v[236:237] op_sel:[0,0,1] op_sel_hi:[1,0,1]
    v_pk_mul_f32 v[48:49], v[48:49], v[32:33]
    v_pk_mul_f32 v[50:51], v[50:51], v[34:35]
    v_pk_mul_f32 v[52:53], v[52:53], v[36:37]
    v_pk_mul_f32 v[54:55], v[54:55], v[38:39]
    s_add_u32 s57, s57, 31744
    buffer_load_dwordx4 v12, s[20:23], s57 offen offset:1024 lds
    v_exp_f32 v48, v48
    v_exp_f32 v49, v49
    v_exp_f32 v50, v50
    v_exp_f32 v51, v51
    v_exp_f32 v52, v52
    v_exp_f32 v53, v53
    v_exp_f32 v54, v54
    v_exp_f32 v55, v55
    v_pk_add_f32 v[48:49], v[48:49], 1.0 op_sel_hi:[1,0]
    v_pk_add_f32 v[50:51], v[50:51], 1.0 op_sel_hi:[1,0]
    v_pk_add_f32 v[52:53], v[52:53], 1.0 op_sel_hi:[1,0]
    v_pk_add_f32 v[54:55], v[54:55], 1.0 op_sel_hi:[1,0]
    s_add_u32 s57, s57, 31744
    buffer_load_dwordx4 v12, s[20:23], s57 offen offset:2048 lds
    v_rcp_f32 v48, v48
    v_rcp_f32 v49, v49
    v_rcp_f32 v50, v50
    v_rcp_f32 v51, v51
    v_rcp_f32 v52, v52
    v_rcp_f32 v53, v53
    v_rcp_f32 v54, v54
    v_rcp_f32 v55, v55
    s_add_u32 s57, s57, 31744
    buffer_load_dwordx4 v12, s[20:23], s57 offen offset:3072 lds
    v_pk_mul_f32 v[48:49], v[48:49], v[32:33]
    v_pk_mul_f32 v[50:51], v[50:51], v[34:35]
    v_pk_mul_f32 v[52:53], v[52:53], v[36:37]
    v_pk_mul_f32 v[54:55], v[54:55], v[38:39]
    v_cvt_pk_bf16_f32 v56, v48, v49
    v_cvt_pk_bf16_f32 v57, v50, v51
    v_cvt_pk_bf16_f32 v58, v52, v53
    v_cvt_pk_bf16_f32 v59, v54, v55
    buffer_store_dwordx4 v[56:59], v23, s[24:27], s67 offen offset:0 sc1
    v_pk_add_f32 v[40:41], v[40:41], v[168:169]
    v_pk_add_f32 v[42:43], v[42:43], v[170:171]
    v_pk_add_f32 v[44:45], v[44:45], v[172:173]
    v_pk_add_f32 v[46:47], v[46:47], v[174:175]
    s_add_u32 m0, s52, 131072
    s_lshl_b32 s57, s77, 7
    s_add_u32 s57, s57, 131072
    buffer_load_dwordx4 v12, s[20:23], s57 offen offset:0 lds
    v_pk_mul_f32 v[48:49], v[40:41], v[40:41]
    v_pk_mul_f32 v[50:51], v[42:43], v[42:43]
    v_pk_mul_f32 v[52:53], v[44:45], v[44:45]
    v_pk_mul_f32 v[54:55], v[46:47], v[46:47]
    v_pk_fma_f32 v[48:49], v[48:49], v[236:237], v[236:237] op_sel:[0,0,1] op_sel_hi:[1,0,1]
    v_pk_fma_f32 v[50:51], v[50:51], v[236:237], v[236:237] op_sel:[0,0,1] op_sel_hi:[1,0,1]
    v_pk_fma_f32 v[52:53], v[52:53], v[236:237], v[236:237] op_sel:[0,0,1] op_sel_hi:[1,0,1]
    v_pk_fma_f32 v[54:55], v[54:55], v[236:237], v[236:237] op_sel:[0,0,1] op_sel_hi:[1,0,1]
    s_add_u32 s57, s57, 31744
    buffer_load_dwordx4 v12, s[20:23], s57 offen offset:1024 lds
    s_waitcnt vmcnt(12)
    ds_read_b64_tr_b16 a[0:1], v6 offset:32768
    ds_read_b64_tr_b16 a[2:3], v6 offset:34816
    ds_read_b64_tr_b16 a[4:5], v7 offset:32768
    ds_read_b64_tr_b16 a[6:7], v7 offset:34816
    v_pk_mul_f32 v[48:49], v[48:49], v[40:41]
    v_pk_mul_f32 v[50:51], v[50:51], v[42:43]
    v_pk_mul_f32 v[52:53], v[52:53], v[44:45]
    v_pk_mul_f32 v[54:55], v[54:55], v[46:47]
    ds_read_b64_tr_b16 a[8:9], v6 offset:33024
    ds_read_b64_tr_b16 a[10:11], v6 offset:35072
    ds_read_b64_tr_b16 a[12:13], v7 offset:33024
    ds_read_b64_tr_b16 a[14:15], v7 offset:35072
    s_add_u32 s57, s57, 31744
    buffer_load_dwordx4 v12, s[20:23], s57 offen offset:2048 lds
    v_exp_f32 v48, v48
    v_exp_f32 v49, v49
    v_exp_f32 v50, v50
    v_exp_f32 v51, v51
    v_exp_f32 v52, v52
    v_exp_f32 v53, v53
    v_exp_f32 v54, v54
    v_exp_f32 v55, v55
    s_add_u32 s57, s57, 31744
    buffer_load_dwordx4 v12, s[20:23], s57 offen offset:3072 lds
    v_pk_add_f32 v[48:49], v[48:49], 1.0 op_sel_hi:[1,0]
    v_pk_add_f32 v[50:51], v[50:51], 1.0 op_sel_hi:[1,0]
    v_pk_add_f32 v[52:53], v[52:53], 1.0 op_sel_hi:[1,0]
    v_pk_add_f32 v[54:55], v[54:55], 1.0 op_sel_hi:[1,0]
    v_rcp_f32 v48, v48
    v_rcp_f32 v49, v49
    v_rcp_f32 v50, v50
    v_rcp_f32 v51, v51
    v_rcp_f32 v52, v52
    v_rcp_f32 v53, v53
    v_rcp_f32 v54, v54
    v_rcp_f32 v55, v55
    s_add_u32 m0, s52, 147456
    s_lshl_b32 s57, s78, 7
    buffer_load_dwordx4 v12, s[20:23], s57 offen offset:0 lds
    v_pk_mul_f32 v[48:49], v[48:49], v[40:41]
    v_pk_mul_f32 v[50:51], v[50:51], v[42:43]
    v_pk_mul_f32 v[52:53], v[52:53], v[44:45]
    v_pk_mul_f32 v[54:55], v[54:55], v[46:47]
    v_cvt_pk_bf16_f32 v60, v48, v49
    v_cvt_pk_bf16_f32 v61, v50, v51
    v_cvt_pk_bf16_f32 v62, v52, v53
    v_cvt_pk_bf16_f32 v63, v54, v55
    buffer_store_dwordx4 v[60:63], v23, s[24:27], s67 offen offset:1024 sc1
    s_add_u32 s57, s57, 31744
    buffer_load_dwordx4 v12, s[20:23], s57 offen offset:1024 lds
    s_waitcnt vmcnt(12)
    ds_read_b64_tr_b16 a[16:17], v6 offset:49152
    ds_read_b64_tr_b16 a[18:19], v6 offset:51200
    ds_read_b64_tr_b16 a[20:21], v7 offset:49152
    ds_read_b64_tr_b16 a[22:23], v7 offset:51200
    ds_read_b64_tr_b16 a[24:25], v6 offset:49408
    ds_read_b64_tr_b16 a[26:27], v6 offset:51456
    ds_read_b64_tr_b16 a[28:29], v7 offset:49408
    ds_read_b64_tr_b16 a[30:31], v7 offset:51456
    s_add_u32 s57, s57, 31744
    buffer_load_dwordx4 v12, s[20:23], s57 offen offset:2048 lds
    s_add_u32 s57, s57, 31744
    buffer_load_dwordx4 v12, s[20:23], s57 offen offset:3072 lds
    s_add_u32 m0, s52, 49152
    s_lshl_b32 s57, s78, 7
    s_add_u32 s57, s57, 131072
    buffer_load_dwordx4 v12, s[20:23], s57 offen offset:0 lds
    s_add_u32 s57, s57, 31744
    buffer_load_dwordx4 v12, s[20:23], s57 offen offset:1024 lds
    s_waitcnt vmcnt(12)
    ds_read_b64_tr_b16 a[32:33], v8 offset:0
    ds_read_b64_tr_b16 a[34:35], v8 offset:2048
    ds_read_b64_tr_b16 a[36:37], v9 offset:0
    ds_read_b64_tr_b16 a[38:39], v9 offset:2048
    s_add_u32 s57, s57, 31744
    buffer_load_dwordx4 v12, s[20:23], s57 offen offset:2048 lds
    ds_read_b64_tr_b16 a[40:41], v8 offset:256
    ds_read_b64_tr_b16 a[42:43], v8 offset:2304
    ds_read_b64_tr_b16 a[44:45], v9 offset:256
    ds_read_b64_tr_b16 a[46:47], v9 offset:2304
    s_add_u32 s57, s57, 31744
    buffer_load_dwordx4 v12, s[20:23], s57 offen offset:3072 lds
    s_add_u32 m0, s52, 65536
    s_lshl_b32 s57, s79, 7
    buffer_load_dwordx4 v12, s[20:23], s57 offen offset:0 lds
    s_add_u32 s57, s57, 31744
    buffer_load_dwordx4 v12, s[20:23], s57 offen offset:1024 lds
    s_waitcnt vmcnt(11)
    ds_read_b64_tr_b16 a[48:49], v8 offset:16384
    ds_read_b64_tr_b16 a[50:51], v8 offset:18432
    ds_read_b64_tr_b16 a[52:53], v9 offset:16384
    ds_read_b64_tr_b16 a[54:55], v9 offset:18432
    s_add_u32 s57, s57, 31744
    buffer_load_dwordx4 v12, s[20:23], s57 offen offset:2048 lds
    ds_read_b64_tr_b16 a[56:57], v8 offset:16640
    ds_read_b64_tr_b16 a[58:59], v8 offset:18688
    ds_read_b64_tr_b16 a[60:61], v9 offset:16640
    ds_read_b64_tr_b16 a[62:63], v9 offset:18688
    s_add_u32 s57, s57, 31744
    buffer_load_dwordx4 v12, s[20:23], s57 offen offset:3072 lds
    s_waitcnt vmcnt(11)
    s_barrier
    s_cmp_lg_u32 s44, 0
    s_cbranch_scc1 L_nopub6
    s_lshl_b32 s60, s51, 5
    s_add_u32 s60, s60, s50
    s_lshl_b32 s60, s60, 7
    s_add_u32 s60, s60, 12713984
    v_mov_b32 v30, s47
    s_mov_b64 exec, 1
    buffer_store_dword v30, off, s[24:27], s60 sc1
    s_mov_b64 exec, -1
L_nopub6:
L_p3join:
    v_lshlrev_b32 v176, 16, v216
    v_and_b32 v177, s61, v216
    v_lshlrev_b32 v178, 16, v217
    v_and_b32 v179, s61, v217
    s_waitcnt lgkmcnt(15)
    s_add_u32 m0, s52, 81920
    s_lshl_b32 s57, s79, 7
    s_add_u32 s57, s57, 131072
    buffer_load_dwordx4 v12, s[20:23], s57 offen offset:0 lds
    v_lshlrev_b32 v180, 16, v218
    v_and_b32 v181, s61, v218
    v_lshlrev_b32 v182, 16, v219
    v_and_b32 v183, s61, v219
    s_add_u32 s57, s57, 31744
    buffer_load_dwordx4 v12, s[20:23], s57 offen offset:1024 lds
    s_waitcnt vmcnt(10)
    ds_read_b64_tr_b16 a[64:65], v8 offset:32768
    ds_read_b64_tr_b16 a[66:67], v8 offset:34816
    ds_read_b64_tr_b16 a[68:69], v9 offset:32768
    ds_read_b64_tr_b16 a[70:71], v9 offset:34816
    s_add_u32 s57, s57, 31744
    buffer_load_dwordx4 v12, s[20:23], s57 offen offset:2048 lds
    ds_read_b64_tr_b16 a[72:73], v8 offset:33024
    ds_read_b64_tr_b16 a[74:75], v8 offset:35072
    ds_read_b64_tr_b16 a[76:77], v9 offset:33024
    ds_read_b64_tr_b16 a[78:79], v9 offset:35072
    v_lshlrev_b32 v184, 16, v220
    v_and_b32 v185, s61, v220
    v_lshlrev_b32 v186, 16, v221
    v_and_b32 v187, s61, v221
    s_add_u32 s57, s57, 31744
    buffer_load_dwordx4 v12, s[20:23], s57 offen offset:3072 lds
    v_lshlrev_b32 v188, 16, v222
    v_and_b32 v189, s61, v222
    v_lshlrev_b32 v190, 16, v223
    v_and_b32 v191, s61, v223
    s_add_u32 m0, s52, 98304
    s_lshl_b32 s57, s80, 7
    buffer_load_dwordx4 v12, s[20:23], s57 offen offset:0 lds
    v_lshlrev_b32 v248, 16, v224
    v_and_b32 v249, s61, v224
    v_lshlrev_b32 v250, 16, v225
    v_and_b32 v251, s61, v225
    s_add_u32 s57, s57, 31744
    buffer_load_dwordx4 v12, s[20:23], s57 offen offset:1024 lds
    s_waitcnt vmcnt(10)
    ds_read_b64_tr_b16 a[80:81], v6 offset:0
    ds_read_b64_tr_b16 a[82:83], v6 offset:2048
    ds_read_b64_tr_b16 a[84:85], v7 offset:0
    ds_read_b64_tr_b16 a[86:87], v7 offset:2048
    v_lshlrev_b32 v231, 16, v228
    v_lshlrev_b32 v230, 16, v228
    v_lshlrev_b32 v229, 16, v228
    v_lshlrev_b32 v228, 16, v228
    ds_read_b64_tr_b16 a[88:89], v6 offset:256
    ds_read_b64_tr_b16 a[90:91], v6 offset:2304
    ds_read_b64_tr_b16 a[92:93], v7 offset:256
    ds_read_b64_tr_b16 a[94:95], v7 offset:2304
    s_add_u32 s57, s57, 31744
    buffer_load_dwordx4 v12, s[20:23], s57 offen offset:2048 lds
    s_add_u32 s57, s57, 31744
    buffer_load_dwordx4 v12, s[20:23], s57 offen offset:3072 lds
    s_waitcnt lgkmcnt(15)
    s_add_u32 m0, s52, 114688
    s_lshl_b32 s57, s80, 7
    s_add_u32 s57, s57, 131072
    buffer_load_dwordx4 v12, s[20:23], s57 offen offset:0 lds
    s_add_u32 s57, s57, 31744
    buffer_load_dwordx4 v12, s[20:23], s57 offen offset:1024 lds
    s_waitcnt vmcnt(10)
    ds_read_b64_tr_b16 a[96:97], v6 offset:16384
    ds_read_b64_tr_b16 a[98:99], v6 offset:18432
    ds_read_b64_tr_b16 a[100:101], v7 offset:16384
    ds_read_b64_tr_b16 a[102:103], v7 offset:18432
    s_add_u32 s57, s57, 31744
    buffer_load_dwordx4 v12, s[20:23], s57 offen offset:2048 lds
    ds_read_b64_tr_b16 a[104:105], v6 offset:16640
    ds_read_b64_tr_b16 a[106:107], v6 offset:18688
    ds_read_b64_tr_b16 a[108:109], v7 offset:16640
    ds_read_b64_tr_b16 a[110:111], v7 offset:18688
    s_add_u32 s57, s57, 31744
    buffer_load_dwordx4 v12, s[20:23], s57 offen offset:3072 lds
    s_add_u32 m0, s52, 131072
    s_lshl_b32 s57, s81, 7
    buffer_load_dwordx4 v12, s[20:23], s57 offen offset:0 lds
    s_add_u32 s57, s57, 31744
    buffer_load_dwordx4 v12, s[20:23], s57 offen offset:1024 lds
    s_waitcnt vmcnt(10)
    ds_read_b64_tr_b16 a[112:113], v6 offset:32768
    ds_read_b64_tr_b16 a[114:115], v6 offset:34816
    ds_read_b64_tr_b16 a[116:117], v7 offset:32768
    ds_read_b64_tr_b16 a[118:119], v7 offset:34816
    s_add_u32 s57, s57, 31744
    buffer_load_dwordx4 v12, s[20:23], s57 offen offset:2048 lds
    ds_read_b64_tr_b16 a[120:121], v6 offset:33024
    ds_read_b64_tr_b16 a[122:123], v6 offset:35072
    ds_read_b64_tr_b16 a[124:125], v7 offset:33024
    ds_read_b64_tr_b16 a[126:127], v7 offset:35072
    s_add_u32 s57, s57, 31744
    buffer_load_dwordx4 v12, s[20:23], s57 offen offset:3072 lds
    s_waitcnt lgkmcnt(15)
    s_add_u32 m0, s52, 147456
    s_lshl_b32 s57, s81, 7
    s_add_u32 s57, s57, 131072
    buffer_load_dwordx4 v12, s[20:23], s57 offen offset:0 lds
    s_add_u32 s57, s57, 31744
    buffer_load_dwordx4 v12, s[20:23], s57 offen offset:1024 lds
    s_waitcnt vmcnt(10)
    ds_read_b64_tr_b16 a[128:129], v6 offset:49152
    ds_read_b64_tr_b16 a[130:131], v6 offset:51200
    ds_read_b64_tr_b16 a[132:133], v7 offset:49152
    ds_read_b64_tr_b16 a[134:135], v7 offset:51200
    s_add_u32 s57, s57, 31744
    buffer_load_dwordx4 v12, s[20:23], s57 offen offset:2048 lds
    ds_read_b64_tr_b16 a[136:137], v6 offset:49408
    ds_read_b64_tr_b16 a[138:139], v6 offset:51456
    ds_read_b64_tr_b16 a[140:141], v7 offset:49408
    ds_read_b64_tr_b16 a[142:143], v7 offset:51456
    s_add_u32 s57, s57, 31744
    buffer_load_dwordx4 v12, s[20:23], s57 offen offset:3072 lds
    s_add_u32 m0, s52, 49152
    s_lshl_b32 s57, s82, 7
    buffer_load_dwordx4 v12, s[20:23], s57 offen offset:0 lds
    s_add_u32 s57, s57, 31744
    buffer_load_dwordx4 v12, s[20:23], s57 offen offset:1024 lds
    s_waitcnt vmcnt(10)
    ds_read_b64_tr_b16 a[144:145], v8 offset:0
    ds_read_b64_tr_b16 a[146:147], v8 offset:2048
    ds_read_b64_tr_b16 a[148:149], v9 offset:0
    ds_read_b64_tr_b16 a[150:151], v9 offset:2048
    s_add_u32 s57, s57, 31744
    buffer_load_dwordx4 v12, s[20:23], s57 offen offset:2048 lds
    ds_read_b64_tr_b16 a[152:153], v8 offset:256
    ds_read_b64_tr_b16 a[154:155], v8 offset:2304
    ds_read_b64_tr_b16 a[156:157], v9 offset:256
    ds_read_b64_tr_b16 a[158:159], v9 offset:2304
    s_add_u32 s57, s57, 31744
    buffer_load_dwordx4 v12, s[20:23], s57 offen offset:3072 lds
    s_waitcnt lgkmcnt(15)
    s_add_u32 m0, s52, 65536
    s_lshl_b32 s57, s82, 7
    s_add_u32 s57, s57, 131072
    buffer_load_dwordx4 v12, s[20:23], s57 offen offset:0 lds
    s_add_u32 s57, s57, 31744
    buffer_load_dwordx4 v12, s[20:23], s57 offen offset:1024 lds
    s_waitcnt vmcnt(10)
    ds_read_b64_tr_b16 a[160:161], v8 offset:16384
    ds_read_b64_tr_b16 a[162:163], v8 offset:18432
    ds_read_b64_tr_b16 a[164:165], v9 offset:16384
    ds_read_b64_tr_b16 a[166:167], v9 offset:18432
    s_add_u32 s57, s57, 31744
    buffer_load_dwordx4 v12, s[20:23], s57 offen offset:2048 lds
    ds_read_b64_tr_b16 a[168:169], v8 offset:16640
    ds_read_b64_tr_b16 a[170:171], v8 offset:18688
    ds_read_b64_tr_b16 a[172:173], v9 offset:16640
    ds_read_b64_tr_b16 a[174:175], v9 offset:18688
    s_add_u32 s57, s57, 31744
    buffer_load_dwordx4 v12, s[20:23], s57 offen offset:3072 lds
    s_add_u32 m0, s52, 81920
    s_mov_b32 s57, s75
    buffer_load_dwordx4 v15, s[12:15], s57 offen offset:0 lds
    s_add_u32 s57, s57, 24064
    buffer_load_dwordx4 v15, s[12:15], s57 offen offset:1024 lds
    s_waitcnt vmcnt(10)
    ds_read_b64_tr_b16 a[176:177], v8 offset:32768
    ds_read_b64_tr_b16 a[178:179], v8 offset:34816
    ds_read_b64_tr_b16 a[180:181], v9 offset:32768
    ds_read_b64_tr_b16 a[182:183], v9 offset:34816
    s_add_u32 s57, s57, 24064
    buffer_load_dwordx4 v15, s[12:15], s57 offen offset:2048 lds
    ds_read_b64_tr_b16 a[184:185], v8 offset:33024
    ds_read_b64_tr_b16 a[186:187], v8 offset:35072
    ds_read_b64_tr_b16 a[188:189], v9 offset:33024
    ds_read_b64_tr_b16 a[190:191], v9 offset:35072
    s_add_u32 s57, s57, 24064
    buffer_load_dwordx4 v15, s[12:15], s57 offen offset:3072 lds
    s_waitcnt lgkmcnt(15)
    s_add_u32 m0, s52, 98304
    s_mov_b32 s57, 0
    buffer_load_dwordx4 v13, s[12:15], s57 offen offset:0 lds
    s_add_u32 s57, s57, 6144
    buffer_load_dwordx4 v14, s[12:15], s57 offen offset:1024 lds
    s_waitcnt vmcnt(10)
    ds_read_b64_tr_b16 a[192:193], v6 offset:0
    ds_read_b64_tr_b16 a[194:195], v6 offset:2048
    ds_read_b64_tr_b16 a[196:197], v7 offset:0
    ds_read_b64_tr_b16 a[198:199], v7 offset:2048
    s_add_u32 s57, s57, 6144
    buffer_load_dwordx4 v13, s[12:15], s57 offen offset:2048 lds
    ds_read_b64_tr_b16 a[200:201], v6 offset:256
    ds_read_b64_tr_b16 a[202:203], v6 offset:2304
    ds_read_b64_tr_b16 a[204:205], v7 offset:256
    ds_read_b64_tr_b16 a[206:207], v7 offset:2304
    s_add_u32 s57, s57, 6144
    buffer_load_dwordx4 v14, s[12:15], s57 offen offset:3072 lds
    s_add_u32 m0, s52, 114688
    s_mov_b32 s57, 25088
    buffer_load_dwordx4 v13, s[12:15], s57 offen offset:0 lds
    s_add_u32 s57, s57, 6144
    buffer_load_dwordx4 v14, s[12:15], s57 offen offset:1024 lds
    s_waitcnt vmcnt(10)
    ds_read_b64_tr_b16 a[208:209], v6 offset:16384
    ds_read_b64_tr_b16 a[210:211], v6 offset:18432
    ds_read_b64_tr_b16 a[212:213], v7 offset:16384
    ds_read_b64_tr_b16 a[214:215], v7 offset:18432
    buffer_load_dword v17, v20, s[24:27], 0 offen sc1
    ds_read_b64_tr_b16 a[216:217], v6 offset:16640
    ds_read_b64_tr_b16 a[218:219], v6 offset:18688
    ds_read_b64_tr_b16 a[220:221], v7 offset:16640
    ds_read_b64_tr_b16 a[222:223], v7 offset:18688
    s_add_u32 s57, s57, 6144
    buffer_load_dwordx4 v13, s[12:15], s57 offen offset:2048 lds
    s_add_u32 s57, s57, 6144
    buffer_load_dwordx4 v14, s[12:15], s57 offen offset:3072 lds
    s_waitcnt lgkmcnt(15)
    s_add_u32 m0, s52, 131072
    s_mov_b32 s57, 50176
    buffer_load_dwordx4 v13, s[12:15], s57 offen offset:0 lds
    s_add_u32 s57, s57, 6144
    buffer_load_dwordx4 v14, s[12:15], s57 offen offset:1024 lds
    s_add_u32 s57, s57, 6144
    buffer_load_dwordx4 v13, s[12:15], s57 offen offset:2048 lds
    s_add_u32 s57, s57, 6144
    buffer_load_dwordx4 v14, s[12:15], s57 offen offset:3072 lds
    s_add_u32 m0, s52, 147456
    s_mov_b32 s57, 75264
    buffer_load_dwordx4 v13, s[12:15], s57 offen offset:0 lds
    s_add_u32 s57, s57, 6144
    buffer_load_dwordx4 v14, s[12:15], s57 offen offset:1024 lds
    s_add_u32 s57, s57, 6144
    buffer_load_dwordx4 v13, s[12:15], s57 offen offset:2048 lds
    s_add_u32 s57, s57, 6144
    buffer_load_dwordx4 v14, s[12:15], s57 offen offset:3072 lds
    s_waitcnt vmcnt(10)
    v_cmp_ne_u32 vcc, s47, v17
    s_nop 0
    s_cbranch_vccz L_ok8
    s_mov_b32 s59, 20000
L_spin7:
    buffer_load_dword v17, v20, s[24:27], 0 offen sc1
    s_waitcnt vmcnt(0)
    v_cmp_ne_u32 vcc, s47, v17
    s_nop 0
    s_cbranch_vccz L_ok8
    s_sub_u32 s59, s59, 1
    s_cbranch_scc0 L_spin7
L_ok8:
    s_cmp_ge_u32 s89, 4
    s_cbranch_scc1 L_p3_alt
    s_mov_b32 s66, s68
    s_add_u32 s58, s66, s76
    buffer_load_dwordx4 v[144:147], v23, s[24:27], s58 offen offset:0 sc1
    buffer_load_dwordx4 v[148:151], v23, s[24:27], s58 offen offset:1024 sc1
    s_add_u32 s58, s66, s77
    buffer_load_dwordx4 v[152:155], v23, s[24:27], s58 offen offset:0 sc1
    buffer_load_dwordx4 v[156:159], v23, s[24:27], s58 offen offset:1024 sc1
    s_add_u32 s58, s66, s78
    buffer_load_dwordx4 v[112:115], v23, s[24:27], s58 offen offset:0 sc1
    buffer_load_dwordx4 v[116:119], v23, s[24:27], s58 offen offset:1024 sc1
    s_add_u32 s58, s66, s79
    buffer_load_dwordx4 v[120:123], v23, s[24:27], s58 offen offset:0 sc1
    buffer_load_dwordx4 v[124:127], v23, s[24:27], s58 offen offset:1024 sc1
    s_add_u32 s58, s66, s80
    buffer_load_dwordx4 v[128:131], v23, s[24:27], s58 offen offset:0 sc1
    buffer_load_dwordx4 v[132:135], v23, s[24:27], s58 offen offset:1024 sc1
    s_add_u32 s58, s66, s81
    buffer_load_dwordx4 v[136:139], v23, s[24:27], s58 offen offset:0 sc1
    s_waitcnt vmcnt(10)
    v_mfma_f32_16x16x32_bf16 v[96:99], v[144:147], a[0:3], v[228:231]
    v_mfma_f32_16x16x32_bf16 v[100:103], v[144:147], a[4:7], 0
    buffer_load_dwordx4 v[140:143], v23, s[24:27], s58 offen offset:1024 sc1
    v_mfma_f32_16x16x32_bf16 v[104:107], v[144:147], a[8:11], 0
    v_mfma_f32_16x16x32_bf16 v[108:111], v[144:147], a[12:15], 0
    s_waitcnt vmcnt(10)
    v_mfma_f32_16x16x32_bf16 v[96:99], v[148:151], a[16:19], v[96:99]
    s_add_u32 s58, s66, s82
    v_mfma_f32_16x16x32_bf16 v[100:103], v[148:151], a[20:23], v[100:103]
    buffer_load_dwordx4 v[144:147], v23, s[24:27], s58 offen offset:0 sc1
    v_mfma_f32_16x16x32_bf16 v[104:107], v[148:151], a[24:27], v[104:107]
    v_mfma_f32_16x16x32_bf16 v[108:111], v[148:151], a[28:31], v[108:111]
    s_waitcnt vmcnt(10)
    v_mfma_f32_16x16x32_bf16 v[96:99], v[152:155], a[32:35], v[96:99]
    v_mfma_f32_16x16x32_bf16 v[100:103], v[152:155], a[36:39], v[100:103]
    buffer_load_dwordx4 v[148:151], v23, s[24:27], s58 offen offset:1024 sc1
    v_mfma_f32_16x16x32_bf16 v[104:107], v[152:155], a[40:43], v[104:107]
    v_mfma_f32_16x16x32_bf16 v[108:111], v[152:155], a[44:47], v[108:111]
    s_waitcnt vmcnt(10)
    v_mfma_f32_16x16x32_bf16 v[96:99], v[156:159], a[48:51], v[96:99]
    s_add_u32 s66, s69, 175872
    s_add_u32 s58, s66, s76
    v_mfma_f32_16x16x32_bf16 v[100:103], v[156:159], a[52:55], v[100:103]
    buffer_load_dwordx4 v[152:155], v23, s[24:27], s58 offen offset:0 sc1
    v_mfma_f32_16x16x32_bf16 v[104:107], v[156:159], a[56:59], v[104:107]
    v_mfma_f32_16x16x32_bf16 v[108:111], v[156:159], a[60:63], v[108:111]
    s_waitcnt vmcnt(10)
    v_mfma_f32_16x16x32_bf16 v[96:99], v[112:115], a[64:67], v[96:99]
    v_mfma_f32_16x16x32_bf16 v[100:103], v[112:115], a[68:71], v[100:103]
    buffer_load_dwordx4 v[156:159], v23, s[24:27], s58 offen offset:1024 sc1
    v_mfma_f32_16x16x32_bf16 v[104:107], v[112:115], a[72:75], v[104:107]
    v_mfma_f32_16x16x32_bf16 v[108:111], v[112:115], a[76:79], v[108:111]
    s_waitcnt vmcnt(10)
    v_mfma_f32_16x16x32_bf16 v[96:99], v[116:119], a[80:83], v[96:99]
    s_add_u32 s58, s66, s77
    v_mfma_f32_16x16x32_bf16 v[100:103], v[116:119], a[84:87], v[100:103]
    buffer_load_dwordx4 v[112:115], v23, s[24:27], s58 offen offset:0 sc1
    v_mfma_f32_16x16x32_bf16 v[104:107], v[116:119], a[88:91], v[104:107]
    v_mfma_f32_16x16x32_bf16 v[108:111], v[116:119], a[92:95], v[108:111]
    s_waitcnt vmcnt(10)
    v_mfma_f32_16x16x32_bf16 v[96:99], v[120:123], a[96:99], v[96:99]
    v_mfma_f32_16x16x32_bf16 v[100:103], v[120:123], a[100:103], v[100:103]
    buffer_load_dwordx4 v[116:119], v23, s[24:27], s58 offen offset:1024 sc1
    v_mfma_f32_16x16x32_bf16 v[104:107], v[120:123], a[104:107], v[104:107]
    v_mfma_f32_16x16x32_bf16 v[108:111], v[120:123], a[108:111], v[108:111]
    s_waitcnt vmcnt(10)
    v_mfma_f32_16x16x32_bf16 v[96:99], v[124:127], a[112:115], v[96:99]
    s_add_u32 s58, s66, s78
    v_mfma_f32_16x16x32_bf16 v[100:103], v[124:127], a[116:119], v[100:103]
    buffer_load_dwordx4 v[120:123], v23, s[24:27], s58 offen offset:0 sc1
    v_mfma_f32_16x16x32_bf16 v[104:107], v[124:127], a[120:123], v[104:107]
    v_mfma_f32_16x16x32_bf16 v[108:111], v[124:127], a[124:127], v[108:111]
    s_waitcnt vmcnt(10)
    v_mfma_f32_16x16x32_bf16 v[96:99], v[128:131], a[128:131], v[96:99]
    v_mfma_f32_16x16x32_bf16 v[100:103], v[128:131], a[132:135], v[100:103]
    buffer_load_dwordx4 v[124:127], v23, s[24:27], s58 offen offset:1024 sc1
    v_mfma_f32_16x16x32_bf16 v[104:107], v[128:131], a[136:139], v[104:107]
    v_mfma_f32_16x16x32_bf16 v[108:111], v[128:131], a[140:143], v[108:111]
    s_waitcnt vmcnt(10)
    v_mfma_f32_16x16x32_bf16 v[96:99], v[132:135], a[144:147], v[96:99]
    s_add_u32 s58, s66, s79
    v_mfma_f32_16x16x32_bf16 v[100:103], v[132:135], a[148:151], v[100:103]
    buffer_load_dwordx4 v[128:131], v23, s[24:27], s58 offen offset:0 sc1
    v_mfma_f32_16x16x32_bf16 v[104:107], v[132:135], a[152:155], v[104:107]
    v_mfma_f32_16x16x32_bf16 v[108:111], v[132:135], a[156:159], v[108:111]
    s_waitcnt vmcnt(10)
    v_mfma_f32_16x16x32_bf16 v[96:99], v[136:139], a[160:163], v[96:99]
    v_mfma_f32_16x16x32_bf16 v[100:103], v[136:139], a[164:167], v[100:103]
    buffer_load_dwordx4 v[132:135], v23, s[24:27], s58 offen offset:1024 sc1
    v_mfma_f32_16x16x32_bf16 v[104:107], v[136:139], a[168:171], v[104:107]
    v_mfma_f32_16x16x32_bf16 v[108:111], v[136:139], a[172:175], v[108:111]
    s_waitcnt vmcnt(10)
    v_mfma_f32_16x16x32_bf16 v[96:99], v[140:143], a[176:179], v[96:99]
    s_add_u32 s58, s66, s80
    v_mfma_f32_16x16x32_bf16 v[100:103], v[140:143], a[180:183], v[100:103]
    buffer_load_dwordx4 v[136:139], v23, s[24:27], s58 offen offset:0 sc1
    v_mfma_f32_16x16x32_bf16 v[104:107], v[140:143], a[184:187], v[104:107]
    v_mfma_f32_16x16x32_bf16 v[108:111], v[140:143], a[188:191], v[108:111]
    s_waitcnt vmcnt(10)
    s_waitcnt lgkmcnt(8)
    v_mfma_f32_16x16x32_bf16 v[96:99], v[144:147], a[192:195], v[96:99]
    v_mfma_f32_16x16x32_bf16 v[100:103], v[144:147], a[196:199], v[100:103]
    buffer_load_dwordx4 v[140:143], v23, s[24:27], s58 offen offset:1024 sc1
    v_mfma_f32_16x16x32_bf16 v[104:107], v[144:147], a[200:203], v[104:107]
    v_mfma_f32_16x16x32_bf16 v[108:111], v[144:147], a[204:207], v[108:111]
    s_waitcnt vmcnt(10)
    s_waitcnt lgkmcnt(0)
    v_mfma_f32_16x16x32_bf16 v[96:99], v[148:151], a[208:211], v[96:99]
    s_add_u32 s58, s66, s81
    v_mfma_f32_16x16x32_bf16 v[100:103], v[148:151], a[212:215], v[100:103]
    buffer_load_dwordx4 v[144:147], v23, s[24:27], s58 offen offset:0 sc1
    v_mfma_f32_16x16x32_bf16 v[104:107], v[148:151], a[216:219], v[104:107]
    v_mfma_f32_16x16x32_bf16 v[108:111], v[148:151], a[220:223], v[108:111]
L_p3_join:
    s_waitcnt vmcnt(10)
    v_mfma_f32_16x16x32_bf16 v[80:83], v[152:155], a[0:3], v[228:231]
    v_mfma_f32_16x16x32_bf16 v[84:87], v[152:155], a[4:7], 0
    buffer_load_dwordx4 v[148:151], v23, s[24:27], s58 offen offset:1024 sc1
    v_mfma_f32_16x16x32_bf16 v[88:91], v[152:155], a[8:11], 0
    v_mfma_f32_16x16x32_bf16 v[92:95], v[152:155], a[12:15], 0
    s_waitcnt vmcnt(10)
    v_mfma_f32_16x16x32_bf16 v[80:83], v[156:159], a[16:19], v[80:83]
    s_add_u32 s58, s66, s82
    v_mfma_f32_16x16x32_bf16 v[84:87], v[156:159], a[20:23], v[84:87]
    buffer_load_dwordx4 v[152:155], v23, s[24:27], s58 offen offset:0 sc1
    v_mfma_f32_16x16x32_bf16 v[88:91], v[156:159], a[24:27], v[88:91]
    ds_write_b128 v232, v[100:103] offset:3072
    v_mfma_f32_16x16x32_bf16 v[92:95], v[156:159], a[28:31], v[92:95]
    s_waitcnt vmcnt(10)
    v_mfma_f32_16x16x32_bf16 v[80:83], v[112:115], a[32:35], v[80:83]
    v_mfma_f32_16x16x32_bf16 v[84:87], v[112:115], a[36:39], v[84:87]
    buffer_load_dwordx4 v[156:159], v23, s[24:27], s58 offen offset:1024 sc1
    v_mfma_f32_16x16x32_bf16 v[88:91], v[112:115], a[40:43], v[88:91]
    ds_write_b128 v232, v[104:107] offset:19456
    v_mfma_f32_16x16x32_bf16 v[92:95], v[112:115], a[44:47], v[92:95]
    s_waitcnt vmcnt(10)
    v_mfma_f32_16x16x32_bf16 v[80:83], v[116:119], a[48:51], v[80:83]
    s_add_u32 s66, s69, 117248
    s_add_u32 s58, s66, s76
    v_mfma_f32_16x16x32_bf16 v[84:87], v[116:119], a[52:55], v[84:87]
    buffer_load_dwordx4 v[112:115], v23, s[24:27], s58 offen offset:0 sc1
    v_mfma_f32_16x16x32_bf16 v[88:91], v[116:119], a[56:59], v[88:91]
    ds_write_b128 v232, v[108:111] offset:35840
    v_mfma_f32_16x16x32_bf16 v[92:95], v[116:119], a[60:63], v[92:95]
    s_waitcnt vmcnt(10)
    v_mfma_f32_16x16x32_bf16 v[80:83], v[120:123], a[64:67], v[80:83]
    v_mfma_f32_16x16x32_bf16 v[84:87], v[120:123], a[68:71], v[84:87]
    buffer_load_dwordx4 v[116:119], v23, s[24:27], s58 offen offset:1024 sc1
    v_mfma_f32_16x16x32_bf16 v[88:91], v[120:123], a[72:75], v[88:91]
    v_mfma_f32_16x16x32_bf16 v[92:95], v[120:123], a[76:79], v[92:95]
    s_waitcnt vmcnt(10)
    v_mfma_f32_16x16x32_bf16 v[80:83], v[124:127], a[80:83], v[80:83]
    s_add_u32 s58, s66, s77
    v_mfma_f32_16x16x32_bf16 v[84:87], v[124:127], a[84:87], v[84:87]
    buffer_load_dwordx4 v[120:123], v23, s[24:27], s58 offen offset:0 sc1
    v_mfma_f32_16x16x32_bf16 v[88:91], v[124:127], a[88:91], v[88:91]
    s_waitcnt lgkmcnt(0)
    s_barrier
    v_mfma_f32_16x16x32_bf16 v[92:95], v[124:127], a[92:95], v[92:95]
    s_waitcnt vmcnt(10)
    v_mfma_f32_16x16x32_bf16 v[80:83], v[128:131], a[96:99], v[80:83]
    v_mfma_f32_16x16x32_bf16 v[84:87], v[128:131], a[100:103], v[84:87]
    buffer_load_dwordx4 v[124:127], v23, s[24:27], s58 offen offset:1024 sc1
    v_mfma_f32_16x16x32_bf16 v[88:91], v[128:131], a[104:107], v[88:91]
    ds_read_b128 v[100:103], v233 offset:3072
    ds_read_b128 v[104:107], v234 offset:19456
    v_mfma_f32_16x16x32_bf16 v[92:95], v[128:131], a[108:111], v[92:95]
    ds_read_b128 v[108:111], v235 offset:35840
    s_waitcnt vmcnt(10)
    v_mfma_f32_16x16x32_bf16 v[80:83], v[132:135], a[112:115], v[80:83]
    s_add_u32 s58, s66, s78
    v_mfma_f32_16x16x32_bf16 v[84:87], v[132:135], a[116:119], v[84:87]
    buffer_load_dwordx4 v[128:131], v23, s[24:27], s58 offen offset:0 sc1
    v_mfma_f32_16x16x32_bf16 v[88:91], v[132:135], a[120:123], v[88:91]
    ds_read_b64_tr_b16 v[160:161], v16 offset:0
    v_mfma_f32_16x16x32_bf16 v[92:95], v[132:135], a[124:127], v[92:95]
    ds_read_b64_tr_b16 v[162:163], v16 offset:512
    s_waitcnt vmcnt(10)
    v_mfma_f32_16x16x32_bf16 v[80:83], v[136:139], a[128:131], v[80:83]
    s_waitcnt lgkmcnt(2)
    v_mfma_f32_16x16x32_bf16 v[84:87], v[136:139], a[132:135], v[84:87]
    buffer_load_dwordx4 v[132:135], v23, s[24:27], s58 offen offset:1024 sc1
    v_mfma_f32_16x16x32_bf16 v[88:91], v[136:139], a[136:139], v[88:91]
    v_add_f32 v96, v96, v100
    v_add_f32 v97, v97, v101
    ds_read_b64_tr_b16 v[164:165], v16 offset:1024
    v_mfma_f32_16x16x32_bf16 v[92:95], v[136:139], a[140:143], v[92:95]
    ds_read_b64_tr_b16 v[166:167], v16 offset:1536
    s_waitcnt vmcnt(10)
    v_mfma_f32_16x16x32_bf16 v[80:83], v[140:143], a[144:147], v[80:83]
    s_add_u32 s58, s66, s79
    v_add_f32 v98, v98, v102
    v_mfma_f32_16x16x32_bf16 v[84:87], v[140:143], a[148:151], v[84:87]
    buffer_load_dwordx4 v[136:139], v23, s[24:27], s58 offen offset:0 sc1
    v_mfma_f32_16x16x32_bf16 v[88:91], v[140:143], a[152:155], v[88:91]
    v_add_f32 v99, v99, v103
    v_add_f32 v96, v96, v104
    ds_read_b64_tr_b16 v[168:169], v16 offset:2048
    v_mfma_f32_16x16x32_bf16 v[92:95], v[140:143], a[156:159], v[92:95]
    ds_read_b64_tr_b16 v[170:171], v16 offset:2560
    s_waitcnt vmcnt(10)
    v_mfma_f32_16x16x32_bf16 v[80:83], v[144:147], a[160:163], v[80:83]
    v_add_f32 v97, v97, v105
    v_mfma_f32_16x16x32_bf16 v[84:87], v[144:147], a[164:167], v[84:87]
    buffer_load_dwordx4 v[140:143], v23, s[24:27], s58 offen offset:1024 sc1
    v_mfma_f32_16x16x32_bf16 v[88:91], v[144:147], a[168:171], v[88:91]
    v_add_f32 v98, v98, v106
    v_add_f32 v99, v99, v107
    ds_read_b64_tr_b16 v[172:173], v16 offset:3072
    v_mfma_f32_16x16x32_bf16 v[92:95], v[144:147], a[172:175], v[92:95]
    ds_read_b64_tr_b16 v[174:175], v16 offset:3584
    s_waitcnt vmcnt(10)
    v_mfma_f32_16x16x32_bf16 v[80:83], v[148:151], a[176:179], v[80:83]
    s_add_u32 s58, s66, s80
    v_mfma_f32_16x16x32_bf16 v[84:87], v[148:151], a[180:183], v[84:87]
    buffer_load_dwordx4 v[144:147], v23, s[24:27], s58 offen offset:0 sc1
    v_mfma_f32_16x16x32_bf16 v[88:91], v[148:151], a[184:187], v[88:91]
    v_add_f32 v96, v96, v108
    v_add_f32 v97, v97, v109
    v_mfma_f32_16x16x32_bf16 v[92:95], v[148:151], a[188:191], v[92:95]
    v_add_f32 v98, v98, v110
    s_waitcnt vmcnt(10)
    v_mfma_f32_16x16x32_bf16 v[80:83], v[152:155], a[192:195], v[80:83]
    v_mfma_f32_16x16x32_bf16 v[84:87], v[152:155], a[196:199], v[84:87]
    buffer_load_dwordx4 v[148:151], v23, s[24:27], s58 offen offset:1024 sc1
    v_mfma_f32_16x16x32_bf16 v[88:91], v[152:155], a[200:203], v[88:91]
    v_add_f32 v99, v99, v111
    v_mfma_f32_16x16x32_bf16 v[92:95], v[152:155], a[204:207], v[92:95]
    s_waitcnt vmcnt(10)
    v_mfma_f32_16x16x32_bf16 v[80:83], v[156:159], a[208:211], v[80:83]
    s_add_u32 s58, s66, s81
    v_mfma_f32_16x16x32_bf16 v[84:87], v[156:159], a[212:215], v[84:87]
    buffer_load_dwordx4 v[152:155], v23, s[24:27], s58 offen offset:0 sc1
    v_mfma_f32_16x16x32_bf16 v[88:91], v[156:159], a[216:219], v[88:91]
    v_mfma_f32_16x16x32_bf16 v[92:95], v[156:159], a[220:223], v[92:95]
    s_waitcnt vmcnt(10)
    v_mfma_f32_16x16x32_bf16 v[64:67], v[112:115], a[0:3], v[228:231]
    v_mfma_f32_16x16x32_bf16 v[68:71], v[112:115], a[4:7], 0
    buffer_load_dwordx4 v[156:159], v23, s[24:27], s58 offen offset:1024 sc1
    v_mfma_f32_16x16x32_bf16 v[72:75], v[112:115], a[8:11], 0
    ds_read_b64_tr_b16 v[192:193], v16 offset:4096
    v_mfma_f32_16x16x32_bf16 v[76:79], v[112:115], a[12:15], 0
    ds_read_b64_tr_b16 v[194:195], v16 offset:4608
    s_waitcnt vmcnt(10)
    v_mfma_f32_16x16x32_bf16 v[64:67], v[116:119], a[16:19], v[64:67]
    s_add_u32 s58, s66, s82
    v_mfma_f32_16x16x32_bf16 v[68:71], v[116:119], a[20:23], v[68:71]
    buffer_load_dwordx4 v[112:115], v23, s[24:27], s58 offen offset:0 sc1
    v_mfma_f32_16x16x32_bf16 v[72:75], v[116:119], a[24:27], v[72:75]
    ds_read_b64_tr_b16 v[196:197], v16 offset:5120
    ds_read_b64_tr_b16 v[198:199], v16 offset:5632
    v_mfma_f32_16x16x32_bf16 v[76:79], v[116:119], a[28:31], v[76:79]
    ds_write_b128 v232, v[84:87] offset:49152
    s_waitcnt vmcnt(10)
    v_mfma_f32_16x16x32_bf16 v[64:67], v[120:123], a[32:35], v[64:67]
    v_mfma_f32_16x16x32_bf16 v[68:71], v[120:123], a[36:39], v[68:71]
    buffer_load_dwordx4 v[116:119], v23, s[24:27], s58 offen offset:1024 sc1
    v_mfma_f32_16x16x32_bf16 v[72:75], v[120:123], a[40:43], v[72:75]
    ds_read_b64_tr_b16 v[200:201], v16 offset:6144
    ds_read_b64_tr_b16 v[202:203], v16 offset:6656
    v_mfma_f32_16x16x32_bf16 v[76:79], v[120:123], a[44:47], v[76:79]
    ds_write_b128 v232, v[88:91] offset:50176
    s_waitcnt vmcnt(10)
    v_mfma_f32_16x16x32_bf16 v[64:67], v[124:127], a[48:51], v[64:67]
    s_add_u32 s66, s69, 58624
    s_add_u32 s58, s66, s76
    v_mfma_f32_16x16x32_bf16 v[68:71], v[124:127], a[52:55], v[68:71]
    buffer_load_dwordx4 v[120:123], v23, s[24:27], s58 offen offset:0 sc1
    v_mfma_f32_16x16x32_bf16 v[72:75], v[124:127], a[56:59], v[72:75]
    ds_read_b64_tr_b16 v[204:205], v16 offset:7168
    ds_read_b64_tr_b16 v[206:207], v16 offset:7680
    v_mfma_f32_16x16x32_bf16 v[76:79], v[124:127], a[60:63], v[76:79]
    ds_write_b128 v232, v[92:95] offset:51200
    s_waitcnt vmcnt(10)
    v_mfma_f32_16x16x32_bf16 v[64:67], v[128:131], a[64:67], v[64:67]
    v_mfma_f32_16x16x32_bf16 v[68:71], v[128:131], a[68:71], v[68:71]
    buffer_load_dwordx4 v[124:127], v23, s[24:27], s58 offen offset:1024 sc1
    v_mfma_f32_16x16x32_bf16 v[72:75], v[128:131], a[72:75], v[72:75]
    ds_read_b64_tr_b16 v[100:101], v16 offset:8192
    v_mfma_f32_16x16x32_bf16 v[76:79], v[128:131], a[76:79], v[76:79]
    ds_read_b64_tr_b16 v[102:103], v16 offset:8704
    s_waitcnt vmcnt(10)
    v_mfma_f32_16x16x32_bf16 v[64:67], v[132:135], a[80:83], v[64:67]
    s_add_u32 s58, s66, s77
    v_mfma_f32_16x16x32_bf16 v[68:71], v[132:135], a[84:87], v[68:71]
    buffer_load_dwordx4 v[128:131], v23, s[24:27], s58 offen offset:0 sc1
    v_mfma_f32_16x16x32_bf16 v[72:75], v[132:135], a[88:91], v[72:75]
    s_waitcnt lgkmcnt(2)
    s_barrier
    v_mfma_f32_16x16x32_bf16 v[76:79], v[132:135], a[92:95], v[76:79]
    s_waitcnt vmcnt(10)
    v_mfma_f32_16x16x32_bf16 v[64:67], v[136:139], a[96:99], v[64:67]
    v_mfma_f32_16x16x32_bf16 v[68:71], v[136:139], a[100:103], v[68:71]
    buffer_load_dwordx4 v[132:135], v23, s[24:27], s58 offen offset:1024 sc1
    v_mfma_f32_16x16x32_bf16 v[72:75], v[136:139], a[104:107], v[72:75]
    ds_read_b128 v[84:87], v233 offset:49152
    ds_read_b128 v[88:91], v234 offset:50176
    v_mfma_f32_16x16x32_bf16 v[76:79], v[136:139], a[108:111], v[76:79]
    ds_read_b128 v[92:95], v235 offset:51200
    s_waitcnt vmcnt(10)
    v_mfma_f32_16x16x32_bf16 v[64:67], v[140:143], a[112:115], v[64:67]
    s_add_u32 s58, s66, s78
    v_mfma_f32_16x16x32_bf16 v[68:71], v[140:143], a[116:119], v[68:71]
    buffer_load_dwordx4 v[136:139], v23, s[24:27], s58 offen offset:0 sc1
    v_mfma_f32_16x16x32_bf16 v[72:75], v[140:143], a[120:123], v[72:75]
    ds_read_b64_tr_b16 a[224:225], v246 offset:0
    v_mfma_f32_16x16x32_bf16 v[76:79], v[140:143], a[124:127], v[76:79]
    ds_read_b64_tr_b16 a[226:227], v246 offset:512
    s_waitcnt vmcnt(10)
    v_mfma_f32_16x16x32_bf16 v[64:67], v[144:147], a[128:131], v[64:67]
    s_waitcnt lgkmcnt(2)
    v_mfma_f32_16x16x32_bf16 v[68:71], v[144:147], a[132:135], v[68:71]
    buffer_load_dwordx4 v[140:143], v23, s[24:27], s58 offen offset:1024 sc1
    v_mfma_f32_16x16x32_bf16 v[72:75], v[144:147], a[136:139], v[72:75]
    v_add_f32 v80, v80, v84
    v_add_f32 v81, v81, v85
    ds_read_b64_tr_b16 a[228:229], v247 offset:0
    v_mfma_f32_16x16x32_bf16 v[76:79], v[144:147], a[140:143], v[76:79]
    ds_read_b64_tr_b16 a[230:231], v247 offset:512
    s_waitcnt vmcnt(10)
    v_mfma_f32_16x16x32_bf16 v[64:67], v[148:151], a[144:147], v[64:67]
    s_add_u32 s58, s66, s79
    v_add_f32 v82, v82, v86
    v_mfma_f32_16x16x32_bf16 v[68:71], v[148:151], a[148:151], v[68:71]
    buffer_load_dwordx4 v[144:147], v23, s[24:27], s58 offen offset:0 sc1
    v_mfma_f32_16x16x32_bf16 v[72:75], v[148:151], a[152:155], v[72:75]
    v_add_f32 v83, v83, v87
    v_add_f32 v80, v80, v88
    ds_read_b64_tr_b16 a[232:233], v246 offset:256
    v_mfma_f32_16x16x32_bf16 v[76:79], v[148:151], a[156:159], v[76:79]
    ds_read_b64_tr_b16 a[234:235], v246 offset:768
    s_waitcnt vmcnt(10)
    v_mfma_f32_16x16x32_bf16 v[64:67], v[152:155], a[160:163], v[64:67]
    v_add_f32 v81, v81, v89
    v_mfma_f32_16x16x32_bf16 v[68:71], v[152:155], a[164:167], v[68:71]
    buffer_load_dwordx4 v[148:151], v23, s[24:27], s58 offen offset:1024 sc1
    v_mfma_f32_16x16x32_bf16 v[72:75], v[152:155], a[168:171], v[72:75]
    v_add_f32 v82, v82, v90
    v_add_f32 v83, v83, v91
    ds_read_b64_tr_b16 a[236:237], v247 offset:256
    v_mfma_f32_16x16x32_bf16 v[76:79], v[152:155], a[172:175], v[76:79]
    ds_read_b64_tr_b16 a[238:239], v247 offset:768
    s_waitcnt vmcnt(10)
    v_mfma_f32_16x16x32_bf16 v[64:67], v[156:159], a[176:179], v[64:67]
    s_add_u32 s58, s66, s80
    v_mfma_f32_16x16x32_bf16 v[68:71], v[156:159], a[180:183], v[68:71]
    buffer_load_dwordx4 v[152:155], v23, s[24:27], s58 offen offset:0 sc1
    v_mfma_f32_16x16x32_bf16 v[72:75], v[156:159], a[184:187], v[72:75]
    v_add_f32 v80, v80, v92
    v_add_f32 v81, v81, v93
    v_mfma_f32_16x16x32_bf16 v[76:79], v[156:159], a[188:191], v[76:79]
    v_add_f32 v82, v82, v94
    s_waitcnt vmcnt(10)
    v_mfma_f32_16x16x32_bf16 v[64:67], v[112:115], a[192:195], v[64:67]
    v_mfma_f32_16x16x32_bf16 v[68:71], v[112:115], a[196:199], v[68:71]
    buffer_load_dwordx4 v[156:159], v23, s[24:27], s58 offen offset:1024 sc1
    v_mfma_f32_16x16x32_bf16 v[72:75], v[112:115], a[200:203], v[72:75]
    v_add_f32 v83, v83, v95
    v_mfma_f32_16x16x32_bf16 v[76:79], v[112:115], a[204:207], v[76:79]
    s_waitcnt vmcnt(10)
    v_mfma_f32_16x16x32_bf16 v[64:67], v[116:119], a[208:211], v[64:67]
    s_add_u32 s58, s66, s81
    v_mfma_f32_16x16x32_bf16 v[68:71], v[116:119], a[212:215], v[68:71]
    buffer_load_dwordx4 v[112:115], v23, s[24:27], s58 offen offset:0 sc1
    v_mfma_f32_16x16x32_bf16 v[72:75], v[116:119], a[216:219], v[72:75]
    v_mfma_f32_16x16x32_bf16 v[76:79], v[116:119], a[220:223], v[76:79]
    s_waitcnt vmcnt(10)
    v_mfma_f32_16x16x32_bf16 v[48:51], v[120:123], a[0:3], v[228:231]
    v_mfma_f32_16x16x32_bf16 v[52:55], v[120:123], a[4:7], 0
    buffer_load_dwordx4 v[116:119], v23, s[24:27], s58 offen offset:1024 sc1
    v_mfma_f32_16x16x32_bf16 v[56:59], v[120:123], a[8:11], 0
    ds_read_b64_tr_b16 v[104:105], v16 offset:9216
    v_mfma_f32_16x16x32_bf16 v[60:63], v[120:123], a[12:15], 0
    ds_read_b64_tr_b16 v[106:107], v16 offset:9728
    s_waitcnt vmcnt(10)
    v_mfma_f32_16x16x32_bf16 v[48:51], v[124:127], a[16:19], v[48:51]
    s_add_u32 s58, s66, s82
    v_mfma_f32_16x16x32_bf16 v[52:55], v[124:127], a[20:23], v[52:55]
    buffer_load_dwordx4 v[120:123], v23, s[24:27], s58 offen offset:0 sc1
    v_mfma_f32_16x16x32_bf16 v[56:59], v[124:127], a[24:27], v[56:59]
    ds_read_b64_tr_b16 v[108:109], v16 offset:10240
    ds_read_b64_tr_b16 v[110:111], v16 offset:10752
    v_mfma_f32_16x16x32_bf16 v[60:63], v[124:127], a[28:31], v[60:63]
    ds_write_b128 v232, v[68:71] offset:32768
    s_waitcnt vmcnt(10)
    v_mfma_f32_16x16x32_bf16 v[48:51], v[128:131], a[32:35], v[48:51]
    v_mfma_f32_16x16x32_bf16 v[52:55], v[128:131], a[36:39], v[52:55]
    buffer_load_dwordx4 v[124:127], v23, s[24:27], s58 offen offset:1024 sc1
    v_mfma_f32_16x16x32_bf16 v[56:59], v[128:131], a[40:43], v[56:59]
    ds_read_b64_tr_b16 v[84:85], v16 offset:11264
    ds_read_b64_tr_b16 v[86:87], v16 offset:11776
    v_mfma_f32_16x16x32_bf16 v[60:63], v[128:131], a[44:47], v[60:63]
    ds_write_b128 v232, v[72:75] offset:33792
    s_waitcnt vmcnt(10)
    v_mfma_f32_16x16x32_bf16 v[48:51], v[132:135], a[48:51], v[48:51]
    s_add_u32 s66, s69, 0
    s_add_u32 s58, s66, s76
    v_mfma_f32_16x16x32_bf16 v[52:55], v[132:135], a[52:55], v[52:55]
    buffer_load_dwordx4 v[128:131], v23, s[24:27], s58 offen offset:0 sc1
    v_mfma_f32_16x16x32_bf16 v[56:59], v[132:135], a[56:59], v[56:59]
    ds_read_b64_tr_b16 v[88:89], v16 offset:12288
    ds_read_b64_tr_b16 v[90:91], v16 offset:12800
    v_mfma_f32_16x16x32_bf16 v[60:63], v[132:135], a[60:63], v[60:63]
    ds_write_b128 v232, v[76:79] offset:34816
    s_waitcnt vmcnt(10)
    v_mfma_f32_16x16x32_bf16 v[48:51], v[136:139], a[64:67], v[48:51]
    v_mfma_f32_16x16x32_bf16 v[52:55], v[136:139], a[68:71], v[52:55]
    buffer_load_dwordx4 v[132:135], v23, s[24:27], s58 offen offset:1024 sc1
    v_mfma_f32_16x16x32_bf16 v[56:59], v[136:139], a[72:75], v[56:59]
    ds_read_b64_tr_b16 v[92:93], v16 offset:13312
    v_mfma_f32_16x16x32_bf16 v[60:63], v[136:139], a[76:79], v[60:63]
    ds_read_b64_tr_b16 v[94:95], v16 offset:13824
    s_waitcnt vmcnt(10)
    v_mfma_f32_16x16x32_bf16 v[48:51], v[140:143], a[80:83], v[48:51]
    s_add_u32 s58, s66, s77
    v_mfma_f32_16x16x32_bf16 v[52:55], v[140:143], a[84:87], v[52:55]
    buffer_load_dwordx4 v[136:139], v23, s[24:27], s58 offen offset:0 sc1
    v_mfma_f32_16x16x32_bf16 v[56:59], v[140:143], a[88:91], v[56:59]
    s_waitcnt lgkmcnt(2)
    s_barrier
    v_mfma_f32_16x16x32_bf16 v[60:63], v[140:143], a[92:95], v[60:63]
    buffer_load_dword v19, v21, s[24:27], 0 offen sc1
    s_waitcnt vmcnt(11)
    v_mfma_f32_16x16x32_bf16 v[48:51], v[144:147], a[96:99], v[48:51]
    ds_read_b128 v[68:71], v233 offset:32768
    v_mfma_f32_16x16x32_bf16 v[52:55], v[144:147], a[100:103], v[52:55]
    ds_read_b128 v[72:75], v234 offset:33792
    v_mfma_f32_16x16x32_bf16 v[56:59], v[144:147], a[104:107], v[56:59]
    ds_read_b128 v[76:79], v235 offset:34816
    v_mfma_f32_16x16x32_bf16 v[60:63], v[144:147], a[108:111], v[60:63]
    s_waitcnt vmcnt(10)
    v_mfma_f32_16x16x32_bf16 v[48:51], v[148:151], a[112:115], v[48:51]
    v_mfma_f32_16x16x32_bf16 v[52:55], v[148:151], a[116:119], v[52:55]
    buffer_load_dwordx4 v[140:143], v23, s[24:27], s58 offen offset:1024 sc1
    v_mfma_f32_16x16x32_bf16 v[56:59], v[148:151], a[120:123], v[56:59]
    ds_read_b64_tr_b16 a[240:241], v246 offset:16384
    v_mfma_f32_16x16x32_bf16 v[60:63], v[148:151], a[124:127], v[60:63]
    ds_read_b64_tr_b16 a[242:243], v246 offset:16896
    s_waitcnt vmcnt(10)
    v_mfma_f32_16x16x32_bf16 v[48:51], v[152:155], a[128:131], v[48:51]
    s_add_u32 s58, s66, s78
    s_waitcnt lgkmcnt(2)
    v_mfma_f32_16x16x32_bf16 v[52:55], v[152:155], a[132:135], v[52:55]
    buffer_load_dwordx4 v[144:147], v23, s[24:27], s58 offen offset:0 sc1
    v_mfma_f32_16x16x32_bf16 v[56:59], v[152:155], a[136:139], v[56:59]
    v_add_f32 v64, v64, v68
    v_add_f32 v65, v65, v69
    ds_read_b64_tr_b16 a[244:245], v247 offset:16384
    v_mfma_f32_16x16x32_bf16 v[60:63], v[152:155], a[140:143], v[60:63]
    ds_read_b64_tr_b16 a[246:247], v247 offset:16896
    s_waitcnt vmcnt(10)
    v_mfma_f32_16x16x32_bf16 v[48:51], v[156:159], a[144:147], v[48:51]
    v_add_f32 v66, v66, v70
    v_mfma_f32_16x16x32_bf16 v[52:55], v[156:159], a[148:151], v[52:55]
    buffer_load_dwordx4 v[148:151], v23, s[24:27], s58 offen offset:1024 sc1
    v_mfma_f32_16x16x32_bf16 v[56:59], v[156:159], a[152:155], v[56:59]
    v_add_f32 v67, v67, v71
    v_add_f32 v64, v64, v72
    ds_read_b64_tr_b16 a[248:249], v246 offset:16640
    v_mfma_f32_16x16x32_bf16 v[60:63], v[156:159], a[156:159], v[60:63]
    ds_read_b64_tr_b16 a[250:251], v246 offset:17152
    s_waitcnt vmcnt(10)
    v_mfma_f32_16x16x32_bf16 v[48:51], v[112:115], a[160:163], v[48:51]
    s_add_u32 s58, s66, s79
    v_add_f32 v65, v65, v73
    v_mfma_f32_16x16x32_bf16 v[52:55], v[112:115], a[164:167], v[52:55]
    buffer_load_dwordx4 v[152:155], v23, s[24:27], s58 offen offset:0 sc1
    v_mfma_f32_16x16x32_bf16 v[56:59], v[112:115], a[168:171], v[56:59]
    v_add_f32 v66, v66, v74
    v_add_f32 v67, v67, v75
    ds_read_b64_tr_b16 a[252:253], v247 offset:16640
    v_mfma_f32_16x16x32_bf16 v[60:63], v[112:115], a[172:175], v[60:63]
    ds_read_b64_tr_b16 a[254:255], v247 offset:17152
    s_waitcnt vmcnt(10)
    v_mfma_f32_16x16x32_bf16 v[48:51], v[116:119], a[176:179], v[48:51]
    v_mfma_f32_16x16x32_bf16 v[52:55], v[116:119], a[180:183], v[52:55]
    buffer_load_dwordx4 v[156:159], v23, s[24:27], s58 offen offset:1024 sc1
    v_mfma_f32_16x16x32_bf16 v[56:59], v[116:119], a[184:187], v[56:59]
    v_add_f32 v64, v64, v76
    v_add_f32 v65, v65, v77
    v_mfma_f32_16x16x32_bf16 v[60:63], v[116:119], a[188:191], v[60:63]
    v_add_f32 v66, v66, v78
    s_waitcnt vmcnt(10)
    v_mfma_f32_16x16x32_bf16 v[48:51], v[120:123], a[192:195], v[48:51]
    s_add_u32 s58, s66, s80
    v_mfma_f32_16x16x32_bf16 v[52:55], v[120:123], a[196:199], v[52:55]
    buffer_load_dwordx4 v[112:115], v23, s[24:27], s58 offen offset:0 sc1
    v_mfma_f32_16x16x32_bf16 v[56:59], v[120:123], a[200:203], v[56:59]
    v_add_f32 v67, v67, v79
    v_mfma_f32_16x16x32_bf16 v[60:63], v[120:123], a[204:207], v[60:63]
    s_waitcnt vmcnt(10)
    v_mfma_f32_16x16x32_bf16 v[48:51], v[124:127], a[208:211], v[48:51]
    v_mfma_f32_16x16x32_bf16 v[52:55], v[124:127], a[212:215], v[52:55]
    buffer_load_dwordx4 v[116:119], v23, s[24:27], s58 offen offset:1024 sc1
    v_mfma_f32_16x16x32_bf16 v[56:59], v[124:127], a[216:219], v[56:59]
    v_mfma_f32_16x16x32_bf16 v[60:63], v[124:127], a[220:223], v[60:63]
    s_waitcnt vmcnt(10)
    v_mfma_f32_16x16x32_bf16 v[32:35], v[128:131], a[0:3], v[228:231]
    s_add_u32 s58, s66, s81
    ds_read_b64_tr_b16 v[68:69], v16 offset:14336
    v_mfma_f32_16x16x32_bf16 v[36:39], v[128:131], a[4:7], 0
    buffer_load_dwordx4 v[120:123], v23, s[24:27], s58 offen offset:0 sc1
    v_mfma_f32_16x16x32_bf16 v[40:43], v[128:131], a[8:11], 0
    ds_read_b64_tr_b16 v[70:71], v16 offset:14848
    ds_read_b64_tr_b16 v[72:73], v16 offset:15360
    v_mfma_f32_16x16x32_bf16 v[44:47], v[128:131], a[12:15], 0
    ds_read_b64_tr_b16 v[74:75], v16 offset:15872
    s_waitcnt vmcnt(10)
    v_mfma_f32_16x16x32_bf16 v[32:35], v[132:135], a[16:19], v[32:35]
    ds_write_b128 v232, v[52:55] offset:16384
    v_mfma_f32_16x16x32_bf16 v[36:39], v[132:135], a[20:23], v[36:39]
    buffer_load_dwordx4 v[124:127], v23, s[24:27], s58 offen offset:1024 sc1
    v_mfma_f32_16x16x32_bf16 v[40:43], v[132:135], a[24:27], v[40:43]
    ds_read_b64_tr_b16 a[0:1], v246 offset:32768
    ds_read_b64_tr_b16 a[2:3], v246 offset:33280
    ds_read_b64_tr_b16 a[4:5], v247 offset:32768
    v_mfma_f32_16x16x32_bf16 v[44:47], v[132:135], a[28:31], v[44:47]
    ds_read_b64_tr_b16 a[6:7], v247 offset:33280
    s_waitcnt vmcnt(10)
    v_mfma_f32_16x16x32_bf16 v[32:35], v[136:139], a[32:35], v[32:35]
    s_add_u32 s58, s66, s82
    ds_write_b128 v232, v[56:59] offset:17408
    v_mfma_f32_16x16x32_bf16 v[36:39], v[136:139], a[36:39], v[36:39]
    buffer_load_dwordx4 v[128:131], v23, s[24:27], s58 offen offset:0 sc1
    v_mfma_f32_16x16x32_bf16 v[40:43], v[136:139], a[40:43], v[40:43]
    ds_read_b64_tr_b16 a[8:9], v246 offset:33024
    ds_read_b64_tr_b16 a[10:11], v246 offset:33536
    ds_read_b64_tr_b16 a[12:13], v247 offset:33024
    v_mfma_f32_16x16x32_bf16 v[44:47], v[136:139], a[44:47], v[44:47]
    ds_read_b64_tr_b16 a[14:15], v247 offset:33536
    buffer_load_dwordx4 v[132:135], v23, s[24:27], s58 offen offset:1024 sc1
    s_waitcnt vmcnt(11)
    v_cmp_ne_u32 vcc, s47, v19
    s_nop 0
    s_cbranch_vccz L_ok10
    s_mov_b32 s59, 20000
L_spin9:
    buffer_load_dword v19, v21, s[24:27], 0 offen sc1
    s_waitcnt vmcnt(0)
    v_cmp_ne_u32 vcc, s47, v19
    s_nop 0
    s_cbranch_vccz L_ok10
    s_sub_u32 s59, s59, 1
    s_cbranch_scc0 L_spin9
L_ok10:
    s_waitcnt vmcnt(10)
    v_mfma_f32_16x16x32_bf16 v[32:35], v[140:143], a[48:51], v[32:35]
    s_add_u32 s58, s70, 0
    ds_write_b128 v232, v[60:63] offset:18432
    v_mfma_f32_16x16x32_bf16 v[36:39], v[140:143], a[52:55], v[36:39]
    buffer_load_dwordx4 v[136:139], v23, s[24:27], s58 offen offset:0 sc1
    v_mfma_f32_16x16x32_bf16 v[40:43], v[140:143], a[56:59], v[40:43]
    ds_read_b64_tr_b16 a[16:17], v246 offset:49152
    ds_read_b64_tr_b16 a[18:19], v246 offset:49664
    ds_read_b64_tr_b16 a[20:21], v247 offset:49152
    v_mfma_f32_16x16x32_bf16 v[44:47], v[140:143], a[60:63], v[44:47]
    ds_read_b64_tr_b16 a[22:23], v247 offset:49664
    s_waitcnt vmcnt(10)
    v_mfma_f32_16x16x32_bf16 v[32:35], v[144:147], a[64:67], v[32:35]
    ds_read_b64_tr_b16 a[24:25], v246 offset:49408
    v_mfma_f32_16x16x32_bf16 v[36:39], v[144:147], a[68:71], v[36:39]
    buffer_load_dwordx4 v[140:143], v23, s[24:27], s58 offen offset:1024 sc1
    v_mfma_f32_16x16x32_bf16 v[40:43], v[144:147], a[72:75], v[40:43]
    ds_read_b64_tr_b16 a[26:27], v246 offset:49920
    ds_read_b64_tr_b16 a[28:29], v247 offset:49408
    v_mfma_f32_16x16x32_bf16 v[44:47], v[144:147], a[76:79], v[44:47]
    ds_read_b64_tr_b16 a[30:31], v247 offset:49920
    s_waitcnt vmcnt(10)
    v_mfma_f32_16x16x32_bf16 v[32:35], v[148:151], a[80:83], v[32:35]
    ds_read_b64_tr_b16 a[32:33], v246 offset:4096
    v_mfma_f32_16x16x32_bf16 v[36:39], v[148:151], a[84:87], v[36:39]
    buffer_load_dwordx4 v[144:147], v23, s[24:27], s58 offen offset:2048 sc1
    v_mfma_f32_16x16x32_bf16 v[40:43], v[148:151], a[88:91], v[40:43]
    ds_read_b64_tr_b16 a[34:35], v246 offset:4608
    ds_read_b64_tr_b16 a[36:37], v247 offset:4096
    v_mfma_f32_16x16x32_bf16 v[44:47], v[148:151], a[92:95], v[44:47]
    ds_read_b64_tr_b16 a[38:39], v247 offset:4608
    s_waitcnt vmcnt(10)
    v_mfma_f32_16x16x32_bf16 v[32:35], v[152:155], a[96:99], v[32:35]
    ds_read_b64_tr_b16 a[40:41], v246 offset:4352
    v_mfma_f32_16x16x32_bf16 v[36:39], v[152:155], a[100:103], v[36:39]
    buffer_load_dwordx4 v[148:151], v23, s[24:27], s58 offen offset:3072 sc1
    v_mfma_f32_16x16x32_bf16 v[40:43], v[152:155], a[104:107], v[40:43]
    ds_read_b64_tr_b16 a[42:43], v246 offset:4864
    ds_read_b64_tr_b16 a[44:45], v247 offset:4352
    v_mfma_f32_16x16x32_bf16 v[44:47], v[152:155], a[108:111], v[44:47]
    ds_read_b64_tr_b16 a[46:47], v247 offset:4864
    s_waitcnt vmcnt(10)
    v_mfma_f32_16x16x32_bf16 v[32:35], v[156:159], a[112:115], v[32:35]
    s_add_u32 s58, s70, 4096
    ds_read_b64_tr_b16 a[48:49], v246 offset:20480
    v_mfma_f32_16x16x32_bf16 v[36:39], v[156:159], a[116:119], v[36:39]
    buffer_load_dwordx4 v[152:155], v23, s[24:27], s58 offen offset:0 sc1
    v_mfma_f32_16x16x32_bf16 v[40:43], v[156:159], a[120:123], v[40:43]
    ds_read_b64_tr_b16 a[50:51], v246 offset:20992
    ds_read_b64_tr_b16 a[52:53], v247 offset:20480
    v_mfma_f32_16x16x32_bf16 v[44:47], v[156:159], a[124:127], v[44:47]
    ds_read_b64_tr_b16 a[54:55], v247 offset:20992
    s_waitcnt vmcnt(10)
    v_mfma_f32_16x16x32_bf16 v[32:35], v[112:115], a[128:131], v[32:35]
    ds_read_b64_tr_b16 a[56:57], v246 offset:20736
    v_mfma_f32_16x16x32_bf16 v[36:39], v[112:115], a[132:135], v[36:39]
    buffer_load_dwordx4 v[156:159], v23, s[24:27], s58 offen offset:1024 sc1
    v_mfma_f32_16x16x32_bf16 v[40:43], v[112:115], a[136:139], v[40:43]
    ds_read_b64_tr_b16 a[58:59], v246 offset:21248
    ds_read_b64_tr_b16 a[60:61], v247 offset:20736
    v_mfma_f32_16x16x32_bf16 v[44:47], v[112:115], a[140:143], v[44:47]
    ds_read_b64_tr_b16 a[62:63], v247 offset:21248
    s_waitcnt vmcnt(10)
    v_mfma_f32_16x16x32_bf16 v[32:35], v[116:119], a[144:147], v[32:35]
    ds_read_b64_tr_b16 a[64:65], v246 offset:36864
    v_mfma_f32_16x16x32_bf16 v[36:39], v[116:119], a[148:151], v[36:39]
    buffer_load_dwordx4 v[112:115], v23, s[24:27], s58 offen offset:2048 sc1
    v_mfma_f32_16x16x32_bf16 v[40:43], v[116:119], a[152:155], v[40:43]
    ds_read_b64_tr_b16 a[66:67], v246 offset:37376
    ds_read_b64_tr_b16 a[68:69], v247 offset:36864
    v_mfma_f32_16x16x32_bf16 v[44:47], v[116:119], a[156:159], v[44:47]
    ds_read_b64_tr_b16 a[70:71], v247 offset:37376
    s_waitcnt vmcnt(10)
    v_mfma_f32_16x16x32_bf16 v[32:35], v[120:123], a[160:163], v[32:35]
    ds_read_b64_tr_b16 a[72:73], v246 offset:37120
    v_mfma_f32_16x16x32_bf16 v[36:39], v[120:123], a[164:167], v[36:39]
    buffer_load_dwordx4 v[116:119], v23, s[24:27], s58 offen offset:3072 sc1
    v_mfma_f32_16x16x32_bf16 v[40:43], v[120:123], a[168:171], v[40:43]
    ds_read_b64_tr_b16 a[74:75], v246 offset:37632
    ds_read_b64_tr_b16 a[76:77], v247 offset:37120
    v_mfma_f32_16x16x32_bf16 v[44:47], v[120:123], a[172:175], v[44:47]
    ds_read_b64_tr_b16 a[78:79], v247 offset:37632
    s_waitcnt vmcnt(10)
    v_mfma_f32_16x16x32_bf16 v[32:35], v[124:127], a[176:179], v[32:35]
    s_add_u32 s58, s70, 8192
    ds_read_b64_tr_b16 a[80:81], v246 offset:53248
    v_mfma_f32_16x16x32_bf16 v[36:39], v[124:127], a[180:183], v[36:39]
    buffer_load_dwordx4 v[120:123], v23, s[24:27], s58 offen offset:0 sc1
    v_mfma_f32_16x16x32_bf16 v[40:43], v[124:127], a[184:187], v[40:43]
    ds_read_b64_tr_b16 a[82:83], v246 offset:53760
    ds_read_b64_tr_b16 a[84:85], v247 offset:53248
    v_mfma_f32_16x16x32_bf16 v[44:47], v[124:127], a[188:191], v[44:47]
    ds_read_b64_tr_b16 a[86:87], v247 offset:53760
    s_waitcnt vmcnt(10)
    v_mfma_f32_16x16x32_bf16 v[32:35], v[128:131], a[192:195], v[32:35]
    ds_read_b64_tr_b16 a[88:89], v246 offset:53504
    v_mfma_f32_16x16x32_bf16 v[36:39], v[128:131], a[196:199], v[36:39]
    buffer_load_dwordx4 v[124:127], v23, s[24:27], s58 offen offset:1024 sc1
    v_mfma_f32_16x16x32_bf16 v[40:43], v[128:131], a[200:203], v[40:43]
    ds_read_b64_tr_b16 a[90:91], v246 offset:54016
    ds_read_b64_tr_b16 a[92:93], v247 offset:53504
    v_mfma_f32_16x16x32_bf16 v[44:47], v[128:131], a[204:207], v[44:47]
    ds_read_b64_tr_b16 a[94:95], v247 offset:54016
    s_waitcnt vmcnt(10)
    v_mfma_f32_16x16x32_bf16 v[32:35], v[132:135], a[208:211], v[32:35]
    ds_read_b64_tr_b16 a[96:97], v246 offset:8192
    v_mfma_f32_16x16x32_bf16 v[36:39], v[132:135], a[212:215], v[36:39]
    buffer_load_dwordx4 v[128:131], v23, s[24:27], s58 offen offset:2048 sc1
    v_mfma_f32_16x16x32_bf16 v[40:43], v[132:135], a[216:219], v[40:43]
    ds_read_b64_tr_b16 a[98:99], v246 offset:8704
    ds_read_b64_tr_b16 a[100:101], v247 offset:8192
    v_mfma_f32_16x16x32_bf16 v[44:47], v[132:135], a[220:223], v[44:47]
    ds_read_b64_tr_b16 a[102:103], v247 offset:8704
    s_waitcnt vmcnt(10)
    v_mfma_f32_16x16x32_bf16 v[32:35], a[224:227], v[136:139], v[32:35]
    ds_read_b64_tr_b16 a[104:105], v246 offset:8448
    v_mfma_f32_16x16x32_bf16 v[48:51], a[228:231], v[136:139], v[48:51]
    buffer_load_dwordx4 v[132:135], v23, s[24:27], s58 offen offset:3072 sc1
    v_mfma_f32_16x16x32_bf16 v[64:67], a[232:235], v[136:139], v[64:67]
    ds_read_b64_tr_b16 a[106:107], v246 offset:8960
    ds_read_b64_tr_b16 a[108:109], v247 offset:8448
    v_mfma_f32_16x16x32_bf16 v[80:83], a[236:239], v[136:139], v[80:83]
    ds_read_b64_tr_b16 a[110:111], v247 offset:8960
    ds_read_b64_tr_b16 a[112:113], v246 offset:24576
    v_mfma_f32_16x16x32_bf16 v[96:99], v[160:163], v[136:139], v[96:99]
    ds_read_b64_tr_b16 a[114:115], v246 offset:25088
    s_waitcnt lgkmcnt(15)
    s_waitcnt vmcnt(10)
    v_mfma_f32_16x16x32_bf16 v[32:35], a[240:243], v[140:143], v[32:35]
    s_add_u32 s58, s70, 12288
    ds_read_b64_tr_b16 a[116:117], v247 offset:24576
    v_mfma_f32_16x16x32_bf16 v[48:51], a[244:247], v[140:143], v[48:51]
    buffer_load_dwordx4 v[136:139], v23, s[24:27], s58 offen offset:0 sc1
    v_mfma_f32_16x16x32_bf16 v[64:67], a[248:251], v[140:143], v[64:67]
    ds_read_b64_tr_b16 a[118:119], v247 offset:25088
    ds_read_b64_tr_b16 a[120:121], v246 offset:24832
    v_mfma_f32_16x16x32_bf16 v[80:83], a[252:255], v[140:143], v[80:83]
    ds_read_b64_tr_b16 a[122:123], v246 offset:25344
    ds_read_b64_tr_b16 a[124:125], v247 offset:24832
    v_mfma_f32_16x16x32_bf16 v[96:99], v[164:167], v[140:143], v[96:99]
    ds_write_b128 v232, v[36:39] offset:0
    s_waitcnt vmcnt(10)
    v_mfma_f32_16x16x32_bf16 v[32:35], a[0:3], v[144:147], v[32:35]
    ds_read_b64_tr_b16 a[126:127], v247 offset:25344
    v_mfma_f32_16x16x32_bf16 v[48:51], a[4:7], v[144:147], v[48:51]
    buffer_load_dwordx4 v[140:143], v23, s[24:27], s58 offen offset:1024 sc1
    v_mfma_f32_16x16x32_bf16 v[64:67], a[8:11], v[144:147], v[64:67]
    ds_read_b64_tr_b16 a[128:129], v246 offset:40960
    ds_read_b64_tr_b16 a[130:131], v246 offset:41472
    v_mfma_f32_16x16x32_bf16 v[80:83], a[12:15], v[144:147], v[80:83]
    ds_read_b64_tr_b16 a[132:133], v247 offset:40960
    ds_read_b64_tr_b16 a[134:135], v247 offset:41472
    v_mfma_f32_16x16x32_bf16 v[96:99], v[168:171], v[144:147], v[96:99]
    ds_write_b128 v232, v[40:43] offset:1024
    s_waitcnt vmcnt(10)
    v_mfma_f32_16x16x32_bf16 v[32:35], a[16:19], v[148:151], v[32:35]
    ds_read_b64_tr_b16 a[136:137], v246 offset:41216
    v_mfma_f32_16x16x32_bf16 v[48:51], a[20:23], v[148:151], v[48:51]
    buffer_load_dwordx4 v[144:147], v23, s[24:27], s58 offen offset:2048 sc1
    v_mfma_f32_16x16x32_bf16 v[64:67], a[24:27], v[148:151], v[64:67]
    ds_read_b64_tr_b16 a[138:139], v246 offset:41728
    ds_read_b64_tr_b16 a[140:141], v247 offset:41216
    v_mfma_f32_16x16x32_bf16 v[80:83], a[28:31], v[148:151], v[80:83]
    ds_read_b64_tr_b16 a[142:143], v247 offset:41728
    ds_read_b64_tr_b16 a[144:145], v246 offset:57344
    v_mfma_f32_16x16x32_bf16 v[96:99], v[172:175], v[148:151], v[96:99]
    ds_write_b128 v232, v[44:47] offset:2048
    s_waitcnt vmcnt(10)
    v_mfma_f32_16x16x32_bf16 v[32:35], a[32:35], v[152:155], v[32:35]
    ds_read_b64_tr_b16 a[146:147], v246 offset:57856
    v_mfma_f32_16x16x32_bf16 v[48:51], a[36:39], v[152:155], v[48:51]
    buffer_load_dwordx4 v[148:151], v23, s[24:27], s58 offen offset:3072 sc1
    v_mfma_f32_16x16x32_bf16 v[64:67], a[40:43], v[152:155], v[64:67]
    ds_read_b64_tr_b16 a[148:149], v247 offset:57344
    ds_read_b64_tr_b16 a[150:151], v247 offset:57856
    v_mfma_f32_16x16x32_bf16 v[80:83], a[44:47], v[152:155], v[80:83]
    ds_read_b64_tr_b16 a[152:153], v246 offset:57600
    ds_read_b64_tr_b16 a[154:155], v246 offset:58112
    v_mfma_f32_16x16x32_bf16 v[96:99], v[192:195], v[152:155], v[96:99]
    ds_read_b64_tr_b16 a[156:157], v247 offset:57600
    s_waitcnt vmcnt(10)
    v_mfma_f32_16x16x32_bf16 v[32:35], a[48:51], v[156:159], v[32:35]
    ds_read_b64_tr_b16 a[158:159], v247 offset:58112
    ds_read_b64_tr_b16 a[160:161], v246 offset:12288
    v_mfma_f32_16x16x32_bf16 v[48:51], a[52:55], v[156:159], v[48:51]
    ds_read_b64_tr_b16 a[162:163], v246 offset:12800
    v_mfma_f32_16x16x32_bf16 v[64:67], a[56:59], v[156:159], v[64:67]
    ds_read_b64_tr_b16 a[164:165], v247 offset:12288
    v_mfma_f32_16x16x32_bf16 v[80:83], a[60:63], v[156:159], v[80:83]
    ds_read_b64_tr_b16 a[166:167], v247 offset:12800
    v_mfma_f32_16x16x32_bf16 v[96:99], v[196:199], v[156:159], v[96:99]
    ds_read_b64_tr_b16 a[168:169], v246 offset:12544
    s_waitcnt vmcnt(9)
    v_mfma_f32_16x16x32_bf16 v[32:35], a[64:67], v[112:115], v[32:35]
    ds_read_b64_tr_b16 a[170:171], v246 offset:13056
    ds_read_b64_tr_b16 a[172:173], v247 offset:12544
    v_mfma_f32_16x16x32_bf16 v[48:51], a[68:71], v[112:115], v[48:51]
    ds_read_b64_tr_b16 a[174:175], v247 offset:13056
    v_mfma_f32_16x16x32_bf16 v[64:67], a[72:75], v[112:115], v[64:67]
    ds_read_b64_tr_b16 a[176:177], v246 offset:28672
    v_mfma_f32_16x16x32_bf16 v[80:83], a[76:79], v[112:115], v[80:83]
    ds_read_b64_tr_b16 a[178:179], v246 offset:29184
    v_mfma_f32_16x16x32_bf16 v[96:99], v[200:203], v[112:115], v[96:99]
    s_waitcnt lgkmcnt(15)
    s_barrier
    s_waitcnt vmcnt(8)
    v_mfma_f32_16x16x32_bf16 v[32:35], a[80:83], v[116:119], v[32:35]
    ds_read_b64_tr_b16 a[180:181], v247 offset:28672
    ds_read_b64_tr_b16 a[182:183], v247 offset:29184
    v_mfma_f32_16x16x32_bf16 v[48:51], a[84:87], v[116:119], v[48:51]
    ds_read_b64_tr_b16 a[184:185], v246 offset:28928
    ds_read_b64_tr_b16 a[186:187], v246 offset:29440
    v_mfma_f32_16x16x32_bf16 v[64:67], a[88:91], v[116:119], v[64:67]
    ds_read_b64_tr_b16 a[188:189], v247 offset:28928
    ds_read_b128 v[52:55], v233 offset:16384
    v_mfma_f32_16x16x32_bf16 v[80:83], a[92:95], v[116:119], v[80:83]
    ds_read_b128 v[56:59], v234 offset:17408
    v_mfma_f32_16x16x32_bf16 v[96:99], v[204:207], v[116:119], v[96:99]
    ds_read_b128 v[60:63], v235 offset:18432
    s_waitcnt vmcnt(7)
    v_mfma_f32_16x16x32_bf16 v[32:35], a[96:99], v[120:123], v[32:35]
    ds_read_b64_tr_b16 a[190:191], v247 offset:29440
    ds_read_b64_tr_b16 a[192:193], v246 offset:45056
    v_mfma_f32_16x16x32_bf16 v[48:51], a[100:103], v[120:123], v[48:51]
    ds_read_b64_tr_b16 a[194:195], v246 offset:45568
    ds_read_b64_tr_b16 a[196:197], v247 offset:45056
    v_mfma_f32_16x16x32_bf16 v[64:67], a[104:107], v[120:123], v[64:67]
    ds_read_b64_tr_b16 a[198:199], v247 offset:45568
    ds_read_b128 v[36:39], v233 offset:0
    v_mfma_f32_16x16x32_bf16 v[80:83], a[108:111], v[120:123], v[80:83]
    ds_read_b128 v[40:43], v234 offset:1024
    v_mfma_f32_16x16x32_bf16 v[96:99], v[100:103], v[120:123], v[96:99]
    ds_read_b128 v[44:47], v235 offset:2048
    s_waitcnt vmcnt(6)
    v_mfma_f32_16x16x32_bf16 v[32:35], a[112:115], v[124:127], v[32:35]
    ds_read_b64_tr_b16 a[200:201], v246 offset:45312
    ds_read_b64_tr_b16 a[202:203], v246 offset:45824
    v_mfma_f32_16x16x32_bf16 v[48:51], a[116:119], v[124:127], v[48:51]
    ds_read_b64_tr_b16 a[204:205], v247 offset:45312
    v_mfma_f32_16x16x32_bf16 v[64:67], a[120:123], v[124:127], v[64:67]
    ds_read_b64_tr_b16 a[206:207], v247 offset:45824
    v_mfma_f32_16x16x32_bf16 v[80:83], a[124:127], v[124:127], v[80:83]
    ds_read_b64_tr_b16 a[208:209], v246 offset:61440
    v_mfma_f32_16x16x32_bf16 v[96:99], v[104:107], v[124:127], v[96:99]
    ds_read_b64_tr_b16 a[210:211], v246 offset:61952
    s_waitcnt vmcnt(5)
    v_mfma_f32_16x16x32_bf16 v[32:35], a[128:131], v[128:131], v[32:35]
    ds_read_b64_tr_b16 a[212:213], v247 offset:61440
    ds_read_b64_tr_b16 a[214:215], v247 offset:61952
    v_mfma_f32_16x16x32_bf16 v[48:51], a[132:135], v[128:131], v[48:51]
    ds_read_b64_tr_b16 a[216:217], v246 offset:61696
    v_mfma_f32_16x16x32_bf16 v[64:67], a[136:139], v[128:131], v[64:67]
    ds_read_b64_tr_b16 a[218:219], v246 offset:62208
    v_mfma_f32_16x16x32_bf16 v[80:83], a[140:143], v[128:131], v[80:83]
    ds_read_b64_tr_b16 a[220:221], v247 offset:61696
    v_mfma_f32_16x16x32_bf16 v[96:99], v[108:111], v[128:131], v[96:99]
    ds_read_b64_tr_b16 a[222:223], v247 offset:62208
    s_waitcnt lgkmcnt(15)
    s_waitcnt vmcnt(4)
    v_mfma_f32_16x16x32_bf16 v[32:35], a[144:147], v[132:135], v[32:35]
    v_mfma_f32_16x16x32_bf16 v[48:51], a[148:151], v[132:135], v[48:51]
    v_add_f32 v52, v52, v56
    v_mfma_f32_16x16x32_bf16 v[64:67], a[152:155], v[132:135], v[64:67]
    v_add_f32 v53, v53, v57
    v_mfma_f32_16x16x32_bf16 v[80:83], a[156:159], v[132:135], v[80:83]
    v_add_f32 v54, v54, v58
    v_mfma_f32_16x16x32_bf16 v[96:99], v[84:87], v[132:135], v[96:99]
    s_waitcnt vmcnt(3)
    v_mfma_f32_16x16x32_bf16 v[32:35], a[160:163], v[136:139], v[32:35]
    v_add_f32 v55, v55, v59
    v_mfma_f32_16x16x32_bf16 v[48:51], a[164:167], v[136:139], v[48:51]
    v_add_f32 v52, v52, v60
    v_mfma_f32_16x16x32_bf16 v[64:67], a[168:171], v[136:139], v[64:67]
    v_add_f32 v53, v53, v61
    v_mfma_f32_16x16x32_bf16 v[80:83], a[172:175], v[136:139], v[80:83]
    v_add_f32 v54, v54, v62
    v_mfma_f32_16x16x32_bf16 v[96:99], v[88:91], v[136:139], v[96:99]
    s_waitcnt vmcnt(2)
    v_mfma_f32_16x16x32_bf16 v[32:35], a[176:179], v[140:143], v[32:35]
    v_add_f32 v55, v55, v63
    v_mfma_f32_16x16x32_bf16 v[48:51], a[180:183], v[140:143], v[48:51]
    s_waitcnt lgkmcnt(12)
    v_mfma_f32_16x16x32_bf16 v[64:67], a[184:187], v[140:143], v[64:67]
    v_add_f32 v36, v36, v40
    v_mfma_f32_16x16x32_bf16 v[80:83], a[188:191], v[140:143], v[80:83]
    v_add_f32 v37, v37, v41
    v_mfma_f32_16x16x32_bf16 v[96:99], v[92:95], v[140:143], v[96:99]
    s_waitcnt lgkmcnt(8)
    s_waitcnt vmcnt(1)
    v_mfma_f32_16x16x32_bf16 v[32:35], a[192:195], v[144:147], v[32:35]
    v_add_f32 v38, v38, v42
    v_mfma_f32_16x16x32_bf16 v[48:51], a[196:199], v[144:147], v[48:51]
    v_add_f32 v39, v39, v43
    v_mfma_f32_16x16x32_bf16 v[64:67], a[200:203], v[144:147], v[64:67]
    v_add_f32 v36, v36, v44
    v_mfma_f32_16x16x32_bf16 v[80:83], a[204:207], v[144:147], v[80:83]
    v_add_f32 v37, v37, v45
    v_mfma_f32_16x16x32_bf16 v[96:99], v[68:71], v[144:147], v[96:99]
    s_waitcnt lgkmcnt(0)
    s_waitcnt vmcnt(0)
    v_mfma_f32_16x16x32_bf16 v[32:35], a[208:211], v[148:151], v[32:35]
    v_add_f32 v38, v38, v46
    v_mfma_f32_16x16x32_bf16 v[48:51], a[212:215], v[148:151], v[48:51]
    v_add_f32 v39, v39, v47
    v_mfma_f32_16x16x32_bf16 v[64:67], a[216:219], v[148:151], v[64:67]
    v_mfma_f32_16x16x32_bf16 v[80:83], a[220:223], v[148:151], v[80:83]
    v_mfma_f32_16x16x32_bf16 v[96:99], v[72:75], v[148:151], v[96:99]
    s_nop 1
    v_pk_add_f32 v[32:33], v[32:33], v[36:37]
    v_pk_add_f32 v[34:35], v[34:35], v[38:39]
    v_pk_add_f32 v[48:49], v[48:49], v[52:53]
    v_pk_add_f32 v[50:51], v[50:51], v[54:55]
    ds_write_b128 v238, v[32:35]
    ds_write_b128 v239, v[48:51]
    ds_write_b128 v240, v[64:67]
    ds_write_b128 v241, v[80:83]
    ds_read_b128 v[160:163], v244 offset:0
    ds_read_b128 v[164:167], v245 offset:0
    ds_read_b128 v[168:171], v244 offset:2048
    ds_read_b128 v[172:175], v245 offset:2048
    ds_write_b128 v242, v[96:99]
    ds_read_b128 v[192:195], v252
    s_waitcnt lgkmcnt(4)
    v_pk_add_f32 v[176:177], v[176:177], v[160:161]
    v_pk_add_f32 v[178:179], v[178:179], v[162:163]
    v_pk_add_f32 v[180:181], v[180:181], v[164:165]
    v_pk_add_f32 v[182:183], v[182:183], v[166:167]
    v_cvt_pk_bf16_f32 v216, v176, v177
    v_cvt_pk_bf16_f32 v217, v178, v179
    v_cvt_pk_bf16_f32 v218, v180, v181
    v_cvt_pk_bf16_f32 v219, v182, v183
    buffer_store_dwordx4 v[216:219], v22, s[28:31], s71 offen
    s_waitcnt lgkmcnt(2)
    v_pk_add_f32 v[184:185], v[184:185], v[168:169]
    v_pk_add_f32 v[186:187], v[186:187], v[170:171]
    v_pk_add_f32 v[188:189], v[188:189], v[172:173]
    v_pk_add_f32 v[190:191], v[190:191], v[174:175]
    v_cvt_pk_bf16_f32 v220, v184, v185
    v_cvt_pk_bf16_f32 v221, v186, v187
    v_cvt_pk_bf16_f32 v222, v188, v189
    v_cvt_pk_bf16_f32 v223, v190, v191
    buffer_store_dwordx4 v[220:223], v22, s[28:31], s72 offen
    s_waitcnt lgkmcnt(0)
    v_pk_add_f32 v[248:249], v[248:249], v[192:193]
    v_pk_add_f32 v[250:251], v[250:251], v[194:195]
    v_cvt_pk_bf16_f32 v224, v248, v249
    v_cvt_pk_bf16_f32 v225, v250, v251
    buffer_store_dwordx2 v[224:225], v26, s[28:31], s73 offen
L_end:
    s_endpgm
L_p2_alt:
    s_add_u32 s57, s57, 27648
    buffer_load_dwordx4 v11, s[16:19], s57 offen offset:3072 lds
    s_xor_b32 s66, s44, 3
    s_lshl2_add_u32 s66, s51, s66
    s_mul_i32 s66, s66, 66816
    s_lshl2_add_u32 s66, s52, s66
    s_lshl_b32 s86, s65, 10
    s_add_u32 s58, s86, s66
    s_add_u32 s86, s66, 13312
    buffer_load_dwordx4 v[128:131], v23, s[24:27], s58 offen offset:0 sc1
    s_add_u32 s58, s58, 1024
    s_cmp_eq_u32 s58, s86
    s_cselect_b32 s58, s66, s58
    buffer_load_dwordx4 v[132:135], v23, s[24:27], s58 offen offset:0 sc1
    s_add_u32 s58, s58, 1024
    s_cmp_eq_u32 s58, s86
    s_cselect_b32 s58, s66, s58
    buffer_load_dwordx4 v[136:139], v23, s[24:27], s58 offen offset:0 sc1
    s_add_u32 s58, s58, 1024
    s_cmp_eq_u32 s58, s86
    s_cselect_b32 s58, s66, s58
    buffer_load_dwordx4 v[140:143], v23, s[24:27], s58 offen offset:0 sc1
    s_add_u32 s58, s58, 1024
    s_cmp_eq_u32 s58, s86
    s_cselect_b32 s58, s66, s58
    buffer_load_dwordx4 v[144:147], v23, s[24:27], s58 offen offset:0 sc1
    s_add_u32 s58, s58, 1024
    s_cmp_eq_u32 s58, s86
    s_cselect_b32 s58, s66, s58
    buffer_load_dwordx4 v[148:151], v23, s[24:27], s58 offen offset:0 sc1
    s_add_u32 s58, s58, 1024
    s_cmp_eq_u32 s58, s86
    s_cselect_b32 s58, s66, s58
    buffer_load_dwordx4 v[152:155], v23, s[24:27], s58 offen offset:0 sc1
    s_add_u32 s58, s58, 1024
    s_cmp_eq_u32 s58, s86
    s_cselect_b32 s58, s66, s58
    buffer_load_dwordx4 v[156:159], v23, s[24:27], s58 offen offset:0 sc1
    s_add_u32 s58, s58, 1024
    s_cmp_eq_u32 s58, s86
    s_cselect_b32 s58, s66, s58
    buffer_load_dwordx4 v[112:115], v23, s[24:27], s58 offen offset:0 sc1
    s_add_u32 s58, s58, 1024
    s_cmp_eq_u32 s58, s86
    s_cselect_b32 s58, s66, s58
    buffer_load_dwordx4 v[116:119], v23, s[24:27], s58 offen offset:0 sc1
    s_add_u32 s58, s58, 1024
    s_cmp_eq_u32 s58, s86
    s_cselect_b32 s58, s66, s58
    buffer_load_dwordx4 v[120:123], v23, s[24:27], s58 offen offset:0 sc1
    s_waitcnt vmcnt(19)
    ds_read_b64_tr_b16 a[208:209], v4 offset:32768
    ds_read_b64_tr_b16 a[210:211], v4 offset:33280
    ds_read_b64_tr_b16 a[212:213], v5 offset:32768
    ds_read_b64_tr_b16 a[214:215], v5 offset:33280
    ds_read_b64_tr_b16 a[216:217], v4 offset:33024
    ds_read_b64_tr_b16 a[218:219], v4 offset:33536
    ds_read_b64_tr_b16 a[220:221], v5 offset:33024
    ds_read_b64_tr_b16 a[222:223], v5 offset:33536
    s_waitcnt vmcnt(15)
    ds_read_b64_tr_b16 a[224:225], v2 offset:0
    ds_read_b64_tr_b16 a[226:227], v2 offset:512
    ds_read_b64_tr_b16 a[228:229], v3 offset:0
    ds_read_b64_tr_b16 a[230:231], v3 offset:512
    ds_read_b64_tr_b16 a[232:233], v2 offset:256
    ds_read_b64_tr_b16 a[234:235], v2 offset:768
    ds_read_b64_tr_b16 a[236:237], v3 offset:256
    ds_read_b64_tr_b16 a[238:239], v3 offset:768
    s_waitcnt vmcnt(11)
    ds_read_b64_tr_b16 a[240:241], v2 offset:16384
    ds_read_b64_tr_b16 a[242:243], v2 offset:16896
    ds_read_b64_tr_b16 a[244:245], v3 offset:16384
    ds_read_b64_tr_b16 a[246:247], v3 offset:16896
    ds_read_b64_tr_b16 a[248:249], v2 offset:16640
    ds_read_b64_tr_b16 a[250:251], v2 offset:17152
    ds_read_b64_tr_b16 a[252:253], v3 offset:16640
    ds_read_b64_tr_b16 a[254:255], v3 offset:17152
    s_waitcnt lgkmcnt(0)
    s_branch L_p2_join
L_p3_alt:
    s_add_u32 s66, s69, 175872
    s_add_u32 s58, s66, s76
    buffer_load_dwordx4 v[152:155], v23, s[24:27], s58 offen offset:0 sc1
    buffer_load_dwordx4 v[156:159], v23, s[24:27], s58 offen offset:1024 sc1
    s_add_u32 s58, s66, s77
    buffer_load_dwordx4 v[112:115], v23, s[24:27], s58 offen offset:0 sc1
    buffer_load_dwordx4 v[116:119], v23, s[24:27], s58 offen offset:1024 sc1
    s_add_u32 s58, s66, s78
    buffer_load_dwordx4 v[120:123], v23, s[24:27], s58 offen offset:0 sc1
    buffer_load_dwordx4 v[124:127], v23, s[24:27], s58 offen offset:1024 sc1
    s_add_u32 s58, s66, s79
    buffer_load_dwordx4 v[128:131], v23, s[24:27], s58 offen offset:0 sc1
    buffer_load_dwordx4 v[132:135], v23, s[24:27], s58 offen offset:1024 sc1
    s_add_u32 s58, s66, s80
    buffer_load_dwordx4 v[136:139], v23, s[24:27], s58 offen offset:0 sc1
    buffer_load_dwordx4 v[140:143], v23, s[24:27], s58 offen offset:1024 sc1
    s_add_u32 s58, s66, s81
    buffer_load_dwordx4 v[144:147], v23, s[24:27], s58 offen offset:0 sc1
    s_waitcnt vmcnt(11) lgkmcnt(0)
    s_branch L_p3_join
L_help:
    s_sub_u32 s55, s46, 21
    v_lshlrev_b32 v217, 7, v1
    v_lshrrev_b32 v218, 2, v1
    v_lshlrev_b32 v218, 12, v218
    v_lshl_add_u32 v218, v210, 7, v218
    v_mul_u32_u24 v220, 3584, v1
    s_lshl4_add_u32 s54, s44, s65
    s_mul_i32 s54, s54, 114688
    s_lshl_b32 s56, s50, 7
    s_add_u32 s54, s54, s56
    buffer_load_dword v108, v220, s[16:19], s54 offen
    v_mul_u32_u24 v109, 960, v25
    v_lshl_add_u32 v109, v26, 4, v109
    v_mul_u32_u24 v110, 960, v209
    v_lshl_add_u32 v110, v208, 5, v110
    v_lshl_add_u32 v110, v210, 3, v110
    s_lshl_b32 s53, s44, 7
    v_add_u32 v110, s53, v110
    v_mul_u32_u24 v111, 66816, v208
    v_lshl_add_u32 v111, v211, 4, v111
    s_mul_i32 s63, s44, 267264
    s_lshl_b32 s53, s2, 8
    s_add_u32 s63, s63, s53
    s_add_u32 s64, s63, 1069056
    s_cmp_eq_u32 s44, 3
    s_cselect_b32 s64, 2130706432, s64
    s_mov_b32 s62, 0x3f803f80
    s_mov_b32 s61, 0xffff0000
    s_mov_b32 s66, 6291456
    v_mov_b32 v96, 0
    v_mov_b32 v97, 0
    s_waitcnt vmcnt(3)
    v_dot2c_f32_bf16 v96, s62, v32
    v_dot2c_f32_bf16 v97, v32, v32
    v_lshlrev_b32 v40, 16, v32
    v_and_b32 v41, s61, v32
    v_dot2c_f32_bf16 v96, s62, v33
    v_dot2c_f32_bf16 v97, v33, v33
    v_lshlrev_b32 v42, 16, v33
    v_and_b32 v43, s61, v33
    v_dot2c_f32_bf16 v96, s62, v34
    v_dot2c_f32_bf16 v97, v34, v34
    v_lshlrev_b32 v44, 16, v34
    v_and_b32 v45, s61, v34
    v_dot2c_f32_bf16 v96, s62, v35
    v_dot2c_f32_bf16 v97, v35, v35
    v_lshlrev_b32 v46, 16, v35
    v_and_b32 v47, s61, v35
    s_waitcnt vmcnt(2)
    v_dot2c_f32_bf16 v96, s62, v36
    v_dot2c_f32_bf16 v97, v36, v36
    v_lshlrev_b32 v48, 16, v36
    v_and_b32 v49, s61, v36
    v_dot2c_f32_bf16 v96, s62, v37
    v_dot2c_f32_bf16 v97, v37, v37
    v_lshlrev_b32 v50, 16, v37
    v_and_b32 v51, s61, v37
    v_dot2c_f32_bf16 v96, s62, v38
    v_dot2c_f32_bf16 v97, v38, v38
    v_lshlrev_b32 v52, 16, v38
    v_and_b32 v53, s61, v38
    v_dot2c_f32_bf16 v96, s62, v39
    v_dot2c_f32_bf16 v97, v39, v39
    v_lshlrev_b32 v54, 16, v39
    v_and_b32 v55, s61, v39
    buffer_load_dword v29, off, s[40:43], 0 sc1
    v_add_f32_dpp v96, v96, v96 quad_perm:[1,0,3,2] row_mask:0xf bank_mask:0xf
    v_add_f32_dpp v97, v97, v97 quad_perm:[1,0,3,2] row_mask:0xf bank_mask:0xf
    s_nop 0
    v_add_f32_dpp v96, v96, v96 quad_perm:[2,3,0,1] row_mask:0xf bank_mask:0xf
    v_add_f32_dpp v97, v97, v97 quad_perm:[2,3,0,1] row_mask:0xf bank_mask:0xf
    s_nop 0
    v_add_f32_dpp v96, v96, v96 row_half_mirror row_mask:0xf bank_mask:0xf
    v_add_f32_dpp v97, v97, v97 row_half_mirror row_mask:0xf bank_mask:0xf
    s_nop 0
    v_add_f32_dpp v96, v96, v96 row_mirror row_mask:0xf bank_mask:0xf
    v_add_f32_dpp v97, v97, v97 row_mirror row_mask:0xf bank_mask:0xf
    v_mov_b32 v98, v96
    v_mov_b32 v99, v97
    s_nop 0
    v_permlane16_swap_b32 v96, v98
    v_permlane16_swap_b32 v97, v99
    v_add_f32 v96, v96, v98
    v_add_f32 v97, v97, v99
    v_mul_f32 v98, 0x3b124925, v96
    v_mul_f32 v99, 0x3b124925, v97
    v_fma_f32 v99, -v98, v98, v99
    v_max_f32 v99, 0, v99
    v_cvt_pk_bf16_f32 v100, 0, v99
    v_add_f32 v100, 0x3727c5ac, v100
    v_cvt_pk_bf16_f32 v100, 0, v100
    v_sqrt_f32 v100, v100
    s_nop 0
    v_cvt_pk_bf16_f32 v100, 0, v100
    v_rcp_f32 v100, v100
    s_nop 0
    v_mul_f32 v99, v99, v100
    v_mul_f32 v102, v98, v100
    v_mul_f32 v99, v99, v100
    v_cvt_pk_bf16_f32 v104, 0, v99
    v_add_f32 v104, 0x3727c5ac, v104
    v_cvt_pk_bf16_f32 v104, 0, v104
    v_sqrt_f32 v104, v104
    s_nop 0
    v_cvt_pk_bf16_f32 v104, 0, v104
    v_rcp_f32 v104, v104
    s_nop 0
    v_mul_f32 v104, v104, v100
    v_mul_f32 v106, v98, v104
    v_pk_fma_f32 v[56:57], v[40:41], v[104:105], v[106:107] op_sel_hi:[1,0,0] neg_lo:[0,0,1] neg_hi:[0,0,1]
    v_pk_fma_f32 v[58:59], v[42:43], v[104:105], v[106:107] op_sel_hi:[1,0,0] neg_lo:[0,0,1] neg_hi:[0,0,1]
    v_pk_fma_f32 v[60:61], v[44:45], v[104:105], v[106:107] op_sel_hi:[1,0,0] neg_lo:[0,0,1] neg_hi:[0,0,1]
    v_pk_fma_f32 v[62:63], v[46:47], v[104:105], v[106:107] op_sel_hi:[1,0,0] neg_lo:[0,0,1] neg_hi:[0,0,1]
    v_pk_fma_f32 v[64:65], v[48:49], v[104:105], v[106:107] op_sel_hi:[1,0,0] neg_lo:[0,0,1] neg_hi:[0,0,1]
    v_pk_fma_f32 v[66:67], v[50:51], v[104:105], v[106:107] op_sel_hi:[1,0,0] neg_lo:[0,0,1] neg_hi:[0,0,1]
    v_pk_fma_f32 v[68:69], v[52:53], v[104:105], v[106:107] op_sel_hi:[1,0,0] neg_lo:[0,0,1] neg_hi:[0,0,1]
    v_pk_fma_f32 v[70:71], v[54:55], v[104:105], v[106:107] op_sel_hi:[1,0,0] neg_lo:[0,0,1] neg_hi:[0,0,1]
    v_cvt_pk_bf16_f32 v80, v56, v57
    v_cvt_pk_bf16_f32 v81, v58, v59
    v_cvt_pk_bf16_f32 v82, v60, v61
    v_cvt_pk_bf16_f32 v83, v62, v63
    v_cvt_pk_bf16_f32 v84, v64, v65
    v_cvt_pk_bf16_f32 v85, v66, v67
    v_cvt_pk_bf16_f32 v86, v68, v69
    v_cvt_pk_bf16_f32 v87, v70, v71
    ds_write_b128 v109, v[80:83] offset:0
    ds_write_b128 v109, v[84:87] offset:448
    v_pk_fma_f32 v[40:41], v[40:41], v[100:101], v[102:103] op_sel_hi:[1,0,0] neg_lo:[0,0,1] neg_hi:[0,0,1]
    v_pk_fma_f32 v[42:43], v[42:43], v[100:101], v[102:103] op_sel_hi:[1,0,0] neg_lo:[0,0,1] neg_hi:[0,0,1]
    v_pk_fma_f32 v[44:45], v[44:45], v[100:101], v[102:103] op_sel_hi:[1,0,0] neg_lo:[0,0,1] neg_hi:[0,0,1]
    v_pk_fma_f32 v[46:47], v[46:47], v[100:101], v[102:103] op_sel_hi:[1,0,0] neg_lo:[0,0,1] neg_hi:[0,0,1]
    v_pk_fma_f32 v[48:49], v[48:49], v[100:101], v[102:103] op_sel_hi:[1,0,0] neg_lo:[0,0,1] neg_hi:[0,0,1]
    v_pk_fma_f32 v[50:51], v[50:51], v[100:101], v[102:103] op_sel_hi:[1,0,0] neg_lo:[0,0,1] neg_hi:[0,0,1]
    v_pk_fma_f32 v[52:53], v[52:53], v[100:101], v[102:103] op_sel_hi:[1,0,0] neg_lo:[0,0,1] neg_hi:[0,0,1]
    v_pk_fma_f32 v[54:55], v[54:55], v[100:101], v[102:103] op_sel_hi:[1,0,0] neg_lo:[0,0,1] neg_hi:[0,0,1]
    v_cvt_pk_bf16_f32 v72, v40, v41
    v_cvt_pk_bf16_f32 v73, v42, v43
    v_cvt_pk_bf16_f32 v74, v44, v45
    v_cvt_pk_bf16_f32 v75, v46, v47
    v_cvt_pk_bf16_f32 v76, v48, v49
    v_cvt_pk_bf16_f32 v77, v50, v51
    v_cvt_pk_bf16_f32 v78, v52, v53
    v_cvt_pk_bf16_f32 v79, v54, v55
    s_waitcnt lgkmcnt(0)
    s_barrier
    ds_read_b64_tr_b16 v[88:89], v110 offset:0
    ds_read_b64_tr_b16 v[90:91], v110 offset:3840
    ds_read_b64_tr_b16 v[92:93], v110 offset:512
    ds_read_b64_tr_b16 v[94:95], v110 offset:4352
    buffer_store_dwordx4 v[72:75], v24, s[24:27], s66 offen offset:0 sc1
    buffer_store_dwordx4 v[76:79], v24, s[24:27], s66 offen offset:448 sc1
    s_waitcnt lgkmcnt(2)
    buffer_store_dwordx4 v[88:91], v111, s[24:27], s63 offen sc1
    s_waitcnt lgkmcnt(0)
    buffer_store_dwordx4 v[92:95], v111, s[24:27], s64 offen sc1
    v_min_u32 v220, 111104, v220
    s_add_u32 s54, s54, 229376
    buffer_load_dword v108, v220, s[16:19], s54 offen
    s_waitcnt vmcnt(1)
    v_cmp_eq_u32 vcc, 0, v29
    s_nop 0
    s_cbranch_vccz L_ok12
    s_mov_b32 s59, 20000
L_spin11:
    buffer_load_dword v29, off, s[40:43], 0 sc1
    s_waitcnt vmcnt(0)
    v_cmp_eq_u32 vcc, 0, v29
    s_nop 0
    s_cbranch_vccz L_ok12
    s_sub_u32 s59, s59, 1
    s_cbranch_scc0 L_spin11
L_ok12:
    v_readfirstlane_b32 s47, v29
    s_barrier
    s_cmp_lg_u32 s44, 0
    s_cbranch_scc1 L_nopub13
    s_lshl_b32 s60, s2, 5
    s_add_u32 s60, s60, 12582912
    v_mov_b32 v30, s47
    s_mov_b64 exec, 1
    buffer_store_dword v30, off, s[24:27], s60 sc1
    s_mov_b64 exec, -1
L_nopub13:
    buffer_load_dword v108, v217, s[32:35], 0 offen
    v_lshrrev_b32 v219, 2, v1
    v_min_u32 v219, 15, v219
    v_mul_u32_u24 v219, 3584, v219
    v_lshl_add_u32 v219, v210, 7, v219
    s_mul_i32 s54, s55, 16
    s_lshl_b32 s56, s44, 9
    s_add_u32 s54, s54, s56
    s_add_u32 s54, s54, 416
    s_mul_i32 s54, s54, 3584
    s_mul_i32 s56, s45, 7
    s_lshr_b32 s56, s56, 1
    s_lshl_b32 s56, s56, 7
    s_add_u32 s54, s54, s56
    buffer_load_dword v108, v219, s[16:19], s54 offen
    s_add_u32 s54, s54, 172032
    buffer_load_dword v108, v219, s[16:19], s54 offen
    s_add_u32 s54, s54, 172032
    s_mul_i32 s54, s44, 28
    s_add_u32 s54, s54, s55
    s_add_u32 s54, s54, 0
    s_lshl_b32 s54, s54, 16
    s_lshl_b32 s56, s45, 9
    s_add_u32 s54, s54, s56
    buffer_load_dword v108, v218, s[20:23], s54 offen
    s_add_u32 s54, s54, 196608
    buffer_load_dword v108, v218, s[20:23], s54 offen
    s_add_u32 s54, s54, 196608
    buffer_load_dword v108, v218, s[20:23], s54 offen
    s_add_u32 s54, s54, 196608
    buffer_load_dword v108, v218, s[20:23], s54 offen
    s_add_u32 s54, s54, 196608
    buffer_load_dword v108, v217, s[36:39], 0 offen
    s_waitcnt vmcnt(0) lgkmcnt(0)
    v_lshlrev_b32 v216, 6, v209
    v_lshl_add_u32 v216, v210, 3, v216
    v_lshl_add_u32 v216, v215, 5, v216
    s_add_u32 s53, s52, 49152
    v_lshl_add_u32 v2, v208, 10, v216
    v_add_u32 v2, s53, v2
    v_xor_b32 v3, 32, v2
    v_add_u32 v4, 65536, v2
    v_add_u32 v5, 65536, v3
    v_lshl_add_u32 v6, v208, 9, v216
    v_add_u32 v6, s53, v6
    v_xor_b32 v7, 32, v6
    v_add_u32 v8, 65536, v6
    v_add_u32 v9, 65536, v7
    s_lshr_b32 s53, s46, 2
    s_and_b32 s89, s46, 3
    s_bfe_u32 s54, s46, 0x20001
    s_and_b32 s55, s46, 1
    s_add_u32 s55, s55, 4
    s_cmp_lt_u32 s46, 16
    s_cselect_b32 s53, s53, s54
    s_cselect_b32 s89, s89, s55
    s_mul_i32 s49, s53, 2
    s_add_u32 s49, s49, s89
    s_sub_u32 s54, s49, 6
    s_min_u32 s49, s49, s54
    s_lshl2_add_u32 s48, s45, s53
    s_mul_i32 s53, s44, 1835008
    s_lshl_b32 s74, s48, 7
    s_add_u32 s53, s53, s74
    s_lshl_b32 s56, s44, 5
    v_lshlrev_b32 v217, 5, v212
    v_xor_b32 v217, v217, v214
    v_xor_b32 v217, s56, v217
    s_add_u32 s74, s74, s56
    v_lshlrev_b32 v12, 12, v213
    v_add3_u32 v12, v12, v217, s53
    s_mul_i32 s53, s44, 100352
    s_lshl_b32 s54, s49, 7
    s_add_u32 s55, s53, s54
    v_mul_u32_u24 v13, 896, v213
    v_add3_u32 v13, v13, v214, s55
    v_xor_b32 v14, 32, v13
    s_mul_i32 s73, s48, 57344
    s_add_u32 s71, s73, s54
    s_mul_i32 s55, s44, 14336
    s_add_u32 s71, s71, s55
    s_add_u32 s72, s71, 7168
    v_bfe_u32 v217, v1, 1, 2
    v_lshl_add_u32 v217, v212, 2, v217
    v_and_b32 v218, 24, v1
    v_add_u32 v217, v217, v218
    v_mul_u32_u24 v15, 896, v217
    v_and_b32 v217, 1, v1
    v_lshl_add_u32 v15, v217, 4, v15
    v_add_u32 v15, s53, v15
    s_lshl_b32 s54, s89, 5
    s_add_u32 s54, s54, 768
    s_add_u32 s68, s89, 24
    s_mul_i32 s68, s68, 58624
    s_mul_i32 s69, s44, 14336
    s_add_u32 s69, s69, 2097152
    s_add_u32 s68, s68, s69
    s_mul_i32 s55, s49, 234496
    s_add_u32 s69, s69, s55
    s_add_u32 s73, s73, s54
    s_mov_b32 s76, 0
    s_add_u32 s77, s76, 2048
    s_cmp_eq_u32 s77, 14336
    s_cselect_b32 s77, 0, s77
    s_add_u32 s78, s77, 2048
    s_cmp_eq_u32 s78, 14336
    s_cselect_b32 s78, 0, s78
    s_add_u32 s79, s78, 2048
    s_cmp_eq_u32 s79, 14336
    s_cselect_b32 s79, 0, s79
    s_add_u32 s80, s79, 2048
    s_cmp_eq_u32 s80, 14336
    s_cselect_b32 s80, 0, s80
    s_add_u32 s81, s80, 2048
    s_cmp_eq_u32 s81, 14336
    s_cselect_b32 s81, 0, s81
    s_add_u32 s82, s81, 2048
    s_cmp_eq_u32 s82, 14336
    s_cselect_b32 s82, 0, s82
    s_cmp_lt_u32 s89, 4
    s_cselect_b32 s75, s54, 2130706432
    s_cselect_b32 s68, s68, 2130706432
    s_cselect_b32 s73, s73, 2130706432
    v_lshlrev_b32 v16, 3, v1
    v_add_u32 v16, 81920, v16
    v_and_b32 v217, 7, v1
    v_min_u32 v218, 6, v217
    s_mul_i32 s54, s44, 7
    v_add_u32 v218, s54, v218
    v_mul_u32_u24 v219, 2, v218
    v_add_u32 v219, s89, v219
    v_mul_u32_u24 v220, 43, v219
    v_lshrrev_b32 v220, 8, v220
    v_mul_u32_u24 v220, 6, v220
    v_sub_u32 v219, v219, v220
    v_subrev_u32 v219, s49, v219
    v_bfe_u32 v220, v1, 3, 1
    v_mul_i32_i24 v219, v219, v220
    v_add_u32 v219, s49, v219
    v_lshl_add_u32 v218, v219, 5, v218
    v_lshlrev_b32 v20, 7, v218
    v_add_u32 v20, 12713984, v20
    s_lshr_b32 s53, s48, 1
    s_lshl_b32 s53, s53, 7
    s_add_u32 s53, s53, 12779520
    v_lshl_add_u32 v21, v210, 11, s53
    s_lshl_b32 s70, s48, 16
    s_lshl2_add_u32 s70, s52, s70
    s_add_u32 s70, s70, 4194304
    v_lshrrev_b32 v218, 3, v1
    v_mul_u32_u24 v22, 896, v218
    v_lshl_add_u32 v22, v217, 4, v22
    v_lshlrev_b32 v25, 1, v211
    s_add_u32 s53, s52, 65536
    v_lshl_add_u32 v244, v218, 8, s53
    v_bfe_u32 v219, v218, 1, 1
    v_lshl_add_u32 v244, v219, 7, v244
    v_xor_b32 v219, v218, v217
    v_lshl_add_u32 v244, v219, 4, v244
    v_xor_b32 v245, 128, v244
    v_xor_b32 v218, v217, v212
    v_lshl_add_u32 v238, v218, 4, s53
    v_bfe_u32 v219, v1, 1, 1
    v_xor_b32 v219, v219, v215
    v_lshl_add_u32 v238, v219, 7, v238
    v_lshl_add_u32 v238, v211, 8, v238
    v_lshrrev_b32 v218, 2, v0
    v_mul_u32_u24 v26, 896, v218
    v_lshl_add_u32 v26, v210, 3, v26
    s_add_u32 s53, s52, 52224
    v_lshrrev_b32 v218, 2, v1
    v_bfe_u32 v219, v218, 1, 2
    v_xor_b32 v219, v219, v210
    v_lshl_add_u32 v252, v218, 6, s53
    v_lshl_add_u32 v252, v219, 4, v252
    v_bfe_u32 v219, v1, 1, 2
    v_xor_b32 v219, v219, v208
    v_lshl_add_u32 v242, v211, 6, s53
    v_lshl_add_u32 v242, v219, 4, v242
    s_sub_u32 s53, 49152, s52
    v_add_u32 v246, s53, v2
    v_add_u32 v247, s53, v3
    v_add_u32 v232, s52, v23
    v_xor_b32 v233, 4096, v232
    v_xor_b32 v234, 8192, v232
    v_xor_b32 v235, 12288, v232
    v_xor_b32 v239, 32, v238
    v_xor_b32 v240, 64, v238
    v_xor_b32 v241, 96, v238
    buffer_load_dwordx4 v[216:219], v22, s[4:7], s71 offen
    buffer_load_dwordx4 v[220:223], v22, s[4:7], s72 offen
    buffer_load_dwordx2 v[224:225], v26, s[4:7], s73 offen
    buffer_load_ushort v228, v25, s[36:39], s74 offen
    s_add_u32 m0, s52, 81920
    s_lshl_b32 s57, s76, 7
    buffer_load_dwordx4 v12, s[20:23], s57 offen offset:0 lds
    s_add_u32 s57, s57, 31744
    buffer_load_dwordx4 v12, s[20:23], s57 offen offset:1024 lds
    s_add_u32 s57, s57, 31744
    buffer_load_dwordx4 v12, s[20:23], s57 offen offset:2048 lds
    s_add_u32 s57, s57, 31744
    buffer_load_dwordx4 v12, s[20:23], s57 offen offset:3072 lds
    s_add_u32 m0, s52, 98304
    s_lshl_b32 s57, s76, 7
    s_add_u32 s57, s57, 131072
    buffer_load_dwordx4 v12, s[20:23], s57 offen offset:0 lds
    s_add_u32 s57, s57, 31744
    buffer_load_dwordx4 v12, s[20:23], s57 offen offset:1024 lds
    s_add_u32 s57, s57, 31744
    buffer_load_dwordx4 v12, s[20:23], s57 offen offset:2048 lds
    s_add_u32 s57, s57, 31744
    buffer_load_dwordx4 v12, s[20:23], s57 offen offset:3072 lds
    s_add_u32 m0, s52, 114688
    s_lshl_b32 s57, s77, 7
    buffer_load_dwordx4 v12, s[20:23], s57 offen offset:0 lds
    s_add_u32 s57, s57, 31744
    buffer_load_dwordx4 v12, s[20:23], s57 offen offset:1024 lds
    s_add_u32 s57, s57, 31744
    buffer_load_dwordx4 v12, s[20:23], s57 offen offset:2048 lds
    s_add_u32 s57, s57, 31744
    buffer_load_dwordx4 v12, s[20:23], s57 offen offset:3072 lds
    s_add_u32 m0, s52, 131072
    s_lshl_b32 s57, s77, 7
    s_add_u32 s57, s57, 131072
    buffer_load_dwordx4 v12, s[20:23], s57 offen offset:0 lds
    s_add_u32 s57, s57, 31744
    buffer_load_dwordx4 v12, s[20:23], s57 offen offset:1024 lds
    s_waitcnt vmcnt(10)
    ds_read_b64_tr_b16 a[0:1], v6 offset:32768
    ds_read_b64_tr_b16 a[2:3], v6 offset:34816
    ds_read_b64_tr_b16 a[4:5], v7 offset:32768
    ds_read_b64_tr_b16 a[6:7], v7 offset:34816
    ds_read_b64_tr_b16 a[8:9], v6 offset:33024
    ds_read_b64_tr_b16 a[10:11], v6 offset:35072
    ds_read_b64_tr_b16 a[12:13], v7 offset:33024
    ds_read_b64_tr_b16 a[14:15], v7 offset:35072
    s_add_u32 s57, s57, 31744
    buffer_load_dwordx4 v12, s[20:23], s57 offen offset:2048 lds
    s_add_u32 s57, s57, 31744
    buffer_load_dwordx4 v12, s[20:23], s57 offen offset:3072 lds
    s_add_u32 m0, s52, 147456
    s_lshl_b32 s57, s78, 7
    buffer_load_dwordx4 v12, s[20:23], s57 offen offset:0 lds
    s_add_u32 s57, s57, 31744
    buffer_load_dwordx4 v12, s[20:23], s57 offen offset:1024 lds
    s_waitcnt vmcnt(10)
    ds_read_b64_tr_b16 a[16:17], v6 offset:49152
    ds_read_b64_tr_b16 a[18:19], v6 offset:51200
    ds_read_b64_tr_b16 a[20:21], v7 offset:49152
    ds_read_b64_tr_b16 a[22:23], v7 offset:51200
    ds_read_b64_tr_b16 a[24:25], v6 offset:49408
    ds_read_b64_tr_b16 a[26:27], v6 offset:51456
    ds_read_b64_tr_b16 a[28:29], v7 offset:49408
    ds_read_b64_tr_b16 a[30:31], v7 offset:51456
    s_add_u32 s57, s57, 31744
    buffer_load_dwordx4 v12, s[20:23], s57 offen offset:2048 lds
    s_add_u32 s57, s57, 31744
    buffer_load_dwordx4 v12, s[20:23], s57 offen offset:3072 lds
    s_add_u32 m0, s52, 49152
    s_lshl_b32 s57, s78, 7
    s_add_u32 s57, s57, 131072
    buffer_load_dwordx4 v12, s[20:23], s57 offen offset:0 lds
    s_add_u32 s57, s57, 31744
    buffer_load_dwordx4 v12, s[20:23], s57 offen offset:1024 lds
    s_waitcnt vmcnt(10)
    ds_read_b64_tr_b16 a[32:33], v8 offset:0
    ds_read_b64_tr_b16 a[34:35], v8 offset:2048
    ds_read_b64_tr_b16 a[36:37], v9 offset:0
    ds_read_b64_tr_b16 a[38:39], v9 offset:2048
    s_add_u32 s57, s57, 31744
    buffer_load_dwordx4 v12, s[20:23], s57 offen offset:2048 lds
    ds_read_b64_tr_b16 a[40:41], v8 offset:256
    ds_read_b64_tr_b16 a[42:43], v8 offset:2304
    ds_read_b64_tr_b16 a[44:45], v9 offset:256
    ds_read_b64_tr_b16 a[46:47], v9 offset:2304
    s_add_u32 s57, s57, 31744
    buffer_load_dwordx4 v12, s[20:23], s57 offen offset:3072 lds
    s_add_u32 m0, s52, 65536
    s_lshl_b32 s57, s79, 7
    buffer_load_dwordx4 v12, s[20:23], s57 offen offset:0 lds
    s_add_u32 s57, s57, 31744
    buffer_load_dwordx4 v12, s[20:23], s57 offen offset:1024 lds
    s_waitcnt vmcnt(10)
    ds_read_b64_tr_b16 a[48:49], v8 offset:16384
    ds_read_b64_tr_b16 a[50:51], v8 offset:18432
    ds_read_b64_tr_b16 a[52:53], v9 offset:16384
    ds_read_b64_tr_b16 a[54:55], v9 offset:18432
    s_add_u32 s57, s57, 31744
    buffer_load_dwordx4 v12, s[20:23], s57 offen offset:2048 lds
    ds_read_b64_tr_b16 a[56:57], v8 offset:16640
    ds_read_b64_tr_b16 a[58:59], v8 offset:18688
    ds_read_b64_tr_b16 a[60:61], v9 offset:16640
    ds_read_b64_tr_b16 a[62:63], v9 offset:18688
    s_add_u32 s57, s57, 31744
    buffer_load_dwordx4 v12, s[20:23], s57 offen offset:3072 lds
    s_waitcnt vmcnt(0) lgkmcnt(0)
    s_branch L_p3join
L_role_a:
    v_lshrrev_b32 v112, 4, v1
    v_bfe_u32 v113, v1, 2, 2
    v_and_b32 v114, 3, v1
    v_and_b32 v115, 15, v1
    v_lshrrev_b32 v116, 5, v1
    s_lshr_b32 s48, s45, 1
    s_and_b32 s53, s45, 1
    s_lshl3_add_u32 s49, s53, s46
    s_sub_u32 s49, s49, 24
    s_lshl_b32 s90, s44, 11
    s_and_b32 s53, s44, 1
    s_lshl_b32 s53, s53, 1
    v_lshlrev_b32 v117, 2, v112
    v_sub_u32 v117, v115, v117
    v_and_b32 v117, 15, v117
    v_xor_b32 v117, s53, v117
    v_mul_u32_u24 v2, 2688, v112
    v_lshl_add_u32 v2, v117, 4, v2
    s_mul_i32 s53, s44, 21504
    s_mul_i32 s54, s48, 224
    s_andn2_b32 s54, s54, 63
    s_add_u32 s53, s53, s54
    v_add_u32 v2, s53, v2
    s_add_u32 m0, s90, 65536
    s_mov_b32 s57, 896
    buffer_load_dwordx4 v2, s[8:11], s57 offen offset:0 lds
    s_mov_b32 s57, 10624
    buffer_load_dwordx4 v2, s[8:11], s57 offen offset:1024 lds
    s_add_u32 m0, s90, 73728
    s_mov_b32 s57, 86912
    buffer_load_dwordx4 v2, s[8:11], s57 offen offset:0 lds
    s_mov_b32 s57, 96640
    buffer_load_dwordx4 v2, s[8:11], s57 offen offset:1024 lds
    v_mul_u32_u24 v109, 960, v25
    v_lshl_add_u32 v109, v26, 4, v109
    v_mul_u32_u24 v110, 960, v113
    v_lshl_add_u32 v110, v112, 5, v110
    v_lshl_add_u32 v110, v114, 3, v110
    s_lshl_b32 s53, s44, 7
    v_add_u32 v110, s53, v110
    v_mul_u32_u24 v111, 66816, v112
    v_lshl_add_u32 v111, v115, 4, v111
    s_mul_i32 s63, s44, 267264
    s_lshl_b32 s53, s2, 8
    s_add_u32 s63, s63, s53
    s_add_u32 s64, s63, 1069056
    s_cmp_eq_u32 s44, 3
    s_cselect_b32 s64, 2130706432, s64
    s_mov_b32 s62, 0x3f803f80
    s_mov_b32 s61, 0xffff0000
    s_mov_b32 s66, 6291456
    v_mov_b32 v96, 0
    v_mov_b32 v97, 0
    v_and_b32 v117, 1, v112
    v_lshlrev_b32 v117, 5, v117
    s_mul_i32 s53, s44, 56
    s_and_b32 s54, s48, 1
    s_lshl_b32 s54, s54, 5
    s_add_u32 s53, s53, s54
    v_lshlrev_b32 v118, 11, v112
    v_lshl_add_u32 v118, v113, 8, v118
    v_add_u32 v118, 65536, v118
    v_lshl_add_u32 v119, v114, 3, s53
    v_add_u32 v119, 0, v119
    v_xor_b32 v119, v119, v117
    v_lshl_add_u32 v119, v113, 6, v119
    v_and_b32 v119, 255, v119
    v_add_u32 v6, v118, v119
    v_add_u32 v10, 49152, v6
    v_subrev_u32 v120, 65536, v6
    v_lshl_add_u32 v119, v114, 3, s53
    v_add_u32 v119, 32, v119
    v_xor_b32 v119, v119, v117
    v_lshl_add_u32 v119, v113, 6, v119
    v_and_b32 v119, 255, v119
    v_add_u32 v7, v118, v119
    v_add_u32 v11, 49152, v7
    v_subrev_u32 v121, 65536, v7
    v_lshl_add_u32 v119, v114, 4, s53
    v_add_u32 v119, 0, v119
    v_xor_b32 v119, v119, v117
    v_lshl_add_u32 v119, v113, 6, v119
    v_and_b32 v119, 255, v119
    v_add_u32 v8, v118, v119
    v_add_u32 v12, 49152, v8
    v_subrev_u32 v122, 65536, v8
    v_lshl_add_u32 v119, v114, 4, s53
    v_add_u32 v119, 8, v119
    v_xor_b32 v119, v119, v117
    v_lshl_add_u32 v119, v113, 6, v119
    v_and_b32 v119, 255, v119
    v_add_u32 v9, v118, v119
    v_add_u32 v13, 49152, v9
    v_subrev_u32 v123, 65536, v9
    s_waitcnt vmcnt(6)
    v_dot2c_f32_bf16 v96, s62, v32
    v_dot2c_f32_bf16 v97, v32, v32
    v_lshlrev_b32 v40, 16, v32
    v_and_b32 v41, s61, v32
    v_dot2c_f32_bf16 v96, s62, v33
    v_dot2c_f32_bf16 v97, v33, v33
    v_lshlrev_b32 v42, 16, v33
    v_and_b32 v43, s61, v33
    v_dot2c_f32_bf16 v96, s62, v34
    v_dot2c_f32_bf16 v97, v34, v34
    v_lshlrev_b32 v44, 16, v34
    v_and_b32 v45, s61, v34
    v_dot2c_f32_bf16 v96, s62, v35
    v_dot2c_f32_bf16 v97, v35, v35
    v_lshlrev_b32 v46, 16, v35
    v_and_b32 v47, s61, v35
    s_waitcnt vmcnt(5)
    v_dot2c_f32_bf16 v96, s62, v36
    v_dot2c_f32_bf16 v97, v36, v36
    v_lshlrev_b32 v48, 16, v36
    v_and_b32 v49, s61, v36
    v_dot2c_f32_bf16 v96, s62, v37
    v_dot2c_f32_bf16 v97, v37, v37
    v_lshlrev_b32 v50, 16, v37
    v_and_b32 v51, s61, v37
    v_dot2c_f32_bf16 v96, s62, v38
    v_dot2c_f32_bf16 v97, v38, v38
    v_lshlrev_b32 v52, 16, v38
    v_and_b32 v53, s61, v38
    v_dot2c_f32_bf16 v96, s62, v39
    v_dot2c_f32_bf16 v97, v39, v39
    v_lshlrev_b32 v54, 16, v39
    v_and_b32 v55, s61, v39
    buffer_load_dword v29, off, s[40:43], 0 sc1
    v_add_f32_dpp v96, v96, v96 quad_perm:[1,0,3,2] row_mask:0xf bank_mask:0xf
    v_add_f32_dpp v97, v97, v97 quad_perm:[1,0,3,2] row_mask:0xf bank_mask:0xf
    s_nop 0
    v_add_f32_dpp v96, v96, v96 quad_perm:[2,3,0,1] row_mask:0xf bank_mask:0xf
    v_add_f32_dpp v97, v97, v97 quad_perm:[2,3,0,1] row_mask:0xf bank_mask:0xf
    s_nop 0
    v_add_f32_dpp v96, v96, v96 row_half_mirror row_mask:0xf bank_mask:0xf
    v_add_f32_dpp v97, v97, v97 row_half_mirror row_mask:0xf bank_mask:0xf
    s_nop 0
    v_add_f32_dpp v96, v96, v96 row_mirror row_mask:0xf bank_mask:0xf
    v_add_f32_dpp v97, v97, v97 row_mirror row_mask:0xf bank_mask:0xf
    v_mov_b32 v98, v96
    v_mov_b32 v99, v97
    s_nop 0
    v_permlane16_swap_b32 v96, v98
    v_permlane16_swap_b32 v97, v99
    v_add_f32 v96, v96, v98
    v_add_f32 v97, v97, v99
    v_mul_f32 v98, 0x3b124925, v96
    v_mul_f32 v99, 0x3b124925, v97
    v_fma_f32 v99, -v98, v98, v99
    v_max_f32 v99, 0, v99
    v_cvt_pk_bf16_f32 v100, 0, v99
    v_add_f32 v100, 0x3727c5ac, v100
    v_cvt_pk_bf16_f32 v100, 0, v100
    v_sqrt_f32 v100, v100
    s_nop 0
    v_cvt_pk_bf16_f32 v100, 0, v100
    v_rcp_f32 v100, v100
    s_nop 0
    v_mul_f32 v99, v99, v100
    v_mul_f32 v102, v98, v100
    v_mul_f32 v99, v99, v100
    v_cvt_pk_bf16_f32 v104, 0, v99
    v_add_f32 v104, 0x3727c5ac, v104
    v_cvt_pk_bf16_f32 v104, 0, v104
    v_sqrt_f32 v104, v104
    s_nop 0
    v_cvt_pk_bf16_f32 v104, 0, v104
    v_rcp_f32 v104, v104
    s_nop 0
    v_mul_f32 v104, v104, v100
    v_mul_f32 v106, v98, v104
    v_pk_fma_f32 v[56:57], v[40:41], v[104:105], v[106:107] op_sel_hi:[1,0,0] neg_lo:[0,0,1] neg_hi:[0,0,1]
    v_pk_fma_f32 v[58:59], v[42:43], v[104:105], v[106:107] op_sel_hi:[1,0,0] neg_lo:[0,0,1] neg_hi:[0,0,1]
    v_pk_fma_f32 v[60:61], v[44:45], v[104:105], v[106:107] op_sel_hi:[1,0,0] neg_lo:[0,0,1] neg_hi:[0,0,1]
    v_pk_fma_f32 v[62:63], v[46:47], v[104:105], v[106:107] op_sel_hi:[1,0,0] neg_lo:[0,0,1] neg_hi:[0,0,1]
    v_pk_fma_f32 v[64:65], v[48:49], v[104:105], v[106:107] op_sel_hi:[1,0,0] neg_lo:[0,0,1] neg_hi:[0,0,1]
    v_pk_fma_f32 v[66:67], v[50:51], v[104:105], v[106:107] op_sel_hi:[1,0,0] neg_lo:[0,0,1] neg_hi:[0,0,1]
    v_pk_fma_f32 v[68:69], v[52:53], v[104:105], v[106:107] op_sel_hi:[1,0,0] neg_lo:[0,0,1] neg_hi:[0,0,1]
    v_pk_fma_f32 v[70:71], v[54:55], v[104:105], v[106:107] op_sel_hi:[1,0,0] neg_lo:[0,0,1] neg_hi:[0,0,1]
    v_cvt_pk_bf16_f32 v80, v56, v57
    v_cvt_pk_bf16_f32 v81, v58, v59
    v_cvt_pk_bf16_f32 v82, v60, v61
    v_cvt_pk_bf16_f32 v83, v62, v63
    v_cvt_pk_bf16_f32 v84, v64, v65
    v_cvt_pk_bf16_f32 v85, v66, v67
    v_cvt_pk_bf16_f32 v86, v68, v69
    v_cvt_pk_bf16_f32 v87, v70, v71
    ds_write_b128 v109, v[80:83] offset:49152
    ds_write_b128 v109, v[84:87] offset:49600
    v_pk_fma_f32 v[40:41], v[40:41], v[100:101], v[102:103] op_sel_hi:[1,0,0] neg_lo:[0,0,1] neg_hi:[0,0,1]
    v_pk_fma_f32 v[42:43], v[42:43], v[100:101], v[102:103] op_sel_hi:[1,0,0] neg_lo:[0,0,1] neg_hi:[0,0,1]
    v_pk_fma_f32 v[44:45], v[44:45], v[100:101], v[102:103] op_sel_hi:[1,0,0] neg_lo:[0,0,1] neg_hi:[0,0,1]
    v_pk_fma_f32 v[46:47], v[46:47], v[100:101], v[102:103] op_sel_hi:[1,0,0] neg_lo:[0,0,1] neg_hi:[0,0,1]
    v_pk_fma_f32 v[48:49], v[48:49], v[100:101], v[102:103] op_sel_hi:[1,0,0] neg_lo:[0,0,1] neg_hi:[0,0,1]
    v_pk_fma_f32 v[50:51], v[50:51], v[100:101], v[102:103] op_sel_hi:[1,0,0] neg_lo:[0,0,1] neg_hi:[0,0,1]
    v_pk_fma_f32 v[52:53], v[52:53], v[100:101], v[102:103] op_sel_hi:[1,0,0] neg_lo:[0,0,1] neg_hi:[0,0,1]
    v_pk_fma_f32 v[54:55], v[54:55], v[100:101], v[102:103] op_sel_hi:[1,0,0] neg_lo:[0,0,1] neg_hi:[0,0,1]
    v_cvt_pk_bf16_f32 v72, v40, v41
    v_cvt_pk_bf16_f32 v73, v42, v43
    v_cvt_pk_bf16_f32 v74, v44, v45
    v_cvt_pk_bf16_f32 v75, v46, v47
    v_cvt_pk_bf16_f32 v76, v48, v49
    v_cvt_pk_bf16_f32 v77, v50, v51
    v_cvt_pk_bf16_f32 v78, v52, v53
    v_cvt_pk_bf16_f32 v79, v54, v55
    s_waitcnt lgkmcnt(0)
    s_barrier
    ds_read_b64_tr_b16 v[88:89], v110 offset:49152
    ds_read_b64_tr_b16 v[90:91], v110 offset:52992
    ds_read_b64_tr_b16 v[92:93], v110 offset:49664
    ds_read_b64_tr_b16 v[94:95], v110 offset:53504
    buffer_store_dwordx4 v[72:75], v24, s[24:27], s66 offen offset:0 sc1
    buffer_store_dwordx4 v[76:79], v24, s[24:27], s66 offen offset:448 sc1
    s_waitcnt lgkmcnt(2)
    buffer_store_dwordx4 v[88:91], v111, s[24:27], s63 offen sc1
    s_waitcnt lgkmcnt(0)
    buffer_store_dwordx4 v[92:95], v111, s[24:27], s64 offen sc1
    s_add_u32 m0, s90, 81920
    s_mov_b32 s57, 172928
    buffer_load_dwordx4 v2, s[8:11], s57 offen offset:0 lds
    v_lshrrev_b32 v119, 3, v1
    v_mul_u32_u24 v3, 896, v119
    v_xor_b32 v118, v119, v1
    v_and_b32 v118, 6, v118
    v_and_or_b32 v118, v1, 1, v118
    v_lshl_add_u32 v3, v118, 4, v3
    v_and_b32 v118, 6, v1
    v_xor_b32 v118, v118, v112
    s_mov_b32 s57, 182656
    buffer_load_dwordx4 v2, s[8:11], s57 offen offset:1024 lds
    v_lshlrev_b32 v4, 7, v115
    v_lshl_add_u32 v4, v118, 4, v4
    v_xor_b32 v25, 64, v4
    s_lshl_b32 s53, s49, 4
    s_sub_u32 s53, s53, 2
    v_min_u32 v117, 17, v1
    v_add_u32 v117, s53, v117
    v_max_i32 v117, 0, v117
    v_lshlrev_b32 v19, 5, v117
    v_add_u32 v19, 12582912, v19
    v_and_b32 v117, 1, v115
    v_cmp_eq_u32 s[76:77], 1, v117
    v_lshl_add_u32 v117, v112, 2, v117
    v_cmp_le_u32 s[78:79], v117, v115
    v_add_u32 v117, 2, v117
    v_cmp_le_u32 s[80:81], v117, v115
    s_add_u32 m0, s90, 90112
    s_mov_b32 s57, 258944
    buffer_load_dwordx4 v2, s[8:11], s57 offen offset:0 lds
    v_cmp_eq_u32 s[82:83], 3, v112
    v_mov_b32 v117, 0xffff
    v_mov_b32 v118, 0xffff0000
    v_cndmask_b32 v117, v117, v118, s[76:77]
    v_cndmask_b32 v14, v117, 0, s[78:79]
    v_cndmask_b32 v15, v117, 0, s[80:81]
    v_cndmask_b32 v16, 0, v117, s[78:79]
    v_cndmask_b32 v17, 0, v117, s[80:81]
    s_mov_b32 s91, 0x3e8b97f6
    v_mov_b32 v18, 0xf149f2ca
    s_lshl_b32 s53, s49, 3
    s_mul_i32 s72, s53, 14336
    s_add_u32 s72, s72, 6291456
    s_lshl_b32 s74, s53, 14
    s_lshl2_add_u32 s54, s48, s44
    s_lshl_b32 s54, s54, 10
    s_mov_b32 s57, 268672
    buffer_load_dwordx4 v2, s[8:11], s57 offen offset:1024 lds
    s_add_u32 s74, s74, s54
    s_add_u32 s74, s74, 4194304
    s_lshl2_add_u32 s53, s44, 0
    s_lshl_b32 s54, s44, 8
    s_add_u32 s54, s54, 0
    s_cmp_lt_u32 s53, 14
    s_cselect_b32 s68, s54, 2130706432
    s_lshl2_add_u32 s53, s44, 1
    s_lshl_b32 s54, s44, 8
    s_add_u32 s54, s54, 6144
    s_cmp_lt_u32 s53, 14
    s_cselect_b32 s69, s54, 2130706432
    s_lshl2_add_u32 s53, s44, 2
    s_lshl_b32 s54, s44, 8
    s_add_u32 s54, s54, -1920
    s_cmp_lt_u32 s53, 14
    s_cselect_b32 s70, s54, 2130706432
    s_lshl2_add_u32 s53, s44, 3
    s_lshl_b32 s54, s44, 8
    s_add_u32 s54, s54, 4224
    s_cmp_lt_u32 s53, 14
    s_cselect_b32 s71, s54, 2130706432
    s_cmp_eq_u32 s49, 0
    s_cselect_b64 s[84:85], -1, 0
    s_andn2_b64 s[86:87], s[84:85], s[80:81]
    s_andn2_b64 s[84:85], s[84:85], s[78:79]
    s_and_b32 s53, s46, 7
    s_mul_i32 s54, s44, 28
    s_add_u32 s54, s54, s53
    s_add_u32 s54, s54, 12
    s_lshl_b32 s73, s54, 16
    s_lshl_b32 s54, s45, 9
    s_add_u32 s73, s73, s54
    s_lshl3_add_u32 s75, s44, s53
    s_lshl_b32 s75, s75, 13
    v_lshrrev_b32 v5, 2, v1
    v_lshlrev_b32 v5, 12, v5
    v_lshl_add_u32 v5, v114, 7, v5
    v_lshlrev_b32 v20, 7, v1
    s_add_u32 m0, s90, 98304
    s_mov_b32 s57, 344960
    buffer_load_dwordx4 v2, s[8:11], s57 offen offset:0 lds
    s_mov_b32 s57, 354688
    buffer_load_dwordx4 v2, s[8:11], s57 offen offset:1024 lds
    s_add_u32 m0, s90, 106496
    s_mov_b32 s57, 430976
    buffer_load_dwordx4 v2, s[8:11], s57 offen offset:0 lds
    s_mov_b32 s57, 440704
    buffer_load_dwordx4 v2, s[8:11], s57 offen offset:1024 lds
    s_add_u32 m0, s90, 114688
    s_mov_b32 s57, 516992
    buffer_load_dwordx4 v2, s[8:11], s57 offen offset:0 lds
    s_mov_b32 s57, 526720
    buffer_load_dwordx4 v2, s[8:11], s57 offen offset:1024 lds
    s_add_u32 m0, s90, 122880
    s_mov_b32 s57, 603008
    buffer_load_dwordx4 v2, s[8:11], s57 offen offset:0 lds
    s_mov_b32 s57, 612736
    buffer_load_dwordx4 v2, s[8:11], s57 offen offset:1024 lds
    s_add_u32 m0, s90, 131072
    s_mov_b32 s57, 689024
    buffer_load_dwordx4 v2, s[8:11], s57 offen offset:0 lds
    s_mov_b32 s57, 698752
    buffer_load_dwordx4 v2, s[8:11], s57 offen offset:1024 lds
    s_add_u32 m0, s90, 139264
    s_mov_b32 s57, 775040
    buffer_load_dwordx4 v2, s[8:11], s57 offen offset:0 lds
    s_mov_b32 s57, 784768
    buffer_load_dwordx4 v2, s[8:11], s57 offen offset:1024 lds
    s_add_u32 m0, s90, 147456
    s_mov_b32 s57, 861056
    buffer_load_dwordx4 v2, s[8:11], s57 offen offset:0 lds
    s_mov_b32 s57, 870784
    buffer_load_dwordx4 v2, s[8:11], s57 offen offset:1024 lds
    s_add_u32 m0, s90, 155648
    s_mov_b32 s57, 947072
    buffer_load_dwordx4 v2, s[8:11], s57 offen offset:0 lds
    s_mov_b32 s57, 956800
    buffer_load_dwordx4 v2, s[8:11], s57 offen offset:1024 lds
    s_waitcnt vmcnt(20)
    v_cmp_eq_u32 vcc, 0, v29
    s_nop 0
    s_cbranch_vccz L_ok15
    s_mov_b32 s59, 20000
L_spin14:
    buffer_load_dword v29, off, s[40:43], 0 sc1
    s_waitcnt vmcnt(0)
    v_cmp_eq_u32 vcc, 0, v29
    s_nop 0
    s_cbranch_vccz L_ok15
    s_sub_u32 s59, s59, 1
    s_cbranch_scc0 L_spin14
L_ok15:
    v_readfirstlane_b32 s47, v29
    s_barrier
    s_cmp_lg_u32 s44, 0
    s_cbranch_scc1 L_nopub16
    s_lshl_b32 s60, s2, 5
    s_add_u32 s60, s60, 12582912
    v_mov_b32 v30, s47
    s_mov_b64 exec, 1
    buffer_store_dword v30, off, s[24:27], s60 sc1
    s_mov_b64 exec, -1
L_nopub16:
    s_waitcnt vmcnt(18)
    s_barrier
    s_add_u32 m0, s90, 0
    s_mov_b32 s57, 1033088
    buffer_load_dwordx4 v2, s[8:11], s57 offen offset:0 lds
    s_mov_b32 s57, 1042816
    buffer_load_dwordx4 v2, s[8:11], s57 offen offset:1024 lds
    ds_read_b64_tr_b16 a[8:9], v6 offset:0
    ds_read_b64_tr_b16 a[10:11], v6 offset:1024
    ds_read_b64_tr_b16 a[12:13], v7 offset:0
    ds_read_b64_tr_b16 a[14:15], v7 offset:1024
    s_add_u32 m0, s90, 8192
    s_mov_b32 s57, 1119104
    buffer_load_dwordx4 v2, s[8:11], s57 offen offset:0 lds
    s_mov_b32 s57, 1128832
    buffer_load_dwordx4 v2, s[8:11], s57 offen offset:1024 lds
    ds_read_b64_tr_b16 a[32:33], v6 offset:8192
    ds_read_b64_tr_b16 a[34:35], v6 offset:9216
    ds_read_b64_tr_b16 a[36:37], v7 offset:8192
    ds_read_b64_tr_b16 a[38:39], v7 offset:9216
    s_add_u32 m0, s90, 16384
    s_mov_b32 s57, 1792
    buffer_load_dwordx4 v2, s[8:11], s57 offen offset:0 lds
    s_mov_b32 s57, 11520
    buffer_load_dwordx4 v2, s[8:11], s57 offen offset:1024 lds
    ds_read_b64_tr_b16 a[56:57], v6 offset:16384
    ds_read_b64_tr_b16 a[58:59], v6 offset:17408
    ds_read_b64_tr_b16 a[60:61], v7 offset:16384
    ds_read_b64_tr_b16 a[62:63], v7 offset:17408
    s_waitcnt vmcnt(18)
    s_waitcnt lgkmcnt(0)
    s_barrier
    s_add_u32 m0, s90, 24576
    s_mov_b32 s57, 87808
    buffer_load_dwordx4 v2, s[8:11], s57 offen offset:0 lds
    s_mov_b32 s57, 97536
    buffer_load_dwordx4 v2, s[8:11], s57 offen offset:1024 lds
    ds_read_b64_tr_b16 a[80:81], v6 offset:24576
    ds_read_b64_tr_b16 a[82:83], v6 offset:25600
    ds_read_b64_tr_b16 a[84:85], v7 offset:24576
    ds_read_b64_tr_b16 a[86:87], v7 offset:25600
    s_add_u32 m0, s90, 32768
    s_mov_b32 s57, 173824
    buffer_load_dwordx4 v2, s[8:11], s57 offen offset:0 lds
    s_mov_b32 s57, 183552
    buffer_load_dwordx4 v2, s[8:11], s57 offen offset:1024 lds
    ds_read_b64_tr_b16 a[104:105], v6 offset:32768
    ds_read_b64_tr_b16 a[106:107], v6 offset:33792
    ds_read_b64_tr_b16 a[108:109], v7 offset:32768
    ds_read_b64_tr_b16 a[110:111], v7 offset:33792
    s_add_u32 m0, s90, 40960
    s_mov_b32 s57, 259840
    buffer_load_dwordx4 v2, s[8:11], s57 offen offset:0 lds
    s_mov_b32 s57, 269568
    buffer_load_dwordx4 v2, s[8:11], s57 offen offset:1024 lds
    ds_read_b64_tr_b16 a[128:129], v6 offset:40960
    ds_read_b64_tr_b16 a[130:131], v6 offset:41984
    ds_read_b64_tr_b16 a[132:133], v7 offset:40960
    ds_read_b64_tr_b16 a[134:135], v7 offset:41984
    s_waitcnt vmcnt(18)
    s_waitcnt lgkmcnt(0)
    s_barrier
    s_add_u32 m0, s90, 65536
    s_mov_b32 s57, 345856
    buffer_load_dwordx4 v2, s[8:11], s57 offen offset:0 lds
    s_mov_b32 s57, 355584
    buffer_load_dwordx4 v2, s[8:11], s57 offen offset:1024 lds
    ds_read_b64_tr_b16 a[152:153], v10 offset:0
    ds_read_b64_tr_b16 a[154:155], v10 offset:1024
    ds_read_b64_tr_b16 a[156:157], v11 offset:0
    ds_read_b64_tr_b16 a[158:159], v11 offset:1024
    s_add_u32 m0, s90, 73728
    s_mov_b32 s57, 431872
    buffer_load_dwordx4 v2, s[8:11], s57 offen offset:0 lds
    s_mov_b32 s57, 441600
    buffer_load_dwordx4 v2, s[8:11], s57 offen offset:1024 lds
    ds_read_b64_tr_b16 a[176:177], v10 offset:8192
    ds_read_b64_tr_b16 a[178:179], v10 offset:9216
    ds_read_b64_tr_b16 a[180:181], v11 offset:8192
    ds_read_b64_tr_b16 a[182:183], v11 offset:9216
    s_add_u32 m0, s90, 81920
    s_mov_b32 s57, 517888
    buffer_load_dwordx4 v2, s[8:11], s57 offen offset:0 lds
    s_mov_b32 s57, 527616
    buffer_load_dwordx4 v2, s[8:11], s57 offen offset:1024 lds
    ds_read_b64_tr_b16 a[200:201], v10 offset:16384
    ds_read_b64_tr_b16 a[202:203], v10 offset:17408
    ds_read_b64_tr_b16 a[204:205], v11 offset:16384
    ds_read_b64_tr_b16 a[206:207], v11 offset:17408
    s_waitcnt vmcnt(18)
    s_waitcnt lgkmcnt(0)
    s_barrier
    s_add_u32 m0, s90, 90112
    s_mov_b32 s57, 603904
    buffer_load_dwordx4 v2, s[8:11], s57 offen offset:0 lds
    s_mov_b32 s57, 613632
    buffer_load_dwordx4 v2, s[8:11], s57 offen offset:1024 lds
    ds_read_b64_tr_b16 a[224:225], v10 offset:24576
    ds_read_b64_tr_b16 a[226:227], v10 offset:25600
    ds_read_b64_tr_b16 a[228:229], v11 offset:24576
    ds_read_b64_tr_b16 a[230:231], v11 offset:25600
    s_add_u32 m0, s90, 98304
    s_mov_b32 s57, 689920
    buffer_load_dwordx4 v2, s[8:11], s57 offen offset:0 lds
    s_mov_b32 s57, 699648
    buffer_load_dwordx4 v2, s[8:11], s57 offen offset:1024 lds
    ds_read_b64_tr_b16 a[248:249], v10 offset:32768
    ds_read_b64_tr_b16 a[250:251], v10 offset:33792
    ds_read_b64_tr_b16 a[252:253], v11 offset:32768
    ds_read_b64_tr_b16 a[254:255], v11 offset:33792
    s_add_u32 m0, s90, 106496
    s_mov_b32 s57, 775936
    buffer_load_dwordx4 v2, s[8:11], s57 offen offset:0 lds
    s_mov_b32 s57, 785664
    buffer_load_dwordx4 v2, s[8:11], s57 offen offset:1024 lds
    ds_read_b64_tr_b16 v[192:193], v10 offset:40960
    ds_read_b64_tr_b16 v[194:195], v10 offset:41984
    ds_read_b64_tr_b16 v[196:197], v11 offset:40960
    ds_read_b64_tr_b16 v[198:199], v11 offset:41984
    s_waitcnt vmcnt(18)
    s_waitcnt lgkmcnt(0)
    s_barrier
    ds_read_b64_tr_b16 v[216:217], v120 offset:0
    ds_read_b64_tr_b16 v[218:219], v120 offset:1024
    ds_read_b64_tr_b16 v[220:221], v121 offset:0
    ds_read_b64_tr_b16 v[222:223], v121 offset:1024
    ds_read_b64_tr_b16 v[240:241], v120 offset:8192
    ds_read_b64_tr_b16 v[242:243], v120 offset:9216
    ds_read_b64_tr_b16 v[244:245], v121 offset:8192
    ds_read_b64_tr_b16 v[246:247], v121 offset:9216
    buffer_load_dword v21, v19, s[24:27], 0 offen sc1
    ds_read_b64_tr_b16 a[16:17], v122 offset:16384
    ds_read_b64_tr_b16 a[18:19], v122 offset:17408
    ds_read_b64_tr_b16 a[20:21], v123 offset:16384
    ds_read_b64_tr_b16 a[22:23], v123 offset:17408
    s_add_u32 m0, s90, 114688
    s_mov_b32 s57, 861952
    buffer_load_dwordx4 v2, s[8:11], s57 offen offset:0 lds
    s_waitcnt vmcnt(14)
    s_waitcnt lgkmcnt(0)
    s_barrier
    ds_read_b64_tr_b16 a[40:41], v122 offset:24576
    ds_read_b64_tr_b16 a[42:43], v122 offset:25600
    ds_read_b64_tr_b16 a[44:45], v123 offset:24576
    ds_read_b64_tr_b16 a[46:47], v123 offset:25600
    ds_read_b64_tr_b16 a[64:65], v122 offset:32768
    ds_read_b64_tr_b16 a[66:67], v122 offset:33792
    ds_read_b64_tr_b16 a[68:69], v123 offset:32768
    ds_read_b64_tr_b16 a[70:71], v123 offset:33792
    ds_read_b64_tr_b16 a[88:89], v122 offset:40960
    ds_read_b64_tr_b16 a[90:91], v122 offset:41984
    ds_read_b64_tr_b16 a[92:93], v123 offset:40960
    ds_read_b64_tr_b16 a[94:95], v123 offset:41984
    s_mov_b32 s57, 871680
    buffer_load_dwordx4 v2, s[8:11], s57 offen offset:1024 lds
    s_add_u32 m0, s90, 122880
    s_mov_b32 s57, 947968
    buffer_load_dwordx4 v2, s[8:11], s57 offen offset:0 lds
    s_mov_b32 s57, 957696
    buffer_load_dwordx4 v2, s[8:11], s57 offen offset:1024 lds
    s_add_u32 m0, s90, 131072
    s_mov_b32 s57, 1033984
    buffer_load_dwordx4 v2, s[8:11], s57 offen offset:0 lds
    s_waitcnt vmcnt(12)
    s_waitcnt lgkmcnt(0)
    s_barrier
    ds_read_b64_tr_b16 a[112:113], v8 offset:0
    ds_read_b64_tr_b16 a[114:115], v8 offset:1024
    ds_read_b64_tr_b16 a[116:117], v9 offset:0
    ds_read_b64_tr_b16 a[118:119], v9 offset:1024
    ds_read_b64_tr_b16 a[136:137], v8 offset:8192
    ds_read_b64_tr_b16 a[138:139], v8 offset:9216
    ds_read_b64_tr_b16 a[140:141], v9 offset:8192
    ds_read_b64_tr_b16 a[142:143], v9 offset:9216
    ds_read_b64_tr_b16 a[160:161], v8 offset:16384
    ds_read_b64_tr_b16 a[162:163], v8 offset:17408
    ds_read_b64_tr_b16 a[164:165], v9 offset:16384
    ds_read_b64_tr_b16 a[166:167], v9 offset:17408
    s_mov_b32 s57, 1043712
    buffer_load_dwordx4 v2, s[8:11], s57 offen offset:1024 lds
    s_waitcnt vmcnt(6)
    v_cmp_ne_u32 vcc, s47, v21
    s_nop 0
    s_cbranch_vccz L_ok18
    s_mov_b32 s59, 20000
L_spin17:
    buffer_load_dword v21, v19, s[24:27], 0 offen sc1
    s_waitcnt vmcnt(0)
    v_cmp_ne_u32 vcc, s47, v21
    s_nop 0
    s_cbranch_vccz L_ok18
    s_sub_u32 s59, s59, 1
    s_cbranch_scc0 L_spin17
L_ok18:
    s_add_u32 m0, s52, 0
    s_sub_u32 s58, s72, 14336
    s_max_u32 s58, s58, 6291456
    s_add_u32 s57, s58, s68
    buffer_load_dwordx4 v3, s[24:27], s57 offen offset:0 sc1 lds
    s_add_u32 s57, s58, s69
    buffer_load_dwordx4 v3, s[24:27], s57 offen offset:1024 sc1 lds
    s_add_u32 s57, s58, s70
    buffer_load_dwordx4 v3, s[24:27], s57 offen offset:2048 sc1 lds
    s_add_u32 s57, s58, s71
    buffer_load_dwordx4 v3, s[24:27], s57 offen offset:3072 sc1 lds
    s_add_u32 m0, s52, 16384
    s_add_u32 s58, s72, 0
    s_add_u32 s57, s58, s68
    buffer_load_dwordx4 v3, s[24:27], s57 offen offset:0 sc1 lds
    s_waitcnt lgkmcnt(0)
    s_barrier
    ds_read_b64_tr_b16 a[184:185], v8 offset:24576
    ds_read_b64_tr_b16 a[186:187], v8 offset:25600
    ds_read_b64_tr_b16 a[188:189], v9 offset:24576
    ds_read_b64_tr_b16 a[190:191], v9 offset:25600
    ds_read_b64_tr_b16 a[208:209], v8 offset:32768
    ds_read_b64_tr_b16 a[210:211], v8 offset:33792
    ds_read_b64_tr_b16 a[212:213], v9 offset:32768
    ds_read_b64_tr_b16 a[214:215], v9 offset:33792
    ds_read_b64_tr_b16 a[232:233], v8 offset:40960
    ds_read_b64_tr_b16 a[234:235], v8 offset:41984
    ds_read_b64_tr_b16 a[236:237], v9 offset:40960
    ds_read_b64_tr_b16 a[238:239], v9 offset:41984
    s_add_u32 s57, s58, s69
    buffer_load_dwordx4 v3, s[24:27], s57 offen offset:1024 sc1 lds
    s_add_u32 s57, s58, s70
    buffer_load_dwordx4 v3, s[24:27], s57 offen offset:2048 sc1 lds
    s_add_u32 s57, s58, s71
    buffer_load_dwordx4 v3, s[24:27], s57 offen offset:3072 sc1 lds
    s_add_u32 m0, s90, 139264
    s_mov_b32 s57, 1120000
    buffer_load_dwordx4 v2, s[8:11], s57 offen offset:0 lds
    s_mov_b32 s57, 1129728
    buffer_load_dwordx4 v2, s[8:11], s57 offen offset:1024 lds
    s_add_u32 m0, s90, 147456
    s_mov_b32 s57, 0
    buffer_load_dwordx4 v2, s[8:11], s57 offen offset:0 lds
    s_mov_b32 s57, 9728
    buffer_load_dwordx4 v2, s[8:11], s57 offen offset:1024 lds
    s_add_u32 m0, s90, 155648
    s_mov_b32 s57, 86016
    buffer_load_dwordx4 v2, s[8:11], s57 offen offset:0 lds
    s_mov_b32 s57, 95744
    buffer_load_dwordx4 v2, s[8:11], s57 offen offset:1024 lds
    s_add_u32 m0, s52, 32768
    s_add_u32 s58, s72, 14336
    s_add_u32 s57, s58, s68
    buffer_load_dwordx4 v3, s[24:27], s57 offen offset:0 sc1 lds
    s_add_u32 s57, s58, s69
    buffer_load_dwordx4 v3, s[24:27], s57 offen offset:1024 sc1 lds
    s_waitcnt vmcnt(12)
    s_waitcnt lgkmcnt(0)
    s_barrier
    ds_read_b128 v[120:123], v4 offset:0
    ds_read_b128 v[124:127], v25 offset:0
    ds_read_b128 v[128:131], v4 offset:2048
    ds_read_b128 v[132:135], v25 offset:2048
    ds_read_b128 v[136:139], v4 offset:4096
    ds_read_b128 v[140:143], v25 offset:4096
    ds_read_b128 v[144:147], v4 offset:6144
    ds_read_b128 v[148:151], v25 offset:6144
    ds_read_b128 v[152:155], v4 offset:8192
    ds_read_b128 v[156:159], v25 offset:8192
    ds_read_b128 v[160:163], v4 offset:10240
    ds_read_b128 v[164:167], v25 offset:10240
    ds_read_b128 v[168:171], v4 offset:12288
    ds_read_b128 v[172:175], v25 offset:12288
    s_waitcnt lgkmcnt(11)
    v_mfma_f32_16x16x32_bf16 v[96:99], a[8:11], v[120:123], 0
    s_add_u32 s57, s58, s70
    ds_read_b64_tr_b16 v[176:177], v12 offset:0
    v_mfma_f32_16x16x32_bf16 v[96:99], a[32:35], v[124:127], v[96:99]
    buffer_load_dwordx4 v3, s[24:27], s57 offen offset:2048 sc1 lds
    v_mfma_f32_16x16x32_bf16 v[96:99], a[56:59], v[128:131], v[96:99]
    ds_read_b64_tr_b16 v[178:179], v12 offset:1024
    ds_read_b64_tr_b16 v[180:181], v13 offset:0
    s_waitcnt lgkmcnt(11)
    v_mfma_f32_16x16x32_bf16 v[96:99], a[80:83], v[132:135], v[96:99]
    ds_read_b64_tr_b16 v[182:183], v13 offset:1024
    ds_read_b64_tr_b16 v[200:201], v12 offset:8192
    v_mfma_f32_16x16x32_bf16 v[96:99], a[104:107], v[136:139], v[96:99]
    s_add_u32 s57, s58, s71
    ds_read_b64_tr_b16 v[202:203], v12 offset:9216
    v_mfma_f32_16x16x32_bf16 v[96:99], a[128:131], v[140:143], v[96:99]
    buffer_load_dwordx4 v3, s[24:27], s57 offen offset:3072 sc1 lds
    s_waitcnt lgkmcnt(11)
    v_mfma_f32_16x16x32_bf16 v[96:99], a[152:155], v[144:147], v[96:99]
    ds_read_b64_tr_b16 v[204:205], v13 offset:8192
    ds_read_b64_tr_b16 v[206:207], v13 offset:9216
    v_mfma_f32_16x16x32_bf16 v[96:99], a[176:179], v[148:151], v[96:99]
    ds_read_b64_tr_b16 v[224:225], v12 offset:16384
    ds_read_b64_tr_b16 v[226:227], v12 offset:17408
    v_mfma_f32_16x16x32_bf16 v[96:99], a[200:203], v[152:155], v[96:99]
    s_add_u32 m0, s90, 65536
    s_mov_b32 s57, 172032
    ds_read_b64_tr_b16 v[228:229], v13 offset:16384
    s_waitcnt lgkmcnt(13)
    v_mfma_f32_16x16x32_bf16 v[96:99], a[224:227], v[156:159], v[96:99]
    buffer_load_dwordx4 v2, s[8:11], s57 offen offset:0 lds
    v_mfma_f32_16x16x32_bf16 v[96:99], a[248:251], v[160:163], v[96:99]
    ds_read_b64_tr_b16 v[230:231], v13 offset:17408
    v_mfma_f32_16x16x32_bf16 v[96:99], v[192:195], v[164:167], v[96:99]
    s_waitcnt lgkmcnt(12)
    v_mfma_f32_16x16x32_bf16 v[96:99], v[216:219], v[168:171], v[96:99]
    s_mov_b32 s57, 181760
    v_mfma_f32_16x16x32_bf16 v[96:99], v[240:243], v[172:175], v[96:99]
    buffer_load_dwordx4 v2, s[8:11], s57 offen offset:1024 lds
    s_waitcnt vmcnt(12)
    s_barrier
    v_mfma_f32_16x16x32_bf16 v[100:103], a[12:15], v[120:123], 0
    ds_read_b128 v[120:123], v4 offset:16384
    v_mfma_f32_16x16x32_bf16 v[100:103], a[36:39], v[124:127], v[100:103]
    ds_read_b128 v[124:127], v25 offset:16384
    v_mfma_f32_16x16x32_bf16 v[100:103], a[60:63], v[128:131], v[100:103]
    ds_read_b128 v[128:131], v4 offset:18432
    s_add_u32 m0, s90, 73728
    s_mov_b32 s57, 258048
    v_mfma_f32_16x16x32_bf16 v[100:103], a[84:87], v[132:135], v[100:103]
    ds_read_b128 v[132:135], v25 offset:18432
    buffer_load_dwordx4 v2, s[8:11], s57 offen offset:0 lds
    v_mfma_f32_16x16x32_bf16 v[100:103], a[108:111], v[136:139], v[100:103]
    ds_read_b128 v[136:139], v4 offset:20480
    v_mfma_f32_16x16x32_bf16 v[100:103], a[132:135], v[140:143], v[100:103]
    ds_read_b128 v[140:143], v25 offset:20480
    v_mfma_f32_16x16x32_bf16 v[100:103], a[156:159], v[144:147], v[100:103]
    ds_read_b128 v[144:147], v4 offset:22528
    s_mov_b32 s57, 267776
    v_mfma_f32_16x16x32_bf16 v[100:103], a[180:183], v[148:151], v[100:103]
    ds_read_b128 v[148:151], v25 offset:22528
    buffer_load_dwordx4 v2, s[8:11], s57 offen offset:1024 lds
    v_mfma_f32_16x16x32_bf16 v[100:103], a[204:207], v[152:155], v[100:103]
    ds_read_b128 v[152:155], v4 offset:24576
    v_cvt_pk_bf16_f32 v52, v96, v97
    v_mfma_f32_16x16x32_bf16 v[100:103], a[228:231], v[156:159], v[100:103]
    ds_read_b128 v[156:159], v25 offset:24576
    v_cvt_pk_bf16_f32 v53, v98, v99
    v_mfma_f32_16x16x32_bf16 v[100:103], a[252:255], v[160:163], v[100:103]
    ds_read_b128 v[160:163], v4 offset:26624
    s_add_u32 m0, s90, 81920
    s_mov_b32 s57, 344064
    v_mfma_f32_16x16x32_bf16 v[100:103], v[196:199], v[164:167], v[100:103]
    ds_read_b128 v[164:167], v25 offset:26624
    buffer_load_dwordx4 v2, s[8:11], s57 offen offset:0 lds
    v_mfma_f32_16x16x32_bf16 v[100:103], v[220:223], v[168:171], v[100:103]
    ds_read_b128 v[168:171], v4 offset:28672
    v_mfma_f32_16x16x32_bf16 v[100:103], v[244:247], v[172:175], v[100:103]
    ds_read_b128 v[172:175], v25 offset:28672
    s_waitcnt lgkmcnt(11)
    v_mfma_f32_16x16x32_bf16 v[104:107], a[8:11], v[120:123], 0
    s_mov_b32 s57, 353792
    v_mfma_f32_16x16x32_bf16 v[104:107], a[32:35], v[124:127], v[104:107]
    buffer_load_dwordx4 v2, s[8:11], s57 offen offset:1024 lds
    v_mfma_f32_16x16x32_bf16 v[104:107], a[56:59], v[128:131], v[104:107]
    s_waitcnt lgkmcnt(8)
    v_mfma_f32_16x16x32_bf16 v[104:107], a[80:83], v[132:135], v[104:107]
    s_waitcnt vmcnt(10)
    s_barrier
    v_mfma_f32_16x16x32_bf16 v[104:107], a[104:107], v[136:139], v[104:107]
    s_add_u32 m0, s90, 90112
    s_mov_b32 s57, 430080
    ds_read_b64_tr_b16 v[248:249], v12 offset:24576
    v_mfma_f32_16x16x32_bf16 v[104:107], a[128:131], v[140:143], v[104:107]
    buffer_load_dwordx4 v2, s[8:11], s57 offen offset:0 lds
    s_waitcnt lgkmcnt(6)
    v_mfma_f32_16x16x32_bf16 v[104:107], a[152:155], v[144:147], v[104:107]
    v_cvt_pk_bf16_f32 v54, v100, v101
    v_cvt_pk_bf16_f32 v55, v102, v103
    v_mfma_f32_16x16x32_bf16 v[104:107], a[176:179], v[148:151], v[104:107]
    v_cndmask_b32 v54, v54, 0, s[82:83]
    v_cndmask_b32 v55, v55, 0, s[82:83]
    v_mfma_f32_16x16x32_bf16 v[104:107], a[200:203], v[152:155], v[104:107]
    s_mov_b32 s57, 439808
    ds_read_b64_tr_b16 v[250:251], v12 offset:25600
    s_waitcnt lgkmcnt(4)
    v_mfma_f32_16x16x32_bf16 v[104:107], a[224:227], v[156:159], v[104:107]
    buffer_load_dwordx4 v2, s[8:11], s57 offen offset:1024 lds
    v_mfma_f32_16x16x32_bf16 v[104:107], a[248:251], v[160:163], v[104:107]
    ds_read_b64_tr_b16 v[252:253], v13 offset:24576
    ds_read_b64_tr_b16 v[254:255], v13 offset:25600
    v_mfma_f32_16x16x32_bf16 v[104:107], v[192:195], v[164:167], v[104:107]
    ds_read_b64_tr_b16 a[0:1], v10 offset:32768
    ds_read_b64_tr_b16 a[2:3], v10 offset:33792
    s_waitcnt lgkmcnt(6)
    v_mfma_f32_16x16x32_bf16 v[104:107], v[216:219], v[168:171], v[104:107]
    s_add_u32 m0, s90, 98304
    s_mov_b32 s57, 516096
    ds_read_b64_tr_b16 a[4:5], v11 offset:32768
    v_mfma_f32_16x16x32_bf16 v[104:107], v[240:243], v[172:175], v[104:107]
    buffer_load_dwordx4 v2, s[8:11], s57 offen offset:0 lds
    s_waitcnt vmcnt(9)
    s_barrier
    v_mfma_f32_16x16x32_bf16 v[108:111], a[12:15], v[120:123], 0
    ds_read_b128 v[120:123], v4 offset:32768
    ds_read_b64_tr_b16 a[6:7], v11 offset:33792
    v_mfma_f32_16x16x32_bf16 v[108:111], a[36:39], v[124:127], v[108:111]
    ds_read_b128 v[124:127], v25 offset:32768
    ds_read_b64_tr_b16 a[24:25], v10 offset:40960
    v_mfma_f32_16x16x32_bf16 v[108:111], a[60:63], v[128:131], v[108:111]
    ds_read_b128 v[128:131], v4 offset:34816
    s_mov_b32 s57, 525824
    v_mfma_f32_16x16x32_bf16 v[108:111], a[84:87], v[132:135], v[108:111]
    ds_read_b128 v[132:135], v25 offset:34816
    buffer_load_dwordx4 v2, s[8:11], s57 offen offset:1024 lds
    v_mfma_f32_16x16x32_bf16 v[108:111], a[108:111], v[136:139], v[108:111]
    ds_read_b128 v[136:139], v4 offset:36864
    ds_read_b64_tr_b16 a[26:27], v10 offset:41984
    v_mfma_f32_16x16x32_bf16 v[108:111], a[132:135], v[140:143], v[108:111]
    ds_read_b128 v[140:143], v25 offset:36864
    ds_read_b64_tr_b16 a[28:29], v11 offset:40960
    v_mfma_f32_16x16x32_bf16 v[108:111], a[156:159], v[144:147], v[108:111]
    ds_read_b128 v[144:147], v4 offset:38912
    s_add_u32 m0, s90, 106496
    s_mov_b32 s57, 602112
    v_mfma_f32_16x16x32_bf16 v[108:111], a[180:183], v[148:151], v[108:111]
    ds_read_b128 v[148:151], v25 offset:38912
    buffer_load_dwordx4 v2, s[8:11], s57 offen offset:0 lds
    v_mfma_f32_16x16x32_bf16 v[108:111], a[204:207], v[152:155], v[108:111]
    ds_read_b128 v[152:155], v4 offset:40960
    v_cvt_pk_bf16_f32 v56, v104, v105
    v_mfma_f32_16x16x32_bf16 v[108:111], a[228:231], v[156:159], v[108:111]
    ds_read_b128 v[156:159], v25 offset:40960
    v_cvt_pk_bf16_f32 v57, v106, v107
    v_mfma_f32_16x16x32_bf16 v[108:111], a[252:255], v[160:163], v[108:111]
    ds_read_b128 v[160:163], v4 offset:43008
    s_mov_b32 s57, 611840
    v_mfma_f32_16x16x32_bf16 v[108:111], v[196:199], v[164:167], v[108:111]
    ds_read_b128 v[164:167], v25 offset:43008
    buffer_load_dwordx4 v2, s[8:11], s57 offen offset:1024 lds
    v_mfma_f32_16x16x32_bf16 v[108:111], v[220:223], v[168:171], v[108:111]
    ds_read_b128 v[168:171], v4 offset:45056
    ds_read_b64_tr_b16 a[30:31], v11 offset:41984
    v_mfma_f32_16x16x32_bf16 v[108:111], v[244:247], v[172:175], v[108:111]
    ds_read_b128 v[172:175], v25 offset:45056
    s_waitcnt lgkmcnt(14)
    v_mfma_f32_16x16x32_bf16 v[112:115], a[8:11], v[120:123], 0
    s_add_u32 m0, s90, 114688
    s_mov_b32 s57, 688128
    v_mfma_f32_16x16x32_bf16 v[112:115], a[32:35], v[124:127], v[112:115]
    buffer_load_dwordx4 v2, s[8:11], s57 offen offset:0 lds
    v_mfma_f32_16x16x32_bf16 v[112:115], a[56:59], v[128:131], v[112:115]
    s_waitcnt lgkmcnt(10)
    v_mfma_f32_16x16x32_bf16 v[112:115], a[80:83], v[132:135], v[112:115]
    v_mfma_f32_16x16x32_bf16 v[112:115], a[104:107], v[136:139], v[112:115]
    s_mov_b32 s57, 697856
    v_mfma_f32_16x16x32_bf16 v[112:115], a[128:131], v[140:143], v[112:115]
    buffer_load_dwordx4 v2, s[8:11], s57 offen offset:1024 lds
    s_waitcnt lgkmcnt(6)
    v_mfma_f32_16x16x32_bf16 v[112:115], a[152:155], v[144:147], v[112:115]
    v_cvt_pk_bf16_f32 v58, v108, v109
    v_cvt_pk_bf16_f32 v59, v110, v111
    v_mfma_f32_16x16x32_bf16 v[112:115], a[176:179], v[148:151], v[112:115]
    v_cndmask_b32 v58, v58, 0, s[82:83]
    v_cndmask_b32 v59, v59, 0, s[82:83]
    v_mfma_f32_16x16x32_bf16 v[112:115], a[200:203], v[152:155], v[112:115]
    s_add_u32 m0, s90, 122880
    s_mov_b32 s57, 774144
    s_waitcnt lgkmcnt(3)
    v_mfma_f32_16x16x32_bf16 v[112:115], a[224:227], v[156:159], v[112:115]
    buffer_load_dwordx4 v2, s[8:11], s57 offen offset:0 lds
    v_mfma_f32_16x16x32_bf16 v[112:115], a[248:251], v[160:163], v[112:115]
    v_mfma_f32_16x16x32_bf16 v[112:115], v[192:195], v[164:167], v[112:115]
    s_waitcnt lgkmcnt(0)
    v_mfma_f32_16x16x32_bf16 v[112:115], v[216:219], v[168:171], v[112:115]
    s_mov_b32 s57, 783872
    v_mfma_f32_16x16x32_bf16 v[112:115], v[240:243], v[172:175], v[112:115]
    buffer_load_dwordx4 v2, s[8:11], s57 offen offset:1024 lds
    v_mfma_f32_16x16x32_bf16 v[116:119], a[12:15], v[120:123], 0
    v_mfma_f32_16x16x32_bf16 v[116:119], a[36:39], v[124:127], v[116:119]
    s_waitcnt vmcnt(10)
    s_barrier
    v_mfma_f32_16x16x32_bf16 v[116:119], a[60:63], v[128:131], v[116:119]
    s_add_u32 m0, s90, 131072
    s_mov_b32 s57, 860160
    ds_read_b64_tr_b16 a[48:49], v6 offset:0
    v_mfma_f32_16x16x32_bf16 v[116:119], a[84:87], v[132:135], v[116:119]
    buffer_load_dwordx4 v2, s[8:11], s57 offen offset:0 lds
    v_mfma_f32_16x16x32_bf16 v[116:119], a[108:111], v[136:139], v[116:119]
    ds_read_b64_tr_b16 a[50:51], v6 offset:1024
    ds_read_b64_tr_b16 a[52:53], v7 offset:0
    v_mfma_f32_16x16x32_bf16 v[116:119], a[132:135], v[140:143], v[116:119]
    ds_read_b64_tr_b16 a[54:55], v7 offset:1024
    ds_read_b64_tr_b16 a[72:73], v6 offset:8192
    v_mfma_f32_16x16x32_bf16 v[116:119], a[156:159], v[144:147], v[116:119]
    s_mov_b32 s57, 869888
    v_cvt_pk_bf16_f32 v60, v112, v113
    v_mfma_f32_16x16x32_bf16 v[116:119], a[180:183], v[148:151], v[116:119]
    buffer_load_dwordx4 v2, s[8:11], s57 offen offset:1024 lds
    v_mfma_f32_16x16x32_bf16 v[116:119], a[204:207], v[152:155], v[116:119]
    v_cvt_pk_bf16_f32 v61, v114, v115
    ds_read_b64_tr_b16 a[74:75], v6 offset:9216
    v_mfma_f32_16x16x32_bf16 v[116:119], a[228:231], v[156:159], v[116:119]
    ds_read_b64_tr_b16 a[76:77], v7 offset:8192
    ds_read_b64_tr_b16 a[78:79], v7 offset:9216
    v_mfma_f32_16x16x32_bf16 v[116:119], a[252:255], v[160:163], v[116:119]
    s_add_u32 m0, s90, 139264
    s_mov_b32 s57, 946176
    ds_read_b64_tr_b16 a[96:97], v6 offset:16384
    v_mfma_f32_16x16x32_bf16 v[116:119], v[196:199], v[164:167], v[116:119]
    buffer_load_dwordx4 v2, s[8:11], s57 offen offset:0 lds
    v_mfma_f32_16x16x32_bf16 v[116:119], v[220:223], v[168:171], v[116:119]
    ds_read_b64_tr_b16 a[98:99], v6 offset:17408
    ds_read_b64_tr_b16 a[100:101], v7 offset:16384
    v_mfma_f32_16x16x32_bf16 v[116:119], v[244:247], v[172:175], v[116:119]
    ds_read_b64_tr_b16 a[102:103], v7 offset:17408
    v_mfma_f32_16x16x32_bf16 v[96:99], v[120:123], a[16:19], 0
    s_mov_b32 s57, 955904
    v_mfma_f32_16x16x32_bf16 v[96:99], v[124:127], a[40:43], v[96:99]
    buffer_load_dwordx4 v2, s[8:11], s57 offen offset:1024 lds
    v_mfma_f32_16x16x32_bf16 v[96:99], v[128:131], a[64:67], v[96:99]
    v_mfma_f32_16x16x32_bf16 v[96:99], v[132:135], a[88:91], v[96:99]
    v_mfma_f32_16x16x32_bf16 v[96:99], v[136:139], a[112:115], v[96:99]
    s_add_u32 m0, s90, 147456
    s_mov_b32 s57, 1032192
    v_mfma_f32_16x16x32_bf16 v[96:99], v[140:143], a[136:139], v[96:99]
    buffer_load_dwordx4 v2, s[8:11], s57 offen offset:0 lds
    v_mfma_f32_16x16x32_bf16 v[96:99], v[144:147], a[160:163], v[96:99]
    v_cvt_pk_bf16_f32 v62, v116, v117
    v_cvt_pk_bf16_f32 v63, v118, v119
    v_mfma_f32_16x16x32_bf16 v[96:99], v[148:151], a[184:187], v[96:99]
    v_cndmask_b32 v62, v62, 0, s[82:83]
    v_cndmask_b32 v63, v63, 0, s[82:83]
    v_mfma_f32_16x16x32_bf16 v[96:99], v[152:155], a[208:211], v[96:99]
    s_mov_b32 s57, 1041920
    v_mfma_f32_16x16x32_bf16 v[96:99], v[156:159], a[232:235], v[96:99]
    buffer_load_dwordx4 v2, s[8:11], s57 offen offset:1024 lds
    v_mfma_f32_16x16x32_bf16 v[96:99], v[160:163], v[176:179], v[96:99]
    v_mfma_f32_16x16x32_bf16 v[96:99], v[164:167], v[200:203], v[96:99]
    s_waitcnt vmcnt(10)
    s_waitcnt lgkmcnt(0)
    s_barrier
    v_mfma_f32_16x16x32_bf16 v[96:99], v[168:171], v[224:227], v[96:99]
    s_add_u32 m0, s90, 155648
    s_mov_b32 s57, 1118208
    ds_read_b64_tr_b16 a[120:121], v6 offset:24576
    v_mfma_f32_16x16x32_bf16 v[96:99], v[172:175], v[248:251], v[96:99]
    buffer_load_dwordx4 v2, s[8:11], s57 offen offset:0 lds
    v_mfma_f32_16x16x32_bf16 v[100:103], v[120:123], a[20:23], 0
    ds_read_b128 v[120:123], v4 offset:16384
    ds_read_b64_tr_b16 a[122:123], v6 offset:25600
    v_mfma_f32_16x16x32_bf16 v[100:103], v[124:127], a[44:47], v[100:103]
    ds_read_b128 v[124:127], v25 offset:16384
    ds_read_b64_tr_b16 a[124:125], v7 offset:24576
    v_mfma_f32_16x16x32_bf16 v[100:103], v[128:131], a[68:71], v[100:103]
    ds_read_b128 v[128:131], v4 offset:18432
    s_mov_b32 s57, 1127936
    v_mfma_f32_16x16x32_bf16 v[100:103], v[132:135], a[92:95], v[100:103]
    ds_read_b128 v[132:135], v25 offset:18432
    buffer_load_dwordx4 v2, s[8:11], s57 offen offset:1024 lds
    v_mfma_f32_16x16x32_bf16 v[100:103], v[136:139], a[116:119], v[100:103]
    ds_read_b128 v[136:139], v4 offset:20480
    ds_read_b64_tr_b16 a[126:127], v7 offset:25600
    v_mfma_f32_16x16x32_bf16 v[100:103], v[140:143], a[140:143], v[100:103]
    ds_read_b128 v[140:143], v25 offset:20480
    ds_read_b64_tr_b16 a[144:145], v6 offset:32768
    v_mfma_f32_16x16x32_bf16 v[100:103], v[144:147], a[164:167], v[100:103]
    ds_read_b128 v[144:147], v4 offset:22528
    s_add_u32 m0, s52, 49152
    s_add_u32 s58, s72, 28672
    s_add_u32 s57, s58, s68
    v_mfma_f32_16x16x32_bf16 v[100:103], v[148:151], a[188:191], v[100:103]
    ds_read_b128 v[148:151], v25 offset:22528
    buffer_load_dwordx4 v3, s[24:27], s57 offen offset:0 sc1 lds
    v_mfma_f32_16x16x32_bf16 v[100:103], v[152:155], a[212:215], v[100:103]
    ds_read_b128 v[152:155], v4 offset:24576
    v_cvt_pk_bf16_f32 v36, v96, v97
    v_mfma_f32_16x16x32_bf16 v[100:103], v[156:159], a[236:239], v[100:103]
    ds_read_b128 v[156:159], v25 offset:24576
    v_cvt_pk_bf16_f32 v37, v98, v99
    v_mfma_f32_16x16x32_bf16 v[100:103], v[160:163], v[180:183], v[100:103]
    ds_read_b128 v[160:163], v4 offset:26624
    s_add_u32 s57, s58, s69
    v_mfma_f32_16x16x32_bf16 v[100:103], v[164:167], v[204:207], v[100:103]
    ds_read_b128 v[164:167], v25 offset:26624
    buffer_load_dwordx4 v3, s[24:27], s57 offen offset:1024 sc1 lds
    v_mfma_f32_16x16x32_bf16 v[100:103], v[168:171], v[228:231], v[100:103]
    ds_read_b128 v[168:171], v4 offset:28672
    ds_read_b64_tr_b16 a[146:147], v6 offset:33792
    v_mfma_f32_16x16x32_bf16 v[100:103], v[172:175], v[252:255], v[100:103]
    ds_read_b128 v[172:175], v25 offset:28672
    ds_read_b64_tr_b16 a[148:149], v7 offset:32768
    s_waitcnt lgkmcnt(15)
    v_mfma_f32_16x16x32_bf16 v[104:107], v[120:123], a[16:19], 0
    s_add_u32 s57, s58, s70
    ds_read_b64_tr_b16 a[150:151], v7 offset:33792
    v_mfma_f32_16x16x32_bf16 v[104:107], v[124:127], a[40:43], v[104:107]
    buffer_load_dwordx4 v3, s[24:27], s57 offen offset:2048 sc1 lds
    v_mfma_f32_16x16x32_bf16 v[104:107], v[128:131], a[64:67], v[104:107]
    ds_read_b64_tr_b16 a[168:169], v6 offset:40960
    ds_read_b64_tr_b16 a[170:171], v6 offset:41984
    s_waitcnt lgkmcnt(14)
    v_mfma_f32_16x16x32_bf16 v[104:107], v[132:135], a[88:91], v[104:107]
    ds_read_b64_tr_b16 a[172:173], v7 offset:40960
    ds_read_b64_tr_b16 a[174:175], v7 offset:41984
    v_mfma_f32_16x16x32_bf16 v[104:107], v[136:139], a[112:115], v[104:107]
    s_add_u32 s57, s58, s71
    v_mfma_f32_16x16x32_bf16 v[104:107], v[140:143], a[136:139], v[104:107]
    buffer_load_dwordx4 v3, s[24:27], s57 offen offset:3072 sc1 lds
    s_waitcnt lgkmcnt(12)
    v_mfma_f32_16x16x32_bf16 v[104:107], v[144:147], a[160:163], v[104:107]
    v_cvt_pk_bf16_f32 v46, v100, v101
    v_cvt_pk_bf16_f32 v47, v102, v103
    v_mfma_f32_16x16x32_bf16 v[104:107], v[148:151], a[184:187], v[104:107]
    s_waitcnt vmcnt(10)
    s_waitcnt lgkmcnt(0)
    s_barrier
    v_mfma_f32_16x16x32_bf16 v[104:107], v[152:155], a[208:211], v[104:107]
    ds_read_b64_tr_b16 a[192:193], v10 offset:0
    ds_read_b64_tr_b16 a[194:195], v10 offset:1024
    v_mfma_f32_16x16x32_bf16 v[104:107], v[156:159], a[232:235], v[104:107]
    ds_read_b64_tr_b16 a[196:197], v11 offset:0
    ds_read_b64_tr_b16 a[198:199], v11 offset:1024
    v_mfma_f32_16x16x32_bf16 v[104:107], v[160:163], v[176:179], v[104:107]
    ds_read_b64_tr_b16 a[216:217], v10 offset:8192
    ds_read_b64_tr_b16 a[218:219], v10 offset:9216
    v_mfma_f32_16x16x32_bf16 v[104:107], v[164:167], v[200:203], v[104:107]
    ds_read_b64_tr_b16 a[220:221], v11 offset:8192
    ds_read_b64_tr_b16 a[222:223], v11 offset:9216
    v_mfma_f32_16x16x32_bf16 v[104:107], v[168:171], v[224:227], v[104:107]
    ds_read_b64_tr_b16 a[240:241], v10 offset:16384
    ds_read_b64_tr_b16 a[242:243], v10 offset:17408
    v_mfma_f32_16x16x32_bf16 v[104:107], v[172:175], v[248:251], v[104:107]
    ds_read_b64_tr_b16 a[244:245], v11 offset:16384
    ds_read_b64_tr_b16 a[246:247], v11 offset:17408
    v_mfma_f32_16x16x32_bf16 v[108:111], v[120:123], a[20:23], 0
    ds_read_b128 v[120:123], v4 offset:0
    v_mfma_f32_16x16x32_bf16 v[108:111], v[124:127], a[44:47], v[108:111]
    ds_read_b128 v[124:127], v25 offset:0
    v_mfma_f32_16x16x32_bf16 v[108:111], v[128:131], a[68:71], v[108:111]
    ds_read_b128 v[128:131], v4 offset:2048
    v_mfma_f32_16x16x32_bf16 v[108:111], v[132:135], a[92:95], v[108:111]
    ds_read_b128 v[132:135], v25 offset:2048
    v_mfma_f32_16x16x32_bf16 v[108:111], v[136:139], a[116:119], v[108:111]
    ds_read_b128 v[136:139], v4 offset:4096
    v_mfma_f32_16x16x32_bf16 v[108:111], v[140:143], a[140:143], v[108:111]
    ds_read_b128 v[140:143], v25 offset:4096
    v_mfma_f32_16x16x32_bf16 v[108:111], v[144:147], a[164:167], v[108:111]
    ds_read_b128 v[144:147], v4 offset:6144
    v_cvt_pk_bf16_f32 v34, v104, v105
    v_mfma_f32_16x16x32_bf16 v[108:111], v[148:151], a[188:191], v[108:111]
    ds_read_b128 v[148:151], v25 offset:6144
    v_cvt_pk_bf16_f32 v35, v106, v107
    v_mfma_f32_16x16x32_bf16 v[108:111], v[152:155], a[212:215], v[108:111]
    ds_read_b128 v[152:155], v4 offset:8192
    v_mfma_f32_16x16x32_bf16 v[108:111], v[156:159], a[236:239], v[108:111]
    ds_read_b128 v[156:159], v25 offset:8192
    v_mfma_f32_16x16x32_bf16 v[108:111], v[160:163], v[180:183], v[108:111]
    ds_read_b128 v[160:163], v4 offset:10240
    v_mfma_f32_16x16x32_bf16 v[108:111], v[164:167], v[204:207], v[108:111]
    ds_read_b128 v[164:167], v25 offset:10240
    v_mfma_f32_16x16x32_bf16 v[108:111], v[168:171], v[228:231], v[108:111]
    ds_read_b128 v[168:171], v4 offset:12288
    v_mfma_f32_16x16x32_bf16 v[108:111], v[172:175], v[252:255], v[108:111]
    ds_read_b128 v[172:175], v25 offset:12288
    s_waitcnt lgkmcnt(11)
    v_mfma_f32_16x16x32_bf16 v[112:115], v[120:123], a[16:19], 0
    v_mfma_f32_16x16x32_bf16 v[112:115], v[124:127], a[40:43], v[112:115]
    v_mfma_f32_16x16x32_bf16 v[112:115], v[128:131], a[64:67], v[112:115]
    s_waitcnt lgkmcnt(8)
    v_mfma_f32_16x16x32_bf16 v[112:115], v[132:135], a[88:91], v[112:115]
    s_waitcnt vmcnt(4)
    s_barrier
    v_mfma_f32_16x16x32_bf16 v[112:115], v[136:139], a[112:115], v[112:115]
    ds_read_b64_tr_b16 v[184:185], v10 offset:24576
    ds_read_b64_tr_b16 v[186:187], v10 offset:25600
    v_mfma_f32_16x16x32_bf16 v[112:115], v[140:143], a[136:139], v[112:115]
    ds_read_b64_tr_b16 v[188:189], v11 offset:24576
    ds_read_b64_tr_b16 v[190:191], v11 offset:25600
    s_waitcnt lgkmcnt(9)
    v_mfma_f32_16x16x32_bf16 v[112:115], v[144:147], a[160:163], v[112:115]
    v_cvt_pk_bf16_f32 v44, v108, v109
    v_cvt_pk_bf16_f32 v45, v110, v111
    v_mfma_f32_16x16x32_bf16 v[112:115], v[148:151], a[184:187], v[112:115]
    ds_read_b64_tr_b16 v[208:209], v10 offset:32768
    ds_read_b64_tr_b16 v[210:211], v10 offset:33792
    v_mfma_f32_16x16x32_bf16 v[112:115], v[152:155], a[208:211], v[112:115]
    ds_read_b64_tr_b16 v[212:213], v11 offset:32768
    ds_read_b64_tr_b16 v[214:215], v11 offset:33792
    s_waitcnt lgkmcnt(10)
    v_mfma_f32_16x16x32_bf16 v[112:115], v[156:159], a[232:235], v[112:115]
    ds_read_b64_tr_b16 v[232:233], v10 offset:40960
    ds_read_b64_tr_b16 v[234:235], v10 offset:41984
    v_mfma_f32_16x16x32_bf16 v[112:115], v[160:163], v[176:179], v[112:115]
    ds_read_b64_tr_b16 v[236:237], v11 offset:40960
    ds_read_b64_tr_b16 v[238:239], v11 offset:41984
    v_mfma_f32_16x16x32_bf16 v[112:115], v[164:167], v[200:203], v[112:115]
    s_waitcnt lgkmcnt(12)
    v_mfma_f32_16x16x32_bf16 v[112:115], v[168:171], v[224:227], v[112:115]
    v_mfma_f32_16x16x32_bf16 v[112:115], v[172:175], v[248:251], v[112:115]
    v_mfma_f32_16x16x32_bf16 v[116:119], v[120:123], a[20:23], 0
    ds_read_b128 v[120:123], v4 offset:16384
    v_mfma_f32_16x16x32_bf16 v[116:119], v[124:127], a[44:47], v[116:119]
    ds_read_b128 v[124:127], v25 offset:16384
    s_waitcnt lgkmcnt(2)
    s_barrier
    v_mfma_f32_16x16x32_bf16 v[116:119], v[128:131], a[68:71], v[116:119]
    ds_read_b128 v[128:131], v4 offset:18432
    s_add_u32 m0, s52, 65536
    s_add_u32 s58, s72, 43008
    s_add_u32 s57, s58, s68
    v_mfma_f32_16x16x32_bf16 v[116:119], v[132:135], a[92:95], v[116:119]
    ds_read_b128 v[132:135], v25 offset:18432
    buffer_load_dwordx4 v3, s[24:27], s57 offen offset:0 sc1 lds
    v_mfma_f32_16x16x32_bf16 v[116:119], v[136:139], a[116:119], v[116:119]
    ds_read_b128 v[136:139], v4 offset:20480
    v_mfma_f32_16x16x32_bf16 v[116:119], v[140:143], a[140:143], v[116:119]
    ds_read_b128 v[140:143], v25 offset:20480
    v_mfma_f32_16x16x32_bf16 v[116:119], v[144:147], a[164:167], v[116:119]
    ds_read_b128 v[144:147], v4 offset:22528
    v_cvt_pk_bf16_f32 v32, v112, v113
    v_mfma_f32_16x16x32_bf16 v[116:119], v[148:151], a[188:191], v[116:119]
    ds_read_b128 v[148:151], v25 offset:22528
    v_cvt_pk_bf16_f32 v33, v114, v115
    v_mfma_f32_16x16x32_bf16 v[116:119], v[152:155], a[212:215], v[116:119]
    ds_read_b128 v[152:155], v4 offset:24576
    s_add_u32 s57, s58, s69
    v_mfma_f32_16x16x32_bf16 v[116:119], v[156:159], a[236:239], v[116:119]
    ds_read_b128 v[156:159], v25 offset:24576
    buffer_load_dwordx4 v3, s[24:27], s57 offen offset:1024 sc1 lds
    v_mfma_f32_16x16x32_bf16 v[116:119], v[160:163], v[180:183], v[116:119]
    ds_read_b128 v[160:163], v4 offset:26624
    v_mfma_f32_16x16x32_bf16 v[116:119], v[164:167], v[204:207], v[116:119]
    ds_read_b128 v[164:167], v25 offset:26624
    v_mfma_f32_16x16x32_bf16 v[116:119], v[168:171], v[228:231], v[116:119]
    ds_read_b128 v[168:171], v4 offset:28672
    v_mfma_f32_16x16x32_bf16 v[116:119], v[172:175], v[252:255], v[116:119]
    ds_read_b128 v[172:175], v25 offset:28672
    s_waitcnt lgkmcnt(11)
    v_mfma_f32_16x16x32_bf16 v[96:99], a[0:3], v[120:123], 0
    s_add_u32 s57, s58, s70
    v_mfma_f32_16x16x32_bf16 v[96:99], a[24:27], v[124:127], v[96:99]
    buffer_load_dwordx4 v3, s[24:27], s57 offen offset:2048 sc1 lds
    v_mfma_f32_16x16x32_bf16 v[96:99], a[48:51], v[128:131], v[96:99]
    s_waitcnt lgkmcnt(8)
    v_mfma_f32_16x16x32_bf16 v[96:99], a[72:75], v[132:135], v[96:99]
    v_mfma_f32_16x16x32_bf16 v[96:99], a[96:99], v[136:139], v[96:99]
    v_mfma_f32_16x16x32_bf16 v[96:99], a[120:123], v[140:143], v[96:99]
    s_waitcnt lgkmcnt(5)
    v_mfma_f32_16x16x32_bf16 v[96:99], a[144:147], v[144:147], v[96:99]
    s_add_u32 s57, s58, s71
    v_cvt_pk_bf16_f32 v42, v116, v117
    v_mfma_f32_16x16x32_bf16 v[96:99], a[168:171], v[148:151], v[96:99]
    buffer_load_dwordx4 v3, s[24:27], s57 offen offset:3072 sc1 lds
    v_mfma_f32_16x16x32_bf16 v[96:99], a[192:195], v[152:155], v[96:99]
    v_cvt_pk_bf16_f32 v43, v118, v119
    s_waitcnt lgkmcnt(2)
    v_mfma_f32_16x16x32_bf16 v[96:99], a[216:219], v[156:159], v[96:99]
    v_mfma_f32_16x16x32_bf16 v[96:99], a[240:243], v[160:163], v[96:99]
    v_mfma_f32_16x16x32_bf16 v[96:99], v[184:187], v[164:167], v[96:99]
    s_waitcnt lgkmcnt(0)
    v_mfma_f32_16x16x32_bf16 v[96:99], v[208:211], v[168:171], v[96:99]
    s_add_u32 m0, s52, 81920
    s_add_u32 s58, s72, 57344
    s_add_u32 s57, s58, s68
    v_mfma_f32_16x16x32_bf16 v[96:99], v[232:235], v[172:175], v[96:99]
    buffer_load_dwordx4 v3, s[24:27], s57 offen offset:0 sc1 lds
    v_mfma_f32_16x16x32_bf16 v[100:103], a[4:7], v[120:123], 0
    ds_read_b128 v[120:123], v4 offset:32768
    v_mfma_f32_16x16x32_bf16 v[100:103], a[28:31], v[124:127], v[100:103]
    ds_read_b128 v[124:127], v25 offset:32768
    v_mfma_f32_16x16x32_bf16 v[100:103], a[52:55], v[128:131], v[100:103]
    ds_read_b128 v[128:131], v4 offset:34816
    v_mfma_f32_16x16x32_bf16 v[100:103], a[76:79], v[132:135], v[100:103]
    ds_read_b128 v[132:135], v25 offset:34816
    v_mfma_f32_16x16x32_bf16 v[100:103], a[100:103], v[136:139], v[100:103]
    ds_read_b128 v[136:139], v4 offset:36864
    s_add_u32 s57, s58, s69
    v_mfma_f32_16x16x32_bf16 v[100:103], a[124:127], v[140:143], v[100:103]
    ds_read_b128 v[140:143], v25 offset:36864
    buffer_load_dwordx4 v3, s[24:27], s57 offen offset:1024 sc1 lds
    v_mfma_f32_16x16x32_bf16 v[100:103], a[148:151], v[144:147], v[100:103]
    ds_read_b128 v[144:147], v4 offset:38912
    v_cvt_pk_bf16_f32 v68, v96, v97
    v_mfma_f32_16x16x32_bf16 v[100:103], a[172:175], v[148:151], v[100:103]
    ds_read_b128 v[148:151], v25 offset:38912
    v_cvt_pk_bf16_f32 v69, v98, v99
    v_mfma_f32_16x16x32_bf16 v[100:103], a[196:199], v[152:155], v[100:103]
    ds_read_b128 v[152:155], v4 offset:40960
    v_mfma_f32_16x16x32_bf16 v[100:103], a[220:223], v[156:159], v[100:103]
    ds_read_b128 v[156:159], v25 offset:40960
    v_mfma_f32_16x16x32_bf16 v[100:103], a[244:247], v[160:163], v[100:103]
    ds_read_b128 v[160:163], v4 offset:43008
    s_add_u32 s57, s58, s70
    v_mfma_f32_16x16x32_bf16 v[100:103], v[188:191], v[164:167], v[100:103]
    ds_read_b128 v[164:167], v25 offset:43008
    buffer_load_dwordx4 v3, s[24:27], s57 offen offset:2048 sc1 lds
    v_mfma_f32_16x16x32_bf16 v[100:103], v[212:215], v[168:171], v[100:103]
    ds_read_b128 v[168:171], v4 offset:45056
    v_mfma_f32_16x16x32_bf16 v[100:103], v[236:239], v[172:175], v[100:103]
    ds_read_b128 v[172:175], v25 offset:45056
    s_waitcnt lgkmcnt(11)
    v_mfma_f32_16x16x32_bf16 v[104:107], a[0:3], v[120:123], 0
    v_mfma_f32_16x16x32_bf16 v[104:107], a[24:27], v[124:127], v[104:107]
    v_mfma_f32_16x16x32_bf16 v[104:107], a[48:51], v[128:131], v[104:107]
    s_add_u32 s57, s58, s71
    s_waitcnt lgkmcnt(8)
    v_mfma_f32_16x16x32_bf16 v[104:107], a[72:75], v[132:135], v[104:107]
    buffer_load_dwordx4 v3, s[24:27], s57 offen offset:3072 sc1 lds
    v_mfma_f32_16x16x32_bf16 v[104:107], a[96:99], v[136:139], v[104:107]
    v_mfma_f32_16x16x32_bf16 v[104:107], a[120:123], v[140:143], v[104:107]
    s_waitcnt lgkmcnt(5)
    v_mfma_f32_16x16x32_bf16 v[104:107], a[144:147], v[144:147], v[104:107]
    v_cvt_pk_bf16_f32 v70, v100, v101
    v_cvt_pk_bf16_f32 v71, v102, v103
    v_mfma_f32_16x16x32_bf16 v[104:107], a[168:171], v[148:151], v[104:107]
    v_cndmask_b32 v70, v70, 0, s[82:83]
    v_cndmask_b32 v71, v71, 0, s[82:83]
    v_mfma_f32_16x16x32_bf16 v[104:107], a[192:195], v[152:155], v[104:107]
    s_add_u32 m0, s52, 98304
    s_add_u32 s58, s72, 71680
    s_add_u32 s57, s58, s68
    s_waitcnt lgkmcnt(2)
    v_mfma_f32_16x16x32_bf16 v[104:107], a[216:219], v[156:159], v[104:107]
    buffer_load_dwordx4 v3, s[24:27], s57 offen offset:0 sc1 lds
    v_mfma_f32_16x16x32_bf16 v[104:107], a[240:243], v[160:163], v[104:107]
    v_mfma_f32_16x16x32_bf16 v[72:75], v[52:55], v[68:71], 0
    v_mfma_f32_16x16x32_bf16 v[104:107], v[184:187], v[164:167], v[104:107]
    v_mfma_f32_16x16x32_bf16 v[76:79], v[56:59], v[68:71], 0
    s_waitcnt lgkmcnt(0)
    v_mfma_f32_16x16x32_bf16 v[104:107], v[208:211], v[168:171], v[104:107]
    v_mfma_f32_16x16x32_bf16 v[104:107], v[232:235], v[172:175], v[104:107]
    s_waitcnt vmcnt(9)
    s_barrier
    v_mfma_f32_16x16x32_bf16 v[108:111], a[4:7], v[120:123], 0
    ds_read_b128 v[120:123], v4 offset:49152
    s_add_u32 s57, s58, s69
    v_mfma_f32_16x16x32_bf16 v[108:111], a[28:31], v[124:127], v[108:111]
    ds_read_b128 v[124:127], v25 offset:49152
    buffer_load_dwordx4 v3, s[24:27], s57 offen offset:1024 sc1 lds
    v_mfma_f32_16x16x32_bf16 v[108:111], a[52:55], v[128:131], v[108:111]
    ds_read_b128 v[128:131], v4 offset:51200
    v_cndmask_b32 v26, v72, v73, s[76:77]
    v_mfma_f32_16x16x32_bf16 v[108:111], a[76:79], v[132:135], v[108:111]
    ds_read_b128 v[132:135], v25 offset:51200
    v_cndmask_b32 v27, v74, v75, s[76:77]
    v_mfma_f32_16x16x32_bf16 v[108:111], a[100:103], v[136:139], v[108:111]
    ds_read_b128 v[136:139], v4 offset:53248
    v_cndmask_b32 v28, v76, v77, s[76:77]
    v_mfma_f32_16x16x32_bf16 v[108:111], a[124:127], v[140:143], v[108:111]
    ds_read_b128 v[140:143], v25 offset:53248
    v_cndmask_b32 v29, v78, v79, s[76:77]
    v_mfma_f32_16x16x32_bf16 v[108:111], a[148:151], v[144:147], v[108:111]
    ds_read_b128 v[144:147], v4 offset:55296
    s_add_u32 s57, s58, s70
    v_mfma_f32_16x16x32_bf16 v[108:111], a[172:175], v[148:151], v[108:111]
    ds_read_b128 v[148:151], v25 offset:55296
    buffer_load_dwordx4 v3, s[24:27], s57 offen offset:2048 sc1 lds
    v_mfma_f32_16x16x32_bf16 v[108:111], a[196:199], v[152:155], v[108:111]
    ds_read_b128 v[152:155], v4 offset:57344
    v_cvt_pk_bf16_f32 v64, v104, v105
    v_mfma_f32_16x16x32_bf16 v[108:111], a[220:223], v[156:159], v[108:111]
    ds_read_b128 v[156:159], v25 offset:57344
    v_cvt_pk_bf16_f32 v65, v106, v107
    v_mfma_f32_16x16x32_bf16 v[108:111], a[244:247], v[160:163], v[108:111]
    ds_read_b128 v[160:163], v4 offset:59392
    v_cndmask_b32 v26, v26, v28, s[78:79]
    v_mfma_f32_16x16x32_bf16 v[108:111], v[188:191], v[164:167], v[108:111]
    ds_read_b128 v[164:167], v25 offset:59392
    v_cndmask_b32 v27, v27, v29, s[80:81]
    v_mfma_f32_16x16x32_bf16 v[108:111], v[212:215], v[168:171], v[108:111]
    ds_read_b128 v[168:171], v4 offset:61440
    s_add_u32 s57, s58, s71
    v_mfma_f32_16x16x32_bf16 v[108:111], v[236:239], v[172:175], v[108:111]
    ds_read_b128 v[172:175], v25 offset:61440
    buffer_load_dwordx4 v3, s[24:27], s57 offen offset:3072 sc1 lds
    s_waitcnt lgkmcnt(11)
    v_mfma_f32_16x16x32_bf16 v[112:115], a[8:11], v[120:123], 0
    v_cndmask_b32 v26, v26, v18, s[84:85]
    v_cndmask_b32 v27, v27, v18, s[86:87]
    v_mfma_f32_16x16x32_bf16 v[112:115], a[32:35], v[124:127], v[112:115]
    v_max_f32 v28, v26, v27
    v_mov_b32 v29, v28
    v_mfma_f32_16x16x32_bf16 v[112:115], a[56:59], v[128:131], v[112:115]
    s_waitcnt lgkmcnt(8)
    v_mfma_f32_16x16x32_bf16 v[112:115], a[80:83], v[132:135], v[112:115]
    v_permlane16_swap_b32 v28, v29
    v_max_f32 v28, v28, v29
    v_mfma_f32_16x16x32_bf16 v[112:115], a[104:107], v[136:139], v[112:115]
    s_add_u32 m0, s52, 114688
    s_add_u32 s58, s72, 86016
    s_add_u32 s57, s58, s68
    v_mov_b32 v29, v28
    v_mfma_f32_16x16x32_bf16 v[112:115], a[128:131], v[140:143], v[112:115]
    buffer_load_dwordx4 v3, s[24:27], s57 offen offset:0 sc1 lds
    s_waitcnt lgkmcnt(5)
    v_mfma_f32_16x16x32_bf16 v[112:115], a[152:155], v[144:147], v[112:115]
    v_cvt_pk_bf16_f32 v66, v108, v109
    v_cvt_pk_bf16_f32 v67, v110, v111
    v_mfma_f32_16x16x32_bf16 v[112:115], a[176:179], v[148:151], v[112:115]
    v_cndmask_b32 v66, v66, 0, s[82:83]
    v_cndmask_b32 v67, v67, 0, s[82:83]
    v_mfma_f32_16x16x32_bf16 v[112:115], a[200:203], v[152:155], v[112:115]
    v_permlane32_swap_b32 v28, v29
    v_max_f32 v28, v28, v29
    s_waitcnt lgkmcnt(2)
    v_mfma_f32_16x16x32_bf16 v[112:115], a[224:227], v[156:159], v[112:115]
    v_sub_f32 v26, v26, v28
    v_sub_f32 v27, v27, v28
    v_mfma_f32_16x16x32_bf16 v[112:115], a[248:251], v[160:163], v[112:115]
    s_add_u32 s57, s58, s69
    v_mul_f32 v26, s91, v26
    v_mfma_f32_16x16x32_bf16 v[112:115], v[192:195], v[164:167], v[112:115]
    buffer_load_dwordx4 v3, s[24:27], s57 offen offset:1024 sc1 lds
    s_waitcnt lgkmcnt(0)
    v_mfma_f32_16x16x32_bf16 v[112:115], v[216:219], v[168:171], v[112:115]
    v_mul_f32 v27, s91, v27
    v_exp_f32 v26, v26
    v_mfma_f32_16x16x32_bf16 v[112:115], v[240:243], v[172:175], v[112:115]
    v_exp_f32 v27, v27
    v_mfma_f32_16x16x32_bf16 v[116:119], a[12:15], v[120:123], 0
    v_add_f32 v28, v26, v27
    v_mov_b32 v29, v28
    v_mfma_f32_16x16x32_bf16 v[116:119], a[36:39], v[124:127], v[116:119]
    v_mfma_f32_16x16x32_bf16 v[116:119], a[60:63], v[128:131], v[116:119]
    s_add_u32 s57, s58, s70
    v_permlane16_swap_b32 v28, v29
    v_mfma_f32_16x16x32_bf16 v[116:119], a[84:87], v[132:135], v[116:119]
    buffer_load_dwordx4 v3, s[24:27], s57 offen offset:2048 sc1 lds
    v_mfma_f32_16x16x32_bf16 v[116:119], a[108:111], v[136:139], v[116:119]
    v_add_f32 v28, v28, v29
    v_mov_b32 v29, v28
    v_mfma_f32_16x16x32_bf16 v[116:119], a[132:135], v[140:143], v[116:119]
    v_mfma_f32_16x16x32_bf16 v[116:119], a[156:159], v[144:147], v[116:119]
    v_cvt_pk_bf16_f32 v52, v112, v113
    v_cvt_pk_bf16_f32 v53, v114, v115
    v_mfma_f32_16x16x32_bf16 v[116:119], a[180:183], v[148:151], v[116:119]
    v_permlane32_swap_b32 v28, v29
    v_add_f32 v28, v28, v29
    v_mfma_f32_16x16x32_bf16 v[116:119], a[204:207], v[152:155], v[116:119]
    s_add_u32 s57, s58, s71
    v_rcp_f32 v28, v28
    v_mfma_f32_16x16x32_bf16 v[116:119], a[228:231], v[156:159], v[116:119]
    buffer_load_dwordx4 v3, s[24:27], s57 offen offset:3072 sc1 lds
    v_mfma_f32_16x16x32_bf16 v[116:119], a[252:255], v[160:163], v[116:119]
    v_mul_f32 v26, v26, v28
    v_mul_f32 v27, v27, v28
    v_mfma_f32_16x16x32_bf16 v[116:119], v[196:199], v[164:167], v[116:119]
    v_cvt_pk_bf16_f32 v26, v26, v26
    v_cvt_pk_bf16_f32 v27, v27, v27
    v_mfma_f32_16x16x32_bf16 v[116:119], v[220:223], v[168:171], v[116:119]
    v_and_b32 v80, v26, v14
    v_and_b32 v81, v27, v15
    v_mfma_f32_16x16x32_bf16 v[116:119], v[244:247], v[172:175], v[116:119]
    v_and_b32 v82, v26, v16
    v_and_b32 v83, v27, v17
    v_mfma_f32_16x16x32_bf16 v[96:99], v[120:123], a[16:19], 0
    s_add_u32 m0, s52, 131072
    s_add_u32 s58, s72, 100352
    s_add_u32 s57, s58, s68
    v_mfma_f32_16x16x32_bf16 v[96:99], v[124:127], a[40:43], v[96:99]
    buffer_load_dwordx4 v3, s[24:27], s57 offen offset:0 sc1 lds
    v_mfma_f32_16x16x32_bf16 v[96:99], v[128:131], a[64:67], v[96:99]
    v_mfma_f32_16x16x32_bf16 v[72:75], v[32:35], v[80:83], 0
    v_mfma_f32_16x16x32_bf16 v[96:99], v[132:135], a[88:91], v[96:99]
    v_mfma_f32_16x16x32_bf16 v[76:79], v[42:45], v[80:83], 0
    v_mfma_f32_16x16x32_bf16 v[96:99], v[136:139], a[112:115], v[96:99]
    s_add_u32 s53, s74, 0
    v_mfma_f32_16x16x32_bf16 v[96:99], v[140:143], a[136:139], v[96:99]
    v_mfma_f32_16x16x32_bf16 v[96:99], v[144:147], a[160:163], v[96:99]
    s_add_u32 s57, s58, s69
    v_cvt_pk_bf16_f32 v54, v116, v117
    v_mfma_f32_16x16x32_bf16 v[96:99], v[148:151], a[184:187], v[96:99]
    buffer_load_dwordx4 v3, s[24:27], s57 offen offset:1024 sc1 lds
    v_mfma_f32_16x16x32_bf16 v[96:99], v[152:155], a[208:211], v[96:99]
    v_cvt_pk_bf16_f32 v55, v118, v119
    v_cndmask_b32 v54, v54, 0, s[82:83]
    v_mfma_f32_16x16x32_bf16 v[96:99], v[156:159], a[232:235], v[96:99]
    v_cndmask_b32 v55, v55, 0, s[82:83]
    v_cvt_pk_bf16_f32 v84, v72, v73
    v_mfma_f32_16x16x32_bf16 v[96:99], v[160:163], v[176:179], v[96:99]
    v_cvt_pk_bf16_f32 v85, v74, v75
    v_cvt_pk_bf16_f32 v86, v76, v77
    v_mfma_f32_16x16x32_bf16 v[96:99], v[164:167], v[200:203], v[96:99]
    v_cvt_pk_bf16_f32 v87, v78, v79
    v_cndmask_b32 v86, v86, 0, s[82:83]
    v_mfma_f32_16x16x32_bf16 v[96:99], v[168:171], v[224:227], v[96:99]
    s_add_u32 s57, s58, s70
    v_cndmask_b32 v87, v87, 0, s[82:83]
    v_mfma_f32_16x16x32_bf16 v[96:99], v[172:175], v[248:251], v[96:99]
    buffer_load_dwordx4 v3, s[24:27], s57 offen offset:2048 sc1 lds
    v_mfma_f32_16x16x32_bf16 v[100:103], v[120:123], a[20:23], 0
    buffer_store_dwordx4 v[84:87], v23, s[24:27], s53 offen sc1
    v_mfma_f32_16x16x32_bf16 v[100:103], v[124:127], a[44:47], v[100:103]
    v_mfma_f32_16x16x32_bf16 v[100:103], v[128:131], a[68:71], v[100:103]
    v_mfma_f32_16x16x32_bf16 v[72:75], v[56:59], v[64:67], 0
    v_mfma_f32_16x16x32_bf16 v[100:103], v[132:135], a[92:95], v[100:103]
    v_mfma_f32_16x16x32_bf16 v[76:79], v[60:63], v[64:67], 0
    v_mfma_f32_16x16x32_bf16 v[100:103], v[136:139], a[116:119], v[100:103]
    s_add_u32 s57, s58, s71
    v_mfma_f32_16x16x32_bf16 v[100:103], v[140:143], a[140:143], v[100:103]
    buffer_load_dwordx4 v3, s[24:27], s57 offen offset:3072 sc1 lds
    v_mfma_f32_16x16x32_bf16 v[100:103], v[144:147], a[164:167], v[100:103]
    v_cvt_pk_bf16_f32 v38, v96, v97
    v_cvt_pk_bf16_f32 v39, v98, v99
    v_mfma_f32_16x16x32_bf16 v[100:103], v[148:151], a[188:191], v[100:103]
    v_mfma_f32_16x16x32_bf16 v[100:103], v[152:155], a[212:215], v[100:103]
    v_cndmask_b32 v26, v72, v73, s[76:77]
    v_cndmask_b32 v27, v74, v75, s[76:77]
    v_mfma_f32_16x16x32_bf16 v[100:103], v[156:159], a[236:239], v[100:103]
    v_cndmask_b32 v28, v76, v77, s[76:77]
    v_cndmask_b32 v29, v78, v79, s[76:77]
    v_mfma_f32_16x16x32_bf16 v[100:103], v[160:163], v[180:183], v[100:103]
    s_add_u32 s57, s73, 0
    v_cndmask_b32 v26, v26, v28, s[78:79]
    v_mfma_f32_16x16x32_bf16 v[100:103], v[164:167], v[204:207], v[100:103]
    buffer_load_dword v22, v5, s[20:23], s57 offen
    v_mfma_f32_16x16x32_bf16 v[100:103], v[168:171], v[228:231], v[100:103]
    v_cndmask_b32 v27, v27, v29, s[80:81]
    v_max_f32 v28, v26, v27
    v_mfma_f32_16x16x32_bf16 v[100:103], v[172:175], v[252:255], v[100:103]
    v_mov_b32 v29, v28
    v_mfma_f32_16x16x32_bf16 v[104:107], a[0:3], v[120:123], 0
    v_mfma_f32_16x16x32_bf16 v[104:107], a[24:27], v[124:127], v[104:107]
    v_permlane16_swap_b32 v28, v29
    v_max_f32 v28, v28, v29
    v_mfma_f32_16x16x32_bf16 v[104:107], a[48:51], v[128:131], v[104:107]
    s_add_u32 s57, s73, 524288
    v_mov_b32 v29, v28
    v_mfma_f32_16x16x32_bf16 v[104:107], a[72:75], v[132:135], v[104:107]
    buffer_load_dword v22, v5, s[20:23], s57 offen
    v_mfma_f32_16x16x32_bf16 v[104:107], a[96:99], v[136:139], v[104:107]
    v_permlane32_swap_b32 v28, v29
    v_max_f32 v28, v28, v29
    v_mfma_f32_16x16x32_bf16 v[104:107], a[120:123], v[140:143], v[104:107]
    v_sub_f32 v26, v26, v28
    v_sub_f32 v27, v27, v28
    v_mfma_f32_16x16x32_bf16 v[104:107], a[144:147], v[144:147], v[104:107]
    v_cvt_pk_bf16_f32 v48, v100, v101
    v_cvt_pk_bf16_f32 v49, v102, v103
    v_mfma_f32_16x16x32_bf16 v[104:107], a[168:171], v[148:151], v[104:107]
    v_mul_f32 v26, s91, v26
    v_mul_f32 v27, s91, v27
    v_mfma_f32_16x16x32_bf16 v[104:107], a[192:195], v[152:155], v[104:107]
    s_add_u32 s57, s75, 0
    v_exp_f32 v26, v26
    v_mfma_f32_16x16x32_bf16 v[104:107], a[216:219], v[156:159], v[104:107]
    buffer_load_dword v22, v20, s[12:15], s57 offen
    v_mfma_f32_16x16x32_bf16 v[104:107], a[240:243], v[160:163], v[104:107]
    v_exp_f32 v27, v27
    v_mfma_f32_16x16x32_bf16 v[104:107], v[184:187], v[164:167], v[104:107]
    v_add_f32 v28, v26, v27
    v_mov_b32 v29, v28
    v_mfma_f32_16x16x32_bf16 v[104:107], v[208:211], v[168:171], v[104:107]
    v_mfma_f32_16x16x32_bf16 v[104:107], v[232:235], v[172:175], v[104:107]
    v_permlane16_swap_b32 v28, v29
    v_add_f32 v28, v28, v29
    s_waitcnt vmcnt(8)
    s_barrier
    v_mfma_f32_16x16x32_bf16 v[108:111], a[4:7], v[120:123], 0
    v_add_u32 v4, 65536, v4
    v_add_u32 v25, 65536, v25
    ds_read_b128 v[120:123], v4 offset:0
    s_add_u32 s57, s75, 262144
    v_mfma_f32_16x16x32_bf16 v[108:111], a[28:31], v[124:127], v[108:111]
    ds_read_b128 v[124:127], v25 offset:0
    buffer_load_dword v22, v20, s[12:15], s57 offen
    v_mfma_f32_16x16x32_bf16 v[108:111], a[52:55], v[128:131], v[108:111]
    ds_read_b128 v[128:131], v4 offset:2048
    v_mov_b32 v29, v28
    v_mfma_f32_16x16x32_bf16 v[108:111], a[76:79], v[132:135], v[108:111]
    ds_read_b128 v[132:135], v25 offset:2048
    v_mfma_f32_16x16x32_bf16 v[108:111], a[100:103], v[136:139], v[108:111]
    ds_read_b128 v[136:139], v4 offset:4096
    v_permlane32_swap_b32 v28, v29
    v_mfma_f32_16x16x32_bf16 v[108:111], a[124:127], v[140:143], v[108:111]
    ds_read_b128 v[140:143], v25 offset:4096
    v_add_f32 v28, v28, v29
    v_mfma_f32_16x16x32_bf16 v[108:111], a[148:151], v[144:147], v[108:111]
    ds_read_b128 v[144:147], v4 offset:6144
    v_cvt_pk_bf16_f32 v68, v104, v105
    v_mfma_f32_16x16x32_bf16 v[108:111], a[172:175], v[148:151], v[108:111]
    ds_read_b128 v[148:151], v25 offset:6144
    v_cvt_pk_bf16_f32 v69, v106, v107
    v_mfma_f32_16x16x32_bf16 v[108:111], a[196:199], v[152:155], v[108:111]
    ds_read_b128 v[152:155], v4 offset:8192
    v_rcp_f32 v28, v28
    v_mfma_f32_16x16x32_bf16 v[108:111], a[220:223], v[156:159], v[108:111]
    ds_read_b128 v[156:159], v25 offset:8192
    v_mul_f32 v26, v26, v28
    v_mfma_f32_16x16x32_bf16 v[108:111], a[244:247], v[160:163], v[108:111]
    ds_read_b128 v[160:163], v4 offset:10240
    v_mul_f32 v27, v27, v28
    v_mfma_f32_16x16x32_bf16 v[108:111], v[188:191], v[164:167], v[108:111]
    ds_read_b128 v[164:167], v25 offset:10240
    v_cvt_pk_bf16_f32 v26, v26, v26
    v_mfma_f32_16x16x32_bf16 v[108:111], v[212:215], v[168:171], v[108:111]
    ds_read_b128 v[168:171], v4 offset:12288
    v_cvt_pk_bf16_f32 v27, v27, v27
    v_mfma_f32_16x16x32_bf16 v[108:111], v[236:239], v[172:175], v[108:111]
    ds_read_b128 v[172:175], v25 offset:12288
    v_and_b32 v80, v26, v14
    s_waitcnt lgkmcnt(11)
    v_mfma_f32_16x16x32_bf16 v[112:115], a[8:11], v[120:123], 0
    v_and_b32 v81, v27, v15
    v_and_b32 v82, v26, v16
    v_mfma_f32_16x16x32_bf16 v[112:115], a[32:35], v[124:127], v[112:115]
    v_and_b32 v83, v27, v17
    v_mfma_f32_16x16x32_bf16 v[112:115], a[56:59], v[128:131], v[112:115]
    s_waitcnt lgkmcnt(8)
    v_mfma_f32_16x16x32_bf16 v[112:115], a[80:83], v[132:135], v[112:115]
    v_mfma_f32_16x16x32_bf16 v[72:75], v[34:37], v[80:83], 0
    v_mfma_f32_16x16x32_bf16 v[112:115], a[104:107], v[136:139], v[112:115]
    v_mfma_f32_16x16x32_bf16 v[76:79], v[44:47], v[80:83], 0
    v_mfma_f32_16x16x32_bf16 v[112:115], a[128:131], v[140:143], v[112:115]
    s_add_u32 s53, s74, 16384
    s_waitcnt lgkmcnt(5)
    v_mfma_f32_16x16x32_bf16 v[112:115], a[152:155], v[144:147], v[112:115]
    v_cvt_pk_bf16_f32 v70, v108, v109
    v_cvt_pk_bf16_f32 v71, v110, v111
    v_mfma_f32_16x16x32_bf16 v[112:115], a[176:179], v[148:151], v[112:115]
    v_cndmask_b32 v70, v70, 0, s[82:83]
    v_cndmask_b32 v71, v71, 0, s[82:83]
    v_mfma_f32_16x16x32_bf16 v[112:115], a[200:203], v[152:155], v[112:115]
    s_waitcnt lgkmcnt(2)
    v_mfma_f32_16x16x32_bf16 v[112:115], a[224:227], v[156:159], v[112:115]
    v_mfma_f32_16x16x32_bf16 v[112:115], a[248:251], v[160:163], v[112:115]
    v_cvt_pk_bf16_f32 v84, v72, v73
    v_cvt_pk_bf16_f32 v85, v74, v75
    v_mfma_f32_16x16x32_bf16 v[112:115], v[192:195], v[164:167], v[112:115]
    v_cvt_pk_bf16_f32 v86, v76, v77
    v_cvt_pk_bf16_f32 v87, v78, v79
    s_waitcnt lgkmcnt(0)
    v_mfma_f32_16x16x32_bf16 v[112:115], v[216:219], v[168:171], v[112:115]
    v_cndmask_b32 v86, v86, 0, s[82:83]
    v_cndmask_b32 v87, v87, 0, s[82:83]
    v_mfma_f32_16x16x32_bf16 v[112:115], v[240:243], v[172:175], v[112:115]
    buffer_store_dwordx4 v[84:87], v23, s[24:27], s53 offen sc1
    v_mfma_f32_16x16x32_bf16 v[116:119], a[12:15], v[120:123], 0
    v_mfma_f32_16x16x32_bf16 v[116:119], a[36:39], v[124:127], v[116:119]
    v_mfma_f32_16x16x32_bf16 v[72:75], v[60:63], v[68:71], 0
    v_mfma_f32_16x16x32_bf16 v[116:119], a[60:63], v[128:131], v[116:119]
    v_mfma_f32_16x16x32_bf16 v[76:79], v[52:55], v[68:71], 0
    v_mfma_f32_16x16x32_bf16 v[116:119], a[84:87], v[132:135], v[116:119]
    v_mfma_f32_16x16x32_bf16 v[116:119], a[108:111], v[136:139], v[116:119]
    v_mfma_f32_16x16x32_bf16 v[116:119], a[132:135], v[140:143], v[116:119]
    v_mfma_f32_16x16x32_bf16 v[116:119], a[156:159], v[144:147], v[116:119]
    v_cvt_pk_bf16_f32 v56, v112, v113
    v_cvt_pk_bf16_f32 v57, v114, v115
    v_mfma_f32_16x16x32_bf16 v[116:119], a[180:183], v[148:151], v[116:119]
    v_cndmask_b32 v26, v72, v73, s[76:77]
    v_cndmask_b32 v27, v74, v75, s[76:77]
    v_mfma_f32_16x16x32_bf16 v[116:119], a[204:207], v[152:155], v[116:119]
    v_cndmask_b32 v28, v76, v77, s[76:77]
    v_cndmask_b32 v29, v78, v79, s[76:77]
    v_mfma_f32_16x16x32_bf16 v[116:119], a[228:231], v[156:159], v[116:119]
    v_cndmask_b32 v26, v26, v28, s[78:79]
    v_cndmask_b32 v27, v27, v29, s[80:81]
    v_mfma_f32_16x16x32_bf16 v[116:119], a[252:255], v[160:163], v[116:119]
    v_max_f32 v28, v26, v27
    v_mov_b32 v29, v28
    v_mfma_f32_16x16x32_bf16 v[116:119], v[196:199], v[164:167], v[116:119]
    v_mfma_f32_16x16x32_bf16 v[116:119], v[220:223], v[168:171], v[116:119]
    v_permlane16_swap_b32 v28, v29
    v_max_f32 v28, v28, v29
    v_mfma_f32_16x16x32_bf16 v[116:119], v[244:247], v[172:175], v[116:119]
    v_mov_b32 v29, v28
    v_mfma_f32_16x16x32_bf16 v[96:99], v[120:123], a[16:19], 0
    v_mfma_f32_16x16x32_bf16 v[96:99], v[124:127], a[40:43], v[96:99]
    v_permlane32_swap_b32 v28, v29
    v_max_f32 v28, v28, v29
    v_mfma_f32_16x16x32_bf16 v[96:99], v[128:131], a[64:67], v[96:99]
    v_sub_f32 v26, v26, v28
    v_sub_f32 v27, v27, v28
    v_mfma_f32_16x16x32_bf16 v[96:99], v[132:135], a[88:91], v[96:99]
    v_mul_f32 v26, s91, v26
    v_mul_f32 v27, s91, v27
    v_mfma_f32_16x16x32_bf16 v[96:99], v[136:139], a[112:115], v[96:99]
    v_exp_f32 v26, v26
    v_mfma_f32_16x16x32_bf16 v[96:99], v[140:143], a[136:139], v[96:99]
    v_exp_f32 v27, v27
    v_mfma_f32_16x16x32_bf16 v[96:99], v[144:147], a[160:163], v[96:99]
    v_cvt_pk_bf16_f32 v58, v116, v117
    v_cvt_pk_bf16_f32 v59, v118, v119
    v_mfma_f32_16x16x32_bf16 v[96:99], v[148:151], a[184:187], v[96:99]
    v_cndmask_b32 v58, v58, 0, s[82:83]
    v_cndmask_b32 v59, v59, 0, s[82:83]
    v_mfma_f32_16x16x32_bf16 v[96:99], v[152:155], a[208:211], v[96:99]
    v_add_f32 v28, v26, v27
    v_mov_b32 v29, v28
    v_mfma_f32_16x16x32_bf16 v[96:99], v[156:159], a[232:235], v[96:99]
    v_mfma_f32_16x16x32_bf16 v[96:99], v[160:163], v[176:179], v[96:99]
    v_permlane16_swap_b32 v28, v29
    v_add_f32 v28, v28, v29
    v_mfma_f32_16x16x32_bf16 v[96:99], v[164:167], v[200:203], v[96:99]
    v_mov_b32 v29, v28
    v_mfma_f32_16x16x32_bf16 v[96:99], v[168:171], v[224:227], v[96:99]
    v_mfma_f32_16x16x32_bf16 v[96:99], v[172:175], v[248:251], v[96:99]
    v_permlane32_swap_b32 v28, v29
    v_add_f32 v28, v28, v29
    v_mfma_f32_16x16x32_bf16 v[100:103], v[120:123], a[20:23], 0
    v_rcp_f32 v28, v28
    v_mfma_f32_16x16x32_bf16 v[100:103], v[124:127], a[44:47], v[100:103]
    v_mul_f32 v26, v26, v28
    v_mul_f32 v27, v27, v28
    v_mfma_f32_16x16x32_bf16 v[100:103], v[128:131], a[68:71], v[100:103]
    v_cvt_pk_bf16_f32 v26, v26, v26
    v_cvt_pk_bf16_f32 v27, v27, v27
    v_mfma_f32_16x16x32_bf16 v[100:103], v[132:135], a[92:95], v[100:103]
    v_and_b32 v80, v26, v14
    v_and_b32 v81, v27, v15
    v_mfma_f32_16x16x32_bf16 v[100:103], v[136:139], a[116:119], v[100:103]
    v_and_b32 v82, v26, v16
    v_and_b32 v83, v27, v17
    v_mfma_f32_16x16x32_bf16 v[100:103], v[140:143], a[140:143], v[100:103]
    v_mfma_f32_16x16x32_bf16 v[100:103], v[144:147], a[164:167], v[100:103]
    v_cvt_pk_bf16_f32 v40, v96, v97
    v_cvt_pk_bf16_f32 v41, v98, v99
    v_mfma_f32_16x16x32_bf16 v[100:103], v[148:151], a[188:191], v[100:103]
    v_cvt_pk_bf16_f32 v32, v96, v97
    v_cvt_pk_bf16_f32 v33, v98, v99
    v_mfma_f32_16x16x32_bf16 v[100:103], v[152:155], a[212:215], v[100:103]
    v_mfma_f32_16x16x32_bf16 v[72:75], v[36:39], v[80:83], 0
    v_mfma_f32_16x16x32_bf16 v[100:103], v[156:159], a[236:239], v[100:103]
    v_mfma_f32_16x16x32_bf16 v[76:79], v[46:49], v[80:83], 0
    v_mfma_f32_16x16x32_bf16 v[100:103], v[160:163], v[180:183], v[100:103]
    s_add_u32 s53, s74, 32768
    v_mfma_f32_16x16x32_bf16 v[100:103], v[164:167], v[204:207], v[100:103]
    v_mfma_f32_16x16x32_bf16 v[100:103], v[168:171], v[228:231], v[100:103]
    v_mfma_f32_16x16x32_bf16 v[100:103], v[172:175], v[252:255], v[100:103]
    v_mfma_f32_16x16x32_bf16 v[104:107], a[0:3], v[120:123], 0
    v_mfma_f32_16x16x32_bf16 v[104:107], a[24:27], v[124:127], v[104:107]
    v_cvt_pk_bf16_f32 v84, v72, v73
    v_cvt_pk_bf16_f32 v85, v74, v75
    v_mfma_f32_16x16x32_bf16 v[104:107], a[48:51], v[128:131], v[104:107]
    v_cvt_pk_bf16_f32 v86, v76, v77
    v_cvt_pk_bf16_f32 v87, v78, v79
    v_mfma_f32_16x16x32_bf16 v[104:107], a[72:75], v[132:135], v[104:107]
    v_cndmask_b32 v86, v86, 0, s[82:83]
    v_cndmask_b32 v87, v87, 0, s[82:83]
    v_mfma_f32_16x16x32_bf16 v[104:107], a[96:99], v[136:139], v[104:107]
    buffer_store_dwordx4 v[84:87], v23, s[24:27], s53 offen sc1
    v_mfma_f32_16x16x32_bf16 v[104:107], a[120:123], v[140:143], v[104:107]
    v_mfma_f32_16x16x32_bf16 v[104:107], a[144:147], v[144:147], v[104:107]
    v_cvt_pk_bf16_f32 v50, v100, v101
    v_cvt_pk_bf16_f32 v51, v102, v103
    v_mfma_f32_16x16x32_bf16 v[104:107], a[168:171], v[148:151], v[104:107]
    v_cvt_pk_bf16_f32 v42, v100, v101
    v_cvt_pk_bf16_f32 v43, v102, v103
    v_mfma_f32_16x16x32_bf16 v[104:107], a[192:195], v[152:155], v[104:107]
    v_mfma_f32_16x16x32_bf16 v[104:107], a[216:219], v[156:159], v[104:107]
    v_mfma_f32_16x16x32_bf16 v[104:107], a[240:243], v[160:163], v[104:107]
    v_mfma_f32_16x16x32_bf16 v[104:107], v[184:187], v[164:167], v[104:107]
    v_mfma_f32_16x16x32_bf16 v[104:107], v[208:211], v[168:171], v[104:107]
    v_mfma_f32_16x16x32_bf16 v[104:107], v[232:235], v[172:175], v[104:107]
    v_mfma_f32_16x16x32_bf16 v[108:111], a[4:7], v[120:123], 0
    ds_read_b128 v[120:123], v4 offset:16384
    v_mfma_f32_16x16x32_bf16 v[108:111], a[28:31], v[124:127], v[108:111]
    ds_read_b128 v[124:127], v25 offset:16384
    v_mfma_f32_16x16x32_bf16 v[108:111], a[52:55], v[128:131], v[108:111]
    ds_read_b128 v[128:131], v4 offset:18432
    v_mfma_f32_16x16x32_bf16 v[108:111], a[76:79], v[132:135], v[108:111]
    ds_read_b128 v[132:135], v25 offset:18432
    v_mfma_f32_16x16x32_bf16 v[108:111], a[100:103], v[136:139], v[108:111]
    ds_read_b128 v[136:139], v4 offset:20480
    v_mfma_f32_16x16x32_bf16 v[108:111], a[124:127], v[140:143], v[108:111]
    ds_read_b128 v[140:143], v25 offset:20480
    v_mfma_f32_16x16x32_bf16 v[108:111], a[148:151], v[144:147], v[108:111]
    ds_read_b128 v[144:147], v4 offset:22528
    v_cvt_pk_bf16_f32 v64, v104, v105
    v_mfma_f32_16x16x32_bf16 v[108:111], a[172:175], v[148:151], v[108:111]
    ds_read_b128 v[148:151], v25 offset:22528
    v_cvt_pk_bf16_f32 v65, v106, v107
    v_mfma_f32_16x16x32_bf16 v[108:111], a[196:199], v[152:155], v[108:111]
    ds_read_b128 v[152:155], v4 offset:24576
    v_mfma_f32_16x16x32_bf16 v[108:111], a[220:223], v[156:159], v[108:111]
    ds_read_b128 v[156:159], v25 offset:24576
    v_mfma_f32_16x16x32_bf16 v[108:111], a[244:247], v[160:163], v[108:111]
    ds_read_b128 v[160:163], v4 offset:26624
    v_mfma_f32_16x16x32_bf16 v[108:111], v[188:191], v[164:167], v[108:111]
    ds_read_b128 v[164:167], v25 offset:26624
    v_mfma_f32_16x16x32_bf16 v[108:111], v[212:215], v[168:171], v[108:111]
    ds_read_b128 v[168:171], v4 offset:28672
    v_mfma_f32_16x16x32_bf16 v[108:111], v[236:239], v[172:175], v[108:111]
    ds_read_b128 v[172:175], v25 offset:28672
    s_waitcnt lgkmcnt(11)
    v_mfma_f32_16x16x32_bf16 v[112:115], a[8:11], v[120:123], 0
    v_mfma_f32_16x16x32_bf16 v[112:115], a[32:35], v[124:127], v[112:115]
    v_mfma_f32_16x16x32_bf16 v[112:115], a[56:59], v[128:131], v[112:115]
    s_waitcnt lgkmcnt(8)
    v_mfma_f32_16x16x32_bf16 v[112:115], a[80:83], v[132:135], v[112:115]
    v_mfma_f32_16x16x32_bf16 v[112:115], a[104:107], v[136:139], v[112:115]
    v_mfma_f32_16x16x32_bf16 v[112:115], a[128:131], v[140:143], v[112:115]
    s_waitcnt lgkmcnt(5)
    v_mfma_f32_16x16x32_bf16 v[112:115], a[152:155], v[144:147], v[112:115]
    v_cvt_pk_bf16_f32 v66, v108, v109
    v_cvt_pk_bf16_f32 v67, v110, v111
    v_mfma_f32_16x16x32_bf16 v[112:115], a[176:179], v[148:151], v[112:115]
    v_cndmask_b32 v66, v66, 0, s[82:83]
    v_cndmask_b32 v67, v67, 0, s[82:83]
    v_mfma_f32_16x16x32_bf16 v[112:115], a[200:203], v[152:155], v[112:115]
    s_waitcnt lgkmcnt(2)
    v_mfma_f32_16x16x32_bf16 v[112:115], a[224:227], v[156:159], v[112:115]
    v_mfma_f32_16x16x32_bf16 v[72:75], v[52:55], v[64:67], 0
    v_mfma_f32_16x16x32_bf16 v[112:115], a[248:251], v[160:163], v[112:115]
    v_mfma_f32_16x16x32_bf16 v[76:79], v[56:59], v[64:67], 0
    v_mfma_f32_16x16x32_bf16 v[112:115], v[192:195], v[164:167], v[112:115]
    s_waitcnt lgkmcnt(0)
    v_mfma_f32_16x16x32_bf16 v[112:115], v[216:219], v[168:171], v[112:115]
    v_mfma_f32_16x16x32_bf16 v[112:115], v[240:243], v[172:175], v[112:115]
    v_mfma_f32_16x16x32_bf16 v[116:119], a[12:15], v[120:123], 0
    v_mfma_f32_16x16x32_bf16 v[116:119], a[36:39], v[124:127], v[116:119]
    v_cndmask_b32 v26, v72, v73, s[76:77]
    v_cndmask_b32 v27, v74, v75, s[76:77]
    v_mfma_f32_16x16x32_bf16 v[116:119], a[60:63], v[128:131], v[116:119]
    v_cndmask_b32 v28, v76, v77, s[76:77]
    v_cndmask_b32 v29, v78, v79, s[76:77]
    v_mfma_f32_16x16x32_bf16 v[116:119], a[84:87], v[132:135], v[116:119]
    v_cndmask_b32 v26, v26, v28, s[78:79]
    v_cndmask_b32 v27, v27, v29, s[80:81]
    v_mfma_f32_16x16x32_bf16 v[116:119], a[108:111], v[136:139], v[116:119]
    v_max_f32 v28, v26, v27
    v_mov_b32 v29, v28
    v_mfma_f32_16x16x32_bf16 v[116:119], a[132:135], v[140:143], v[116:119]
    v_mfma_f32_16x16x32_bf16 v[116:119], a[156:159], v[144:147], v[116:119]
    v_cvt_pk_bf16_f32 v60, v112, v113
    v_cvt_pk_bf16_f32 v61, v114, v115
    v_mfma_f32_16x16x32_bf16 v[116:119], a[180:183], v[148:151], v[116:119]
    v_permlane16_swap_b32 v28, v29
    v_max_f32 v28, v28, v29
    v_mfma_f32_16x16x32_bf16 v[116:119], a[204:207], v[152:155], v[116:119]
    v_mov_b32 v29, v28
    v_mfma_f32_16x16x32_bf16 v[116:119], a[228:231], v[156:159], v[116:119]
    v_mfma_f32_16x16x32_bf16 v[116:119], a[252:255], v[160:163], v[116:119]
    v_permlane32_swap_b32 v28, v29
    v_max_f32 v28, v28, v29
    v_mfma_f32_16x16x32_bf16 v[116:119], v[196:199], v[164:167], v[116:119]
    v_sub_f32 v26, v26, v28
    v_sub_f32 v27, v27, v28
    v_mfma_f32_16x16x32_bf16 v[116:119], v[220:223], v[168:171], v[116:119]
    v_mul_f32 v26, s91, v26
    v_mul_f32 v27, s91, v27
    v_mfma_f32_16x16x32_bf16 v[116:119], v[244:247], v[172:175], v[116:119]
    v_exp_f32 v26, v26
    v_mfma_f32_16x16x32_bf16 v[96:99], v[120:123], a[16:19], 0
    v_exp_f32 v27, v27
    v_mfma_f32_16x16x32_bf16 v[96:99], v[124:127], a[40:43], v[96:99]
    v_add_f32 v28, v26, v27
    v_mov_b32 v29, v28
    v_mfma_f32_16x16x32_bf16 v[96:99], v[128:131], a[64:67], v[96:99]
    v_mfma_f32_16x16x32_bf16 v[96:99], v[132:135], a[88:91], v[96:99]
    v_permlane16_swap_b32 v28, v29
    v_add_f32 v28, v28, v29
    v_mfma_f32_16x16x32_bf16 v[96:99], v[136:139], a[112:115], v[96:99]
    v_mov_b32 v29, v28
    v_mfma_f32_16x16x32_bf16 v[96:99], v[140:143], a[136:139], v[96:99]
    v_mfma_f32_16x16x32_bf16 v[96:99], v[144:147], a[160:163], v[96:99]
    v_cvt_pk_bf16_f32 v62, v116, v117
    v_cvt_pk_bf16_f32 v63, v118, v119
    v_mfma_f32_16x16x32_bf16 v[96:99], v[148:151], a[184:187], v[96:99]
    v_cndmask_b32 v62, v62, 0, s[82:83]
    v_cndmask_b32 v63, v63, 0, s[82:83]
    v_mfma_f32_16x16x32_bf16 v[96:99], v[152:155], a[208:211], v[96:99]
    v_permlane32_swap_b32 v28, v29
    v_add_f32 v28, v28, v29
    v_mfma_f32_16x16x32_bf16 v[96:99], v[156:159], a[232:235], v[96:99]
    v_rcp_f32 v28, v28
    v_mfma_f32_16x16x32_bf16 v[96:99], v[160:163], v[176:179], v[96:99]
    v_mul_f32 v26, v26, v28
    v_mul_f32 v27, v27, v28
    v_mfma_f32_16x16x32_bf16 v[96:99], v[164:167], v[200:203], v[96:99]
    v_cvt_pk_bf16_f32 v26, v26, v26
    v_cvt_pk_bf16_f32 v27, v27, v27
    v_mfma_f32_16x16x32_bf16 v[96:99], v[168:171], v[224:227], v[96:99]
    v_and_b32 v80, v26, v14
    v_and_b32 v81, v27, v15
    v_mfma_f32_16x16x32_bf16 v[96:99], v[172:175], v[248:251], v[96:99]
    v_and_b32 v82, v26, v16
    v_and_b32 v83, v27, v17
    v_mfma_f32_16x16x32_bf16 v[100:103], v[120:123], a[20:23], 0
    v_mfma_f32_16x16x32_bf16 v[100:103], v[124:127], a[44:47], v[100:103]
    v_mfma_f32_16x16x32_bf16 v[72:75], v[38:41], v[80:83], 0
    v_mfma_f32_16x16x32_bf16 v[100:103], v[128:131], a[68:71], v[100:103]
    v_mfma_f32_16x16x32_bf16 v[76:79], v[48:51], v[80:83], 0
    v_mfma_f32_16x16x32_bf16 v[100:103], v[132:135], a[92:95], v[100:103]
    s_add_u32 s53, s74, 49152
    v_mfma_f32_16x16x32_bf16 v[100:103], v[136:139], a[116:119], v[100:103]
    v_mfma_f32_16x16x32_bf16 v[100:103], v[140:143], a[140:143], v[100:103]
    v_mfma_f32_16x16x32_bf16 v[100:103], v[144:147], a[164:167], v[100:103]
    v_cvt_pk_bf16_f32 v34, v96, v97
    v_cvt_pk_bf16_f32 v35, v98, v99
    v_mfma_f32_16x16x32_bf16 v[100:103], v[148:151], a[188:191], v[100:103]
    v_mfma_f32_16x16x32_bf16 v[100:103], v[152:155], a[212:215], v[100:103]
    v_cvt_pk_bf16_f32 v84, v72, v73
    v_cvt_pk_bf16_f32 v85, v74, v75
    v_mfma_f32_16x16x32_bf16 v[100:103], v[156:159], a[236:239], v[100:103]
    v_cvt_pk_bf16_f32 v86, v76, v77
    v_cvt_pk_bf16_f32 v87, v78, v79
    v_mfma_f32_16x16x32_bf16 v[100:103], v[160:163], v[180:183], v[100:103]
    v_cndmask_b32 v86, v86, 0, s[82:83]
    v_cndmask_b32 v87, v87, 0, s[82:83]
    v_mfma_f32_16x16x32_bf16 v[100:103], v[164:167], v[204:207], v[100:103]
    buffer_store_dwordx4 v[84:87], v23, s[24:27], s53 offen sc1
    v_mfma_f32_16x16x32_bf16 v[100:103], v[168:171], v[228:231], v[100:103]
    v_mfma_f32_16x16x32_bf16 v[100:103], v[172:175], v[252:255], v[100:103]
    v_mfma_f32_16x16x32_bf16 v[104:107], a[0:3], v[120:123], 0
    v_mfma_f32_16x16x32_bf16 v[104:107], a[24:27], v[124:127], v[104:107]
    v_mfma_f32_16x16x32_bf16 v[104:107], a[48:51], v[128:131], v[104:107]
    v_mfma_f32_16x16x32_bf16 v[104:107], a[72:75], v[132:135], v[104:107]
    v_mfma_f32_16x16x32_bf16 v[104:107], a[96:99], v[136:139], v[104:107]
    v_mfma_f32_16x16x32_bf16 v[104:107], a[120:123], v[140:143], v[104:107]
    v_mfma_f32_16x16x32_bf16 v[104:107], a[144:147], v[144:147], v[104:107]
    s_nop 0
    v_cvt_pk_bf16_f32 v44, v100, v101
    v_cvt_pk_bf16_f32 v45, v102, v103
    v_mfma_f32_16x16x32_bf16 v[104:107], a[168:171], v[148:151], v[104:107]
    v_mfma_f32_16x16x32_bf16 v[104:107], a[192:195], v[152:155], v[104:107]
    v_mfma_f32_16x16x32_bf16 v[104:107], a[216:219], v[156:159], v[104:107]
    v_mfma_f32_16x16x32_bf16 v[104:107], a[240:243], v[160:163], v[104:107]
    v_mfma_f32_16x16x32_bf16 v[104:107], v[184:187], v[164:167], v[104:107]
    v_mfma_f32_16x16x32_bf16 v[104:107], v[208:211], v[168:171], v[104:107]
    v_mfma_f32_16x16x32_bf16 v[104:107], v[232:235], v[172:175], v[104:107]
    v_mfma_f32_16x16x32_bf16 v[108:111], a[4:7], v[120:123], 0
    ds_read_b128 v[120:123], v4 offset:32768
    v_mfma_f32_16x16x32_bf16 v[108:111], a[28:31], v[124:127], v[108:111]
    ds_read_b128 v[124:127], v25 offset:32768
    v_mfma_f32_16x16x32_bf16 v[108:111], a[52:55], v[128:131], v[108:111]
    ds_read_b128 v[128:131], v4 offset:34816
    v_mfma_f32_16x16x32_bf16 v[108:111], a[76:79], v[132:135], v[108:111]
    ds_read_b128 v[132:135], v25 offset:34816
    v_mfma_f32_16x16x32_bf16 v[108:111], a[100:103], v[136:139], v[108:111]
    ds_read_b128 v[136:139], v4 offset:36864
    v_mfma_f32_16x16x32_bf16 v[108:111], a[124:127], v[140:143], v[108:111]
    ds_read_b128 v[140:143], v25 offset:36864
    v_mfma_f32_16x16x32_bf16 v[108:111], a[148:151], v[144:147], v[108:111]
    ds_read_b128 v[144:147], v4 offset:38912
    v_cvt_pk_bf16_f32 v68, v104, v105
    v_mfma_f32_16x16x32_bf16 v[108:111], a[172:175], v[148:151], v[108:111]
    ds_read_b128 v[148:151], v25 offset:38912
    v_cvt_pk_bf16_f32 v69, v106, v107
    v_mfma_f32_16x16x32_bf16 v[108:111], a[196:199], v[152:155], v[108:111]
    ds_read_b128 v[152:155], v4 offset:40960
    v_mfma_f32_16x16x32_bf16 v[108:111], a[220:223], v[156:159], v[108:111]
    ds_read_b128 v[156:159], v25 offset:40960
    v_mfma_f32_16x16x32_bf16 v[108:111], a[244:247], v[160:163], v[108:111]
    ds_read_b128 v[160:163], v4 offset:43008
    v_mfma_f32_16x16x32_bf16 v[108:111], v[188:191], v[164:167], v[108:111]
    ds_read_b128 v[164:167], v25 offset:43008
    v_mfma_f32_16x16x32_bf16 v[108:111], v[212:215], v[168:171], v[108:111]
    ds_read_b128 v[168:171], v4 offset:45056
    v_mfma_f32_16x16x32_bf16 v[108:111], v[236:239], v[172:175], v[108:111]
    ds_read_b128 v[172:175], v25 offset:45056
    s_waitcnt lgkmcnt(11)
    v_mfma_f32_16x16x32_bf16 v[112:115], a[8:11], v[120:123], 0
    v_mfma_f32_16x16x32_bf16 v[112:115], a[32:35], v[124:127], v[112:115]
    v_mfma_f32_16x16x32_bf16 v[112:115], a[56:59], v[128:131], v[112:115]
    s_waitcnt lgkmcnt(8)
    v_mfma_f32_16x16x32_bf16 v[112:115], a[80:83], v[132:135], v[112:115]
    v_mfma_f32_16x16x32_bf16 v[112:115], a[104:107], v[136:139], v[112:115]
    v_mfma_f32_16x16x32_bf16 v[112:115], a[128:131], v[140:143], v[112:115]
    s_waitcnt lgkmcnt(5)
    v_mfma_f32_16x16x32_bf16 v[112:115], a[152:155], v[144:147], v[112:115]
    v_cvt_pk_bf16_f32 v70, v108, v109
    v_cvt_pk_bf16_f32 v71, v110, v111
    v_mfma_f32_16x16x32_bf16 v[112:115], a[176:179], v[148:151], v[112:115]
    v_cndmask_b32 v70, v70, 0, s[82:83]
    v_cndmask_b32 v71, v71, 0, s[82:83]
    v_mfma_f32_16x16x32_bf16 v[112:115], a[200:203], v[152:155], v[112:115]
    s_waitcnt lgkmcnt(2)
    v_mfma_f32_16x16x32_bf16 v[112:115], a[224:227], v[156:159], v[112:115]
    v_mfma_f32_16x16x32_bf16 v[72:75], v[56:59], v[68:71], 0
    v_mfma_f32_16x16x32_bf16 v[112:115], a[248:251], v[160:163], v[112:115]
    v_mfma_f32_16x16x32_bf16 v[76:79], v[60:63], v[68:71], 0
    v_mfma_f32_16x16x32_bf16 v[112:115], v[192:195], v[164:167], v[112:115]
    s_waitcnt lgkmcnt(0)
    v_mfma_f32_16x16x32_bf16 v[112:115], v[216:219], v[168:171], v[112:115]
    v_mfma_f32_16x16x32_bf16 v[112:115], v[240:243], v[172:175], v[112:115]
    v_mfma_f32_16x16x32_bf16 v[116:119], a[12:15], v[120:123], 0
    v_mfma_f32_16x16x32_bf16 v[116:119], a[36:39], v[124:127], v[116:119]
    v_cndmask_b32 v26, v72, v73, s[76:77]
    v_cndmask_b32 v27, v74, v75, s[76:77]
    v_mfma_f32_16x16x32_bf16 v[116:119], a[60:63], v[128:131], v[116:119]
    v_cndmask_b32 v28, v76, v77, s[76:77]
    v_cndmask_b32 v29, v78, v79, s[76:77]
    v_mfma_f32_16x16x32_bf16 v[116:119], a[84:87], v[132:135], v[116:119]
    v_cndmask_b32 v26, v26, v28, s[78:79]
    v_cndmask_b32 v27, v27, v29, s[80:81]
    v_mfma_f32_16x16x32_bf16 v[116:119], a[108:111], v[136:139], v[116:119]
    v_max_f32 v28, v26, v27
    v_mov_b32 v29, v28
    v_mfma_f32_16x16x32_bf16 v[116:119], a[132:135], v[140:143], v[116:119]
    v_mfma_f32_16x16x32_bf16 v[116:119], a[156:159], v[144:147], v[116:119]
    v_cvt_pk_bf16_f32 v52, v112, v113
    v_cvt_pk_bf16_f32 v53, v114, v115
    v_mfma_f32_16x16x32_bf16 v[116:119], a[180:183], v[148:151], v[116:119]
    v_permlane16_swap_b32 v28, v29
    v_max_f32 v28, v28, v29
    v_mfma_f32_16x16x32_bf16 v[116:119], a[204:207], v[152:155], v[116:119]
    v_mov_b32 v29, v28
    v_mfma_f32_16x16x32_bf16 v[116:119], a[228:231], v[156:159], v[116:119]
    v_mfma_f32_16x16x32_bf16 v[116:119], a[252:255], v[160:163], v[116:119]
    v_permlane32_swap_b32 v28, v29
    v_max_f32 v28, v28, v29
    v_mfma_f32_16x16x32_bf16 v[116:119], v[196:199], v[164:167], v[116:119]
    v_sub_f32 v26, v26, v28
    v_sub_f32 v27, v27, v28
    v_mfma_f32_16x16x32_bf16 v[116:119], v[220:223], v[168:171], v[116:119]
    v_mul_f32 v26, s91, v26
    v_mul_f32 v27, s91, v27
    v_mfma_f32_16x16x32_bf16 v[116:119], v[244:247], v[172:175], v[116:119]
    v_exp_f32 v26, v26
    v_mfma_f32_16x16x32_bf16 v[96:99], v[120:123], a[16:19], 0
    v_exp_f32 v27, v27
    v_mfma_f32_16x16x32_bf16 v[96:99], v[124:127], a[40:43], v[96:99]
    v_add_f32 v28, v26, v27
    v_mov_b32 v29, v28
    v_mfma_f32_16x16x32_bf16 v[96:99], v[128:131], a[64:67], v[96:99]
    v_mfma_f32_16x16x32_bf16 v[96:99], v[132:135], a[88:91], v[96:99]
    v_permlane16_swap_b32 v28, v29
    v_add_f32 v28, v28, v29
    v_mfma_f32_16x16x32_bf16 v[96:99], v[136:139], a[112:115], v[96:99]
    v_mov_b32 v29, v28
    v_mfma_f32_16x16x32_bf16 v[96:99], v[140:143], a[136:139], v[96:99]
    v_mfma_f32_16x16x32_bf16 v[96:99], v[144:147], a[160:163], v[96:99]
    v_cvt_pk_bf16_f32 v54, v116, v117
    v_cvt_pk_bf16_f32 v55, v118, v119
    v_mfma_f32_16x16x32_bf16 v[96:99], v[148:151], a[184:187], v[96:99]
    v_cndmask_b32 v54, v54, 0, s[82:83]
    v_cndmask_b32 v55, v55, 0, s[82:83]
    v_mfma_f32_16x16x32_bf16 v[96:99], v[152:155], a[208:211], v[96:99]
    v_permlane32_swap_b32 v28, v29
    v_add_f32 v28, v28, v29
    v_mfma_f32_16x16x32_bf16 v[96:99], v[156:159], a[232:235], v[96:99]
    v_rcp_f32 v28, v28
    v_mfma_f32_16x16x32_bf16 v[96:99], v[160:163], v[176:179], v[96:99]
    v_mul_f32 v26, v26, v28
    v_mul_f32 v27, v27, v28
    v_mfma_f32_16x16x32_bf16 v[96:99], v[164:167], v[200:203], v[96:99]
    v_cvt_pk_bf16_f32 v26, v26, v26
    v_cvt_pk_bf16_f32 v27, v27, v27
    v_mfma_f32_16x16x32_bf16 v[96:99], v[168:171], v[224:227], v[96:99]
    v_and_b32 v80, v26, v14
    v_and_b32 v81, v27, v15
    v_mfma_f32_16x16x32_bf16 v[96:99], v[172:175], v[248:251], v[96:99]
    v_and_b32 v82, v26, v16
    v_and_b32 v83, v27, v17
    v_mfma_f32_16x16x32_bf16 v[100:103], v[120:123], a[20:23], 0
    v_mfma_f32_16x16x32_bf16 v[100:103], v[124:127], a[44:47], v[100:103]
    v_mfma_f32_16x16x32_bf16 v[72:75], v[32:35], v[80:83], 0
    v_mfma_f32_16x16x32_bf16 v[100:103], v[128:131], a[68:71], v[100:103]
    v_mfma_f32_16x16x32_bf16 v[76:79], v[42:45], v[80:83], 0
    v_mfma_f32_16x16x32_bf16 v[100:103], v[132:135], a[92:95], v[100:103]
    s_add_u32 s53, s74, 65536
    v_mfma_f32_16x16x32_bf16 v[100:103], v[136:139], a[116:119], v[100:103]
    v_mfma_f32_16x16x32_bf16 v[100:103], v[140:143], a[140:143], v[100:103]
    v_mfma_f32_16x16x32_bf16 v[100:103], v[144:147], a[164:167], v[100:103]
    v_cvt_pk_bf16_f32 v36, v96, v97
    v_cvt_pk_bf16_f32 v37, v98, v99
    v_mfma_f32_16x16x32_bf16 v[100:103], v[148:151], a[188:191], v[100:103]
    v_mfma_f32_16x16x32_bf16 v[100:103], v[152:155], a[212:215], v[100:103]
    v_cvt_pk_bf16_f32 v84, v72, v73
    v_cvt_pk_bf16_f32 v85, v74, v75
    v_mfma_f32_16x16x32_bf16 v[100:103], v[156:159], a[236:239], v[100:103]
    v_cvt_pk_bf16_f32 v86, v76, v77
    v_cvt_pk_bf16_f32 v87, v78, v79
    v_mfma_f32_16x16x32_bf16 v[100:103], v[160:163], v[180:183], v[100:103]
    v_cndmask_b32 v86, v86, 0, s[82:83]
    v_cndmask_b32 v87, v87, 0, s[82:83]
    v_mfma_f32_16x16x32_bf16 v[100:103], v[164:167], v[204:207], v[100:103]
    buffer_store_dwordx4 v[84:87], v23, s[24:27], s53 offen sc1
    v_mfma_f32_16x16x32_bf16 v[100:103], v[168:171], v[228:231], v[100:103]
    v_mfma_f32_16x16x32_bf16 v[100:103], v[172:175], v[252:255], v[100:103]
    v_mfma_f32_16x16x32_bf16 v[104:107], a[0:3], v[120:123], 0
    v_mfma_f32_16x16x32_bf16 v[104:107], a[24:27], v[124:127], v[104:107]
    v_mfma_f32_16x16x32_bf16 v[104:107], a[48:51], v[128:131], v[104:107]
    v_mfma_f32_16x16x32_bf16 v[104:107], a[72:75], v[132:135], v[104:107]
    v_mfma_f32_16x16x32_bf16 v[104:107], a[96:99], v[136:139], v[104:107]
    v_mfma_f32_16x16x32_bf16 v[104:107], a[120:123], v[140:143], v[104:107]
    v_mfma_f32_16x16x32_bf16 v[104:107], a[144:147], v[144:147], v[104:107]
    s_nop 0
    v_cvt_pk_bf16_f32 v46, v100, v101
    v_cvt_pk_bf16_f32 v47, v102, v103
    v_mfma_f32_16x16x32_bf16 v[104:107], a[168:171], v[148:151], v[104:107]
    v_mfma_f32_16x16x32_bf16 v[104:107], a[192:195], v[152:155], v[104:107]
    v_mfma_f32_16x16x32_bf16 v[104:107], a[216:219], v[156:159], v[104:107]
    v_mfma_f32_16x16x32_bf16 v[104:107], a[240:243], v[160:163], v[104:107]
    v_mfma_f32_16x16x32_bf16 v[104:107], v[184:187], v[164:167], v[104:107]
    v_mfma_f32_16x16x32_bf16 v[104:107], v[208:211], v[168:171], v[104:107]
    v_mfma_f32_16x16x32_bf16 v[104:107], v[232:235], v[172:175], v[104:107]
    v_mfma_f32_16x16x32_bf16 v[108:111], a[4:7], v[120:123], 0
    ds_read_b128 v[120:123], v4 offset:49152
    v_mfma_f32_16x16x32_bf16 v[108:111], a[28:31], v[124:127], v[108:111]
    ds_read_b128 v[124:127], v25 offset:49152
    v_mfma_f32_16x16x32_bf16 v[108:111], a[52:55], v[128:131], v[108:111]
    ds_read_b128 v[128:131], v4 offset:51200
    v_mfma_f32_16x16x32_bf16 v[108:111], a[76:79], v[132:135], v[108:111]
    ds_read_b128 v[132:135], v25 offset:51200
    v_mfma_f32_16x16x32_bf16 v[108:111], a[100:103], v[136:139], v[108:111]
    ds_read_b128 v[136:139], v4 offset:53248
    v_mfma_f32_16x16x32_bf16 v[108:111], a[124:127], v[140:143], v[108:111]
    ds_read_b128 v[140:143], v25 offset:53248
    v_mfma_f32_16x16x32_bf16 v[108:111], a[148:151], v[144:147], v[108:111]
    ds_read_b128 v[144:147], v4 offset:55296
    v_cvt_pk_bf16_f32 v64, v104, v105
    v_mfma_f32_16x16x32_bf16 v[108:111], a[172:175], v[148:151], v[108:111]
    ds_read_b128 v[148:151], v25 offset:55296
    v_cvt_pk_bf16_f32 v65, v106, v107
    v_mfma_f32_16x16x32_bf16 v[108:111], a[196:199], v[152:155], v[108:111]
    ds_read_b128 v[152:155], v4 offset:57344
    v_mfma_f32_16x16x32_bf16 v[108:111], a[220:223], v[156:159], v[108:111]
    ds_read_b128 v[156:159], v25 offset:57344
    v_mfma_f32_16x16x32_bf16 v[108:111], a[244:247], v[160:163], v[108:111]
    ds_read_b128 v[160:163], v4 offset:59392
    v_mfma_f32_16x16x32_bf16 v[108:111], v[188:191], v[164:167], v[108:111]
    ds_read_b128 v[164:167], v25 offset:59392
    v_mfma_f32_16x16x32_bf16 v[108:111], v[212:215], v[168:171], v[108:111]
    ds_read_b128 v[168:171], v4 offset:61440
    v_mfma_f32_16x16x32_bf16 v[108:111], v[236:239], v[172:175], v[108:111]
    ds_read_b128 v[172:175], v25 offset:61440
    s_waitcnt lgkmcnt(11)
    v_mfma_f32_16x16x32_bf16 v[112:115], a[8:11], v[120:123], 0
    v_mfma_f32_16x16x32_bf16 v[112:115], a[32:35], v[124:127], v[112:115]
    v_mfma_f32_16x16x32_bf16 v[112:115], a[56:59], v[128:131], v[112:115]
    s_waitcnt lgkmcnt(8)
    v_mfma_f32_16x16x32_bf16 v[112:115], a[80:83], v[132:135], v[112:115]
    v_mfma_f32_16x16x32_bf16 v[112:115], a[104:107], v[136:139], v[112:115]
    v_mfma_f32_16x16x32_bf16 v[112:115], a[128:131], v[140:143], v[112:115]
    s_waitcnt lgkmcnt(5)
    v_mfma_f32_16x16x32_bf16 v[112:115], a[152:155], v[144:147], v[112:115]
    v_cvt_pk_bf16_f32 v66, v108, v109
    v_cvt_pk_bf16_f32 v67, v110, v111
    v_mfma_f32_16x16x32_bf16 v[112:115], a[176:179], v[148:151], v[112:115]
    v_cndmask_b32 v66, v66, 0, s[82:83]
    v_cndmask_b32 v67, v67, 0, s[82:83]
    v_mfma_f32_16x16x32_bf16 v[112:115], a[200:203], v[152:155], v[112:115]
    s_waitcnt lgkmcnt(2)
    v_mfma_f32_16x16x32_bf16 v[112:115], a[224:227], v[156:159], v[112:115]
    v_mfma_f32_16x16x32_bf16 v[72:75], v[60:63], v[64:67], 0
    v_mfma_f32_16x16x32_bf16 v[112:115], a[248:251], v[160:163], v[112:115]
    v_mfma_f32_16x16x32_bf16 v[76:79], v[52:55], v[64:67], 0
    v_mfma_f32_16x16x32_bf16 v[112:115], v[192:195], v[164:167], v[112:115]
    s_waitcnt lgkmcnt(0)
    v_mfma_f32_16x16x32_bf16 v[112:115], v[216:219], v[168:171], v[112:115]
    v_mfma_f32_16x16x32_bf16 v[112:115], v[240:243], v[172:175], v[112:115]
    v_mfma_f32_16x16x32_bf16 v[116:119], a[12:15], v[120:123], 0
    v_mfma_f32_16x16x32_bf16 v[116:119], a[36:39], v[124:127], v[116:119]
    v_cndmask_b32 v26, v72, v73, s[76:77]
    v_cndmask_b32 v27, v74, v75, s[76:77]
    v_mfma_f32_16x16x32_bf16 v[116:119], a[60:63], v[128:131], v[116:119]
    v_cndmask_b32 v28, v76, v77, s[76:77]
    v_cndmask_b32 v29, v78, v79, s[76:77]
    v_mfma_f32_16x16x32_bf16 v[116:119], a[84:87], v[132:135], v[116:119]
    v_cndmask_b32 v26, v26, v28, s[78:79]
    v_cndmask_b32 v27, v27, v29, s[80:81]
    v_mfma_f32_16x16x32_bf16 v[116:119], a[108:111], v[136:139], v[116:119]
    v_max_f32 v28, v26, v27
    v_mov_b32 v29, v28
    v_mfma_f32_16x16x32_bf16 v[116:119], a[132:135], v[140:143], v[116:119]
    v_mfma_f32_16x16x32_bf16 v[116:119], a[156:159], v[144:147], v[116:119]
    v_cvt_pk_bf16_f32 v56, v112, v113
    v_cvt_pk_bf16_f32 v57, v114, v115
    v_mfma_f32_16x16x32_bf16 v[116:119], a[180:183], v[148:151], v[116:119]
    v_permlane16_swap_b32 v28, v29
    v_max_f32 v28, v28, v29
    v_mfma_f32_16x16x32_bf16 v[116:119], a[204:207], v[152:155], v[116:119]
    v_mov_b32 v29, v28
    v_mfma_f32_16x16x32_bf16 v[116:119], a[228:231], v[156:159], v[116:119]
    v_mfma_f32_16x16x32_bf16 v[116:119], a[252:255], v[160:163], v[116:119]
    v_permlane32_swap_b32 v28, v29
    v_max_f32 v28, v28, v29
    v_mfma_f32_16x16x32_bf16 v[116:119], v[196:199], v[164:167], v[116:119]
    v_sub_f32 v26, v26, v28
    v_sub_f32 v27, v27, v28
    v_mfma_f32_16x16x32_bf16 v[116:119], v[220:223], v[168:171], v[116:119]
    v_mul_f32 v26, s91, v26
    v_mul_f32 v27, s91, v27
    v_mfma_f32_16x16x32_bf16 v[116:119], v[244:247], v[172:175], v[116:119]
    v_exp_f32 v26, v26
    v_mfma_f32_16x16x32_bf16 v[96:99], v[120:123], a[16:19], 0
    v_exp_f32 v27, v27
    v_mfma_f32_16x16x32_bf16 v[96:99], v[124:127], a[40:43], v[96:99]
    v_add_f32 v28, v26, v27
    v_mov_b32 v29, v28
    v_mfma_f32_16x16x32_bf16 v[96:99], v[128:131], a[64:67], v[96:99]
    v_mfma_f32_16x16x32_bf16 v[96:99], v[132:135], a[88:91], v[96:99]
    v_permlane16_swap_b32 v28, v29
    v_add_f32 v28, v28, v29
    v_mfma_f32_16x16x32_bf16 v[96:99], v[136:139], a[112:115], v[96:99]
    v_mov_b32 v29, v28
    v_mfma_f32_16x16x32_bf16 v[96:99], v[140:143], a[136:139], v[96:99]
    v_mfma_f32_16x16x32_bf16 v[96:99], v[144:147], a[160:163], v[96:99]
    v_cvt_pk_bf16_f32 v58, v116, v117
    v_cvt_pk_bf16_f32 v59, v118, v119
    v_mfma_f32_16x16x32_bf16 v[96:99], v[148:151], a[184:187], v[96:99]
    v_cndmask_b32 v58, v58, 0, s[82:83]
    v_cndmask_b32 v59, v59, 0, s[82:83]
    v_mfma_f32_16x16x32_bf16 v[96:99], v[152:155], a[208:211], v[96:99]
    v_permlane32_swap_b32 v28, v29
    v_add_f32 v28, v28, v29
    v_mfma_f32_16x16x32_bf16 v[96:99], v[156:159], a[232:235], v[96:99]
    v_rcp_f32 v28, v28
    v_mfma_f32_16x16x32_bf16 v[96:99], v[160:163], v[176:179], v[96:99]
    v_mul_f32 v26, v26, v28
    v_mul_f32 v27, v27, v28
    v_mfma_f32_16x16x32_bf16 v[96:99], v[164:167], v[200:203], v[96:99]
    v_cvt_pk_bf16_f32 v26, v26, v26
    v_cvt_pk_bf16_f32 v27, v27, v27
    v_mfma_f32_16x16x32_bf16 v[96:99], v[168:171], v[224:227], v[96:99]
    v_and_b32 v80, v26, v14
    v_and_b32 v81, v27, v15
    v_mfma_f32_16x16x32_bf16 v[96:99], v[172:175], v[248:251], v[96:99]
    v_and_b32 v82, v26, v16
    v_and_b32 v83, v27, v17
    v_mfma_f32_16x16x32_bf16 v[100:103], v[120:123], a[20:23], 0
    v_mfma_f32_16x16x32_bf16 v[100:103], v[124:127], a[44:47], v[100:103]
    v_mfma_f32_16x16x32_bf16 v[72:75], v[34:37], v[80:83], 0
    v_mfma_f32_16x16x32_bf16 v[100:103], v[128:131], a[68:71], v[100:103]
    v_mfma_f32_16x16x32_bf16 v[76:79], v[44:47], v[80:83], 0
    v_mfma_f32_16x16x32_bf16 v[100:103], v[132:135], a[92:95], v[100:103]
    s_add_u32 s53, s74, 81920
    v_mfma_f32_16x16x32_bf16 v[100:103], v[136:139], a[116:119], v[100:103]
    v_mfma_f32_16x16x32_bf16 v[100:103], v[140:143], a[140:143], v[100:103]
    v_mfma_f32_16x16x32_bf16 v[100:103], v[144:147], a[164:167], v[100:103]
    v_cvt_pk_bf16_f32 v38, v96, v97
    v_cvt_pk_bf16_f32 v39, v98, v99
    v_mfma_f32_16x16x32_bf16 v[100:103], v[148:151], a[188:191], v[100:103]
    v_mfma_f32_16x16x32_bf16 v[100:103], v[152:155], a[212:215], v[100:103]
    v_cvt_pk_bf16_f32 v84, v72, v73
    v_cvt_pk_bf16_f32 v85, v74, v75
    v_mfma_f32_16x16x32_bf16 v[100:103], v[156:159], a[236:239], v[100:103]
    v_cvt_pk_bf16_f32 v86, v76, v77
    v_cvt_pk_bf16_f32 v87, v78, v79
    v_mfma_f32_16x16x32_bf16 v[100:103], v[160:163], v[180:183], v[100:103]
    v_cndmask_b32 v86, v86, 0, s[82:83]
    v_cndmask_b32 v87, v87, 0, s[82:83]
    v_mfma_f32_16x16x32_bf16 v[100:103], v[164:167], v[204:207], v[100:103]
    buffer_store_dwordx4 v[84:87], v23, s[24:27], s53 offen sc1
    v_mfma_f32_16x16x32_bf16 v[100:103], v[168:171], v[228:231], v[100:103]
    v_mfma_f32_16x16x32_bf16 v[100:103], v[172:175], v[252:255], v[100:103]
    v_mfma_f32_16x16x32_bf16 v[104:107], a[0:3], v[120:123], 0
    v_mfma_f32_16x16x32_bf16 v[104:107], a[24:27], v[124:127], v[104:107]
    v_mfma_f32_16x16x32_bf16 v[104:107], a[48:51], v[128:131], v[104:107]
    v_mfma_f32_16x16x32_bf16 v[104:107], a[72:75], v[132:135], v[104:107]
    v_mfma_f32_16x16x32_bf16 v[104:107], a[96:99], v[136:139], v[104:107]
    v_mfma_f32_16x16x32_bf16 v[104:107], a[120:123], v[140:143], v[104:107]
    v_mfma_f32_16x16x32_bf16 v[104:107], a[144:147], v[144:147], v[104:107]
    s_nop 0
    v_cvt_pk_bf16_f32 v48, v100, v101
    v_cvt_pk_bf16_f32 v49, v102, v103
    v_mfma_f32_16x16x32_bf16 v[104:107], a[168:171], v[148:151], v[104:107]
    v_mfma_f32_16x16x32_bf16 v[104:107], a[192:195], v[152:155], v[104:107]
    v_mfma_f32_16x16x32_bf16 v[104:107], a[216:219], v[156:159], v[104:107]
    v_mfma_f32_16x16x32_bf16 v[104:107], a[240:243], v[160:163], v[104:107]
    v_mfma_f32_16x16x32_bf16 v[104:107], v[184:187], v[164:167], v[104:107]
    v_mfma_f32_16x16x32_bf16 v[104:107], v[208:211], v[168:171], v[104:107]
    v_mfma_f32_16x16x32_bf16 v[104:107], v[232:235], v[172:175], v[104:107]
    s_waitcnt vmcnt(9)
    s_barrier
    v_mfma_f32_16x16x32_bf16 v[108:111], a[4:7], v[120:123], 0
    v_add_u32 v4, 65536, v4
    v_add_u32 v25, 65536, v25
    ds_read_b128 v[120:123], v4 offset:0
    v_mfma_f32_16x16x32_bf16 v[108:111], a[28:31], v[124:127], v[108:111]
    ds_read_b128 v[124:127], v25 offset:0
    v_mfma_f32_16x16x32_bf16 v[108:111], a[52:55], v[128:131], v[108:111]
    ds_read_b128 v[128:131], v4 offset:2048
    v_mfma_f32_16x16x32_bf16 v[108:111], a[76:79], v[132:135], v[108:111]
    ds_read_b128 v[132:135], v25 offset:2048
    v_mfma_f32_16x16x32_bf16 v[108:111], a[100:103], v[136:139], v[108:111]
    ds_read_b128 v[136:139], v4 offset:4096
    v_mfma_f32_16x16x32_bf16 v[108:111], a[124:127], v[140:143], v[108:111]
    ds_read_b128 v[140:143], v25 offset:4096
    v_mfma_f32_16x16x32_bf16 v[108:111], a[148:151], v[144:147], v[108:111]
    ds_read_b128 v[144:147], v4 offset:6144
    v_cvt_pk_bf16_f32 v68, v104, v105
    v_mfma_f32_16x16x32_bf16 v[108:111], a[172:175], v[148:151], v[108:111]
    ds_read_b128 v[148:151], v25 offset:6144
    v_cvt_pk_bf16_f32 v69, v106, v107
    v_mfma_f32_16x16x32_bf16 v[108:111], a[196:199], v[152:155], v[108:111]
    ds_read_b128 v[152:155], v4 offset:8192
    v_mfma_f32_16x16x32_bf16 v[108:111], a[220:223], v[156:159], v[108:111]
    ds_read_b128 v[156:159], v25 offset:8192
    v_mfma_f32_16x16x32_bf16 v[108:111], a[244:247], v[160:163], v[108:111]
    ds_read_b128 v[160:163], v4 offset:10240
    v_mfma_f32_16x16x32_bf16 v[108:111], v[188:191], v[164:167], v[108:111]
    ds_read_b128 v[164:167], v25 offset:10240
    v_mfma_f32_16x16x32_bf16 v[108:111], v[212:215], v[168:171], v[108:111]
    ds_read_b128 v[168:171], v4 offset:12288
    v_mfma_f32_16x16x32_bf16 v[108:111], v[236:239], v[172:175], v[108:111]
    ds_read_b128 v[172:175], v25 offset:12288
    s_waitcnt lgkmcnt(11)
    v_mfma_f32_16x16x32_bf16 v[112:115], a[0:3], v[120:123], 0
    v_mfma_f32_16x16x32_bf16 v[112:115], a[24:27], v[124:127], v[112:115]
    v_mfma_f32_16x16x32_bf16 v[112:115], a[48:51], v[128:131], v[112:115]
    s_waitcnt lgkmcnt(8)
    v_mfma_f32_16x16x32_bf16 v[112:115], a[72:75], v[132:135], v[112:115]
    v_mfma_f32_16x16x32_bf16 v[112:115], a[96:99], v[136:139], v[112:115]
    v_mfma_f32_16x16x32_bf16 v[112:115], a[120:123], v[140:143], v[112:115]
    s_waitcnt lgkmcnt(5)
    v_mfma_f32_16x16x32_bf16 v[112:115], a[144:147], v[144:147], v[112:115]
    v_cvt_pk_bf16_f32 v70, v108, v109
    v_cvt_pk_bf16_f32 v71, v110, v111
    v_mfma_f32_16x16x32_bf16 v[112:115], a[168:171], v[148:151], v[112:115]
    v_cndmask_b32 v70, v70, 0, s[82:83]
    v_cndmask_b32 v71, v71, 0, s[82:83]
    v_mfma_f32_16x16x32_bf16 v[112:115], a[192:195], v[152:155], v[112:115]
    s_waitcnt lgkmcnt(2)
    v_mfma_f32_16x16x32_bf16 v[112:115], a[216:219], v[156:159], v[112:115]
    v_mfma_f32_16x16x32_bf16 v[72:75], v[52:55], v[68:71], 0
    v_mfma_f32_16x16x32_bf16 v[112:115], a[240:243], v[160:163], v[112:115]
    v_mfma_f32_16x16x32_bf16 v[76:79], v[56:59], v[68:71], 0
    v_mfma_f32_16x16x32_bf16 v[112:115], v[184:187], v[164:167], v[112:115]
    s_waitcnt lgkmcnt(0)
    v_mfma_f32_16x16x32_bf16 v[112:115], v[208:211], v[168:171], v[112:115]
    v_mfma_f32_16x16x32_bf16 v[112:115], v[232:235], v[172:175], v[112:115]
    v_mfma_f32_16x16x32_bf16 v[116:119], a[4:7], v[120:123], 0
    v_mfma_f32_16x16x32_bf16 v[116:119], a[28:31], v[124:127], v[116:119]
    v_cndmask_b32 v26, v72, v73, s[76:77]
    v_cndmask_b32 v27, v74, v75, s[76:77]
    v_mfma_f32_16x16x32_bf16 v[116:119], a[52:55], v[128:131], v[116:119]
    v_cndmask_b32 v28, v76, v77, s[76:77]
    v_cndmask_b32 v29, v78, v79, s[76:77]
    v_mfma_f32_16x16x32_bf16 v[116:119], a[76:79], v[132:135], v[116:119]
    v_cndmask_b32 v26, v26, v28, s[78:79]
    v_cndmask_b32 v27, v27, v29, s[80:81]
    v_mfma_f32_16x16x32_bf16 v[116:119], a[100:103], v[136:139], v[116:119]
    v_max_f32 v28, v26, v27
    v_mov_b32 v29, v28
    v_mfma_f32_16x16x32_bf16 v[116:119], a[124:127], v[140:143], v[116:119]
    v_mfma_f32_16x16x32_bf16 v[116:119], a[148:151], v[144:147], v[116:119]
    v_cvt_pk_bf16_f32 v64, v112, v113
    v_cvt_pk_bf16_f32 v65, v114, v115
    v_mfma_f32_16x16x32_bf16 v[116:119], a[172:175], v[148:151], v[116:119]
    v_permlane16_swap_b32 v28, v29
    v_max_f32 v28, v28, v29
    v_mfma_f32_16x16x32_bf16 v[116:119], a[196:199], v[152:155], v[116:119]
    v_mov_b32 v29, v28
    v_mfma_f32_16x16x32_bf16 v[116:119], a[220:223], v[156:159], v[116:119]
    v_mfma_f32_16x16x32_bf16 v[116:119], a[244:247], v[160:163], v[116:119]
    v_permlane32_swap_b32 v28, v29
    v_max_f32 v28, v28, v29
    v_mfma_f32_16x16x32_bf16 v[116:119], v[188:191], v[164:167], v[116:119]
    v_sub_f32 v26, v26, v28
    v_sub_f32 v27, v27, v28
    v_mfma_f32_16x16x32_bf16 v[116:119], v[212:215], v[168:171], v[116:119]
    v_mul_f32 v26, s91, v26
    v_mul_f32 v27, s91, v27
    v_mfma_f32_16x16x32_bf16 v[116:119], v[236:239], v[172:175], v[116:119]
    v_exp_f32 v26, v26
    v_mfma_f32_16x16x32_bf16 v[96:99], a[8:11], v[120:123], 0
    v_exp_f32 v27, v27
    v_mfma_f32_16x16x32_bf16 v[96:99], a[32:35], v[124:127], v[96:99]
    v_add_f32 v28, v26, v27
    v_mov_b32 v29, v28
    v_mfma_f32_16x16x32_bf16 v[96:99], a[56:59], v[128:131], v[96:99]
    v_mfma_f32_16x16x32_bf16 v[96:99], a[80:83], v[132:135], v[96:99]
    v_permlane16_swap_b32 v28, v29
    v_add_f32 v28, v28, v29
    v_mfma_f32_16x16x32_bf16 v[96:99], a[104:107], v[136:139], v[96:99]
    v_mov_b32 v29, v28
    v_mfma_f32_16x16x32_bf16 v[96:99], a[128:131], v[140:143], v[96:99]
    v_mfma_f32_16x16x32_bf16 v[96:99], a[152:155], v[144:147], v[96:99]
    v_cvt_pk_bf16_f32 v66, v116, v117
    v_cvt_pk_bf16_f32 v67, v118, v119
    v_mfma_f32_16x16x32_bf16 v[96:99], a[176:179], v[148:151], v[96:99]
    v_cndmask_b32 v66, v66, 0, s[82:83]
    v_cndmask_b32 v67, v67, 0, s[82:83]
    v_mfma_f32_16x16x32_bf16 v[96:99], a[200:203], v[152:155], v[96:99]
    v_permlane32_swap_b32 v28, v29
    v_add_f32 v28, v28, v29
    v_mfma_f32_16x16x32_bf16 v[96:99], a[224:227], v[156:159], v[96:99]
    v_rcp_f32 v28, v28
    v_mfma_f32_16x16x32_bf16 v[96:99], a[248:251], v[160:163], v[96:99]
    v_mul_f32 v26, v26, v28
    v_mul_f32 v27, v27, v28
    v_mfma_f32_16x16x32_bf16 v[96:99], v[192:195], v[164:167], v[96:99]
    v_cvt_pk_bf16_f32 v26, v26, v26
    v_cvt_pk_bf16_f32 v27, v27, v27
    v_mfma_f32_16x16x32_bf16 v[96:99], v[216:219], v[168:171], v[96:99]
    v_and_b32 v80, v26, v14
    v_and_b32 v81, v27, v15
    v_mfma_f32_16x16x32_bf16 v[96:99], v[240:243], v[172:175], v[96:99]
    v_and_b32 v82, v26, v16
    v_and_b32 v83, v27, v17
    v_mfma_f32_16x16x32_bf16 v[100:103], a[12:15], v[120:123], 0
    v_mfma_f32_16x16x32_bf16 v[100:103], a[36:39], v[124:127], v[100:103]
    v_mfma_f32_16x16x32_bf16 v[72:75], v[36:39], v[80:83], 0
    v_mfma_f32_16x16x32_bf16 v[100:103], a[60:63], v[128:131], v[100:103]
    v_mfma_f32_16x16x32_bf16 v[76:79], v[46:49], v[80:83], 0
    v_mfma_f32_16x16x32_bf16 v[100:103], a[84:87], v[132:135], v[100:103]
    s_add_u32 s53, s74, 98304
    v_mfma_f32_16x16x32_bf16 v[100:103], a[108:111], v[136:139], v[100:103]
    v_mfma_f32_16x16x32_bf16 v[100:103], a[132:135], v[140:143], v[100:103]
    v_mfma_f32_16x16x32_bf16 v[100:103], a[156:159], v[144:147], v[100:103]
    v_cvt_pk_bf16_f32 v60, v96, v97
    v_cvt_pk_bf16_f32 v61, v98, v99
    v_mfma_f32_16x16x32_bf16 v[100:103], a[180:183], v[148:151], v[100:103]
    v_mfma_f32_16x16x32_bf16 v[100:103], a[204:207], v[152:155], v[100:103]
    v_cvt_pk_bf16_f32 v84, v72, v73
    v_cvt_pk_bf16_f32 v85, v74, v75
    v_mfma_f32_16x16x32_bf16 v[100:103], a[228:231], v[156:159], v[100:103]
    v_cvt_pk_bf16_f32 v86, v76, v77
    v_cvt_pk_bf16_f32 v87, v78, v79
    v_mfma_f32_16x16x32_bf16 v[100:103], a[252:255], v[160:163], v[100:103]
    v_cndmask_b32 v86, v86, 0, s[82:83]
    v_cndmask_b32 v87, v87, 0, s[82:83]
    v_mfma_f32_16x16x32_bf16 v[100:103], v[196:199], v[164:167], v[100:103]
    buffer_store_dwordx4 v[84:87], v23, s[24:27], s53 offen sc1
    v_mfma_f32_16x16x32_bf16 v[100:103], v[220:223], v[168:171], v[100:103]
    v_mfma_f32_16x16x32_bf16 v[100:103], v[244:247], v[172:175], v[100:103]
    v_mfma_f32_16x16x32_bf16 v[104:107], v[120:123], a[16:19], 0
    v_mfma_f32_16x16x32_bf16 v[104:107], v[124:127], a[40:43], v[104:107]
    v_mfma_f32_16x16x32_bf16 v[104:107], v[128:131], a[64:67], v[104:107]
    v_mfma_f32_16x16x32_bf16 v[104:107], v[132:135], a[88:91], v[104:107]
    v_mfma_f32_16x16x32_bf16 v[104:107], v[136:139], a[112:115], v[104:107]
    v_mfma_f32_16x16x32_bf16 v[104:107], v[140:143], a[136:139], v[104:107]
    v_mfma_f32_16x16x32_bf16 v[104:107], v[144:147], a[160:163], v[104:107]
    s_nop 0
    v_cvt_pk_bf16_f32 v62, v100, v101
    v_cvt_pk_bf16_f32 v63, v102, v103
    v_mfma_f32_16x16x32_bf16 v[104:107], v[148:151], a[184:187], v[104:107]
    v_cndmask_b32 v62, v62, 0, s[82:83]
    v_cndmask_b32 v63, v63, 0, s[82:83]
    v_mfma_f32_16x16x32_bf16 v[104:107], v[152:155], a[208:211], v[104:107]
    v_mfma_f32_16x16x32_bf16 v[104:107], v[156:159], a[232:235], v[104:107]
    v_mfma_f32_16x16x32_bf16 v[72:75], v[56:59], v[64:67], 0
    v_mfma_f32_16x16x32_bf16 v[104:107], v[160:163], v[176:179], v[104:107]
    v_mfma_f32_16x16x32_bf16 v[76:79], v[60:63], v[64:67], 0
    v_mfma_f32_16x16x32_bf16 v[104:107], v[164:167], v[200:203], v[104:107]
    v_mfma_f32_16x16x32_bf16 v[104:107], v[168:171], v[224:227], v[104:107]
    v_mfma_f32_16x16x32_bf16 v[104:107], v[172:175], v[248:251], v[104:107]
    v_mfma_f32_16x16x32_bf16 v[108:111], v[120:123], a[20:23], 0
    v_mfma_f32_16x16x32_bf16 v[108:111], v[124:127], a[44:47], v[108:111]
    s_nop 0
    v_cndmask_b32 v26, v72, v73, s[76:77]
    v_cndmask_b32 v27, v74, v75, s[76:77]
    v_mfma_f32_16x16x32_bf16 v[108:111], v[128:131], a[68:71], v[108:111]
    v_cndmask_b32 v28, v76, v77, s[76:77]
    v_cndmask_b32 v29, v78, v79, s[76:77]
    v_mfma_f32_16x16x32_bf16 v[108:111], v[132:135], a[92:95], v[108:111]
    v_cndmask_b32 v26, v26, v28, s[78:79]
    v_cndmask_b32 v27, v27, v29, s[80:81]
    v_mfma_f32_16x16x32_bf16 v[108:111], v[136:139], a[116:119], v[108:111]
    v_max_f32 v28, v26, v27
    v_mov_b32 v29, v28
    v_mfma_f32_16x16x32_bf16 v[108:111], v[140:143], a[140:143], v[108:111]
    v_mfma_f32_16x16x32_bf16 v[108:111], v[144:147], a[164:167], v[108:111]
    v_cvt_pk_bf16_f32 v40, v104, v105
    v_cvt_pk_bf16_f32 v41, v106, v107
    v_mfma_f32_16x16x32_bf16 v[108:111], v[148:151], a[188:191], v[108:111]
    v_permlane16_swap_b32 v28, v29
    v_max_f32 v28, v28, v29
    v_mfma_f32_16x16x32_bf16 v[108:111], v[152:155], a[212:215], v[108:111]
    v_mov_b32 v29, v28
    v_mfma_f32_16x16x32_bf16 v[108:111], v[156:159], a[236:239], v[108:111]
    v_mfma_f32_16x16x32_bf16 v[108:111], v[160:163], v[180:183], v[108:111]
    v_permlane32_swap_b32 v28, v29
    v_max_f32 v28, v28, v29
    v_mfma_f32_16x16x32_bf16 v[108:111], v[164:167], v[204:207], v[108:111]
    v_sub_f32 v26, v26, v28
    v_sub_f32 v27, v27, v28
    v_mfma_f32_16x16x32_bf16 v[108:111], v[168:171], v[228:231], v[108:111]
    v_mul_f32 v26, s91, v26
    v_mul_f32 v27, s91, v27
    v_mfma_f32_16x16x32_bf16 v[108:111], v[172:175], v[252:255], v[108:111]
    v_exp_f32 v26, v26
    s_nop 6
    v_cvt_pk_bf16_f32 v50, v108, v109
    v_cvt_pk_bf16_f32 v51, v110, v111
    v_exp_f32 v27, v27
    s_nop 0
    v_add_f32 v28, v26, v27
    v_mov_b32 v29, v28
    s_nop 1
    v_permlane16_swap_b32 v28, v29
    v_add_f32 v28, v28, v29
    v_mov_b32 v29, v28
    s_nop 1
    v_permlane32_swap_b32 v28, v29
    v_add_f32 v28, v28, v29
    v_rcp_f32 v28, v28
    s_nop 0
    v_mul_f32 v26, v26, v28
    v_mul_f32 v27, v27, v28
    v_cvt_pk_bf16_f32 v26, v26, v26
    v_cvt_pk_bf16_f32 v27, v27, v27
    v_and_b32 v80, v26, v14
    v_and_b32 v81, v27, v15
    v_and_b32 v82, v26, v16
    v_and_b32 v83, v27, v17
    s_nop 1
    v_mfma_f32_16x16x32_bf16 v[72:75], v[38:41], v[80:83], 0
    v_mfma_f32_16x16x32_bf16 v[76:79], v[48:51], v[80:83], 0
    s_add_u32 s53, s74, 114688
    s_nop 5
    v_cvt_pk_bf16_f32 v84, v72, v73
    v_cvt_pk_bf16_f32 v85, v74, v75
    v_cvt_pk_bf16_f32 v86, v76, v77
    v_cvt_pk_bf16_f32 v87, v78, v79
    v_cndmask_b32 v86, v86, 0, s[82:83]
    v_cndmask_b32 v87, v87, 0, s[82:83]
    buffer_store_dwordx4 v[84:87], v23, s[24:27], s53 offen sc1
    s_waitcnt vmcnt(0) lgkmcnt(0)
    s_barrier
    s_cmp_lg_u32 s44, 0
    s_cbranch_scc1 L_nopub19
    s_lshl_b32 s60, s48, 4
    s_add_u32 s60, s60, s49
    s_lshl_b32 s60, s60, 7
    s_add_u32 s60, s60, 12779520
    v_mov_b32 v30, s47
    s_mov_b64 exec, 1
    buffer_store_dword v30, off, s[24:27], s60 sc1
    s_mov_b64 exec, -1
L_nopub19:
    s_endpgm
L_codeend:
.section .rodata,"a"
.p2align 6
.amdhsa_kernel parallel_sum__sliding_local_dilated__mixer_token_mlp__prompt_kernel
  .amdhsa_next_free_vgpr 512
  .amdhsa_next_free_sgpr 102
  .amdhsa_accum_offset 256
  .amdhsa_group_segment_fixed_size 0
  .amdhsa_kernarg_size 88
  .amdhsa_user_sgpr_count 2
  .amdhsa_user_sgpr_kernarg_segment_ptr 1
  .amdhsa_system_sgpr_workgroup_id_x 1
  .amdhsa_float_denorm_mode_32 3
.end_amdhsa_kernel
```

```asm
; @launch grid=(256,1,1) block=(256,1,1) lds=163840
.amdgcn_target "amdgcn-amd-amdhsa--gfx950"
.text
.globl parallel_sum__sliding_local_dilated__mixer_token_mlp__prompt_kernel
.p2align 8
.type parallel_sum__sliding_local_dilated__mixer_token_mlp__prompt_kernel,@function
parallel_sum__sliding_local_dilated__mixer_token_mlp__prompt_kernel:
    s_cmp_ge_u32 s2, 256
    s_cbranch_scc1 L_end
    s_load_dwordx2 s[4:5], s[0:1], 0
    s_load_dwordx16 s[76:91], s[0:1], 0
    s_load_dwordx4 s[92:95], s[0:1], 64
    s_load_dwordx2 s[24:25], s[0:1], 80
    s_lshr_b32 s46, s2, 3
    s_getpc_b64 s[98:99]
L_pc:
    s_mul_i32 s53, s46, 1408
    v_lshrrev_b32 v26, 4, v0
    v_min_u32 v26, 10, v26
    v_lshl_add_u32 v26, v26, 7, s53
    v_lshrrev_b32 v25, 5, v0
    v_min_u32 v26, L_codeend-L_pc-4, v26
    v_mov_b32 v29, s99
    v_add_co_u32 v28, vcc, s98, v26
    s_nop 1
    v_addc_co_u32 v29, vcc, 0, v29, vcc
    global_load_dword v108, v[28:29], off
    v_and_b32 v26, 31, v0
    v_mul_u32_u24 v24, 896, v25
    v_lshl_add_u32 v24, v26, 4, v24
    s_mul_i32 s53, s2, 7168
    v_add_u32 v24, s53, v24
    v_cmp_gt_u32 vcc, 24, v26
    v_mov_b32 v27, 2130706432
    s_mov_b32 s6, 1835008
    s_mov_b32 s7, 0x20000
    v_cndmask_b32 v22, v27, v24, vcc
    v_lshrrev_b32 v27, 6, v0
    v_and_b32 v1, 63, v0
    s_waitcnt lgkmcnt(0)
    buffer_load_dwordx4 v[32:35], v24, s[4:7], 0 offen
    buffer_load_dwordx4 v[36:39], v22, s[4:7], 0 offen offset:512
    v_readfirstlane_b32 s44, v27
    s_and_b32 s45, s2, 7
    s_mov_b64 s[8:9], s[78:79]
    s_mov_b32 s10, 1204224
    s_mov_b32 s11, s7
    s_lshr_b32 s53, s45, 1
    s_add_u32 s54, s53, 1
    s_bfe_u32 s54, s54, 0x10001
    s_add_u32 s54, s54, 1
    s_mul_i32 s53, s53, 224
    s_andn2_b32 s53, s53, 127
    s_sub_u32 s55, s46, 3
    s_cmp_lt_u32 s46, 24
    s_cselect_b32 s55, 63, s55
    s_cmp_lt_u32 s46, 21
    s_cselect_b32 s55, s46, s55
    s_mul_i32 s55, s55, 43008
    s_add_u32 s53, s53, s55
    v_and_b32 v27, 3, v0
    v_min_u32 v27, s54, v27
    v_bfe_u32 v28, v0, 2, 2
    v_min_u32 v28, 2, v28
    v_mul_u32_u24 v28, 7, v28
    v_add_u32 v27, v27, v28
    v_lshrrev_b32 v28, 4, v0
    v_min_u32 v28, 15, v28
    v_mul_u32_u24 v28, 21, v28
    v_add_lshl_u32 v27, v27, v28, 7
    buffer_load_dword v108, v27, s[8:11], s53 offen
    s_mov_b64 s[40:41], s[94:95]
    s_mov_b32 s42, 256
    s_mov_b32 s43, s7
    s_or_b32 s53, s2, s44
    s_cbranch_scc1 L_nononce
    s_memrealtime s[98:99]
    s_waitcnt lgkmcnt(0)
    s_or_b32 s98, s98, 1
    v_mov_b32 v28, s98
    s_mov_b64 exec, 1
    buffer_store_dword v28, off, s[40:43], 0 sc1
    s_mov_b64 exec, -1
L_nononce:
    s_mov_b64 s[16:17], s[84:85]
    s_mov_b32 s18, 7340032
    s_mov_b32 s19, s7
    s_mov_b32 s26, 16777216
    s_mov_b32 s27, s7
    s_mov_b64 s[20:21], s[88:89]
    s_mov_b32 s22, 7340032
    s_mov_b32 s23, s7
    s_mov_b64 s[12:13], s[80:81]
    s_mov_b32 s14, 401408
    s_mov_b32 s15, s7
    s_mov_b64 s[28:29], s[92:93]
    s_mov_b32 s30, 1835008
    s_mov_b32 s31, s7
    s_mov_b64 s[32:33], s[86:87]
    s_mov_b32 s34, 3584
    s_mov_b32 s35, s7
    s_mov_b64 s[36:37], s[90:91]
    s_mov_b32 s38, 4096
    s_mov_b32 s39, s7
    s_lshl_b32 s52, s44, 12
    v_lshlrev_b32 v23, 4, v1
    s_cmp_ge_u32 s46, 24
    s_cbranch_scc1 L_role_a
    v_lshrrev_b32 v208, 4, v1
    v_bfe_u32 v209, v1, 2, 2
    v_and_b32 v210, 3, v1
    v_and_b32 v211, 15, v1
    v_lshrrev_b32 v212, 5, v1
    s_mul_i32 s55, s45, 3
    s_max_u32 s55, s55, 1
    s_add_u32 s55, s55, s46
    s_sub_u32 s55, s55, 1
    s_sub_u32 s56, s55, 21
    s_min_u32 s55, s55, s56
    s_and_b32 s54, s45, 1
    s_mul_i32 s54, s54, 24
    s_sub_u32 s54, s46, s54
    s_cmp_ge_u32 s46, 21
    s_cselect_b32 s54, s54, s55
    s_mul_i32 s53, s45, 21
    s_add_u32 s53, s53, s54
    s_mul_i32 s50, s53, 171
    s_lshr_b32 s50, s50, 10
    s_mul_i32 s54, s50, 6
    s_sub_u32 s88, s53, s54
    s_mul_i32 s51, s50, 2
    s_add_u32 s51, s51, s88
    s_mul_i32 s54, s51, 43
    s_lshr_b32 s54, s54, 8
    s_mul_i32 s54, s54, 6
    s_sub_u32 s51, s51, s54
    s_mul_i32 s65, s51, 13
    s_add_u32 s65, s65, 2
    s_mul_i32 s65, s65, 171
    s_lshr_b32 s65, s65, 10
    v_lshl_add_u32 v213, v212, 2, v209
    v_and_b32 v215, 1, v208
    v_lshlrev_b32 v214, 4, v210
    v_lshl_add_u32 v214, v215, 6, v214
    s_mul_i32 s53, s44, 1835008
    s_lshl_b32 s54, s50, 7
    s_add_u32 s53, s53, s54
    v_mul_u32_u24 v10, 3584, v213
    v_add3_u32 v10, v10, v214, s53
    v_xor_b32 v11, 32, v10
    s_cmp_ge_u32 s46, 21
    s_cbranch_scc1 L_help
    s_add_u32 m0, s52, 49152
    s_add_u32 s57, s65, 0
    s_sub_u32 s3, s57, 13
    s_min_u32 s57, s57, s3
    s_mul_i32 s57, s57, 114688
    buffer_load_dwordx4 v10, s[16:19], s57 offen offset:0 lds
    s_add_u32 s57, s57, 27648
    buffer_load_dwordx4 v11, s[16:19], s57 offen offset:1024 lds
    v_mul_u32_u24 v109, 1088, v25
    v_lshl_add_u32 v109, v26, 4, v109
    v_mul_u32_u24 v110, 1088, v209
    v_lshl_add_u32 v110, v208, 5, v110
    v_lshl_add_u32 v110, v210, 3, v110
    s_lshl_b32 s53, s44, 7
    v_add_u32 v110, s53, v110
    v_mul_u32_u24 v111, 66816, v208
    v_lshl_add_u32 v111, v211, 4, v111
    s_mul_i32 s63, s44, 267264
    s_lshl_b32 s53, s2, 8
    s_add_u32 s63, s63, s53
    s_add_u32 s64, s63, 1069056
    v_cmp_gt_u32 vcc, 208, v0
    v_mov_b32 v100, 2130706432
    v_cmp_le_u32 s[92:93], 24, v26
    v_cndmask_b32 v22, v100, v111, vcc
    s_mov_b32 s62, 0x3f803f80
    s_mov_b32 s61, 0xffff0000
    v_mov_b32 v96, 0
    v_mov_b32 v97, 0
    v_lshlrev_b32 v216, 6, v209
    v_lshl_add_u32 v216, v210, 3, v216
    v_lshl_add_u32 v216, v215, 5, v216
    s_add_u32 s53, s52, 49152
    v_lshl_add_u32 v2, v208, 10, v216
    v_add_u32 v2, s53, v2
    v_xor_b32 v3, 32, v2
    v_add_u32 v4, 65536, v2
    v_add_u32 v5, 65536, v3
    v_lshl_add_u32 v6, v208, 9, v216
    v_add_u32 v6, s53, v6
    v_xor_b32 v7, 32, v6
    v_add_u32 v8, 65536, v6
    v_add_u32 v9, 65536, v7
    s_waitcnt vmcnt(4)
    v_dot2c_f32_bf16 v96, s62, v32
    v_dot2c_f32_bf16 v97, v32, v32
    v_lshlrev_b32 v40, 16, v32
    v_and_b32 v41, s61, v32
    v_dot2c_f32_bf16 v96, s62, v33
    v_dot2c_f32_bf16 v97, v33, v33
    v_lshlrev_b32 v42, 16, v33
    v_and_b32 v43, s61, v33
    v_dot2c_f32_bf16 v96, s62, v34
    v_dot2c_f32_bf16 v97, v34, v34
    v_lshlrev_b32 v44, 16, v34
    v_and_b32 v45, s61, v34
    v_dot2c_f32_bf16 v96, s62, v35
    v_dot2c_f32_bf16 v97, v35, v35
    v_lshlrev_b32 v46, 16, v35
    v_and_b32 v47, s61, v35
    s_waitcnt vmcnt(3)
    v_dot2c_f32_bf16 v96, s62, v36
    v_dot2c_f32_bf16 v97, v36, v36
    v_lshlrev_b32 v48, 16, v36
    v_and_b32 v49, s61, v36
    v_dot2c_f32_bf16 v96, s62, v37
    v_dot2c_f32_bf16 v97, v37, v37
    v_lshlrev_b32 v50, 16, v37
    v_and_b32 v51, s61, v37
    v_dot2c_f32_bf16 v96, s62, v38
    v_dot2c_f32_bf16 v97, v38, v38
    v_lshlrev_b32 v52, 16, v38
    v_and_b32 v53, s61, v38
    v_dot2c_f32_bf16 v96, s62, v39
    v_dot2c_f32_bf16 v97, v39, v39
    v_lshlrev_b32 v54, 16, v39
    v_and_b32 v55, s61, v39
    buffer_load_dword v29, off, s[40:43], 0 sc1
    v_add_f32_dpp v96, v96, v96 quad_perm:[1,0,3,2] row_mask:0xf bank_mask:0xf
    v_add_f32_dpp v97, v97, v97 quad_perm:[1,0,3,2] row_mask:0xf bank_mask:0xf
    s_nop 0
    v_add_f32_dpp v96, v96, v96 quad_perm:[2,3,0,1] row_mask:0xf bank_mask:0xf
    v_add_f32_dpp v97, v97, v97 quad_perm:[2,3,0,1] row_mask:0xf bank_mask:0xf
    s_nop 0
    v_add_f32_dpp v96, v96, v96 row_half_mirror row_mask:0xf bank_mask:0xf
    v_add_f32_dpp v97, v97, v97 row_half_mirror row_mask:0xf bank_mask:0xf
    s_nop 0
    v_add_f32_dpp v96, v96, v96 row_mirror row_mask:0xf bank_mask:0xf
    v_add_f32_dpp v97, v97, v97 row_mirror row_mask:0xf bank_mask:0xf
    v_mov_b32 v98, v96
    v_mov_b32 v99, v97
    s_nop 0
    v_permlane16_swap_b32 v96, v98
    v_permlane16_swap_b32 v97, v99
    v_add_f32 v96, v96, v98
    v_add_f32 v97, v97, v99
    v_mul_f32 v98, 0x3b124925, v96
    v_mul_f32 v99, 0x3b124925, v97
    v_fma_f32 v99, -v98, v98, v99
    v_max_f32 v99, 0, v99
    v_cvt_pk_bf16_f32 v100, 0, v99
    v_add_f32 v100, 0x3727c5ac, v100
    v_cvt_pk_bf16_f32 v100, 0, v100
    v_sqrt_f32 v100, v100
    s_nop 0
    v_cvt_pk_bf16_f32 v100, 0, v100
    v_rcp_f32 v100, v100
    s_nop 0
    v_mul_f32 v99, v99, v100
    v_mul_f32 v99, v99, v100
    v_cvt_pk_bf16_f32 v104, 0, v99
    v_add_f32 v104, 0x3727c5ac, v104
    v_cvt_pk_bf16_f32 v104, 0, v104
    v_sqrt_f32 v104, v104
    s_nop 0
    v_cvt_pk_bf16_f32 v102, 0, v104
    v_rcp_f32 v104, v102
    s_nop 0
    v_mul_f32 v104, v104, v100
    v_mul_f32 v106, v98, v104
    v_pk_fma_f32 v[56:57], v[40:41], v[104:105], v[106:107] op_sel_hi:[1,0,0] neg_lo:[0,0,1] neg_hi:[0,0,1]
    v_pk_fma_f32 v[58:59], v[42:43], v[104:105], v[106:107] op_sel_hi:[1,0,0] neg_lo:[0,0,1] neg_hi:[0,0,1]
    v_pk_fma_f32 v[60:61], v[44:45], v[104:105], v[106:107] op_sel_hi:[1,0,0] neg_lo:[0,0,1] neg_hi:[0,0,1]
    v_pk_fma_f32 v[62:63], v[46:47], v[104:105], v[106:107] op_sel_hi:[1,0,0] neg_lo:[0,0,1] neg_hi:[0,0,1]
    v_pk_fma_f32 v[64:65], v[48:49], v[104:105], v[106:107] op_sel_hi:[1,0,0] neg_lo:[0,0,1] neg_hi:[0,0,1]
    v_pk_fma_f32 v[66:67], v[50:51], v[104:105], v[106:107] op_sel_hi:[1,0,0] neg_lo:[0,0,1] neg_hi:[0,0,1]
    v_pk_fma_f32 v[68:69], v[52:53], v[104:105], v[106:107] op_sel_hi:[1,0,0] neg_lo:[0,0,1] neg_hi:[0,0,1]
    v_pk_fma_f32 v[70:71], v[54:55], v[104:105], v[106:107] op_sel_hi:[1,0,0] neg_lo:[0,0,1] neg_hi:[0,0,1]
    v_cvt_pk_bf16_f32 v80, v56, v57
    v_cvt_pk_bf16_f32 v81, v58, v59
    v_cvt_pk_bf16_f32 v82, v60, v61
    v_cvt_pk_bf16_f32 v83, v62, v63
    v_cvt_pk_bf16_f32 v84, v64, v65
    v_cvt_pk_bf16_f32 v85, v66, v67
    v_cvt_pk_bf16_f32 v86, v68, v69
    v_cvt_pk_bf16_f32 v87, v70, v71
    v_lshrrev_b32 v102, 16, v102
    v_cndmask_b32 v84, v84, v102, s[92:93]
    ds_write_b128 v109, v[80:83] offset:0
    ds_write_b128 v109, v[84:87] offset:512
    s_waitcnt lgkmcnt(0)
    s_barrier
    ds_read_b64_tr_b16 v[88:89], v110 offset:0
    ds_read_b64_tr_b16 v[90:91], v110 offset:4352
    ds_read_b64_tr_b16 v[92:93], v110 offset:512
    ds_read_b64_tr_b16 v[94:95], v110 offset:4864
    s_waitcnt lgkmcnt(2)
    buffer_store_dwordx4 v[88:91], v111, s[24:27], s63 offen sc1
    s_waitcnt lgkmcnt(0)
    buffer_store_dwordx4 v[92:95], v22, s[24:27], s64 offen sc1
    s_add_u32 s57, s57, 27648
    buffer_load_dwordx4 v10, s[16:19], s57 offen offset:2048 lds
    s_add_u32 s57, s57, 27648
    buffer_load_dwordx4 v11, s[16:19], s57 offen offset:3072 lds
    s_add_u32 m0, s52, 65536
    s_add_u32 s57, s65, 1
    s_sub_u32 s3, s57, 13
    s_min_u32 s57, s57, s3
    s_mul_i32 s57, s57, 114688
    buffer_load_dwordx4 v10, s[16:19], s57 offen offset:0 lds
    s_add_u32 s57, s57, 27648
    buffer_load_dwordx4 v11, s[16:19], s57 offen offset:1024 lds
    s_add_u32 s57, s57, 27648
    buffer_load_dwordx4 v10, s[16:19], s57 offen offset:2048 lds
    s_add_u32 s57, s57, 27648
    buffer_load_dwordx4 v11, s[16:19], s57 offen offset:3072 lds
    s_waitcnt vmcnt(6)
    v_cmp_eq_u32 vcc, 0, v29
    s_nop 0
    s_cbranch_vccz L_ok2
    s_mov_b32 s59, 20000
L_spin1:
    buffer_load_dword v29, off, s[40:43], 0 sc1
    s_waitcnt vmcnt(0)
    v_cmp_eq_u32 vcc, 0, v29
    s_nop 0
    s_cbranch_vccz L_ok2
    s_sub_u32 s59, s59, 1
    s_cbranch_scc0 L_spin1
L_ok2:
    v_readfirstlane_b32 s47, v29
    s_barrier
    s_cmp_lg_u32 s44, 0
    s_cbranch_scc1 L_nopub3
    s_lshl_b32 s60, s2, 5
    s_add_u32 s60, s60, 12582912
    v_mov_b32 v30, s47
    s_mov_b64 exec, 1
    buffer_store_dword v30, off, s[24:27], s60 sc1
    s_mov_b64 exec, -1
L_nopub3:
    s_lshl_b32 s53, s44, 11
    s_add_u32 s53, s53, 12582912
    v_lshl_add_u32 v18, v1, 5, s53
    s_lshl_b32 s53, s50, 7
    s_add_u32 m0, s52, 81920
    s_add_u32 s57, s65, 2
    s_sub_u32 s3, s57, 13
    s_min_u32 s57, s57, s3
    s_mul_i32 s57, s57, 114688
    buffer_load_dwordx4 v10, s[16:19], s57 offen offset:0 lds
    v_lshl_add_u32 v19, v208, 3, s53
    s_lshl2_add_u32 s67, s51, s44
    s_mul_i32 s67, s67, 58624
    s_lshl_b32 s53, s50, 11
    s_add_u32 s57, s57, 27648
    buffer_load_dwordx4 v11, s[16:19], s57 offen offset:1024 lds
    s_add_u32 s67, s67, s53
    s_add_u32 s67, s67, 2097152
    v_mov_b32 v236, 0xbdd2d3e8
    v_mov_b32 v237, 0xc0135761
    s_add_u32 s57, s57, 27648
    buffer_load_dwordx4 v10, s[16:19], s57 offen offset:2048 lds
    s_or_b32 s88, s88, 0
    s_add_u32 s54, s88, 24
    s_mul_i32 s84, s54, 66816
    s_lshl2_add_u32 s84, s52, s84
    s_mul_i32 s83, s54, 58624
    s_add_u32 s83, s83, s53
    s_and_b32 s54, s44, 1
    s_lshl_b32 s54, s54, 10
    s_add_u32 s57, s57, 27648
    buffer_load_dwordx4 v11, s[16:19], s57 offen offset:3072 lds
    s_add_u32 s83, s83, s54
    s_add_u32 s83, s83, 2097152
    s_lshl1_add_u32 s54, s54, 49152
    v_add_u32 v243, s54, v23
    s_add_u32 m0, s52, 98304
    s_add_u32 s57, s65, 3
    s_sub_u32 s3, s57, 13
    s_min_u32 s57, s57, s3
    s_mul_i32 s57, s57, 114688
    buffer_load_dwordx4 v10, s[16:19], s57 offen offset:0 lds
    s_cmp_lt_u32 s88, 4
    s_cselect_b32 s84, s84, 2130706432
    s_cselect_b32 s83, s83, 2130706432
    s_cmp_lt_u32 s44, 2
    s_cselect_b32 s83, s83, 2130706432
    s_cmp_eq_u32 s44, 0
    s_cselect_b32 s85, 1.0, 0
    s_mul_i32 s53, s45, 7
    s_lshr_b32 s53, s53, 1
    s_sub_u32 s53, s50, s53
    s_lshl1_add_u32 s53, s53, s88
    s_sub_u32 s53, s53, 4
    s_mul_i32 s54, s44, 28
    s_add_u32 s54, s54, s53
    s_lshl_b32 s87, s54, 16
    s_lshl_b32 s54, s45, 9
    s_add_u32 s87, s87, s54
    s_cmp_ge_u32 s88, 4
    s_cselect_b32 s87, s87, 2130706432
    v_lshrrev_b32 v254, 2, v1
    v_lshlrev_b32 v254, 12, v254
    v_lshl_add_u32 v254, v210, 7, v254
    s_add_u32 s57, s57, 27648
    buffer_load_dwordx4 v11, s[16:19], s57 offen offset:1024 lds
    s_waitcnt vmcnt(10)
    ds_read_b64_tr_b16 a[0:1], v2 offset:0
    ds_read_b64_tr_b16 a[2:3], v2 offset:512
    ds_read_b64_tr_b16 a[4:5], v3 offset:0
    ds_read_b64_tr_b16 a[6:7], v3 offset:512
    s_add_u32 s57, s57, 27648
    buffer_load_dwordx4 v10, s[16:19], s57 offen offset:2048 lds
    ds_read_b64_tr_b16 a[8:9], v2 offset:256
    ds_read_b64_tr_b16 a[10:11], v2 offset:768
    ds_read_b64_tr_b16 a[12:13], v3 offset:256
    ds_read_b64_tr_b16 a[14:15], v3 offset:768
    s_add_u32 s57, s57, 27648
    buffer_load_dwordx4 v11, s[16:19], s57 offen offset:3072 lds
    s_lshr_b32 s53, s46, 2
    s_and_b32 s89, s46, 3
    s_bfe_u32 s54, s46, 0x20001
    s_and_b32 s55, s46, 1
    s_add_u32 s55, s55, 4
    s_cmp_lt_u32 s46, 16
    s_cselect_b32 s53, s53, s54
    s_cselect_b32 s89, s89, s55
    s_mul_i32 s49, s53, 2
    s_add_u32 s49, s49, s89
    s_sub_u32 s54, s49, 6
    s_min_u32 s49, s49, s54
    s_or_b32 s89, s89, 0
    s_add_u32 m0, s52, 114688
    s_add_u32 s57, s65, 4
    s_sub_u32 s3, s57, 13
    s_min_u32 s57, s57, s3
    s_mul_i32 s57, s57, 114688
    buffer_load_dwordx4 v10, s[16:19], s57 offen offset:0 lds
    s_lshl2_add_u32 s48, s45, s53
    s_mul_i32 s53, s44, 1835008
    s_lshl_b32 s74, s48, 7
    s_add_u32 s53, s53, s74
    s_add_u32 s57, s57, 27648
    buffer_load_dwordx4 v11, s[16:19], s57 offen offset:1024 lds
    s_waitcnt vmcnt(10)
    ds_read_b64_tr_b16 a[16:17], v2 offset:16384
    ds_read_b64_tr_b16 a[18:19], v2 offset:16896
    ds_read_b64_tr_b16 a[20:21], v3 offset:16384
    ds_read_b64_tr_b16 a[22:23], v3 offset:16896
    s_add_u32 s57, s57, 27648
    buffer_load_dwordx4 v10, s[16:19], s57 offen offset:2048 lds
    ds_read_b64_tr_b16 a[24:25], v2 offset:16640
    ds_read_b64_tr_b16 a[26:27], v2 offset:17152
    ds_read_b64_tr_b16 a[28:29], v3 offset:16640
    ds_read_b64_tr_b16 a[30:31], v3 offset:17152
    s_lshl_b32 s56, s44, 5
    v_lshlrev_b32 v217, 5, v212
    v_xor_b32 v217, v217, v214
    v_xor_b32 v217, s56, v217
    s_add_u32 s57, s57, 27648
    buffer_load_dwordx4 v11, s[16:19], s57 offen offset:3072 lds
    s_add_u32 s74, s74, s56
    v_lshlrev_b32 v12, 12, v213
    v_add3_u32 v12, v12, v217, s53
    s_mul_i32 s53, s44, 100352
    s_add_u32 m0, s52, 131072
    s_add_u32 s57, s65, 5
    s_sub_u32 s3, s57, 13
    s_min_u32 s57, s57, s3
    s_mul_i32 s57, s57, 114688
    buffer_load_dwordx4 v10, s[16:19], s57 offen offset:0 lds
    s_lshl_b32 s54, s49, 7
    s_add_u32 s55, s53, s54
    v_mul_u32_u24 v13, 896, v213
    v_add3_u32 v13, v13, v214, s55
    s_add_u32 s57, s57, 27648
    buffer_load_dwordx4 v11, s[16:19], s57 offen offset:1024 lds
    s_waitcnt vmcnt(10)
    ds_read_b64_tr_b16 a[32:33], v2 offset:32768
    ds_read_b64_tr_b16 a[34:35], v2 offset:33280
    ds_read_b64_tr_b16 a[36:37], v3 offset:32768
    ds_read_b64_tr_b16 a[38:39], v3 offset:33280
    v_xor_b32 v14, 32, v13
    s_mul_i32 s73, s48, 57344
    s_add_u32 s71, s73, s54
    s_mul_i32 s55, s44, 14336
    ds_read_b64_tr_b16 a[40:41], v2 offset:33024
    ds_read_b64_tr_b16 a[42:43], v2 offset:33536
    ds_read_b64_tr_b16 a[44:45], v3 offset:33024
    ds_read_b64_tr_b16 a[46:47], v3 offset:33536
    s_add_u32 s57, s57, 27648
    buffer_load_dwordx4 v10, s[16:19], s57 offen offset:2048 lds
    s_add_u32 s71, s71, s55
    s_add_u32 s72, s71, 7168
    v_bfe_u32 v217, v1, 1, 2
    v_lshl_add_u32 v217, v212, 2, v217
    s_add_u32 s57, s57, 27648
    buffer_load_dwordx4 v11, s[16:19], s57 offen offset:3072 lds
    v_and_b32 v218, 24, v1
    v_add_u32 v217, v217, v218
    v_mul_u32_u24 v15, 896, v217
    v_and_b32 v217, 1, v1
    s_add_u32 m0, s52, 147456
    s_add_u32 s57, s65, 6
    s_sub_u32 s3, s57, 13
    s_min_u32 s57, s57, s3
    s_mul_i32 s57, s57, 114688
    buffer_load_dwordx4 v10, s[16:19], s57 offen offset:0 lds
    v_lshl_add_u32 v15, v217, 4, v15
    v_add_u32 v15, s53, v15
    s_lshl_b32 s54, s89, 5
    s_add_u32 s54, s54, 768
    s_add_u32 s68, s89, 24
    s_mul_i32 s68, s68, 58624
    s_mul_i32 s69, s44, 14336
    s_add_u32 s69, s69, 2097152
    s_add_u32 s57, s57, 27648
    buffer_load_dwordx4 v11, s[16:19], s57 offen offset:1024 lds
    s_waitcnt vmcnt(10)
    ds_read_b64_tr_b16 a[48:49], v2 offset:49152
    ds_read_b64_tr_b16 a[50:51], v2 offset:49664
    ds_read_b64_tr_b16 a[52:53], v3 offset:49152
    ds_read_b64_tr_b16 a[54:55], v3 offset:49664
    s_add_u32 s57, s57, 27648
    buffer_load_dwordx4 v10, s[16:19], s57 offen offset:2048 lds
    ds_read_b64_tr_b16 a[56:57], v2 offset:49408
    ds_read_b64_tr_b16 a[58:59], v2 offset:49920
    ds_read_b64_tr_b16 a[60:61], v3 offset:49408
    ds_read_b64_tr_b16 a[62:63], v3 offset:49920
    s_add_u32 s57, s57, 27648
    buffer_load_dwordx4 v11, s[16:19], s57 offen offset:3072 lds
    s_add_u32 s68, s68, s69
    s_mul_i32 s55, s49, 234496
    s_add_u32 s69, s69, s55
    s_add_u32 s73, s73, s54
    s_mov_b32 s76, 0
    s_add_u32 s77, s76, 2048
    s_cmp_eq_u32 s77, 14336
    s_cselect_b32 s77, 0, s77
    s_add_u32 s78, s77, 2048
    s_cmp_eq_u32 s78, 14336
    s_cselect_b32 s78, 0, s78
    s_add_u32 s79, s78, 2048
    s_cmp_eq_u32 s79, 14336
    s_cselect_b32 s79, 0, s79
    s_add_u32 s80, s79, 2048
    s_cmp_eq_u32 s80, 14336
    s_cselect_b32 s80, 0, s80
    s_add_u32 s81, s80, 2048
    s_cmp_eq_u32 s81, 14336
    s_cselect_b32 s81, 0, s81
    s_add_u32 s82, s81, 2048
    s_cmp_eq_u32 s82, 14336
    s_cselect_b32 s82, 0, s82
    s_waitcnt lgkmcnt(15)
    s_add_u32 m0, s52, 49152
    s_add_u32 s57, s65, 7
    s_sub_u32 s3, s57, 13
    s_min_u32 s57, s57, s3
    s_mul_i32 s57, s57, 114688
    buffer_load_dwordx4 v10, s[16:19], s57 offen offset:0 lds
    s_cmp_lt_u32 s89, 4
    s_cselect_b32 s75, s54, 2130706432
    s_cselect_b32 s68, s68, 2130706432
    s_cselect_b32 s73, s73, 2130706432
    s_add_u32 s57, s57, 27648
    buffer_load_dwordx4 v11, s[16:19], s57 offen offset:1024 lds
    s_waitcnt vmcnt(10)
    ds_read_b64_tr_b16 a[64:65], v4 offset:0
    ds_read_b64_tr_b16 a[66:67], v4 offset:512
    ds_read_b64_tr_b16 a[68:69], v5 offset:0
    ds_read_b64_tr_b16 a[70:71], v5 offset:512
    s_add_u32 s57, s57, 27648
    buffer_load_dwordx4 v10, s[16:19], s57 offen offset:2048 lds
    ds_read_b64_tr_b16 a[72:73], v4 offset:256
    ds_read_b64_tr_b16 a[74:75], v4 offset:768
    ds_read_b64_tr_b16 a[76:77], v5 offset:256
    ds_read_b64_tr_b16 a[78:79], v5 offset:768
    v_lshlrev_b32 v16, 3, v1
    v_add_u32 v16, 81920, v16
    v_and_b32 v217, 7, v1
    v_min_u32 v218, 6, v217
    s_add_u32 s57, s57, 27648
    buffer_load_dwordx4 v11, s[16:19], s57 offen offset:3072 lds
    s_mul_i32 s54, s44, 7
    v_add_u32 v218, s54, v218
    v_mul_u32_u24 v219, 2, v218
    v_add_u32 v219, s89, v219
    s_add_u32 m0, s52, 65536
    s_add_u32 s57, s65, 8
    s_sub_u32 s3, s57, 13
    s_min_u32 s57, s57, s3
    s_mul_i32 s57, s57, 114688
    buffer_load_dwordx4 v10, s[16:19], s57 offen offset:0 lds
    v_mul_u32_u24 v220, 43, v219
    v_lshrrev_b32 v220, 8, v220
    v_mul_u32_u24 v220, 6, v220
    v_sub_u32 v219, v219, v220
    s_add_u32 s57, s57, 27648
    buffer_load_dwordx4 v11, s[16:19], s57 offen offset:1024 lds
    s_waitcnt vmcnt(10)
    ds_read_b64_tr_b16 a[80:81], v4 offset:16384
    ds_read_b64_tr_b16 a[82:83], v4 offset:16896
    ds_read_b64_tr_b16 a[84:85], v5 offset:16384
    ds_read_b64_tr_b16 a[86:87], v5 offset:16896
    v_subrev_u32 v219, s49, v219
    v_bfe_u32 v220, v1, 3, 1
    v_mul_i32_i24 v219, v219, v220
    v_add_u32 v219, s49, v219
    ds_read_b64_tr_b16 a[88:89], v4 offset:16640
    ds_read_b64_tr_b16 a[90:91], v4 offset:17152
    ds_read_b64_tr_b16 a[92:93], v5 offset:16640
    ds_read_b64_tr_b16 a[94:95], v5 offset:17152
    s_add_u32 s57, s57, 27648
    buffer_load_dwordx4 v10, s[16:19], s57 offen offset:2048 lds
    v_lshl_add_u32 v218, v219, 5, v218
    v_lshlrev_b32 v20, 7, v218
    v_add_u32 v20, 12713984, v20
    s_lshr_b32 s53, s48, 1
    s_add_u32 s57, s57, 27648
    buffer_load_dwordx4 v11, s[16:19], s57 offen offset:3072 lds
    s_lshl_b32 s53, s53, 7
    s_add_u32 s53, s53, 12779520
    v_lshl_add_u32 v21, v210, 11, s53
    s_lshl_b32 s70, s48, 16
    s_waitcnt lgkmcnt(15)
    s_add_u32 m0, s52, 81920
    s_add_u32 s57, s65, 9
    s_sub_u32 s3, s57, 13
    s_min_u32 s57, s57, s3
    s_mul_i32 s57, s57, 114688
    buffer_load_dwordx4 v10, s[16:19], s57 offen offset:0 lds
    s_lshl2_add_u32 s70, s52, s70
    s_add_u32 s70, s70, 4194304
    v_lshrrev_b32 v218, 3, v1
    v_mul_u32_u24 v22, 896, v218
    v_lshl_add_u32 v22, v217, 4, v22
    v_lshlrev_b32 v25, 1, v211
    s_add_u32 s53, s52, 65536
    v_lshl_add_u32 v244, v218, 8, s53
    s_add_u32 s57, s57, 27648
    buffer_load_dwordx4 v11, s[16:19], s57 offen offset:1024 lds
    s_waitcnt vmcnt(10)
    ds_read_b64_tr_b16 a[96:97], v4 offset:32768
    ds_read_b64_tr_b16 a[98:99], v4 offset:33280
    ds_read_b64_tr_b16 a[100:101], v5 offset:32768
    ds_read_b64_tr_b16 a[102:103], v5 offset:33280
    s_add_u32 s57, s57, 27648
    buffer_load_dwordx4 v10, s[16:19], s57 offen offset:2048 lds
    ds_read_b64_tr_b16 a[104:105], v4 offset:33024
    ds_read_b64_tr_b16 a[106:107], v4 offset:33536
    ds_read_b64_tr_b16 a[108:109], v5 offset:33024
    ds_read_b64_tr_b16 a[110:111], v5 offset:33536
    s_add_u32 s57, s57, 27648
    buffer_load_dwordx4 v11, s[16:19], s57 offen offset:3072 lds
    v_bfe_u32 v219, v218, 1, 1
    v_lshl_add_u32 v244, v219, 7, v244
    v_xor_b32 v219, v218, v217
    v_lshl_add_u32 v244, v219, 4, v244
    v_xor_b32 v245, 128, v244
    v_xor_b32 v218, v217, v212
    v_lshl_add_u32 v238, v218, 4, s53
    v_bfe_u32 v219, v1, 1, 1
    buffer_load_dwordx2 v[224:225], v19, s[32:35], 0 offen offset:0
    v_xor_b32 v219, v219, v215
    v_lshl_add_u32 v238, v219, 7, v238
    v_lshl_add_u32 v238, v211, 8, v238
    v_lshrrev_b32 v218, 2, v0
    buffer_load_dwordx2 v[226:227], v19, s[32:35], 0 offen offset:32
    s_waitcnt vmcnt(10)
    ds_read_b64_tr_b16 a[112:113], v2 offset:0
    ds_read_b64_tr_b16 a[114:115], v2 offset:512
    ds_read_b64_tr_b16 a[116:117], v3 offset:0
    ds_read_b64_tr_b16 a[118:119], v3 offset:512
    buffer_load_dwordx2 v[228:229], v19, s[32:35], 0 offen offset:64
    ds_read_b64_tr_b16 a[120:121], v2 offset:256
    ds_read_b64_tr_b16 a[122:123], v2 offset:768
    ds_read_b64_tr_b16 a[124:125], v3 offset:256
    ds_read_b64_tr_b16 a[126:127], v3 offset:768
    buffer_load_dwordx2 v[230:231], v19, s[32:35], 0 offen offset:96
    v_mul_u32_u24 v26, 896, v218
    v_lshl_add_u32 v26, v210, 3, v26
    s_add_u32 s53, s52, 52224
    v_lshrrev_b32 v218, 2, v1
    s_add_u32 m0, s52, 98304
    s_add_u32 s57, s65, 10
    s_sub_u32 s3, s57, 13
    s_min_u32 s57, s57, s3
    s_mul_i32 s57, s57, 114688
    buffer_load_dwordx4 v10, s[16:19], s57 offen offset:0 lds
    v_bfe_u32 v219, v218, 1, 2
    v_xor_b32 v219, v219, v210
    v_lshl_add_u32 v252, v218, 6, s53
    v_lshl_add_u32 v252, v219, 4, v252
    v_bfe_u32 v219, v1, 1, 2
    v_xor_b32 v219, v219, v208
    v_lshl_add_u32 v242, v211, 6, s53
    v_lshl_add_u32 v242, v219, 4, v242
    s_add_u32 s57, s57, 27648
    buffer_load_dwordx4 v11, s[16:19], s57 offen offset:1024 lds
    s_waitcnt vmcnt(10)
    ds_read_b64_tr_b16 a[128:129], v2 offset:16384
    ds_read_b64_tr_b16 a[130:131], v2 offset:16896
    ds_read_b64_tr_b16 a[132:133], v3 offset:16384
    ds_read_b64_tr_b16 a[134:135], v3 offset:16896
    s_add_u32 s57, s57, 27648
    buffer_load_dwordx4 v10, s[16:19], s57 offen offset:2048 lds
    ds_read_b64_tr_b16 a[136:137], v2 offset:16640
    ds_read_b64_tr_b16 a[138:139], v2 offset:17152
    ds_read_b64_tr_b16 a[140:141], v3 offset:16640
    ds_read_b64_tr_b16 a[142:143], v3 offset:17152
    s_add_u32 s57, s57, 27648
    buffer_load_dwordx4 v11, s[16:19], s57 offen offset:3072 lds
    s_sub_u32 s53, 49152, s52
    v_add_u32 v246, s53, v2
    v_add_u32 v247, s53, v3
    v_add_u32 v232, s52, v23
    v_xor_b32 v233, 4096, v232
    v_xor_b32 v234, 8192, v232
    v_xor_b32 v235, 12288, v232
    v_xor_b32 v239, 32, v238
    s_waitcnt lgkmcnt(15)
    s_add_u32 m0, s52, 114688
    s_add_u32 s57, s65, 11
    s_sub_u32 s3, s57, 13
    s_min_u32 s57, s57, s3
    s_mul_i32 s57, s57, 114688
    buffer_load_dwordx4 v10, s[16:19], s57 offen offset:0 lds
    v_xor_b32 v240, 64, v238
    v_xor_b32 v241, 96, v238
    s_add_u32 s57, s57, 27648
    buffer_load_dwordx4 v11, s[16:19], s57 offen offset:1024 lds
    s_waitcnt vmcnt(10)
    ds_read_b64_tr_b16 a[144:145], v2 offset:32768
    ds_read_b64_tr_b16 a[146:147], v2 offset:33280
    ds_read_b64_tr_b16 a[148:149], v3 offset:32768
    ds_read_b64_tr_b16 a[150:151], v3 offset:33280
    s_add_u32 s57, s57, 27648
    buffer_load_dwordx4 v10, s[16:19], s57 offen offset:2048 lds
    ds_read_b64_tr_b16 a[152:153], v2 offset:33024
    ds_read_b64_tr_b16 a[154:155], v2 offset:33536
    ds_read_b64_tr_b16 a[156:157], v3 offset:33024
    ds_read_b64_tr_b16 a[158:159], v3 offset:33536
    s_add_u32 s57, s57, 27648
    buffer_load_dwordx4 v11, s[16:19], s57 offen offset:3072 lds
    s_add_u32 m0, s52, 131072
    s_add_u32 s57, s65, 12
    s_sub_u32 s3, s57, 13
    s_min_u32 s57, s57, s3
    s_mul_i32 s57, s57, 114688
    buffer_load_dwordx4 v10, s[16:19], s57 offen offset:0 lds
    s_add_u32 s57, s57, 27648
    buffer_load_dwordx4 v11, s[16:19], s57 offen offset:1024 lds
    s_add_u32 s57, s57, 27648
    buffer_load_dwordx4 v10, s[16:19], s57 offen offset:2048 lds
    s_waitcnt vmcnt(11)
    v_lshlrev_b32 v32, 16, v224
    v_and_b32 v33, s61, v224
    v_lshlrev_b32 v34, 16, v225
    v_and_b32 v35, s61, v225
    v_lshlrev_b32 v36, 16, v226
    v_and_b32 v37, s61, v226
    v_lshlrev_b32 v38, 16, v227
    v_and_b32 v39, s61, v227
    s_add_u32 s57, s57, 27648
    buffer_load_dwordx4 v11, s[16:19], s57 offen offset:3072 lds
    v_lshlrev_b32 v40, 16, v228
    v_and_b32 v41, s61, v228
    v_lshlrev_b32 v42, 16, v229
    v_and_b32 v43, s61, v229
    buffer_load_dword v17, v18, s[24:27], 0 offen sc1
    v_lshlrev_b32 v44, 16, v230
    v_and_b32 v45, s61, v230
    v_lshlrev_b32 v46, 16, v231
    v_and_b32 v47, s61, v231
    v_mul_f32 v96, s85, v32
    v_mul_f32 v97, s85, v33
    v_mul_f32 v98, s85, v34
    v_mul_f32 v99, s85, v35
    s_add_u32 m0, s52, 147456
    s_mov_b32 s57, 1490944
    buffer_load_dwordx4 v10, s[16:19], s57 offen offset:0 lds
    s_waitcnt vmcnt(10)
    ds_read_b64_tr_b16 a[160:161], v2 offset:49152
    ds_read_b64_tr_b16 a[162:163], v2 offset:49664
    ds_read_b64_tr_b16 a[164:165], v3 offset:49152
    ds_read_b64_tr_b16 a[166:167], v3 offset:49664
    v_mul_f32 v100, s85, v36
    v_mul_f32 v101, s85, v37
    v_mul_f32 v102, s85, v38
    v_mul_f32 v103, s85, v39
    ds_read_b64_tr_b16 a[168:169], v2 offset:49408
    ds_read_b64_tr_b16 a[170:171], v2 offset:49920
    ds_read_b64_tr_b16 a[172:173], v3 offset:49408
    ds_read_b64_tr_b16 a[174:175], v3 offset:49920
    s_add_u32 s57, s57, 27648
    buffer_load_dwordx4 v11, s[16:19], s57 offen offset:1024 lds
    v_mul_f32 v104, s85, v40
    v_mul_f32 v105, s85, v41
    v_mul_f32 v106, s85, v42
    v_mul_f32 v107, s85, v43
    s_add_u32 s57, s57, 27648
    buffer_load_dwordx4 v10, s[16:19], s57 offen offset:2048 lds
    v_mul_f32 v108, s85, v44
    v_mul_f32 v109, s85, v45
    v_mul_f32 v110, s85, v46
    v_mul_f32 v111, s85, v47
    s_add_u32 s57, s57, 27648
    buffer_load_dwordx4 v11, s[16:19], s57 offen offset:3072 lds
    s_waitcnt lgkmcnt(15)
    s_add_u32 m0, s52, 49152
    s_mov_b32 s57, 1605632
    buffer_load_dwordx4 v10, s[16:19], s57 offen offset:0 lds
    s_waitcnt vmcnt(10)
    ds_read_b64_tr_b16 a[176:177], v4 offset:0
    ds_read_b64_tr_b16 a[178:179], v4 offset:512
    ds_read_b64_tr_b16 a[180:181], v5 offset:0
    ds_read_b64_tr_b16 a[182:183], v5 offset:512
    s_add_u32 s57, s57, 27648
    buffer_load_dwordx4 v11, s[16:19], s57 offen offset:1024 lds
    ds_read_b64_tr_b16 a[184:185], v4 offset:256
    ds_read_b64_tr_b16 a[186:187], v4 offset:768
    ds_read_b64_tr_b16 a[188:189], v5 offset:256
    ds_read_b64_tr_b16 a[190:191], v5 offset:768
    s_add_u32 s57, s57, 27648
    buffer_load_dwordx4 v10, s[16:19], s57 offen offset:2048 lds
    s_add_u32 s57, s57, 27648
    buffer_load_dwordx4 v11, s[16:19], s57 offen offset:3072 lds
    s_add_u32 m0, s52, 65536
    s_mov_b32 s57, 1720320
    buffer_load_dwordx4 v10, s[16:19], s57 offen offset:0 lds
    s_waitcnt vmcnt(10)
    ds_read_b64_tr_b16 a[192:193], v4 offset:16384
    ds_read_b64_tr_b16 a[194:195], v4 offset:16896
    ds_read_b64_tr_b16 a[196:197], v5 offset:16384
    ds_read_b64_tr_b16 a[198:199], v5 offset:16896
    s_add_u32 s57, s57, 27648
    buffer_load_dwordx4 v11, s[16:19], s57 offen offset:1024 lds
    ds_read_b64_tr_b16 a[200:201], v4 offset:16640
    ds_read_b64_tr_b16 a[202:203], v4 offset:17152
    ds_read_b64_tr_b16 a[204:205], v5 offset:16640
    ds_read_b64_tr_b16 a[206:207], v5 offset:17152
    s_add_u32 s57, s57, 27648
    buffer_load_dwordx4 v10, s[16:19], s57 offen offset:2048 lds
    s_waitcnt vmcnt(11)
    v_cmp_ne_u32 vcc, s47, v17
    s_nop 0
    s_cbranch_vccz L_ok5
    s_mov_b32 s59, 20000
L_spin4:
    buffer_load_dword v17, v18, s[24:27], 0 offen sc1
    s_waitcnt vmcnt(0)
    v_cmp_ne_u32 vcc, s47, v17
    s_nop 0
    s_cbranch_vccz L_ok5
    s_sub_u32 s59, s59, 1
    s_cbranch_scc0 L_spin4
L_ok5:
    s_cmp_ge_u32 s88, 4
    s_cbranch_scc1 L_p2_alt
    s_add_u32 s57, s57, 27648
    buffer_load_dwordx4 v11, s[16:19], s57 offen offset:3072 lds
    s_mov_b32 s66, s84
    s_lshl_b32 s86, s65, 10
    s_add_u32 s58, s86, s66
    s_add_u32 s86, s66, 13312
    buffer_load_dwordx4 v[112:115], v23, s[24:27], s58 offen offset:0 sc1
    s_add_u32 s58, s58, 1024
    s_cmp_eq_u32 s58, s86
    s_cselect_b32 s58, s66, s58
    buffer_load_dwordx4 v[116:119], v23, s[24:27], s58 offen offset:0 sc1
    s_waitcnt vmcnt(10)
    ds_read_b64_tr_b16 a[208:209], v4 offset:32768
    ds_read_b64_tr_b16 a[210:211], v4 offset:33280
    ds_read_b64_tr_b16 a[212:213], v5 offset:32768
    ds_read_b64_tr_b16 a[214:215], v5 offset:33280
    s_add_u32 s58, s58, 1024
    s_cmp_eq_u32 s58, s86
    s_cselect_b32 s58, s66, s58
    buffer_load_dwordx4 v[120:123], v23, s[24:27], s58 offen offset:0 sc1
    ds_read_b64_tr_b16 a[216:217], v4 offset:33024
    ds_read_b64_tr_b16 a[218:219], v4 offset:33536
    ds_read_b64_tr_b16 a[220:221], v5 offset:33024
    ds_read_b64_tr_b16 a[222:223], v5 offset:33536
    s_add_u32 s58, s58, 1024
    s_cmp_eq_u32 s58, s86
    s_cselect_b32 s58, s66, s58
    buffer_load_dwordx4 v[124:127], v23, s[24:27], s58 offen offset:0 sc1
    s_add_u32 s58, s58, 1024
    s_cmp_eq_u32 s58, s86
    s_cselect_b32 s58, s66, s58
    buffer_load_dwordx4 v[128:131], v23, s[24:27], s58 offen offset:0 sc1
    s_add_u32 s58, s58, 1024
    s_cmp_eq_u32 s58, s86
    s_cselect_b32 s58, s66, s58
    buffer_load_dwordx4 v[132:135], v23, s[24:27], s58 offen offset:0 sc1
    s_waitcnt vmcnt(10)
    ds_read_b64_tr_b16 a[224:225], v2 offset:0
    ds_read_b64_tr_b16 a[226:227], v2 offset:512
    ds_read_b64_tr_b16 a[228:229], v3 offset:0
    ds_read_b64_tr_b16 a[230:231], v3 offset:512
    s_add_u32 s58, s58, 1024
    s_cmp_eq_u32 s58, s86
    s_cselect_b32 s58, s66, s58
    buffer_load_dwordx4 v[136:139], v23, s[24:27], s58 offen offset:0 sc1
    ds_read_b64_tr_b16 a[232:233], v2 offset:256
    ds_read_b64_tr_b16 a[234:235], v2 offset:768
    ds_read_b64_tr_b16 a[236:237], v3 offset:256
    ds_read_b64_tr_b16 a[238:239], v3 offset:768
    s_add_u32 s58, s58, 1024
    s_cmp_eq_u32 s58, s86
    s_cselect_b32 s58, s66, s58
    buffer_load_dwordx4 v[140:143], v23, s[24:27], s58 offen offset:0 sc1
    s_add_u32 s58, s58, 1024
    s_cmp_eq_u32 s58, s86
    s_cselect_b32 s58, s66, s58
    buffer_load_dwordx4 v[144:147], v23, s[24:27], s58 offen offset:0 sc1
    s_add_u32 s58, s58, 1024
    s_cmp_eq_u32 s58, s86
    s_cselect_b32 s58, s66, s58
    buffer_load_dwordx4 v[148:151], v23, s[24:27], s58 offen offset:0 sc1
    s_waitcnt vmcnt(10)
    ds_read_b64_tr_b16 a[240:241], v2 offset:16384
    ds_read_b64_tr_b16 a[242:243], v2 offset:16896
    ds_read_b64_tr_b16 a[244:245], v3 offset:16384
    ds_read_b64_tr_b16 a[246:247], v3 offset:16896
    s_add_u32 s58, s58, 1024
    s_cmp_eq_u32 s58, s86
    s_cselect_b32 s58, s66, s58
    buffer_load_dwordx4 v[152:155], v23, s[24:27], s58 offen offset:0 sc1
    ds_read_b64_tr_b16 a[248:249], v2 offset:16640
    ds_read_b64_tr_b16 a[250:251], v2 offset:17152
    ds_read_b64_tr_b16 a[252:253], v3 offset:16640
    ds_read_b64_tr_b16 a[254:255], v3 offset:17152
    s_waitcnt vmcnt(10)
    v_mfma_f32_16x16x32_bf16 v[96:99], a[0:3], v[112:115], v[96:99]
    s_add_u32 s58, s58, 1024
    s_cmp_eq_u32 s58, s86
    s_cselect_b32 s58, s66, s58
    v_mfma_f32_16x16x32_bf16 v[100:103], a[4:7], v[112:115], v[100:103]
    buffer_load_dwordx4 v[156:159], v23, s[24:27], s58 offen offset:0 sc1
    v_mfma_f32_16x16x32_bf16 v[104:107], a[8:11], v[112:115], v[104:107]
    v_mfma_f32_16x16x32_bf16 v[108:111], a[12:15], v[112:115], v[108:111]
    s_waitcnt vmcnt(10)
    v_mfma_f32_16x16x32_bf16 v[96:99], a[16:19], v[116:119], v[96:99]
    s_add_u32 s58, s58, 1024
    s_cmp_eq_u32 s58, s86
    s_cselect_b32 s58, s66, s58
    v_mfma_f32_16x16x32_bf16 v[100:103], a[20:23], v[116:119], v[100:103]
    buffer_load_dwordx4 v[112:115], v23, s[24:27], s58 offen offset:0 sc1
    v_mfma_f32_16x16x32_bf16 v[104:107], a[24:27], v[116:119], v[104:107]
    v_mfma_f32_16x16x32_bf16 v[108:111], a[28:31], v[116:119], v[108:111]
    s_waitcnt vmcnt(10)
    v_mfma_f32_16x16x32_bf16 v[96:99], a[32:35], v[120:123], v[96:99]
    s_add_u32 s58, s66, 13312
    v_mfma_f32_16x16x32_bf16 v[100:103], a[36:39], v[120:123], v[100:103]
    buffer_load_dwordx4 v[116:119], v23, s[24:27], s58 offen offset:0 sc1
    v_mfma_f32_16x16x32_bf16 v[104:107], a[40:43], v[120:123], v[104:107]
    v_mfma_f32_16x16x32_bf16 v[108:111], a[44:47], v[120:123], v[108:111]
    s_waitcnt vmcnt(10)
    v_mfma_f32_16x16x32_bf16 v[96:99], a[48:51], v[124:127], v[96:99]
    s_add_u32 s58, s66, 14336
    v_mfma_f32_16x16x32_bf16 v[100:103], a[52:55], v[124:127], v[100:103]
    buffer_load_dwordx4 v[120:123], v23, s[24:27], s58 offen offset:0 sc1
    v_mfma_f32_16x16x32_bf16 v[104:107], a[56:59], v[124:127], v[104:107]
    v_mfma_f32_16x16x32_bf16 v[108:111], a[60:63], v[124:127], v[108:111]
    s_waitcnt vmcnt(10)
    v_mfma_f32_16x16x32_bf16 v[96:99], a[64:67], v[128:131], v[96:99]
    s_add_u32 s58, s66, 15360
    v_mfma_f32_16x16x32_bf16 v[100:103], a[68:71], v[128:131], v[100:103]
    buffer_load_dwordx4 v[124:127], v23, s[24:27], s58 offen offset:0 sc1
    v_mfma_f32_16x16x32_bf16 v[104:107], a[72:75], v[128:131], v[104:107]
    v_mfma_f32_16x16x32_bf16 v[108:111], a[76:79], v[128:131], v[108:111]
    s_waitcnt vmcnt(10)
    v_mfma_f32_16x16x32_bf16 v[96:99], a[80:83], v[132:135], v[96:99]
    s_xor_b32 s66, s44, 3
    s_lshl2_add_u32 s66, s51, s66
    s_mul_i32 s66, s66, 66816
    s_lshl2_add_u32 s66, s52, s66
    s_lshl_b32 s86, s65, 10
    s_add_u32 s58, s86, s66
    s_add_u32 s86, s66, 13312
    v_mfma_f32_16x16x32_bf16 v[100:103], a[84:87], v[132:135], v[100:103]
    buffer_load_dwordx4 v[128:131], v23, s[24:27], s58 offen offset:0 sc1
    v_mfma_f32_16x16x32_bf16 v[104:107], a[88:91], v[132:135], v[104:107]
    v_mfma_f32_16x16x32_bf16 v[108:111], a[92:95], v[132:135], v[108:111]
    s_waitcnt vmcnt(10)
    v_mfma_f32_16x16x32_bf16 v[96:99], a[96:99], v[136:139], v[96:99]
    s_add_u32 s58, s58, 1024
    s_cmp_eq_u32 s58, s86
    s_cselect_b32 s58, s66, s58
    v_mfma_f32_16x16x32_bf16 v[100:103], a[100:103], v[136:139], v[100:103]
    buffer_load_dwordx4 v[132:135], v23, s[24:27], s58 offen offset:0 sc1
    v_mfma_f32_16x16x32_bf16 v[104:107], a[104:107], v[136:139], v[104:107]
    v_mfma_f32_16x16x32_bf16 v[108:111], a[108:111], v[136:139], v[108:111]
    s_waitcnt vmcnt(10)
    v_mfma_f32_16x16x32_bf16 v[96:99], a[112:115], v[140:143], v[96:99]
    s_add_u32 s58, s58, 1024
    s_cmp_eq_u32 s58, s86
    s_cselect_b32 s58, s66, s58
    v_mfma_f32_16x16x32_bf16 v[100:103], a[116:119], v[140:143], v[100:103]
    buffer_load_dwordx4 v[136:139], v23, s[24:27], s58 offen offset:0 sc1
    v_mfma_f32_16x16x32_bf16 v[104:107], a[120:123], v[140:143], v[104:107]
    v_mfma_f32_16x16x32_bf16 v[108:111], a[124:127], v[140:143], v[108:111]
    s_waitcnt vmcnt(10)
    v_mfma_f32_16x16x32_bf16 v[96:99], a[128:131], v[144:147], v[96:99]
    s_add_u32 s58, s58, 1024
    s_cmp_eq_u32 s58, s86
    s_cselect_b32 s58, s66, s58
    v_mfma_f32_16x16x32_bf16 v[100:103], a[132:135], v[144:147], v[100:103]
    buffer_load_dwordx4 v[140:143], v23, s[24:27], s58 offen offset:0 sc1
    v_mfma_f32_16x16x32_bf16 v[104:107], a[136:139], v[144:147], v[104:107]
    v_mfma_f32_16x16x32_bf16 v[108:111], a[140:143], v[144:147], v[108:111]
    s_waitcnt vmcnt(10)
    s_waitcnt lgkmcnt(15)
    v_mfma_f32_16x16x32_bf16 v[96:99], a[144:147], v[148:151], v[96:99]
    s_add_u32 s58, s58, 1024
    s_cmp_eq_u32 s58, s86
    s_cselect_b32 s58, s66, s58
    v_mfma_f32_16x16x32_bf16 v[100:103], a[148:151], v[148:151], v[100:103]
    buffer_load_dwordx4 v[144:147], v23, s[24:27], s58 offen offset:0 sc1
    v_mfma_f32_16x16x32_bf16 v[104:107], a[152:155], v[148:151], v[104:107]
    v_mfma_f32_16x16x32_bf16 v[108:111], a[156:159], v[148:151], v[108:111]
    s_waitcnt vmcnt(10)
    v_mfma_f32_16x16x32_bf16 v[96:99], a[160:163], v[152:155], v[96:99]
    s_add_u32 s58, s58, 1024
    s_cmp_eq_u32 s58, s86
    s_cselect_b32 s58, s66, s58
    v_mfma_f32_16x16x32_bf16 v[100:103], a[164:167], v[152:155], v[100:103]
    buffer_load_dwordx4 v[148:151], v23, s[24:27], s58 offen offset:0 sc1
    v_mfma_f32_16x16x32_bf16 v[104:107], a[168:171], v[152:155], v[104:107]
    v_mfma_f32_16x16x32_bf16 v[108:111], a[172:175], v[152:155], v[108:111]
    s_waitcnt vmcnt(10)
    v_mfma_f32_16x16x32_bf16 v[96:99], a[176:179], v[156:159], v[96:99]
    s_add_u32 s58, s58, 1024
    s_cmp_eq_u32 s58, s86
    s_cselect_b32 s58, s66, s58
    v_mfma_f32_16x16x32_bf16 v[100:103], a[180:183], v[156:159], v[100:103]
    buffer_load_dwordx4 v[152:155], v23, s[24:27], s58 offen offset:0 sc1
    v_mfma_f32_16x16x32_bf16 v[104:107], a[184:187], v[156:159], v[104:107]
    v_mfma_f32_16x16x32_bf16 v[108:111], a[188:191], v[156:159], v[108:111]
    s_waitcnt vmcnt(10)
    v_mfma_f32_16x16x32_bf16 v[96:99], a[192:195], v[112:115], v[96:99]
    s_add_u32 s58, s58, 1024
    s_cmp_eq_u32 s58, s86
    s_cselect_b32 s58, s66, s58
    v_mfma_f32_16x16x32_bf16 v[100:103], a[196:199], v[112:115], v[100:103]
    buffer_load_dwordx4 v[156:159], v23, s[24:27], s58 offen offset:0 sc1
    v_mfma_f32_16x16x32_bf16 v[104:107], a[200:203], v[112:115], v[104:107]
    v_mfma_f32_16x16x32_bf16 v[108:111], a[204:207], v[112:115], v[108:111]
    s_waitcnt vmcnt(10)
    v_mfma_f32_16x16x32_bf16 v[96:99], a[208:211], v[116:119], v[96:99]
    s_add_u32 s58, s58, 1024
    s_cmp_eq_u32 s58, s86
    s_cselect_b32 s58, s66, s58
    v_mfma_f32_16x16x32_bf16 v[100:103], a[212:215], v[116:119], v[100:103]
    buffer_load_dwordx4 v[112:115], v23, s[24:27], s58 offen offset:0 sc1
    v_mfma_f32_16x16x32_bf16 v[104:107], a[216:219], v[116:119], v[104:107]
    v_mfma_f32_16x16x32_bf16 v[108:111], a[220:223], v[116:119], v[108:111]
    s_waitcnt vmcnt(10)
    s_waitcnt lgkmcnt(8)
    v_mfma_f32_16x16x32_bf16 v[96:99], a[224:227], v[120:123], v[96:99]
    s_add_u32 s58, s58, 1024
    s_cmp_eq_u32 s58, s86
    s_cselect_b32 s58, s66, s58
    v_mfma_f32_16x16x32_bf16 v[100:103], a[228:231], v[120:123], v[100:103]
    buffer_load_dwordx4 v[116:119], v23, s[24:27], s58 offen offset:0 sc1
    v_mfma_f32_16x16x32_bf16 v[104:107], a[232:235], v[120:123], v[104:107]
    v_mfma_f32_16x16x32_bf16 v[108:111], a[236:239], v[120:123], v[108:111]
    s_waitcnt vmcnt(10)
    s_waitcnt lgkmcnt(0)
    v_mfma_f32_16x16x32_bf16 v[96:99], a[240:243], v[124:127], v[96:99]
    s_add_u32 s58, s58, 1024
    s_cmp_eq_u32 s58, s86
    s_cselect_b32 s58, s66, s58
    v_mfma_f32_16x16x32_bf16 v[100:103], a[244:247], v[124:127], v[100:103]
    buffer_load_dwordx4 v[120:123], v23, s[24:27], s58 offen offset:0 sc1
    v_mfma_f32_16x16x32_bf16 v[104:107], a[248:251], v[124:127], v[104:107]
    v_mfma_f32_16x16x32_bf16 v[108:111], a[252:255], v[124:127], v[108:111]
L_p2_join:
    s_waitcnt vmcnt(10)
    v_mfma_f32_16x16x32_bf16 v[80:83], a[0:3], v[128:131], 0
    s_add_u32 s58, s58, 1024
    s_cmp_eq_u32 s58, s86
    s_cselect_b32 s58, s66, s58
    v_mfma_f32_16x16x32_bf16 v[84:87], a[4:7], v[128:131], 0
    buffer_load_dwordx4 v[124:127], v23, s[24:27], s58 offen offset:0 sc1
    v_mfma_f32_16x16x32_bf16 v[88:91], a[8:11], v[128:131], 0
    v_mfma_f32_16x16x32_bf16 v[92:95], a[12:15], v[128:131], 0
    s_waitcnt vmcnt(10)
    v_mfma_f32_16x16x32_bf16 v[80:83], a[16:19], v[132:135], v[80:83]
    s_add_u32 s58, s58, 1024
    s_cmp_eq_u32 s58, s86
    s_cselect_b32 s58, s66, s58
    v_mfma_f32_16x16x32_bf16 v[84:87], a[20:23], v[132:135], v[84:87]
    buffer_load_dwordx4 v[128:131], v23, s[24:27], s58 offen offset:0 sc1
    v_mfma_f32_16x16x32_bf16 v[88:91], a[24:27], v[132:135], v[88:91]
    ds_write_b128 v232, v[96:99] offset:49152
    v_mfma_f32_16x16x32_bf16 v[92:95], a[28:31], v[132:135], v[92:95]
    s_waitcnt vmcnt(10)
    v_mfma_f32_16x16x32_bf16 v[80:83], a[32:35], v[136:139], v[80:83]
    s_add_u32 s58, s66, 13312
    v_mfma_f32_16x16x32_bf16 v[84:87], a[36:39], v[136:139], v[84:87]
    buffer_load_dwordx4 v[132:135], v23, s[24:27], s58 offen offset:0 sc1
    v_mfma_f32_16x16x32_bf16 v[88:91], a[40:43], v[136:139], v[88:91]
    ds_write_b128 v232, v[100:103] offset:50176
    v_mfma_f32_16x16x32_bf16 v[92:95], a[44:47], v[136:139], v[92:95]
    s_waitcnt vmcnt(10)
    v_mfma_f32_16x16x32_bf16 v[80:83], a[48:51], v[140:143], v[80:83]
    s_add_u32 s58, s66, 14336
    v_mfma_f32_16x16x32_bf16 v[84:87], a[52:55], v[140:143], v[84:87]
    buffer_load_dwordx4 v[136:139], v23, s[24:27], s58 offen offset:0 sc1
    v_mfma_f32_16x16x32_bf16 v[88:91], a[56:59], v[140:143], v[88:91]
    ds_write_b128 v232, v[104:107] offset:51200
    v_mfma_f32_16x16x32_bf16 v[92:95], a[60:63], v[140:143], v[92:95]
    s_waitcnt vmcnt(10)
    v_mfma_f32_16x16x32_bf16 v[80:83], a[64:67], v[144:147], v[80:83]
    s_add_u32 s58, s66, 15360
    v_mfma_f32_16x16x32_bf16 v[84:87], a[68:71], v[144:147], v[84:87]
    buffer_load_dwordx4 v[140:143], v23, s[24:27], s58 offen offset:0 sc1
    v_mfma_f32_16x16x32_bf16 v[88:91], a[72:75], v[144:147], v[88:91]
    ds_write_b128 v232, v[108:111] offset:52224
    v_mfma_f32_16x16x32_bf16 v[92:95], a[76:79], v[144:147], v[92:95]
    s_waitcnt vmcnt(10)
    v_mfma_f32_16x16x32_bf16 v[80:83], a[80:83], v[148:151], v[80:83]
    s_xor_b32 s66, s44, 2
    s_lshl2_add_u32 s66, s51, s66
    s_mul_i32 s66, s66, 66816
    s_lshl2_add_u32 s66, s52, s66
    s_lshl_b32 s86, s65, 10
    s_add_u32 s58, s86, s66
    s_add_u32 s86, s66, 13312
    v_mfma_f32_16x16x32_bf16 v[84:87], a[84:87], v[148:151], v[84:87]
    buffer_load_dwordx4 v[144:147], v23, s[24:27], s58 offen offset:0 sc1
    v_mfma_f32_16x16x32_bf16 v[88:91], a[88:91], v[148:151], v[88:91]
    v_mfma_f32_16x16x32_bf16 v[92:95], a[92:95], v[148:151], v[92:95]
    s_waitcnt vmcnt(10)
    v_mfma_f32_16x16x32_bf16 v[80:83], a[96:99], v[152:155], v[80:83]
    s_add_u32 s58, s58, 1024
    s_cmp_eq_u32 s58, s86
    s_cselect_b32 s58, s66, s58
    v_mfma_f32_16x16x32_bf16 v[84:87], a[100:103], v[152:155], v[84:87]
    buffer_load_dwordx4 v[148:151], v23, s[24:27], s58 offen offset:0 sc1
    v_mfma_f32_16x16x32_bf16 v[88:91], a[104:107], v[152:155], v[88:91]
    v_mfma_f32_16x16x32_bf16 v[92:95], a[108:111], v[152:155], v[92:95]
    s_waitcnt vmcnt(10)
    v_mfma_f32_16x16x32_bf16 v[80:83], a[112:115], v[156:159], v[80:83]
    s_add_u32 s58, s58, 1024
    s_cmp_eq_u32 s58, s86
    s_cselect_b32 s58, s66, s58
    v_mfma_f32_16x16x32_bf16 v[84:87], a[116:119], v[156:159], v[84:87]
    buffer_load_dwordx4 v[152:155], v23, s[24:27], s58 offen offset:0 sc1
    v_mfma_f32_16x16x32_bf16 v[88:91], a[120:123], v[156:159], v[88:91]
    s_waitcnt lgkmcnt(0)
    s_barrier
    v_mfma_f32_16x16x32_bf16 v[92:95], a[124:127], v[156:159], v[92:95]
    s_waitcnt vmcnt(10)
    v_mfma_f32_16x16x32_bf16 v[80:83], a[128:131], v[112:115], v[80:83]
    s_add_u32 s58, s58, 1024
    s_cmp_eq_u32 s58, s86
    s_cselect_b32 s58, s66, s58
    v_mfma_f32_16x16x32_bf16 v[84:87], a[132:135], v[112:115], v[84:87]
    buffer_load_dwordx4 v[156:159], v23, s[24:27], s58 offen offset:0 sc1
    v_mfma_f32_16x16x32_bf16 v[88:91], a[136:139], v[112:115], v[88:91]
    ds_read_b128 v[160:163], v243 offset:0
    ds_read_b128 v[164:167], v243 offset:1024
    v_mfma_f32_16x16x32_bf16 v[92:95], a[140:143], v[112:115], v[92:95]
    ds_read_b128 v[168:171], v243 offset:4096
    s_waitcnt vmcnt(10)
    v_mfma_f32_16x16x32_bf16 v[80:83], a[144:147], v[116:119], v[80:83]
    s_add_u32 s58, s58, 1024
    s_cmp_eq_u32 s58, s86
    s_cselect_b32 s58, s66, s58
    v_mfma_f32_16x16x32_bf16 v[84:87], a[148:151], v[116:119], v[84:87]
    buffer_load_dwordx4 v[112:115], v23, s[24:27], s58 offen offset:0 sc1
    v_mfma_f32_16x16x32_bf16 v[88:91], a[152:155], v[116:119], v[88:91]
    ds_read_b128 v[172:175], v243 offset:5120
    ds_read_b128 v[176:179], v243 offset:8192
    v_mfma_f32_16x16x32_bf16 v[92:95], a[156:159], v[116:119], v[92:95]
    ds_read_b128 v[180:183], v243 offset:9216
    s_waitcnt vmcnt(10)
    v_mfma_f32_16x16x32_bf16 v[80:83], a[160:163], v[120:123], v[80:83]
    s_add_u32 s58, s58, 1024
    s_cmp_eq_u32 s58, s86
    s_cselect_b32 s58, s66, s58
    v_mfma_f32_16x16x32_bf16 v[84:87], a[164:167], v[120:123], v[84:87]
    buffer_load_dwordx4 v[116:119], v23, s[24:27], s58 offen offset:0 sc1
    v_mfma_f32_16x16x32_bf16 v[88:91], a[168:171], v[120:123], v[88:91]
    ds_read_b128 v[184:187], v243 offset:12288
    v_mfma_f32_16x16x32_bf16 v[92:95], a[172:175], v[120:123], v[92:95]
    ds_read_b128 v[188:191], v243 offset:13312
    s_waitcnt vmcnt(10)
    v_mfma_f32_16x16x32_bf16 v[80:83], a[176:179], v[124:127], v[80:83]
    s_add_u32 s58, s58, 1024
    s_cmp_eq_u32 s58, s86
    s_cselect_b32 s58, s66, s58
    v_mfma_f32_16x16x32_bf16 v[84:87], a[180:183], v[124:127], v[84:87]
    buffer_load_dwordx4 v[120:123], v23, s[24:27], s58 offen offset:0 sc1
    v_mfma_f32_16x16x32_bf16 v[88:91], a[184:187], v[124:127], v[88:91]
    v_mfma_f32_16x16x32_bf16 v[92:95], a[188:191], v[124:127], v[92:95]
    s_waitcnt vmcnt(10)
    v_mfma_f32_16x16x32_bf16 v[80:83], a[192:195], v[128:131], v[80:83]
    s_add_u32 s58, s58, 1024
    s_cmp_eq_u32 s58, s86
    s_cselect_b32 s58, s66, s58
    v_mfma_f32_16x16x32_bf16 v[84:87], a[196:199], v[128:131], v[84:87]
    buffer_load_dwordx4 v[124:127], v23, s[24:27], s58 offen offset:0 sc1
    v_mfma_f32_16x16x32_bf16 v[88:91], a[200:203], v[128:131], v[88:91]
    s_waitcnt lgkmcnt(0)
    v_add_f32 v160, v160, v168
    v_mfma_f32_16x16x32_bf16 v[92:95], a[204:207], v[128:131], v[92:95]
    v_add_f32 v161, v161, v169
    s_waitcnt vmcnt(10)
    v_mfma_f32_16x16x32_bf16 v[80:83], a[208:211], v[132:135], v[80:83]
    s_add_u32 s58, s58, 1024
    s_cmp_eq_u32 s58, s86
    s_cselect_b32 s58, s66, s58
    v_mfma_f32_16x16x32_bf16 v[84:87], a[212:215], v[132:135], v[84:87]
    buffer_load_dwordx4 v[128:131], v23, s[24:27], s58 offen offset:0 sc1
    v_mfma_f32_16x16x32_bf16 v[88:91], a[216:219], v[132:135], v[88:91]
    v_add_f32 v162, v162, v170
    v_add_f32 v163, v163, v171
    v_mfma_f32_16x16x32_bf16 v[92:95], a[220:223], v[132:135], v[92:95]
    v_add_f32 v164, v164, v172
    s_waitcnt vmcnt(10)
    v_mfma_f32_16x16x32_bf16 v[80:83], a[224:227], v[136:139], v[80:83]
    s_add_u32 s58, s58, 1024
    s_cmp_eq_u32 s58, s86
    s_cselect_b32 s58, s66, s58
    v_mfma_f32_16x16x32_bf16 v[84:87], a[228:231], v[136:139], v[84:87]
    buffer_load_dwordx4 v[132:135], v23, s[24:27], s58 offen offset:0 sc1
    v_mfma_f32_16x16x32_bf16 v[88:91], a[232:235], v[136:139], v[88:91]
    v_add_f32 v165, v165, v173
    v_add_f32 v166, v166, v174
    v_mfma_f32_16x16x32_bf16 v[92:95], a[236:239], v[136:139], v[92:95]
    v_add_f32 v167, v167, v175
    s_waitcnt vmcnt(10)
    v_mfma_f32_16x16x32_bf16 v[80:83], a[240:243], v[140:143], v[80:83]
    s_add_u32 s58, s58, 1024
    s_cmp_eq_u32 s58, s86
    s_cselect_b32 s58, s66, s58
    v_mfma_f32_16x16x32_bf16 v[84:87], a[244:247], v[140:143], v[84:87]
    buffer_load_dwordx4 v[136:139], v23, s[24:27], s58 offen offset:0 sc1
    v_mfma_f32_16x16x32_bf16 v[88:91], a[248:251], v[140:143], v[88:91]
    v_add_f32 v160, v160, v176
    v_add_f32 v161, v161, v177
    v_mfma_f32_16x16x32_bf16 v[92:95], a[252:255], v[140:143], v[92:95]
    v_add_f32 v162, v162, v178
    s_waitcnt vmcnt(10)
    v_mfma_f32_16x16x32_bf16 v[64:67], a[0:3], v[144:147], 0
    s_add_u32 s58, s58, 1024
    s_cmp_eq_u32 s58, s86
    s_cselect_b32 s58, s66, s58
    v_mfma_f32_16x16x32_bf16 v[68:71], a[4:7], v[144:147], 0
    buffer_load_dwordx4 v[140:143], v23, s[24:27], s58 offen offset:0 sc1
    v_mfma_f32_16x16x32_bf16 v[72:75], a[8:11], v[144:147], 0
    v_mfma_f32_16x16x32_bf16 v[76:79], a[12:15], v[144:147], 0
    s_waitcnt vmcnt(10)
    v_mfma_f32_16x16x32_bf16 v[64:67], a[16:19], v[148:151], v[64:67]
    s_add_u32 s58, s58, 1024
    s_cmp_eq_u32 s58, s86
    s_cselect_b32 s58, s66, s58
    v_mfma_f32_16x16x32_bf16 v[68:71], a[20:23], v[148:151], v[68:71]
    buffer_load_dwordx4 v[144:147], v23, s[24:27], s58 offen offset:0 sc1
    v_mfma_f32_16x16x32_bf16 v[72:75], a[24:27], v[148:151], v[72:75]
    ds_write_b128 v232, v[80:83] offset:32768
    v_mfma_f32_16x16x32_bf16 v[76:79], a[28:31], v[148:151], v[76:79]
    s_waitcnt vmcnt(10)
    v_mfma_f32_16x16x32_bf16 v[64:67], a[32:35], v[152:155], v[64:67]
    s_add_u32 s58, s66, 13312
    v_mfma_f32_16x16x32_bf16 v[68:71], a[36:39], v[152:155], v[68:71]
    buffer_load_dwordx4 v[148:151], v23, s[24:27], s58 offen offset:0 sc1
    v_mfma_f32_16x16x32_bf16 v[72:75], a[40:43], v[152:155], v[72:75]
    ds_write_b128 v232, v[84:87] offset:33792
    v_mfma_f32_16x16x32_bf16 v[76:79], a[44:47], v[152:155], v[76:79]
    s_waitcnt vmcnt(10)
    v_mfma_f32_16x16x32_bf16 v[64:67], a[48:51], v[156:159], v[64:67]
    s_add_u32 s58, s66, 14336
    ds_write_b128 v232, v[88:91] offset:34816
    v_mfma_f32_16x16x32_bf16 v[68:71], a[52:55], v[156:159], v[68:71]
    buffer_load_dwordx4 v[152:155], v23, s[24:27], s58 offen offset:0 sc1
    v_mfma_f32_16x16x32_bf16 v[72:75], a[56:59], v[156:159], v[72:75]
    v_add_f32 v163, v163, v179
    v_add_f32 v164, v164, v180
    v_mfma_f32_16x16x32_bf16 v[76:79], a[60:63], v[156:159], v[76:79]
    v_add_f32 v165, v165, v181
    s_waitcnt vmcnt(10)
    v_mfma_f32_16x16x32_bf16 v[64:67], a[64:67], v[112:115], v[64:67]
    s_add_u32 s58, s66, 15360
    ds_write_b128 v232, v[92:95] offset:35840
    v_mfma_f32_16x16x32_bf16 v[68:71], a[68:71], v[112:115], v[68:71]
    buffer_load_dwordx4 v[156:159], v23, s[24:27], s58 offen offset:0 sc1
    v_mfma_f32_16x16x32_bf16 v[72:75], a[72:75], v[112:115], v[72:75]
    v_add_f32 v166, v166, v182
    v_add_f32 v167, v167, v183
    v_mfma_f32_16x16x32_bf16 v[76:79], a[76:79], v[112:115], v[76:79]
    v_add_f32 v160, v160, v184
    s_waitcnt vmcnt(10)
    v_mfma_f32_16x16x32_bf16 v[64:67], a[80:83], v[116:119], v[64:67]
    s_xor_b32 s66, s44, 1
    s_lshl2_add_u32 s66, s51, s66
    s_mul_i32 s66, s66, 66816
    s_lshl2_add_u32 s66, s52, s66
    s_lshl_b32 s86, s65, 10
    s_add_u32 s58, s86, s66
    s_add_u32 s86, s66, 13312
    v_mfma_f32_16x16x32_bf16 v[68:71], a[84:87], v[116:119], v[68:71]
    buffer_load_dwordx4 v[112:115], v23, s[24:27], s58 offen offset:0 sc1
    v_mfma_f32_16x16x32_bf16 v[72:75], a[88:91], v[116:119], v[72:75]
    v_add_f32 v161, v161, v185
    v_add_f32 v162, v162, v186
    v_mfma_f32_16x16x32_bf16 v[76:79], a[92:95], v[116:119], v[76:79]
    v_add_f32 v163, v163, v187
    s_waitcnt vmcnt(10)
    v_mfma_f32_16x16x32_bf16 v[64:67], a[96:99], v[120:123], v[64:67]
    s_add_u32 s58, s58, 1024
    s_cmp_eq_u32 s58, s86
    s_cselect_b32 s58, s66, s58
    v_mfma_f32_16x16x32_bf16 v[68:71], a[100:103], v[120:123], v[68:71]
    buffer_load_dwordx4 v[116:119], v23, s[24:27], s58 offen offset:0 sc1
    v_mfma_f32_16x16x32_bf16 v[72:75], a[104:107], v[120:123], v[72:75]
    v_add_f32 v164, v164, v188
    v_add_f32 v165, v165, v189
    v_mfma_f32_16x16x32_bf16 v[76:79], a[108:111], v[120:123], v[76:79]
    v_add_f32 v166, v166, v190
    s_waitcnt vmcnt(10)
    v_mfma_f32_16x16x32_bf16 v[64:67], a[112:115], v[124:127], v[64:67]
    s_add_u32 s58, s58, 1024
    s_cmp_eq_u32 s58, s86
    s_cselect_b32 s58, s66, s58
    v_mfma_f32_16x16x32_bf16 v[68:71], a[116:119], v[124:127], v[68:71]
    buffer_load_dwordx4 v[120:123], v23, s[24:27], s58 offen offset:0 sc1
    v_mfma_f32_16x16x32_bf16 v[72:75], a[120:123], v[124:127], v[72:75]
    v_add_f32 v167, v167, v191
    v_mul_f32 v192, v160, v160
    v_mfma_f32_16x16x32_bf16 v[76:79], a[124:127], v[124:127], v[76:79]
    v_mul_f32 v193, v161, v161
    s_waitcnt vmcnt(10)
    v_mfma_f32_16x16x32_bf16 v[64:67], a[128:131], v[128:131], v[64:67]
    s_add_u32 s58, s58, 1024
    s_cmp_eq_u32 s58, s86
    s_cselect_b32 s58, s66, s58
    v_mfma_f32_16x16x32_bf16 v[68:71], a[132:135], v[128:131], v[68:71]
    buffer_load_dwordx4 v[124:127], v23, s[24:27], s58 offen offset:0 sc1
    v_mfma_f32_16x16x32_bf16 v[72:75], a[136:139], v[128:131], v[72:75]
    v_mul_f32 v194, v162, v162
    v_mul_f32 v195, v163, v163
    v_mfma_f32_16x16x32_bf16 v[76:79], a[140:143], v[128:131], v[76:79]
    v_mul_f32 v196, v164, v164
    s_waitcnt vmcnt(10)
    v_mfma_f32_16x16x32_bf16 v[64:67], a[144:147], v[132:135], v[64:67]
    s_add_u32 s58, s58, 1024
    s_cmp_eq_u32 s58, s86
    s_cselect_b32 s58, s66, s58
    v_mfma_f32_16x16x32_bf16 v[68:71], a[148:151], v[132:135], v[68:71]
    buffer_load_dwordx4 v[128:131], v23, s[24:27], s58 offen offset:0 sc1
    v_mfma_f32_16x16x32_bf16 v[72:75], a[152:155], v[132:135], v[72:75]
    v_mul_f32 v197, v165, v165
    v_mul_f32 v198, v166, v166
    v_mfma_f32_16x16x32_bf16 v[76:79], a[156:159], v[132:135], v[76:79]
    v_mul_f32 v199, v167, v167
    s_waitcnt vmcnt(10)
    v_mfma_f32_16x16x32_bf16 v[64:67], a[160:163], v[136:139], v[64:67]
    s_add_u32 s58, s58, 1024
    s_cmp_eq_u32 s58, s86
    s_cselect_b32 s58, s66, s58
    v_mfma_f32_16x16x32_bf16 v[68:71], a[164:167], v[136:139], v[68:71]
    buffer_load_dwordx4 v[132:135], v23, s[24:27], s58 offen offset:0 sc1
    v_mfma_f32_16x16x32_bf16 v[72:75], a[168:171], v[136:139], v[72:75]
    v_fma_f32 v192, v192, v236, v237
    v_fma_f32 v193, v193, v236, v237
    v_mfma_f32_16x16x32_bf16 v[76:79], a[172:175], v[136:139], v[76:79]
    v_fma_f32 v194, v194, v236, v237
    s_waitcnt vmcnt(10)
    v_mfma_f32_16x16x32_bf16 v[64:67], a[176:179], v[140:143], v[64:67]
    s_add_u32 s58, s58, 1024
    s_cmp_eq_u32 s58, s86
    s_cselect_b32 s58, s66, s58
    v_mfma_f32_16x16x32_bf16 v[68:71], a[180:183], v[140:143], v[68:71]
    buffer_load_dwordx4 v[136:139], v23, s[24:27], s58 offen offset:0 sc1
    v_mfma_f32_16x16x32_bf16 v[72:75], a[184:187], v[140:143], v[72:75]
    v_fma_f32 v195, v195, v236, v237
    v_fma_f32 v196, v196, v236, v237
    v_mfma_f32_16x16x32_bf16 v[76:79], a[188:191], v[140:143], v[76:79]
    v_fma_f32 v197, v197, v236, v237
    s_waitcnt vmcnt(10)
    v_mfma_f32_16x16x32_bf16 v[64:67], a[192:195], v[144:147], v[64:67]
    s_add_u32 s58, s58, 1024
    s_cmp_eq_u32 s58, s86
    s_cselect_b32 s58, s66, s58
    v_mfma_f32_16x16x32_bf16 v[68:71], a[196:199], v[144:147], v[68:71]
    buffer_load_dwordx4 v[140:143], v23, s[24:27], s58 offen offset:0 sc1
    v_mfma_f32_16x16x32_bf16 v[72:75], a[200:203], v[144:147], v[72:75]
    v_fma_f32 v198, v198, v236, v237
    v_fma_f32 v199, v199, v236, v237
    v_mfma_f32_16x16x32_bf16 v[76:79], a[204:207], v[144:147], v[76:79]
    v_mul_f32 v192, v192, v160
    s_waitcnt vmcnt(10)
    v_mfma_f32_16x16x32_bf16 v[64:67], a[208:211], v[148:151], v[64:67]
    s_add_u32 s58, s58, 1024
    s_cmp_eq_u32 s58, s86
    s_cselect_b32 s58, s66, s58
    v_mfma_f32_16x16x32_bf16 v[68:71], a[212:215], v[148:151], v[68:71]
    buffer_load_dwordx4 v[144:147], v23, s[24:27], s58 offen offset:0 sc1
    v_mfma_f32_16x16x32_bf16 v[72:75], a[216:219], v[148:151], v[72:75]
    v_mul_f32 v193, v193, v161
    v_mul_f32 v194, v194, v162
    v_mfma_f32_16x16x32_bf16 v[76:79], a[220:223], v[148:151], v[76:79]
    v_mul_f32 v195, v195, v163
    s_waitcnt vmcnt(10)
    v_mfma_f32_16x16x32_bf16 v[64:67], a[224:227], v[152:155], v[64:67]
    s_add_u32 s58, s58, 1024
    s_cmp_eq_u32 s58, s86
    s_cselect_b32 s58, s66, s58
    v_mfma_f32_16x16x32_bf16 v[68:71], a[228:231], v[152:155], v[68:71]
    buffer_load_dwordx4 v[148:151], v23, s[24:27], s58 offen offset:0 sc1
    v_mfma_f32_16x16x32_bf16 v[72:75], a[232:235], v[152:155], v[72:75]
    v_mul_f32 v196, v196, v164
    v_mul_f32 v197, v197, v165
    v_mfma_f32_16x16x32_bf16 v[76:79], a[236:239], v[152:155], v[76:79]
    v_mul_f32 v198, v198, v166
    s_waitcnt vmcnt(10)
    v_mfma_f32_16x16x32_bf16 v[64:67], a[240:243], v[156:159], v[64:67]
    s_add_u32 s58, s58, 1024
    s_cmp_eq_u32 s58, s86
    s_cselect_b32 s58, s66, s58
    v_mfma_f32_16x16x32_bf16 v[68:71], a[244:247], v[156:159], v[68:71]
    buffer_load_dwordx4 v[152:155], v23, s[24:27], s58 offen offset:0 sc1
    v_mfma_f32_16x16x32_bf16 v[72:75], a[248:251], v[156:159], v[72:75]
    v_mul_f32 v199, v199, v167
    v_mfma_f32_16x16x32_bf16 v[76:79], a[252:255], v[156:159], v[76:79]
    s_waitcnt vmcnt(10)
    v_mfma_f32_16x16x32_bf16 v[48:51], a[0:3], v[112:115], 0
    s_add_u32 s58, s58, 1024
    s_cmp_eq_u32 s58, s86
    s_cselect_b32 s58, s66, s58
    v_mfma_f32_16x16x32_bf16 v[52:55], a[4:7], v[112:115], 0
    buffer_load_dwordx4 v[156:159], v23, s[24:27], s58 offen offset:0 sc1
    v_mfma_f32_16x16x32_bf16 v[56:59], a[8:11], v[112:115], 0
    v_mfma_f32_16x16x32_bf16 v[60:63], a[12:15], v[112:115], 0
    s_waitcnt vmcnt(10)
    v_mfma_f32_16x16x32_bf16 v[48:51], a[16:19], v[116:119], v[48:51]
    s_add_u32 s58, s58, 1024
    s_cmp_eq_u32 s58, s86
    s_cselect_b32 s58, s66, s58
    v_mfma_f32_16x16x32_bf16 v[52:55], a[20:23], v[116:119], v[52:55]
    buffer_load_dwordx4 v[112:115], v23, s[24:27], s58 offen offset:0 sc1
    v_mfma_f32_16x16x32_bf16 v[56:59], a[24:27], v[116:119], v[56:59]
    ds_write_b128 v232, v[64:67] offset:16384
    v_mfma_f32_16x16x32_bf16 v[60:63], a[28:31], v[116:119], v[60:63]
    s_waitcnt vmcnt(10)
    v_mfma_f32_16x16x32_bf16 v[48:51], a[32:35], v[120:123], v[48:51]
    s_add_u32 s58, s66, 13312
    v_mfma_f32_16x16x32_bf16 v[52:55], a[36:39], v[120:123], v[52:55]
    buffer_load_dwordx4 v[116:119], v23, s[24:27], s58 offen offset:0 sc1
    v_mfma_f32_16x16x32_bf16 v[56:59], a[40:43], v[120:123], v[56:59]
    ds_write_b128 v232, v[68:71] offset:17408
    v_mfma_f32_16x16x32_bf16 v[60:63], a[44:47], v[120:123], v[60:63]
    s_waitcnt vmcnt(10)
    v_mfma_f32_16x16x32_bf16 v[48:51], a[48:51], v[124:127], v[48:51]
    s_add_u32 s58, s66, 14336
    ds_write_b128 v232, v[72:75] offset:18432
    v_mfma_f32_16x16x32_bf16 v[52:55], a[52:55], v[124:127], v[52:55]
    buffer_load_dwordx4 v[120:123], v23, s[24:27], s58 offen offset:0 sc1
    v_mfma_f32_16x16x32_bf16 v[56:59], a[56:59], v[124:127], v[56:59]
    v_exp_f32 v192, v192
    v_exp_f32 v193, v193
    v_mfma_f32_16x16x32_bf16 v[60:63], a[60:63], v[124:127], v[60:63]
    v_exp_f32 v194, v194
    s_waitcnt vmcnt(10)
    v_mfma_f32_16x16x32_bf16 v[48:51], a[64:67], v[128:131], v[48:51]
    s_add_u32 s58, s66, 15360
    ds_write_b128 v232, v[76:79] offset:19456
    v_mfma_f32_16x16x32_bf16 v[52:55], a[68:71], v[128:131], v[52:55]
    buffer_load_dwordx4 v[124:127], v23, s[24:27], s58 offen offset:0 sc1
    v_mfma_f32_16x16x32_bf16 v[56:59], a[72:75], v[128:131], v[56:59]
    v_exp_f32 v195, v195
    v_exp_f32 v196, v196
    v_mfma_f32_16x16x32_bf16 v[60:63], a[76:79], v[128:131], v[60:63]
    v_exp_f32 v197, v197
    s_waitcnt vmcnt(10)
    v_mfma_f32_16x16x32_bf16 v[48:51], a[80:83], v[132:135], v[48:51]
    s_xor_b32 s66, s44, 0
    s_lshl2_add_u32 s66, s51, s66
    s_mul_i32 s66, s66, 66816
    s_lshl2_add_u32 s66, s52, s66
    s_lshl_b32 s86, s65, 10
    s_add_u32 s58, s86, s66
    s_add_u32 s86, s66, 13312
    v_mfma_f32_16x16x32_bf16 v[52:55], a[84:87], v[132:135], v[52:55]
    buffer_load_dwordx4 v[128:131], v23, s[24:27], s58 offen offset:0 sc1
    v_mfma_f32_16x16x32_bf16 v[56:59], a[88:91], v[132:135], v[56:59]
    v_exp_f32 v198, v198
    v_exp_f32 v199, v199
    v_mfma_f32_16x16x32_bf16 v[60:63], a[92:95], v[132:135], v[60:63]
    v_add_f32 v192, 1.0, v192
    s_waitcnt vmcnt(10)
    v_mfma_f32_16x16x32_bf16 v[48:51], a[96:99], v[136:139], v[48:51]
    s_add_u32 s58, s58, 1024
    s_cmp_eq_u32 s58, s86
    s_cselect_b32 s58, s66, s58
    v_mfma_f32_16x16x32_bf16 v[52:55], a[100:103], v[136:139], v[52:55]
    buffer_load_dwordx4 v[132:135], v23, s[24:27], s58 offen offset:0 sc1
    v_mfma_f32_16x16x32_bf16 v[56:59], a[104:107], v[136:139], v[56:59]
    v_add_f32 v193, 1.0, v193
    v_add_f32 v194, 1.0, v194
    v_mfma_f32_16x16x32_bf16 v[60:63], a[108:111], v[136:139], v[60:63]
    v_add_f32 v195, 1.0, v195
    s_waitcnt vmcnt(10)
    v_mfma_f32_16x16x32_bf16 v[48:51], a[112:115], v[140:143], v[48:51]
    s_add_u32 s58, s58, 1024
    s_cmp_eq_u32 s58, s86
    s_cselect_b32 s58, s66, s58
    v_mfma_f32_16x16x32_bf16 v[52:55], a[116:119], v[140:143], v[52:55]
    buffer_load_dwordx4 v[136:139], v23, s[24:27], s58 offen offset:0 sc1
    v_mfma_f32_16x16x32_bf16 v[56:59], a[120:123], v[140:143], v[56:59]
    v_add_f32 v196, 1.0, v196
    v_add_f32 v197, 1.0, v197
    v_mfma_f32_16x16x32_bf16 v[60:63], a[124:127], v[140:143], v[60:63]
    v_add_f32 v198, 1.0, v198
    s_waitcnt vmcnt(10)
    v_mfma_f32_16x16x32_bf16 v[48:51], a[128:131], v[144:147], v[48:51]
    s_add_u32 s58, s58, 1024
    s_cmp_eq_u32 s58, s86
    s_cselect_b32 s58, s66, s58
    v_mfma_f32_16x16x32_bf16 v[52:55], a[132:135], v[144:147], v[52:55]
    buffer_load_dwordx4 v[140:143], v23, s[24:27], s58 offen offset:0 sc1
    v_mfma_f32_16x16x32_bf16 v[56:59], a[136:139], v[144:147], v[56:59]
    v_add_f32 v199, 1.0, v199
    v_rcp_f32 v192, v192
    v_mfma_f32_16x16x32_bf16 v[60:63], a[140:143], v[144:147], v[60:63]
    v_rcp_f32 v193, v193
    s_waitcnt vmcnt(10)
    v_mfma_f32_16x16x32_bf16 v[48:51], a[144:147], v[148:151], v[48:51]
    s_add_u32 s58, s58, 1024
    s_cmp_eq_u32 s58, s86
    s_cselect_b32 s58, s66, s58
    v_mfma_f32_16x16x32_bf16 v[52:55], a[148:151], v[148:151], v[52:55]
    buffer_load_dwordx4 v[144:147], v23, s[24:27], s58 offen offset:0 sc1
    v_mfma_f32_16x16x32_bf16 v[56:59], a[152:155], v[148:151], v[56:59]
    v_rcp_f32 v194, v194
    v_rcp_f32 v195, v195
    v_mfma_f32_16x16x32_bf16 v[60:63], a[156:159], v[148:151], v[60:63]
    v_rcp_f32 v196, v196
    s_waitcnt vmcnt(10)
    v_mfma_f32_16x16x32_bf16 v[48:51], a[160:163], v[152:155], v[48:51]
    s_add_u32 s58, s58, 1024
    s_cmp_eq_u32 s58, s86
    s_cselect_b32 s58, s66, s58
    v_mfma_f32_16x16x32_bf16 v[52:55], a[164:167], v[152:155], v[52:55]
    buffer_load_dwordx4 v[148:151], v23, s[24:27], s58 offen offset:0 sc1
    v_mfma_f32_16x16x32_bf16 v[56:59], a[168:171], v[152:155], v[56:59]
    v_rcp_f32 v197, v197
    v_rcp_f32 v198, v198
    v_mfma_f32_16x16x32_bf16 v[60:63], a[172:175], v[152:155], v[60:63]
    v_rcp_f32 v199, v199
    s_waitcnt vmcnt(10)
    v_mfma_f32_16x16x32_bf16 v[48:51], a[176:179], v[156:159], v[48:51]
    s_add_u32 s58, s58, 1024
    s_cmp_eq_u32 s58, s86
    s_cselect_b32 s58, s66, s58
    v_mfma_f32_16x16x32_bf16 v[52:55], a[180:183], v[156:159], v[52:55]
    buffer_load_dwordx4 v[152:155], v23, s[24:27], s58 offen offset:0 sc1
    v_mfma_f32_16x16x32_bf16 v[56:59], a[184:187], v[156:159], v[56:59]
    v_mul_f32 v192, v192, v160
    v_mul_f32 v193, v193, v161
    v_mfma_f32_16x16x32_bf16 v[60:63], a[188:191], v[156:159], v[60:63]
    v_mul_f32 v194, v194, v162
    s_waitcnt vmcnt(10)
    v_mfma_f32_16x16x32_bf16 v[48:51], a[192:195], v[112:115], v[48:51]
    s_add_u32 s58, s58, 1024
    s_cmp_eq_u32 s58, s86
    s_cselect_b32 s58, s66, s58
    v_mfma_f32_16x16x32_bf16 v[52:55], a[196:199], v[112:115], v[52:55]
    buffer_load_dwordx4 v[156:159], v23, s[24:27], s58 offen offset:0 sc1
    v_mfma_f32_16x16x32_bf16 v[56:59], a[200:203], v[112:115], v[56:59]
    v_mul_f32 v195, v195, v163
    v_mul_f32 v196, v196, v164
    v_mfma_f32_16x16x32_bf16 v[60:63], a[204:207], v[112:115], v[60:63]
    v_mul_f32 v197, v197, v165
    s_waitcnt vmcnt(10)
    v_mfma_f32_16x16x32_bf16 v[48:51], a[208:211], v[116:119], v[48:51]
    s_add_u32 s58, s58, 1024
    s_cmp_eq_u32 s58, s86
    s_cselect_b32 s58, s66, s58
    v_mfma_f32_16x16x32_bf16 v[52:55], a[212:215], v[116:119], v[52:55]
    buffer_load_dwordx4 v[112:115], v23, s[24:27], s58 offen offset:0 sc1
    v_mfma_f32_16x16x32_bf16 v[56:59], a[216:219], v[116:119], v[56:59]
    v_mul_f32 v198, v198, v166
    v_mul_f32 v199, v199, v167
    v_mfma_f32_16x16x32_bf16 v[60:63], a[220:223], v[116:119], v[60:63]
    v_cvt_pk_bf16_f32 v96, v192, v193
    s_waitcnt vmcnt(10)
    v_mfma_f32_16x16x32_bf16 v[48:51], a[224:227], v[120:123], v[48:51]
    s_add_u32 s58, s58, 1024
    s_cmp_eq_u32 s58, s86
    s_cselect_b32 s58, s66, s58
    v_mfma_f32_16x16x32_bf16 v[52:55], a[228:231], v[120:123], v[52:55]
    buffer_load_dwordx4 v[116:119], v23, s[24:27], s58 offen offset:0 sc1
    v_mfma_f32_16x16x32_bf16 v[56:59], a[232:235], v[120:123], v[56:59]
    v_cvt_pk_bf16_f32 v97, v194, v195
    v_cvt_pk_bf16_f32 v98, v196, v197
    v_mfma_f32_16x16x32_bf16 v[60:63], a[236:239], v[120:123], v[60:63]
    v_cvt_pk_bf16_f32 v99, v198, v199
    s_waitcnt vmcnt(10)
    v_mfma_f32_16x16x32_bf16 v[48:51], a[240:243], v[124:127], v[48:51]
    s_add_u32 s58, s58, 1024
    s_cmp_eq_u32 s58, s86
    s_cselect_b32 s58, s66, s58
    v_mfma_f32_16x16x32_bf16 v[52:55], a[244:247], v[124:127], v[52:55]
    buffer_load_dwordx4 v[120:123], v23, s[24:27], s58 offen offset:0 sc1
    v_mfma_f32_16x16x32_bf16 v[56:59], a[248:251], v[124:127], v[56:59]
    v_mfma_f32_16x16x32_bf16 v[60:63], a[252:255], v[124:127], v[60:63]
    s_waitcnt vmcnt(10)
    v_mfma_f32_16x16x32_bf16 v[32:35], a[0:3], v[128:131], v[32:35]
    s_add_u32 s58, s58, 1024
    s_cmp_eq_u32 s58, s86
    s_cselect_b32 s58, s66, s58
    v_mfma_f32_16x16x32_bf16 v[36:39], a[4:7], v[128:131], v[36:39]
    buffer_load_dwordx4 v[124:127], v23, s[24:27], s58 offen offset:0 sc1
    v_mfma_f32_16x16x32_bf16 v[40:43], a[8:11], v[128:131], v[40:43]
    v_mfma_f32_16x16x32_bf16 v[44:47], a[12:15], v[128:131], v[44:47]
    s_waitcnt vmcnt(10)
    v_mfma_f32_16x16x32_bf16 v[32:35], a[16:19], v[132:135], v[32:35]
    s_add_u32 s58, s58, 1024
    s_cmp_eq_u32 s58, s86
    s_cselect_b32 s58, s66, s58
    v_mfma_f32_16x16x32_bf16 v[36:39], a[20:23], v[132:135], v[36:39]
    buffer_load_dwordx4 v[128:131], v23, s[24:27], s58 offen offset:0 sc1
    v_mfma_f32_16x16x32_bf16 v[40:43], a[24:27], v[132:135], v[40:43]
    ds_write_b128 v232, v[48:51] offset:0
    v_mfma_f32_16x16x32_bf16 v[44:47], a[28:31], v[132:135], v[44:47]
    ds_write_b128 v232, v[52:55] offset:1024
    s_waitcnt vmcnt(10)
    v_mfma_f32_16x16x32_bf16 v[32:35], a[32:35], v[136:139], v[32:35]
    s_add_u32 s58, s66, 13312
    v_mfma_f32_16x16x32_bf16 v[36:39], a[36:39], v[136:139], v[36:39]
    buffer_load_dwordx4 v[132:135], v23, s[24:27], s58 offen offset:0 sc1
    v_mfma_f32_16x16x32_bf16 v[40:43], a[40:43], v[136:139], v[40:43]
    ds_write_b128 v232, v[56:59] offset:2048
    v_mfma_f32_16x16x32_bf16 v[44:47], a[44:47], v[136:139], v[44:47]
    ds_write_b128 v232, v[60:63] offset:3072
    s_waitcnt vmcnt(10)
    v_mfma_f32_16x16x32_bf16 v[32:35], a[48:51], v[140:143], v[32:35]
    s_add_u32 s58, s66, 14336
    v_mfma_f32_16x16x32_bf16 v[36:39], a[52:55], v[140:143], v[36:39]
    buffer_load_dwordx4 v[136:139], v23, s[24:27], s58 offen offset:0 sc1
    v_mfma_f32_16x16x32_bf16 v[40:43], a[56:59], v[140:143], v[40:43]
    v_mfma_f32_16x16x32_bf16 v[44:47], a[60:63], v[140:143], v[44:47]
    s_waitcnt vmcnt(10)
    v_mfma_f32_16x16x32_bf16 v[32:35], a[64:67], v[144:147], v[32:35]
    s_add_u32 s58, s66, 15360
    v_mfma_f32_16x16x32_bf16 v[36:39], a[68:71], v[144:147], v[36:39]
    buffer_load_dwordx4 v[140:143], v23, s[24:27], s58 offen offset:0 sc1
    v_mfma_f32_16x16x32_bf16 v[40:43], a[72:75], v[144:147], v[40:43]
    v_mfma_f32_16x16x32_bf16 v[44:47], a[76:79], v[144:147], v[44:47]
    buffer_load_dwordx4 v[216:219], v22, s[4:7], s71 offen
    s_waitcnt vmcnt(11)
    v_mfma_f32_16x16x32_bf16 v[32:35], a[80:83], v[148:151], v[32:35]
    s_waitcnt lgkmcnt(0)
    s_barrier
    v_mfma_f32_16x16x32_bf16 v[36:39], a[84:87], v[148:151], v[36:39]
    v_mfma_f32_16x16x32_bf16 v[40:43], a[88:91], v[148:151], v[40:43]
    v_mfma_f32_16x16x32_bf16 v[44:47], a[92:95], v[148:151], v[44:47]
    buffer_load_dwordx4 v[220:223], v22, s[4:7], s72 offen
    s_waitcnt vmcnt(11)
    v_mfma_f32_16x16x32_bf16 v[32:35], a[96:99], v[152:155], v[32:35]
    ds_read_b128 v[160:163], v233 offset:0
    v_mfma_f32_16x16x32_bf16 v[36:39], a[100:103], v[152:155], v[36:39]
    ds_read_b128 v[176:179], v234 offset:16384
    v_mfma_f32_16x16x32_bf16 v[40:43], a[104:107], v[152:155], v[40:43]
    ds_read_b128 v[192:195], v235 offset:32768
    v_mfma_f32_16x16x32_bf16 v[44:47], a[108:111], v[152:155], v[44:47]
    buffer_load_dwordx2 v[224:225], v26, s[4:7], s73 offen
    s_waitcnt vmcnt(11)
    v_mfma_f32_16x16x32_bf16 v[32:35], a[112:115], v[156:159], v[32:35]
    ds_read_b128 v[164:167], v233 offset:1024
    v_mfma_f32_16x16x32_bf16 v[36:39], a[116:119], v[156:159], v[36:39]
    ds_read_b128 v[180:183], v234 offset:17408
    v_mfma_f32_16x16x32_bf16 v[40:43], a[120:123], v[156:159], v[40:43]
    ds_read_b128 v[196:199], v235 offset:33792
    v_mfma_f32_16x16x32_bf16 v[44:47], a[124:127], v[156:159], v[44:47]
    buffer_load_ushort v228, v25, s[36:39], s74 offen
    s_waitcnt vmcnt(11)
    v_mfma_f32_16x16x32_bf16 v[32:35], a[128:131], v[112:115], v[32:35]
    ds_read_b128 v[168:171], v233 offset:2048
    v_mfma_f32_16x16x32_bf16 v[36:39], a[132:135], v[112:115], v[36:39]
    ds_read_b128 v[184:187], v234 offset:18432
    v_mfma_f32_16x16x32_bf16 v[40:43], a[136:139], v[112:115], v[40:43]
    ds_read_b128 v[200:203], v235 offset:34816
    v_mfma_f32_16x16x32_bf16 v[44:47], a[140:143], v[112:115], v[44:47]
    s_add_u32 m0, s52, 81920
    s_lshl_b32 s57, s76, 7
    buffer_load_dwordx4 v12, s[20:23], s57 offen offset:0 lds
    s_waitcnt vmcnt(11)
    v_mfma_f32_16x16x32_bf16 v[32:35], a[144:147], v[116:119], v[32:35]
    ds_read_b128 v[172:175], v233 offset:3072
    v_mfma_f32_16x16x32_bf16 v[36:39], a[148:151], v[116:119], v[36:39]
    ds_read_b128 v[188:191], v234 offset:19456
    v_mfma_f32_16x16x32_bf16 v[40:43], a[152:155], v[116:119], v[40:43]
    ds_read_b128 v[204:207], v235 offset:35840
    v_mfma_f32_16x16x32_bf16 v[44:47], a[156:159], v[116:119], v[44:47]
    s_add_u32 s57, s57, 31744
    buffer_load_dwordx4 v12, s[20:23], s57 offen offset:1024 lds
    s_waitcnt vmcnt(11)
    v_mfma_f32_16x16x32_bf16 v[32:35], a[160:163], v[120:123], v[32:35]
    v_mfma_f32_16x16x32_bf16 v[36:39], a[164:167], v[120:123], v[36:39]
    v_mfma_f32_16x16x32_bf16 v[40:43], a[168:171], v[120:123], v[40:43]
    v_mfma_f32_16x16x32_bf16 v[44:47], a[172:175], v[120:123], v[44:47]
    s_add_u32 s57, s57, 31744
    buffer_load_dwordx4 v12, s[20:23], s57 offen offset:2048 lds
    s_waitcnt vmcnt(11)
    v_mfma_f32_16x16x32_bf16 v[32:35], a[176:179], v[124:127], v[32:35]
    s_waitcnt lgkmcnt(9)
    v_mfma_f32_16x16x32_bf16 v[36:39], a[180:183], v[124:127], v[36:39]
    v_add_f32 v160, v160, v176
    v_mfma_f32_16x16x32_bf16 v[40:43], a[184:187], v[124:127], v[40:43]
    v_add_f32 v161, v161, v177
    v_mfma_f32_16x16x32_bf16 v[44:47], a[188:191], v[124:127], v[44:47]
    v_add_f32 v162, v162, v178
    s_add_u32 s57, s57, 31744
    buffer_load_dwordx4 v12, s[20:23], s57 offen offset:3072 lds
    s_waitcnt vmcnt(11)
    v_mfma_f32_16x16x32_bf16 v[32:35], a[192:195], v[128:131], v[32:35]
    v_add_f32 v163, v163, v179
    v_mfma_f32_16x16x32_bf16 v[36:39], a[196:199], v[128:131], v[36:39]
    s_waitcnt lgkmcnt(6)
    v_mfma_f32_16x16x32_bf16 v[40:43], a[200:203], v[128:131], v[40:43]
    v_add_f32 v164, v164, v180
    v_mfma_f32_16x16x32_bf16 v[44:47], a[204:207], v[128:131], v[44:47]
    v_add_f32 v165, v165, v181
    s_add_u32 m0, s52, 98304
    s_lshl_b32 s57, s76, 7
    s_add_u32 s57, s57, 131072
    buffer_load_dwordx4 v12, s[20:23], s57 offen offset:0 lds
    s_waitcnt vmcnt(11)
    v_mfma_f32_16x16x32_bf16 v[32:35], a[208:211], v[132:135], v[32:35]
    v_add_f32 v166, v166, v182
    v_mfma_f32_16x16x32_bf16 v[36:39], a[212:215], v[132:135], v[36:39]
    v_add_f32 v167, v167, v183
    v_mfma_f32_16x16x32_bf16 v[40:43], a[216:219], v[132:135], v[40:43]
    s_waitcnt lgkmcnt(3)
    v_mfma_f32_16x16x32_bf16 v[44:47], a[220:223], v[132:135], v[44:47]
    v_add_f32 v168, v168, v184
    s_add_u32 s57, s57, 31744
    buffer_load_dwordx4 v12, s[20:23], s57 offen offset:1024 lds
    s_waitcnt vmcnt(11)
    v_mfma_f32_16x16x32_bf16 v[32:35], a[224:227], v[136:139], v[32:35]
    v_add_f32 v169, v169, v185
    v_mfma_f32_16x16x32_bf16 v[36:39], a[228:231], v[136:139], v[36:39]
    v_add_f32 v170, v170, v186
    v_mfma_f32_16x16x32_bf16 v[40:43], a[232:235], v[136:139], v[40:43]
    v_add_f32 v171, v171, v187
    v_mfma_f32_16x16x32_bf16 v[44:47], a[236:239], v[136:139], v[44:47]
    s_waitcnt lgkmcnt(0)
    s_add_u32 s57, s57, 31744
    buffer_load_dwordx4 v12, s[20:23], s57 offen offset:2048 lds
    s_waitcnt vmcnt(11)
    v_mfma_f32_16x16x32_bf16 v[32:35], a[240:243], v[140:143], v[32:35]
    v_add_f32 v172, v172, v188
    v_mfma_f32_16x16x32_bf16 v[36:39], a[244:247], v[140:143], v[36:39]
    v_add_f32 v173, v173, v189
    v_mfma_f32_16x16x32_bf16 v[40:43], a[248:251], v[140:143], v[40:43]
    v_add_f32 v174, v174, v190
    v_mfma_f32_16x16x32_bf16 v[44:47], a[252:255], v[140:143], v[44:47]
    v_add_f32 v175, v175, v191
    v_pk_add_f32 v[160:161], v[160:161], v[192:193]
    v_pk_add_f32 v[162:163], v[162:163], v[194:195]
    v_pk_add_f32 v[164:165], v[164:165], v[196:197]
    v_pk_add_f32 v[166:167], v[166:167], v[198:199]
    v_pk_add_f32 v[168:169], v[168:169], v[200:201]
    v_pk_add_f32 v[170:171], v[170:171], v[202:203]
    v_pk_add_f32 v[172:173], v[172:173], v[204:205]
    v_pk_add_f32 v[174:175], v[174:175], v[206:207]
    buffer_store_dwordx4 v[96:99], v23, s[24:27], s83 offen sc1
    s_add_u32 s57, s57, 31744
    buffer_load_dwordx4 v12, s[20:23], s57 offen offset:3072 lds
    v_pk_add_f32 v[32:33], v[32:33], v[160:161]
    v_pk_add_f32 v[34:35], v[34:35], v[162:163]
    v_pk_add_f32 v[36:37], v[36:37], v[164:165]
    v_pk_add_f32 v[38:39], v[38:39], v[166:167]
    v_pk_mul_f32 v[48:49], v[32:33], v[32:33]
    v_pk_mul_f32 v[50:51], v[34:35], v[34:35]
    v_pk_mul_f32 v[52:53], v[36:37], v[36:37]
    v_pk_mul_f32 v[54:55], v[38:39], v[38:39]
    s_add_u32 m0, s52, 114688
    s_lshl_b32 s57, s77, 7
    buffer_load_dwordx4 v12, s[20:23], s57 offen offset:0 lds
    v_pk_fma_f32 v[48:49], v[48:49], v[236:237], v[236:237] op_sel:[0,0,1] op_sel_hi:[1,0,1]
    v_pk_fma_f32 v[50:51], v[50:51], v[236:237], v[236:237] op_sel:[0,0,1] op_sel_hi:[1,0,1]
    v_pk_fma_f32 v[52:53], v[52:53], v[236:237], v[236:237] op_sel:[0,0,1] op_sel_hi:[1,0,1]
    v_pk_fma_f32 v[54:55], v[54:55], v[236:237], v[236:237] op_sel:[0,0,1] op_sel_hi:[1,0,1]
    v_pk_mul_f32 v[48:49], v[48:49], v[32:33]
    v_pk_mul_f32 v[50:51], v[50:51], v[34:35]
    v_pk_mul_f32 v[52:53], v[52:53], v[36:37]
    v_pk_mul_f32 v[54:55], v[54:55], v[38:39]
    s_add_u32 s57, s57, 31744
    buffer_load_dwordx4 v12, s[20:23], s57 offen offset:1024 lds
    v_exp_f32 v48, v48
    v_exp_f32 v49, v49
    v_exp_f32 v50, v50
    v_exp_f32 v51, v51
    v_exp_f32 v52, v52
    v_exp_f32 v53, v53
    v_exp_f32 v54, v54
    v_exp_f32 v55, v55
    v_pk_add_f32 v[48:49], v[48:49], 1.0 op_sel_hi:[1,0]
    v_pk_add_f32 v[50:51], v[50:51], 1.0 op_sel_hi:[1,0]
    v_pk_add_f32 v[52:53], v[52:53], 1.0 op_sel_hi:[1,0]
    v_pk_add_f32 v[54:55], v[54:55], 1.0 op_sel_hi:[1,0]
    s_add_u32 s57, s57, 31744
    buffer_load_dwordx4 v12, s[20:23], s57 offen offset:2048 lds
    v_rcp_f32 v48, v48
    v_rcp_f32 v49, v49
    v_rcp_f32 v50, v50
    v_rcp_f32 v51, v51
    v_rcp_f32 v52, v52
    v_rcp_f32 v53, v53
    v_rcp_f32 v54, v54
    v_rcp_f32 v55, v55
    s_add_u32 s57, s57, 31744
    buffer_load_dwordx4 v12, s[20:23], s57 offen offset:3072 lds
    v_pk_mul_f32 v[48:49], v[48:49], v[32:33]
    v_pk_mul_f32 v[50:51], v[50:51], v[34:35]
    v_pk_mul_f32 v[52:53], v[52:53], v[36:37]
    v_pk_mul_f32 v[54:55], v[54:55], v[38:39]
    v_cvt_pk_bf16_f32 v56, v48, v49
    v_cvt_pk_bf16_f32 v57, v50, v51
    v_cvt_pk_bf16_f32 v58, v52, v53
    v_cvt_pk_bf16_f32 v59, v54, v55
    buffer_store_dwordx4 v[56:59], v23, s[24:27], s67 offen offset:0 sc1
    v_pk_add_f32 v[40:41], v[40:41], v[168:169]
    v_pk_add_f32 v[42:43], v[42:43], v[170:171]
    v_pk_add_f32 v[44:45], v[44:45], v[172:173]
    v_pk_add_f32 v[46:47], v[46:47], v[174:175]
    s_add_u32 m0, s52, 131072
    s_lshl_b32 s57, s77, 7
    s_add_u32 s57, s57, 131072
    buffer_load_dwordx4 v12, s[20:23], s57 offen offset:0 lds
    v_pk_mul_f32 v[48:49], v[40:41], v[40:41]
    v_pk_mul_f32 v[50:51], v[42:43], v[42:43]
    v_pk_mul_f32 v[52:53], v[44:45], v[44:45]
    v_pk_mul_f32 v[54:55], v[46:47], v[46:47]
    v_pk_fma_f32 v[48:49], v[48:49], v[236:237], v[236:237] op_sel:[0,0,1] op_sel_hi:[1,0,1]
    v_pk_fma_f32 v[50:51], v[50:51], v[236:237], v[236:237] op_sel:[0,0,1] op_sel_hi:[1,0,1]
    v_pk_fma_f32 v[52:53], v[52:53], v[236:237], v[236:237] op_sel:[0,0,1] op_sel_hi:[1,0,1]
    v_pk_fma_f32 v[54:55], v[54:55], v[236:237], v[236:237] op_sel:[0,0,1] op_sel_hi:[1,0,1]
    s_add_u32 s57, s57, 31744
    buffer_load_dwordx4 v12, s[20:23], s57 offen offset:1024 lds
    s_waitcnt vmcnt(12)
    ds_read_b64_tr_b16 a[0:1], v6 offset:32768
    ds_read_b64_tr_b16 a[2:3], v6 offset:34816
    ds_read_b64_tr_b16 a[4:5], v7 offset:32768
    ds_read_b64_tr_b16 a[6:7], v7 offset:34816
    v_pk_mul_f32 v[48:49], v[48:49], v[40:41]
    v_pk_mul_f32 v[50:51], v[50:51], v[42:43]
    v_pk_mul_f32 v[52:53], v[52:53], v[44:45]
    v_pk_mul_f32 v[54:55], v[54:55], v[46:47]
    ds_read_b64_tr_b16 a[8:9], v6 offset:33024
    ds_read_b64_tr_b16 a[10:11], v6 offset:35072
    ds_read_b64_tr_b16 a[12:13], v7 offset:33024
    ds_read_b64_tr_b16 a[14:15], v7 offset:35072
    s_add_u32 s57, s57, 31744
    buffer_load_dwordx4 v12, s[20:23], s57 offen offset:2048 lds
    v_exp_f32 v48, v48
    v_exp_f32 v49, v49
    v_exp_f32 v50, v50
    v_exp_f32 v51, v51
    v_exp_f32 v52, v52
    v_exp_f32 v53, v53
    v_exp_f32 v54, v54
    v_exp_f32 v55, v55
    s_add_u32 s57, s57, 31744
    buffer_load_dwordx4 v12, s[20:23], s57 offen offset:3072 lds
    v_pk_add_f32 v[48:49], v[48:49], 1.0 op_sel_hi:[1,0]
    v_pk_add_f32 v[50:51], v[50:51], 1.0 op_sel_hi:[1,0]
    v_pk_add_f32 v[52:53], v[52:53], 1.0 op_sel_hi:[1,0]
    v_pk_add_f32 v[54:55], v[54:55], 1.0 op_sel_hi:[1,0]
    v_rcp_f32 v48, v48
    v_rcp_f32 v49, v49
    v_rcp_f32 v50, v50
    v_rcp_f32 v51, v51
    v_rcp_f32 v52, v52
    v_rcp_f32 v53, v53
    v_rcp_f32 v54, v54
    v_rcp_f32 v55, v55
    s_add_u32 m0, s52, 147456
    s_lshl_b32 s57, s78, 7
    buffer_load_dwordx4 v12, s[20:23], s57 offen offset:0 lds
    v_pk_mul_f32 v[48:49], v[48:49], v[40:41]
    v_pk_mul_f32 v[50:51], v[50:51], v[42:43]
    v_pk_mul_f32 v[52:53], v[52:53], v[44:45]
    v_pk_mul_f32 v[54:55], v[54:55], v[46:47]
    v_cvt_pk_bf16_f32 v60, v48, v49
    v_cvt_pk_bf16_f32 v61, v50, v51
    v_cvt_pk_bf16_f32 v62, v52, v53
    v_cvt_pk_bf16_f32 v63, v54, v55
    buffer_store_dwordx4 v[60:63], v23, s[24:27], s67 offen offset:1024 sc1
    s_add_u32 s57, s57, 31744
    buffer_load_dwordx4 v12, s[20:23], s57 offen offset:1024 lds
    s_waitcnt vmcnt(12)
    ds_read_b64_tr_b16 a[16:17], v6 offset:49152
    ds_read_b64_tr_b16 a[18:19], v6 offset:51200
    ds_read_b64_tr_b16 a[20:21], v7 offset:49152
    ds_read_b64_tr_b16 a[22:23], v7 offset:51200
    ds_read_b64_tr_b16 a[24:25], v6 offset:49408
    ds_read_b64_tr_b16 a[26:27], v6 offset:51456
    ds_read_b64_tr_b16 a[28:29], v7 offset:49408
    ds_read_b64_tr_b16 a[30:31], v7 offset:51456
    s_add_u32 s57, s57, 31744
    buffer_load_dwordx4 v12, s[20:23], s57 offen offset:2048 lds
    s_add_u32 s57, s57, 31744
    buffer_load_dwordx4 v12, s[20:23], s57 offen offset:3072 lds
    s_add_u32 m0, s52, 49152
    s_lshl_b32 s57, s78, 7
    s_add_u32 s57, s57, 131072
    buffer_load_dwordx4 v12, s[20:23], s57 offen offset:0 lds
    s_add_u32 s57, s57, 31744
    buffer_load_dwordx4 v12, s[20:23], s57 offen offset:1024 lds
    s_waitcnt vmcnt(12)
    ds_read_b64_tr_b16 a[32:33], v8 offset:0
    ds_read_b64_tr_b16 a[34:35], v8 offset:2048
    ds_read_b64_tr_b16 a[36:37], v9 offset:0
    ds_read_b64_tr_b16 a[38:39], v9 offset:2048
    s_add_u32 s57, s57, 31744
    buffer_load_dwordx4 v12, s[20:23], s57 offen offset:2048 lds
    ds_read_b64_tr_b16 a[40:41], v8 offset:256
    ds_read_b64_tr_b16 a[42:43], v8 offset:2304
    ds_read_b64_tr_b16 a[44:45], v9 offset:256
    ds_read_b64_tr_b16 a[46:47], v9 offset:2304
    s_add_u32 s57, s57, 31744
    buffer_load_dwordx4 v12, s[20:23], s57 offen offset:3072 lds
    s_add_u32 m0, s52, 65536
    s_lshl_b32 s57, s79, 7
    buffer_load_dwordx4 v12, s[20:23], s57 offen offset:0 lds
    s_add_u32 s57, s57, 31744
    buffer_load_dwordx4 v12, s[20:23], s57 offen offset:1024 lds
    s_waitcnt vmcnt(11)
    ds_read_b64_tr_b16 a[48:49], v8 offset:16384
    ds_read_b64_tr_b16 a[50:51], v8 offset:18432
    ds_read_b64_tr_b16 a[52:53], v9 offset:16384
    ds_read_b64_tr_b16 a[54:55], v9 offset:18432
    s_add_u32 s57, s57, 31744
    buffer_load_dwordx4 v12, s[20:23], s57 offen offset:2048 lds
    ds_read_b64_tr_b16 a[56:57], v8 offset:16640
    ds_read_b64_tr_b16 a[58:59], v8 offset:18688
    ds_read_b64_tr_b16 a[60:61], v9 offset:16640
    ds_read_b64_tr_b16 a[62:63], v9 offset:18688
    s_add_u32 s57, s57, 31744
    buffer_load_dwordx4 v12, s[20:23], s57 offen offset:3072 lds
    s_waitcnt vmcnt(11)
    s_barrier
    s_cmp_lg_u32 s44, 0
    s_cbranch_scc1 L_nopub6
    s_lshl_b32 s60, s51, 5
    s_add_u32 s60, s60, s50
    s_lshl_b32 s60, s60, 7
    s_add_u32 s60, s60, 12713984
    v_mov_b32 v30, s47
    s_mov_b64 exec, 1
    buffer_store_dword v30, off, s[24:27], s60 sc1
    s_mov_b64 exec, -1
L_nopub6:
L_p3join:
    v_lshlrev_b32 v176, 16, v216
    v_and_b32 v177, s61, v216
    v_lshlrev_b32 v178, 16, v217
    v_and_b32 v179, s61, v217
    s_waitcnt lgkmcnt(15)
    s_add_u32 m0, s52, 81920
    s_lshl_b32 s57, s79, 7
    s_add_u32 s57, s57, 131072
    buffer_load_dwordx4 v12, s[20:23], s57 offen offset:0 lds
    v_lshlrev_b32 v180, 16, v218
    v_and_b32 v181, s61, v218
    v_lshlrev_b32 v182, 16, v219
    v_and_b32 v183, s61, v219
    s_add_u32 s57, s57, 31744
    buffer_load_dwordx4 v12, s[20:23], s57 offen offset:1024 lds
    s_waitcnt vmcnt(10)
    ds_read_b64_tr_b16 a[64:65], v8 offset:32768
    ds_read_b64_tr_b16 a[66:67], v8 offset:34816
    ds_read_b64_tr_b16 a[68:69], v9 offset:32768
    ds_read_b64_tr_b16 a[70:71], v9 offset:34816
    s_add_u32 s57, s57, 31744
    buffer_load_dwordx4 v12, s[20:23], s57 offen offset:2048 lds
    ds_read_b64_tr_b16 a[72:73], v8 offset:33024
    ds_read_b64_tr_b16 a[74:75], v8 offset:35072
    ds_read_b64_tr_b16 a[76:77], v9 offset:33024
    ds_read_b64_tr_b16 a[78:79], v9 offset:35072
    v_lshlrev_b32 v184, 16, v220
    v_and_b32 v185, s61, v220
    v_lshlrev_b32 v186, 16, v221
    v_and_b32 v187, s61, v221
    s_add_u32 s57, s57, 31744
    buffer_load_dwordx4 v12, s[20:23], s57 offen offset:3072 lds
    v_lshlrev_b32 v188, 16, v222
    v_and_b32 v189, s61, v222
    v_lshlrev_b32 v190, 16, v223
    v_and_b32 v191, s61, v223
    s_add_u32 m0, s52, 98304
    s_lshl_b32 s57, s80, 7
    buffer_load_dwordx4 v12, s[20:23], s57 offen offset:0 lds
    v_lshlrev_b32 v248, 16, v224
    v_and_b32 v249, s61, v224
    v_lshlrev_b32 v250, 16, v225
    v_and_b32 v251, s61, v225
    s_add_u32 s57, s57, 31744
    buffer_load_dwordx4 v12, s[20:23], s57 offen offset:1024 lds
    s_waitcnt vmcnt(10)
    ds_read_b64_tr_b16 a[80:81], v6 offset:0
    ds_read_b64_tr_b16 a[82:83], v6 offset:2048
    ds_read_b64_tr_b16 a[84:85], v7 offset:0
    ds_read_b64_tr_b16 a[86:87], v7 offset:2048
    v_lshlrev_b32 v231, 16, v228
    v_lshlrev_b32 v230, 16, v228
    v_lshlrev_b32 v229, 16, v228
    v_lshlrev_b32 v228, 16, v228
    ds_read_b64_tr_b16 a[88:89], v6 offset:256
    ds_read_b64_tr_b16 a[90:91], v6 offset:2304
    ds_read_b64_tr_b16 a[92:93], v7 offset:256
    ds_read_b64_tr_b16 a[94:95], v7 offset:2304
    s_add_u32 s57, s57, 31744
    buffer_load_dwordx4 v12, s[20:23], s57 offen offset:2048 lds
    s_add_u32 s57, s57, 31744
    buffer_load_dwordx4 v12, s[20:23], s57 offen offset:3072 lds
    s_waitcnt lgkmcnt(15)
    s_add_u32 m0, s52, 114688
    s_lshl_b32 s57, s80, 7
    s_add_u32 s57, s57, 131072
    buffer_load_dwordx4 v12, s[20:23], s57 offen offset:0 lds
    s_add_u32 s57, s57, 31744
    buffer_load_dwordx4 v12, s[20:23], s57 offen offset:1024 lds
    s_waitcnt vmcnt(10)
    ds_read_b64_tr_b16 a[96:97], v6 offset:16384
    ds_read_b64_tr_b16 a[98:99], v6 offset:18432
    ds_read_b64_tr_b16 a[100:101], v7 offset:16384
    ds_read_b64_tr_b16 a[102:103], v7 offset:18432
    s_add_u32 s57, s57, 31744
    buffer_load_dwordx4 v12, s[20:23], s57 offen offset:2048 lds
    ds_read_b64_tr_b16 a[104:105], v6 offset:16640
    ds_read_b64_tr_b16 a[106:107], v6 offset:18688
    ds_read_b64_tr_b16 a[108:109], v7 offset:16640
    ds_read_b64_tr_b16 a[110:111], v7 offset:18688
    s_add_u32 s57, s57, 31744
    buffer_load_dwordx4 v12, s[20:23], s57 offen offset:3072 lds
    s_add_u32 m0, s52, 131072
    s_lshl_b32 s57, s81, 7
    buffer_load_dwordx4 v12, s[20:23], s57 offen offset:0 lds
    s_add_u32 s57, s57, 31744
    buffer_load_dwordx4 v12, s[20:23], s57 offen offset:1024 lds
    s_waitcnt vmcnt(10)
    ds_read_b64_tr_b16 a[112:113], v6 offset:32768
    ds_read_b64_tr_b16 a[114:115], v6 offset:34816
    ds_read_b64_tr_b16 a[116:117], v7 offset:32768
    ds_read_b64_tr_b16 a[118:119], v7 offset:34816
    s_add_u32 s57, s57, 31744
    buffer_load_dwordx4 v12, s[20:23], s57 offen offset:2048 lds
    ds_read_b64_tr_b16 a[120:121], v6 offset:33024
    ds_read_b64_tr_b16 a[122:123], v6 offset:35072
    ds_read_b64_tr_b16 a[124:125], v7 offset:33024
    ds_read_b64_tr_b16 a[126:127], v7 offset:35072
    s_add_u32 s57, s57, 31744
    buffer_load_dwordx4 v12, s[20:23], s57 offen offset:3072 lds
    s_waitcnt lgkmcnt(15)
    s_add_u32 m0, s52, 147456
    s_lshl_b32 s57, s81, 7
    s_add_u32 s57, s57, 131072
    buffer_load_dwordx4 v12, s[20:23], s57 offen offset:0 lds
    s_add_u32 s57, s57, 31744
    buffer_load_dwordx4 v12, s[20:23], s57 offen offset:1024 lds
    s_waitcnt vmcnt(10)
    ds_read_b64_tr_b16 a[128:129], v6 offset:49152
    ds_read_b64_tr_b16 a[130:131], v6 offset:51200
    ds_read_b64_tr_b16 a[132:133], v7 offset:49152
    ds_read_b64_tr_b16 a[134:135], v7 offset:51200
    s_add_u32 s57, s57, 31744
    buffer_load_dwordx4 v12, s[20:23], s57 offen offset:2048 lds
    ds_read_b64_tr_b16 a[136:137], v6 offset:49408
    ds_read_b64_tr_b16 a[138:139], v6 offset:51456
    ds_read_b64_tr_b16 a[140:141], v7 offset:49408
    ds_read_b64_tr_b16 a[142:143], v7 offset:51456
    s_add_u32 s57, s57, 31744
    buffer_load_dwordx4 v12, s[20:23], s57 offen offset:3072 lds
    s_add_u32 m0, s52, 49152
    s_lshl_b32 s57, s82, 7
    buffer_load_dwordx4 v12, s[20:23], s57 offen offset:0 lds
    s_add_u32 s57, s57, 31744
    buffer_load_dwordx4 v12, s[20:23], s57 offen offset:1024 lds
    s_waitcnt vmcnt(10)
    ds_read_b64_tr_b16 a[144:145], v8 offset:0
    ds_read_b64_tr_b16 a[146:147], v8 offset:2048
    ds_read_b64_tr_b16 a[148:149], v9 offset:0
    ds_read_b64_tr_b16 a[150:151], v9 offset:2048
    s_add_u32 s57, s57, 31744
    buffer_load_dwordx4 v12, s[20:23], s57 offen offset:2048 lds
    ds_read_b64_tr_b16 a[152:153], v8 offset:256
    ds_read_b64_tr_b16 a[154:155], v8 offset:2304
    ds_read_b64_tr_b16 a[156:157], v9 offset:256
    ds_read_b64_tr_b16 a[158:159], v9 offset:2304
    s_add_u32 s57, s57, 31744
    buffer_load_dwordx4 v12, s[20:23], s57 offen offset:3072 lds
    s_waitcnt lgkmcnt(15)
    s_add_u32 m0, s52, 65536
    s_lshl_b32 s57, s82, 7
    s_add_u32 s57, s57, 131072
    buffer_load_dwordx4 v12, s[20:23], s57 offen offset:0 lds
    s_add_u32 s57, s57, 31744
    buffer_load_dwordx4 v12, s[20:23], s57 offen offset:1024 lds
    s_waitcnt vmcnt(10)
    ds_read_b64_tr_b16 a[160:161], v8 offset:16384
    ds_read_b64_tr_b16 a[162:163], v8 offset:18432
    ds_read_b64_tr_b16 a[164:165], v9 offset:16384
    ds_read_b64_tr_b16 a[166:167], v9 offset:18432
    s_add_u32 s57, s57, 31744
    buffer_load_dwordx4 v12, s[20:23], s57 offen offset:2048 lds
    ds_read_b64_tr_b16 a[168:169], v8 offset:16640
    ds_read_b64_tr_b16 a[170:171], v8 offset:18688
    ds_read_b64_tr_b16 a[172:173], v9 offset:16640
    ds_read_b64_tr_b16 a[174:175], v9 offset:18688
    s_add_u32 s57, s57, 31744
    buffer_load_dwordx4 v12, s[20:23], s57 offen offset:3072 lds
    s_add_u32 m0, s52, 81920
    s_mov_b32 s57, s75
    buffer_load_dwordx4 v15, s[12:15], s57 offen offset:0 lds
    s_add_u32 s57, s57, 24064
    buffer_load_dwordx4 v15, s[12:15], s57 offen offset:1024 lds
    s_waitcnt vmcnt(10)
    ds_read_b64_tr_b16 a[176:177], v8 offset:32768
    ds_read_b64_tr_b16 a[178:179], v8 offset:34816
    ds_read_b64_tr_b16 a[180:181], v9 offset:32768
    ds_read_b64_tr_b16 a[182:183], v9 offset:34816
    s_add_u32 s57, s57, 24064
    buffer_load_dwordx4 v15, s[12:15], s57 offen offset:2048 lds
    ds_read_b64_tr_b16 a[184:185], v8 offset:33024
    ds_read_b64_tr_b16 a[186:187], v8 offset:35072
    ds_read_b64_tr_b16 a[188:189], v9 offset:33024
    ds_read_b64_tr_b16 a[190:191], v9 offset:35072
    s_add_u32 s57, s57, 24064
    buffer_load_dwordx4 v15, s[12:15], s57 offen offset:3072 lds
    s_waitcnt lgkmcnt(15)
    s_add_u32 m0, s52, 98304
    s_mov_b32 s57, 0
    buffer_load_dwordx4 v13, s[12:15], s57 offen offset:0 lds
    s_add_u32 s57, s57, 6144
    buffer_load_dwordx4 v14, s[12:15], s57 offen offset:1024 lds
    s_waitcnt vmcnt(10)
    ds_read_b64_tr_b16 a[192:193], v6 offset:0
    ds_read_b64_tr_b16 a[194:195], v6 offset:2048
    ds_read_b64_tr_b16 a[196:197], v7 offset:0
    ds_read_b64_tr_b16 a[198:199], v7 offset:2048
    s_add_u32 s57, s57, 6144
    buffer_load_dwordx4 v13, s[12:15], s57 offen offset:2048 lds
    ds_read_b64_tr_b16 a[200:201], v6 offset:256
    ds_read_b64_tr_b16 a[202:203], v6 offset:2304
    ds_read_b64_tr_b16 a[204:205], v7 offset:256
    ds_read_b64_tr_b16 a[206:207], v7 offset:2304
    s_add_u32 s57, s57, 6144
    buffer_load_dwordx4 v14, s[12:15], s57 offen offset:3072 lds
    s_add_u32 m0, s52, 114688
    s_mov_b32 s57, 25088
    buffer_load_dwordx4 v13, s[12:15], s57 offen offset:0 lds
    s_add_u32 s57, s57, 6144
    buffer_load_dwordx4 v14, s[12:15], s57 offen offset:1024 lds
    s_waitcnt vmcnt(10)
    ds_read_b64_tr_b16 a[208:209], v6 offset:16384
    ds_read_b64_tr_b16 a[210:211], v6 offset:18432
    ds_read_b64_tr_b16 a[212:213], v7 offset:16384
    ds_read_b64_tr_b16 a[214:215], v7 offset:18432
    buffer_load_dword v17, v20, s[24:27], 0 offen sc1
    ds_read_b64_tr_b16 a[216:217], v6 offset:16640
    ds_read_b64_tr_b16 a[218:219], v6 offset:18688
    ds_read_b64_tr_b16 a[220:221], v7 offset:16640
    ds_read_b64_tr_b16 a[222:223], v7 offset:18688
    s_add_u32 s57, s57, 6144
    buffer_load_dwordx4 v13, s[12:15], s57 offen offset:2048 lds
    s_add_u32 s57, s57, 6144
    buffer_load_dwordx4 v14, s[12:15], s57 offen offset:3072 lds
    s_waitcnt lgkmcnt(15)
    s_add_u32 m0, s52, 131072
    s_mov_b32 s57, 50176
    buffer_load_dwordx4 v13, s[12:15], s57 offen offset:0 lds
    s_add_u32 s57, s57, 6144
    buffer_load_dwordx4 v14, s[12:15], s57 offen offset:1024 lds
    s_add_u32 s57, s57, 6144
    buffer_load_dwordx4 v13, s[12:15], s57 offen offset:2048 lds
    s_add_u32 s57, s57, 6144
    buffer_load_dwordx4 v14, s[12:15], s57 offen offset:3072 lds
    s_add_u32 m0, s52, 147456
    s_mov_b32 s57, 75264
    buffer_load_dwordx4 v13, s[12:15], s57 offen offset:0 lds
    s_add_u32 s57, s57, 6144
    buffer_load_dwordx4 v14, s[12:15], s57 offen offset:1024 lds
    s_add_u32 s57, s57, 6144
    buffer_load_dwordx4 v13, s[12:15], s57 offen offset:2048 lds
    s_add_u32 s57, s57, 6144
    buffer_load_dwordx4 v14, s[12:15], s57 offen offset:3072 lds
    s_waitcnt vmcnt(10)
    v_cmp_ne_u32 vcc, s47, v17
    s_nop 0
    s_cbranch_vccz L_ok8
    s_mov_b32 s59, 20000
L_spin7:
    buffer_load_dword v17, v20, s[24:27], 0 offen sc1
    s_waitcnt vmcnt(0)
    v_cmp_ne_u32 vcc, s47, v17
    s_nop 0
    s_cbranch_vccz L_ok8
    s_sub_u32 s59, s59, 1
    s_cbranch_scc0 L_spin7
L_ok8:
    s_cmp_ge_u32 s89, 4
    s_cbranch_scc1 L_p3_alt
    s_mov_b32 s66, s68
    s_add_u32 s58, s66, s76
    buffer_load_dwordx4 v[144:147], v23, s[24:27], s58 offen offset:0 sc1
    buffer_load_dwordx4 v[148:151], v23, s[24:27], s58 offen offset:1024 sc1
    s_add_u32 s58, s66, s77
    buffer_load_dwordx4 v[152:155], v23, s[24:27], s58 offen offset:0 sc1
    buffer_load_dwordx4 v[156:159], v23, s[24:27], s58 offen offset:1024 sc1
    s_add_u32 s58, s66, s78
    buffer_load_dwordx4 v[112:115], v23, s[24:27], s58 offen offset:0 sc1
    buffer_load_dwordx4 v[116:119], v23, s[24:27], s58 offen offset:1024 sc1
    s_add_u32 s58, s66, s79
    buffer_load_dwordx4 v[120:123], v23, s[24:27], s58 offen offset:0 sc1
    buffer_load_dwordx4 v[124:127], v23, s[24:27], s58 offen offset:1024 sc1
    s_add_u32 s58, s66, s80
    buffer_load_dwordx4 v[128:131], v23, s[24:27], s58 offen offset:0 sc1
    buffer_load_dwordx4 v[132:135], v23, s[24:27], s58 offen offset:1024 sc1
    s_add_u32 s58, s66, s81
    buffer_load_dwordx4 v[136:139], v23, s[24:27], s58 offen offset:0 sc1
    s_waitcnt vmcnt(10)
    v_mfma_f32_16x16x32_bf16 v[96:99], v[144:147], a[0:3], v[228:231]
    v_mfma_f32_16x16x32_bf16 v[100:103], v[144:147], a[4:7], 0
    buffer_load_dwordx4 v[140:143], v23, s[24:27], s58 offen offset:1024 sc1
    v_mfma_f32_16x16x32_bf16 v[104:107], v[144:147], a[8:11], 0
    v_mfma_f32_16x16x32_bf16 v[108:111], v[144:147], a[12:15], 0
    s_waitcnt vmcnt(10)
    v_mfma_f32_16x16x32_bf16 v[96:99], v[148:151], a[16:19], v[96:99]
    s_add_u32 s58, s66, s82
    v_mfma_f32_16x16x32_bf16 v[100:103], v[148:151], a[20:23], v[100:103]
    buffer_load_dwordx4 v[144:147], v23, s[24:27], s58 offen offset:0 sc1
    v_mfma_f32_16x16x32_bf16 v[104:107], v[148:151], a[24:27], v[104:107]
    v_mfma_f32_16x16x32_bf16 v[108:111], v[148:151], a[28:31], v[108:111]
    s_waitcnt vmcnt(10)
    v_mfma_f32_16x16x32_bf16 v[96:99], v[152:155], a[32:35], v[96:99]
    v_mfma_f32_16x16x32_bf16 v[100:103], v[152:155], a[36:39], v[100:103]
    buffer_load_dwordx4 v[148:151], v23, s[24:27], s58 offen offset:1024 sc1
    v_mfma_f32_16x16x32_bf16 v[104:107], v[152:155], a[40:43], v[104:107]
    v_mfma_f32_16x16x32_bf16 v[108:111], v[152:155], a[44:47], v[108:111]
    s_waitcnt vmcnt(10)
    v_mfma_f32_16x16x32_bf16 v[96:99], v[156:159], a[48:51], v[96:99]
    s_add_u32 s66, s69, 175872
    s_add_u32 s58, s66, s76
    v_mfma_f32_16x16x32_bf16 v[100:103], v[156:159], a[52:55], v[100:103]
    buffer_load_dwordx4 v[152:155], v23, s[24:27], s58 offen offset:0 sc1
    v_mfma_f32_16x16x32_bf16 v[104:107], v[156:159], a[56:59], v[104:107]
    v_mfma_f32_16x16x32_bf16 v[108:111], v[156:159], a[60:63], v[108:111]
    s_waitcnt vmcnt(10)
    v_mfma_f32_16x16x32_bf16 v[96:99], v[112:115], a[64:67], v[96:99]
    v_mfma_f32_16x16x32_bf16 v[100:103], v[112:115], a[68:71], v[100:103]
    buffer_load_dwordx4 v[156:159], v23, s[24:27], s58 offen offset:1024 sc1
    v_mfma_f32_16x16x32_bf16 v[104:107], v[112:115], a[72:75], v[104:107]
    v_mfma_f32_16x16x32_bf16 v[108:111], v[112:115], a[76:79], v[108:111]
    s_waitcnt vmcnt(10)
    v_mfma_f32_16x16x32_bf16 v[96:99], v[116:119], a[80:83], v[96:99]
    s_add_u32 s58, s66, s77
    v_mfma_f32_16x16x32_bf16 v[100:103], v[116:119], a[84:87], v[100:103]
    buffer_load_dwordx4 v[112:115], v23, s[24:27], s58 offen offset:0 sc1
    v_mfma_f32_16x16x32_bf16 v[104:107], v[116:119], a[88:91], v[104:107]
    v_mfma_f32_16x16x32_bf16 v[108:111], v[116:119], a[92:95], v[108:111]
    s_waitcnt vmcnt(10)
    v_mfma_f32_16x16x32_bf16 v[96:99], v[120:123], a[96:99], v[96:99]
    v_mfma_f32_16x16x32_bf16 v[100:103], v[120:123], a[100:103], v[100:103]
    buffer_load_dwordx4 v[116:119], v23, s[24:27], s58 offen offset:1024 sc1
    v_mfma_f32_16x16x32_bf16 v[104:107], v[120:123], a[104:107], v[104:107]
    v_mfma_f32_16x16x32_bf16 v[108:111], v[120:123], a[108:111], v[108:111]
    s_waitcnt vmcnt(10)
    v_mfma_f32_16x16x32_bf16 v[96:99], v[124:127], a[112:115], v[96:99]
    s_add_u32 s58, s66, s78
    v_mfma_f32_16x16x32_bf16 v[100:103], v[124:127], a[116:119], v[100:103]
    buffer_load_dwordx4 v[120:123], v23, s[24:27], s58 offen offset:0 sc1
    v_mfma_f32_16x16x32_bf16 v[104:107], v[124:127], a[120:123], v[104:107]
    v_mfma_f32_16x16x32_bf16 v[108:111], v[124:127], a[124:127], v[108:111]
    s_waitcnt vmcnt(10)
    v_mfma_f32_16x16x32_bf16 v[96:99], v[128:131], a[128:131], v[96:99]
    v_mfma_f32_16x16x32_bf16 v[100:103], v[128:131], a[132:135], v[100:103]
    buffer_load_dwordx4 v[124:127], v23, s[24:27], s58 offen offset:1024 sc1
    v_mfma_f32_16x16x32_bf16 v[104:107], v[128:131], a[136:139], v[104:107]
    v_mfma_f32_16x16x32_bf16 v[108:111], v[128:131], a[140:143], v[108:111]
    s_waitcnt vmcnt(10)
    v_mfma_f32_16x16x32_bf16 v[96:99], v[132:135], a[144:147], v[96:99]
    s_add_u32 s58, s66, s79
    v_mfma_f32_16x16x32_bf16 v[100:103], v[132:135], a[148:151], v[100:103]
    buffer_load_dwordx4 v[128:131], v23, s[24:27], s58 offen offset:0 sc1
    v_mfma_f32_16x16x32_bf16 v[104:107], v[132:135], a[152:155], v[104:107]
    v_mfma_f32_16x16x32_bf16 v[108:111], v[132:135], a[156:159], v[108:111]
    s_waitcnt vmcnt(10)
    v_mfma_f32_16x16x32_bf16 v[96:99], v[136:139], a[160:163], v[96:99]
    v_mfma_f32_16x16x32_bf16 v[100:103], v[136:139], a[164:167], v[100:103]
    buffer_load_dwordx4 v[132:135], v23, s[24:27], s58 offen offset:1024 sc1
    v_mfma_f32_16x16x32_bf16 v[104:107], v[136:139], a[168:171], v[104:107]
    v_mfma_f32_16x16x32_bf16 v[108:111], v[136:139], a[172:175], v[108:111]
    s_waitcnt vmcnt(10)
    v_mfma_f32_16x16x32_bf16 v[96:99], v[140:143], a[176:179], v[96:99]
    s_add_u32 s58, s66, s80
    v_mfma_f32_16x16x32_bf16 v[100:103], v[140:143], a[180:183], v[100:103]
    buffer_load_dwordx4 v[136:139], v23, s[24:27], s58 offen offset:0 sc1
    v_mfma_f32_16x16x32_bf16 v[104:107], v[140:143], a[184:187], v[104:107]
    v_mfma_f32_16x16x32_bf16 v[108:111], v[140:143], a[188:191], v[108:111]
    s_waitcnt vmcnt(10)
    s_waitcnt lgkmcnt(8)
    v_mfma_f32_16x16x32_bf16 v[96:99], v[144:147], a[192:195], v[96:99]
    v_mfma_f32_16x16x32_bf16 v[100:103], v[144:147], a[196:199], v[100:103]
    buffer_load_dwordx4 v[140:143], v23, s[24:27], s58 offen offset:1024 sc1
    v_mfma_f32_16x16x32_bf16 v[104:107], v[144:147], a[200:203], v[104:107]
    v_mfma_f32_16x16x32_bf16 v[108:111], v[144:147], a[204:207], v[108:111]
    s_waitcnt vmcnt(10)
    s_waitcnt lgkmcnt(0)
    v_mfma_f32_16x16x32_bf16 v[96:99], v[148:151], a[208:211], v[96:99]
    s_add_u32 s58, s66, s81
    v_mfma_f32_16x16x32_bf16 v[100:103], v[148:151], a[212:215], v[100:103]
    buffer_load_dwordx4 v[144:147], v23, s[24:27], s58 offen offset:0 sc1
    v_mfma_f32_16x16x32_bf16 v[104:107], v[148:151], a[216:219], v[104:107]
    v_mfma_f32_16x16x32_bf16 v[108:111], v[148:151], a[220:223], v[108:111]
L_p3_join:
    s_waitcnt vmcnt(10)
    v_mfma_f32_16x16x32_bf16 v[80:83], v[152:155], a[0:3], v[228:231]
    v_mfma_f32_16x16x32_bf16 v[84:87], v[152:155], a[4:7], 0
    buffer_load_dwordx4 v[148:151], v23, s[24:27], s58 offen offset:1024 sc1
    v_mfma_f32_16x16x32_bf16 v[88:91], v[152:155], a[8:11], 0
    v_mfma_f32_16x16x32_bf16 v[92:95], v[152:155], a[12:15], 0
    s_waitcnt vmcnt(10)
    v_mfma_f32_16x16x32_bf16 v[80:83], v[156:159], a[16:19], v[80:83]
    s_add_u32 s58, s66, s82
    v_mfma_f32_16x16x32_bf16 v[84:87], v[156:159], a[20:23], v[84:87]
    buffer_load_dwordx4 v[152:155], v23, s[24:27], s58 offen offset:0 sc1
    v_mfma_f32_16x16x32_bf16 v[88:91], v[156:159], a[24:27], v[88:91]
    ds_write_b128 v232, v[100:103] offset:3072
    v_mfma_f32_16x16x32_bf16 v[92:95], v[156:159], a[28:31], v[92:95]
    s_waitcnt vmcnt(10)
    v_mfma_f32_16x16x32_bf16 v[80:83], v[112:115], a[32:35], v[80:83]
    v_mfma_f32_16x16x32_bf16 v[84:87], v[112:115], a[36:39], v[84:87]
    buffer_load_dwordx4 v[156:159], v23, s[24:27], s58 offen offset:1024 sc1
    v_mfma_f32_16x16x32_bf16 v[88:91], v[112:115], a[40:43], v[88:91]
    ds_write_b128 v232, v[104:107] offset:19456
    v_mfma_f32_16x16x32_bf16 v[92:95], v[112:115], a[44:47], v[92:95]
    s_waitcnt vmcnt(10)
    v_mfma_f32_16x16x32_bf16 v[80:83], v[116:119], a[48:51], v[80:83]
    s_add_u32 s66, s69, 117248
    s_add_u32 s58, s66, s76
    v_mfma_f32_16x16x32_bf16 v[84:87], v[116:119], a[52:55], v[84:87]
    buffer_load_dwordx4 v[112:115], v23, s[24:27], s58 offen offset:0 sc1
    v_mfma_f32_16x16x32_bf16 v[88:91], v[116:119], a[56:59], v[88:91]
    ds_write_b128 v232, v[108:111] offset:35840
    v_mfma_f32_16x16x32_bf16 v[92:95], v[116:119], a[60:63], v[92:95]
    s_waitcnt vmcnt(10)
    v_mfma_f32_16x16x32_bf16 v[80:83], v[120:123], a[64:67], v[80:83]
    v_mfma_f32_16x16x32_bf16 v[84:87], v[120:123], a[68:71], v[84:87]
    buffer_load_dwordx4 v[116:119], v23, s[24:27], s58 offen offset:1024 sc1
    v_mfma_f32_16x16x32_bf16 v[88:91], v[120:123], a[72:75], v[88:91]
    v_mfma_f32_16x16x32_bf16 v[92:95], v[120:123], a[76:79], v[92:95]
    s_waitcnt vmcnt(10)
    v_mfma_f32_16x16x32_bf16 v[80:83], v[124:127], a[80:83], v[80:83]
    s_add_u32 s58, s66, s77
    v_mfma_f32_16x16x32_bf16 v[84:87], v[124:127], a[84:87], v[84:87]
    buffer_load_dwordx4 v[120:123], v23, s[24:27], s58 offen offset:0 sc1
    v_mfma_f32_16x16x32_bf16 v[88:91], v[124:127], a[88:91], v[88:91]
    s_waitcnt lgkmcnt(0)
    s_barrier
    v_mfma_f32_16x16x32_bf16 v[92:95], v[124:127], a[92:95], v[92:95]
    s_waitcnt vmcnt(10)
    v_mfma_f32_16x16x32_bf16 v[80:83], v[128:131], a[96:99], v[80:83]
    v_mfma_f32_16x16x32_bf16 v[84:87], v[128:131], a[100:103], v[84:87]
    buffer_load_dwordx4 v[124:127], v23, s[24:27], s58 offen offset:1024 sc1
    v_mfma_f32_16x16x32_bf16 v[88:91], v[128:131], a[104:107], v[88:91]
    ds_read_b128 v[100:103], v233 offset:3072
    ds_read_b128 v[104:107], v234 offset:19456
    v_mfma_f32_16x16x32_bf16 v[92:95], v[128:131], a[108:111], v[92:95]
    ds_read_b128 v[108:111], v235 offset:35840
    s_waitcnt vmcnt(10)
    v_mfma_f32_16x16x32_bf16 v[80:83], v[132:135], a[112:115], v[80:83]
    s_add_u32 s58, s66, s78
    v_mfma_f32_16x16x32_bf16 v[84:87], v[132:135], a[116:119], v[84:87]
    buffer_load_dwordx4 v[128:131], v23, s[24:27], s58 offen offset:0 sc1
    v_mfma_f32_16x16x32_bf16 v[88:91], v[132:135], a[120:123], v[88:91]
    ds_read_b64_tr_b16 v[160:161], v16 offset:0
    v_mfma_f32_16x16x32_bf16 v[92:95], v[132:135], a[124:127], v[92:95]
    ds_read_b64_tr_b16 v[162:163], v16 offset:512
    s_waitcnt vmcnt(10)
    v_mfma_f32_16x16x32_bf16 v[80:83], v[136:139], a[128:131], v[80:83]
    s_waitcnt lgkmcnt(2)
    v_mfma_f32_16x16x32_bf16 v[84:87], v[136:139], a[132:135], v[84:87]
    buffer_load_dwordx4 v[132:135], v23, s[24:27], s58 offen offset:1024 sc1
    v_mfma_f32_16x16x32_bf16 v[88:91], v[136:139], a[136:139], v[88:91]
    v_add_f32 v96, v96, v100
    v_add_f32 v97, v97, v101
    ds_read_b64_tr_b16 v[164:165], v16 offset:1024
    v_mfma_f32_16x16x32_bf16 v[92:95], v[136:139], a[140:143], v[92:95]
    ds_read_b64_tr_b16 v[166:167], v16 offset:1536
    s_waitcnt vmcnt(10)
    v_mfma_f32_16x16x32_bf16 v[80:83], v[140:143], a[144:147], v[80:83]
    s_add_u32 s58, s66, s79
    v_add_f32 v98, v98, v102
    v_mfma_f32_16x16x32_bf16 v[84:87], v[140:143], a[148:151], v[84:87]
    buffer_load_dwordx4 v[136:139], v23, s[24:27], s58 offen offset:0 sc1
    v_mfma_f32_16x16x32_bf16 v[88:91], v[140:143], a[152:155], v[88:91]
    v_add_f32 v99, v99, v103
    v_add_f32 v96, v96, v104
    ds_read_b64_tr_b16 v[168:169], v16 offset:2048
    v_mfma_f32_16x16x32_bf16 v[92:95], v[140:143], a[156:159], v[92:95]
    ds_read_b64_tr_b16 v[170:171], v16 offset:2560
    s_waitcnt vmcnt(10)
    v_mfma_f32_16x16x32_bf16 v[80:83], v[144:147], a[160:163], v[80:83]
    v_add_f32 v97, v97, v105
    v_mfma_f32_16x16x32_bf16 v[84:87], v[144:147], a[164:167], v[84:87]
    buffer_load_dwordx4 v[140:143], v23, s[24:27], s58 offen offset:1024 sc1
    v_mfma_f32_16x16x32_bf16 v[88:91], v[144:147], a[168:171], v[88:91]
    v_add_f32 v98, v98, v106
    v_add_f32 v99, v99, v107
    ds_read_b64_tr_b16 v[172:173], v16 offset:3072
    v_mfma_f32_16x16x32_bf16 v[92:95], v[144:147], a[172:175], v[92:95]
    ds_read_b64_tr_b16 v[174:175], v16 offset:3584
    s_waitcnt vmcnt(10)
    v_mfma_f32_16x16x32_bf16 v[80:83], v[148:151], a[176:179], v[80:83]
    s_add_u32 s58, s66, s80
    v_mfma_f32_16x16x32_bf16 v[84:87], v[148:151], a[180:183], v[84:87]
    buffer_load_dwordx4 v[144:147], v23, s[24:27], s58 offen offset:0 sc1
    v_mfma_f32_16x16x32_bf16 v[88:91], v[148:151], a[184:187], v[88:91]
    v_add_f32 v96, v96, v108
    v_add_f32 v97, v97, v109
    v_mfma_f32_16x16x32_bf16 v[92:95], v[148:151], a[188:191], v[92:95]
    v_add_f32 v98, v98, v110
    s_waitcnt vmcnt(10)
    v_mfma_f32_16x16x32_bf16 v[80:83], v[152:155], a[192:195], v[80:83]
    v_mfma_f32_16x16x32_bf16 v[84:87], v[152:155], a[196:199], v[84:87]
    buffer_load_dwordx4 v[148:151], v23, s[24:27], s58 offen offset:1024 sc1
    v_mfma_f32_16x16x32_bf16 v[88:91], v[152:155], a[200:203], v[88:91]
    v_add_f32 v99, v99, v111
    v_mfma_f32_16x16x32_bf16 v[92:95], v[152:155], a[204:207], v[92:95]
    s_waitcnt vmcnt(10)
    v_mfma_f32_16x16x32_bf16 v[80:83], v[156:159], a[208:211], v[80:83]
    s_add_u32 s58, s66, s81
    v_mfma_f32_16x16x32_bf16 v[84:87], v[156:159], a[212:215], v[84:87]
    buffer_load_dwordx4 v[152:155], v23, s[24:27], s58 offen offset:0 sc1
    v_mfma_f32_16x16x32_bf16 v[88:91], v[156:159], a[216:219], v[88:91]
    v_mfma_f32_16x16x32_bf16 v[92:95], v[156:159], a[220:223], v[92:95]
    s_waitcnt vmcnt(10)
    v_mfma_f32_16x16x32_bf16 v[64:67], v[112:115], a[0:3], v[228:231]
    v_mfma_f32_16x16x32_bf16 v[68:71], v[112:115], a[4:7], 0
    buffer_load_dwordx4 v[156:159], v23, s[24:27], s58 offen offset:1024 sc1
    v_mfma_f32_16x16x32_bf16 v[72:75], v[112:115], a[8:11], 0
    ds_read_b64_tr_b16 v[192:193], v16 offset:4096
    v_mfma_f32_16x16x32_bf16 v[76:79], v[112:115], a[12:15], 0
    ds_read_b64_tr_b16 v[194:195], v16 offset:4608
    s_waitcnt vmcnt(10)
    v_mfma_f32_16x16x32_bf16 v[64:67], v[116:119], a[16:19], v[64:67]
    s_add_u32 s58, s66, s82
    v_mfma_f32_16x16x32_bf16 v[68:71], v[116:119], a[20:23], v[68:71]
    buffer_load_dwordx4 v[112:115], v23, s[24:27], s58 offen offset:0 sc1
    v_mfma_f32_16x16x32_bf16 v[72:75], v[116:119], a[24:27], v[72:75]
    ds_read_b64_tr_b16 v[196:197], v16 offset:5120
    ds_read_b64_tr_b16 v[198:199], v16 offset:5632
    v_mfma_f32_16x16x32_bf16 v[76:79], v[116:119], a[28:31], v[76:79]
    ds_write_b128 v232, v[84:87] offset:49152
    s_waitcnt vmcnt(10)
    v_mfma_f32_16x16x32_bf16 v[64:67], v[120:123], a[32:35], v[64:67]
    v_mfma_f32_16x16x32_bf16 v[68:71], v[120:123], a[36:39], v[68:71]
    buffer_load_dwordx4 v[116:119], v23, s[24:27], s58 offen offset:1024 sc1
    v_mfma_f32_16x16x32_bf16 v[72:75], v[120:123], a[40:43], v[72:75]
    ds_read_b64_tr_b16 v[200:201], v16 offset:6144
    ds_read_b64_tr_b16 v[202:203], v16 offset:6656
    v_mfma_f32_16x16x32_bf16 v[76:79], v[120:123], a[44:47], v[76:79]
    ds_write_b128 v232, v[88:91] offset:50176
    s_waitcnt vmcnt(10)
    v_mfma_f32_16x16x32_bf16 v[64:67], v[124:127], a[48:51], v[64:67]
    s_add_u32 s66, s69, 58624
    s_add_u32 s58, s66, s76
    v_mfma_f32_16x16x32_bf16 v[68:71], v[124:127], a[52:55], v[68:71]
    buffer_load_dwordx4 v[120:123], v23, s[24:27], s58 offen offset:0 sc1
    v_mfma_f32_16x16x32_bf16 v[72:75], v[124:127], a[56:59], v[72:75]
    ds_read_b64_tr_b16 v[204:205], v16 offset:7168
    ds_read_b64_tr_b16 v[206:207], v16 offset:7680
    v_mfma_f32_16x16x32_bf16 v[76:79], v[124:127], a[60:63], v[76:79]
    ds_write_b128 v232, v[92:95] offset:51200
    s_waitcnt vmcnt(10)
    v_mfma_f32_16x16x32_bf16 v[64:67], v[128:131], a[64:67], v[64:67]
    v_mfma_f32_16x16x32_bf16 v[68:71], v[128:131], a[68:71], v[68:71]
    buffer_load_dwordx4 v[124:127], v23, s[24:27], s58 offen offset:1024 sc1
    v_mfma_f32_16x16x32_bf16 v[72:75], v[128:131], a[72:75], v[72:75]
    ds_read_b64_tr_b16 v[100:101], v16 offset:8192
    v_mfma_f32_16x16x32_bf16 v[76:79], v[128:131], a[76:79], v[76:79]
    ds_read_b64_tr_b16 v[102:103], v16 offset:8704
    s_waitcnt vmcnt(10)
    v_mfma_f32_16x16x32_bf16 v[64:67], v[132:135], a[80:83], v[64:67]
    s_add_u32 s58, s66, s77
    v_mfma_f32_16x16x32_bf16 v[68:71], v[132:135], a[84:87], v[68:71]
    buffer_load_dwordx4 v[128:131], v23, s[24:27], s58 offen offset:0 sc1
    v_mfma_f32_16x16x32_bf16 v[72:75], v[132:135], a[88:91], v[72:75]
    s_waitcnt lgkmcnt(2)
    s_barrier
    v_mfma_f32_16x16x32_bf16 v[76:79], v[132:135], a[92:95], v[76:79]
    s_waitcnt vmcnt(10)
    v_mfma_f32_16x16x32_bf16 v[64:67], v[136:139], a[96:99], v[64:67]
    v_mfma_f32_16x16x32_bf16 v[68:71], v[136:139], a[100:103], v[68:71]
    buffer_load_dwordx4 v[132:135], v23, s[24:27], s58 offen offset:1024 sc1
    v_mfma_f32_16x16x32_bf16 v[72:75], v[136:139], a[104:107], v[72:75]
    ds_read_b128 v[84:87], v233 offset:49152
    ds_read_b128 v[88:91], v234 offset:50176
    v_mfma_f32_16x16x32_bf16 v[76:79], v[136:139], a[108:111], v[76:79]
    ds_read_b128 v[92:95], v235 offset:51200
    s_waitcnt vmcnt(10)
    v_mfma_f32_16x16x32_bf16 v[64:67], v[140:143], a[112:115], v[64:67]
    s_add_u32 s58, s66, s78
    v_mfma_f32_16x16x32_bf16 v[68:71], v[140:143], a[116:119], v[68:71]
    buffer_load_dwordx4 v[136:139], v23, s[24:27], s58 offen offset:0 sc1
    v_mfma_f32_16x16x32_bf16 v[72:75], v[140:143], a[120:123], v[72:75]
    ds_read_b64_tr_b16 a[224:225], v246 offset:0
    v_mfma_f32_16x16x32_bf16 v[76:79], v[140:143], a[124:127], v[76:79]
    ds_read_b64_tr_b16 a[226:227], v246 offset:512
    s_waitcnt vmcnt(10)
    v_mfma_f32_16x16x32_bf16 v[64:67], v[144:147], a[128:131], v[64:67]
    s_waitcnt lgkmcnt(2)
    v_mfma_f32_16x16x32_bf16 v[68:71], v[144:147], a[132:135], v[68:71]
    buffer_load_dwordx4 v[140:143], v23, s[24:27], s58 offen offset:1024 sc1
    v_mfma_f32_16x16x32_bf16 v[72:75], v[144:147], a[136:139], v[72:75]
    v_add_f32 v80, v80, v84
    v_add_f32 v81, v81, v85
    ds_read_b64_tr_b16 a[228:229], v247 offset:0
    v_mfma_f32_16x16x32_bf16 v[76:79], v[144:147], a[140:143], v[76:79]
    ds_read_b64_tr_b16 a[230:231], v247 offset:512
    s_waitcnt vmcnt(10)
    v_mfma_f32_16x16x32_bf16 v[64:67], v[148:151], a[144:147], v[64:67]
    s_add_u32 s58, s66, s79
    v_add_f32 v82, v82, v86
    v_mfma_f32_16x16x32_bf16 v[68:71], v[148:151], a[148:151], v[68:71]
    buffer_load_dwordx4 v[144:147], v23, s[24:27], s58 offen offset:0 sc1
    v_mfma_f32_16x16x32_bf16 v[72:75], v[148:151], a[152:155], v[72:75]
    v_add_f32 v83, v83, v87
    v_add_f32 v80, v80, v88
    ds_read_b64_tr_b16 a[232:233], v246 offset:256
    v_mfma_f32_16x16x32_bf16 v[76:79], v[148:151], a[156:159], v[76:79]
    ds_read_b64_tr_b16 a[234:235], v246 offset:768
    s_waitcnt vmcnt(10)
    v_mfma_f32_16x16x32_bf16 v[64:67], v[152:155], a[160:163], v[64:67]
    v_add_f32 v81, v81, v89
    v_mfma_f32_16x16x32_bf16 v[68:71], v[152:155], a[164:167], v[68:71]
    buffer_load_dwordx4 v[148:151], v23, s[24:27], s58 offen offset:1024 sc1
    v_mfma_f32_16x16x32_bf16 v[72:75], v[152:155], a[168:171], v[72:75]
    v_add_f32 v82, v82, v90
    v_add_f32 v83, v83, v91
    ds_read_b64_tr_b16 a[236:237], v247 offset:256
    v_mfma_f32_16x16x32_bf16 v[76:79], v[152:155], a[172:175], v[76:79]
    ds_read_b64_tr_b16 a[238:239], v247 offset:768
    s_waitcnt vmcnt(10)
    v_mfma_f32_16x16x32_bf16 v[64:67], v[156:159], a[176:179], v[64:67]
    s_add_u32 s58, s66, s80
    v_mfma_f32_16x16x32_bf16 v[68:71], v[156:159], a[180:183], v[68:71]
    buffer_load_dwordx4 v[152:155], v23, s[24:27], s58 offen offset:0 sc1
    v_mfma_f32_16x16x32_bf16 v[72:75], v[156:159], a[184:187], v[72:75]
    v_add_f32 v80, v80, v92
    v_add_f32 v81, v81, v93
    v_mfma_f32_16x16x32_bf16 v[76:79], v[156:159], a[188:191], v[76:79]
    v_add_f32 v82, v82, v94
    s_waitcnt vmcnt(10)
    v_mfma_f32_16x16x32_bf16 v[64:67], v[112:115], a[192:195], v[64:67]
    v_mfma_f32_16x16x32_bf16 v[68:71], v[112:115], a[196:199], v[68:71]
    buffer_load_dwordx4 v[156:159], v23, s[24:27], s58 offen offset:1024 sc1
    v_mfma_f32_16x16x32_bf16 v[72:75], v[112:115], a[200:203], v[72:75]
    v_add_f32 v83, v83, v95
    v_mfma_f32_16x16x32_bf16 v[76:79], v[112:115], a[204:207], v[76:79]
    s_waitcnt vmcnt(10)
    v_mfma_f32_16x16x32_bf16 v[64:67], v[116:119], a[208:211], v[64:67]
    s_add_u32 s58, s66, s81
    v_mfma_f32_16x16x32_bf16 v[68:71], v[116:119], a[212:215], v[68:71]
    buffer_load_dwordx4 v[112:115], v23, s[24:27], s58 offen offset:0 sc1
    v_mfma_f32_16x16x32_bf16 v[72:75], v[116:119], a[216:219], v[72:75]
    v_mfma_f32_16x16x32_bf16 v[76:79], v[116:119], a[220:223], v[76:79]
    s_waitcnt vmcnt(10)
    v_mfma_f32_16x16x32_bf16 v[48:51], v[120:123], a[0:3], v[228:231]
    v_mfma_f32_16x16x32_bf16 v[52:55], v[120:123], a[4:7], 0
    buffer_load_dwordx4 v[116:119], v23, s[24:27], s58 offen offset:1024 sc1
    v_mfma_f32_16x16x32_bf16 v[56:59], v[120:123], a[8:11], 0
    ds_read_b64_tr_b16 v[104:105], v16 offset:9216
    v_mfma_f32_16x16x32_bf16 v[60:63], v[120:123], a[12:15], 0
    ds_read_b64_tr_b16 v[106:107], v16 offset:9728
    s_waitcnt vmcnt(10)
    v_mfma_f32_16x16x32_bf16 v[48:51], v[124:127], a[16:19], v[48:51]
    s_add_u32 s58, s66, s82
    v_mfma_f32_16x16x32_bf16 v[52:55], v[124:127], a[20:23], v[52:55]
    buffer_load_dwordx4 v[120:123], v23, s[24:27], s58 offen offset:0 sc1
    v_mfma_f32_16x16x32_bf16 v[56:59], v[124:127], a[24:27], v[56:59]
    ds_read_b64_tr_b16 v[108:109], v16 offset:10240
    ds_read_b64_tr_b16 v[110:111], v16 offset:10752
    v_mfma_f32_16x16x32_bf16 v[60:63], v[124:127], a[28:31], v[60:63]
    ds_write_b128 v232, v[68:71] offset:32768
    s_waitcnt vmcnt(10)
    v_mfma_f32_16x16x32_bf16 v[48:51], v[128:131], a[32:35], v[48:51]
    v_mfma_f32_16x16x32_bf16 v[52:55], v[128:131], a[36:39], v[52:55]
    buffer_load_dwordx4 v[124:127], v23, s[24:27], s58 offen offset:1024 sc1
    v_mfma_f32_16x16x32_bf16 v[56:59], v[128:131], a[40:43], v[56:59]
    ds_read_b64_tr_b16 v[84:85], v16 offset:11264
    ds_read_b64_tr_b16 v[86:87], v16 offset:11776
    v_mfma_f32_16x16x32_bf16 v[60:63], v[128:131], a[44:47], v[60:63]
    ds_write_b128 v232, v[72:75] offset:33792
    s_waitcnt vmcnt(10)
    v_mfma_f32_16x16x32_bf16 v[48:51], v[132:135], a[48:51], v[48:51]
    s_add_u32 s66, s69, 0
    s_add_u32 s58, s66, s76
    v_mfma_f32_16x16x32_bf16 v[52:55], v[132:135], a[52:55], v[52:55]
    buffer_load_dwordx4 v[128:131], v23, s[24:27], s58 offen offset:0 sc1
    v_mfma_f32_16x16x32_bf16 v[56:59], v[132:135], a[56:59], v[56:59]
    ds_read_b64_tr_b16 v[88:89], v16 offset:12288
    ds_read_b64_tr_b16 v[90:91], v16 offset:12800
    v_mfma_f32_16x16x32_bf16 v[60:63], v[132:135], a[60:63], v[60:63]
    ds_write_b128 v232, v[76:79] offset:34816
    s_waitcnt vmcnt(10)
    v_mfma_f32_16x16x32_bf16 v[48:51], v[136:139], a[64:67], v[48:51]
    v_mfma_f32_16x16x32_bf16 v[52:55], v[136:139], a[68:71], v[52:55]
    buffer_load_dwordx4 v[132:135], v23, s[24:27], s58 offen offset:1024 sc1
    v_mfma_f32_16x16x32_bf16 v[56:59], v[136:139], a[72:75], v[56:59]
    ds_read_b64_tr_b16 v[92:93], v16 offset:13312
    v_mfma_f32_16x16x32_bf16 v[60:63], v[136:139], a[76:79], v[60:63]
    ds_read_b64_tr_b16 v[94:95], v16 offset:13824
    s_waitcnt vmcnt(10)
    v_mfma_f32_16x16x32_bf16 v[48:51], v[140:143], a[80:83], v[48:51]
    s_add_u32 s58, s66, s77
    v_mfma_f32_16x16x32_bf16 v[52:55], v[140:143], a[84:87], v[52:55]
    buffer_load_dwordx4 v[136:139], v23, s[24:27], s58 offen offset:0 sc1
    v_mfma_f32_16x16x32_bf16 v[56:59], v[140:143], a[88:91], v[56:59]
    s_waitcnt lgkmcnt(2)
    s_barrier
    v_mfma_f32_16x16x32_bf16 v[60:63], v[140:143], a[92:95], v[60:63]
    buffer_load_dword v19, v21, s[24:27], 0 offen sc1
    s_waitcnt vmcnt(11)
    v_mfma_f32_16x16x32_bf16 v[48:51], v[144:147], a[96:99], v[48:51]
    ds_read_b128 v[68:71], v233 offset:32768
    v_mfma_f32_16x16x32_bf16 v[52:55], v[144:147], a[100:103], v[52:55]
    ds_read_b128 v[72:75], v234 offset:33792
    v_mfma_f32_16x16x32_bf16 v[56:59], v[144:147], a[104:107], v[56:59]
    ds_read_b128 v[76:79], v235 offset:34816
    v_mfma_f32_16x16x32_bf16 v[60:63], v[144:147], a[108:111], v[60:63]
    s_waitcnt vmcnt(10)
    v_mfma_f32_16x16x32_bf16 v[48:51], v[148:151], a[112:115], v[48:51]
    v_mfma_f32_16x16x32_bf16 v[52:55], v[148:151], a[116:119], v[52:55]
    buffer_load_dwordx4 v[140:143], v23, s[24:27], s58 offen offset:1024 sc1
    v_mfma_f32_16x16x32_bf16 v[56:59], v[148:151], a[120:123], v[56:59]
    ds_read_b64_tr_b16 a[240:241], v246 offset:16384
    v_mfma_f32_16x16x32_bf16 v[60:63], v[148:151], a[124:127], v[60:63]
    ds_read_b64_tr_b16 a[242:243], v246 offset:16896
    s_waitcnt vmcnt(10)
    v_mfma_f32_16x16x32_bf16 v[48:51], v[152:155], a[128:131], v[48:51]
    s_add_u32 s58, s66, s78
    s_waitcnt lgkmcnt(2)
    v_mfma_f32_16x16x32_bf16 v[52:55], v[152:155], a[132:135], v[52:55]
    buffer_load_dwordx4 v[144:147], v23, s[24:27], s58 offen offset:0 sc1
    v_mfma_f32_16x16x32_bf16 v[56:59], v[152:155], a[136:139], v[56:59]
    v_add_f32 v64, v64, v68
    v_add_f32 v65, v65, v69
    ds_read_b64_tr_b16 a[244:245], v247 offset:16384
    v_mfma_f32_16x16x32_bf16 v[60:63], v[152:155], a[140:143], v[60:63]
    ds_read_b64_tr_b16 a[246:247], v247 offset:16896
    s_waitcnt vmcnt(10)
    v_mfma_f32_16x16x32_bf16 v[48:51], v[156:159], a[144:147], v[48:51]
    v_add_f32 v66, v66, v70
    v_mfma_f32_16x16x32_bf16 v[52:55], v[156:159], a[148:151], v[52:55]
    buffer_load_dwordx4 v[148:151], v23, s[24:27], s58 offen offset:1024 sc1
    v_mfma_f32_16x16x32_bf16 v[56:59], v[156:159], a[152:155], v[56:59]
    v_add_f32 v67, v67, v71
    v_add_f32 v64, v64, v72
    ds_read_b64_tr_b16 a[248:249], v246 offset:16640
    v_mfma_f32_16x16x32_bf16 v[60:63], v[156:159], a[156:159], v[60:63]
    ds_read_b64_tr_b16 a[250:251], v246 offset:17152
    s_waitcnt vmcnt(10)
    v_mfma_f32_16x16x32_bf16 v[48:51], v[112:115], a[160:163], v[48:51]
    s_add_u32 s58, s66, s79
    v_add_f32 v65, v65, v73
    v_mfma_f32_16x16x32_bf16 v[52:55], v[112:115], a[164:167], v[52:55]
    buffer_load_dwordx4 v[152:155], v23, s[24:27], s58 offen offset:0 sc1
    v_mfma_f32_16x16x32_bf16 v[56:59], v[112:115], a[168:171], v[56:59]
    v_add_f32 v66, v66, v74
    v_add_f32 v67, v67, v75
    ds_read_b64_tr_b16 a[252:253], v247 offset:16640
    v_mfma_f32_16x16x32_bf16 v[60:63], v[112:115], a[172:175], v[60:63]
    ds_read_b64_tr_b16 a[254:255], v247 offset:17152
    s_waitcnt vmcnt(10)
    v_mfma_f32_16x16x32_bf16 v[48:51], v[116:119], a[176:179], v[48:51]
    v_mfma_f32_16x16x32_bf16 v[52:55], v[116:119], a[180:183], v[52:55]
    buffer_load_dwordx4 v[156:159], v23, s[24:27], s58 offen offset:1024 sc1
    v_mfma_f32_16x16x32_bf16 v[56:59], v[116:119], a[184:187], v[56:59]
    v_add_f32 v64, v64, v76
    v_add_f32 v65, v65, v77
    v_mfma_f32_16x16x32_bf16 v[60:63], v[116:119], a[188:191], v[60:63]
    v_add_f32 v66, v66, v78
    s_waitcnt vmcnt(10)
    v_mfma_f32_16x16x32_bf16 v[48:51], v[120:123], a[192:195], v[48:51]
    s_add_u32 s58, s66, s80
    v_mfma_f32_16x16x32_bf16 v[52:55], v[120:123], a[196:199], v[52:55]
    buffer_load_dwordx4 v[112:115], v23, s[24:27], s58 offen offset:0 sc1
    v_mfma_f32_16x16x32_bf16 v[56:59], v[120:123], a[200:203], v[56:59]
    v_add_f32 v67, v67, v79
    v_mfma_f32_16x16x32_bf16 v[60:63], v[120:123], a[204:207], v[60:63]
    s_waitcnt vmcnt(10)
    v_mfma_f32_16x16x32_bf16 v[48:51], v[124:127], a[208:211], v[48:51]
    v_mfma_f32_16x16x32_bf16 v[52:55], v[124:127], a[212:215], v[52:55]
    buffer_load_dwordx4 v[116:119], v23, s[24:27], s58 offen offset:1024 sc1
    v_mfma_f32_16x16x32_bf16 v[56:59], v[124:127], a[216:219], v[56:59]
    v_mfma_f32_16x16x32_bf16 v[60:63], v[124:127], a[220:223], v[60:63]
    s_waitcnt vmcnt(10)
    v_mfma_f32_16x16x32_bf16 v[32:35], v[128:131], a[0:3], v[228:231]
    s_add_u32 s58, s66, s81
    ds_read_b64_tr_b16 v[68:69], v16 offset:14336
    v_mfma_f32_16x16x32_bf16 v[36:39], v[128:131], a[4:7], 0
    buffer_load_dwordx4 v[120:123], v23, s[24:27], s58 offen offset:0 sc1
    v_mfma_f32_16x16x32_bf16 v[40:43], v[128:131], a[8:11], 0
    ds_read_b64_tr_b16 v[70:71], v16 offset:14848
    ds_read_b64_tr_b16 v[72:73], v16 offset:15360
    v_mfma_f32_16x16x32_bf16 v[44:47], v[128:131], a[12:15], 0
    ds_read_b64_tr_b16 v[74:75], v16 offset:15872
    s_waitcnt vmcnt(10)
    v_mfma_f32_16x16x32_bf16 v[32:35], v[132:135], a[16:19], v[32:35]
    ds_write_b128 v232, v[52:55] offset:16384
    v_mfma_f32_16x16x32_bf16 v[36:39], v[132:135], a[20:23], v[36:39]
    buffer_load_dwordx4 v[124:127], v23, s[24:27], s58 offen offset:1024 sc1
    v_mfma_f32_16x16x32_bf16 v[40:43], v[132:135], a[24:27], v[40:43]
    ds_read_b64_tr_b16 a[0:1], v246 offset:32768
    ds_read_b64_tr_b16 a[2:3], v246 offset:33280
    ds_read_b64_tr_b16 a[4:5], v247 offset:32768
    v_mfma_f32_16x16x32_bf16 v[44:47], v[132:135], a[28:31], v[44:47]
    ds_read_b64_tr_b16 a[6:7], v247 offset:33280
    s_waitcnt vmcnt(10)
    v_mfma_f32_16x16x32_bf16 v[32:35], v[136:139], a[32:35], v[32:35]
    s_add_u32 s58, s66, s82
    ds_write_b128 v232, v[56:59] offset:17408
    v_mfma_f32_16x16x32_bf16 v[36:39], v[136:139], a[36:39], v[36:39]
    buffer_load_dwordx4 v[128:131], v23, s[24:27], s58 offen offset:0 sc1
    v_mfma_f32_16x16x32_bf16 v[40:43], v[136:139], a[40:43], v[40:43]
    ds_read_b64_tr_b16 a[8:9], v246 offset:33024
    ds_read_b64_tr_b16 a[10:11], v246 offset:33536
    ds_read_b64_tr_b16 a[12:13], v247 offset:33024
    v_mfma_f32_16x16x32_bf16 v[44:47], v[136:139], a[44:47], v[44:47]
    ds_read_b64_tr_b16 a[14:15], v247 offset:33536
    buffer_load_dwordx4 v[132:135], v23, s[24:27], s58 offen offset:1024 sc1
    s_waitcnt vmcnt(11)
    v_cmp_ne_u32 vcc, s47, v19
    s_nop 0
    s_cbranch_vccz L_ok10
    s_mov_b32 s59, 20000
L_spin9:
    buffer_load_dword v19, v21, s[24:27], 0 offen sc1
    s_waitcnt vmcnt(0)
    v_cmp_ne_u32 vcc, s47, v19
    s_nop 0
    s_cbranch_vccz L_ok10
    s_sub_u32 s59, s59, 1
    s_cbranch_scc0 L_spin9
L_ok10:
    s_waitcnt vmcnt(10)
    v_mfma_f32_16x16x32_bf16 v[32:35], v[140:143], a[48:51], v[32:35]
    s_add_u32 s58, s70, 0
    ds_write_b128 v232, v[60:63] offset:18432
    v_mfma_f32_16x16x32_bf16 v[36:39], v[140:143], a[52:55], v[36:39]
    buffer_load_dwordx4 v[136:139], v23, s[24:27], s58 offen offset:0 sc1
    v_mfma_f32_16x16x32_bf16 v[40:43], v[140:143], a[56:59], v[40:43]
    ds_read_b64_tr_b16 a[16:17], v246 offset:49152
    ds_read_b64_tr_b16 a[18:19], v246 offset:49664
    ds_read_b64_tr_b16 a[20:21], v247 offset:49152
    v_mfma_f32_16x16x32_bf16 v[44:47], v[140:143], a[60:63], v[44:47]
    ds_read_b64_tr_b16 a[22:23], v247 offset:49664
    s_waitcnt vmcnt(10)
    v_mfma_f32_16x16x32_bf16 v[32:35], v[144:147], a[64:67], v[32:35]
    ds_read_b64_tr_b16 a[24:25], v246 offset:49408
    v_mfma_f32_16x16x32_bf16 v[36:39], v[144:147], a[68:71], v[36:39]
    buffer_load_dwordx4 v[140:143], v23, s[24:27], s58 offen offset:1024 sc1
    v_mfma_f32_16x16x32_bf16 v[40:43], v[144:147], a[72:75], v[40:43]
    ds_read_b64_tr_b16 a[26:27], v246 offset:49920
    ds_read_b64_tr_b16 a[28:29], v247 offset:49408
    v_mfma_f32_16x16x32_bf16 v[44:47], v[144:147], a[76:79], v[44:47]
    ds_read_b64_tr_b16 a[30:31], v247 offset:49920
    s_waitcnt vmcnt(10)
    v_mfma_f32_16x16x32_bf16 v[32:35], v[148:151], a[80:83], v[32:35]
    ds_read_b64_tr_b16 a[32:33], v246 offset:4096
    v_mfma_f32_16x16x32_bf16 v[36:39], v[148:151], a[84:87], v[36:39]
    buffer_load_dwordx4 v[144:147], v23, s[24:27], s58 offen offset:2048 sc1
    v_mfma_f32_16x16x32_bf16 v[40:43], v[148:151], a[88:91], v[40:43]
    ds_read_b64_tr_b16 a[34:35], v246 offset:4608
    ds_read_b64_tr_b16 a[36:37], v247 offset:4096
    v_mfma_f32_16x16x32_bf16 v[44:47], v[148:151], a[92:95], v[44:47]
    ds_read_b64_tr_b16 a[38:39], v247 offset:4608
    s_waitcnt vmcnt(10)
    v_mfma_f32_16x16x32_bf16 v[32:35], v[152:155], a[96:99], v[32:35]
    ds_read_b64_tr_b16 a[40:41], v246 offset:4352
    v_mfma_f32_16x16x32_bf16 v[36:39], v[152:155], a[100:103], v[36:39]
    buffer_load_dwordx4 v[148:151], v23, s[24:27], s58 offen offset:3072 sc1
    v_mfma_f32_16x16x32_bf16 v[40:43], v[152:155], a[104:107], v[40:43]
    ds_read_b64_tr_b16 a[42:43], v246 offset:4864
    ds_read_b64_tr_b16 a[44:45], v247 offset:4352
    v_mfma_f32_16x16x32_bf16 v[44:47], v[152:155], a[108:111], v[44:47]
    ds_read_b64_tr_b16 a[46:47], v247 offset:4864
    s_waitcnt vmcnt(10)
    v_mfma_f32_16x16x32_bf16 v[32:35], v[156:159], a[112:115], v[32:35]
    s_add_u32 s58, s70, 4096
    ds_read_b64_tr_b16 a[48:49], v246 offset:20480
    v_mfma_f32_16x16x32_bf16 v[36:39], v[156:159], a[116:119], v[36:39]
    buffer_load_dwordx4 v[152:155], v23, s[24:27], s58 offen offset:0 sc1
    v_mfma_f32_16x16x32_bf16 v[40:43], v[156:159], a[120:123], v[40:43]
    ds_read_b64_tr_b16 a[50:51], v246 offset:20992
    ds_read_b64_tr_b16 a[52:53], v247 offset:20480
    v_mfma_f32_16x16x32_bf16 v[44:47], v[156:159], a[124:127], v[44:47]
    ds_read_b64_tr_b16 a[54:55], v247 offset:20992
    s_waitcnt vmcnt(10)
    v_mfma_f32_16x16x32_bf16 v[32:35], v[112:115], a[128:131], v[32:35]
    ds_read_b64_tr_b16 a[56:57], v246 offset:20736
    v_mfma_f32_16x16x32_bf16 v[36:39], v[112:115], a[132:135], v[36:39]
    buffer_load_dwordx4 v[156:159], v23, s[24:27], s58 offen offset:1024 sc1
    v_mfma_f32_16x16x32_bf16 v[40:43], v[112:115], a[136:139], v[40:43]
    ds_read_b64_tr_b16 a[58:59], v246 offset:21248
    ds_read_b64_tr_b16 a[60:61], v247 offset:20736
    v_mfma_f32_16x16x32_bf16 v[44:47], v[112:115], a[140:143], v[44:47]
    ds_read_b64_tr_b16 a[62:63], v247 offset:21248
    s_waitcnt vmcnt(10)
    v_mfma_f32_16x16x32_bf16 v[32:35], v[116:119], a[144:147], v[32:35]
    ds_read_b64_tr_b16 a[64:65], v246 offset:36864
    v_mfma_f32_16x16x32_bf16 v[36:39], v[116:119], a[148:151], v[36:39]
    buffer_load_dwordx4 v[112:115], v23, s[24:27], s58 offen offset:2048 sc1
    v_mfma_f32_16x16x32_bf16 v[40:43], v[116:119], a[152:155], v[40:43]
    ds_read_b64_tr_b16 a[66:67], v246 offset:37376
    ds_read_b64_tr_b16 a[68:69], v247 offset:36864
    v_mfma_f32_16x16x32_bf16 v[44:47], v[116:119], a[156:159], v[44:47]
    ds_read_b64_tr_b16 a[70:71], v247 offset:37376
    s_waitcnt vmcnt(10)
    v_mfma_f32_16x16x32_bf16 v[32:35], v[120:123], a[160:163], v[32:35]
    ds_read_b64_tr_b16 a[72:73], v246 offset:37120
    v_mfma_f32_16x16x32_bf16 v[36:39], v[120:123], a[164:167], v[36:39]
    buffer_load_dwordx4 v[116:119], v23, s[24:27], s58 offen offset:3072 sc1
    v_mfma_f32_16x16x32_bf16 v[40:43], v[120:123], a[168:171], v[40:43]
    ds_read_b64_tr_b16 a[74:75], v246 offset:37632
    ds_read_b64_tr_b16 a[76:77], v247 offset:37120
    v_mfma_f32_16x16x32_bf16 v[44:47], v[120:123], a[172:175], v[44:47]
    ds_read_b64_tr_b16 a[78:79], v247 offset:37632
    s_waitcnt vmcnt(10)
    v_mfma_f32_16x16x32_bf16 v[32:35], v[124:127], a[176:179], v[32:35]
    s_add_u32 s58, s70, 8192
    ds_read_b64_tr_b16 a[80:81], v246 offset:53248
    v_mfma_f32_16x16x32_bf16 v[36:39], v[124:127], a[180:183], v[36:39]
    buffer_load_dwordx4 v[120:123], v23, s[24:27], s58 offen offset:0 sc1
    v_mfma_f32_16x16x32_bf16 v[40:43], v[124:127], a[184:187], v[40:43]
    ds_read_b64_tr_b16 a[82:83], v246 offset:53760
    ds_read_b64_tr_b16 a[84:85], v247 offset:53248
    v_mfma_f32_16x16x32_bf16 v[44:47], v[124:127], a[188:191], v[44:47]
    ds_read_b64_tr_b16 a[86:87], v247 offset:53760
    s_waitcnt vmcnt(10)
    v_mfma_f32_16x16x32_bf16 v[32:35], v[128:131], a[192:195], v[32:35]
    ds_read_b64_tr_b16 a[88:89], v246 offset:53504
    v_mfma_f32_16x16x32_bf16 v[36:39], v[128:131], a[196:199], v[36:39]
    buffer_load_dwordx4 v[124:127], v23, s[24:27], s58 offen offset:1024 sc1
    v_mfma_f32_16x16x32_bf16 v[40:43], v[128:131], a[200:203], v[40:43]
    ds_read_b64_tr_b16 a[90:91], v246 offset:54016
    ds_read_b64_tr_b16 a[92:93], v247 offset:53504
    v_mfma_f32_16x16x32_bf16 v[44:47], v[128:131], a[204:207], v[44:47]
    ds_read_b64_tr_b16 a[94:95], v247 offset:54016
    s_waitcnt vmcnt(10)
    v_mfma_f32_16x16x32_bf16 v[32:35], v[132:135], a[208:211], v[32:35]
    ds_read_b64_tr_b16 a[96:97], v246 offset:8192
    v_mfma_f32_16x16x32_bf16 v[36:39], v[132:135], a[212:215], v[36:39]
    buffer_load_dwordx4 v[128:131], v23, s[24:27], s58 offen offset:2048 sc1
    v_mfma_f32_16x16x32_bf16 v[40:43], v[132:135], a[216:219], v[40:43]
    ds_read_b64_tr_b16 a[98:99], v246 offset:8704
    ds_read_b64_tr_b16 a[100:101], v247 offset:8192
    v_mfma_f32_16x16x32_bf16 v[44:47], v[132:135], a[220:223], v[44:47]
    ds_read_b64_tr_b16 a[102:103], v247 offset:8704
    s_waitcnt vmcnt(10)
    v_mfma_f32_16x16x32_bf16 v[32:35], a[224:227], v[136:139], v[32:35]
    ds_read_b64_tr_b16 a[104:105], v246 offset:8448
    v_mfma_f32_16x16x32_bf16 v[48:51], a[228:231], v[136:139], v[48:51]
    buffer_load_dwordx4 v[132:135], v23, s[24:27], s58 offen offset:3072 sc1
    v_mfma_f32_16x16x32_bf16 v[64:67], a[232:235], v[136:139], v[64:67]
    ds_read_b64_tr_b16 a[106:107], v246 offset:8960
    ds_read_b64_tr_b16 a[108:109], v247 offset:8448
    v_mfma_f32_16x16x32_bf16 v[80:83], a[236:239], v[136:139], v[80:83]
    ds_read_b64_tr_b16 a[110:111], v247 offset:8960
    ds_read_b64_tr_b16 a[112:113], v246 offset:24576
    v_mfma_f32_16x16x32_bf16 v[96:99], v[160:163], v[136:139], v[96:99]
    ds_read_b64_tr_b16 a[114:115], v246 offset:25088
    s_waitcnt lgkmcnt(15)
    s_waitcnt vmcnt(10)
    v_mfma_f32_16x16x32_bf16 v[32:35], a[240:243], v[140:143], v[32:35]
    s_add_u32 s58, s70, 12288
    ds_read_b64_tr_b16 a[116:117], v247 offset:24576
    v_mfma_f32_16x16x32_bf16 v[48:51], a[244:247], v[140:143], v[48:51]
    buffer_load_dwordx4 v[136:139], v23, s[24:27], s58 offen offset:0 sc1
    v_mfma_f32_16x16x32_bf16 v[64:67], a[248:251], v[140:143], v[64:67]
    ds_read_b64_tr_b16 a[118:119], v247 offset:25088
    ds_read_b64_tr_b16 a[120:121], v246 offset:24832
    v_mfma_f32_16x16x32_bf16 v[80:83], a[252:255], v[140:143], v[80:83]
    ds_read_b64_tr_b16 a[122:123], v246 offset:25344
    ds_read_b64_tr_b16 a[124:125], v247 offset:24832
    v_mfma_f32_16x16x32_bf16 v[96:99], v[164:167], v[140:143], v[96:99]
    ds_write_b128 v232, v[36:39] offset:0
    s_waitcnt vmcnt(10)
    v_mfma_f32_16x16x32_bf16 v[32:35], a[0:3], v[144:147], v[32:35]
    ds_read_b64_tr_b16 a[126:127], v247 offset:25344
    v_mfma_f32_16x16x32_bf16 v[48:51], a[4:7], v[144:147], v[48:51]
    buffer_load_dwordx4 v[140:143], v23, s[24:27], s58 offen offset:1024 sc1
    v_mfma_f32_16x16x32_bf16 v[64:67], a[8:11], v[144:147], v[64:67]
    ds_read_b64_tr_b16 a[128:129], v246 offset:40960
    ds_read_b64_tr_b16 a[130:131], v246 offset:41472
    v_mfma_f32_16x16x32_bf16 v[80:83], a[12:15], v[144:147], v[80:83]
    ds_read_b64_tr_b16 a[132:133], v247 offset:40960
    ds_read_b64_tr_b16 a[134:135], v247 offset:41472
    v_mfma_f32_16x16x32_bf16 v[96:99], v[168:171], v[144:147], v[96:99]
    ds_write_b128 v232, v[40:43] offset:1024
    s_waitcnt vmcnt(10)
    v_mfma_f32_16x16x32_bf16 v[32:35], a[16:19], v[148:151], v[32:35]
    ds_read_b64_tr_b16 a[136:137], v246 offset:41216
    v_mfma_f32_16x16x32_bf16 v[48:51], a[20:23], v[148:151], v[48:51]
    buffer_load_dwordx4 v[144:147], v23, s[24:27], s58 offen offset:2048 sc1
    v_mfma_f32_16x16x32_bf16 v[64:67], a[24:27], v[148:151], v[64:67]
    ds_read_b64_tr_b16 a[138:139], v246 offset:41728
    ds_read_b64_tr_b16 a[140:141], v247 offset:41216
    v_mfma_f32_16x16x32_bf16 v[80:83], a[28:31], v[148:151], v[80:83]
    ds_read_b64_tr_b16 a[142:143], v247 offset:41728
    ds_read_b64_tr_b16 a[144:145], v246 offset:57344
    v_mfma_f32_16x16x32_bf16 v[96:99], v[172:175], v[148:151], v[96:99]
    ds_write_b128 v232, v[44:47] offset:2048
    s_waitcnt vmcnt(10)
    v_mfma_f32_16x16x32_bf16 v[32:35], a[32:35], v[152:155], v[32:35]
    ds_read_b64_tr_b16 a[146:147], v246 offset:57856
    v_mfma_f32_16x16x32_bf16 v[48:51], a[36:39], v[152:155], v[48:51]
    buffer_load_dwordx4 v[148:151], v23, s[24:27], s58 offen offset:3072 sc1
    v_mfma_f32_16x16x32_bf16 v[64:67], a[40:43], v[152:155], v[64:67]
    ds_read_b64_tr_b16 a[148:149], v247 offset:57344
    ds_read_b64_tr_b16 a[150:151], v247 offset:57856
    v_mfma_f32_16x16x32_bf16 v[80:83], a[44:47], v[152:155], v[80:83]
    ds_read_b64_tr_b16 a[152:153], v246 offset:57600
    ds_read_b64_tr_b16 a[154:155], v246 offset:58112
    v_mfma_f32_16x16x32_bf16 v[96:99], v[192:195], v[152:155], v[96:99]
    ds_read_b64_tr_b16 a[156:157], v247 offset:57600
    s_waitcnt vmcnt(10)
    v_mfma_f32_16x16x32_bf16 v[32:35], a[48:51], v[156:159], v[32:35]
    ds_read_b64_tr_b16 a[158:159], v247 offset:58112
    ds_read_b64_tr_b16 a[160:161], v246 offset:12288
    v_mfma_f32_16x16x32_bf16 v[48:51], a[52:55], v[156:159], v[48:51]
    ds_read_b64_tr_b16 a[162:163], v246 offset:12800
    v_mfma_f32_16x16x32_bf16 v[64:67], a[56:59], v[156:159], v[64:67]
    ds_read_b64_tr_b16 a[164:165], v247 offset:12288
    v_mfma_f32_16x16x32_bf16 v[80:83], a[60:63], v[156:159], v[80:83]
    ds_read_b64_tr_b16 a[166:167], v247 offset:12800
    v_mfma_f32_16x16x32_bf16 v[96:99], v[196:199], v[156:159], v[96:99]
    ds_read_b64_tr_b16 a[168:169], v246 offset:12544
    s_waitcnt vmcnt(9)
    v_mfma_f32_16x16x32_bf16 v[32:35], a[64:67], v[112:115], v[32:35]
    ds_read_b64_tr_b16 a[170:171], v246 offset:13056
    ds_read_b64_tr_b16 a[172:173], v247 offset:12544
    v_mfma_f32_16x16x32_bf16 v[48:51], a[68:71], v[112:115], v[48:51]
    ds_read_b64_tr_b16 a[174:175], v247 offset:13056
    v_mfma_f32_16x16x32_bf16 v[64:67], a[72:75], v[112:115], v[64:67]
    ds_read_b64_tr_b16 a[176:177], v246 offset:28672
    v_mfma_f32_16x16x32_bf16 v[80:83], a[76:79], v[112:115], v[80:83]
    ds_read_b64_tr_b16 a[178:179], v246 offset:29184
    v_mfma_f32_16x16x32_bf16 v[96:99], v[200:203], v[112:115], v[96:99]
    s_waitcnt lgkmcnt(15)
    s_barrier
    s_waitcnt vmcnt(8)
    v_mfma_f32_16x16x32_bf16 v[32:35], a[80:83], v[116:119], v[32:35]
    ds_read_b64_tr_b16 a[180:181], v247 offset:28672
    ds_read_b64_tr_b16 a[182:183], v247 offset:29184
    v_mfma_f32_16x16x32_bf16 v[48:51], a[84:87], v[116:119], v[48:51]
    ds_read_b64_tr_b16 a[184:185], v246 offset:28928
    ds_read_b64_tr_b16 a[186:187], v246 offset:29440
    v_mfma_f32_16x16x32_bf16 v[64:67], a[88:91], v[116:119], v[64:67]
    ds_read_b64_tr_b16 a[188:189], v247 offset:28928
    ds_read_b128 v[52:55], v233 offset:16384
    v_mfma_f32_16x16x32_bf16 v[80:83], a[92:95], v[116:119], v[80:83]
    ds_read_b128 v[56:59], v234 offset:17408
    v_mfma_f32_16x16x32_bf16 v[96:99], v[204:207], v[116:119], v[96:99]
    ds_read_b128 v[60:63], v235 offset:18432
    s_waitcnt vmcnt(7)
    v_mfma_f32_16x16x32_bf16 v[32:35], a[96:99], v[120:123], v[32:35]
    ds_read_b64_tr_b16 a[190:191], v247 offset:29440
    ds_read_b64_tr_b16 a[192:193], v246 offset:45056
    v_mfma_f32_16x16x32_bf16 v[48:51], a[100:103], v[120:123], v[48:51]
    ds_read_b64_tr_b16 a[194:195], v246 offset:45568
    ds_read_b64_tr_b16 a[196:197], v247 offset:45056
    v_mfma_f32_16x16x32_bf16 v[64:67], a[104:107], v[120:123], v[64:67]
    ds_read_b64_tr_b16 a[198:199], v247 offset:45568
    ds_read_b128 v[36:39], v233 offset:0
    v_mfma_f32_16x16x32_bf16 v[80:83], a[108:111], v[120:123], v[80:83]
    ds_read_b128 v[40:43], v234 offset:1024
    v_mfma_f32_16x16x32_bf16 v[96:99], v[100:103], v[120:123], v[96:99]
    ds_read_b128 v[44:47], v235 offset:2048
    s_waitcnt vmcnt(6)
    v_mfma_f32_16x16x32_bf16 v[32:35], a[112:115], v[124:127], v[32:35]
    ds_read_b64_tr_b16 a[200:201], v246 offset:45312
    ds_read_b64_tr_b16 a[202:203], v246 offset:45824
    v_mfma_f32_16x16x32_bf16 v[48:51], a[116:119], v[124:127], v[48:51]
    ds_read_b64_tr_b16 a[204:205], v247 offset:45312
    v_mfma_f32_16x16x32_bf16 v[64:67], a[120:123], v[124:127], v[64:67]
    ds_read_b64_tr_b16 a[206:207], v247 offset:45824
    v_mfma_f32_16x16x32_bf16 v[80:83], a[124:127], v[124:127], v[80:83]
    ds_read_b64_tr_b16 a[208:209], v246 offset:61440
    v_mfma_f32_16x16x32_bf16 v[96:99], v[104:107], v[124:127], v[96:99]
    ds_read_b64_tr_b16 a[210:211], v246 offset:61952
    s_waitcnt vmcnt(5)
    v_mfma_f32_16x16x32_bf16 v[32:35], a[128:131], v[128:131], v[32:35]
    ds_read_b64_tr_b16 a[212:213], v247 offset:61440
    ds_read_b64_tr_b16 a[214:215], v247 offset:61952
    v_mfma_f32_16x16x32_bf16 v[48:51], a[132:135], v[128:131], v[48:51]
    ds_read_b64_tr_b16 a[216:217], v246 offset:61696
    v_mfma_f32_16x16x32_bf16 v[64:67], a[136:139], v[128:131], v[64:67]
    ds_read_b64_tr_b16 a[218:219], v246 offset:62208
    v_mfma_f32_16x16x32_bf16 v[80:83], a[140:143], v[128:131], v[80:83]
    ds_read_b64_tr_b16 a[220:221], v247 offset:61696
    v_mfma_f32_16x16x32_bf16 v[96:99], v[108:111], v[128:131], v[96:99]
    ds_read_b64_tr_b16 a[222:223], v247 offset:62208
    s_waitcnt lgkmcnt(15)
    s_waitcnt vmcnt(4)
    v_mfma_f32_16x16x32_bf16 v[32:35], a[144:147], v[132:135], v[32:35]
    v_mfma_f32_16x16x32_bf16 v[48:51], a[148:151], v[132:135], v[48:51]
    v_add_f32 v52, v52, v56
    v_mfma_f32_16x16x32_bf16 v[64:67], a[152:155], v[132:135], v[64:67]
    v_add_f32 v53, v53, v57
    v_mfma_f32_16x16x32_bf16 v[80:83], a[156:159], v[132:135], v[80:83]
    v_add_f32 v54, v54, v58
    v_mfma_f32_16x16x32_bf16 v[96:99], v[84:87], v[132:135], v[96:99]
    s_waitcnt vmcnt(3)
    v_mfma_f32_16x16x32_bf16 v[32:35], a[160:163], v[136:139], v[32:35]
    v_add_f32 v55, v55, v59
    v_mfma_f32_16x16x32_bf16 v[48:51], a[164:167], v[136:139], v[48:51]
    v_add_f32 v52, v52, v60
    v_mfma_f32_16x16x32_bf16 v[64:67], a[168:171], v[136:139], v[64:67]
    v_add_f32 v53, v53, v61
    v_mfma_f32_16x16x32_bf16 v[80:83], a[172:175], v[136:139], v[80:83]
    v_add_f32 v54, v54, v62
    v_mfma_f32_16x16x32_bf16 v[96:99], v[88:91], v[136:139], v[96:99]
    s_waitcnt vmcnt(2)
    v_mfma_f32_16x16x32_bf16 v[32:35], a[176:179], v[140:143], v[32:35]
    v_add_f32 v55, v55, v63
    v_mfma_f32_16x16x32_bf16 v[48:51], a[180:183], v[140:143], v[48:51]
    s_waitcnt lgkmcnt(12)
    v_mfma_f32_16x16x32_bf16 v[64:67], a[184:187], v[140:143], v[64:67]
    v_add_f32 v36, v36, v40
    v_mfma_f32_16x16x32_bf16 v[80:83], a[188:191], v[140:143], v[80:83]
    v_add_f32 v37, v37, v41
    v_mfma_f32_16x16x32_bf16 v[96:99], v[92:95], v[140:143], v[96:99]
    s_waitcnt lgkmcnt(8)
    s_waitcnt vmcnt(1)
    v_mfma_f32_16x16x32_bf16 v[32:35], a[192:195], v[144:147], v[32:35]
    v_add_f32 v38, v38, v42
    v_mfma_f32_16x16x32_bf16 v[48:51], a[196:199], v[144:147], v[48:51]
    v_add_f32 v39, v39, v43
    v_mfma_f32_16x16x32_bf16 v[64:67], a[200:203], v[144:147], v[64:67]
    v_add_f32 v36, v36, v44
    v_mfma_f32_16x16x32_bf16 v[80:83], a[204:207], v[144:147], v[80:83]
    v_add_f32 v37, v37, v45
    v_mfma_f32_16x16x32_bf16 v[96:99], v[68:71], v[144:147], v[96:99]
    s_waitcnt lgkmcnt(0)
    s_waitcnt vmcnt(0)
    v_mfma_f32_16x16x32_bf16 v[32:35], a[208:211], v[148:151], v[32:35]
    v_add_f32 v38, v38, v46
    v_mfma_f32_16x16x32_bf16 v[48:51], a[212:215], v[148:151], v[48:51]
    v_add_f32 v39, v39, v47
    v_mfma_f32_16x16x32_bf16 v[64:67], a[216:219], v[148:151], v[64:67]
    v_mfma_f32_16x16x32_bf16 v[80:83], a[220:223], v[148:151], v[80:83]
    v_mfma_f32_16x16x32_bf16 v[96:99], v[72:75], v[148:151], v[96:99]
    s_nop 1
    v_pk_add_f32 v[32:33], v[32:33], v[36:37]
    v_pk_add_f32 v[34:35], v[34:35], v[38:39]
    v_pk_add_f32 v[48:49], v[48:49], v[52:53]
    v_pk_add_f32 v[50:51], v[50:51], v[54:55]
    ds_write_b128 v238, v[32:35]
    ds_write_b128 v239, v[48:51]
    ds_write_b128 v240, v[64:67]
    ds_write_b128 v241, v[80:83]
    ds_read_b128 v[160:163], v244 offset:0
    ds_read_b128 v[164:167], v245 offset:0
    ds_read_b128 v[168:171], v244 offset:2048
    ds_read_b128 v[172:175], v245 offset:2048
    ds_write_b128 v242, v[96:99]
    ds_read_b128 v[192:195], v252
    s_waitcnt lgkmcnt(4)
    v_pk_add_f32 v[176:177], v[176:177], v[160:161]
    v_pk_add_f32 v[178:179], v[178:179], v[162:163]
    v_pk_add_f32 v[180:181], v[180:181], v[164:165]
    v_pk_add_f32 v[182:183], v[182:183], v[166:167]
    v_cvt_pk_bf16_f32 v216, v176, v177
    v_cvt_pk_bf16_f32 v217, v178, v179
    v_cvt_pk_bf16_f32 v218, v180, v181
    v_cvt_pk_bf16_f32 v219, v182, v183
    buffer_store_dwordx4 v[216:219], v22, s[28:31], s71 offen
    s_waitcnt lgkmcnt(2)
    v_pk_add_f32 v[184:185], v[184:185], v[168:169]
    v_pk_add_f32 v[186:187], v[186:187], v[170:171]
    v_pk_add_f32 v[188:189], v[188:189], v[172:173]
    v_pk_add_f32 v[190:191], v[190:191], v[174:175]
    v_cvt_pk_bf16_f32 v220, v184, v185
    v_cvt_pk_bf16_f32 v221, v186, v187
    v_cvt_pk_bf16_f32 v222, v188, v189
    v_cvt_pk_bf16_f32 v223, v190, v191
    buffer_store_dwordx4 v[220:223], v22, s[28:31], s72 offen
    s_waitcnt lgkmcnt(0)
    v_pk_add_f32 v[248:249], v[248:249], v[192:193]
    v_pk_add_f32 v[250:251], v[250:251], v[194:195]
    v_cvt_pk_bf16_f32 v224, v248, v249
    v_cvt_pk_bf16_f32 v225, v250, v251
    buffer_store_dwordx2 v[224:225], v26, s[28:31], s73 offen
L_end:
    s_endpgm
L_p2_alt:
    s_add_u32 s57, s57, 27648
    buffer_load_dwordx4 v11, s[16:19], s57 offen offset:3072 lds
    s_xor_b32 s66, s44, 3
    s_lshl2_add_u32 s66, s51, s66
    s_mul_i32 s66, s66, 66816
    s_lshl2_add_u32 s66, s52, s66
    s_lshl_b32 s86, s65, 10
    s_add_u32 s58, s86, s66
    s_add_u32 s86, s66, 13312
    buffer_load_dwordx4 v[128:131], v23, s[24:27], s58 offen offset:0 sc1
    s_add_u32 s58, s58, 1024
    s_cmp_eq_u32 s58, s86
    s_cselect_b32 s58, s66, s58
    buffer_load_dwordx4 v[132:135], v23, s[24:27], s58 offen offset:0 sc1
    s_add_u32 s58, s58, 1024
    s_cmp_eq_u32 s58, s86
    s_cselect_b32 s58, s66, s58
    buffer_load_dwordx4 v[136:139], v23, s[24:27], s58 offen offset:0 sc1
    s_add_u32 s58, s58, 1024
    s_cmp_eq_u32 s58, s86
    s_cselect_b32 s58, s66, s58
    buffer_load_dwordx4 v[140:143], v23, s[24:27], s58 offen offset:0 sc1
    s_add_u32 s58, s58, 1024
    s_cmp_eq_u32 s58, s86
    s_cselect_b32 s58, s66, s58
    buffer_load_dwordx4 v[144:147], v23, s[24:27], s58 offen offset:0 sc1
    s_add_u32 s58, s58, 1024
    s_cmp_eq_u32 s58, s86
    s_cselect_b32 s58, s66, s58
    buffer_load_dwordx4 v[148:151], v23, s[24:27], s58 offen offset:0 sc1
    s_add_u32 s58, s58, 1024
    s_cmp_eq_u32 s58, s86
    s_cselect_b32 s58, s66, s58
    buffer_load_dwordx4 v[152:155], v23, s[24:27], s58 offen offset:0 sc1
    s_add_u32 s58, s58, 1024
    s_cmp_eq_u32 s58, s86
    s_cselect_b32 s58, s66, s58
    buffer_load_dwordx4 v[156:159], v23, s[24:27], s58 offen offset:0 sc1
    s_add_u32 s58, s58, 1024
    s_cmp_eq_u32 s58, s86
    s_cselect_b32 s58, s66, s58
    buffer_load_dwordx4 v[112:115], v23, s[24:27], s58 offen offset:0 sc1
    s_add_u32 s58, s58, 1024
    s_cmp_eq_u32 s58, s86
    s_cselect_b32 s58, s66, s58
    buffer_load_dwordx4 v[116:119], v23, s[24:27], s58 offen offset:0 sc1
    s_add_u32 s58, s58, 1024
    s_cmp_eq_u32 s58, s86
    s_cselect_b32 s58, s66, s58
    buffer_load_dwordx4 v[120:123], v23, s[24:27], s58 offen offset:0 sc1
    s_waitcnt vmcnt(19)
    ds_read_b64_tr_b16 a[208:209], v4 offset:32768
    ds_read_b64_tr_b16 a[210:211], v4 offset:33280
    ds_read_b64_tr_b16 a[212:213], v5 offset:32768
    ds_read_b64_tr_b16 a[214:215], v5 offset:33280
    ds_read_b64_tr_b16 a[216:217], v4 offset:33024
    ds_read_b64_tr_b16 a[218:219], v4 offset:33536
    ds_read_b64_tr_b16 a[220:221], v5 offset:33024
    ds_read_b64_tr_b16 a[222:223], v5 offset:33536
    s_waitcnt vmcnt(15)
    ds_read_b64_tr_b16 a[224:225], v2 offset:0
    ds_read_b64_tr_b16 a[226:227], v2 offset:512
    ds_read_b64_tr_b16 a[228:229], v3 offset:0
    ds_read_b64_tr_b16 a[230:231], v3 offset:512
    ds_read_b64_tr_b16 a[232:233], v2 offset:256
    ds_read_b64_tr_b16 a[234:235], v2 offset:768
    ds_read_b64_tr_b16 a[236:237], v3 offset:256
    ds_read_b64_tr_b16 a[238:239], v3 offset:768
    s_waitcnt vmcnt(11)
    ds_read_b64_tr_b16 a[240:241], v2 offset:16384
    ds_read_b64_tr_b16 a[242:243], v2 offset:16896
    ds_read_b64_tr_b16 a[244:245], v3 offset:16384
    ds_read_b64_tr_b16 a[246:247], v3 offset:16896
    ds_read_b64_tr_b16 a[248:249], v2 offset:16640
    ds_read_b64_tr_b16 a[250:251], v2 offset:17152
    ds_read_b64_tr_b16 a[252:253], v3 offset:16640
    ds_read_b64_tr_b16 a[254:255], v3 offset:17152
    s_waitcnt lgkmcnt(0)
    s_branch L_p2_join
L_p3_alt:
    s_add_u32 s66, s69, 175872
    s_add_u32 s58, s66, s76
    buffer_load_dwordx4 v[152:155], v23, s[24:27], s58 offen offset:0 sc1
    buffer_load_dwordx4 v[156:159], v23, s[24:27], s58 offen offset:1024 sc1
    s_add_u32 s58, s66, s77
    buffer_load_dwordx4 v[112:115], v23, s[24:27], s58 offen offset:0 sc1
    buffer_load_dwordx4 v[116:119], v23, s[24:27], s58 offen offset:1024 sc1
    s_add_u32 s58, s66, s78
    buffer_load_dwordx4 v[120:123], v23, s[24:27], s58 offen offset:0 sc1
    buffer_load_dwordx4 v[124:127], v23, s[24:27], s58 offen offset:1024 sc1
    s_add_u32 s58, s66, s79
    buffer_load_dwordx4 v[128:131], v23, s[24:27], s58 offen offset:0 sc1
    buffer_load_dwordx4 v[132:135], v23, s[24:27], s58 offen offset:1024 sc1
    s_add_u32 s58, s66, s80
    buffer_load_dwordx4 v[136:139], v23, s[24:27], s58 offen offset:0 sc1
    buffer_load_dwordx4 v[140:143], v23, s[24:27], s58 offen offset:1024 sc1
    s_add_u32 s58, s66, s81
    buffer_load_dwordx4 v[144:147], v23, s[24:27], s58 offen offset:0 sc1
    s_waitcnt vmcnt(11) lgkmcnt(0)
    s_branch L_p3_join
L_help:
    s_sub_u32 s55, s46, 21
    v_lshlrev_b32 v217, 7, v1
    v_lshrrev_b32 v218, 2, v1
    v_lshlrev_b32 v218, 12, v218
    v_lshl_add_u32 v218, v210, 7, v218
    v_mul_u32_u24 v220, 3584, v1
    s_lshl4_add_u32 s54, s44, s65
    s_mul_i32 s54, s54, 114688
    s_lshl_b32 s56, s50, 7
    s_add_u32 s54, s54, s56
    buffer_load_dword v108, v220, s[16:19], s54 offen
    v_mul_u32_u24 v109, 1088, v25
    v_lshl_add_u32 v109, v26, 4, v109
    v_mul_u32_u24 v110, 1088, v209
    v_lshl_add_u32 v110, v208, 5, v110
    v_lshl_add_u32 v110, v210, 3, v110
    s_lshl_b32 s53, s44, 7
    v_add_u32 v110, s53, v110
    v_mul_u32_u24 v111, 66816, v208
    v_lshl_add_u32 v111, v211, 4, v111
    s_mul_i32 s63, s44, 267264
    s_lshl_b32 s53, s2, 8
    s_add_u32 s63, s63, s53
    s_add_u32 s64, s63, 1069056
    v_cmp_gt_u32 vcc, 208, v0
    v_mov_b32 v100, 2130706432
    v_cmp_le_u32 s[92:93], 24, v26
    v_cndmask_b32 v22, v100, v111, vcc
    s_mov_b32 s62, 0x3f803f80
    s_mov_b32 s61, 0xffff0000
    v_mov_b32 v96, 0
    v_mov_b32 v97, 0
    s_waitcnt vmcnt(3)
    v_dot2c_f32_bf16 v96, s62, v32
    v_dot2c_f32_bf16 v97, v32, v32
    v_lshlrev_b32 v40, 16, v32
    v_and_b32 v41, s61, v32
    v_dot2c_f32_bf16 v96, s62, v33
    v_dot2c_f32_bf16 v97, v33, v33
    v_lshlrev_b32 v42, 16, v33
    v_and_b32 v43, s61, v33
    v_dot2c_f32_bf16 v96, s62, v34
    v_dot2c_f32_bf16 v97, v34, v34
    v_lshlrev_b32 v44, 16, v34
    v_and_b32 v45, s61, v34
    v_dot2c_f32_bf16 v96, s62, v35
    v_dot2c_f32_bf16 v97, v35, v35
    v_lshlrev_b32 v46, 16, v35
    v_and_b32 v47, s61, v35
    s_waitcnt vmcnt(2)
    v_dot2c_f32_bf16 v96, s62, v36
    v_dot2c_f32_bf16 v97, v36, v36
    v_lshlrev_b32 v48, 16, v36
    v_and_b32 v49, s61, v36
    v_dot2c_f32_bf16 v96, s62, v37
    v_dot2c_f32_bf16 v97, v37, v37
    v_lshlrev_b32 v50, 16, v37
    v_and_b32 v51, s61, v37
    v_dot2c_f32_bf16 v96, s62, v38
    v_dot2c_f32_bf16 v97, v38, v38
    v_lshlrev_b32 v52, 16, v38
    v_and_b32 v53, s61, v38
    v_dot2c_f32_bf16 v96, s62, v39
    v_dot2c_f32_bf16 v97, v39, v39
    v_lshlrev_b32 v54, 16, v39
    v_and_b32 v55, s61, v39
    buffer_load_dword v29, off, s[40:43], 0 sc1
    v_add_f32_dpp v96, v96, v96 quad_perm:[1,0,3,2] row_mask:0xf bank_mask:0xf
    v_add_f32_dpp v97, v97, v97 quad_perm:[1,0,3,2] row_mask:0xf bank_mask:0xf
    s_nop 0
    v_add_f32_dpp v96, v96, v96 quad_perm:[2,3,0,1] row_mask:0xf bank_mask:0xf
    v_add_f32_dpp v97, v97, v97 quad_perm:[2,3,0,1] row_mask:0xf bank_mask:0xf
    s_nop 0
    v_add_f32_dpp v96, v96, v96 row_half_mirror row_mask:0xf bank_mask:0xf
    v_add_f32_dpp v97, v97, v97 row_half_mirror row_mask:0xf bank_mask:0xf
    s_nop 0
    v_add_f32_dpp v96, v96, v96 row_mirror row_mask:0xf bank_mask:0xf
    v_add_f32_dpp v97, v97, v97 row_mirror row_mask:0xf bank_mask:0xf
    v_mov_b32 v98, v96
    v_mov_b32 v99, v97
    s_nop 0
    v_permlane16_swap_b32 v96, v98
    v_permlane16_swap_b32 v97, v99
    v_add_f32 v96, v96, v98
    v_add_f32 v97, v97, v99
    v_mul_f32 v98, 0x3b124925, v96
    v_mul_f32 v99, 0x3b124925, v97
    v_fma_f32 v99, -v98, v98, v99
    v_max_f32 v99, 0, v99
    v_cvt_pk_bf16_f32 v100, 0, v99
    v_add_f32 v100, 0x3727c5ac, v100
    v_cvt_pk_bf16_f32 v100, 0, v100
    v_sqrt_f32 v100, v100
    s_nop 0
    v_cvt_pk_bf16_f32 v100, 0, v100
    v_rcp_f32 v100, v100
    s_nop 0
    v_mul_f32 v99, v99, v100
    v_mul_f32 v99, v99, v100
    v_cvt_pk_bf16_f32 v104, 0, v99
    v_add_f32 v104, 0x3727c5ac, v104
    v_cvt_pk_bf16_f32 v104, 0, v104
    v_sqrt_f32 v104, v104
    s_nop 0
    v_cvt_pk_bf16_f32 v102, 0, v104
    v_rcp_f32 v104, v102
    s_nop 0
    v_mul_f32 v104, v104, v100
    v_mul_f32 v106, v98, v104
    v_pk_fma_f32 v[56:57], v[40:41], v[104:105], v[106:107] op_sel_hi:[1,0,0] neg_lo:[0,0,1] neg_hi:[0,0,1]
    v_pk_fma_f32 v[58:59], v[42:43], v[104:105], v[106:107] op_sel_hi:[1,0,0] neg_lo:[0,0,1] neg_hi:[0,0,1]
    v_pk_fma_f32 v[60:61], v[44:45], v[104:105], v[106:107] op_sel_hi:[1,0,0] neg_lo:[0,0,1] neg_hi:[0,0,1]
    v_pk_fma_f32 v[62:63], v[46:47], v[104:105], v[106:107] op_sel_hi:[1,0,0] neg_lo:[0,0,1] neg_hi:[0,0,1]
    v_pk_fma_f32 v[64:65], v[48:49], v[104:105], v[106:107] op_sel_hi:[1,0,0] neg_lo:[0,0,1] neg_hi:[0,0,1]
    v_pk_fma_f32 v[66:67], v[50:51], v[104:105], v[106:107] op_sel_hi:[1,0,0] neg_lo:[0,0,1] neg_hi:[0,0,1]
    v_pk_fma_f32 v[68:69], v[52:53], v[104:105], v[106:107] op_sel_hi:[1,0,0] neg_lo:[0,0,1] neg_hi:[0,0,1]
    v_pk_fma_f32 v[70:71], v[54:55], v[104:105], v[106:107] op_sel_hi:[1,0,0] neg_lo:[0,0,1] neg_hi:[0,0,1]
    v_cvt_pk_bf16_f32 v80, v56, v57
    v_cvt_pk_bf16_f32 v81, v58, v59
    v_cvt_pk_bf16_f32 v82, v60, v61
    v_cvt_pk_bf16_f32 v83, v62, v63
    v_cvt_pk_bf16_f32 v84, v64, v65
    v_cvt_pk_bf16_f32 v85, v66, v67
    v_cvt_pk_bf16_f32 v86, v68, v69
    v_cvt_pk_bf16_f32 v87, v70, v71
    v_lshrrev_b32 v102, 16, v102
    v_cndmask_b32 v84, v84, v102, s[92:93]
    ds_write_b128 v109, v[80:83] offset:0
    ds_write_b128 v109, v[84:87] offset:512
    s_waitcnt lgkmcnt(0)
    s_barrier
    ds_read_b64_tr_b16 v[88:89], v110 offset:0
    ds_read_b64_tr_b16 v[90:91], v110 offset:4352
    ds_read_b64_tr_b16 v[92:93], v110 offset:512
    ds_read_b64_tr_b16 v[94:95], v110 offset:4864
    s_waitcnt lgkmcnt(2)
    buffer_store_dwordx4 v[88:91], v111, s[24:27], s63 offen sc1
    s_waitcnt lgkmcnt(0)
    buffer_store_dwordx4 v[92:95], v22, s[24:27], s64 offen sc1
    v_min_u32 v220, 111104, v220
    s_add_u32 s54, s54, 229376
    buffer_load_dword v108, v220, s[16:19], s54 offen
    s_waitcnt vmcnt(1)
    v_cmp_eq_u32 vcc, 0, v29
    s_nop 0
    s_cbranch_vccz L_ok12
    s_mov_b32 s59, 20000
L_spin11:
    buffer_load_dword v29, off, s[40:43], 0 sc1
    s_waitcnt vmcnt(0)
    v_cmp_eq_u32 vcc, 0, v29
    s_nop 0
    s_cbranch_vccz L_ok12
    s_sub_u32 s59, s59, 1
    s_cbranch_scc0 L_spin11
L_ok12:
    v_readfirstlane_b32 s47, v29
    s_barrier
    s_cmp_lg_u32 s44, 0
    s_cbranch_scc1 L_nopub13
    s_lshl_b32 s60, s2, 5
    s_add_u32 s60, s60, 12582912
    v_mov_b32 v30, s47
    s_mov_b64 exec, 1
    buffer_store_dword v30, off, s[24:27], s60 sc1
    s_mov_b64 exec, -1
L_nopub13:
    buffer_load_dword v108, v217, s[32:35], 0 offen
    v_lshrrev_b32 v219, 2, v1
    v_min_u32 v219, 15, v219
    v_mul_u32_u24 v219, 3584, v219
    v_lshl_add_u32 v219, v210, 7, v219
    s_mul_i32 s54, s55, 16
    s_lshl_b32 s56, s44, 9
    s_add_u32 s54, s54, s56
    s_add_u32 s54, s54, 416
    s_mul_i32 s54, s54, 3584
    s_mul_i32 s56, s45, 7
    s_lshr_b32 s56, s56, 1
    s_lshl_b32 s56, s56, 7
    s_add_u32 s54, s54, s56
    buffer_load_dword v108, v219, s[16:19], s54 offen
    s_add_u32 s54, s54, 172032
    buffer_load_dword v108, v219, s[16:19], s54 offen
    s_add_u32 s54, s54, 172032
    s_mul_i32 s54, s44, 28
    s_add_u32 s54, s54, s55
    s_add_u32 s54, s54, 0
    s_lshl_b32 s54, s54, 16
    s_lshl_b32 s56, s45, 9
    s_add_u32 s54, s54, s56
    buffer_load_dword v108, v218, s[20:23], s54 offen
    s_add_u32 s54, s54, 196608
    buffer_load_dword v108, v218, s[20:23], s54 offen
    s_add_u32 s54, s54, 196608
    buffer_load_dword v108, v218, s[20:23], s54 offen
    s_add_u32 s54, s54, 196608
    buffer_load_dword v108, v218, s[20:23], s54 offen
    s_add_u32 s54, s54, 196608
    buffer_load_dword v108, v217, s[36:39], 0 offen
    s_waitcnt vmcnt(0) lgkmcnt(0)
    v_lshlrev_b32 v216, 6, v209
    v_lshl_add_u32 v216, v210, 3, v216
    v_lshl_add_u32 v216, v215, 5, v216
    s_add_u32 s53, s52, 49152
    v_lshl_add_u32 v2, v208, 10, v216
    v_add_u32 v2, s53, v2
    v_xor_b32 v3, 32, v2
    v_add_u32 v4, 65536, v2
    v_add_u32 v5, 65536, v3
    v_lshl_add_u32 v6, v208, 9, v216
    v_add_u32 v6, s53, v6
    v_xor_b32 v7, 32, v6
    v_add_u32 v8, 65536, v6
    v_add_u32 v9, 65536, v7
    s_lshr_b32 s53, s46, 2
    s_and_b32 s89, s46, 3
    s_bfe_u32 s54, s46, 0x20001
    s_and_b32 s55, s46, 1
    s_add_u32 s55, s55, 4
    s_cmp_lt_u32 s46, 16
    s_cselect_b32 s53, s53, s54
    s_cselect_b32 s89, s89, s55
    s_mul_i32 s49, s53, 2
    s_add_u32 s49, s49, s89
    s_sub_u32 s54, s49, 6
    s_min_u32 s49, s49, s54
    s_or_b32 s89, s89, 0
    s_lshl2_add_u32 s48, s45, s53
    s_mul_i32 s53, s44, 1835008
    s_lshl_b32 s74, s48, 7
    s_add_u32 s53, s53, s74
    s_lshl_b32 s56, s44, 5
    v_lshlrev_b32 v217, 5, v212
    v_xor_b32 v217, v217, v214
    v_xor_b32 v217, s56, v217
    s_add_u32 s74, s74, s56
    v_lshlrev_b32 v12, 12, v213
    v_add3_u32 v12, v12, v217, s53
    s_mul_i32 s53, s44, 100352
    s_lshl_b32 s54, s49, 7
    s_add_u32 s55, s53, s54
    v_mul_u32_u24 v13, 896, v213
    v_add3_u32 v13, v13, v214, s55
    v_xor_b32 v14, 32, v13
    s_mul_i32 s73, s48, 57344
    s_add_u32 s71, s73, s54
    s_mul_i32 s55, s44, 14336
    s_add_u32 s71, s71, s55
    s_add_u32 s72, s71, 7168
    v_bfe_u32 v217, v1, 1, 2
    v_lshl_add_u32 v217, v212, 2, v217
    v_and_b32 v218, 24, v1
    v_add_u32 v217, v217, v218
    v_mul_u32_u24 v15, 896, v217
    v_and_b32 v217, 1, v1
    v_lshl_add_u32 v15, v217, 4, v15
    v_add_u32 v15, s53, v15
    s_lshl_b32 s54, s89, 5
    s_add_u32 s54, s54, 768
    s_add_u32 s68, s89, 24
    s_mul_i32 s68, s68, 58624
    s_mul_i32 s69, s44, 14336
    s_add_u32 s69, s69, 2097152
    s_add_u32 s68, s68, s69
    s_mul_i32 s55, s49, 234496
    s_add_u32 s69, s69, s55
    s_add_u32 s73, s73, s54
    s_mov_b32 s76, 0
    s_add_u32 s77, s76, 2048
    s_cmp_eq_u32 s77, 14336
    s_cselect_b32 s77, 0, s77
    s_add_u32 s78, s77, 2048
    s_cmp_eq_u32 s78, 14336
    s_cselect_b32 s78, 0, s78
    s_add_u32 s79, s78, 2048
    s_cmp_eq_u32 s79, 14336
    s_cselect_b32 s79, 0, s79
    s_add_u32 s80, s79, 2048
    s_cmp_eq_u32 s80, 14336
    s_cselect_b32 s80, 0, s80
    s_add_u32 s81, s80, 2048
    s_cmp_eq_u32 s81, 14336
    s_cselect_b32 s81, 0, s81
    s_add_u32 s82, s81, 2048
    s_cmp_eq_u32 s82, 14336
    s_cselect_b32 s82, 0, s82
    s_cmp_lt_u32 s89, 4
    s_cselect_b32 s75, s54, 2130706432
    s_cselect_b32 s68, s68, 2130706432
    s_cselect_b32 s73, s73, 2130706432
    v_lshlrev_b32 v16, 3, v1
    v_add_u32 v16, 81920, v16
    v_and_b32 v217, 7, v1
    v_min_u32 v218, 6, v217
    s_mul_i32 s54, s44, 7
    v_add_u32 v218, s54, v218
    v_mul_u32_u24 v219, 2, v218
    v_add_u32 v219, s89, v219
    v_mul_u32_u24 v220, 43, v219
    v_lshrrev_b32 v220, 8, v220
    v_mul_u32_u24 v220, 6, v220
    v_sub_u32 v219, v219, v220
    v_subrev_u32 v219, s49, v219
    v_bfe_u32 v220, v1, 3, 1
    v_mul_i32_i24 v219, v219, v220
    v_add_u32 v219, s49, v219
    v_lshl_add_u32 v218, v219, 5, v218
    v_lshlrev_b32 v20, 7, v218
    v_add_u32 v20, 12713984, v20
    s_lshr_b32 s53, s48, 1
    s_lshl_b32 s53, s53, 7
    s_add_u32 s53, s53, 12779520
    v_lshl_add_u32 v21, v210, 11, s53
    s_lshl_b32 s70, s48, 16
    s_lshl2_add_u32 s70, s52, s70
    s_add_u32 s70, s70, 4194304
    v_lshrrev_b32 v218, 3, v1
    v_mul_u32_u24 v22, 896, v218
    v_lshl_add_u32 v22, v217, 4, v22
    v_lshlrev_b32 v25, 1, v211
    s_add_u32 s53, s52, 65536
    v_lshl_add_u32 v244, v218, 8, s53
    v_bfe_u32 v219, v218, 1, 1
    v_lshl_add_u32 v244, v219, 7, v244
    v_xor_b32 v219, v218, v217
    v_lshl_add_u32 v244, v219, 4, v244
    v_xor_b32 v245, 128, v244
    v_xor_b32 v218, v217, v212
    v_lshl_add_u32 v238, v218, 4, s53
    v_bfe_u32 v219, v1, 1, 1
    v_xor_b32 v219, v219, v215
    v_lshl_add_u32 v238, v219, 7, v238
    v_lshl_add_u32 v238, v211, 8, v238
    v_lshrrev_b32 v218, 2, v0
    v_mul_u32_u24 v26, 896, v218
    v_lshl_add_u32 v26, v210, 3, v26
    s_add_u32 s53, s52, 52224
    v_lshrrev_b32 v218, 2, v1
    v_bfe_u32 v219, v218, 1, 2
    v_xor_b32 v219, v219, v210
    v_lshl_add_u32 v252, v218, 6, s53
    v_lshl_add_u32 v252, v219, 4, v252
    v_bfe_u32 v219, v1, 1, 2
    v_xor_b32 v219, v219, v208
    v_lshl_add_u32 v242, v211, 6, s53
    v_lshl_add_u32 v242, v219, 4, v242
    s_sub_u32 s53, 49152, s52
    v_add_u32 v246, s53, v2
    v_add_u32 v247, s53, v3
    v_add_u32 v232, s52, v23
    v_xor_b32 v233, 4096, v232
    v_xor_b32 v234, 8192, v232
    v_xor_b32 v235, 12288, v232
    v_xor_b32 v239, 32, v238
    v_xor_b32 v240, 64, v238
    v_xor_b32 v241, 96, v238
    buffer_load_dwordx4 v[216:219], v22, s[4:7], s71 offen
    buffer_load_dwordx4 v[220:223], v22, s[4:7], s72 offen
    buffer_load_dwordx2 v[224:225], v26, s[4:7], s73 offen
    buffer_load_ushort v228, v25, s[36:39], s74 offen
    s_add_u32 m0, s52, 81920
    s_lshl_b32 s57, s76, 7
    buffer_load_dwordx4 v12, s[20:23], s57 offen offset:0 lds
    s_add_u32 s57, s57, 31744
    buffer_load_dwordx4 v12, s[20:23], s57 offen offset:1024 lds
    s_add_u32 s57, s57, 31744
    buffer_load_dwordx4 v12, s[20:23], s57 offen offset:2048 lds
    s_add_u32 s57, s57, 31744
    buffer_load_dwordx4 v12, s[20:23], s57 offen offset:3072 lds
    s_add_u32 m0, s52, 98304
    s_lshl_b32 s57, s76, 7
    s_add_u32 s57, s57, 131072
    buffer_load_dwordx4 v12, s[20:23], s57 offen offset:0 lds
    s_add_u32 s57, s57, 31744
    buffer_load_dwordx4 v12, s[20:23], s57 offen offset:1024 lds
    s_add_u32 s57, s57, 31744
    buffer_load_dwordx4 v12, s[20:23], s57 offen offset:2048 lds
    s_add_u32 s57, s57, 31744
    buffer_load_dwordx4 v12, s[20:23], s57 offen offset:3072 lds
    s_add_u32 m0, s52, 114688
    s_lshl_b32 s57, s77, 7
    buffer_load_dwordx4 v12, s[20:23], s57 offen offset:0 lds
    s_add_u32 s57, s57, 31744
    buffer_load_dwordx4 v12, s[20:23], s57 offen offset:1024 lds
    s_add_u32 s57, s57, 31744
    buffer_load_dwordx4 v12, s[20:23], s57 offen offset:2048 lds
    s_add_u32 s57, s57, 31744
    buffer_load_dwordx4 v12, s[20:23], s57 offen offset:3072 lds
    s_add_u32 m0, s52, 131072
    s_lshl_b32 s57, s77, 7
    s_add_u32 s57, s57, 131072
    buffer_load_dwordx4 v12, s[20:23], s57 offen offset:0 lds
    s_add_u32 s57, s57, 31744
    buffer_load_dwordx4 v12, s[20:23], s57 offen offset:1024 lds
    s_waitcnt vmcnt(10)
    ds_read_b64_tr_b16 a[0:1], v6 offset:32768
    ds_read_b64_tr_b16 a[2:3], v6 offset:34816
    ds_read_b64_tr_b16 a[4:5], v7 offset:32768
    ds_read_b64_tr_b16 a[6:7], v7 offset:34816
    ds_read_b64_tr_b16 a[8:9], v6 offset:33024
    ds_read_b64_tr_b16 a[10:11], v6 offset:35072
    ds_read_b64_tr_b16 a[12:13], v7 offset:33024
    ds_read_b64_tr_b16 a[14:15], v7 offset:35072
    s_add_u32 s57, s57, 31744
    buffer_load_dwordx4 v12, s[20:23], s57 offen offset:2048 lds
    s_add_u32 s57, s57, 31744
    buffer_load_dwordx4 v12, s[20:23], s57 offen offset:3072 lds
    s_add_u32 m0, s52, 147456
    s_lshl_b32 s57, s78, 7
    buffer_load_dwordx4 v12, s[20:23], s57 offen offset:0 lds
    s_add_u32 s57, s57, 31744
    buffer_load_dwordx4 v12, s[20:23], s57 offen offset:1024 lds
    s_waitcnt vmcnt(10)
    ds_read_b64_tr_b16 a[16:17], v6 offset:49152
    ds_read_b64_tr_b16 a[18:19], v6 offset:51200
    ds_read_b64_tr_b16 a[20:21], v7 offset:49152
    ds_read_b64_tr_b16 a[22:23], v7 offset:51200
    ds_read_b64_tr_b16 a[24:25], v6 offset:49408
    ds_read_b64_tr_b16 a[26:27], v6 offset:51456
    ds_read_b64_tr_b16 a[28:29], v7 offset:49408
    ds_read_b64_tr_b16 a[30:31], v7 offset:51456
    s_add_u32 s57, s57, 31744
    buffer_load_dwordx4 v12, s[20:23], s57 offen offset:2048 lds
    s_add_u32 s57, s57, 31744
    buffer_load_dwordx4 v12, s[20:23], s57 offen offset:3072 lds
    s_add_u32 m0, s52, 49152
    s_lshl_b32 s57, s78, 7
    s_add_u32 s57, s57, 131072
    buffer_load_dwordx4 v12, s[20:23], s57 offen offset:0 lds
    s_add_u32 s57, s57, 31744
    buffer_load_dwordx4 v12, s[20:23], s57 offen offset:1024 lds
    s_waitcnt vmcnt(10)
    ds_read_b64_tr_b16 a[32:33], v8 offset:0
    ds_read_b64_tr_b16 a[34:35], v8 offset:2048
    ds_read_b64_tr_b16 a[36:37], v9 offset:0
    ds_read_b64_tr_b16 a[38:39], v9 offset:2048
    s_add_u32 s57, s57, 31744
    buffer_load_dwordx4 v12, s[20:23], s57 offen offset:2048 lds
    ds_read_b64_tr_b16 a[40:41], v8 offset:256
    ds_read_b64_tr_b16 a[42:43], v8 offset:2304
    ds_read_b64_tr_b16 a[44:45], v9 offset:256
    ds_read_b64_tr_b16 a[46:47], v9 offset:2304
    s_add_u32 s57, s57, 31744
    buffer_load_dwordx4 v12, s[20:23], s57 offen offset:3072 lds
    s_add_u32 m0, s52, 65536
    s_lshl_b32 s57, s79, 7
    buffer_load_dwordx4 v12, s[20:23], s57 offen offset:0 lds
    s_add_u32 s57, s57, 31744
    buffer_load_dwordx4 v12, s[20:23], s57 offen offset:1024 lds
    s_waitcnt vmcnt(10)
    ds_read_b64_tr_b16 a[48:49], v8 offset:16384
    ds_read_b64_tr_b16 a[50:51], v8 offset:18432
    ds_read_b64_tr_b16 a[52:53], v9 offset:16384
    ds_read_b64_tr_b16 a[54:55], v9 offset:18432
    s_add_u32 s57, s57, 31744
    buffer_load_dwordx4 v12, s[20:23], s57 offen offset:2048 lds
    ds_read_b64_tr_b16 a[56:57], v8 offset:16640
    ds_read_b64_tr_b16 a[58:59], v8 offset:18688
    ds_read_b64_tr_b16 a[60:61], v9 offset:16640
    ds_read_b64_tr_b16 a[62:63], v9 offset:18688
    s_add_u32 s57, s57, 31744
    buffer_load_dwordx4 v12, s[20:23], s57 offen offset:3072 lds
    s_waitcnt vmcnt(0) lgkmcnt(0)
    s_branch L_p3join
L_role_a:
    v_lshrrev_b32 v112, 4, v1
    v_bfe_u32 v113, v1, 2, 2
    v_and_b32 v114, 3, v1
    v_and_b32 v115, 15, v1
    v_lshrrev_b32 v116, 5, v1
    s_lshr_b32 s48, s45, 1
    s_and_b32 s53, s45, 1
    s_lshl3_add_u32 s49, s53, s46
    s_sub_u32 s49, s49, 24
    s_lshl_b32 s90, s44, 11
    s_and_b32 s53, s44, 1
    s_lshl_b32 s53, s53, 1
    v_lshlrev_b32 v117, 2, v112
    v_sub_u32 v117, v115, v117
    v_and_b32 v117, 15, v117
    v_xor_b32 v117, s53, v117
    v_mul_u32_u24 v2, 2688, v112
    v_lshl_add_u32 v2, v117, 4, v2
    s_mul_i32 s53, s44, 21504
    s_mul_i32 s54, s48, 224
    s_andn2_b32 s54, s54, 63
    s_add_u32 s53, s53, s54
    v_add_u32 v2, s53, v2
    s_add_u32 m0, s90, 65536
    s_mov_b32 s57, 896
    buffer_load_dwordx4 v2, s[8:11], s57 offen offset:0 lds
    s_mov_b32 s57, 10624
    buffer_load_dwordx4 v2, s[8:11], s57 offen offset:1024 lds
    s_add_u32 m0, s90, 73728
    s_mov_b32 s57, 86912
    buffer_load_dwordx4 v2, s[8:11], s57 offen offset:0 lds
    s_mov_b32 s57, 96640
    buffer_load_dwordx4 v2, s[8:11], s57 offen offset:1024 lds
    v_mul_u32_u24 v109, 1088, v25
    v_lshl_add_u32 v109, v26, 4, v109
    v_mul_u32_u24 v110, 1088, v113
    v_lshl_add_u32 v110, v112, 5, v110
    v_lshl_add_u32 v110, v114, 3, v110
    s_lshl_b32 s53, s44, 7
    v_add_u32 v110, s53, v110
    v_mul_u32_u24 v111, 66816, v112
    v_lshl_add_u32 v111, v115, 4, v111
    s_mul_i32 s63, s44, 267264
    s_lshl_b32 s53, s2, 8
    s_add_u32 s63, s63, s53
    s_add_u32 s64, s63, 1069056
    v_cmp_gt_u32 vcc, 208, v0
    v_mov_b32 v100, 2130706432
    v_cmp_le_u32 s[92:93], 24, v26
    v_cndmask_b32 v22, v100, v111, vcc
    s_mov_b32 s62, 0x3f803f80
    s_mov_b32 s61, 0xffff0000
    v_mov_b32 v96, 0
    v_mov_b32 v97, 0
    v_and_b32 v117, 1, v112
    v_lshlrev_b32 v117, 5, v117
    s_mul_i32 s53, s44, 56
    s_and_b32 s54, s48, 1
    s_lshl_b32 s54, s54, 5
    s_add_u32 s53, s53, s54
    v_lshlrev_b32 v118, 11, v112
    v_lshl_add_u32 v118, v113, 8, v118
    v_add_u32 v118, 65536, v118
    v_lshl_add_u32 v119, v114, 3, s53
    v_add_u32 v119, 0, v119
    v_xor_b32 v119, v119, v117
    v_lshl_add_u32 v119, v113, 6, v119
    v_and_b32 v119, 255, v119
    v_add_u32 v6, v118, v119
    v_add_u32 v10, 49152, v6
    v_subrev_u32 v120, 65536, v6
    v_lshl_add_u32 v119, v114, 3, s53
    v_add_u32 v119, 32, v119
    v_xor_b32 v119, v119, v117
    v_lshl_add_u32 v119, v113, 6, v119
    v_and_b32 v119, 255, v119
    v_add_u32 v7, v118, v119
    v_add_u32 v11, 49152, v7
    v_subrev_u32 v121, 65536, v7
    v_lshl_add_u32 v119, v114, 4, s53
    v_add_u32 v119, 0, v119
    v_xor_b32 v119, v119, v117
    v_lshl_add_u32 v119, v113, 6, v119
    v_and_b32 v119, 255, v119
    v_add_u32 v8, v118, v119
    v_add_u32 v12, 49152, v8
    v_subrev_u32 v122, 65536, v8
    v_lshl_add_u32 v119, v114, 4, s53
    v_add_u32 v119, 8, v119
    v_xor_b32 v119, v119, v117
    v_lshl_add_u32 v119, v113, 6, v119
    v_and_b32 v119, 255, v119
    v_add_u32 v9, v118, v119
    v_add_u32 v13, 49152, v9
    v_subrev_u32 v123, 65536, v9
    s_waitcnt vmcnt(6)
    v_dot2c_f32_bf16 v96, s62, v32
    v_dot2c_f32_bf16 v97, v32, v32
    v_lshlrev_b32 v40, 16, v32
    v_and_b32 v41, s61, v32
    v_dot2c_f32_bf16 v96, s62, v33
    v_dot2c_f32_bf16 v97, v33, v33
    v_lshlrev_b32 v42, 16, v33
    v_and_b32 v43, s61, v33
    v_dot2c_f32_bf16 v96, s62, v34
    v_dot2c_f32_bf16 v97, v34, v34
    v_lshlrev_b32 v44, 16, v34
    v_and_b32 v45, s61, v34
    v_dot2c_f32_bf16 v96, s62, v35
    v_dot2c_f32_bf16 v97, v35, v35
    v_lshlrev_b32 v46, 16, v35
    v_and_b32 v47, s61, v35
    s_waitcnt vmcnt(5)
    v_dot2c_f32_bf16 v96, s62, v36
    v_dot2c_f32_bf16 v97, v36, v36
    v_lshlrev_b32 v48, 16, v36
    v_and_b32 v49, s61, v36
    v_dot2c_f32_bf16 v96, s62, v37
    v_dot2c_f32_bf16 v97, v37, v37
    v_lshlrev_b32 v50, 16, v37
    v_and_b32 v51, s61, v37
    v_dot2c_f32_bf16 v96, s62, v38
    v_dot2c_f32_bf16 v97, v38, v38
    v_lshlrev_b32 v52, 16, v38
    v_and_b32 v53, s61, v38
    v_dot2c_f32_bf16 v96, s62, v39
    v_dot2c_f32_bf16 v97, v39, v39
    v_lshlrev_b32 v54, 16, v39
    v_and_b32 v55, s61, v39
    buffer_load_dword v29, off, s[40:43], 0 sc1
    v_add_f32_dpp v96, v96, v96 quad_perm:[1,0,3,2] row_mask:0xf bank_mask:0xf
    v_add_f32_dpp v97, v97, v97 quad_perm:[1,0,3,2] row_mask:0xf bank_mask:0xf
    s_nop 0
    v_add_f32_dpp v96, v96, v96 quad_perm:[2,3,0,1] row_mask:0xf bank_mask:0xf
    v_add_f32_dpp v97, v97, v97 quad_perm:[2,3,0,1] row_mask:0xf bank_mask:0xf
    s_nop 0
    v_add_f32_dpp v96, v96, v96 row_half_mirror row_mask:0xf bank_mask:0xf
    v_add_f32_dpp v97, v97, v97 row_half_mirror row_mask:0xf bank_mask:0xf
    s_nop 0
    v_add_f32_dpp v96, v96, v96 row_mirror row_mask:0xf bank_mask:0xf
    v_add_f32_dpp v97, v97, v97 row_mirror row_mask:0xf bank_mask:0xf
    v_mov_b32 v98, v96
    v_mov_b32 v99, v97
    s_nop 0
    v_permlane16_swap_b32 v96, v98
    v_permlane16_swap_b32 v97, v99
    v_add_f32 v96, v96, v98
    v_add_f32 v97, v97, v99
    v_mul_f32 v98, 0x3b124925, v96
    v_mul_f32 v99, 0x3b124925, v97
    v_fma_f32 v99, -v98, v98, v99
    v_max_f32 v99, 0, v99
    v_cvt_pk_bf16_f32 v100, 0, v99
    v_add_f32 v100, 0x3727c5ac, v100
    v_cvt_pk_bf16_f32 v100, 0, v100
    v_sqrt_f32 v100, v100
    s_nop 0
    v_cvt_pk_bf16_f32 v100, 0, v100
    v_rcp_f32 v100, v100
    s_nop 0
    v_mul_f32 v99, v99, v100
    v_mul_f32 v99, v99, v100
    v_cvt_pk_bf16_f32 v104, 0, v99
    v_add_f32 v104, 0x3727c5ac, v104
    v_cvt_pk_bf16_f32 v104, 0, v104
    v_sqrt_f32 v104, v104
    s_nop 0
    v_cvt_pk_bf16_f32 v102, 0, v104
    v_rcp_f32 v104, v102
    s_nop 0
    v_mul_f32 v104, v104, v100
    v_mul_f32 v106, v98, v104
    v_pk_fma_f32 v[56:57], v[40:41], v[104:105], v[106:107] op_sel_hi:[1,0,0] neg_lo:[0,0,1] neg_hi:[0,0,1]
    v_pk_fma_f32 v[58:59], v[42:43], v[104:105], v[106:107] op_sel_hi:[1,0,0] neg_lo:[0,0,1] neg_hi:[0,0,1]
    v_pk_fma_f32 v[60:61], v[44:45], v[104:105], v[106:107] op_sel_hi:[1,0,0] neg_lo:[0,0,1] neg_hi:[0,0,1]
    v_pk_fma_f32 v[62:63], v[46:47], v[104:105], v[106:107] op_sel_hi:[1,0,0] neg_lo:[0,0,1] neg_hi:[0,0,1]
    v_pk_fma_f32 v[64:65], v[48:49], v[104:105], v[106:107] op_sel_hi:[1,0,0] neg_lo:[0,0,1] neg_hi:[0,0,1]
    v_pk_fma_f32 v[66:67], v[50:51], v[104:105], v[106:107] op_sel_hi:[1,0,0] neg_lo:[0,0,1] neg_hi:[0,0,1]
    v_pk_fma_f32 v[68:69], v[52:53], v[104:105], v[106:107] op_sel_hi:[1,0,0] neg_lo:[0,0,1] neg_hi:[0,0,1]
    v_pk_fma_f32 v[70:71], v[54:55], v[104:105], v[106:107] op_sel_hi:[1,0,0] neg_lo:[0,0,1] neg_hi:[0,0,1]
    v_cvt_pk_bf16_f32 v80, v56, v57
    v_cvt_pk_bf16_f32 v81, v58, v59
    v_cvt_pk_bf16_f32 v82, v60, v61
    v_cvt_pk_bf16_f32 v83, v62, v63
    v_cvt_pk_bf16_f32 v84, v64, v65
    v_cvt_pk_bf16_f32 v85, v66, v67
    v_cvt_pk_bf16_f32 v86, v68, v69
    v_cvt_pk_bf16_f32 v87, v70, v71
    v_lshrrev_b32 v102, 16, v102
    v_cndmask_b32 v84, v84, v102, s[92:93]
    ds_write_b128 v109, v[80:83] offset:49152
    ds_write_b128 v109, v[84:87] offset:49664
    s_waitcnt lgkmcnt(0)
    s_barrier
    ds_read_b64_tr_b16 v[88:89], v110 offset:49152
    ds_read_b64_tr_b16 v[90:91], v110 offset:53504
    ds_read_b64_tr_b16 v[92:93], v110 offset:49664
    ds_read_b64_tr_b16 v[94:95], v110 offset:54016
    s_waitcnt lgkmcnt(2)
    buffer_store_dwordx4 v[88:91], v111, s[24:27], s63 offen sc1
    s_waitcnt lgkmcnt(0)
    buffer_store_dwordx4 v[92:95], v22, s[24:27], s64 offen sc1
    s_add_u32 m0, s90, 81920
    s_mov_b32 s57, 172928
    buffer_load_dwordx4 v2, s[8:11], s57 offen offset:0 lds
    s_movk_i32 s94, 224
    v_mul_u32_u24 v3, 66816, v116
    v_and_b32 v118, 1, v112
    v_lshlrev_b32 v119, 2, v118
    v_xor_b32 v119, v119, v115
    v_lshl_add_u32 v3, v118, 8, v3
    v_lshl_add_u32 v3, v119, 4, v3
    v_cmp_gt_u32 s[92:93], s94, v0
    v_mov_b32 v119, 2130706432
    s_mov_b32 s57, 182656
    buffer_load_dwordx4 v2, s[8:11], s57 offen offset:1024 lds
    v_lshlrev_b32 v4, 9, v116
    v_cndmask_b32 v24, v119, v3, s[92:93]
    v_lshl_add_u32 v4, v118, 7, v4
    v_lshl_add_u32 v4, v113, 4, v4
    v_lshrrev_b32 v118, 1, v114
    v_mul_u32_u24 v118, 320, v118
    v_add_u32 v4, v118, v4
    v_and_b32 v118, 1, v114
    v_lshl_add_u32 v4, v118, 3, v4
    v_xor_b32 v25, 64, v4
    s_lshl_b32 s53, s49, 4
    s_sub_u32 s53, s53, 2
    v_min_u32 v117, 17, v1
    v_add_u32 v117, s53, v117
    v_max_i32 v117, 0, v117
    v_lshlrev_b32 v19, 5, v117
    s_add_u32 m0, s90, 90112
    s_mov_b32 s57, 258944
    buffer_load_dwordx4 v2, s[8:11], s57 offen offset:0 lds
    v_add_u32 v19, 12582912, v19
    v_and_b32 v117, 1, v115
    v_cmp_eq_u32 s[76:77], 1, v117
    v_lshl_add_u32 v117, v112, 2, v117
    v_cmp_le_u32 s[78:79], v117, v115
    v_mul_u32_u24 v118, 304, v116
    v_lshl_add_u32 v93, v117, 1, v118
    v_add_u32 v117, 2, v117
    v_cmp_le_u32 s[80:81], v117, v115
    v_add_u32 v94, 4, v93
    v_mov_b32 v118, 14336
    v_mov_b32 v119, 30720
    v_cndmask_b32 v117, v118, v119, s[78:79]
    v_add_u32 v93, v117, v93
    v_cndmask_b32 v117, v118, v119, s[80:81]
    v_add_u32 v94, v117, v94
    s_mov_b32 s57, 268672
    buffer_load_dwordx4 v2, s[8:11], s57 offen offset:1024 lds
    v_lshrrev_b32 v117, 3, v115
    v_mul_u32_u24 v117, 304, v117
    v_lshl_add_u32 v92, v115, 1, v117
    v_add_u32 v92, v119, v92
    v_cmp_eq_u32 s[82:83], 3, v112
    v_mov_b32 v117, 0xffff
    v_mov_b32 v118, 0xffff0000
    v_cndmask_b32 v117, v117, v118, s[76:77]
    v_cndmask_b32 v14, v117, 0, s[78:79]
    v_cndmask_b32 v15, v117, 0, s[80:81]
    v_cndmask_b32 v16, 0, v117, s[78:79]
    v_cndmask_b32 v17, 0, v117, s[80:81]
    s_mov_b32 s91, 0x3e8b97f6
    v_mov_b32 v18, 0xf149f2ca
    s_lshl_b32 s53, s49, 3
    s_lshl_b32 s72, s53, 9
    s_add_u32 m0, s90, 98304
    s_mov_b32 s57, 344960
    buffer_load_dwordx4 v2, s[8:11], s57 offen offset:0 lds
    s_lshl_b32 s74, s53, 14
    s_lshl2_add_u32 s54, s48, s44
    s_lshl_b32 s54, s54, 10
    s_add_u32 s74, s74, s54
    s_add_u32 s74, s74, 4194304
    s_mul_i32 s68, s44, 534528
    s_add_u32 s68, s68, 0
    s_mul_i32 s69, s44, 534528
    s_add_u32 s69, s69, 132608
    s_mul_i32 s70, s44, 534528
    s_add_u32 s70, s70, 265216
    s_mul_i32 s71, s44, 534528
    s_add_u32 s71, s71, 397824
    s_cmp_eq_u32 s44, 3
    s_cselect_b32 s71, 2130706432, s71
    s_cmp_eq_u32 s49, 0
    s_cselect_b64 s[84:85], -1, 0
    s_andn2_b64 s[86:87], s[84:85], s[80:81]
    s_andn2_b64 s[84:85], s[84:85], s[78:79]
    s_and_b32 s53, s46, 7
    s_mul_i32 s54, s44, 28
    s_add_u32 s54, s54, s53
    s_add_u32 s54, s54, 12
    s_lshl_b32 s73, s54, 16
    s_lshl_b32 s54, s45, 9
    s_add_u32 s73, s73, s54
    s_lshl3_add_u32 s75, s44, s53
    s_lshl_b32 s75, s75, 13
    v_lshrrev_b32 v5, 2, v1
    v_lshlrev_b32 v5, 12, v5
    v_lshl_add_u32 v5, v114, 7, v5
    v_lshlrev_b32 v20, 7, v1
    s_mov_b32 s57, 354688
    buffer_load_dwordx4 v2, s[8:11], s57 offen offset:1024 lds
    s_add_u32 m0, s90, 106496
    s_mov_b32 s57, 430976
    buffer_load_dwordx4 v2, s[8:11], s57 offen offset:0 lds
    s_mov_b32 s57, 440704
    buffer_load_dwordx4 v2, s[8:11], s57 offen offset:1024 lds
    s_add_u32 m0, s90, 114688
    s_mov_b32 s57, 516992
    buffer_load_dwordx4 v2, s[8:11], s57 offen offset:0 lds
    s_mov_b32 s57, 526720
    buffer_load_dwordx4 v2, s[8:11], s57 offen offset:1024 lds
    s_add_u32 m0, s90, 122880
    s_mov_b32 s57, 603008
    buffer_load_dwordx4 v2, s[8:11], s57 offen offset:0 lds
    s_mov_b32 s57, 612736
    buffer_load_dwordx4 v2, s[8:11], s57 offen offset:1024 lds
    s_add_u32 m0, s90, 131072
    s_mov_b32 s57, 689024
    buffer_load_dwordx4 v2, s[8:11], s57 offen offset:0 lds
    s_mov_b32 s57, 698752
    buffer_load_dwordx4 v2, s[8:11], s57 offen offset:1024 lds
    s_add_u32 m0, s90, 139264
    s_mov_b32 s57, 775040
    buffer_load_dwordx4 v2, s[8:11], s57 offen offset:0 lds
    s_mov_b32 s57, 784768
    buffer_load_dwordx4 v2, s[8:11], s57 offen offset:1024 lds
    s_add_u32 m0, s90, 147456
    s_mov_b32 s57, 861056
    buffer_load_dwordx4 v2, s[8:11], s57 offen offset:0 lds
    s_mov_b32 s57, 870784
    buffer_load_dwordx4 v2, s[8:11], s57 offen offset:1024 lds
    s_add_u32 m0, s90, 155648
    s_mov_b32 s57, 947072
    buffer_load_dwordx4 v2, s[8:11], s57 offen offset:0 lds
    s_mov_b32 s57, 956800
    buffer_load_dwordx4 v2, s[8:11], s57 offen offset:1024 lds
    s_waitcnt vmcnt(20)
    v_cmp_eq_u32 vcc, 0, v29
    s_nop 0
    s_cbranch_vccz L_ok15
    s_mov_b32 s59, 20000
L_spin14:
    buffer_load_dword v29, off, s[40:43], 0 sc1
    s_waitcnt vmcnt(0)
    v_cmp_eq_u32 vcc, 0, v29
    s_nop 0
    s_cbranch_vccz L_ok15
    s_sub_u32 s59, s59, 1
    s_cbranch_scc0 L_spin14
L_ok15:
    v_readfirstlane_b32 s47, v29
    s_barrier
    s_cmp_lg_u32 s44, 0
    s_cbranch_scc1 L_nopub16
    s_lshl_b32 s60, s2, 5
    s_add_u32 s60, s60, 12582912
    v_mov_b32 v30, s47
    s_mov_b64 exec, 1
    buffer_store_dword v30, off, s[24:27], s60 sc1
    s_mov_b64 exec, -1
L_nopub16:
    s_waitcnt vmcnt(18)
    s_barrier
    s_add_u32 m0, s90, 0
    s_mov_b32 s57, 1033088
    buffer_load_dwordx4 v2, s[8:11], s57 offen offset:0 lds
    s_mov_b32 s57, 1042816
    buffer_load_dwordx4 v2, s[8:11], s57 offen offset:1024 lds
    ds_read_b64_tr_b16 a[8:9], v6 offset:0
    ds_read_b64_tr_b16 a[10:11], v6 offset:1024
    ds_read_b64_tr_b16 a[12:13], v7 offset:0
    ds_read_b64_tr_b16 a[14:15], v7 offset:1024
    s_add_u32 m0, s90, 8192
    s_mov_b32 s57, 1119104
    buffer_load_dwordx4 v2, s[8:11], s57 offen offset:0 lds
    s_mov_b32 s57, 1128832
    buffer_load_dwordx4 v2, s[8:11], s57 offen offset:1024 lds
    ds_read_b64_tr_b16 a[32:33], v6 offset:8192
    ds_read_b64_tr_b16 a[34:35], v6 offset:9216
    ds_read_b64_tr_b16 a[36:37], v7 offset:8192
    ds_read_b64_tr_b16 a[38:39], v7 offset:9216
    s_add_u32 m0, s90, 16384
    s_mov_b32 s57, 1792
    buffer_load_dwordx4 v2, s[8:11], s57 offen offset:0 lds
    s_mov_b32 s57, 11520
    buffer_load_dwordx4 v2, s[8:11], s57 offen offset:1024 lds
    ds_read_b64_tr_b16 a[56:57], v6 offset:16384
    ds_read_b64_tr_b16 a[58:59], v6 offset:17408
    ds_read_b64_tr_b16 a[60:61], v7 offset:16384
    ds_read_b64_tr_b16 a[62:63], v7 offset:17408
    s_waitcnt vmcnt(18)
    s_waitcnt lgkmcnt(0)
    s_barrier
    s_add_u32 m0, s90, 24576
    s_mov_b32 s57, 87808
    buffer_load_dwordx4 v2, s[8:11], s57 offen offset:0 lds
    s_mov_b32 s57, 97536
    buffer_load_dwordx4 v2, s[8:11], s57 offen offset:1024 lds
    ds_read_b64_tr_b16 a[80:81], v6 offset:24576
    ds_read_b64_tr_b16 a[82:83], v6 offset:25600
    ds_read_b64_tr_b16 a[84:85], v7 offset:24576
    ds_read_b64_tr_b16 a[86:87], v7 offset:25600
    s_add_u32 m0, s90, 32768
    s_mov_b32 s57, 173824
    buffer_load_dwordx4 v2, s[8:11], s57 offen offset:0 lds
    s_mov_b32 s57, 183552
    buffer_load_dwordx4 v2, s[8:11], s57 offen offset:1024 lds
    ds_read_b64_tr_b16 a[104:105], v6 offset:32768
    ds_read_b64_tr_b16 a[106:107], v6 offset:33792
    ds_read_b64_tr_b16 a[108:109], v7 offset:32768
    ds_read_b64_tr_b16 a[110:111], v7 offset:33792
    s_add_u32 m0, s90, 40960
    s_mov_b32 s57, 259840
    buffer_load_dwordx4 v2, s[8:11], s57 offen offset:0 lds
    s_mov_b32 s57, 269568
    buffer_load_dwordx4 v2, s[8:11], s57 offen offset:1024 lds
    ds_read_b64_tr_b16 a[128:129], v6 offset:40960
    ds_read_b64_tr_b16 a[130:131], v6 offset:41984
    ds_read_b64_tr_b16 a[132:133], v7 offset:40960
    ds_read_b64_tr_b16 a[134:135], v7 offset:41984
    s_waitcnt vmcnt(18)
    s_waitcnt lgkmcnt(0)
    s_barrier
    s_add_u32 m0, s90, 65536
    s_mov_b32 s57, 345856
    buffer_load_dwordx4 v2, s[8:11], s57 offen offset:0 lds
    s_mov_b32 s57, 355584
    buffer_load_dwordx4 v2, s[8:11], s57 offen offset:1024 lds
    ds_read_b64_tr_b16 a[152:153], v10 offset:0
    ds_read_b64_tr_b16 a[154:155], v10 offset:1024
    ds_read_b64_tr_b16 a[156:157], v11 offset:0
    ds_read_b64_tr_b16 a[158:159], v11 offset:1024
    s_add_u32 m0, s90, 73728
    s_mov_b32 s57, 431872
    buffer_load_dwordx4 v2, s[8:11], s57 offen offset:0 lds
    s_mov_b32 s57, 441600
    buffer_load_dwordx4 v2, s[8:11], s57 offen offset:1024 lds
    ds_read_b64_tr_b16 a[176:177], v10 offset:8192
    ds_read_b64_tr_b16 a[178:179], v10 offset:9216
    ds_read_b64_tr_b16 a[180:181], v11 offset:8192
    ds_read_b64_tr_b16 a[182:183], v11 offset:9216
    s_add_u32 m0, s90, 81920
    s_mov_b32 s57, 517888
    buffer_load_dwordx4 v2, s[8:11], s57 offen offset:0 lds
    s_mov_b32 s57, 527616
    buffer_load_dwordx4 v2, s[8:11], s57 offen offset:1024 lds
    ds_read_b64_tr_b16 a[200:201], v10 offset:16384
    ds_read_b64_tr_b16 a[202:203], v10 offset:17408
    ds_read_b64_tr_b16 a[204:205], v11 offset:16384
    ds_read_b64_tr_b16 a[206:207], v11 offset:17408
    s_waitcnt vmcnt(18)
    s_waitcnt lgkmcnt(0)
    s_barrier
    s_add_u32 m0, s90, 90112
    s_mov_b32 s57, 603904
    buffer_load_dwordx4 v2, s[8:11], s57 offen offset:0 lds
    s_mov_b32 s57, 613632
    buffer_load_dwordx4 v2, s[8:11], s57 offen offset:1024 lds
    ds_read_b64_tr_b16 a[224:225], v10 offset:24576
    ds_read_b64_tr_b16 a[226:227], v10 offset:25600
    ds_read_b64_tr_b16 a[228:229], v11 offset:24576
    ds_read_b64_tr_b16 a[230:231], v11 offset:25600
    s_add_u32 m0, s90, 98304
    s_mov_b32 s57, 689920
    buffer_load_dwordx4 v2, s[8:11], s57 offen offset:0 lds
    s_mov_b32 s57, 699648
    buffer_load_dwordx4 v2, s[8:11], s57 offen offset:1024 lds
    ds_read_b64_tr_b16 a[248:249], v10 offset:32768
    ds_read_b64_tr_b16 a[250:251], v10 offset:33792
    ds_read_b64_tr_b16 a[252:253], v11 offset:32768
    ds_read_b64_tr_b16 a[254:255], v11 offset:33792
    s_add_u32 m0, s90, 106496
    s_mov_b32 s57, 775936
    buffer_load_dwordx4 v2, s[8:11], s57 offen offset:0 lds
    s_mov_b32 s57, 785664
    buffer_load_dwordx4 v2, s[8:11], s57 offen offset:1024 lds
    ds_read_b64_tr_b16 v[192:193], v10 offset:40960
    ds_read_b64_tr_b16 v[194:195], v10 offset:41984
    ds_read_b64_tr_b16 v[196:197], v11 offset:40960
    ds_read_b64_tr_b16 v[198:199], v11 offset:41984
    s_waitcnt vmcnt(18)
    s_waitcnt lgkmcnt(0)
    s_barrier
    ds_read_b64_tr_b16 v[216:217], v120 offset:0
    ds_read_b64_tr_b16 v[218:219], v120 offset:1024
    ds_read_b64_tr_b16 v[220:221], v121 offset:0
    ds_read_b64_tr_b16 v[222:223], v121 offset:1024
    ds_read_b64_tr_b16 v[240:241], v120 offset:8192
    ds_read_b64_tr_b16 v[242:243], v120 offset:9216
    ds_read_b64_tr_b16 v[244:245], v121 offset:8192
    ds_read_b64_tr_b16 v[246:247], v121 offset:9216
    buffer_load_dword v21, v19, s[24:27], 0 offen sc1
    ds_read_b64_tr_b16 a[16:17], v122 offset:16384
    ds_read_b64_tr_b16 a[18:19], v122 offset:17408
    ds_read_b64_tr_b16 a[20:21], v123 offset:16384
    ds_read_b64_tr_b16 a[22:23], v123 offset:17408
    s_add_u32 m0, s90, 114688
    s_mov_b32 s57, 861952
    buffer_load_dwordx4 v2, s[8:11], s57 offen offset:0 lds
    s_waitcnt vmcnt(14)
    s_waitcnt lgkmcnt(0)
    s_barrier
    ds_read_b64_tr_b16 a[40:41], v122 offset:24576
    ds_read_b64_tr_b16 a[42:43], v122 offset:25600
    ds_read_b64_tr_b16 a[44:45], v123 offset:24576
    ds_read_b64_tr_b16 a[46:47], v123 offset:25600
    ds_read_b64_tr_b16 a[64:65], v122 offset:32768
    ds_read_b64_tr_b16 a[66:67], v122 offset:33792
    ds_read_b64_tr_b16 a[68:69], v123 offset:32768
    ds_read_b64_tr_b16 a[70:71], v123 offset:33792
    ds_read_b64_tr_b16 a[88:89], v122 offset:40960
    ds_read_b64_tr_b16 a[90:91], v122 offset:41984
    ds_read_b64_tr_b16 a[92:93], v123 offset:40960
    ds_read_b64_tr_b16 a[94:95], v123 offset:41984
    s_mov_b32 s57, 871680
    buffer_load_dwordx4 v2, s[8:11], s57 offen offset:1024 lds
    s_add_u32 m0, s90, 122880
    s_mov_b32 s57, 947968
    buffer_load_dwordx4 v2, s[8:11], s57 offen offset:0 lds
    s_mov_b32 s57, 957696
    buffer_load_dwordx4 v2, s[8:11], s57 offen offset:1024 lds
    s_add_u32 m0, s90, 131072
    s_mov_b32 s57, 1033984
    buffer_load_dwordx4 v2, s[8:11], s57 offen offset:0 lds
    s_waitcnt vmcnt(12)
    s_waitcnt lgkmcnt(0)
    s_barrier
    ds_read_b64_tr_b16 a[112:113], v8 offset:0
    ds_read_b64_tr_b16 a[114:115], v8 offset:1024
    ds_read_b64_tr_b16 a[116:117], v9 offset:0
    ds_read_b64_tr_b16 a[118:119], v9 offset:1024
    ds_read_b64_tr_b16 a[136:137], v8 offset:8192
    ds_read_b64_tr_b16 a[138:139], v8 offset:9216
    ds_read_b64_tr_b16 a[140:141], v9 offset:8192
    ds_read_b64_tr_b16 a[142:143], v9 offset:9216
    ds_read_b64_tr_b16 a[160:161], v8 offset:16384
    ds_read_b64_tr_b16 a[162:163], v8 offset:17408
    ds_read_b64_tr_b16 a[164:165], v9 offset:16384
    ds_read_b64_tr_b16 a[166:167], v9 offset:17408
    s_mov_b32 s57, 1043712
    buffer_load_dwordx4 v2, s[8:11], s57 offen offset:1024 lds
    s_waitcnt vmcnt(6)
    v_cmp_ne_u32 vcc, s47, v21
    s_nop 0
    s_cbranch_vccz L_ok18
    s_mov_b32 s59, 20000
L_spin17:
    buffer_load_dword v21, v19, s[24:27], 0 offen sc1
    s_waitcnt vmcnt(0)
    v_cmp_ne_u32 vcc, s47, v21
    s_nop 0
    s_cbranch_vccz L_ok18
    s_sub_u32 s59, s59, 1
    s_cbranch_scc0 L_spin17
L_ok18:
    s_add_u32 m0, s52, 0
    s_sub_u32 s58, s72, 512
    s_max_i32 s58, s58, 0
    s_add_u32 s57, s58, s68
    buffer_load_dwordx4 v3, s[24:27], s57 offen offset:0 sc1 lds
    s_add_u32 s57, s58, s69
    buffer_load_dwordx4 v3, s[24:27], s57 offen offset:1024 sc1 lds
    s_add_u32 s57, s58, s70
    buffer_load_dwordx4 v24, s[24:27], s57 offen offset:2048 sc1 lds
    s_add_u32 s57, s58, s71
    buffer_load_dwordx4 v3, s[24:27], s57 offen offset:3072 sc1 lds
    s_add_u32 m0, s52, 16384
    s_add_u32 s58, s72, 0
    s_add_u32 s57, s58, s68
    buffer_load_dwordx4 v3, s[24:27], s57 offen offset:0 sc1 lds
    s_waitcnt lgkmcnt(0)
    s_barrier
    ds_read_b64_tr_b16 a[184:185], v8 offset:24576
    ds_read_b64_tr_b16 a[186:187], v8 offset:25600
    ds_read_b64_tr_b16 a[188:189], v9 offset:24576
    ds_read_b64_tr_b16 a[190:191], v9 offset:25600
    ds_read_b64_tr_b16 a[208:209], v8 offset:32768
    ds_read_b64_tr_b16 a[210:211], v8 offset:33792
    ds_read_b64_tr_b16 a[212:213], v9 offset:32768
    ds_read_b64_tr_b16 a[214:215], v9 offset:33792
    ds_read_b64_tr_b16 a[232:233], v8 offset:40960
    ds_read_b64_tr_b16 a[234:235], v8 offset:41984
    ds_read_b64_tr_b16 a[236:237], v9 offset:40960
    ds_read_b64_tr_b16 a[238:239], v9 offset:41984
    s_add_u32 s57, s58, s69
    buffer_load_dwordx4 v3, s[24:27], s57 offen offset:1024 sc1 lds
    s_add_u32 s57, s58, s70
    buffer_load_dwordx4 v24, s[24:27], s57 offen offset:2048 sc1 lds
    s_add_u32 s57, s58, s71
    buffer_load_dwordx4 v3, s[24:27], s57 offen offset:3072 sc1 lds
    s_add_u32 m0, s90, 139264
    s_mov_b32 s57, 1120000
    buffer_load_dwordx4 v2, s[8:11], s57 offen offset:0 lds
    s_mov_b32 s57, 1129728
    buffer_load_dwordx4 v2, s[8:11], s57 offen offset:1024 lds
    s_add_u32 m0, s90, 147456
    s_mov_b32 s57, 0
    buffer_load_dwordx4 v2, s[8:11], s57 offen offset:0 lds
    s_mov_b32 s57, 9728
    buffer_load_dwordx4 v2, s[8:11], s57 offen offset:1024 lds
    s_add_u32 m0, s90, 155648
    s_mov_b32 s57, 86016
    buffer_load_dwordx4 v2, s[8:11], s57 offen offset:0 lds
    s_mov_b32 s57, 95744
    buffer_load_dwordx4 v2, s[8:11], s57 offen offset:1024 lds
    s_add_u32 m0, s52, 32768
    s_add_u32 s58, s72, 512
    s_add_u32 s57, s58, s68
    buffer_load_dwordx4 v3, s[24:27], s57 offen offset:0 sc1 lds
    s_add_u32 s57, s58, s69
    buffer_load_dwordx4 v3, s[24:27], s57 offen offset:1024 sc1 lds
    s_waitcnt vmcnt(12)
    s_waitcnt lgkmcnt(0)
    s_barrier
    ds_read_b64_tr_b16 v[120:121], v4 offset:0
    ds_read_b64_tr_b16 v[122:123], v25 offset:0
    ds_read_b64_tr_b16 v[124:125], v4 offset:1024
    ds_read_b64_tr_b16 v[126:127], v25 offset:1024
    ds_read_b64_tr_b16 v[128:129], v4 offset:2048
    ds_read_b64_tr_b16 v[130:131], v25 offset:2048
    ds_read_b64_tr_b16 v[132:133], v4 offset:3072
    ds_read_b64_tr_b16 v[134:135], v25 offset:3072
    ds_read_b64_tr_b16 v[136:137], v4 offset:4096
    ds_read_b64_tr_b16 v[138:139], v25 offset:4096
    ds_read_b64_tr_b16 v[140:141], v4 offset:5120
    ds_read_b64_tr_b16 v[142:143], v25 offset:5120
    ds_read_b64_tr_b16 v[144:145], v4 offset:6144
    ds_read_b64_tr_b16 v[146:147], v25 offset:6144
    ds_read_b64_tr_b16 v[148:149], v4 offset:7168
    ds_read_b64_tr_b16 v[150:151], v25 offset:7168
    ds_read_b64_tr_b16 v[152:153], v4 offset:8192
    ds_read_b64_tr_b16 v[154:155], v25 offset:8192
    ds_read_b64_tr_b16 v[156:157], v4 offset:9216
    ds_read_b64_tr_b16 v[158:159], v25 offset:9216
    ds_read_b64_tr_b16 v[160:161], v4 offset:10240
    ds_read_b64_tr_b16 v[162:163], v25 offset:10240
    ds_read_b64_tr_b16 v[164:165], v4 offset:11264
    ds_read_b64_tr_b16 v[166:167], v25 offset:11264
    ds_read_b64_tr_b16 v[168:169], v4 offset:12288
    ds_read_b64_tr_b16 v[170:171], v25 offset:12288
    ds_read_b64_tr_b16 v[172:173], v4 offset:13312
    ds_read_b64_tr_b16 v[174:175], v25 offset:13312
    s_waitcnt lgkmcnt(15)
    v_mfma_f32_16x16x32_bf16 v[96:99], a[8:11], v[120:123], 0
    s_add_u32 s57, s58, s70
    ds_read_b64_tr_b16 v[176:177], v12 offset:0
    v_mfma_f32_16x16x32_bf16 v[96:99], a[32:35], v[124:127], v[96:99]
    buffer_load_dwordx4 v24, s[24:27], s57 offen offset:2048 sc1 lds
    v_mfma_f32_16x16x32_bf16 v[96:99], a[56:59], v[128:131], v[96:99]
    ds_read_b64_tr_b16 v[178:179], v12 offset:1024
    ds_read_b64_tr_b16 v[180:181], v13 offset:0
    v_mfma_f32_16x16x32_bf16 v[96:99], a[80:83], v[132:135], v[96:99]
    ds_read_b64_tr_b16 v[182:183], v13 offset:1024
    ds_read_b64_tr_b16 v[200:201], v12 offset:8192
    v_mfma_f32_16x16x32_bf16 v[96:99], a[104:107], v[136:139], v[96:99]
    s_add_u32 s57, s58, s71
    ds_read_b64_tr_b16 v[202:203], v12 offset:9216
    v_mfma_f32_16x16x32_bf16 v[96:99], a[128:131], v[140:143], v[96:99]
    buffer_load_dwordx4 v3, s[24:27], s57 offen offset:3072 sc1 lds
    s_waitcnt lgkmcnt(15)
    v_mfma_f32_16x16x32_bf16 v[96:99], a[152:155], v[144:147], v[96:99]
    ds_read_b64_tr_b16 v[204:205], v13 offset:8192
    ds_read_b64_tr_b16 v[206:207], v13 offset:9216
    v_mfma_f32_16x16x32_bf16 v[96:99], a[176:179], v[148:151], v[96:99]
    ds_read_b64_tr_b16 v[224:225], v12 offset:16384
    ds_read_b64_tr_b16 v[226:227], v12 offset:17408
    v_mfma_f32_16x16x32_bf16 v[96:99], a[200:203], v[152:155], v[96:99]
    s_add_u32 m0, s90, 65536
    s_mov_b32 s57, 172032
    ds_read_b64_tr_b16 v[228:229], v13 offset:16384
    s_waitcnt lgkmcnt(15)
    v_mfma_f32_16x16x32_bf16 v[96:99], a[224:227], v[156:159], v[96:99]
    buffer_load_dwordx4 v2, s[8:11], s57 offen offset:0 lds
    v_mfma_f32_16x16x32_bf16 v[96:99], a[248:251], v[160:163], v[96:99]
    ds_read_b64_tr_b16 v[230:231], v13 offset:17408
    v_mfma_f32_16x16x32_bf16 v[96:99], v[192:195], v[164:167], v[96:99]
    s_waitcnt lgkmcnt(12)
    v_mfma_f32_16x16x32_bf16 v[96:99], v[216:219], v[168:171], v[96:99]
    s_mov_b32 s57, 181760
    v_mfma_f32_16x16x32_bf16 v[96:99], v[240:243], v[172:175], v[96:99]
    buffer_load_dwordx4 v2, s[8:11], s57 offen offset:1024 lds
    s_waitcnt vmcnt(12)
    s_barrier
    v_mfma_f32_16x16x32_bf16 v[100:103], a[12:15], v[120:123], 0
    ds_read_b64_tr_b16 v[120:121], v4 offset:16384
    ds_read_b64_tr_b16 v[122:123], v25 offset:16384
    v_mfma_f32_16x16x32_bf16 v[100:103], a[36:39], v[124:127], v[100:103]
    ds_read_b64_tr_b16 v[124:125], v4 offset:17408
    ds_read_b64_tr_b16 v[126:127], v25 offset:17408
    v_mfma_f32_16x16x32_bf16 v[100:103], a[60:63], v[128:131], v[100:103]
    ds_read_b64_tr_b16 v[128:129], v4 offset:18432
    ds_read_b64_tr_b16 v[130:131], v25 offset:18432
    s_add_u32 m0, s90, 73728
    s_mov_b32 s57, 258048
    v_mfma_f32_16x16x32_bf16 v[100:103], a[84:87], v[132:135], v[100:103]
    ds_read_b64_tr_b16 v[132:133], v4 offset:19456
    ds_read_b64_tr_b16 v[134:135], v25 offset:19456
    buffer_load_dwordx4 v2, s[8:11], s57 offen offset:0 lds
    v_mfma_f32_16x16x32_bf16 v[100:103], a[108:111], v[136:139], v[100:103]
    ds_read_b64_tr_b16 v[136:137], v4 offset:20480
    ds_read_b64_tr_b16 v[138:139], v25 offset:20480
    v_mfma_f32_16x16x32_bf16 v[100:103], a[132:135], v[140:143], v[100:103]
    ds_read_b64_tr_b16 v[140:141], v4 offset:21504
    ds_read_b64_tr_b16 v[142:143], v25 offset:21504
    v_mfma_f32_16x16x32_bf16 v[100:103], a[156:159], v[144:147], v[100:103]
    ds_read_b64_tr_b16 v[144:145], v4 offset:22528
    ds_read_b64_tr_b16 v[146:147], v25 offset:22528
    s_mov_b32 s57, 267776
    v_mfma_f32_16x16x32_bf16 v[100:103], a[180:183], v[148:151], v[100:103]
    ds_read_b64_tr_b16 v[148:149], v4 offset:23552
    ds_read_b64_tr_b16 v[150:151], v25 offset:23552
    buffer_load_dwordx4 v2, s[8:11], s57 offen offset:1024 lds
    v_mfma_f32_16x16x32_bf16 v[100:103], a[204:207], v[152:155], v[100:103]
    ds_read_b64_tr_b16 v[152:153], v4 offset:24576
    ds_read_b64_tr_b16 v[154:155], v25 offset:24576
    v_mfma_f32_16x16x32_bf16 v[100:103], a[228:231], v[156:159], v[100:103]
    ds_read_b64_tr_b16 v[156:157], v4 offset:25600
    ds_read_b64_tr_b16 v[158:159], v25 offset:25600
    v_mfma_f32_16x16x32_bf16 v[100:103], a[252:255], v[160:163], v[100:103]
    ds_read_b64_tr_b16 v[160:161], v4 offset:26624
    ds_read_b64_tr_b16 v[162:163], v25 offset:26624
    s_add_u32 m0, s90, 81920
    s_mov_b32 s57, 344064
    v_mfma_f32_16x16x32_bf16 v[100:103], v[196:199], v[164:167], v[100:103]
    ds_read_b64_tr_b16 v[164:165], v4 offset:27648
    ds_read_b64_tr_b16 v[166:167], v25 offset:27648
    buffer_load_dwordx4 v2, s[8:11], s57 offen offset:0 lds
    v_mfma_f32_16x16x32_bf16 v[100:103], v[220:223], v[168:171], v[100:103]
    ds_read_b64_tr_b16 v[168:169], v4 offset:28672
    ds_read_b64_tr_b16 v[170:171], v25 offset:28672
    v_mfma_f32_16x16x32_bf16 v[100:103], v[244:247], v[172:175], v[100:103]
    ds_read_b64_tr_b16 v[172:173], v4 offset:29696
    ds_read_b64_tr_b16 v[174:175], v25 offset:29696
    s_waitcnt lgkmcnt(15)
    v_mfma_f32_16x16x32_bf16 v[104:107], a[8:11], v[120:123], 0
    s_mov_b32 s57, 353792
    v_cvt_pk_bf16_f32 v52, v96, v97
    v_mfma_f32_16x16x32_bf16 v[104:107], a[32:35], v[124:127], v[104:107]
    buffer_load_dwordx4 v2, s[8:11], s57 offen offset:1024 lds
    v_mfma_f32_16x16x32_bf16 v[104:107], a[56:59], v[128:131], v[104:107]
    v_cvt_pk_bf16_f32 v53, v98, v99
    v_mfma_f32_16x16x32_bf16 v[104:107], a[80:83], v[132:135], v[104:107]
    s_waitcnt vmcnt(10)
    s_barrier
    v_mfma_f32_16x16x32_bf16 v[104:107], a[104:107], v[136:139], v[104:107]
    s_add_u32 m0, s90, 90112
    s_mov_b32 s57, 430080
    ds_read_b64_tr_b16 v[248:249], v12 offset:24576
    v_mfma_f32_16x16x32_bf16 v[104:107], a[128:131], v[140:143], v[104:107]
    buffer_load_dwordx4 v2, s[8:11], s57 offen offset:0 lds
    s_waitcnt lgkmcnt(11)
    v_mfma_f32_16x16x32_bf16 v[104:107], a[152:155], v[144:147], v[104:107]
    v_cvt_pk_bf16_f32 v54, v100, v101
    v_cvt_pk_bf16_f32 v55, v102, v103
    v_mfma_f32_16x16x32_bf16 v[104:107], a[176:179], v[148:151], v[104:107]
    v_cndmask_b32 v54, v54, 0, s[82:83]
    v_cndmask_b32 v55, v55, 0, s[82:83]
    v_mfma_f32_16x16x32_bf16 v[104:107], a[200:203], v[152:155], v[104:107]
    s_mov_b32 s57, 439808
    ds_read_b64_tr_b16 v[250:251], v12 offset:25600
    s_waitcnt lgkmcnt(6)
    v_mfma_f32_16x16x32_bf16 v[104:107], a[224:227], v[156:159], v[104:107]
    buffer_load_dwordx4 v2, s[8:11], s57 offen offset:1024 lds
    v_mfma_f32_16x16x32_bf16 v[104:107], a[248:251], v[160:163], v[104:107]
    ds_read_b64_tr_b16 v[252:253], v13 offset:24576
    ds_read_b64_tr_b16 v[254:255], v13 offset:25600
    v_mfma_f32_16x16x32_bf16 v[104:107], v[192:195], v[164:167], v[104:107]
    ds_read_b64_tr_b16 a[0:1], v10 offset:32768
    ds_read_b64_tr_b16 a[2:3], v10 offset:33792
    s_waitcnt lgkmcnt(6)
    v_mfma_f32_16x16x32_bf16 v[104:107], v[216:219], v[168:171], v[104:107]
    s_add_u32 m0, s90, 98304
    s_mov_b32 s57, 516096
    ds_read_b64_tr_b16 a[4:5], v11 offset:32768
    v_mfma_f32_16x16x32_bf16 v[104:107], v[240:243], v[172:175], v[104:107]
    buffer_load_dwordx4 v2, s[8:11], s57 offen offset:0 lds
    s_waitcnt vmcnt(9)
    s_barrier
    v_mfma_f32_16x16x32_bf16 v[108:111], a[12:15], v[120:123], 0
    ds_read_b64_tr_b16 v[120:121], v4 offset:32768
    ds_read_b64_tr_b16 v[122:123], v25 offset:32768
    v_mfma_f32_16x16x32_bf16 v[108:111], a[36:39], v[124:127], v[108:111]
    ds_read_b64_tr_b16 v[124:125], v4 offset:33792
    ds_read_b64_tr_b16 v[126:127], v25 offset:33792
    v_mfma_f32_16x16x32_bf16 v[108:111], a[60:63], v[128:131], v[108:111]
    ds_read_b64_tr_b16 v[128:129], v4 offset:34816
    ds_read_b64_tr_b16 v[130:131], v25 offset:34816
    s_mov_b32 s57, 525824
    v_mfma_f32_16x16x32_bf16 v[108:111], a[84:87], v[132:135], v[108:111]
    ds_read_b64_tr_b16 v[132:133], v4 offset:35840
    ds_read_b64_tr_b16 v[134:135], v25 offset:35840
    buffer_load_dwordx4 v2, s[8:11], s57 offen offset:1024 lds
    v_mfma_f32_16x16x32_bf16 v[108:111], a[108:111], v[136:139], v[108:111]
    ds_read_b64_tr_b16 v[136:137], v4 offset:36864
    ds_read_b64_tr_b16 v[138:139], v25 offset:36864
    v_mfma_f32_16x16x32_bf16 v[108:111], a[132:135], v[140:143], v[108:111]
    ds_read_b64_tr_b16 v[140:141], v4 offset:37888
    ds_read_b64_tr_b16 v[142:143], v25 offset:37888
    v_mfma_f32_16x16x32_bf16 v[108:111], a[156:159], v[144:147], v[108:111]
    ds_read_b64_tr_b16 v[144:145], v4 offset:38912
    ds_read_b64_tr_b16 v[146:147], v25 offset:38912
    s_add_u32 m0, s90, 106496
    s_mov_b32 s57, 602112
    v_mfma_f32_16x16x32_bf16 v[108:111], a[180:183], v[148:151], v[108:111]
    ds_read_b64_tr_b16 v[148:149], v4 offset:39936
    ds_read_b64_tr_b16 v[150:151], v25 offset:39936
    buffer_load_dwordx4 v2, s[8:11], s57 offen offset:0 lds
    v_mfma_f32_16x16x32_bf16 v[108:111], a[204:207], v[152:155], v[108:111]
    ds_read_b64_tr_b16 v[152:153], v4 offset:40960
    ds_read_b64_tr_b16 v[154:155], v25 offset:40960
    v_mfma_f32_16x16x32_bf16 v[108:111], a[228:231], v[156:159], v[108:111]
    ds_read_b64_tr_b16 v[156:157], v4 offset:41984
    ds_read_b64_tr_b16 v[158:159], v25 offset:41984
    v_mfma_f32_16x16x32_bf16 v[108:111], a[252:255], v[160:163], v[108:111]
    ds_read_b64_tr_b16 v[160:161], v4 offset:43008
    ds_read_b64_tr_b16 v[162:163], v25 offset:43008
    s_mov_b32 s57, 611840
    v_mfma_f32_16x16x32_bf16 v[108:111], v[196:199], v[164:167], v[108:111]
    ds_read_b64_tr_b16 v[164:165], v4 offset:44032
    ds_read_b64_tr_b16 v[166:167], v25 offset:44032
    buffer_load_dwordx4 v2, s[8:11], s57 offen offset:1024 lds
    v_mfma_f32_16x16x32_bf16 v[108:111], v[220:223], v[168:171], v[108:111]
    ds_read_b64_tr_b16 v[168:169], v4 offset:45056
    ds_read_b64_tr_b16 v[170:171], v25 offset:45056
    v_mfma_f32_16x16x32_bf16 v[108:111], v[244:247], v[172:175], v[108:111]
    ds_read_b64_tr_b16 v[172:173], v4 offset:46080
    ds_read_b64_tr_b16 v[174:175], v25 offset:46080
    s_waitcnt lgkmcnt(15)
    v_mfma_f32_16x16x32_bf16 v[112:115], a[8:11], v[120:123], 0
    s_add_u32 m0, s90, 114688
    s_mov_b32 s57, 688128
    v_cvt_pk_bf16_f32 v56, v104, v105
    v_mfma_f32_16x16x32_bf16 v[112:115], a[32:35], v[124:127], v[112:115]
    buffer_load_dwordx4 v2, s[8:11], s57 offen offset:0 lds
    v_mfma_f32_16x16x32_bf16 v[112:115], a[56:59], v[128:131], v[112:115]
    v_cvt_pk_bf16_f32 v57, v106, v107
    ds_read_b64_tr_b16 a[6:7], v11 offset:33792
    v_mfma_f32_16x16x32_bf16 v[112:115], a[80:83], v[132:135], v[112:115]
    ds_read_b64_tr_b16 a[24:25], v10 offset:40960
    ds_read_b64_tr_b16 a[26:27], v10 offset:41984
    v_mfma_f32_16x16x32_bf16 v[112:115], a[104:107], v[136:139], v[112:115]
    s_mov_b32 s57, 697856
    ds_read_b64_tr_b16 a[28:29], v11 offset:40960
    v_mfma_f32_16x16x32_bf16 v[112:115], a[128:131], v[140:143], v[112:115]
    buffer_load_dwordx4 v2, s[8:11], s57 offen offset:1024 lds
    s_waitcnt lgkmcnt(14)
    v_mfma_f32_16x16x32_bf16 v[112:115], a[152:155], v[144:147], v[112:115]
    v_cvt_pk_bf16_f32 v58, v108, v109
    v_cvt_pk_bf16_f32 v59, v110, v111
    v_mfma_f32_16x16x32_bf16 v[112:115], a[176:179], v[148:151], v[112:115]
    v_cndmask_b32 v58, v58, 0, s[82:83]
    v_cndmask_b32 v59, v59, 0, s[82:83]
    v_mfma_f32_16x16x32_bf16 v[112:115], a[200:203], v[152:155], v[112:115]
    s_add_u32 m0, s90, 122880
    s_mov_b32 s57, 774144
    ds_read_b64_tr_b16 a[30:31], v11 offset:41984
    s_waitcnt lgkmcnt(9)
    v_mfma_f32_16x16x32_bf16 v[112:115], a[224:227], v[156:159], v[112:115]
    buffer_load_dwordx4 v2, s[8:11], s57 offen offset:0 lds
    v_mfma_f32_16x16x32_bf16 v[112:115], a[248:251], v[160:163], v[112:115]
    v_mfma_f32_16x16x32_bf16 v[112:115], v[192:195], v[164:167], v[112:115]
    s_waitcnt lgkmcnt(5)
    v_mfma_f32_16x16x32_bf16 v[112:115], v[216:219], v[168:171], v[112:115]
    s_mov_b32 s57, 783872
    v_mfma_f32_16x16x32_bf16 v[112:115], v[240:243], v[172:175], v[112:115]
    buffer_load_dwordx4 v2, s[8:11], s57 offen offset:1024 lds
    v_mfma_f32_16x16x32_bf16 v[116:119], a[12:15], v[120:123], 0
    v_mfma_f32_16x16x32_bf16 v[116:119], a[36:39], v[124:127], v[116:119]
    s_waitcnt vmcnt(10)
    s_waitcnt lgkmcnt(0)
    s_barrier
    v_mfma_f32_16x16x32_bf16 v[116:119], a[60:63], v[128:131], v[116:119]
    s_add_u32 m0, s90, 131072
    s_mov_b32 s57, 860160
    ds_read_b64_tr_b16 a[48:49], v6 offset:0
    v_mfma_f32_16x16x32_bf16 v[116:119], a[84:87], v[132:135], v[116:119]
    buffer_load_dwordx4 v2, s[8:11], s57 offen offset:0 lds
    v_mfma_f32_16x16x32_bf16 v[116:119], a[108:111], v[136:139], v[116:119]
    ds_read_b64_tr_b16 a[50:51], v6 offset:1024
    ds_read_b64_tr_b16 a[52:53], v7 offset:0
    v_mfma_f32_16x16x32_bf16 v[116:119], a[132:135], v[140:143], v[116:119]
    ds_read_b64_tr_b16 a[54:55], v7 offset:1024
    ds_read_b64_tr_b16 a[72:73], v6 offset:8192
    v_mfma_f32_16x16x32_bf16 v[116:119], a[156:159], v[144:147], v[116:119]
    s_mov_b32 s57, 869888
    v_cvt_pk_bf16_f32 v60, v112, v113
    v_mfma_f32_16x16x32_bf16 v[116:119], a[180:183], v[148:151], v[116:119]
    buffer_load_dwordx4 v2, s[8:11], s57 offen offset:1024 lds
    v_mfma_f32_16x16x32_bf16 v[116:119], a[204:207], v[152:155], v[116:119]
    v_cvt_pk_bf16_f32 v61, v114, v115
    ds_read_b64_tr_b16 a[74:75], v6 offset:9216
    v_mfma_f32_16x16x32_bf16 v[116:119], a[228:231], v[156:159], v[116:119]
    ds_read_b64_tr_b16 a[76:77], v7 offset:8192
    ds_read_b64_tr_b16 a[78:79], v7 offset:9216
    v_mfma_f32_16x16x32_bf16 v[116:119], a[252:255], v[160:163], v[116:119]
    s_add_u32 m0, s90, 139264
    s_mov_b32 s57, 946176
    ds_read_b64_tr_b16 a[96:97], v6 offset:16384
    v_mfma_f32_16x16x32_bf16 v[116:119], v[196:199], v[164:167], v[116:119]
    buffer_load_dwordx4 v2, s[8:11], s57 offen offset:0 lds
    v_mfma_f32_16x16x32_bf16 v[116:119], v[220:223], v[168:171], v[116:119]
    ds_read_b64_tr_b16 a[98:99], v6 offset:17408
    ds_read_b64_tr_b16 a[100:101], v7 offset:16384
    v_mfma_f32_16x16x32_bf16 v[116:119], v[244:247], v[172:175], v[116:119]
    ds_read_b64_tr_b16 a[102:103], v7 offset:17408
    v_mfma_f32_16x16x32_bf16 v[96:99], v[120:123], a[16:19], 0
    s_mov_b32 s57, 955904
    v_mfma_f32_16x16x32_bf16 v[96:99], v[124:127], a[40:43], v[96:99]
    buffer_load_dwordx4 v2, s[8:11], s57 offen offset:1024 lds
    v_mfma_f32_16x16x32_bf16 v[96:99], v[128:131], a[64:67], v[96:99]
    v_mfma_f32_16x16x32_bf16 v[96:99], v[132:135], a[88:91], v[96:99]
    v_mfma_f32_16x16x32_bf16 v[96:99], v[136:139], a[112:115], v[96:99]
    s_add_u32 m0, s90, 147456
    s_mov_b32 s57, 1032192
    v_mfma_f32_16x16x32_bf16 v[96:99], v[140:143], a[136:139], v[96:99]
    buffer_load_dwordx4 v2, s[8:11], s57 offen offset:0 lds
    v_mfma_f32_16x16x32_bf16 v[96:99], v[144:147], a[160:163], v[96:99]
    v_cvt_pk_bf16_f32 v62, v116, v117
    v_cvt_pk_bf16_f32 v63, v118, v119
    v_mfma_f32_16x16x32_bf16 v[96:99], v[148:151], a[184:187], v[96:99]
    v_cndmask_b32 v62, v62, 0, s[82:83]
    v_cndmask_b32 v63, v63, 0, s[82:83]
    v_mfma_f32_16x16x32_bf16 v[96:99], v[152:155], a[208:211], v[96:99]
    s_mov_b32 s57, 1041920
    v_mfma_f32_16x16x32_bf16 v[96:99], v[156:159], a[232:235], v[96:99]
    buffer_load_dwordx4 v2, s[8:11], s57 offen offset:1024 lds
    v_mfma_f32_16x16x32_bf16 v[96:99], v[160:163], v[176:179], v[96:99]
    v_mfma_f32_16x16x32_bf16 v[96:99], v[164:167], v[200:203], v[96:99]
    s_waitcnt vmcnt(10)
    s_waitcnt lgkmcnt(0)
    s_barrier
    v_mfma_f32_16x16x32_bf16 v[96:99], v[168:171], v[224:227], v[96:99]
    s_add_u32 m0, s90, 155648
    s_mov_b32 s57, 1118208
    ds_read_b64_tr_b16 a[120:121], v6 offset:24576
    v_mfma_f32_16x16x32_bf16 v[96:99], v[172:175], v[248:251], v[96:99]
    buffer_load_dwordx4 v2, s[8:11], s57 offen offset:0 lds
    v_mfma_f32_16x16x32_bf16 v[100:103], v[120:123], a[20:23], 0
    ds_read_b64_tr_b16 v[120:121], v4 offset:16384
    ds_read_b64_tr_b16 v[122:123], v25 offset:16384
    v_mfma_f32_16x16x32_bf16 v[100:103], v[124:127], a[44:47], v[100:103]
    ds_read_b64_tr_b16 v[124:125], v4 offset:17408
    ds_read_b64_tr_b16 v[126:127], v25 offset:17408
    v_mfma_f32_16x16x32_bf16 v[100:103], v[128:131], a[68:71], v[100:103]
    ds_read_b64_tr_b16 v[128:129], v4 offset:18432
    ds_read_b64_tr_b16 v[130:131], v25 offset:18432
    s_mov_b32 s57, 1127936
    v_mfma_f32_16x16x32_bf16 v[100:103], v[132:135], a[92:95], v[100:103]
    ds_read_b64_tr_b16 v[132:133], v4 offset:19456
    ds_read_b64_tr_b16 v[134:135], v25 offset:19456
    buffer_load_dwordx4 v2, s[8:11], s57 offen offset:1024 lds
    v_mfma_f32_16x16x32_bf16 v[100:103], v[136:139], a[116:119], v[100:103]
    ds_read_b64_tr_b16 v[136:137], v4 offset:20480
    ds_read_b64_tr_b16 v[138:139], v25 offset:20480
    v_mfma_f32_16x16x32_bf16 v[100:103], v[140:143], a[140:143], v[100:103]
    ds_read_b64_tr_b16 v[140:141], v4 offset:21504
    ds_read_b64_tr_b16 v[142:143], v25 offset:21504
    v_mfma_f32_16x16x32_bf16 v[100:103], v[144:147], a[164:167], v[100:103]
    ds_read_b64_tr_b16 v[144:145], v4 offset:22528
    ds_read_b64_tr_b16 v[146:147], v25 offset:22528
    s_add_u32 m0, s52, 49152
    s_add_u32 s58, s72, 1024
    s_add_u32 s57, s58, s68
    v_mfma_f32_16x16x32_bf16 v[100:103], v[148:151], a[188:191], v[100:103]
    ds_read_b64_tr_b16 v[148:149], v4 offset:23552
    ds_read_b64_tr_b16 v[150:151], v25 offset:23552
    buffer_load_dwordx4 v3, s[24:27], s57 offen offset:0 sc1 lds
    v_mfma_f32_16x16x32_bf16 v[100:103], v[152:155], a[212:215], v[100:103]
    ds_read_b64_tr_b16 v[152:153], v4 offset:24576
    ds_read_b64_tr_b16 v[154:155], v25 offset:24576
    v_mfma_f32_16x16x32_bf16 v[100:103], v[156:159], a[236:239], v[100:103]
    ds_read_b64_tr_b16 v[156:157], v4 offset:25600
    ds_read_b64_tr_b16 v[158:159], v25 offset:25600
    v_mfma_f32_16x16x32_bf16 v[100:103], v[160:163], v[180:183], v[100:103]
    ds_read_b64_tr_b16 v[160:161], v4 offset:26624
    ds_read_b64_tr_b16 v[162:163], v25 offset:26624
    s_add_u32 s57, s58, s69
    v_mfma_f32_16x16x32_bf16 v[100:103], v[164:167], v[204:207], v[100:103]
    ds_read_b64_tr_b16 v[164:165], v4 offset:27648
    ds_read_b64_tr_b16 v[166:167], v25 offset:27648
    buffer_load_dwordx4 v3, s[24:27], s57 offen offset:1024 sc1 lds
    v_mfma_f32_16x16x32_bf16 v[100:103], v[168:171], v[228:231], v[100:103]
    ds_read_b64_tr_b16 v[168:169], v4 offset:28672
    ds_read_b64_tr_b16 v[170:171], v25 offset:28672
    v_mfma_f32_16x16x32_bf16 v[100:103], v[172:175], v[252:255], v[100:103]
    ds_read_b64_tr_b16 v[172:173], v4 offset:29696
    ds_read_b64_tr_b16 v[174:175], v25 offset:29696
    s_waitcnt lgkmcnt(15)
    v_mfma_f32_16x16x32_bf16 v[104:107], v[120:123], a[16:19], 0
    s_add_u32 s57, s58, s70
    v_cvt_pk_bf16_f32 v36, v96, v97
    v_mfma_f32_16x16x32_bf16 v[104:107], v[124:127], a[40:43], v[104:107]
    buffer_load_dwordx4 v24, s[24:27], s57 offen offset:2048 sc1 lds
    v_mfma_f32_16x16x32_bf16 v[104:107], v[128:131], a[64:67], v[104:107]
    v_cvt_pk_bf16_f32 v37, v98, v99
    ds_read_b64_tr_b16 a[122:123], v6 offset:25600
    v_mfma_f32_16x16x32_bf16 v[104:107], v[132:135], a[88:91], v[104:107]
    ds_read_b64_tr_b16 a[124:125], v7 offset:24576
    ds_read_b64_tr_b16 a[126:127], v7 offset:25600
    v_mfma_f32_16x16x32_bf16 v[104:107], v[136:139], a[112:115], v[104:107]
    s_add_u32 s57, s58, s71
    ds_read_b64_tr_b16 a[144:145], v6 offset:32768
    v_mfma_f32_16x16x32_bf16 v[104:107], v[140:143], a[136:139], v[104:107]
    buffer_load_dwordx4 v3, s[24:27], s57 offen offset:3072 sc1 lds
    s_waitcnt lgkmcnt(14)
    v_mfma_f32_16x16x32_bf16 v[104:107], v[144:147], a[160:163], v[104:107]
    v_cvt_pk_bf16_f32 v46, v100, v101
    v_cvt_pk_bf16_f32 v47, v102, v103
    v_mfma_f32_16x16x32_bf16 v[104:107], v[148:151], a[184:187], v[104:107]
    ds_read_b64_tr_b16 a[146:147], v6 offset:33792
    ds_read_b64_tr_b16 a[148:149], v7 offset:32768
    v_mfma_f32_16x16x32_bf16 v[104:107], v[152:155], a[208:211], v[104:107]
    ds_read_b64_tr_b16 a[150:151], v7 offset:33792
    ds_read_b64_tr_b16 a[168:169], v6 offset:40960
    s_waitcnt lgkmcnt(12)
    v_mfma_f32_16x16x32_bf16 v[104:107], v[156:159], a[232:235], v[104:107]
    ds_read_b64_tr_b16 a[170:171], v6 offset:41984
    ds_read_b64_tr_b16 a[172:173], v7 offset:40960
    v_mfma_f32_16x16x32_bf16 v[104:107], v[160:163], v[176:179], v[104:107]
    ds_read_b64_tr_b16 a[174:175], v7 offset:41984
    s_waitcnt vmcnt(10)
    s_waitcnt lgkmcnt(0)
    s_barrier
    v_mfma_f32_16x16x32_bf16 v[104:107], v[164:167], v[200:203], v[104:107]
    ds_read_b64_tr_b16 a[192:193], v10 offset:0
    ds_read_b64_tr_b16 a[194:195], v10 offset:1024
    v_mfma_f32_16x16x32_bf16 v[104:107], v[168:171], v[224:227], v[104:107]
    ds_read_b64_tr_b16 a[196:197], v11 offset:0
    ds_read_b64_tr_b16 a[198:199], v11 offset:1024
    v_mfma_f32_16x16x32_bf16 v[104:107], v[172:175], v[248:251], v[104:107]
    ds_read_b64_tr_b16 a[216:217], v10 offset:8192
    ds_read_b64_tr_b16 a[218:219], v10 offset:9216
    v_mfma_f32_16x16x32_bf16 v[108:111], v[120:123], a[20:23], 0
    ds_read_b64_tr_b16 v[120:121], v4 offset:0
    ds_read_b64_tr_b16 v[122:123], v25 offset:0
    v_mfma_f32_16x16x32_bf16 v[108:111], v[124:127], a[44:47], v[108:111]
    ds_read_b64_tr_b16 v[124:125], v4 offset:1024
    ds_read_b64_tr_b16 v[126:127], v25 offset:1024
    v_mfma_f32_16x16x32_bf16 v[108:111], v[128:131], a[68:71], v[108:111]
    ds_read_b64_tr_b16 v[128:129], v4 offset:2048
    ds_read_b64_tr_b16 v[130:131], v25 offset:2048
    v_mfma_f32_16x16x32_bf16 v[108:111], v[132:135], a[92:95], v[108:111]
    ds_read_b64_tr_b16 v[132:133], v4 offset:3072
    ds_read_b64_tr_b16 v[134:135], v25 offset:3072
    v_mfma_f32_16x16x32_bf16 v[108:111], v[136:139], a[116:119], v[108:111]
    ds_read_b64_tr_b16 v[136:137], v4 offset:4096
    ds_read_b64_tr_b16 v[138:139], v25 offset:4096
    v_mfma_f32_16x16x32_bf16 v[108:111], v[140:143], a[140:143], v[108:111]
    ds_read_b64_tr_b16 v[140:141], v4 offset:5120
    ds_read_b64_tr_b16 v[142:143], v25 offset:5120
    v_mfma_f32_16x16x32_bf16 v[108:111], v[144:147], a[164:167], v[108:111]
    ds_read_b64_tr_b16 v[144:145], v4 offset:6144
    ds_read_b64_tr_b16 v[146:147], v25 offset:6144
    v_mfma_f32_16x16x32_bf16 v[108:111], v[148:151], a[188:191], v[108:111]
    ds_read_b64_tr_b16 v[148:149], v4 offset:7168
    ds_read_b64_tr_b16 v[150:151], v25 offset:7168
    v_mfma_f32_16x16x32_bf16 v[108:111], v[152:155], a[212:215], v[108:111]
    ds_read_b64_tr_b16 v[152:153], v4 offset:8192
    ds_read_b64_tr_b16 v[154:155], v25 offset:8192
    v_mfma_f32_16x16x32_bf16 v[108:111], v[156:159], a[236:239], v[108:111]
    ds_read_b64_tr_b16 v[156:157], v4 offset:9216
    ds_read_b64_tr_b16 v[158:159], v25 offset:9216
    v_mfma_f32_16x16x32_bf16 v[108:111], v[160:163], v[180:183], v[108:111]
    ds_read_b64_tr_b16 v[160:161], v4 offset:10240
    ds_read_b64_tr_b16 v[162:163], v25 offset:10240
    v_mfma_f32_16x16x32_bf16 v[108:111], v[164:167], v[204:207], v[108:111]
    ds_read_b64_tr_b16 v[164:165], v4 offset:11264
    ds_read_b64_tr_b16 v[166:167], v25 offset:11264
    v_mfma_f32_16x16x32_bf16 v[108:111], v[168:171], v[228:231], v[108:111]
    ds_read_b64_tr_b16 v[168:169], v4 offset:12288
    ds_read_b64_tr_b16 v[170:171], v25 offset:12288
    v_mfma_f32_16x16x32_bf16 v[108:111], v[172:175], v[252:255], v[108:111]
    ds_read_b64_tr_b16 v[172:173], v4 offset:13312
    ds_read_b64_tr_b16 v[174:175], v25 offset:13312
    s_waitcnt lgkmcnt(15)
    v_mfma_f32_16x16x32_bf16 v[112:115], v[120:123], a[16:19], 0
    v_cvt_pk_bf16_f32 v34, v104, v105
    v_cvt_pk_bf16_f32 v35, v106, v107
    v_mfma_f32_16x16x32_bf16 v[112:115], v[124:127], a[40:43], v[112:115]
    ds_read_b64_tr_b16 a[220:221], v11 offset:8192
    ds_read_b64_tr_b16 a[222:223], v11 offset:9216
    v_mfma_f32_16x16x32_bf16 v[112:115], v[128:131], a[64:67], v[112:115]
    ds_read_b64_tr_b16 a[240:241], v10 offset:16384
    ds_read_b64_tr_b16 a[242:243], v10 offset:17408
    v_mfma_f32_16x16x32_bf16 v[112:115], v[132:135], a[88:91], v[112:115]
    ds_read_b64_tr_b16 a[244:245], v11 offset:16384
    ds_read_b64_tr_b16 a[246:247], v11 offset:17408
    s_waitcnt vmcnt(4)
    s_waitcnt lgkmcnt(0)
    s_barrier
    v_mfma_f32_16x16x32_bf16 v[112:115], v[136:139], a[112:115], v[112:115]
    ds_read_b64_tr_b16 v[184:185], v10 offset:24576
    ds_read_b64_tr_b16 v[186:187], v10 offset:25600
    v_mfma_f32_16x16x32_bf16 v[112:115], v[140:143], a[136:139], v[112:115]
    ds_read_b64_tr_b16 v[188:189], v11 offset:24576
    ds_read_b64_tr_b16 v[190:191], v11 offset:25600
    v_mfma_f32_16x16x32_bf16 v[112:115], v[144:147], a[160:163], v[112:115]
    v_cvt_pk_bf16_f32 v44, v108, v109
    v_cvt_pk_bf16_f32 v45, v110, v111
    v_mfma_f32_16x16x32_bf16 v[112:115], v[148:151], a[184:187], v[112:115]
    ds_read_b64_tr_b16 v[208:209], v10 offset:32768
    ds_read_b64_tr_b16 v[210:211], v10 offset:33792
    v_mfma_f32_16x16x32_bf16 v[112:115], v[152:155], a[208:211], v[112:115]
    ds_read_b64_tr_b16 v[212:213], v11 offset:32768
    ds_read_b64_tr_b16 v[214:215], v11 offset:33792
    v_mfma_f32_16x16x32_bf16 v[112:115], v[156:159], a[232:235], v[112:115]
    ds_read_b64_tr_b16 v[232:233], v10 offset:40960
    ds_read_b64_tr_b16 v[234:235], v10 offset:41984
    v_mfma_f32_16x16x32_bf16 v[112:115], v[160:163], v[176:179], v[112:115]
    ds_read_b64_tr_b16 v[236:237], v11 offset:40960
    ds_read_b64_tr_b16 v[238:239], v11 offset:41984
    v_mfma_f32_16x16x32_bf16 v[112:115], v[164:167], v[200:203], v[112:115]
    v_mfma_f32_16x16x32_bf16 v[112:115], v[168:171], v[224:227], v[112:115]
    v_mfma_f32_16x16x32_bf16 v[112:115], v[172:175], v[248:251], v[112:115]
    v_mfma_f32_16x16x32_bf16 v[116:119], v[120:123], a[20:23], 0
    ds_read_b64_tr_b16 v[120:121], v4 offset:16384
    ds_read_b64_tr_b16 v[122:123], v25 offset:16384
    v_mfma_f32_16x16x32_bf16 v[116:119], v[124:127], a[44:47], v[116:119]
    ds_read_b64_tr_b16 v[124:125], v4 offset:17408
    ds_read_b64_tr_b16 v[126:127], v25 offset:17408
    s_waitcnt lgkmcnt(4)
    s_barrier
    v_mfma_f32_16x16x32_bf16 v[116:119], v[128:131], a[68:71], v[116:119]
    ds_read_b64_tr_b16 v[128:129], v4 offset:18432
    ds_read_b64_tr_b16 v[130:131], v25 offset:18432
    s_add_u32 m0, s52, 65536
    s_add_u32 s58, s72, 1536
    s_add_u32 s57, s58, s68
    v_mfma_f32_16x16x32_bf16 v[116:119], v[132:135], a[92:95], v[116:119]
    ds_read_b64_tr_b16 v[132:133], v4 offset:19456
    ds_read_b64_tr_b16 v[134:135], v25 offset:19456
    buffer_load_dwordx4 v3, s[24:27], s57 offen offset:0 sc1 lds
    v_mfma_f32_16x16x32_bf16 v[116:119], v[136:139], a[116:119], v[116:119]
    ds_read_b64_tr_b16 v[136:137], v4 offset:20480
    ds_read_b64_tr_b16 v[138:139], v25 offset:20480
    v_mfma_f32_16x16x32_bf16 v[116:119], v[140:143], a[140:143], v[116:119]
    ds_read_b64_tr_b16 v[140:141], v4 offset:21504
    ds_read_b64_tr_b16 v[142:143], v25 offset:21504
    v_mfma_f32_16x16x32_bf16 v[116:119], v[144:147], a[164:167], v[116:119]
    ds_read_b64_tr_b16 v[144:145], v4 offset:22528
    ds_read_b64_tr_b16 v[146:147], v25 offset:22528
    v_mfma_f32_16x16x32_bf16 v[116:119], v[148:151], a[188:191], v[116:119]
    ds_read_b64_tr_b16 v[148:149], v4 offset:23552
    ds_read_b64_tr_b16 v[150:151], v25 offset:23552
    v_mfma_f32_16x16x32_bf16 v[116:119], v[152:155], a[212:215], v[116:119]
    ds_read_b64_tr_b16 v[152:153], v4 offset:24576
    ds_read_b64_tr_b16 v[154:155], v25 offset:24576
    s_add_u32 s57, s58, s69
    v_mfma_f32_16x16x32_bf16 v[116:119], v[156:159], a[236:239], v[116:119]
    ds_read_b64_tr_b16 v[156:157], v4 offset:25600
    ds_read_b64_tr_b16 v[158:159], v25 offset:25600
    buffer_load_dwordx4 v3, s[24:27], s57 offen offset:1024 sc1 lds
    v_mfma_f32_16x16x32_bf16 v[116:119], v[160:163], v[180:183], v[116:119]
    ds_read_b64_tr_b16 v[160:161], v4 offset:26624
    ds_read_b64_tr_b16 v[162:163], v25 offset:26624
    v_mfma_f32_16x16x32_bf16 v[116:119], v[164:167], v[204:207], v[116:119]
    ds_read_b64_tr_b16 v[164:165], v4 offset:27648
    ds_read_b64_tr_b16 v[166:167], v25 offset:27648
    v_mfma_f32_16x16x32_bf16 v[116:119], v[168:171], v[228:231], v[116:119]
    ds_read_b64_tr_b16 v[168:169], v4 offset:28672
    ds_read_b64_tr_b16 v[170:171], v25 offset:28672
    v_mfma_f32_16x16x32_bf16 v[116:119], v[172:175], v[252:255], v[116:119]
    ds_read_b64_tr_b16 v[172:173], v4 offset:29696
    ds_read_b64_tr_b16 v[174:175], v25 offset:29696
    s_waitcnt lgkmcnt(15)
    v_mfma_f32_16x16x32_bf16 v[96:99], a[0:3], v[120:123], 0
    s_add_u32 s57, s58, s70
    v_cvt_pk_bf16_f32 v32, v112, v113
    v_mfma_f32_16x16x32_bf16 v[96:99], a[24:27], v[124:127], v[96:99]
    buffer_load_dwordx4 v24, s[24:27], s57 offen offset:2048 sc1 lds
    v_mfma_f32_16x16x32_bf16 v[96:99], a[48:51], v[128:131], v[96:99]
    v_cvt_pk_bf16_f32 v33, v114, v115
    v_mfma_f32_16x16x32_bf16 v[96:99], a[72:75], v[132:135], v[96:99]
    v_mfma_f32_16x16x32_bf16 v[96:99], a[96:99], v[136:139], v[96:99]
    v_mfma_f32_16x16x32_bf16 v[96:99], a[120:123], v[140:143], v[96:99]
    s_waitcnt lgkmcnt(10)
    v_mfma_f32_16x16x32_bf16 v[96:99], a[144:147], v[144:147], v[96:99]
    s_add_u32 s57, s58, s71
    v_cvt_pk_bf16_f32 v42, v116, v117
    v_mfma_f32_16x16x32_bf16 v[96:99], a[168:171], v[148:151], v[96:99]
    buffer_load_dwordx4 v3, s[24:27], s57 offen offset:3072 sc1 lds
    v_mfma_f32_16x16x32_bf16 v[96:99], a[192:195], v[152:155], v[96:99]
    v_cvt_pk_bf16_f32 v43, v118, v119
    s_waitcnt lgkmcnt(4)
    v_mfma_f32_16x16x32_bf16 v[96:99], a[216:219], v[156:159], v[96:99]
    v_mfma_f32_16x16x32_bf16 v[96:99], a[240:243], v[160:163], v[96:99]
    v_mfma_f32_16x16x32_bf16 v[96:99], v[184:187], v[164:167], v[96:99]
    s_waitcnt lgkmcnt(0)
    v_mfma_f32_16x16x32_bf16 v[96:99], v[208:211], v[168:171], v[96:99]
    s_add_u32 m0, s52, 81920
    s_add_u32 s58, s72, 2048
    s_add_u32 s57, s58, s68
    v_mfma_f32_16x16x32_bf16 v[96:99], v[232:235], v[172:175], v[96:99]
    buffer_load_dwordx4 v3, s[24:27], s57 offen offset:0 sc1 lds
    v_mfma_f32_16x16x32_bf16 v[100:103], a[4:7], v[120:123], 0
    ds_read_b64_tr_b16 v[120:121], v4 offset:32768
    ds_read_b64_tr_b16 v[122:123], v25 offset:32768
    v_mfma_f32_16x16x32_bf16 v[100:103], a[28:31], v[124:127], v[100:103]
    ds_read_b64_tr_b16 v[124:125], v4 offset:33792
    ds_read_b64_tr_b16 v[126:127], v25 offset:33792
    v_mfma_f32_16x16x32_bf16 v[100:103], a[52:55], v[128:131], v[100:103]
    ds_read_b64_tr_b16 v[128:129], v4 offset:34816
    ds_read_b64_tr_b16 v[130:131], v25 offset:34816
    v_mfma_f32_16x16x32_bf16 v[100:103], a[76:79], v[132:135], v[100:103]
    ds_read_b64_tr_b16 v[132:133], v4 offset:35840
    ds_read_b64_tr_b16 v[134:135], v25 offset:35840
    v_mfma_f32_16x16x32_bf16 v[100:103], a[100:103], v[136:139], v[100:103]
    ds_read_b64_tr_b16 v[136:137], v4 offset:36864
    ds_read_b64_tr_b16 v[138:139], v25 offset:36864
    s_add_u32 s57, s58, s69
    v_mfma_f32_16x16x32_bf16 v[100:103], a[124:127], v[140:143], v[100:103]
    ds_read_b64_tr_b16 v[140:141], v4 offset:37888
    ds_read_b64_tr_b16 v[142:143], v25 offset:37888
    buffer_load_dwordx4 v3, s[24:27], s57 offen offset:1024 sc1 lds
    v_mfma_f32_16x16x32_bf16 v[100:103], a[148:151], v[144:147], v[100:103]
    ds_read_b64_tr_b16 v[144:145], v4 offset:38912
    ds_read_b64_tr_b16 v[146:147], v25 offset:38912
    v_mfma_f32_16x16x32_bf16 v[100:103], a[172:175], v[148:151], v[100:103]
    ds_read_b64_tr_b16 v[148:149], v4 offset:39936
    ds_read_b64_tr_b16 v[150:151], v25 offset:39936
    v_mfma_f32_16x16x32_bf16 v[100:103], a[196:199], v[152:155], v[100:103]
    ds_read_b64_tr_b16 v[152:153], v4 offset:40960
    ds_read_b64_tr_b16 v[154:155], v25 offset:40960
    v_mfma_f32_16x16x32_bf16 v[100:103], a[220:223], v[156:159], v[100:103]
    ds_read_b64_tr_b16 v[156:157], v4 offset:41984
    ds_read_b64_tr_b16 v[158:159], v25 offset:41984
    v_mfma_f32_16x16x32_bf16 v[100:103], a[244:247], v[160:163], v[100:103]
    ds_read_b64_tr_b16 v[160:161], v4 offset:43008
    ds_read_b64_tr_b16 v[162:163], v25 offset:43008
    s_add_u32 s57, s58, s70
    v_mfma_f32_16x16x32_bf16 v[100:103], v[188:191], v[164:167], v[100:103]
    ds_read_b64_tr_b16 v[164:165], v4 offset:44032
    ds_read_b64_tr_b16 v[166:167], v25 offset:44032
    buffer_load_dwordx4 v24, s[24:27], s57 offen offset:2048 sc1 lds
    v_mfma_f32_16x16x32_bf16 v[100:103], v[212:215], v[168:171], v[100:103]
    ds_read_b64_tr_b16 v[168:169], v4 offset:45056
    ds_read_b64_tr_b16 v[170:171], v25 offset:45056
    v_mfma_f32_16x16x32_bf16 v[100:103], v[236:239], v[172:175], v[100:103]
    ds_read_b64_tr_b16 v[172:173], v4 offset:46080
    ds_read_b64_tr_b16 v[174:175], v25 offset:46080
    s_waitcnt lgkmcnt(15)
    v_mfma_f32_16x16x32_bf16 v[104:107], a[0:3], v[120:123], 0
    v_cvt_pk_bf16_f32 v68, v96, v97
    v_cvt_pk_bf16_f32 v69, v98, v99
    v_mfma_f32_16x16x32_bf16 v[104:107], a[24:27], v[124:127], v[104:107]
    v_mfma_f32_16x16x32_bf16 v[104:107], a[48:51], v[128:131], v[104:107]
    s_add_u32 s57, s58, s71
    v_mfma_f32_16x16x32_bf16 v[104:107], a[72:75], v[132:135], v[104:107]
    buffer_load_dwordx4 v3, s[24:27], s57 offen offset:3072 sc1 lds
    v_mfma_f32_16x16x32_bf16 v[104:107], a[96:99], v[136:139], v[104:107]
    v_mfma_f32_16x16x32_bf16 v[104:107], a[120:123], v[140:143], v[104:107]
    s_waitcnt lgkmcnt(10)
    v_mfma_f32_16x16x32_bf16 v[104:107], a[144:147], v[144:147], v[104:107]
    v_cvt_pk_bf16_f32 v70, v100, v101
    v_cvt_pk_bf16_f32 v71, v102, v103
    v_mfma_f32_16x16x32_bf16 v[104:107], a[168:171], v[148:151], v[104:107]
    v_cndmask_b32 v70, v70, 0, s[82:83]
    v_cndmask_b32 v71, v71, 0, s[82:83]
    v_mfma_f32_16x16x32_bf16 v[104:107], a[192:195], v[152:155], v[104:107]
    s_add_u32 m0, s52, 98304
    s_add_u32 s58, s72, 2560
    s_add_u32 s57, s58, s68
    v_mov_b32 v8, 0
    s_waitcnt lgkmcnt(4)
    v_mfma_f32_16x16x32_bf16 v[104:107], a[216:219], v[156:159], v[104:107]
    buffer_load_dwordx4 v3, s[24:27], s57 offen offset:0 sc1 lds
    v_mfma_f32_16x16x32_bf16 v[104:107], a[240:243], v[160:163], v[104:107]
    v_mov_b32 v9, 0
    v_mov_b32 v10, 0
    v_mfma_f32_16x16x32_bf16 v[104:107], v[184:187], v[164:167], v[104:107]
    v_mfma_f32_16x16x32_bf16 v[72:75], v[52:55], v[68:71], 0
    s_waitcnt lgkmcnt(0)
    v_mfma_f32_16x16x32_bf16 v[104:107], v[208:211], v[168:171], v[104:107]
    v_mfma_f32_16x16x32_bf16 v[76:79], v[56:59], v[68:71], 0
    v_mfma_f32_16x16x32_bf16 v[104:107], v[232:235], v[172:175], v[104:107]
    ds_read_u16_d16_hi v8, v93 offset:0
    ds_read_u16_d16_hi v9, v94 offset:0
    s_waitcnt vmcnt(9)
    s_barrier
    v_mfma_f32_16x16x32_bf16 v[108:111], a[4:7], v[120:123], 0
    ds_read_b64_tr_b16 v[120:121], v4 offset:49152
    ds_read_b64_tr_b16 v[122:123], v25 offset:49152
    s_add_u32 s57, s58, s69
    v_mfma_f32_16x16x32_bf16 v[108:111], a[28:31], v[124:127], v[108:111]
    ds_read_b64_tr_b16 v[124:125], v4 offset:50176
    ds_read_b64_tr_b16 v[126:127], v25 offset:50176
    buffer_load_dwordx4 v3, s[24:27], s57 offen offset:1024 sc1 lds
    v_mfma_f32_16x16x32_bf16 v[108:111], a[52:55], v[128:131], v[108:111]
    ds_read_b64_tr_b16 v[128:129], v4 offset:51200
    ds_read_b64_tr_b16 v[130:131], v25 offset:51200
    v_mfma_f32_16x16x32_bf16 v[108:111], a[76:79], v[132:135], v[108:111]
    ds_read_b64_tr_b16 v[132:133], v4 offset:52224
    ds_read_b64_tr_b16 v[134:135], v25 offset:52224
    v_mfma_f32_16x16x32_bf16 v[108:111], a[100:103], v[136:139], v[108:111]
    ds_read_b64_tr_b16 v[136:137], v4 offset:53248
    ds_read_b64_tr_b16 v[138:139], v25 offset:53248
    v_mfma_f32_16x16x32_bf16 v[108:111], a[124:127], v[140:143], v[108:111]
    ds_read_b64_tr_b16 v[140:141], v4 offset:54272
    ds_read_b64_tr_b16 v[142:143], v25 offset:54272
    v_mfma_f32_16x16x32_bf16 v[108:111], a[148:151], v[144:147], v[108:111]
    ds_read_b64_tr_b16 v[144:145], v4 offset:55296
    ds_read_b64_tr_b16 v[146:147], v25 offset:55296
    s_add_u32 s57, s58, s70
    v_mfma_f32_16x16x32_bf16 v[108:111], a[172:175], v[148:151], v[108:111]
    ds_read_b64_tr_b16 v[148:149], v4 offset:56320
    ds_read_b64_tr_b16 v[150:151], v25 offset:56320
    buffer_load_dwordx4 v24, s[24:27], s57 offen offset:2048 sc1 lds
    v_mfma_f32_16x16x32_bf16 v[108:111], a[196:199], v[152:155], v[108:111]
    ds_read_b64_tr_b16 v[152:153], v4 offset:57344
    ds_read_b64_tr_b16 v[154:155], v25 offset:57344
    v_mfma_f32_16x16x32_bf16 v[108:111], a[220:223], v[156:159], v[108:111]
    ds_read_b64_tr_b16 v[156:157], v4 offset:58368
    ds_read_b64_tr_b16 v[158:159], v25 offset:58368
    v_mfma_f32_16x16x32_bf16 v[108:111], a[244:247], v[160:163], v[108:111]
    ds_read_b64_tr_b16 v[160:161], v4 offset:59392
    ds_read_b64_tr_b16 v[162:163], v25 offset:59392
    v_mfma_f32_16x16x32_bf16 v[108:111], v[188:191], v[164:167], v[108:111]
    ds_read_b64_tr_b16 v[164:165], v4 offset:60416
    ds_read_b64_tr_b16 v[166:167], v25 offset:60416
    v_mfma_f32_16x16x32_bf16 v[108:111], v[212:215], v[168:171], v[108:111]
    ds_read_b64_tr_b16 v[168:169], v4 offset:61440
    ds_read_b64_tr_b16 v[170:171], v25 offset:61440
    s_add_u32 s57, s58, s71
    v_mfma_f32_16x16x32_bf16 v[108:111], v[236:239], v[172:175], v[108:111]
    ds_read_b64_tr_b16 v[172:173], v4 offset:62464
    ds_read_b64_tr_b16 v[174:175], v25 offset:62464
    buffer_load_dwordx4 v3, s[24:27], s57 offen offset:3072 sc1 lds
    s_waitcnt lgkmcnt(15)
    v_mfma_f32_16x16x32_bf16 v[112:115], a[8:11], v[120:123], 0
    v_cvt_pk_bf16_f32 v64, v104, v105
    v_cvt_pk_bf16_f32 v65, v106, v107
    v_mfma_f32_16x16x32_bf16 v[112:115], a[32:35], v[124:127], v[112:115]
    ds_read_u16_d16_hi v10, v92 offset:0
    v_mfma_f32_16x16x32_bf16 v[112:115], a[56:59], v[128:131], v[112:115]
    v_mfma_f32_16x16x32_bf16 v[112:115], a[80:83], v[132:135], v[112:115]
    v_mfma_f32_16x16x32_bf16 v[112:115], a[104:107], v[136:139], v[112:115]
    s_add_u32 m0, s52, 114688
    s_add_u32 s58, s72, 3072
    s_add_u32 s57, s58, s68
    v_mfma_f32_16x16x32_bf16 v[112:115], a[128:131], v[140:143], v[112:115]
    buffer_load_dwordx4 v3, s[24:27], s57 offen offset:0 sc1 lds
    s_waitcnt lgkmcnt(11)
    v_mfma_f32_16x16x32_bf16 v[112:115], a[152:155], v[144:147], v[112:115]
    v_cvt_pk_bf16_f32 v66, v108, v109
    v_cvt_pk_bf16_f32 v67, v110, v111
    v_mfma_f32_16x16x32_bf16 v[112:115], a[176:179], v[148:151], v[112:115]
    v_cndmask_b32 v66, v66, 0, s[82:83]
    v_cndmask_b32 v67, v67, 0, s[82:83]
    v_mfma_f32_16x16x32_bf16 v[112:115], a[200:203], v[152:155], v[112:115]
    v_cndmask_b32 v26, v72, v73, s[76:77]
    v_cndmask_b32 v27, v74, v75, s[76:77]
    s_waitcnt lgkmcnt(5)
    v_mfma_f32_16x16x32_bf16 v[112:115], a[224:227], v[156:159], v[112:115]
    v_cndmask_b32 v28, v76, v77, s[76:77]
    v_cndmask_b32 v29, v78, v79, s[76:77]
    v_mfma_f32_16x16x32_bf16 v[112:115], a[248:251], v[160:163], v[112:115]
    s_add_u32 s57, s58, s69
    v_cndmask_b32 v26, v26, v28, s[78:79]
    v_mfma_f32_16x16x32_bf16 v[112:115], v[192:195], v[164:167], v[112:115]
    buffer_load_dwordx4 v3, s[24:27], s57 offen offset:1024 sc1 lds
    s_waitcnt lgkmcnt(1)
    v_mfma_f32_16x16x32_bf16 v[112:115], v[216:219], v[168:171], v[112:115]
    v_cndmask_b32 v27, v27, v29, s[80:81]
    s_waitcnt lgkmcnt(0)
    v_mfma_f32_16x16x32_bf16 v[112:115], v[240:243], v[172:175], v[112:115]
    v_mul_f32 v26, v26, v8
    v_mul_f32 v27, v27, v9
    v_mfma_f32_16x16x32_bf16 v[116:119], a[12:15], v[120:123], 0
    v_mul_f32 v11, s91, v10
    v_cndmask_b32 v26, v26, v18, s[84:85]
    v_mfma_f32_16x16x32_bf16 v[116:119], a[36:39], v[124:127], v[116:119]
    v_cndmask_b32 v27, v27, v18, s[86:87]
    v_max_f32 v28, v26, v27
    v_mfma_f32_16x16x32_bf16 v[116:119], a[60:63], v[128:131], v[116:119]
    s_add_u32 s57, s58, s70
    v_mov_b32 v29, v28
    v_mfma_f32_16x16x32_bf16 v[116:119], a[84:87], v[132:135], v[116:119]
    buffer_load_dwordx4 v24, s[24:27], s57 offen offset:2048 sc1 lds
    v_mfma_f32_16x16x32_bf16 v[116:119], a[108:111], v[136:139], v[116:119]
    v_permlane16_swap_b32 v28, v29
    v_max_f32 v28, v28, v29
    v_mfma_f32_16x16x32_bf16 v[116:119], a[132:135], v[140:143], v[116:119]
    v_mov_b32 v29, v28
    v_mfma_f32_16x16x32_bf16 v[116:119], a[156:159], v[144:147], v[116:119]
    v_cvt_pk_bf16_f32 v52, v112, v113
    v_cvt_pk_bf16_f32 v53, v114, v115
    v_mfma_f32_16x16x32_bf16 v[116:119], a[180:183], v[148:151], v[116:119]
    v_permlane32_swap_b32 v28, v29
    v_max_f32 v28, v28, v29
    v_mfma_f32_16x16x32_bf16 v[116:119], a[204:207], v[152:155], v[116:119]
    s_add_u32 s57, s58, s71
    v_sub_f32 v26, v26, v28
    v_mfma_f32_16x16x32_bf16 v[116:119], a[228:231], v[156:159], v[116:119]
    buffer_load_dwordx4 v3, s[24:27], s57 offen offset:3072 sc1 lds
    v_mfma_f32_16x16x32_bf16 v[116:119], a[252:255], v[160:163], v[116:119]
    v_sub_f32 v27, v27, v28
    v_mul_f32 v26, v11, v26
    v_mfma_f32_16x16x32_bf16 v[116:119], v[196:199], v[164:167], v[116:119]
    v_mul_f32 v27, v11, v27
    v_exp_f32 v26, v26
    v_mfma_f32_16x16x32_bf16 v[116:119], v[220:223], v[168:171], v[116:119]
    v_exp_f32 v27, v27
    v_mfma_f32_16x16x32_bf16 v[116:119], v[244:247], v[172:175], v[116:119]
    v_add_f32 v28, v26, v27
    v_mov_b32 v29, v28
    v_mfma_f32_16x16x32_bf16 v[96:99], v[120:123], a[16:19], 0
    s_add_u32 m0, s52, 131072
    s_add_u32 s58, s72, 3584
    s_add_u32 s57, s58, s68
    v_mfma_f32_16x16x32_bf16 v[96:99], v[124:127], a[40:43], v[96:99]
    buffer_load_dwordx4 v3, s[24:27], s57 offen offset:0 sc1 lds
    v_mfma_f32_16x16x32_bf16 v[96:99], v[128:131], a[64:67], v[96:99]
    v_permlane16_swap_b32 v28, v29
    v_add_f32 v28, v28, v29
    v_mfma_f32_16x16x32_bf16 v[96:99], v[132:135], a[88:91], v[96:99]
    v_mov_b32 v29, v28
    v_mfma_f32_16x16x32_bf16 v[96:99], v[136:139], a[112:115], v[96:99]
    v_mfma_f32_16x16x32_bf16 v[96:99], v[140:143], a[136:139], v[96:99]
    v_permlane32_swap_b32 v28, v29
    v_add_f32 v28, v28, v29
    v_mfma_f32_16x16x32_bf16 v[96:99], v[144:147], a[160:163], v[96:99]
    s_add_u32 s57, s58, s69
    v_cvt_pk_bf16_f32 v54, v116, v117
    v_mfma_f32_16x16x32_bf16 v[96:99], v[148:151], a[184:187], v[96:99]
    buffer_load_dwordx4 v3, s[24:27], s57 offen offset:1024 sc1 lds
    v_mfma_f32_16x16x32_bf16 v[96:99], v[152:155], a[208:211], v[96:99]
    v_cvt_pk_bf16_f32 v55, v118, v119
    v_cndmask_b32 v54, v54, 0, s[82:83]
    v_mfma_f32_16x16x32_bf16 v[96:99], v[156:159], a[232:235], v[96:99]
    v_cndmask_b32 v55, v55, 0, s[82:83]
    v_rcp_f32 v28, v28
    v_mfma_f32_16x16x32_bf16 v[96:99], v[160:163], v[176:179], v[96:99]
    v_mul_f32 v26, v26, v8
    v_mul_f32 v27, v27, v9
    v_mfma_f32_16x16x32_bf16 v[96:99], v[164:167], v[200:203], v[96:99]
    v_mul_f32 v26, v26, v28
    v_mul_f32 v27, v27, v28
    v_mfma_f32_16x16x32_bf16 v[96:99], v[168:171], v[224:227], v[96:99]
    s_add_u32 s57, s58, s70
    v_cvt_pk_bf16_f32 v26, v26, v26
    v_mfma_f32_16x16x32_bf16 v[96:99], v[172:175], v[248:251], v[96:99]
    buffer_load_dwordx4 v24, s[24:27], s57 offen offset:2048 sc1 lds
    v_mfma_f32_16x16x32_bf16 v[100:103], v[120:123], a[20:23], 0
    v_cvt_pk_bf16_f32 v27, v27, v27
    v_and_b32 v80, v26, v14
    v_mfma_f32_16x16x32_bf16 v[100:103], v[124:127], a[44:47], v[100:103]
    v_and_b32 v81, v27, v15
    v_and_b32 v82, v26, v16
    v_mfma_f32_16x16x32_bf16 v[100:103], v[128:131], a[68:71], v[100:103]
    v_and_b32 v83, v27, v17
    v_mfma_f32_16x16x32_bf16 v[100:103], v[132:135], a[92:95], v[100:103]
    v_mfma_f32_16x16x32_bf16 v[100:103], v[136:139], a[116:119], v[100:103]
    s_add_u32 s57, s58, s71
    v_mfma_f32_16x16x32_bf16 v[72:75], v[32:35], v[80:83], 0
    v_mfma_f32_16x16x32_bf16 v[100:103], v[140:143], a[140:143], v[100:103]
    buffer_load_dwordx4 v3, s[24:27], s57 offen offset:3072 sc1 lds
    v_mfma_f32_16x16x32_bf16 v[100:103], v[144:147], a[164:167], v[100:103]
    v_cvt_pk_bf16_f32 v38, v96, v97
    v_cvt_pk_bf16_f32 v39, v98, v99
    v_mfma_f32_16x16x32_bf16 v[100:103], v[148:151], a[188:191], v[100:103]
    v_mfma_f32_16x16x32_bf16 v[76:79], v[42:45], v[80:83], 0
    v_mfma_f32_16x16x32_bf16 v[100:103], v[152:155], a[212:215], v[100:103]
    s_add_u32 s53, s74, 0
    v_mfma_f32_16x16x32_bf16 v[100:103], v[156:159], a[236:239], v[100:103]
    v_mfma_f32_16x16x32_bf16 v[100:103], v[160:163], v[180:183], v[100:103]
    s_add_u32 s57, s73, 0
    v_mfma_f32_16x16x32_bf16 v[100:103], v[164:167], v[204:207], v[100:103]
    buffer_load_dword v22, v5, s[20:23], s57 offen
    v_mfma_f32_16x16x32_bf16 v[100:103], v[168:171], v[228:231], v[100:103]
    v_mfma_f32_16x16x32_bf16 v[100:103], v[172:175], v[252:255], v[100:103]
    v_cvt_pk_bf16_f32 v84, v72, v73
    v_cvt_pk_bf16_f32 v85, v74, v75
    v_mfma_f32_16x16x32_bf16 v[104:107], a[0:3], v[120:123], 0
    v_cvt_pk_bf16_f32 v86, v76, v77
    v_cvt_pk_bf16_f32 v87, v78, v79
    v_mfma_f32_16x16x32_bf16 v[104:107], a[24:27], v[124:127], v[104:107]
    v_cndmask_b32 v86, v86, 0, s[82:83]
    v_cndmask_b32 v87, v87, 0, s[82:83]
    v_mfma_f32_16x16x32_bf16 v[104:107], a[48:51], v[128:131], v[104:107]
    s_add_u32 s57, s73, 524288
    v_mfma_f32_16x16x32_bf16 v[104:107], a[72:75], v[132:135], v[104:107]
    buffer_load_dword v22, v5, s[20:23], s57 offen
    v_mfma_f32_16x16x32_bf16 v[104:107], a[96:99], v[136:139], v[104:107]
    buffer_store_dwordx4 v[84:87], v23, s[24:27], s53 offen sc1
    v_mfma_f32_16x16x32_bf16 v[104:107], a[120:123], v[140:143], v[104:107]
    v_mfma_f32_16x16x32_bf16 v[104:107], a[144:147], v[144:147], v[104:107]
    v_cvt_pk_bf16_f32 v48, v100, v101
    v_cvt_pk_bf16_f32 v49, v102, v103
    v_mfma_f32_16x16x32_bf16 v[104:107], a[168:171], v[148:151], v[104:107]
    v_mfma_f32_16x16x32_bf16 v[72:75], v[56:59], v[64:67], 0
    v_mfma_f32_16x16x32_bf16 v[104:107], a[192:195], v[152:155], v[104:107]
    s_add_u32 s57, s75, 0
    v_mfma_f32_16x16x32_bf16 v[76:79], v[60:63], v[64:67], 0
    v_mfma_f32_16x16x32_bf16 v[104:107], a[216:219], v[156:159], v[104:107]
    buffer_load_dword v22, v20, s[12:15], s57 offen
    v_mfma_f32_16x16x32_bf16 v[104:107], a[240:243], v[160:163], v[104:107]
    ds_read_u16_d16_hi v8, v93 offset:16384
    ds_read_u16_d16_hi v9, v94 offset:16384
    v_mfma_f32_16x16x32_bf16 v[104:107], v[184:187], v[164:167], v[104:107]
    ds_read_u16_d16_hi v10, v92 offset:16384
    v_mfma_f32_16x16x32_bf16 v[104:107], v[208:211], v[168:171], v[104:107]
    v_mfma_f32_16x16x32_bf16 v[104:107], v[232:235], v[172:175], v[104:107]
    s_waitcnt vmcnt(8)
    s_barrier
    v_mfma_f32_16x16x32_bf16 v[108:111], a[4:7], v[120:123], 0
    v_add_u32 v4, 65536, v4
    v_add_u32 v25, 65536, v25
    ds_read_b64_tr_b16 v[120:121], v4 offset:0
    ds_read_b64_tr_b16 v[122:123], v25 offset:0
    s_add_u32 s57, s75, 262144
    v_mfma_f32_16x16x32_bf16 v[108:111], a[28:31], v[124:127], v[108:111]
    ds_read_b64_tr_b16 v[124:125], v4 offset:1024
    ds_read_b64_tr_b16 v[126:127], v25 offset:1024
    buffer_load_dword v22, v20, s[12:15], s57 offen
    v_mfma_f32_16x16x32_bf16 v[108:111], a[52:55], v[128:131], v[108:111]
    ds_read_b64_tr_b16 v[128:129], v4 offset:2048
    ds_read_b64_tr_b16 v[130:131], v25 offset:2048
    v_mfma_f32_16x16x32_bf16 v[108:111], a[76:79], v[132:135], v[108:111]
    ds_read_b64_tr_b16 v[132:133], v4 offset:3072
    ds_read_b64_tr_b16 v[134:135], v25 offset:3072
    v_mfma_f32_16x16x32_bf16 v[108:111], a[100:103], v[136:139], v[108:111]
    ds_read_b64_tr_b16 v[136:137], v4 offset:4096
    ds_read_b64_tr_b16 v[138:139], v25 offset:4096
    v_mfma_f32_16x16x32_bf16 v[108:111], a[124:127], v[140:143], v[108:111]
    ds_read_b64_tr_b16 v[140:141], v4 offset:5120
    ds_read_b64_tr_b16 v[142:143], v25 offset:5120
    v_mfma_f32_16x16x32_bf16 v[108:111], a[148:151], v[144:147], v[108:111]
    ds_read_b64_tr_b16 v[144:145], v4 offset:6144
    ds_read_b64_tr_b16 v[146:147], v25 offset:6144
    v_mfma_f32_16x16x32_bf16 v[108:111], a[172:175], v[148:151], v[108:111]
    ds_read_b64_tr_b16 v[148:149], v4 offset:7168
    ds_read_b64_tr_b16 v[150:151], v25 offset:7168
    v_mfma_f32_16x16x32_bf16 v[108:111], a[196:199], v[152:155], v[108:111]
    ds_read_b64_tr_b16 v[152:153], v4 offset:8192
    ds_read_b64_tr_b16 v[154:155], v25 offset:8192
    v_mfma_f32_16x16x32_bf16 v[108:111], a[220:223], v[156:159], v[108:111]
    ds_read_b64_tr_b16 v[156:157], v4 offset:9216
    ds_read_b64_tr_b16 v[158:159], v25 offset:9216
    v_mfma_f32_16x16x32_bf16 v[108:111], a[244:247], v[160:163], v[108:111]
    ds_read_b64_tr_b16 v[160:161], v4 offset:10240
    ds_read_b64_tr_b16 v[162:163], v25 offset:10240
    v_mfma_f32_16x16x32_bf16 v[108:111], v[188:191], v[164:167], v[108:111]
    ds_read_b64_tr_b16 v[164:165], v4 offset:11264
    ds_read_b64_tr_b16 v[166:167], v25 offset:11264
    v_mfma_f32_16x16x32_bf16 v[108:111], v[212:215], v[168:171], v[108:111]
    ds_read_b64_tr_b16 v[168:169], v4 offset:12288
    ds_read_b64_tr_b16 v[170:171], v25 offset:12288
    v_mfma_f32_16x16x32_bf16 v[108:111], v[236:239], v[172:175], v[108:111]
    ds_read_b64_tr_b16 v[172:173], v4 offset:13312
    ds_read_b64_tr_b16 v[174:175], v25 offset:13312
    s_waitcnt lgkmcnt(15)
    v_mfma_f32_16x16x32_bf16 v[112:115], a[8:11], v[120:123], 0
    v_cvt_pk_bf16_f32 v68, v104, v105
    v_cvt_pk_bf16_f32 v69, v106, v107
    v_mfma_f32_16x16x32_bf16 v[112:115], a[32:35], v[124:127], v[112:115]
    v_cndmask_b32 v26, v72, v73, s[76:77]
    v_cndmask_b32 v27, v74, v75, s[76:77]
    v_mfma_f32_16x16x32_bf16 v[112:115], a[56:59], v[128:131], v[112:115]
    v_cndmask_b32 v28, v76, v77, s[76:77]
    v_cndmask_b32 v29, v78, v79, s[76:77]
    v_mfma_f32_16x16x32_bf16 v[112:115], a[80:83], v[132:135], v[112:115]
    v_cndmask_b32 v26, v26, v28, s[78:79]
    v_cndmask_b32 v27, v27, v29, s[80:81]
    v_mfma_f32_16x16x32_bf16 v[112:115], a[104:107], v[136:139], v[112:115]
    v_mul_f32 v26, v26, v8
    v_mfma_f32_16x16x32_bf16 v[112:115], a[128:131], v[140:143], v[112:115]
    v_mul_f32 v27, v27, v9
    v_mul_f32 v11, s91, v10
    s_waitcnt lgkmcnt(10)
    v_mfma_f32_16x16x32_bf16 v[112:115], a[152:155], v[144:147], v[112:115]
    v_cvt_pk_bf16_f32 v70, v108, v109
    v_cvt_pk_bf16_f32 v71, v110, v111
    v_mfma_f32_16x16x32_bf16 v[112:115], a[176:179], v[148:151], v[112:115]
    v_cndmask_b32 v70, v70, 0, s[82:83]
    v_cndmask_b32 v71, v71, 0, s[82:83]
    v_mfma_f32_16x16x32_bf16 v[112:115], a[200:203], v[152:155], v[112:115]
    v_max_f32 v28, v26, v27
    v_mov_b32 v29, v28
    s_waitcnt lgkmcnt(4)
    v_mfma_f32_16x16x32_bf16 v[112:115], a[224:227], v[156:159], v[112:115]
    v_mfma_f32_16x16x32_bf16 v[112:115], a[248:251], v[160:163], v[112:115]
    v_permlane16_swap_b32 v28, v29
    v_max_f32 v28, v28, v29
    v_mfma_f32_16x16x32_bf16 v[112:115], v[192:195], v[164:167], v[112:115]
    v_mov_b32 v29, v28
    s_waitcnt lgkmcnt(0)
    v_mfma_f32_16x16x32_bf16 v[112:115], v[216:219], v[168:171], v[112:115]
    v_mfma_f32_16x16x32_bf16 v[112:115], v[240:243], v[172:175], v[112:115]
    v_permlane32_swap_b32 v28, v29
    v_max_f32 v28, v28, v29
    v_mfma_f32_16x16x32_bf16 v[116:119], a[12:15], v[120:123], 0
    v_sub_f32 v26, v26, v28
    v_sub_f32 v27, v27, v28
    v_mfma_f32_16x16x32_bf16 v[116:119], a[36:39], v[124:127], v[116:119]
    v_mul_f32 v26, v11, v26
    v_mul_f32 v27, v11, v27
    v_mfma_f32_16x16x32_bf16 v[116:119], a[60:63], v[128:131], v[116:119]
    v_exp_f32 v26, v26
    v_mfma_f32_16x16x32_bf16 v[116:119], a[84:87], v[132:135], v[116:119]
    v_exp_f32 v27, v27
    v_mfma_f32_16x16x32_bf16 v[116:119], a[108:111], v[136:139], v[116:119]
    v_add_f32 v28, v26, v27
    v_mov_b32 v29, v28
    v_mfma_f32_16x16x32_bf16 v[116:119], a[132:135], v[140:143], v[116:119]
    v_mfma_f32_16x16x32_bf16 v[116:119], a[156:159], v[144:147], v[116:119]
    v_cvt_pk_bf16_f32 v56, v112, v113
    v_cvt_pk_bf16_f32 v57, v114, v115
    v_mfma_f32_16x16x32_bf16 v[116:119], a[180:183], v[148:151], v[116:119]
    v_permlane16_swap_b32 v28, v29
    v_add_f32 v28, v28, v29
    v_mfma_f32_16x16x32_bf16 v[116:119], a[204:207], v[152:155], v[116:119]
    v_mov_b32 v29, v28
    v_mfma_f32_16x16x32_bf16 v[116:119], a[228:231], v[156:159], v[116:119]
    v_mfma_f32_16x16x32_bf16 v[116:119], a[252:255], v[160:163], v[116:119]
    v_permlane32_swap_b32 v28, v29
    v_add_f32 v28, v28, v29
    v_mfma_f32_16x16x32_bf16 v[116:119], v[196:199], v[164:167], v[116:119]
    v_rcp_f32 v28, v28
    v_mfma_f32_16x16x32_bf16 v[116:119], v[220:223], v[168:171], v[116:119]
    v_mul_f32 v26, v26, v8
    v_mul_f32 v27, v27, v9
    v_mfma_f32_16x16x32_bf16 v[116:119], v[244:247], v[172:175], v[116:119]
    v_mul_f32 v26, v26, v28
    v_mul_f32 v27, v27, v28
    v_mfma_f32_16x16x32_bf16 v[96:99], v[120:123], a[16:19], 0
    v_cvt_pk_bf16_f32 v26, v26, v26
    v_cvt_pk_bf16_f32 v27, v27, v27
    v_mfma_f32_16x16x32_bf16 v[96:99], v[124:127], a[40:43], v[96:99]
    v_and_b32 v80, v26, v14
    v_and_b32 v81, v27, v15
    v_mfma_f32_16x16x32_bf16 v[96:99], v[128:131], a[64:67], v[96:99]
    v_and_b32 v82, v26, v16
    v_and_b32 v83, v27, v17
    v_mfma_f32_16x16x32_bf16 v[96:99], v[132:135], a[88:91], v[96:99]
    v_mfma_f32_16x16x32_bf16 v[96:99], v[136:139], a[112:115], v[96:99]
    v_mfma_f32_16x16x32_bf16 v[72:75], v[34:37], v[80:83], 0
    v_mfma_f32_16x16x32_bf16 v[96:99], v[140:143], a[136:139], v[96:99]
    v_mfma_f32_16x16x32_bf16 v[76:79], v[44:47], v[80:83], 0
    v_mfma_f32_16x16x32_bf16 v[96:99], v[144:147], a[160:163], v[96:99]
    v_cvt_pk_bf16_f32 v58, v116, v117
    v_cvt_pk_bf16_f32 v59, v118, v119
    v_mfma_f32_16x16x32_bf16 v[96:99], v[148:151], a[184:187], v[96:99]
    v_cndmask_b32 v58, v58, 0, s[82:83]
    v_cndmask_b32 v59, v59, 0, s[82:83]
    v_mfma_f32_16x16x32_bf16 v[96:99], v[152:155], a[208:211], v[96:99]
    s_add_u32 s53, s74, 16384
    v_mfma_f32_16x16x32_bf16 v[96:99], v[156:159], a[232:235], v[96:99]
    v_mfma_f32_16x16x32_bf16 v[96:99], v[160:163], v[176:179], v[96:99]
    v_mfma_f32_16x16x32_bf16 v[96:99], v[164:167], v[200:203], v[96:99]
    v_mfma_f32_16x16x32_bf16 v[96:99], v[168:171], v[224:227], v[96:99]
    v_mfma_f32_16x16x32_bf16 v[96:99], v[172:175], v[248:251], v[96:99]
    v_cvt_pk_bf16_f32 v84, v72, v73
    v_cvt_pk_bf16_f32 v85, v74, v75
    v_mfma_f32_16x16x32_bf16 v[100:103], v[120:123], a[20:23], 0
    v_cvt_pk_bf16_f32 v86, v76, v77
    v_cvt_pk_bf16_f32 v87, v78, v79
    v_mfma_f32_16x16x32_bf16 v[100:103], v[124:127], a[44:47], v[100:103]
    v_cndmask_b32 v86, v86, 0, s[82:83]
    v_cndmask_b32 v87, v87, 0, s[82:83]
    v_mfma_f32_16x16x32_bf16 v[100:103], v[128:131], a[68:71], v[100:103]
    buffer_store_dwordx4 v[84:87], v23, s[24:27], s53 offen sc1
    v_mfma_f32_16x16x32_bf16 v[100:103], v[132:135], a[92:95], v[100:103]
    v_mfma_f32_16x16x32_bf16 v[100:103], v[136:139], a[116:119], v[100:103]
    v_mfma_f32_16x16x32_bf16 v[72:75], v[60:63], v[68:71], 0
    v_mfma_f32_16x16x32_bf16 v[100:103], v[140:143], a[140:143], v[100:103]
    v_mfma_f32_16x16x32_bf16 v[76:79], v[52:55], v[68:71], 0
    v_mfma_f32_16x16x32_bf16 v[100:103], v[144:147], a[164:167], v[100:103]
    v_cvt_pk_bf16_f32 v40, v96, v97
    v_cvt_pk_bf16_f32 v41, v98, v99
    v_mfma_f32_16x16x32_bf16 v[100:103], v[148:151], a[188:191], v[100:103]
    v_cvt_pk_bf16_f32 v32, v96, v97
    v_cvt_pk_bf16_f32 v33, v98, v99
    v_mfma_f32_16x16x32_bf16 v[100:103], v[152:155], a[212:215], v[100:103]
    ds_read_u16_d16_hi v8, v93 offset:32768
    ds_read_u16_d16_hi v9, v94 offset:32768
    v_mfma_f32_16x16x32_bf16 v[100:103], v[156:159], a[236:239], v[100:103]
    ds_read_u16_d16_hi v10, v92 offset:32768
    v_mfma_f32_16x16x32_bf16 v[100:103], v[160:163], v[180:183], v[100:103]
    v_mfma_f32_16x16x32_bf16 v[100:103], v[164:167], v[204:207], v[100:103]
    v_mfma_f32_16x16x32_bf16 v[100:103], v[168:171], v[228:231], v[100:103]
    v_mfma_f32_16x16x32_bf16 v[100:103], v[172:175], v[252:255], v[100:103]
    v_cndmask_b32 v26, v72, v73, s[76:77]
    v_cndmask_b32 v27, v74, v75, s[76:77]
    v_mfma_f32_16x16x32_bf16 v[104:107], a[0:3], v[120:123], 0
    v_cndmask_b32 v28, v76, v77, s[76:77]
    v_cndmask_b32 v29, v78, v79, s[76:77]
    v_mfma_f32_16x16x32_bf16 v[104:107], a[24:27], v[124:127], v[104:107]
    v_cndmask_b32 v26, v26, v28, s[78:79]
    v_cndmask_b32 v27, v27, v29, s[80:81]
    v_mfma_f32_16x16x32_bf16 v[104:107], a[48:51], v[128:131], v[104:107]
    s_waitcnt lgkmcnt(0)
    v_mul_f32 v26, v26, v8
    v_mfma_f32_16x16x32_bf16 v[104:107], a[72:75], v[132:135], v[104:107]
    v_mul_f32 v27, v27, v9
    v_mul_f32 v11, s91, v10
    v_mfma_f32_16x16x32_bf16 v[104:107], a[96:99], v[136:139], v[104:107]
    v_max_f32 v28, v26, v27
    v_mov_b32 v29, v28
    v_mfma_f32_16x16x32_bf16 v[104:107], a[120:123], v[140:143], v[104:107]
    v_mfma_f32_16x16x32_bf16 v[104:107], a[144:147], v[144:147], v[104:107]
    v_cvt_pk_bf16_f32 v50, v100, v101
    v_cvt_pk_bf16_f32 v51, v102, v103
    v_mfma_f32_16x16x32_bf16 v[104:107], a[168:171], v[148:151], v[104:107]
    v_cvt_pk_bf16_f32 v42, v100, v101
    v_cvt_pk_bf16_f32 v43, v102, v103
    v_mfma_f32_16x16x32_bf16 v[104:107], a[192:195], v[152:155], v[104:107]
    v_permlane16_swap_b32 v28, v29
    v_max_f32 v28, v28, v29
    v_mfma_f32_16x16x32_bf16 v[104:107], a[216:219], v[156:159], v[104:107]
    v_mov_b32 v29, v28
    v_mfma_f32_16x16x32_bf16 v[104:107], a[240:243], v[160:163], v[104:107]
    v_mfma_f32_16x16x32_bf16 v[104:107], v[184:187], v[164:167], v[104:107]
    v_permlane32_swap_b32 v28, v29
    v_max_f32 v28, v28, v29
    v_mfma_f32_16x16x32_bf16 v[104:107], v[208:211], v[168:171], v[104:107]
    v_sub_f32 v26, v26, v28
    v_sub_f32 v27, v27, v28
    v_mfma_f32_16x16x32_bf16 v[104:107], v[232:235], v[172:175], v[104:107]
    v_mul_f32 v26, v11, v26
    v_mul_f32 v27, v11, v27
    v_mfma_f32_16x16x32_bf16 v[108:111], a[4:7], v[120:123], 0
    ds_read_b64_tr_b16 v[120:121], v4 offset:16384
    ds_read_b64_tr_b16 v[122:123], v25 offset:16384
    v_mfma_f32_16x16x32_bf16 v[108:111], a[28:31], v[124:127], v[108:111]
    ds_read_b64_tr_b16 v[124:125], v4 offset:17408
    ds_read_b64_tr_b16 v[126:127], v25 offset:17408
    v_mfma_f32_16x16x32_bf16 v[108:111], a[52:55], v[128:131], v[108:111]
    ds_read_b64_tr_b16 v[128:129], v4 offset:18432
    ds_read_b64_tr_b16 v[130:131], v25 offset:18432
    v_mfma_f32_16x16x32_bf16 v[108:111], a[76:79], v[132:135], v[108:111]
    ds_read_b64_tr_b16 v[132:133], v4 offset:19456
    ds_read_b64_tr_b16 v[134:135], v25 offset:19456
    v_mfma_f32_16x16x32_bf16 v[108:111], a[100:103], v[136:139], v[108:111]
    ds_read_b64_tr_b16 v[136:137], v4 offset:20480
    ds_read_b64_tr_b16 v[138:139], v25 offset:20480
    v_mfma_f32_16x16x32_bf16 v[108:111], a[124:127], v[140:143], v[108:111]
    ds_read_b64_tr_b16 v[140:141], v4 offset:21504
    ds_read_b64_tr_b16 v[142:143], v25 offset:21504
    v_mfma_f32_16x16x32_bf16 v[108:111], a[148:151], v[144:147], v[108:111]
    ds_read_b64_tr_b16 v[144:145], v4 offset:22528
    ds_read_b64_tr_b16 v[146:147], v25 offset:22528
    v_mfma_f32_16x16x32_bf16 v[108:111], a[172:175], v[148:151], v[108:111]
    ds_read_b64_tr_b16 v[148:149], v4 offset:23552
    ds_read_b64_tr_b16 v[150:151], v25 offset:23552
    v_mfma_f32_16x16x32_bf16 v[108:111], a[196:199], v[152:155], v[108:111]
    ds_read_b64_tr_b16 v[152:153], v4 offset:24576
    ds_read_b64_tr_b16 v[154:155], v25 offset:24576
    v_mfma_f32_16x16x32_bf16 v[108:111], a[220:223], v[156:159], v[108:111]
    ds_read_b64_tr_b16 v[156:157], v4 offset:25600
    ds_read_b64_tr_b16 v[158:159], v25 offset:25600
    v_mfma_f32_16x16x32_bf16 v[108:111], a[244:247], v[160:163], v[108:111]
    ds_read_b64_tr_b16 v[160:161], v4 offset:26624
    ds_read_b64_tr_b16 v[162:163], v25 offset:26624
    v_mfma_f32_16x16x32_bf16 v[108:111], v[188:191], v[164:167], v[108:111]
    ds_read_b64_tr_b16 v[164:165], v4 offset:27648
    ds_read_b64_tr_b16 v[166:167], v25 offset:27648
    v_mfma_f32_16x16x32_bf16 v[108:111], v[212:215], v[168:171], v[108:111]
    ds_read_b64_tr_b16 v[168:169], v4 offset:28672
    ds_read_b64_tr_b16 v[170:171], v25 offset:28672
    v_mfma_f32_16x16x32_bf16 v[108:111], v[236:239], v[172:175], v[108:111]
    ds_read_b64_tr_b16 v[172:173], v4 offset:29696
    ds_read_b64_tr_b16 v[174:175], v25 offset:29696
    s_waitcnt lgkmcnt(15)
    v_mfma_f32_16x16x32_bf16 v[112:115], a[8:11], v[120:123], 0
    v_cvt_pk_bf16_f32 v64, v104, v105
    v_cvt_pk_bf16_f32 v65, v106, v107
    v_mfma_f32_16x16x32_bf16 v[112:115], a[32:35], v[124:127], v[112:115]
    v_exp_f32 v26, v26
    v_mfma_f32_16x16x32_bf16 v[112:115], a[56:59], v[128:131], v[112:115]
    v_exp_f32 v27, v27
    v_mfma_f32_16x16x32_bf16 v[112:115], a[80:83], v[132:135], v[112:115]
    v_add_f32 v28, v26, v27
    v_mov_b32 v29, v28
    v_mfma_f32_16x16x32_bf16 v[112:115], a[104:107], v[136:139], v[112:115]
    v_mfma_f32_16x16x32_bf16 v[112:115], a[128:131], v[140:143], v[112:115]
    v_permlane16_swap_b32 v28, v29
    v_add_f32 v28, v28, v29
    s_waitcnt lgkmcnt(10)
    v_mfma_f32_16x16x32_bf16 v[112:115], a[152:155], v[144:147], v[112:115]
    v_cvt_pk_bf16_f32 v66, v108, v109
    v_cvt_pk_bf16_f32 v67, v110, v111
    v_mfma_f32_16x16x32_bf16 v[112:115], a[176:179], v[148:151], v[112:115]
    v_cndmask_b32 v66, v66, 0, s[82:83]
    v_cndmask_b32 v67, v67, 0, s[82:83]
    v_mfma_f32_16x16x32_bf16 v[112:115], a[200:203], v[152:155], v[112:115]
    v_mov_b32 v29, v28
    s_waitcnt lgkmcnt(4)
    v_mfma_f32_16x16x32_bf16 v[112:115], a[224:227], v[156:159], v[112:115]
    v_mfma_f32_16x16x32_bf16 v[112:115], a[248:251], v[160:163], v[112:115]
    v_permlane32_swap_b32 v28, v29
    v_add_f32 v28, v28, v29
    v_mfma_f32_16x16x32_bf16 v[112:115], v[192:195], v[164:167], v[112:115]
    v_rcp_f32 v28, v28
    s_waitcnt lgkmcnt(0)
    v_mfma_f32_16x16x32_bf16 v[112:115], v[216:219], v[168:171], v[112:115]
    v_mul_f32 v26, v26, v8
    v_mul_f32 v27, v27, v9
    v_mfma_f32_16x16x32_bf16 v[112:115], v[240:243], v[172:175], v[112:115]
    v_mul_f32 v26, v26, v28
    v_mul_f32 v27, v27, v28
    v_mfma_f32_16x16x32_bf16 v[116:119], a[12:15], v[120:123], 0
    v_cvt_pk_bf16_f32 v26, v26, v26
    v_cvt_pk_bf16_f32 v27, v27, v27
    v_mfma_f32_16x16x32_bf16 v[116:119], a[36:39], v[124:127], v[116:119]
    v_and_b32 v80, v26, v14
    v_and_b32 v81, v27, v15
    v_mfma_f32_16x16x32_bf16 v[116:119], a[60:63], v[128:131], v[116:119]
    v_and_b32 v82, v26, v16
    v_and_b32 v83, v27, v17
    v_mfma_f32_16x16x32_bf16 v[116:119], a[84:87], v[132:135], v[116:119]
    v_mfma_f32_16x16x32_bf16 v[116:119], a[108:111], v[136:139], v[116:119]
    v_mfma_f32_16x16x32_bf16 v[72:75], v[36:39], v[80:83], 0
    v_mfma_f32_16x16x32_bf16 v[116:119], a[132:135], v[140:143], v[116:119]
    v_mfma_f32_16x16x32_bf16 v[76:79], v[46:49], v[80:83], 0
    v_mfma_f32_16x16x32_bf16 v[116:119], a[156:159], v[144:147], v[116:119]
    v_cvt_pk_bf16_f32 v60, v112, v113
    v_cvt_pk_bf16_f32 v61, v114, v115
    v_mfma_f32_16x16x32_bf16 v[116:119], a[180:183], v[148:151], v[116:119]
    s_add_u32 s53, s74, 32768
    v_mfma_f32_16x16x32_bf16 v[116:119], a[204:207], v[152:155], v[116:119]
    v_mfma_f32_16x16x32_bf16 v[116:119], a[228:231], v[156:159], v[116:119]
    v_mfma_f32_16x16x32_bf16 v[116:119], a[252:255], v[160:163], v[116:119]
    v_mfma_f32_16x16x32_bf16 v[116:119], v[196:199], v[164:167], v[116:119]
    v_mfma_f32_16x16x32_bf16 v[116:119], v[220:223], v[168:171], v[116:119]
    v_cvt_pk_bf16_f32 v84, v72, v73
    v_cvt_pk_bf16_f32 v85, v74, v75
    v_mfma_f32_16x16x32_bf16 v[116:119], v[244:247], v[172:175], v[116:119]
    v_cvt_pk_bf16_f32 v86, v76, v77
    v_cvt_pk_bf16_f32 v87, v78, v79
    v_mfma_f32_16x16x32_bf16 v[96:99], v[120:123], a[16:19], 0
    v_cndmask_b32 v86, v86, 0, s[82:83]
    v_cndmask_b32 v87, v87, 0, s[82:83]
    v_mfma_f32_16x16x32_bf16 v[96:99], v[124:127], a[40:43], v[96:99]
    buffer_store_dwordx4 v[84:87], v23, s[24:27], s53 offen sc1
    v_mfma_f32_16x16x32_bf16 v[96:99], v[128:131], a[64:67], v[96:99]
    v_mfma_f32_16x16x32_bf16 v[96:99], v[132:135], a[88:91], v[96:99]
    v_mfma_f32_16x16x32_bf16 v[72:75], v[52:55], v[64:67], 0
    v_mfma_f32_16x16x32_bf16 v[96:99], v[136:139], a[112:115], v[96:99]
    v_mfma_f32_16x16x32_bf16 v[76:79], v[56:59], v[64:67], 0
    v_mfma_f32_16x16x32_bf16 v[96:99], v[140:143], a[136:139], v[96:99]
    ds_read_u16_d16_hi v8, v93 offset:49152
    ds_read_u16_d16_hi v9, v94 offset:49152
    v_mfma_f32_16x16x32_bf16 v[96:99], v[144:147], a[160:163], v[96:99]
    v_cvt_pk_bf16_f32 v62, v116, v117
    v_cvt_pk_bf16_f32 v63, v118, v119
    v_mfma_f32_16x16x32_bf16 v[96:99], v[148:151], a[184:187], v[96:99]
    v_cndmask_b32 v62, v62, 0, s[82:83]
    v_cndmask_b32 v63, v63, 0, s[82:83]
    v_mfma_f32_16x16x32_bf16 v[96:99], v[152:155], a[208:211], v[96:99]
    ds_read_u16_d16_hi v10, v92 offset:49152
    v_mfma_f32_16x16x32_bf16 v[96:99], v[156:159], a[232:235], v[96:99]
    v_mfma_f32_16x16x32_bf16 v[96:99], v[160:163], v[176:179], v[96:99]
    v_mfma_f32_16x16x32_bf16 v[96:99], v[164:167], v[200:203], v[96:99]
    v_mfma_f32_16x16x32_bf16 v[96:99], v[168:171], v[224:227], v[96:99]
    v_cndmask_b32 v26, v72, v73, s[76:77]
    v_cndmask_b32 v27, v74, v75, s[76:77]
    v_mfma_f32_16x16x32_bf16 v[96:99], v[172:175], v[248:251], v[96:99]
    v_cndmask_b32 v28, v76, v77, s[76:77]
    v_cndmask_b32 v29, v78, v79, s[76:77]
    v_mfma_f32_16x16x32_bf16 v[100:103], v[120:123], a[20:23], 0
    v_cndmask_b32 v26, v26, v28, s[78:79]
    v_cndmask_b32 v27, v27, v29, s[80:81]
    v_mfma_f32_16x16x32_bf16 v[100:103], v[124:127], a[44:47], v[100:103]
    s_waitcnt lgkmcnt(0)
    v_mul_f32 v26, v26, v8
    v_mfma_f32_16x16x32_bf16 v[100:103], v[128:131], a[68:71], v[100:103]
    v_mul_f32 v27, v27, v9
    v_mul_f32 v11, s91, v10
    v_mfma_f32_16x16x32_bf16 v[100:103], v[132:135], a[92:95], v[100:103]
    v_max_f32 v28, v26, v27
    v_mov_b32 v29, v28
    v_mfma_f32_16x16x32_bf16 v[100:103], v[136:139], a[116:119], v[100:103]
    v_mfma_f32_16x16x32_bf16 v[100:103], v[140:143], a[140:143], v[100:103]
    v_permlane16_swap_b32 v28, v29
    v_max_f32 v28, v28, v29
    v_mfma_f32_16x16x32_bf16 v[100:103], v[144:147], a[164:167], v[100:103]
    v_cvt_pk_bf16_f32 v34, v96, v97
    v_cvt_pk_bf16_f32 v35, v98, v99
    v_mfma_f32_16x16x32_bf16 v[100:103], v[148:151], a[188:191], v[100:103]
    v_mov_b32 v29, v28
    v_mfma_f32_16x16x32_bf16 v[100:103], v[152:155], a[212:215], v[100:103]
    v_mfma_f32_16x16x32_bf16 v[100:103], v[156:159], a[236:239], v[100:103]
    v_permlane32_swap_b32 v28, v29
    v_max_f32 v28, v28, v29
    v_mfma_f32_16x16x32_bf16 v[100:103], v[160:163], v[180:183], v[100:103]
    v_sub_f32 v26, v26, v28
    v_sub_f32 v27, v27, v28
    v_mfma_f32_16x16x32_bf16 v[100:103], v[164:167], v[204:207], v[100:103]
    v_mul_f32 v26, v11, v26
    v_mul_f32 v27, v11, v27
    v_mfma_f32_16x16x32_bf16 v[100:103], v[168:171], v[228:231], v[100:103]
    v_exp_f32 v26, v26
    v_mfma_f32_16x16x32_bf16 v[100:103], v[172:175], v[252:255], v[100:103]
    v_exp_f32 v27, v27
    v_mfma_f32_16x16x32_bf16 v[104:107], a[0:3], v[120:123], 0
    v_add_f32 v28, v26, v27
    v_mov_b32 v29, v28
    v_mfma_f32_16x16x32_bf16 v[104:107], a[24:27], v[124:127], v[104:107]
    v_mfma_f32_16x16x32_bf16 v[104:107], a[48:51], v[128:131], v[104:107]
    v_permlane16_swap_b32 v28, v29
    v_add_f32 v28, v28, v29
    v_mfma_f32_16x16x32_bf16 v[104:107], a[72:75], v[132:135], v[104:107]
    v_mov_b32 v29, v28
    v_mfma_f32_16x16x32_bf16 v[104:107], a[96:99], v[136:139], v[104:107]
    v_mfma_f32_16x16x32_bf16 v[104:107], a[120:123], v[140:143], v[104:107]
    v_permlane32_swap_b32 v28, v29
    v_add_f32 v28, v28, v29
    v_mfma_f32_16x16x32_bf16 v[104:107], a[144:147], v[144:147], v[104:107]
    v_cvt_pk_bf16_f32 v44, v100, v101
    v_cvt_pk_bf16_f32 v45, v102, v103
    v_mfma_f32_16x16x32_bf16 v[104:107], a[168:171], v[148:151], v[104:107]
    v_rcp_f32 v28, v28
    v_mfma_f32_16x16x32_bf16 v[104:107], a[192:195], v[152:155], v[104:107]
    v_mul_f32 v26, v26, v8
    v_mul_f32 v27, v27, v9
    v_mfma_f32_16x16x32_bf16 v[104:107], a[216:219], v[156:159], v[104:107]
    v_mul_f32 v26, v26, v28
    v_mul_f32 v27, v27, v28
    v_mfma_f32_16x16x32_bf16 v[104:107], a[240:243], v[160:163], v[104:107]
    v_cvt_pk_bf16_f32 v26, v26, v26
    v_cvt_pk_bf16_f32 v27, v27, v27
    v_mfma_f32_16x16x32_bf16 v[104:107], v[184:187], v[164:167], v[104:107]
    v_and_b32 v80, v26, v14
    v_and_b32 v81, v27, v15
    v_mfma_f32_16x16x32_bf16 v[104:107], v[208:211], v[168:171], v[104:107]
    v_and_b32 v82, v26, v16
    v_and_b32 v83, v27, v17
    v_mfma_f32_16x16x32_bf16 v[104:107], v[232:235], v[172:175], v[104:107]
    v_mfma_f32_16x16x32_bf16 v[108:111], a[4:7], v[120:123], 0
    ds_read_b64_tr_b16 v[120:121], v4 offset:32768
    ds_read_b64_tr_b16 v[122:123], v25 offset:32768
    v_mfma_f32_16x16x32_bf16 v[108:111], a[28:31], v[124:127], v[108:111]
    ds_read_b64_tr_b16 v[124:125], v4 offset:33792
    ds_read_b64_tr_b16 v[126:127], v25 offset:33792
    v_mfma_f32_16x16x32_bf16 v[108:111], a[52:55], v[128:131], v[108:111]
    ds_read_b64_tr_b16 v[128:129], v4 offset:34816
    ds_read_b64_tr_b16 v[130:131], v25 offset:34816
    v_mfma_f32_16x16x32_bf16 v[108:111], a[76:79], v[132:135], v[108:111]
    ds_read_b64_tr_b16 v[132:133], v4 offset:35840
    ds_read_b64_tr_b16 v[134:135], v25 offset:35840
    v_mfma_f32_16x16x32_bf16 v[108:111], a[100:103], v[136:139], v[108:111]
    ds_read_b64_tr_b16 v[136:137], v4 offset:36864
    ds_read_b64_tr_b16 v[138:139], v25 offset:36864
    v_mfma_f32_16x16x32_bf16 v[108:111], a[124:127], v[140:143], v[108:111]
    ds_read_b64_tr_b16 v[140:141], v4 offset:37888
    ds_read_b64_tr_b16 v[142:143], v25 offset:37888
    v_mfma_f32_16x16x32_bf16 v[108:111], a[148:151], v[144:147], v[108:111]
    ds_read_b64_tr_b16 v[144:145], v4 offset:38912
    ds_read_b64_tr_b16 v[146:147], v25 offset:38912
    v_mfma_f32_16x16x32_bf16 v[108:111], a[172:175], v[148:151], v[108:111]
    ds_read_b64_tr_b16 v[148:149], v4 offset:39936
    ds_read_b64_tr_b16 v[150:151], v25 offset:39936
    v_mfma_f32_16x16x32_bf16 v[108:111], a[196:199], v[152:155], v[108:111]
    ds_read_b64_tr_b16 v[152:153], v4 offset:40960
    ds_read_b64_tr_b16 v[154:155], v25 offset:40960
    v_mfma_f32_16x16x32_bf16 v[108:111], a[220:223], v[156:159], v[108:111]
    ds_read_b64_tr_b16 v[156:157], v4 offset:41984
    ds_read_b64_tr_b16 v[158:159], v25 offset:41984
    v_mfma_f32_16x16x32_bf16 v[108:111], a[244:247], v[160:163], v[108:111]
    ds_read_b64_tr_b16 v[160:161], v4 offset:43008
    ds_read_b64_tr_b16 v[162:163], v25 offset:43008
    v_mfma_f32_16x16x32_bf16 v[108:111], v[188:191], v[164:167], v[108:111]
    ds_read_b64_tr_b16 v[164:165], v4 offset:44032
    ds_read_b64_tr_b16 v[166:167], v25 offset:44032
    v_mfma_f32_16x16x32_bf16 v[108:111], v[212:215], v[168:171], v[108:111]
    ds_read_b64_tr_b16 v[168:169], v4 offset:45056
    ds_read_b64_tr_b16 v[170:171], v25 offset:45056
    v_mfma_f32_16x16x32_bf16 v[108:111], v[236:239], v[172:175], v[108:111]
    ds_read_b64_tr_b16 v[172:173], v4 offset:46080
    ds_read_b64_tr_b16 v[174:175], v25 offset:46080
    s_waitcnt lgkmcnt(15)
    v_mfma_f32_16x16x32_bf16 v[112:115], a[8:11], v[120:123], 0
    v_cvt_pk_bf16_f32 v68, v104, v105
    v_cvt_pk_bf16_f32 v69, v106, v107
    v_mfma_f32_16x16x32_bf16 v[112:115], a[32:35], v[124:127], v[112:115]
    v_mfma_f32_16x16x32_bf16 v[72:75], v[38:41], v[80:83], 0
    v_mfma_f32_16x16x32_bf16 v[112:115], a[56:59], v[128:131], v[112:115]
    v_mfma_f32_16x16x32_bf16 v[76:79], v[48:51], v[80:83], 0
    v_mfma_f32_16x16x32_bf16 v[112:115], a[80:83], v[132:135], v[112:115]
    s_add_u32 s53, s74, 49152
    v_mfma_f32_16x16x32_bf16 v[112:115], a[104:107], v[136:139], v[112:115]
    v_mfma_f32_16x16x32_bf16 v[112:115], a[128:131], v[140:143], v[112:115]
    s_waitcnt lgkmcnt(10)
    v_mfma_f32_16x16x32_bf16 v[112:115], a[152:155], v[144:147], v[112:115]
    v_cvt_pk_bf16_f32 v70, v108, v109
    v_cvt_pk_bf16_f32 v71, v110, v111
    v_mfma_f32_16x16x32_bf16 v[112:115], a[176:179], v[148:151], v[112:115]
    v_cndmask_b32 v70, v70, 0, s[82:83]
    v_cndmask_b32 v71, v71, 0, s[82:83]
    v_mfma_f32_16x16x32_bf16 v[112:115], a[200:203], v[152:155], v[112:115]
    v_cvt_pk_bf16_f32 v84, v72, v73
    v_cvt_pk_bf16_f32 v85, v74, v75
    s_waitcnt lgkmcnt(4)
    v_mfma_f32_16x16x32_bf16 v[112:115], a[224:227], v[156:159], v[112:115]
    v_cvt_pk_bf16_f32 v86, v76, v77
    v_cvt_pk_bf16_f32 v87, v78, v79
    v_mfma_f32_16x16x32_bf16 v[112:115], a[248:251], v[160:163], v[112:115]
    v_cndmask_b32 v86, v86, 0, s[82:83]
    v_cndmask_b32 v87, v87, 0, s[82:83]
    v_mfma_f32_16x16x32_bf16 v[112:115], v[192:195], v[164:167], v[112:115]
    buffer_store_dwordx4 v[84:87], v23, s[24:27], s53 offen sc1
    s_waitcnt lgkmcnt(0)
    v_mfma_f32_16x16x32_bf16 v[112:115], v[216:219], v[168:171], v[112:115]
    v_add_u32 v92, 65536, v92
    v_add_u32 v93, 65536, v93
    v_mfma_f32_16x16x32_bf16 v[112:115], v[240:243], v[172:175], v[112:115]
    v_add_u32 v94, 65536, v94
    v_mfma_f32_16x16x32_bf16 v[116:119], a[12:15], v[120:123], 0
    v_mfma_f32_16x16x32_bf16 v[72:75], v[56:59], v[68:71], 0
    v_mfma_f32_16x16x32_bf16 v[116:119], a[36:39], v[124:127], v[116:119]
    v_mfma_f32_16x16x32_bf16 v[76:79], v[60:63], v[68:71], 0
    v_mfma_f32_16x16x32_bf16 v[116:119], a[60:63], v[128:131], v[116:119]
    ds_read_u16_d16_hi v8, v93 offset:0
    ds_read_u16_d16_hi v9, v94 offset:0
    v_mfma_f32_16x16x32_bf16 v[116:119], a[84:87], v[132:135], v[116:119]
    ds_read_u16_d16_hi v10, v92 offset:0
    v_mfma_f32_16x16x32_bf16 v[116:119], a[108:111], v[136:139], v[116:119]
    v_mfma_f32_16x16x32_bf16 v[116:119], a[132:135], v[140:143], v[116:119]
    v_mfma_f32_16x16x32_bf16 v[116:119], a[156:159], v[144:147], v[116:119]
    v_cvt_pk_bf16_f32 v52, v112, v113
    v_cvt_pk_bf16_f32 v53, v114, v115
    v_mfma_f32_16x16x32_bf16 v[116:119], a[180:183], v[148:151], v[116:119]
    v_cndmask_b32 v26, v72, v73, s[76:77]
    v_cndmask_b32 v27, v74, v75, s[76:77]
    v_mfma_f32_16x16x32_bf16 v[116:119], a[204:207], v[152:155], v[116:119]
    v_cndmask_b32 v28, v76, v77, s[76:77]
    v_cndmask_b32 v29, v78, v79, s[76:77]
    v_mfma_f32_16x16x32_bf16 v[116:119], a[228:231], v[156:159], v[116:119]
    v_cndmask_b32 v26, v26, v28, s[78:79]
    v_cndmask_b32 v27, v27, v29, s[80:81]
    v_mfma_f32_16x16x32_bf16 v[116:119], a[252:255], v[160:163], v[116:119]
    s_waitcnt lgkmcnt(0)
    v_mul_f32 v26, v26, v8
    v_mfma_f32_16x16x32_bf16 v[116:119], v[196:199], v[164:167], v[116:119]
    v_mul_f32 v27, v27, v9
    v_mul_f32 v11, s91, v10
    v_mfma_f32_16x16x32_bf16 v[116:119], v[220:223], v[168:171], v[116:119]
    v_max_f32 v28, v26, v27
    v_mov_b32 v29, v28
    v_mfma_f32_16x16x32_bf16 v[116:119], v[244:247], v[172:175], v[116:119]
    v_mfma_f32_16x16x32_bf16 v[96:99], v[120:123], a[16:19], 0
    v_permlane16_swap_b32 v28, v29
    v_max_f32 v28, v28, v29
    v_mfma_f32_16x16x32_bf16 v[96:99], v[124:127], a[40:43], v[96:99]
    v_mov_b32 v29, v28
    v_mfma_f32_16x16x32_bf16 v[96:99], v[128:131], a[64:67], v[96:99]
    v_mfma_f32_16x16x32_bf16 v[96:99], v[132:135], a[88:91], v[96:99]
    v_permlane32_swap_b32 v28, v29
    v_max_f32 v28, v28, v29
    v_mfma_f32_16x16x32_bf16 v[96:99], v[136:139], a[112:115], v[96:99]
    v_sub_f32 v26, v26, v28
    v_sub_f32 v27, v27, v28
    v_mfma_f32_16x16x32_bf16 v[96:99], v[140:143], a[136:139], v[96:99]
    v_mul_f32 v26, v11, v26
    v_mul_f32 v27, v11, v27
    v_mfma_f32_16x16x32_bf16 v[96:99], v[144:147], a[160:163], v[96:99]
    v_cvt_pk_bf16_f32 v54, v116, v117
    v_cvt_pk_bf16_f32 v55, v118, v119
    v_mfma_f32_16x16x32_bf16 v[96:99], v[148:151], a[184:187], v[96:99]
    v_cndmask_b32 v54, v54, 0, s[82:83]
    v_cndmask_b32 v55, v55, 0, s[82:83]
    v_mfma_f32_16x16x32_bf16 v[96:99], v[152:155], a[208:211], v[96:99]
    v_exp_f32 v26, v26
    v_mfma_f32_16x16x32_bf16 v[96:99], v[156:159], a[232:235], v[96:99]
    v_exp_f32 v27, v27
    v_mfma_f32_16x16x32_bf16 v[96:99], v[160:163], v[176:179], v[96:99]
    v_add_f32 v28, v26, v27
    v_mov_b32 v29, v28
    v_mfma_f32_16x16x32_bf16 v[96:99], v[164:167], v[200:203], v[96:99]
    v_mfma_f32_16x16x32_bf16 v[96:99], v[168:171], v[224:227], v[96:99]
    v_permlane16_swap_b32 v28, v29
    v_add_f32 v28, v28, v29
    v_mfma_f32_16x16x32_bf16 v[96:99], v[172:175], v[248:251], v[96:99]
    v_mov_b32 v29, v28
    v_mfma_f32_16x16x32_bf16 v[100:103], v[120:123], a[20:23], 0
    v_mfma_f32_16x16x32_bf16 v[100:103], v[124:127], a[44:47], v[100:103]
    v_permlane32_swap_b32 v28, v29
    v_add_f32 v28, v28, v29
    v_mfma_f32_16x16x32_bf16 v[100:103], v[128:131], a[68:71], v[100:103]
    v_rcp_f32 v28, v28
    v_mfma_f32_16x16x32_bf16 v[100:103], v[132:135], a[92:95], v[100:103]
    v_mul_f32 v26, v26, v8
    v_mul_f32 v27, v27, v9
    v_mfma_f32_16x16x32_bf16 v[100:103], v[136:139], a[116:119], v[100:103]
    v_mul_f32 v26, v26, v28
    v_mul_f32 v27, v27, v28
    v_mfma_f32_16x16x32_bf16 v[100:103], v[140:143], a[140:143], v[100:103]
    v_cvt_pk_bf16_f32 v26, v26, v26
    v_cvt_pk_bf16_f32 v27, v27, v27
    v_mfma_f32_16x16x32_bf16 v[100:103], v[144:147], a[164:167], v[100:103]
    v_cvt_pk_bf16_f32 v36, v96, v97
    v_cvt_pk_bf16_f32 v37, v98, v99
    v_mfma_f32_16x16x32_bf16 v[100:103], v[148:151], a[188:191], v[100:103]
    v_and_b32 v80, v26, v14
    v_and_b32 v81, v27, v15
    v_mfma_f32_16x16x32_bf16 v[100:103], v[152:155], a[212:215], v[100:103]
    v_and_b32 v82, v26, v16
    v_and_b32 v83, v27, v17
    v_mfma_f32_16x16x32_bf16 v[100:103], v[156:159], a[236:239], v[100:103]
    v_mfma_f32_16x16x32_bf16 v[100:103], v[160:163], v[180:183], v[100:103]
    v_mfma_f32_16x16x32_bf16 v[72:75], v[32:35], v[80:83], 0
    v_mfma_f32_16x16x32_bf16 v[100:103], v[164:167], v[204:207], v[100:103]
    v_mfma_f32_16x16x32_bf16 v[76:79], v[42:45], v[80:83], 0
    v_mfma_f32_16x16x32_bf16 v[100:103], v[168:171], v[228:231], v[100:103]
    s_add_u32 s53, s74, 65536
    v_mfma_f32_16x16x32_bf16 v[100:103], v[172:175], v[252:255], v[100:103]
    v_mfma_f32_16x16x32_bf16 v[104:107], a[0:3], v[120:123], 0
    v_mfma_f32_16x16x32_bf16 v[104:107], a[24:27], v[124:127], v[104:107]
    v_mfma_f32_16x16x32_bf16 v[104:107], a[48:51], v[128:131], v[104:107]
    v_mfma_f32_16x16x32_bf16 v[104:107], a[72:75], v[132:135], v[104:107]
    v_cvt_pk_bf16_f32 v84, v72, v73
    v_cvt_pk_bf16_f32 v85, v74, v75
    v_mfma_f32_16x16x32_bf16 v[104:107], a[96:99], v[136:139], v[104:107]
    v_cvt_pk_bf16_f32 v86, v76, v77
    v_cvt_pk_bf16_f32 v87, v78, v79
    v_mfma_f32_16x16x32_bf16 v[104:107], a[120:123], v[140:143], v[104:107]
    v_cndmask_b32 v86, v86, 0, s[82:83]
    v_cndmask_b32 v87, v87, 0, s[82:83]
    v_mfma_f32_16x16x32_bf16 v[104:107], a[144:147], v[144:147], v[104:107]
    v_cvt_pk_bf16_f32 v46, v100, v101
    v_cvt_pk_bf16_f32 v47, v102, v103
    v_mfma_f32_16x16x32_bf16 v[104:107], a[168:171], v[148:151], v[104:107]
    buffer_store_dwordx4 v[84:87], v23, s[24:27], s53 offen sc1
    v_mfma_f32_16x16x32_bf16 v[104:107], a[192:195], v[152:155], v[104:107]
    v_mfma_f32_16x16x32_bf16 v[104:107], a[216:219], v[156:159], v[104:107]
    v_mfma_f32_16x16x32_bf16 v[104:107], a[240:243], v[160:163], v[104:107]
    v_mfma_f32_16x16x32_bf16 v[104:107], v[184:187], v[164:167], v[104:107]
    v_mfma_f32_16x16x32_bf16 v[104:107], v[208:211], v[168:171], v[104:107]
    v_mfma_f32_16x16x32_bf16 v[104:107], v[232:235], v[172:175], v[104:107]
    v_mfma_f32_16x16x32_bf16 v[108:111], a[4:7], v[120:123], 0
    ds_read_b64_tr_b16 v[120:121], v4 offset:49152
    ds_read_b64_tr_b16 v[122:123], v25 offset:49152
    v_mfma_f32_16x16x32_bf16 v[108:111], a[28:31], v[124:127], v[108:111]
    ds_read_b64_tr_b16 v[124:125], v4 offset:50176
    ds_read_b64_tr_b16 v[126:127], v25 offset:50176
    v_mfma_f32_16x16x32_bf16 v[108:111], a[52:55], v[128:131], v[108:111]
    ds_read_b64_tr_b16 v[128:129], v4 offset:51200
    ds_read_b64_tr_b16 v[130:131], v25 offset:51200
    v_mfma_f32_16x16x32_bf16 v[108:111], a[76:79], v[132:135], v[108:111]
    ds_read_b64_tr_b16 v[132:133], v4 offset:52224
    ds_read_b64_tr_b16 v[134:135], v25 offset:52224
    v_mfma_f32_16x16x32_bf16 v[108:111], a[100:103], v[136:139], v[108:111]
    ds_read_b64_tr_b16 v[136:137], v4 offset:53248
    ds_read_b64_tr_b16 v[138:139], v25 offset:53248
    v_mfma_f32_16x16x32_bf16 v[108:111], a[124:127], v[140:143], v[108:111]
    ds_read_b64_tr_b16 v[140:141], v4 offset:54272
    ds_read_b64_tr_b16 v[142:143], v25 offset:54272
    v_mfma_f32_16x16x32_bf16 v[108:111], a[148:151], v[144:147], v[108:111]
    ds_read_b64_tr_b16 v[144:145], v4 offset:55296
    ds_read_b64_tr_b16 v[146:147], v25 offset:55296
    v_mfma_f32_16x16x32_bf16 v[108:111], a[172:175], v[148:151], v[108:111]
    ds_read_b64_tr_b16 v[148:149], v4 offset:56320
    ds_read_b64_tr_b16 v[150:151], v25 offset:56320
    v_mfma_f32_16x16x32_bf16 v[108:111], a[196:199], v[152:155], v[108:111]
    ds_read_b64_tr_b16 v[152:153], v4 offset:57344
    ds_read_b64_tr_b16 v[154:155], v25 offset:57344
    v_mfma_f32_16x16x32_bf16 v[108:111], a[220:223], v[156:159], v[108:111]
    ds_read_b64_tr_b16 v[156:157], v4 offset:58368
    ds_read_b64_tr_b16 v[158:159], v25 offset:58368
    v_mfma_f32_16x16x32_bf16 v[108:111], a[244:247], v[160:163], v[108:111]
    ds_read_b64_tr_b16 v[160:161], v4 offset:59392
    ds_read_b64_tr_b16 v[162:163], v25 offset:59392
    v_mfma_f32_16x16x32_bf16 v[108:111], v[188:191], v[164:167], v[108:111]
    ds_read_b64_tr_b16 v[164:165], v4 offset:60416
    ds_read_b64_tr_b16 v[166:167], v25 offset:60416
    v_mfma_f32_16x16x32_bf16 v[108:111], v[212:215], v[168:171], v[108:111]
    ds_read_b64_tr_b16 v[168:169], v4 offset:61440
    ds_read_b64_tr_b16 v[170:171], v25 offset:61440
    v_mfma_f32_16x16x32_bf16 v[108:111], v[236:239], v[172:175], v[108:111]
    ds_read_b64_tr_b16 v[172:173], v4 offset:62464
    ds_read_b64_tr_b16 v[174:175], v25 offset:62464
    s_waitcnt lgkmcnt(15)
    v_mfma_f32_16x16x32_bf16 v[112:115], a[8:11], v[120:123], 0
    v_cvt_pk_bf16_f32 v64, v104, v105
    v_cvt_pk_bf16_f32 v65, v106, v107
    v_mfma_f32_16x16x32_bf16 v[112:115], a[32:35], v[124:127], v[112:115]
    v_mfma_f32_16x16x32_bf16 v[112:115], a[56:59], v[128:131], v[112:115]
    v_mfma_f32_16x16x32_bf16 v[112:115], a[80:83], v[132:135], v[112:115]
    v_mfma_f32_16x16x32_bf16 v[112:115], a[104:107], v[136:139], v[112:115]
    v_mfma_f32_16x16x32_bf16 v[112:115], a[128:131], v[140:143], v[112:115]
    s_waitcnt lgkmcnt(10)
    v_mfma_f32_16x16x32_bf16 v[112:115], a[152:155], v[144:147], v[112:115]
    v_cvt_pk_bf16_f32 v66, v108, v109
    v_cvt_pk_bf16_f32 v67, v110, v111
    v_mfma_f32_16x16x32_bf16 v[112:115], a[176:179], v[148:151], v[112:115]
    v_cndmask_b32 v66, v66, 0, s[82:83]
    v_cndmask_b32 v67, v67, 0, s[82:83]
    v_mfma_f32_16x16x32_bf16 v[112:115], a[200:203], v[152:155], v[112:115]
    s_waitcnt lgkmcnt(4)
    v_mfma_f32_16x16x32_bf16 v[112:115], a[224:227], v[156:159], v[112:115]
    v_mfma_f32_16x16x32_bf16 v[72:75], v[60:63], v[64:67], 0
    v_mfma_f32_16x16x32_bf16 v[112:115], a[248:251], v[160:163], v[112:115]
    v_mfma_f32_16x16x32_bf16 v[76:79], v[52:55], v[64:67], 0
    v_mfma_f32_16x16x32_bf16 v[112:115], v[192:195], v[164:167], v[112:115]
    ds_read_u16_d16_hi v8, v93 offset:16384
    ds_read_u16_d16_hi v9, v94 offset:16384
    s_waitcnt lgkmcnt(2)
    v_mfma_f32_16x16x32_bf16 v[112:115], v[216:219], v[168:171], v[112:115]
    ds_read_u16_d16_hi v10, v92 offset:16384
    v_mfma_f32_16x16x32_bf16 v[112:115], v[240:243], v[172:175], v[112:115]
    v_mfma_f32_16x16x32_bf16 v[116:119], a[12:15], v[120:123], 0
    v_mfma_f32_16x16x32_bf16 v[116:119], a[36:39], v[124:127], v[116:119]
    v_mfma_f32_16x16x32_bf16 v[116:119], a[60:63], v[128:131], v[116:119]
    v_cndmask_b32 v26, v72, v73, s[76:77]
    v_cndmask_b32 v27, v74, v75, s[76:77]
    v_mfma_f32_16x16x32_bf16 v[116:119], a[84:87], v[132:135], v[116:119]
    v_cndmask_b32 v28, v76, v77, s[76:77]
    v_cndmask_b32 v29, v78, v79, s[76:77]
    v_mfma_f32_16x16x32_bf16 v[116:119], a[108:111], v[136:139], v[116:119]
    v_cndmask_b32 v26, v26, v28, s[78:79]
    v_cndmask_b32 v27, v27, v29, s[80:81]
    v_mfma_f32_16x16x32_bf16 v[116:119], a[132:135], v[140:143], v[116:119]
    s_waitcnt lgkmcnt(0)
    v_mul_f32 v26, v26, v8
    v_mfma_f32_16x16x32_bf16 v[116:119], a[156:159], v[144:147], v[116:119]
    v_cvt_pk_bf16_f32 v56, v112, v113
    v_cvt_pk_bf16_f32 v57, v114, v115
    v_mfma_f32_16x16x32_bf16 v[116:119], a[180:183], v[148:151], v[116:119]
    v_mul_f32 v27, v27, v9
    v_mul_f32 v11, s91, v10
    v_mfma_f32_16x16x32_bf16 v[116:119], a[204:207], v[152:155], v[116:119]
    v_max_f32 v28, v26, v27
    v_mov_b32 v29, v28
    v_mfma_f32_16x16x32_bf16 v[116:119], a[228:231], v[156:159], v[116:119]
    v_mfma_f32_16x16x32_bf16 v[116:119], a[252:255], v[160:163], v[116:119]
    v_permlane16_swap_b32 v28, v29
    v_max_f32 v28, v28, v29
    v_mfma_f32_16x16x32_bf16 v[116:119], v[196:199], v[164:167], v[116:119]
    v_mov_b32 v29, v28
    v_mfma_f32_16x16x32_bf16 v[116:119], v[220:223], v[168:171], v[116:119]
    v_mfma_f32_16x16x32_bf16 v[116:119], v[244:247], v[172:175], v[116:119]
    v_permlane32_swap_b32 v28, v29
    v_max_f32 v28, v28, v29
    v_mfma_f32_16x16x32_bf16 v[96:99], v[120:123], a[16:19], 0
    v_sub_f32 v26, v26, v28
    v_sub_f32 v27, v27, v28
    v_mfma_f32_16x16x32_bf16 v[96:99], v[124:127], a[40:43], v[96:99]
    v_mul_f32 v26, v11, v26
    v_mul_f32 v27, v11, v27
    v_mfma_f32_16x16x32_bf16 v[96:99], v[128:131], a[64:67], v[96:99]
    v_exp_f32 v26, v26
    v_mfma_f32_16x16x32_bf16 v[96:99], v[132:135], a[88:91], v[96:99]
    v_exp_f32 v27, v27
    v_mfma_f32_16x16x32_bf16 v[96:99], v[136:139], a[112:115], v[96:99]
    v_add_f32 v28, v26, v27
    v_mov_b32 v29, v28
    v_mfma_f32_16x16x32_bf16 v[96:99], v[140:143], a[136:139], v[96:99]
    v_mfma_f32_16x16x32_bf16 v[96:99], v[144:147], a[160:163], v[96:99]
    v_cvt_pk_bf16_f32 v58, v116, v117
    v_cvt_pk_bf16_f32 v59, v118, v119
    v_mfma_f32_16x16x32_bf16 v[96:99], v[148:151], a[184:187], v[96:99]
    v_cndmask_b32 v58, v58, 0, s[82:83]
    v_cndmask_b32 v59, v59, 0, s[82:83]
    v_mfma_f32_16x16x32_bf16 v[96:99], v[152:155], a[208:211], v[96:99]
    v_permlane16_swap_b32 v28, v29
    v_add_f32 v28, v28, v29
    v_mfma_f32_16x16x32_bf16 v[96:99], v[156:159], a[232:235], v[96:99]
    v_mov_b32 v29, v28
    v_mfma_f32_16x16x32_bf16 v[96:99], v[160:163], v[176:179], v[96:99]
    v_mfma_f32_16x16x32_bf16 v[96:99], v[164:167], v[200:203], v[96:99]
    v_permlane32_swap_b32 v28, v29
    v_add_f32 v28, v28, v29
    v_mfma_f32_16x16x32_bf16 v[96:99], v[168:171], v[224:227], v[96:99]
    v_rcp_f32 v28, v28
    v_mfma_f32_16x16x32_bf16 v[96:99], v[172:175], v[248:251], v[96:99]
    v_mul_f32 v26, v26, v8
    v_mul_f32 v27, v27, v9
    v_mfma_f32_16x16x32_bf16 v[100:103], v[120:123], a[20:23], 0
    v_mul_f32 v26, v26, v28
    v_mul_f32 v27, v27, v28
    v_mfma_f32_16x16x32_bf16 v[100:103], v[124:127], a[44:47], v[100:103]
    v_cvt_pk_bf16_f32 v26, v26, v26
    v_cvt_pk_bf16_f32 v27, v27, v27
    v_mfma_f32_16x16x32_bf16 v[100:103], v[128:131], a[68:71], v[100:103]
    v_and_b32 v80, v26, v14
    v_and_b32 v81, v27, v15
    v_mfma_f32_16x16x32_bf16 v[100:103], v[132:135], a[92:95], v[100:103]
    v_and_b32 v82, v26, v16
    v_and_b32 v83, v27, v17
    v_mfma_f32_16x16x32_bf16 v[100:103], v[136:139], a[116:119], v[100:103]
    v_mfma_f32_16x16x32_bf16 v[100:103], v[140:143], a[140:143], v[100:103]
    v_mfma_f32_16x16x32_bf16 v[72:75], v[34:37], v[80:83], 0
    v_mfma_f32_16x16x32_bf16 v[100:103], v[144:147], a[164:167], v[100:103]
    v_cvt_pk_bf16_f32 v38, v96, v97
    v_cvt_pk_bf16_f32 v39, v98, v99
    v_mfma_f32_16x16x32_bf16 v[100:103], v[148:151], a[188:191], v[100:103]
    v_mfma_f32_16x16x32_bf16 v[76:79], v[44:47], v[80:83], 0
    v_mfma_f32_16x16x32_bf16 v[100:103], v[152:155], a[212:215], v[100:103]
    s_add_u32 s53, s74, 81920
    v_mfma_f32_16x16x32_bf16 v[100:103], v[156:159], a[236:239], v[100:103]
    v_mfma_f32_16x16x32_bf16 v[100:103], v[160:163], v[180:183], v[100:103]
    v_mfma_f32_16x16x32_bf16 v[100:103], v[164:167], v[204:207], v[100:103]
    v_mfma_f32_16x16x32_bf16 v[100:103], v[168:171], v[228:231], v[100:103]
    v_mfma_f32_16x16x32_bf16 v[100:103], v[172:175], v[252:255], v[100:103]
    v_cvt_pk_bf16_f32 v84, v72, v73
    v_cvt_pk_bf16_f32 v85, v74, v75
    v_mfma_f32_16x16x32_bf16 v[104:107], a[0:3], v[120:123], 0
    v_cvt_pk_bf16_f32 v86, v76, v77
    v_cvt_pk_bf16_f32 v87, v78, v79
    v_mfma_f32_16x16x32_bf16 v[104:107], a[24:27], v[124:127], v[104:107]
    v_cndmask_b32 v86, v86, 0, s[82:83]
    v_cndmask_b32 v87, v87, 0, s[82:83]
    v_mfma_f32_16x16x32_bf16 v[104:107], a[48:51], v[128:131], v[104:107]
    buffer_store_dwordx4 v[84:87], v23, s[24:27], s53 offen sc1
    v_mfma_f32_16x16x32_bf16 v[104:107], a[72:75], v[132:135], v[104:107]
    v_mfma_f32_16x16x32_bf16 v[104:107], a[96:99], v[136:139], v[104:107]
    v_mfma_f32_16x16x32_bf16 v[104:107], a[120:123], v[140:143], v[104:107]
    v_mfma_f32_16x16x32_bf16 v[104:107], a[144:147], v[144:147], v[104:107]
    v_cvt_pk_bf16_f32 v48, v100, v101
    v_cvt_pk_bf16_f32 v49, v102, v103
    v_mfma_f32_16x16x32_bf16 v[104:107], a[168:171], v[148:151], v[104:107]
    v_mfma_f32_16x16x32_bf16 v[104:107], a[192:195], v[152:155], v[104:107]
    v_mfma_f32_16x16x32_bf16 v[104:107], a[216:219], v[156:159], v[104:107]
    v_mfma_f32_16x16x32_bf16 v[104:107], a[240:243], v[160:163], v[104:107]
    v_mfma_f32_16x16x32_bf16 v[104:107], v[184:187], v[164:167], v[104:107]
    v_mfma_f32_16x16x32_bf16 v[104:107], v[208:211], v[168:171], v[104:107]
    v_mfma_f32_16x16x32_bf16 v[104:107], v[232:235], v[172:175], v[104:107]
    s_waitcnt vmcnt(10)
    s_barrier
    v_mfma_f32_16x16x32_bf16 v[108:111], a[4:7], v[120:123], 0
    v_add_u32 v4, 65536, v4
    v_add_u32 v25, 65536, v25
    ds_read_b64_tr_b16 v[120:121], v4 offset:0
    ds_read_b64_tr_b16 v[122:123], v25 offset:0
    v_mfma_f32_16x16x32_bf16 v[108:111], a[28:31], v[124:127], v[108:111]
    ds_read_b64_tr_b16 v[124:125], v4 offset:1024
    ds_read_b64_tr_b16 v[126:127], v25 offset:1024
    v_mfma_f32_16x16x32_bf16 v[108:111], a[52:55], v[128:131], v[108:111]
    ds_read_b64_tr_b16 v[128:129], v4 offset:2048
    ds_read_b64_tr_b16 v[130:131], v25 offset:2048
    v_mfma_f32_16x16x32_bf16 v[108:111], a[76:79], v[132:135], v[108:111]
    ds_read_b64_tr_b16 v[132:133], v4 offset:3072
    ds_read_b64_tr_b16 v[134:135], v25 offset:3072
    v_mfma_f32_16x16x32_bf16 v[108:111], a[100:103], v[136:139], v[108:111]
    ds_read_b64_tr_b16 v[136:137], v4 offset:4096
    ds_read_b64_tr_b16 v[138:139], v25 offset:4096
    v_mfma_f32_16x16x32_bf16 v[108:111], a[124:127], v[140:143], v[108:111]
    ds_read_b64_tr_b16 v[140:141], v4 offset:5120
    ds_read_b64_tr_b16 v[142:143], v25 offset:5120
    v_mfma_f32_16x16x32_bf16 v[108:111], a[148:151], v[144:147], v[108:111]
    ds_read_b64_tr_b16 v[144:145], v4 offset:6144
    ds_read_b64_tr_b16 v[146:147], v25 offset:6144
    v_mfma_f32_16x16x32_bf16 v[108:111], a[172:175], v[148:151], v[108:111]
    ds_read_b64_tr_b16 v[148:149], v4 offset:7168
    ds_read_b64_tr_b16 v[150:151], v25 offset:7168
    v_mfma_f32_16x16x32_bf16 v[108:111], a[196:199], v[152:155], v[108:111]
    ds_read_b64_tr_b16 v[152:153], v4 offset:8192
    ds_read_b64_tr_b16 v[154:155], v25 offset:8192
    v_mfma_f32_16x16x32_bf16 v[108:111], a[220:223], v[156:159], v[108:111]
    ds_read_b64_tr_b16 v[156:157], v4 offset:9216
    ds_read_b64_tr_b16 v[158:159], v25 offset:9216
    v_mfma_f32_16x16x32_bf16 v[108:111], a[244:247], v[160:163], v[108:111]
    ds_read_b64_tr_b16 v[160:161], v4 offset:10240
    ds_read_b64_tr_b16 v[162:163], v25 offset:10240
    v_mfma_f32_16x16x32_bf16 v[108:111], v[188:191], v[164:167], v[108:111]
    ds_read_b64_tr_b16 v[164:165], v4 offset:11264
    ds_read_b64_tr_b16 v[166:167], v25 offset:11264
    v_mfma_f32_16x16x32_bf16 v[108:111], v[212:215], v[168:171], v[108:111]
    ds_read_b64_tr_b16 v[168:169], v4 offset:12288
    ds_read_b64_tr_b16 v[170:171], v25 offset:12288
    v_mfma_f32_16x16x32_bf16 v[108:111], v[236:239], v[172:175], v[108:111]
    ds_read_b64_tr_b16 v[172:173], v4 offset:13312
    ds_read_b64_tr_b16 v[174:175], v25 offset:13312
    s_waitcnt lgkmcnt(15)
    v_mfma_f32_16x16x32_bf16 v[112:115], a[0:3], v[120:123], 0
    v_cvt_pk_bf16_f32 v68, v104, v105
    v_cvt_pk_bf16_f32 v69, v106, v107
    v_mfma_f32_16x16x32_bf16 v[112:115], a[24:27], v[124:127], v[112:115]
    v_mfma_f32_16x16x32_bf16 v[112:115], a[48:51], v[128:131], v[112:115]
    v_mfma_f32_16x16x32_bf16 v[112:115], a[72:75], v[132:135], v[112:115]
    v_mfma_f32_16x16x32_bf16 v[112:115], a[96:99], v[136:139], v[112:115]
    v_mfma_f32_16x16x32_bf16 v[112:115], a[120:123], v[140:143], v[112:115]
    s_waitcnt lgkmcnt(10)
    v_mfma_f32_16x16x32_bf16 v[112:115], a[144:147], v[144:147], v[112:115]
    v_cvt_pk_bf16_f32 v70, v108, v109
    v_cvt_pk_bf16_f32 v71, v110, v111
    v_mfma_f32_16x16x32_bf16 v[112:115], a[168:171], v[148:151], v[112:115]
    v_cndmask_b32 v70, v70, 0, s[82:83]
    v_cndmask_b32 v71, v71, 0, s[82:83]
    v_mfma_f32_16x16x32_bf16 v[112:115], a[192:195], v[152:155], v[112:115]
    s_waitcnt lgkmcnt(4)
    v_mfma_f32_16x16x32_bf16 v[112:115], a[216:219], v[156:159], v[112:115]
    v_mfma_f32_16x16x32_bf16 v[72:75], v[52:55], v[68:71], 0
    v_mfma_f32_16x16x32_bf16 v[112:115], a[240:243], v[160:163], v[112:115]
    v_mfma_f32_16x16x32_bf16 v[76:79], v[56:59], v[68:71], 0
    v_mfma_f32_16x16x32_bf16 v[112:115], v[184:187], v[164:167], v[112:115]
    ds_read_u16_d16_hi v8, v93 offset:32768
    ds_read_u16_d16_hi v9, v94 offset:32768
    s_waitcnt lgkmcnt(2)
    v_mfma_f32_16x16x32_bf16 v[112:115], v[208:211], v[168:171], v[112:115]
    ds_read_u16_d16_hi v10, v92 offset:32768
    v_mfma_f32_16x16x32_bf16 v[112:115], v[232:235], v[172:175], v[112:115]
    v_mfma_f32_16x16x32_bf16 v[116:119], a[4:7], v[120:123], 0
    v_mfma_f32_16x16x32_bf16 v[116:119], a[28:31], v[124:127], v[116:119]
    v_mfma_f32_16x16x32_bf16 v[116:119], a[52:55], v[128:131], v[116:119]
    v_cndmask_b32 v26, v72, v73, s[76:77]
    v_cndmask_b32 v27, v74, v75, s[76:77]
    v_mfma_f32_16x16x32_bf16 v[116:119], a[76:79], v[132:135], v[116:119]
    v_cndmask_b32 v28, v76, v77, s[76:77]
    v_cndmask_b32 v29, v78, v79, s[76:77]
    v_mfma_f32_16x16x32_bf16 v[116:119], a[100:103], v[136:139], v[116:119]
    v_cndmask_b32 v26, v26, v28, s[78:79]
    v_cndmask_b32 v27, v27, v29, s[80:81]
    v_mfma_f32_16x16x32_bf16 v[116:119], a[124:127], v[140:143], v[116:119]
    s_waitcnt lgkmcnt(0)
    v_mul_f32 v26, v26, v8
    v_mfma_f32_16x16x32_bf16 v[116:119], a[148:151], v[144:147], v[116:119]
    v_cvt_pk_bf16_f32 v64, v112, v113
    v_cvt_pk_bf16_f32 v65, v114, v115
    v_mfma_f32_16x16x32_bf16 v[116:119], a[172:175], v[148:151], v[116:119]
    v_mul_f32 v27, v27, v9
    v_mul_f32 v11, s91, v10
    v_mfma_f32_16x16x32_bf16 v[116:119], a[196:199], v[152:155], v[116:119]
    v_max_f32 v28, v26, v27
    v_mov_b32 v29, v28
    v_mfma_f32_16x16x32_bf16 v[116:119], a[220:223], v[156:159], v[116:119]
    v_mfma_f32_16x16x32_bf16 v[116:119], a[244:247], v[160:163], v[116:119]
    v_permlane16_swap_b32 v28, v29
    v_max_f32 v28, v28, v29
    v_mfma_f32_16x16x32_bf16 v[116:119], v[188:191], v[164:167], v[116:119]
    v_mov_b32 v29, v28
    v_mfma_f32_16x16x32_bf16 v[116:119], v[212:215], v[168:171], v[116:119]
    v_mfma_f32_16x16x32_bf16 v[116:119], v[236:239], v[172:175], v[116:119]
    v_permlane32_swap_b32 v28, v29
    v_max_f32 v28, v28, v29
    v_mfma_f32_16x16x32_bf16 v[96:99], a[8:11], v[120:123], 0
    v_sub_f32 v26, v26, v28
    v_sub_f32 v27, v27, v28
    v_mfma_f32_16x16x32_bf16 v[96:99], a[32:35], v[124:127], v[96:99]
    v_mul_f32 v26, v11, v26
    v_mul_f32 v27, v11, v27
    v_mfma_f32_16x16x32_bf16 v[96:99], a[56:59], v[128:131], v[96:99]
    v_exp_f32 v26, v26
    v_mfma_f32_16x16x32_bf16 v[96:99], a[80:83], v[132:135], v[96:99]
    v_exp_f32 v27, v27
    v_mfma_f32_16x16x32_bf16 v[96:99], a[104:107], v[136:139], v[96:99]
    v_add_f32 v28, v26, v27
    v_mov_b32 v29, v28
    v_mfma_f32_16x16x32_bf16 v[96:99], a[128:131], v[140:143], v[96:99]
    v_mfma_f32_16x16x32_bf16 v[96:99], a[152:155], v[144:147], v[96:99]
    v_cvt_pk_bf16_f32 v66, v116, v117
    v_cvt_pk_bf16_f32 v67, v118, v119
    v_mfma_f32_16x16x32_bf16 v[96:99], a[176:179], v[148:151], v[96:99]
    v_cndmask_b32 v66, v66, 0, s[82:83]
    v_cndmask_b32 v67, v67, 0, s[82:83]
    v_mfma_f32_16x16x32_bf16 v[96:99], a[200:203], v[152:155], v[96:99]
    v_permlane16_swap_b32 v28, v29
    v_add_f32 v28, v28, v29
    v_mfma_f32_16x16x32_bf16 v[96:99], a[224:227], v[156:159], v[96:99]
    v_mov_b32 v29, v28
    v_mfma_f32_16x16x32_bf16 v[96:99], a[248:251], v[160:163], v[96:99]
    v_mfma_f32_16x16x32_bf16 v[96:99], v[192:195], v[164:167], v[96:99]
    v_permlane32_swap_b32 v28, v29
    v_add_f32 v28, v28, v29
    v_mfma_f32_16x16x32_bf16 v[96:99], v[216:219], v[168:171], v[96:99]
    v_rcp_f32 v28, v28
    v_mfma_f32_16x16x32_bf16 v[96:99], v[240:243], v[172:175], v[96:99]
    v_mul_f32 v26, v26, v8
    v_mul_f32 v27, v27, v9
    v_mfma_f32_16x16x32_bf16 v[100:103], a[12:15], v[120:123], 0
    v_mul_f32 v26, v26, v28
    v_mul_f32 v27, v27, v28
    v_mfma_f32_16x16x32_bf16 v[100:103], a[36:39], v[124:127], v[100:103]
    v_cvt_pk_bf16_f32 v26, v26, v26
    v_cvt_pk_bf16_f32 v27, v27, v27
    v_mfma_f32_16x16x32_bf16 v[100:103], a[60:63], v[128:131], v[100:103]
    v_and_b32 v80, v26, v14
    v_and_b32 v81, v27, v15
    v_mfma_f32_16x16x32_bf16 v[100:103], a[84:87], v[132:135], v[100:103]
    v_and_b32 v82, v26, v16
    v_and_b32 v83, v27, v17
    v_mfma_f32_16x16x32_bf16 v[100:103], a[108:111], v[136:139], v[100:103]
    v_mfma_f32_16x16x32_bf16 v[100:103], a[132:135], v[140:143], v[100:103]
    v_mfma_f32_16x16x32_bf16 v[72:75], v[36:39], v[80:83], 0
    v_mfma_f32_16x16x32_bf16 v[100:103], a[156:159], v[144:147], v[100:103]
    v_cvt_pk_bf16_f32 v60, v96, v97
    v_cvt_pk_bf16_f32 v61, v98, v99
    v_mfma_f32_16x16x32_bf16 v[100:103], a[180:183], v[148:151], v[100:103]
    v_mfma_f32_16x16x32_bf16 v[76:79], v[46:49], v[80:83], 0
    v_mfma_f32_16x16x32_bf16 v[100:103], a[204:207], v[152:155], v[100:103]
    s_add_u32 s53, s74, 98304
    v_mfma_f32_16x16x32_bf16 v[100:103], a[228:231], v[156:159], v[100:103]
    v_mfma_f32_16x16x32_bf16 v[100:103], a[252:255], v[160:163], v[100:103]
    v_mfma_f32_16x16x32_bf16 v[100:103], v[196:199], v[164:167], v[100:103]
    v_mfma_f32_16x16x32_bf16 v[100:103], v[220:223], v[168:171], v[100:103]
    v_mfma_f32_16x16x32_bf16 v[100:103], v[244:247], v[172:175], v[100:103]
    v_cvt_pk_bf16_f32 v84, v72, v73
    v_cvt_pk_bf16_f32 v85, v74, v75
    v_mfma_f32_16x16x32_bf16 v[104:107], v[120:123], a[16:19], 0
    v_cvt_pk_bf16_f32 v86, v76, v77
    v_cvt_pk_bf16_f32 v87, v78, v79
    v_mfma_f32_16x16x32_bf16 v[104:107], v[124:127], a[40:43], v[104:107]
    v_cndmask_b32 v86, v86, 0, s[82:83]
    v_cndmask_b32 v87, v87, 0, s[82:83]
    v_mfma_f32_16x16x32_bf16 v[104:107], v[128:131], a[64:67], v[104:107]
    buffer_store_dwordx4 v[84:87], v23, s[24:27], s53 offen sc1
    v_mfma_f32_16x16x32_bf16 v[104:107], v[132:135], a[88:91], v[104:107]
    v_mfma_f32_16x16x32_bf16 v[104:107], v[136:139], a[112:115], v[104:107]
    v_mfma_f32_16x16x32_bf16 v[104:107], v[140:143], a[136:139], v[104:107]
    v_mfma_f32_16x16x32_bf16 v[104:107], v[144:147], a[160:163], v[104:107]
    v_cvt_pk_bf16_f32 v62, v100, v101
    v_cvt_pk_bf16_f32 v63, v102, v103
    v_mfma_f32_16x16x32_bf16 v[104:107], v[148:151], a[184:187], v[104:107]
    v_cndmask_b32 v62, v62, 0, s[82:83]
    v_cndmask_b32 v63, v63, 0, s[82:83]
    v_mfma_f32_16x16x32_bf16 v[104:107], v[152:155], a[208:211], v[104:107]
    v_mfma_f32_16x16x32_bf16 v[104:107], v[156:159], a[232:235], v[104:107]
    v_mfma_f32_16x16x32_bf16 v[72:75], v[56:59], v[64:67], 0
    v_mfma_f32_16x16x32_bf16 v[104:107], v[160:163], v[176:179], v[104:107]
    v_mfma_f32_16x16x32_bf16 v[76:79], v[60:63], v[64:67], 0
    v_mfma_f32_16x16x32_bf16 v[104:107], v[164:167], v[200:203], v[104:107]
    ds_read_u16_d16_hi v8, v93 offset:49152
    ds_read_u16_d16_hi v9, v94 offset:49152
    v_mfma_f32_16x16x32_bf16 v[104:107], v[168:171], v[224:227], v[104:107]
    ds_read_u16_d16_hi v10, v92 offset:49152
    v_mfma_f32_16x16x32_bf16 v[104:107], v[172:175], v[248:251], v[104:107]
    v_mfma_f32_16x16x32_bf16 v[108:111], v[120:123], a[20:23], 0
    v_mfma_f32_16x16x32_bf16 v[108:111], v[124:127], a[44:47], v[108:111]
    v_mfma_f32_16x16x32_bf16 v[108:111], v[128:131], a[68:71], v[108:111]
    v_cndmask_b32 v26, v72, v73, s[76:77]
    v_cndmask_b32 v27, v74, v75, s[76:77]
    v_mfma_f32_16x16x32_bf16 v[108:111], v[132:135], a[92:95], v[108:111]
    v_cndmask_b32 v28, v76, v77, s[76:77]
    v_cndmask_b32 v29, v78, v79, s[76:77]
    v_mfma_f32_16x16x32_bf16 v[108:111], v[136:139], a[116:119], v[108:111]
    v_cndmask_b32 v26, v26, v28, s[78:79]
    v_cndmask_b32 v27, v27, v29, s[80:81]
    v_mfma_f32_16x16x32_bf16 v[108:111], v[140:143], a[140:143], v[108:111]
    s_waitcnt lgkmcnt(0)
    v_mul_f32 v26, v26, v8
    v_mfma_f32_16x16x32_bf16 v[108:111], v[144:147], a[164:167], v[108:111]
    v_cvt_pk_bf16_f32 v40, v104, v105
    v_cvt_pk_bf16_f32 v41, v106, v107
    v_mfma_f32_16x16x32_bf16 v[108:111], v[148:151], a[188:191], v[108:111]
    v_mul_f32 v27, v27, v9
    v_mul_f32 v11, s91, v10
    v_mfma_f32_16x16x32_bf16 v[108:111], v[152:155], a[212:215], v[108:111]
    v_max_f32 v28, v26, v27
    v_mov_b32 v29, v28
    v_mfma_f32_16x16x32_bf16 v[108:111], v[156:159], a[236:239], v[108:111]
    v_mfma_f32_16x16x32_bf16 v[108:111], v[160:163], v[180:183], v[108:111]
    v_permlane16_swap_b32 v28, v29
    v_max_f32 v28, v28, v29
    v_mfma_f32_16x16x32_bf16 v[108:111], v[164:167], v[204:207], v[108:111]
    v_mov_b32 v29, v28
    v_mfma_f32_16x16x32_bf16 v[108:111], v[168:171], v[228:231], v[108:111]
    v_mfma_f32_16x16x32_bf16 v[108:111], v[172:175], v[252:255], v[108:111]
    v_permlane32_swap_b32 v28, v29
    v_max_f32 v28, v28, v29
    s_nop 5
    v_cvt_pk_bf16_f32 v50, v108, v109
    v_cvt_pk_bf16_f32 v51, v110, v111
    v_sub_f32 v26, v26, v28
    v_sub_f32 v27, v27, v28
    v_mul_f32 v26, v11, v26
    v_mul_f32 v27, v11, v27
    v_exp_f32 v26, v26
    v_exp_f32 v27, v27
    s_nop 0
    v_add_f32 v28, v26, v27
    v_mov_b32 v29, v28
    s_nop 1
    v_permlane16_swap_b32 v28, v29
    v_add_f32 v28, v28, v29
    v_mov_b32 v29, v28
    s_nop 1
    v_permlane32_swap_b32 v28, v29
    v_add_f32 v28, v28, v29
    v_rcp_f32 v28, v28
    v_mul_f32 v26, v26, v8
    v_mul_f32 v27, v27, v9
    v_mul_f32 v26, v26, v28
    v_mul_f32 v27, v27, v28
    v_cvt_pk_bf16_f32 v26, v26, v26
    v_cvt_pk_bf16_f32 v27, v27, v27
    v_and_b32 v80, v26, v14
    v_and_b32 v81, v27, v15
    v_and_b32 v82, v26, v16
    v_and_b32 v83, v27, v17
    s_nop 1
    v_mfma_f32_16x16x32_bf16 v[72:75], v[38:41], v[80:83], 0
    v_mfma_f32_16x16x32_bf16 v[76:79], v[48:51], v[80:83], 0
    s_add_u32 s53, s74, 114688
    s_nop 5
    v_cvt_pk_bf16_f32 v84, v72, v73
    v_cvt_pk_bf16_f32 v85, v74, v75
    v_cvt_pk_bf16_f32 v86, v76, v77
    v_cvt_pk_bf16_f32 v87, v78, v79
    v_cndmask_b32 v86, v86, 0, s[82:83]
    v_cndmask_b32 v87, v87, 0, s[82:83]
    buffer_store_dwordx4 v[84:87], v23, s[24:27], s53 offen sc1
    s_waitcnt vmcnt(0) lgkmcnt(0)
    s_barrier
    s_cmp_lg_u32 s44, 0
    s_cbranch_scc1 L_nopub19
    s_lshl_b32 s60, s48, 4
    s_add_u32 s60, s60, s49
    s_lshl_b32 s60, s60, 7
    s_add_u32 s60, s60, 12779520
    v_mov_b32 v30, s47
    s_mov_b64 exec, 1
    buffer_store_dword v30, off, s[24:27], s60 sc1
    s_mov_b64 exec, -1
L_nopub19:
    s_endpgm
L_codeend:
.section .rodata,"a"
.p2align 6
.amdhsa_kernel parallel_sum__sliding_local_dilated__mixer_token_mlp__prompt_kernel
  .amdhsa_next_free_vgpr 512
  .amdhsa_next_free_sgpr 102
  .amdhsa_accum_offset 256
  .amdhsa_group_segment_fixed_size 0
  .amdhsa_kernarg_size 88
  .amdhsa_user_sgpr_count 2
  .amdhsa_user_sgpr_kernarg_segment_ptr 1
  .amdhsa_system_sgpr_workgroup_id_x 1
  .amdhsa_float_denorm_mode_32 3
.end_amdhsa_kernel
```

```asm
; @launch grid=(256,1,1) block=(256,1,1) lds=163840
.amdgcn_target "amdgcn-amd-amdhsa--gfx950"
.text
.globl parallel_sum__sliding_local_dilated__mixer_token_mlp__prompt_kernel
.p2align 8
.type parallel_sum__sliding_local_dilated__mixer_token_mlp__prompt_kernel,@function
parallel_sum__sliding_local_dilated__mixer_token_mlp__prompt_kernel:
    s_cmp_ge_u32 s2, 256
    s_cbranch_scc1 L_end
    s_load_dwordx2 s[4:5], s[0:1], 0
    s_load_dwordx16 s[76:91], s[0:1], 0
    s_load_dwordx4 s[92:95], s[0:1], 64
    s_load_dwordx2 s[24:25], s[0:1], 80
    s_lshr_b32 s46, s2, 3
    s_getpc_b64 s[98:99]
L_pc:
    s_mul_i32 s53, s46, 1408
    v_lshrrev_b32 v26, 4, v0
    v_min_u32 v26, 10, v26
    v_lshl_add_u32 v26, v26, 7, s53
    v_lshrrev_b32 v25, 5, v0
    v_min_u32 v26, L_codeend-L_pc-4, v26
    v_mov_b32 v29, s99
    v_add_co_u32 v28, vcc, s98, v26
    s_nop 1
    v_addc_co_u32 v29, vcc, 0, v29, vcc
    global_load_dword v108, v[28:29], off
    v_and_b32 v26, 31, v0
    v_mul_u32_u24 v24, 896, v25
    v_lshl_add_u32 v24, v26, 4, v24
    s_mul_i32 s53, s2, 7168
    v_add_u32 v24, s53, v24
    v_cmp_gt_u32 vcc, 24, v26
    v_mov_b32 v27, 2130706432
    s_mov_b32 s6, 1835008
    s_mov_b32 s7, 0x20000
    v_cndmask_b32 v22, v27, v24, vcc
    v_lshrrev_b32 v27, 6, v0
    v_and_b32 v1, 63, v0
    s_waitcnt lgkmcnt(0)
    buffer_load_dwordx4 v[32:35], v24, s[4:7], 0 offen
    buffer_load_dwordx4 v[36:39], v22, s[4:7], 0 offen offset:512
    v_readfirstlane_b32 s44, v27
    s_and_b32 s45, s2, 7
    s_mov_b64 s[8:9], s[78:79]
    s_mov_b32 s10, 1204224
    s_mov_b32 s11, s7
    s_lshr_b32 s53, s45, 1
    s_add_u32 s54, s53, 1
    s_bfe_u32 s54, s54, 0x10001
    s_add_u32 s54, s54, 1
    s_mul_i32 s53, s53, 224
    s_andn2_b32 s53, s53, 127
    s_sub_u32 s55, s46, 3
    s_cmp_lt_u32 s46, 24
    s_cselect_b32 s55, 63, s55
    s_cmp_lt_u32 s46, 21
    s_cselect_b32 s55, s46, s55
    s_mul_i32 s55, s55, 43008
    s_add_u32 s53, s53, s55
    v_and_b32 v27, 3, v0
    v_min_u32 v27, s54, v27
    v_bfe_u32 v28, v0, 2, 2
    v_min_u32 v28, 2, v28
    v_mul_u32_u24 v28, 7, v28
    v_add_u32 v27, v27, v28
    v_lshrrev_b32 v28, 4, v0
    v_min_u32 v28, 15, v28
    v_mul_u32_u24 v28, 21, v28
    v_add_lshl_u32 v27, v27, v28, 7
    buffer_load_dword v108, v27, s[8:11], s53 offen
    s_mov_b64 s[40:41], s[94:95]
    s_mov_b32 s42, 256
    s_mov_b32 s43, s7
    s_or_b32 s53, s2, s44
    s_cbranch_scc1 L_nononce
    s_memrealtime s[98:99]
    s_waitcnt lgkmcnt(0)
    s_or_b32 s98, s98, 1
    v_mov_b32 v28, s98
    s_mov_b64 exec, 1
    buffer_store_dword v28, off, s[40:43], 0 sc1
    s_mov_b64 exec, -1
L_nononce:
    s_mov_b64 s[16:17], s[84:85]
    s_mov_b32 s18, 7340032
    s_mov_b32 s19, s7
    s_mov_b32 s26, 16777216
    s_mov_b32 s27, s7
    s_mov_b64 s[20:21], s[88:89]
    s_mov_b32 s22, 7340032
    s_mov_b32 s23, s7
    s_mov_b64 s[12:13], s[80:81]
    s_mov_b32 s14, 401408
    s_mov_b32 s15, s7
    s_mov_b64 s[28:29], s[92:93]
    s_mov_b32 s30, 1835008
    s_mov_b32 s31, s7
    s_mov_b64 s[32:33], s[86:87]
    s_mov_b32 s34, 3584
    s_mov_b32 s35, s7
    s_mov_b64 s[36:37], s[90:91]
    s_mov_b32 s38, 4096
    s_mov_b32 s39, s7
    s_lshl_b32 s52, s44, 12
    v_lshlrev_b32 v23, 4, v1
    s_cmp_ge_u32 s46, 24
    s_cbranch_scc1 L_role_a
    v_lshrrev_b32 v208, 4, v1
    v_bfe_u32 v209, v1, 2, 2
    v_and_b32 v210, 3, v1
    v_and_b32 v211, 15, v1
    v_lshrrev_b32 v212, 5, v1
    s_mul_i32 s55, s45, 3
    s_max_u32 s55, s55, 1
    s_add_u32 s55, s55, s46
    s_sub_u32 s55, s55, 1
    s_sub_u32 s56, s55, 21
    s_min_u32 s55, s55, s56
    s_and_b32 s54, s45, 1
    s_mul_i32 s54, s54, 24
    s_sub_u32 s54, s46, s54
    s_cmp_ge_u32 s46, 21
    s_cselect_b32 s54, s54, s55
    s_mul_i32 s53, s45, 21
    s_add_u32 s53, s53, s54
    s_mul_i32 s50, s53, 171
    s_lshr_b32 s50, s50, 10
    s_mul_i32 s54, s50, 6
    s_sub_u32 s88, s53, s54
    s_mul_i32 s51, s50, 2
    s_add_u32 s51, s51, s88
    s_mul_i32 s54, s51, 43
    s_lshr_b32 s54, s54, 8
    s_mul_i32 s54, s54, 6
    s_sub_u32 s51, s51, s54
    s_mul_i32 s65, s51, 13
    s_add_u32 s65, s65, 2
    s_mul_i32 s65, s65, 171
    s_lshr_b32 s65, s65, 10
    v_lshl_add_u32 v213, v212, 2, v209
    v_and_b32 v215, 1, v208
    v_lshlrev_b32 v214, 4, v210
    v_lshl_add_u32 v214, v215, 6, v214
    s_mul_i32 s53, s44, 1835008
    s_lshl_b32 s54, s50, 7
    s_add_u32 s53, s53, s54
    v_mul_u32_u24 v10, 3584, v213
    v_add3_u32 v10, v10, v214, s53
    v_xor_b32 v11, 32, v10
    s_cmp_ge_u32 s46, 21
    s_cbranch_scc1 L_help
    s_add_u32 m0, s52, 49152
    s_add_u32 s57, s65, 0
    s_sub_u32 s3, s57, 13
    s_min_u32 s57, s57, s3
    s_mul_i32 s57, s57, 114688
    buffer_load_dwordx4 v10, s[16:19], s57 offen offset:0 lds
    s_add_u32 s57, s57, 27648
    buffer_load_dwordx4 v11, s[16:19], s57 offen offset:1024 lds
    v_mul_u32_u24 v109, 1088, v25
    v_lshl_add_u32 v109, v26, 4, v109
    v_mul_u32_u24 v110, 1088, v209
    v_lshl_add_u32 v110, v208, 5, v110
    v_lshl_add_u32 v110, v210, 3, v110
    s_lshl_b32 s53, s44, 7
    v_add_u32 v110, s53, v110
    v_mul_u32_u24 v111, 66816, v208
    v_lshl_add_u32 v111, v211, 4, v111
    s_mul_i32 s63, s44, 267264
    s_lshl_b32 s53, s2, 8
    s_add_u32 s63, s63, s53
    s_add_u32 s64, s63, 1069056
    v_cmp_gt_u32 vcc, 208, v0
    v_mov_b32 v100, 2130706432
    v_cmp_le_u32 s[92:93], 24, v26
    v_cndmask_b32 v22, v100, v111, vcc
    s_mov_b32 s62, 0x3f803f80
    s_mov_b32 s61, 0xffff0000
    v_mov_b32 v96, 0
    v_mov_b32 v97, 0
    v_lshlrev_b32 v216, 6, v209
    v_lshl_add_u32 v216, v210, 3, v216
    v_lshl_add_u32 v216, v215, 5, v216
    s_add_u32 s53, s52, 49152
    v_lshl_add_u32 v2, v208, 10, v216
    v_add_u32 v2, s53, v2
    v_xor_b32 v3, 32, v2
    v_add_u32 v4, 65536, v2
    v_add_u32 v5, 65536, v3
    v_lshl_add_u32 v6, v208, 9, v216
    v_add_u32 v6, s53, v6
    v_xor_b32 v7, 32, v6
    v_add_u32 v8, 65536, v6
    v_add_u32 v9, 65536, v7
    s_waitcnt vmcnt(4)
    v_dot2c_f32_bf16 v96, s62, v32
    v_dot2c_f32_bf16 v97, v32, v32
    v_lshlrev_b32 v40, 16, v32
    v_and_b32 v41, s61, v32
    v_dot2c_f32_bf16 v96, s62, v33
    v_dot2c_f32_bf16 v97, v33, v33
    v_lshlrev_b32 v42, 16, v33
    v_and_b32 v43, s61, v33
    v_dot2c_f32_bf16 v96, s62, v34
    v_dot2c_f32_bf16 v97, v34, v34
    v_lshlrev_b32 v44, 16, v34
    v_and_b32 v45, s61, v34
    v_dot2c_f32_bf16 v96, s62, v35
    v_dot2c_f32_bf16 v97, v35, v35
    v_lshlrev_b32 v46, 16, v35
    v_and_b32 v47, s61, v35
    s_waitcnt vmcnt(3)
    v_dot2c_f32_bf16 v96, s62, v36
    v_dot2c_f32_bf16 v97, v36, v36
    v_lshlrev_b32 v48, 16, v36
    v_and_b32 v49, s61, v36
    v_dot2c_f32_bf16 v96, s62, v37
    v_dot2c_f32_bf16 v97, v37, v37
    v_lshlrev_b32 v50, 16, v37
    v_and_b32 v51, s61, v37
    v_dot2c_f32_bf16 v96, s62, v38
    v_dot2c_f32_bf16 v97, v38, v38
    v_lshlrev_b32 v52, 16, v38
    v_and_b32 v53, s61, v38
    v_dot2c_f32_bf16 v96, s62, v39
    v_dot2c_f32_bf16 v97, v39, v39
    v_lshlrev_b32 v54, 16, v39
    v_and_b32 v55, s61, v39
    buffer_load_dword v29, off, s[40:43], 0 sc1
    v_add_f32_dpp v96, v96, v96 quad_perm:[1,0,3,2] row_mask:0xf bank_mask:0xf
    v_add_f32_dpp v97, v97, v97 quad_perm:[1,0,3,2] row_mask:0xf bank_mask:0xf
    s_nop 0
    v_add_f32_dpp v96, v96, v96 quad_perm:[2,3,0,1] row_mask:0xf bank_mask:0xf
    v_add_f32_dpp v97, v97, v97 quad_perm:[2,3,0,1] row_mask:0xf bank_mask:0xf
    s_nop 0
    v_add_f32_dpp v96, v96, v96 row_half_mirror row_mask:0xf bank_mask:0xf
    v_add_f32_dpp v97, v97, v97 row_half_mirror row_mask:0xf bank_mask:0xf
    s_nop 0
    v_add_f32_dpp v96, v96, v96 row_mirror row_mask:0xf bank_mask:0xf
    v_add_f32_dpp v97, v97, v97 row_mirror row_mask:0xf bank_mask:0xf
    v_mov_b32 v98, v96
    v_mov_b32 v99, v97
    s_nop 0
    v_permlane16_swap_b32 v96, v98
    v_permlane16_swap_b32 v97, v99
    v_add_f32 v96, v96, v98
    v_add_f32 v97, v97, v99
    v_mul_f32 v98, 0x3b124925, v96
    v_mul_f32 v99, 0x3b124925, v97
    v_fma_f32 v99, -v98, v98, v99
    v_max_f32 v99, 0, v99
    v_cvt_pk_bf16_f32 v100, 0, v99
    v_add_f32 v100, 0x3727c5ac, v100
    v_cvt_pk_bf16_f32 v100, 0, v100
    v_sqrt_f32 v100, v100
    s_nop 0
    v_cvt_pk_bf16_f32 v100, 0, v100
    v_rcp_f32 v100, v100
    s_nop 0
    v_mul_f32 v99, v99, v100
    v_mul_f32 v99, v99, v100
    v_cvt_pk_bf16_f32 v104, 0, v99
    v_add_f32 v104, 0x3727c5ac, v104
    v_cvt_pk_bf16_f32 v104, 0, v104
    v_sqrt_f32 v104, v104
    s_nop 0
    v_cvt_pk_bf16_f32 v102, 0, v104
    v_rcp_f32 v104, v102
    s_nop 0
    v_mul_f32 v104, v104, v100
    v_mul_f32 v106, v98, v104
    v_pk_fma_f32 v[56:57], v[40:41], v[104:105], v[106:107] op_sel_hi:[1,0,0] neg_lo:[0,0,1] neg_hi:[0,0,1]
    v_pk_fma_f32 v[58:59], v[42:43], v[104:105], v[106:107] op_sel_hi:[1,0,0] neg_lo:[0,0,1] neg_hi:[0,0,1]
    v_pk_fma_f32 v[60:61], v[44:45], v[104:105], v[106:107] op_sel_hi:[1,0,0] neg_lo:[0,0,1] neg_hi:[0,0,1]
    v_pk_fma_f32 v[62:63], v[46:47], v[104:105], v[106:107] op_sel_hi:[1,0,0] neg_lo:[0,0,1] neg_hi:[0,0,1]
    v_pk_fma_f32 v[64:65], v[48:49], v[104:105], v[106:107] op_sel_hi:[1,0,0] neg_lo:[0,0,1] neg_hi:[0,0,1]
    v_pk_fma_f32 v[66:67], v[50:51], v[104:105], v[106:107] op_sel_hi:[1,0,0] neg_lo:[0,0,1] neg_hi:[0,0,1]
    v_pk_fma_f32 v[68:69], v[52:53], v[104:105], v[106:107] op_sel_hi:[1,0,0] neg_lo:[0,0,1] neg_hi:[0,0,1]
    v_pk_fma_f32 v[70:71], v[54:55], v[104:105], v[106:107] op_sel_hi:[1,0,0] neg_lo:[0,0,1] neg_hi:[0,0,1]
    v_cvt_pk_bf16_f32 v80, v56, v57
    v_cvt_pk_bf16_f32 v81, v58, v59
    v_cvt_pk_bf16_f32 v82, v60, v61
    v_cvt_pk_bf16_f32 v83, v62, v63
    v_cvt_pk_bf16_f32 v84, v64, v65
    v_cvt_pk_bf16_f32 v85, v66, v67
    v_cvt_pk_bf16_f32 v86, v68, v69
    v_cvt_pk_bf16_f32 v87, v70, v71
    v_lshrrev_b32 v102, 16, v102
    v_cndmask_b32 v84, v84, v102, s[92:93]
    ds_write_b128 v109, v[80:83] offset:0
    ds_write_b128 v109, v[84:87] offset:512
    s_waitcnt lgkmcnt(0)
    s_barrier
    ds_read_b64_tr_b16 v[88:89], v110 offset:0
    ds_read_b64_tr_b16 v[90:91], v110 offset:4352
    ds_read_b64_tr_b16 v[92:93], v110 offset:512
    ds_read_b64_tr_b16 v[94:95], v110 offset:4864
    s_waitcnt lgkmcnt(2)
    buffer_store_dwordx4 v[88:91], v111, s[24:27], s63 offen sc1
    s_waitcnt lgkmcnt(0)
    buffer_store_dwordx4 v[92:95], v22, s[24:27], s64 offen sc1
    s_add_u32 s57, s57, 27648
    buffer_load_dwordx4 v10, s[16:19], s57 offen offset:2048 lds
    s_add_u32 s57, s57, 27648
    buffer_load_dwordx4 v11, s[16:19], s57 offen offset:3072 lds
    s_add_u32 m0, s52, 65536
    s_add_u32 s57, s65, 1
    s_sub_u32 s3, s57, 13
    s_min_u32 s57, s57, s3
    s_mul_i32 s57, s57, 114688
    buffer_load_dwordx4 v10, s[16:19], s57 offen offset:0 lds
    s_add_u32 s57, s57, 27648
    buffer_load_dwordx4 v11, s[16:19], s57 offen offset:1024 lds
    s_add_u32 s57, s57, 27648
    buffer_load_dwordx4 v10, s[16:19], s57 offen offset:2048 lds
    s_add_u32 s57, s57, 27648
    buffer_load_dwordx4 v11, s[16:19], s57 offen offset:3072 lds
    s_waitcnt vmcnt(6)
    v_cmp_eq_u32 vcc, 0, v29
    s_nop 0
    s_cbranch_vccz L_ok2
    s_mov_b32 s59, 20000
L_spin1:
    buffer_load_dword v29, off, s[40:43], 0 sc1
    s_waitcnt vmcnt(0)
    v_cmp_eq_u32 vcc, 0, v29
    s_nop 0
    s_cbranch_vccz L_ok2
    s_sub_u32 s59, s59, 1
    s_cbranch_scc0 L_spin1
L_ok2:
    v_readfirstlane_b32 s47, v29
    s_barrier
    s_cmp_lg_u32 s44, 0
    s_cbranch_scc1 L_nopub3
    s_lshl_b32 s60, s2, 5
    s_add_u32 s60, s60, 12582912
    v_mov_b32 v30, s47
    s_mov_b64 exec, 1
    buffer_store_dword v30, off, s[24:27], s60 sc1
    s_mov_b64 exec, -1
L_nopub3:
    s_lshl_b32 s53, s44, 11
    s_add_u32 s53, s53, 12582912
    v_lshl_add_u32 v18, v1, 5, s53
    s_lshl_b32 s53, s50, 7
    s_add_u32 m0, s52, 81920
    s_add_u32 s57, s65, 2
    s_sub_u32 s3, s57, 13
    s_min_u32 s57, s57, s3
    s_mul_i32 s57, s57, 114688
    buffer_load_dwordx4 v10, s[16:19], s57 offen offset:0 lds
    v_lshl_add_u32 v19, v208, 3, s53
    s_lshl2_add_u32 s67, s51, s44
    s_mul_i32 s67, s67, 58624
    s_lshl_b32 s53, s50, 11
    s_add_u32 s57, s57, 27648
    buffer_load_dwordx4 v11, s[16:19], s57 offen offset:1024 lds
    s_add_u32 s67, s67, s53
    s_add_u32 s67, s67, 2097152
    v_mov_b32 v236, 0xbdd2d3e8
    v_mov_b32 v237, 0xc0135761
    s_add_u32 s57, s57, 27648
    buffer_load_dwordx4 v10, s[16:19], s57 offen offset:2048 lds
    s_or_b32 s88, s88, 0
    s_add_u32 s54, s88, 24
    s_mul_i32 s84, s54, 66816
    s_lshl2_add_u32 s84, s52, s84
    s_mul_i32 s83, s54, 58624
    s_add_u32 s83, s83, s53
    s_and_b32 s54, s44, 1
    s_lshl_b32 s54, s54, 10
    s_add_u32 s57, s57, 27648
    buffer_load_dwordx4 v11, s[16:19], s57 offen offset:3072 lds
    s_add_u32 s83, s83, s54
    s_add_u32 s83, s83, 2097152
    s_lshl1_add_u32 s54, s54, 49152
    v_add_u32 v243, s54, v23
    s_add_u32 m0, s52, 98304
    s_add_u32 s57, s65, 3
    s_sub_u32 s3, s57, 13
    s_min_u32 s57, s57, s3
    s_mul_i32 s57, s57, 114688
    buffer_load_dwordx4 v10, s[16:19], s57 offen offset:0 lds
    s_cmp_lt_u32 s88, 4
    s_cselect_b32 s84, s84, 2130706432
    s_cselect_b32 s83, s83, 2130706432
    s_cmp_lt_u32 s44, 2
    s_cselect_b32 s83, s83, 2130706432
    s_cmp_eq_u32 s44, 0
    s_cselect_b32 s85, 1.0, 0
    s_mul_i32 s53, s45, 7
    s_lshr_b32 s53, s53, 1
    s_sub_u32 s53, s50, s53
    s_lshl1_add_u32 s53, s53, s88
    s_sub_u32 s53, s53, 4
    s_mul_i32 s54, s44, 28
    s_add_u32 s54, s54, s53
    s_lshl_b32 s87, s54, 16
    s_lshl_b32 s54, s45, 9
    s_add_u32 s87, s87, s54
    s_cmp_ge_u32 s88, 4
    s_cselect_b32 s87, s87, 2130706432
    v_lshrrev_b32 v254, 2, v1
    v_lshlrev_b32 v254, 12, v254
    v_lshl_add_u32 v254, v210, 7, v254
    s_add_u32 s57, s57, 27648
    buffer_load_dwordx4 v11, s[16:19], s57 offen offset:1024 lds
    s_waitcnt vmcnt(10)
    ds_read_b64_tr_b16 a[0:1], v2 offset:0
    ds_read_b64_tr_b16 a[2:3], v2 offset:512
    ds_read_b64_tr_b16 a[4:5], v3 offset:0
    ds_read_b64_tr_b16 a[6:7], v3 offset:512
    s_add_u32 s57, s57, 27648
    buffer_load_dwordx4 v10, s[16:19], s57 offen offset:2048 lds
    ds_read_b64_tr_b16 a[8:9], v2 offset:256
    ds_read_b64_tr_b16 a[10:11], v2 offset:768
    ds_read_b64_tr_b16 a[12:13], v3 offset:256
    ds_read_b64_tr_b16 a[14:15], v3 offset:768
    s_add_u32 s57, s57, 27648
    buffer_load_dwordx4 v11, s[16:19], s57 offen offset:3072 lds
    s_lshr_b32 s53, s46, 2
    s_and_b32 s89, s46, 3
    s_bfe_u32 s54, s46, 0x20001
    s_and_b32 s55, s46, 1
    s_add_u32 s55, s55, 4
    s_cmp_lt_u32 s46, 16
    s_cselect_b32 s53, s53, s54
    s_cselect_b32 s89, s89, s55
    s_mul_i32 s49, s53, 2
    s_add_u32 s49, s49, s89
    s_sub_u32 s54, s49, 6
    s_min_u32 s49, s49, s54
    s_or_b32 s89, s89, 0
    s_add_u32 m0, s52, 114688
    s_add_u32 s57, s65, 4
    s_sub_u32 s3, s57, 13
    s_min_u32 s57, s57, s3
    s_mul_i32 s57, s57, 114688
    buffer_load_dwordx4 v10, s[16:19], s57 offen offset:0 lds
    s_lshl2_add_u32 s48, s45, s53
    s_mul_i32 s53, s44, 1835008
    s_lshl_b32 s74, s48, 7
    s_add_u32 s53, s53, s74
    s_add_u32 s57, s57, 27648
    buffer_load_dwordx4 v11, s[16:19], s57 offen offset:1024 lds
    s_waitcnt vmcnt(10)
    ds_read_b64_tr_b16 a[16:17], v2 offset:16384
    ds_read_b64_tr_b16 a[18:19], v2 offset:16896
    ds_read_b64_tr_b16 a[20:21], v3 offset:16384
    ds_read_b64_tr_b16 a[22:23], v3 offset:16896
    s_add_u32 s57, s57, 27648
    buffer_load_dwordx4 v10, s[16:19], s57 offen offset:2048 lds
    ds_read_b64_tr_b16 a[24:25], v2 offset:16640
    ds_read_b64_tr_b16 a[26:27], v2 offset:17152
    ds_read_b64_tr_b16 a[28:29], v3 offset:16640
    ds_read_b64_tr_b16 a[30:31], v3 offset:17152
    s_lshl_b32 s56, s44, 5
    v_lshlrev_b32 v217, 5, v212
    v_xor_b32 v217, v217, v214
    v_xor_b32 v217, s56, v217
    s_add_u32 s57, s57, 27648
    buffer_load_dwordx4 v11, s[16:19], s57 offen offset:3072 lds
    s_add_u32 s74, s74, s56
    v_lshlrev_b32 v12, 12, v213
    v_add3_u32 v12, v12, v217, s53
    s_mul_i32 s53, s44, 100352
    s_add_u32 m0, s52, 131072
    s_add_u32 s57, s65, 5
    s_sub_u32 s3, s57, 13
    s_min_u32 s57, s57, s3
    s_mul_i32 s57, s57, 114688
    buffer_load_dwordx4 v10, s[16:19], s57 offen offset:0 lds
    s_lshl_b32 s54, s49, 7
    s_add_u32 s55, s53, s54
    v_mul_u32_u24 v13, 896, v213
    v_add3_u32 v13, v13, v214, s55
    s_add_u32 s57, s57, 27648
    buffer_load_dwordx4 v11, s[16:19], s57 offen offset:1024 lds
    s_waitcnt vmcnt(10)
    ds_read_b64_tr_b16 a[32:33], v2 offset:32768
    ds_read_b64_tr_b16 a[34:35], v2 offset:33280
    ds_read_b64_tr_b16 a[36:37], v3 offset:32768
    ds_read_b64_tr_b16 a[38:39], v3 offset:33280
    v_xor_b32 v14, 32, v13
    s_mul_i32 s73, s48, 57344
    s_add_u32 s71, s73, s54
    s_mul_i32 s55, s44, 14336
    ds_read_b64_tr_b16 a[40:41], v2 offset:33024
    ds_read_b64_tr_b16 a[42:43], v2 offset:33536
    ds_read_b64_tr_b16 a[44:45], v3 offset:33024
    ds_read_b64_tr_b16 a[46:47], v3 offset:33536
    s_add_u32 s57, s57, 27648
    buffer_load_dwordx4 v10, s[16:19], s57 offen offset:2048 lds
    s_add_u32 s71, s71, s55
    s_add_u32 s72, s71, 7168
    v_bfe_u32 v217, v1, 1, 2
    v_lshl_add_u32 v217, v212, 2, v217
    s_add_u32 s57, s57, 27648
    buffer_load_dwordx4 v11, s[16:19], s57 offen offset:3072 lds
    v_and_b32 v218, 24, v1
    v_add_u32 v217, v217, v218
    v_mul_u32_u24 v15, 896, v217
    v_and_b32 v217, 1, v1
    s_add_u32 m0, s52, 147456
    s_add_u32 s57, s65, 6
    s_sub_u32 s3, s57, 13
    s_min_u32 s57, s57, s3
    s_mul_i32 s57, s57, 114688
    buffer_load_dwordx4 v10, s[16:19], s57 offen offset:0 lds
    v_lshl_add_u32 v15, v217, 4, v15
    v_add_u32 v15, s53, v15
    s_lshl_b32 s54, s89, 5
    s_add_u32 s54, s54, 768
    s_add_u32 s68, s89, 24
    s_mul_i32 s68, s68, 58624
    s_mul_i32 s69, s44, 14336
    s_add_u32 s69, s69, 2097152
    s_add_u32 s57, s57, 27648
    buffer_load_dwordx4 v11, s[16:19], s57 offen offset:1024 lds
    s_waitcnt vmcnt(10)
    ds_read_b64_tr_b16 a[48:49], v2 offset:49152
    ds_read_b64_tr_b16 a[50:51], v2 offset:49664
    ds_read_b64_tr_b16 a[52:53], v3 offset:49152
    ds_read_b64_tr_b16 a[54:55], v3 offset:49664
    s_add_u32 s57, s57, 27648
    buffer_load_dwordx4 v10, s[16:19], s57 offen offset:2048 lds
    ds_read_b64_tr_b16 a[56:57], v2 offset:49408
    ds_read_b64_tr_b16 a[58:59], v2 offset:49920
    ds_read_b64_tr_b16 a[60:61], v3 offset:49408
    ds_read_b64_tr_b16 a[62:63], v3 offset:49920
    s_add_u32 s57, s57, 27648
    buffer_load_dwordx4 v11, s[16:19], s57 offen offset:3072 lds
    s_add_u32 s68, s68, s69
    s_mul_i32 s55, s49, 234496
    s_add_u32 s69, s69, s55
    s_add_u32 s73, s73, s54
    s_mov_b32 s76, 0
    s_add_u32 s77, s76, 2048
    s_cmp_eq_u32 s77, 14336
    s_cselect_b32 s77, 0, s77
    s_add_u32 s78, s77, 2048
    s_cmp_eq_u32 s78, 14336
    s_cselect_b32 s78, 0, s78
    s_add_u32 s79, s78, 2048
    s_cmp_eq_u32 s79, 14336
    s_cselect_b32 s79, 0, s79
    s_add_u32 s80, s79, 2048
    s_cmp_eq_u32 s80, 14336
    s_cselect_b32 s80, 0, s80
    s_add_u32 s81, s80, 2048
    s_cmp_eq_u32 s81, 14336
    s_cselect_b32 s81, 0, s81
    s_add_u32 s82, s81, 2048
    s_cmp_eq_u32 s82, 14336
    s_cselect_b32 s82, 0, s82
    s_waitcnt lgkmcnt(15)
    s_add_u32 m0, s52, 49152
    s_add_u32 s57, s65, 7
    s_sub_u32 s3, s57, 13
    s_min_u32 s57, s57, s3
    s_mul_i32 s57, s57, 114688
    buffer_load_dwordx4 v10, s[16:19], s57 offen offset:0 lds
    s_cmp_lt_u32 s89, 4
    s_cselect_b32 s75, s54, 2130706432
    s_cselect_b32 s68, s68, 2130706432
    s_cselect_b32 s73, s73, 2130706432
    s_add_u32 s57, s57, 27648
    buffer_load_dwordx4 v11, s[16:19], s57 offen offset:1024 lds
    s_waitcnt vmcnt(10)
    ds_read_b64_tr_b16 a[64:65], v4 offset:0
    ds_read_b64_tr_b16 a[66:67], v4 offset:512
    ds_read_b64_tr_b16 a[68:69], v5 offset:0
    ds_read_b64_tr_b16 a[70:71], v5 offset:512
    s_add_u32 s57, s57, 27648
    buffer_load_dwordx4 v10, s[16:19], s57 offen offset:2048 lds
    ds_read_b64_tr_b16 a[72:73], v4 offset:256
    ds_read_b64_tr_b16 a[74:75], v4 offset:768
    ds_read_b64_tr_b16 a[76:77], v5 offset:256
    ds_read_b64_tr_b16 a[78:79], v5 offset:768
    v_lshlrev_b32 v16, 3, v1
    v_add_u32 v16, 81920, v16
    v_and_b32 v217, 7, v1
    v_min_u32 v218, 6, v217
    s_add_u32 s57, s57, 27648
    buffer_load_dwordx4 v11, s[16:19], s57 offen offset:3072 lds
    s_mul_i32 s54, s44, 7
    v_add_u32 v218, s54, v218
    v_mul_u32_u24 v219, 2, v218
    v_add_u32 v219, s89, v219
    s_add_u32 m0, s52, 65536
    s_add_u32 s57, s65, 8
    s_sub_u32 s3, s57, 13
    s_min_u32 s57, s57, s3
    s_mul_i32 s57, s57, 114688
    buffer_load_dwordx4 v10, s[16:19], s57 offen offset:0 lds
    v_mul_u32_u24 v220, 43, v219
    v_lshrrev_b32 v220, 8, v220
    v_mul_u32_u24 v220, 6, v220
    v_sub_u32 v219, v219, v220
    s_add_u32 s57, s57, 27648
    buffer_load_dwordx4 v11, s[16:19], s57 offen offset:1024 lds
    s_waitcnt vmcnt(10)
    ds_read_b64_tr_b16 a[80:81], v4 offset:16384
    ds_read_b64_tr_b16 a[82:83], v4 offset:16896
    ds_read_b64_tr_b16 a[84:85], v5 offset:16384
    ds_read_b64_tr_b16 a[86:87], v5 offset:16896
    v_subrev_u32 v219, s49, v219
    v_bfe_u32 v220, v1, 3, 1
    v_mul_i32_i24 v219, v219, v220
    v_add_u32 v219, s49, v219
    ds_read_b64_tr_b16 a[88:89], v4 offset:16640
    ds_read_b64_tr_b16 a[90:91], v4 offset:17152
    ds_read_b64_tr_b16 a[92:93], v5 offset:16640
    ds_read_b64_tr_b16 a[94:95], v5 offset:17152
    s_add_u32 s57, s57, 27648
    buffer_load_dwordx4 v10, s[16:19], s57 offen offset:2048 lds
    v_lshl_add_u32 v218, v219, 5, v218
    v_lshlrev_b32 v20, 7, v218
    v_add_u32 v20, 12713984, v20
    s_lshr_b32 s53, s48, 1
    s_add_u32 s57, s57, 27648
    buffer_load_dwordx4 v11, s[16:19], s57 offen offset:3072 lds
    s_lshl_b32 s53, s53, 7
    s_add_u32 s53, s53, 12779520
    v_lshl_add_u32 v21, v210, 11, s53
    s_lshl_b32 s70, s48, 16
    s_waitcnt lgkmcnt(15)
    s_add_u32 m0, s52, 81920
    s_add_u32 s57, s65, 9
    s_sub_u32 s3, s57, 13
    s_min_u32 s57, s57, s3
    s_mul_i32 s57, s57, 114688
    buffer_load_dwordx4 v10, s[16:19], s57 offen offset:0 lds
    s_lshl2_add_u32 s70, s52, s70
    s_add_u32 s70, s70, 4194304
    v_lshrrev_b32 v218, 3, v1
    v_mul_u32_u24 v22, 896, v218
    v_lshl_add_u32 v22, v217, 4, v22
    v_lshlrev_b32 v25, 1, v211
    s_add_u32 s53, s52, 65536
    v_mul_u32_u24 v244, 176, v218
    s_add_u32 s57, s57, 27648
    buffer_load_dwordx4 v11, s[16:19], s57 offen offset:1024 lds
    s_waitcnt vmcnt(10)
    ds_read_b64_tr_b16 a[96:97], v4 offset:32768
    ds_read_b64_tr_b16 a[98:99], v4 offset:33280
    ds_read_b64_tr_b16 a[100:101], v5 offset:32768
    ds_read_b64_tr_b16 a[102:103], v5 offset:33280
    s_add_u32 s57, s57, 27648
    buffer_load_dwordx4 v10, s[16:19], s57 offen offset:2048 lds
    ds_read_b64_tr_b16 a[104:105], v4 offset:33024
    ds_read_b64_tr_b16 a[106:107], v4 offset:33536
    ds_read_b64_tr_b16 a[108:109], v5 offset:33024
    ds_read_b64_tr_b16 a[110:111], v5 offset:33536
    s_add_u32 s57, s57, 27648
    buffer_load_dwordx4 v11, s[16:19], s57 offen offset:3072 lds
    v_lshl_add_u32 v244, v217, 4, v244
    v_add_u32 v244, s53, v244
    v_mul_u32_u24 v238, 176, v211
    v_lshl_add_u32 v238, v208, 3, v238
    v_add_u32 v238, s53, v238
    v_lshrrev_b32 v218, 2, v0
    v_mul_u32_u24 v26, 896, v218
    v_lshl_add_u32 v26, v210, 3, v26
    buffer_load_dwordx2 v[224:225], v19, s[32:35], 0 offen offset:0
    v_lshrrev_b32 v218, 2, v1
    v_mul_u32_u24 v252, 176, v218
    v_lshl_add_u32 v252, v210, 3, v252
    v_add_u32 v252, s53, v252
    buffer_load_dwordx2 v[226:227], v19, s[32:35], 0 offen offset:32
    s_waitcnt vmcnt(10)
    ds_read_b64_tr_b16 a[112:113], v2 offset:0
    ds_read_b64_tr_b16 a[114:115], v2 offset:512
    ds_read_b64_tr_b16 a[116:117], v3 offset:0
    ds_read_b64_tr_b16 a[118:119], v3 offset:512
    buffer_load_dwordx2 v[228:229], v19, s[32:35], 0 offen offset:64
    ds_read_b64_tr_b16 a[120:121], v2 offset:256
    ds_read_b64_tr_b16 a[122:123], v2 offset:768
    ds_read_b64_tr_b16 a[124:125], v3 offset:256
    ds_read_b64_tr_b16 a[126:127], v3 offset:768
    buffer_load_dwordx2 v[230:231], v19, s[32:35], 0 offen offset:96
    s_sub_u32 s53, 49152, s52
    v_add_u32 v246, s53, v2
    v_add_u32 v247, s53, v3
    v_add_u32 v232, s52, v23
    s_add_u32 m0, s52, 98304
    s_add_u32 s57, s65, 10
    s_sub_u32 s3, s57, 13
    s_min_u32 s57, s57, s3
    s_mul_i32 s57, s57, 114688
    buffer_load_dwordx4 v10, s[16:19], s57 offen offset:0 lds
    v_xor_b32 v233, 4096, v232
    v_xor_b32 v234, 8192, v232
    v_xor_b32 v235, 12288, v232
    s_add_u32 s57, s57, 27648
    buffer_load_dwordx4 v11, s[16:19], s57 offen offset:1024 lds
    s_waitcnt vmcnt(10)
    ds_read_b64_tr_b16 a[128:129], v2 offset:16384
    ds_read_b64_tr_b16 a[130:131], v2 offset:16896
    ds_read_b64_tr_b16 a[132:133], v3 offset:16384
    ds_read_b64_tr_b16 a[134:135], v3 offset:16896
    s_add_u32 s57, s57, 27648
    buffer_load_dwordx4 v10, s[16:19], s57 offen offset:2048 lds
    ds_read_b64_tr_b16 a[136:137], v2 offset:16640
    ds_read_b64_tr_b16 a[138:139], v2 offset:17152
    ds_read_b64_tr_b16 a[140:141], v3 offset:16640
    ds_read_b64_tr_b16 a[142:143], v3 offset:17152
    s_add_u32 s57, s57, 27648
    buffer_load_dwordx4 v11, s[16:19], s57 offen offset:3072 lds
    s_waitcnt lgkmcnt(15)
    s_add_u32 m0, s52, 114688
    s_add_u32 s57, s65, 11
    s_sub_u32 s3, s57, 13
    s_min_u32 s57, s57, s3
    s_mul_i32 s57, s57, 114688
    buffer_load_dwordx4 v10, s[16:19], s57 offen offset:0 lds
    s_add_u32 s57, s57, 27648
    buffer_load_dwordx4 v11, s[16:19], s57 offen offset:1024 lds
    s_waitcnt vmcnt(10)
    ds_read_b64_tr_b16 a[144:145], v2 offset:32768
    ds_read_b64_tr_b16 a[146:147], v2 offset:33280
    ds_read_b64_tr_b16 a[148:149], v3 offset:32768
    ds_read_b64_tr_b16 a[150:151], v3 offset:33280
    s_add_u32 s57, s57, 27648
    buffer_load_dwordx4 v10, s[16:19], s57 offen offset:2048 lds
    ds_read_b64_tr_b16 a[152:153], v2 offset:33024
    ds_read_b64_tr_b16 a[154:155], v2 offset:33536
    ds_read_b64_tr_b16 a[156:157], v3 offset:33024
    ds_read_b64_tr_b16 a[158:159], v3 offset:33536
    s_add_u32 s57, s57, 27648
    buffer_load_dwordx4 v11, s[16:19], s57 offen offset:3072 lds
    s_add_u32 m0, s52, 131072
    s_add_u32 s57, s65, 12
    s_sub_u32 s3, s57, 13
    s_min_u32 s57, s57, s3
    s_mul_i32 s57, s57, 114688
    buffer_load_dwordx4 v10, s[16:19], s57 offen offset:0 lds
    s_add_u32 s57, s57, 27648
    buffer_load_dwordx4 v11, s[16:19], s57 offen offset:1024 lds
    s_add_u32 s57, s57, 27648
    buffer_load_dwordx4 v10, s[16:19], s57 offen offset:2048 lds
    s_waitcnt vmcnt(11)
    v_lshlrev_b32 v32, 16, v224
    v_and_b32 v33, s61, v224
    v_lshlrev_b32 v34, 16, v225
    v_and_b32 v35, s61, v225
    v_lshlrev_b32 v36, 16, v226
    v_and_b32 v37, s61, v226
    v_lshlrev_b32 v38, 16, v227
    v_and_b32 v39, s61, v227
    s_add_u32 s57, s57, 27648
    buffer_load_dwordx4 v11, s[16:19], s57 offen offset:3072 lds
    v_lshlrev_b32 v40, 16, v228
    v_and_b32 v41, s61, v228
    v_lshlrev_b32 v42, 16, v229
    v_and_b32 v43, s61, v229
    buffer_load_dword v17, v18, s[24:27], 0 offen sc1
    v_lshlrev_b32 v44, 16, v230
    v_and_b32 v45, s61, v230
    v_lshlrev_b32 v46, 16, v231
    v_and_b32 v47, s61, v231
    v_mul_f32 v96, s85, v32
    v_mul_f32 v97, s85, v33
    v_mul_f32 v98, s85, v34
    v_mul_f32 v99, s85, v35
    s_add_u32 m0, s52, 147456
    s_mov_b32 s57, 1490944
    buffer_load_dwordx4 v10, s[16:19], s57 offen offset:0 lds
    s_waitcnt vmcnt(10)
    ds_read_b64_tr_b16 a[160:161], v2 offset:49152
    ds_read_b64_tr_b16 a[162:163], v2 offset:49664
    ds_read_b64_tr_b16 a[164:165], v3 offset:49152
    ds_read_b64_tr_b16 a[166:167], v3 offset:49664
    v_mul_f32 v100, s85, v36
    v_mul_f32 v101, s85, v37
    v_mul_f32 v102, s85, v38
    v_mul_f32 v103, s85, v39
    ds_read_b64_tr_b16 a[168:169], v2 offset:49408
    ds_read_b64_tr_b16 a[170:171], v2 offset:49920
    ds_read_b64_tr_b16 a[172:173], v3 offset:49408
    ds_read_b64_tr_b16 a[174:175], v3 offset:49920
    s_add_u32 s57, s57, 27648
    buffer_load_dwordx4 v11, s[16:19], s57 offen offset:1024 lds
    v_mul_f32 v104, s85, v40
    v_mul_f32 v105, s85, v41
    v_mul_f32 v106, s85, v42
    v_mul_f32 v107, s85, v43
    s_add_u32 s57, s57, 27648
    buffer_load_dwordx4 v10, s[16:19], s57 offen offset:2048 lds
    v_mul_f32 v108, s85, v44
    v_mul_f32 v109, s85, v45
    v_mul_f32 v110, s85, v46
    v_mul_f32 v111, s85, v47
    s_add_u32 s57, s57, 27648
    buffer_load_dwordx4 v11, s[16:19], s57 offen offset:3072 lds
    s_waitcnt lgkmcnt(15)
    s_add_u32 m0, s52, 49152
    s_mov_b32 s57, 1605632
    buffer_load_dwordx4 v10, s[16:19], s57 offen offset:0 lds
    s_waitcnt vmcnt(10)
    ds_read_b64_tr_b16 a[176:177], v4 offset:0
    ds_read_b64_tr_b16 a[178:179], v4 offset:512
    ds_read_b64_tr_b16 a[180:181], v5 offset:0
    ds_read_b64_tr_b16 a[182:183], v5 offset:512
    s_add_u32 s57, s57, 27648
    buffer_load_dwordx4 v11, s[16:19], s57 offen offset:1024 lds
    ds_read_b64_tr_b16 a[184:185], v4 offset:256
    ds_read_b64_tr_b16 a[186:187], v4 offset:768
    ds_read_b64_tr_b16 a[188:189], v5 offset:256
    ds_read_b64_tr_b16 a[190:191], v5 offset:768
    s_add_u32 s57, s57, 27648
    buffer_load_dwordx4 v10, s[16:19], s57 offen offset:2048 lds
    s_add_u32 s57, s57, 27648
    buffer_load_dwordx4 v11, s[16:19], s57 offen offset:3072 lds
    s_add_u32 m0, s52, 65536
    s_mov_b32 s57, 1720320
    buffer_load_dwordx4 v10, s[16:19], s57 offen offset:0 lds
    s_waitcnt vmcnt(10)
    ds_read_b64_tr_b16 a[192:193], v4 offset:16384
    ds_read_b64_tr_b16 a[194:195], v4 offset:16896
    ds_read_b64_tr_b16 a[196:197], v5 offset:16384
    ds_read_b64_tr_b16 a[198:199], v5 offset:16896
    s_add_u32 s57, s57, 27648
    buffer_load_dwordx4 v11, s[16:19], s57 offen offset:1024 lds
    ds_read_b64_tr_b16 a[200:201], v4 offset:16640
    ds_read_b64_tr_b16 a[202:203], v4 offset:17152
    ds_read_b64_tr_b16 a[204:205], v5 offset:16640
    ds_read_b64_tr_b16 a[206:207], v5 offset:17152
    s_add_u32 s57, s57, 27648
    buffer_load_dwordx4 v10, s[16:19], s57 offen offset:2048 lds
    s_waitcnt vmcnt(11)
    v_cmp_ne_u32 vcc, s47, v17
    s_nop 0
    s_cbranch_vccz L_ok5
    s_mov_b32 s59, 20000
L_spin4:
    buffer_load_dword v17, v18, s[24:27], 0 offen sc1
    s_waitcnt vmcnt(0)
    v_cmp_ne_u32 vcc, s47, v17
    s_nop 0
    s_cbranch_vccz L_ok5
    s_sub_u32 s59, s59, 1
    s_cbranch_scc0 L_spin4
L_ok5:
    s_cmp_ge_u32 s88, 4
    s_cbranch_scc1 L_p2_alt
    s_add_u32 s57, s57, 27648
    buffer_load_dwordx4 v11, s[16:19], s57 offen offset:3072 lds
    s_mov_b32 s66, s84
    s_lshl_b32 s86, s65, 10
    s_add_u32 s58, s86, s66
    s_add_u32 s86, s66, 13312
    buffer_load_dwordx4 v[112:115], v23, s[24:27], s58 offen offset:0 sc1
    s_add_u32 s58, s58, 1024
    s_cmp_eq_u32 s58, s86
    s_cselect_b32 s58, s66, s58
    buffer_load_dwordx4 v[116:119], v23, s[24:27], s58 offen offset:0 sc1
    s_waitcnt vmcnt(10)
    ds_read_b64_tr_b16 a[208:209], v4 offset:32768
    ds_read_b64_tr_b16 a[210:211], v4 offset:33280
    ds_read_b64_tr_b16 a[212:213], v5 offset:32768
    ds_read_b64_tr_b16 a[214:215], v5 offset:33280
    s_add_u32 s58, s58, 1024
    s_cmp_eq_u32 s58, s86
    s_cselect_b32 s58, s66, s58
    buffer_load_dwordx4 v[120:123], v23, s[24:27], s58 offen offset:0 sc1
    ds_read_b64_tr_b16 a[216:217], v4 offset:33024
    ds_read_b64_tr_b16 a[218:219], v4 offset:33536
    ds_read_b64_tr_b16 a[220:221], v5 offset:33024
    ds_read_b64_tr_b16 a[222:223], v5 offset:33536
    s_add_u32 s58, s58, 1024
    s_cmp_eq_u32 s58, s86
    s_cselect_b32 s58, s66, s58
    buffer_load_dwordx4 v[124:127], v23, s[24:27], s58 offen offset:0 sc1
    s_add_u32 s58, s58, 1024
    s_cmp_eq_u32 s58, s86
    s_cselect_b32 s58, s66, s58
    buffer_load_dwordx4 v[128:131], v23, s[24:27], s58 offen offset:0 sc1
    s_add_u32 s58, s58, 1024
    s_cmp_eq_u32 s58, s86
    s_cselect_b32 s58, s66, s58
    buffer_load_dwordx4 v[132:135], v23, s[24:27], s58 offen offset:0 sc1
    s_waitcnt vmcnt(10)
    ds_read_b64_tr_b16 a[224:225], v2 offset:0
    ds_read_b64_tr_b16 a[226:227], v2 offset:512
    ds_read_b64_tr_b16 a[228:229], v3 offset:0
    ds_read_b64_tr_b16 a[230:231], v3 offset:512
    s_add_u32 s58, s58, 1024
    s_cmp_eq_u32 s58, s86
    s_cselect_b32 s58, s66, s58
    buffer_load_dwordx4 v[136:139], v23, s[24:27], s58 offen offset:0 sc1
    ds_read_b64_tr_b16 a[232:233], v2 offset:256
    ds_read_b64_tr_b16 a[234:235], v2 offset:768
    ds_read_b64_tr_b16 a[236:237], v3 offset:256
    ds_read_b64_tr_b16 a[238:239], v3 offset:768
    s_add_u32 s58, s58, 1024
    s_cmp_eq_u32 s58, s86
    s_cselect_b32 s58, s66, s58
    buffer_load_dwordx4 v[140:143], v23, s[24:27], s58 offen offset:0 sc1
    s_add_u32 s58, s58, 1024
    s_cmp_eq_u32 s58, s86
    s_cselect_b32 s58, s66, s58
    buffer_load_dwordx4 v[144:147], v23, s[24:27], s58 offen offset:0 sc1
    s_add_u32 s58, s58, 1024
    s_cmp_eq_u32 s58, s86
    s_cselect_b32 s58, s66, s58
    buffer_load_dwordx4 v[148:151], v23, s[24:27], s58 offen offset:0 sc1
    s_waitcnt vmcnt(10)
    ds_read_b64_tr_b16 a[240:241], v2 offset:16384
    ds_read_b64_tr_b16 a[242:243], v2 offset:16896
    ds_read_b64_tr_b16 a[244:245], v3 offset:16384
    ds_read_b64_tr_b16 a[246:247], v3 offset:16896
    s_add_u32 s58, s58, 1024
    s_cmp_eq_u32 s58, s86
    s_cselect_b32 s58, s66, s58
    buffer_load_dwordx4 v[152:155], v23, s[24:27], s58 offen offset:0 sc1
    ds_read_b64_tr_b16 a[248:249], v2 offset:16640
    ds_read_b64_tr_b16 a[250:251], v2 offset:17152
    ds_read_b64_tr_b16 a[252:253], v3 offset:16640
    ds_read_b64_tr_b16 a[254:255], v3 offset:17152
    s_waitcnt vmcnt(10)
    v_mfma_f32_16x16x32_bf16 v[96:99], a[0:3], v[112:115], v[96:99]
    s_add_u32 s58, s58, 1024
    s_cmp_eq_u32 s58, s86
    s_cselect_b32 s58, s66, s58
    v_mfma_f32_16x16x32_bf16 v[100:103], a[4:7], v[112:115], v[100:103]
    buffer_load_dwordx4 v[156:159], v23, s[24:27], s58 offen offset:0 sc1
    v_mfma_f32_16x16x32_bf16 v[104:107], a[8:11], v[112:115], v[104:107]
    v_mfma_f32_16x16x32_bf16 v[108:111], a[12:15], v[112:115], v[108:111]
    s_waitcnt vmcnt(10)
    v_mfma_f32_16x16x32_bf16 v[96:99], a[16:19], v[116:119], v[96:99]
    s_add_u32 s58, s58, 1024
    s_cmp_eq_u32 s58, s86
    s_cselect_b32 s58, s66, s58
    v_mfma_f32_16x16x32_bf16 v[100:103], a[20:23], v[116:119], v[100:103]
    buffer_load_dwordx4 v[112:115], v23, s[24:27], s58 offen offset:0 sc1
    v_mfma_f32_16x16x32_bf16 v[104:107], a[24:27], v[116:119], v[104:107]
    v_mfma_f32_16x16x32_bf16 v[108:111], a[28:31], v[116:119], v[108:111]
    s_waitcnt vmcnt(10)
    v_mfma_f32_16x16x32_bf16 v[96:99], a[32:35], v[120:123], v[96:99]
    s_add_u32 s58, s66, 13312
    v_mfma_f32_16x16x32_bf16 v[100:103], a[36:39], v[120:123], v[100:103]
    buffer_load_dwordx4 v[116:119], v23, s[24:27], s58 offen offset:0 sc1
    v_mfma_f32_16x16x32_bf16 v[104:107], a[40:43], v[120:123], v[104:107]
    v_mfma_f32_16x16x32_bf16 v[108:111], a[44:47], v[120:123], v[108:111]
    s_waitcnt vmcnt(10)
    v_mfma_f32_16x16x32_bf16 v[96:99], a[48:51], v[124:127], v[96:99]
    s_add_u32 s58, s66, 14336
    v_mfma_f32_16x16x32_bf16 v[100:103], a[52:55], v[124:127], v[100:103]
    buffer_load_dwordx4 v[120:123], v23, s[24:27], s58 offen offset:0 sc1
    v_mfma_f32_16x16x32_bf16 v[104:107], a[56:59], v[124:127], v[104:107]
    v_mfma_f32_16x16x32_bf16 v[108:111], a[60:63], v[124:127], v[108:111]
    s_waitcnt vmcnt(10)
    v_mfma_f32_16x16x32_bf16 v[96:99], a[64:67], v[128:131], v[96:99]
    s_add_u32 s58, s66, 15360
    v_mfma_f32_16x16x32_bf16 v[100:103], a[68:71], v[128:131], v[100:103]
    buffer_load_dwordx4 v[124:127], v23, s[24:27], s58 offen offset:0 sc1
    v_mfma_f32_16x16x32_bf16 v[104:107], a[72:75], v[128:131], v[104:107]
    v_mfma_f32_16x16x32_bf16 v[108:111], a[76:79], v[128:131], v[108:111]
    s_waitcnt vmcnt(10)
    v_mfma_f32_16x16x32_bf16 v[96:99], a[80:83], v[132:135], v[96:99]
    s_xor_b32 s66, s44, 3
    s_lshl2_add_u32 s66, s51, s66
    s_mul_i32 s66, s66, 66816
    s_lshl2_add_u32 s66, s52, s66
    s_lshl_b32 s86, s65, 10
    s_add_u32 s58, s86, s66
    s_add_u32 s86, s66, 13312
    v_mfma_f32_16x16x32_bf16 v[100:103], a[84:87], v[132:135], v[100:103]
    buffer_load_dwordx4 v[128:131], v23, s[24:27], s58 offen offset:0 sc1
    v_mfma_f32_16x16x32_bf16 v[104:107], a[88:91], v[132:135], v[104:107]
    v_mfma_f32_16x16x32_bf16 v[108:111], a[92:95], v[132:135], v[108:111]
    s_waitcnt vmcnt(10)
    v_mfma_f32_16x16x32_bf16 v[96:99], a[96:99], v[136:139], v[96:99]
    s_add_u32 s58, s58, 1024
    s_cmp_eq_u32 s58, s86
    s_cselect_b32 s58, s66, s58
    v_mfma_f32_16x16x32_bf16 v[100:103], a[100:103], v[136:139], v[100:103]
    buffer_load_dwordx4 v[132:135], v23, s[24:27], s58 offen offset:0 sc1
    v_mfma_f32_16x16x32_bf16 v[104:107], a[104:107], v[136:139], v[104:107]
    v_mfma_f32_16x16x32_bf16 v[108:111], a[108:111], v[136:139], v[108:111]
    s_waitcnt vmcnt(10)
    v_mfma_f32_16x16x32_bf16 v[96:99], a[112:115], v[140:143], v[96:99]
    s_add_u32 s58, s58, 1024
    s_cmp_eq_u32 s58, s86
    s_cselect_b32 s58, s66, s58
    v_mfma_f32_16x16x32_bf16 v[100:103], a[116:119], v[140:143], v[100:103]
    buffer_load_dwordx4 v[136:139], v23, s[24:27], s58 offen offset:0 sc1
    v_mfma_f32_16x16x32_bf16 v[104:107], a[120:123], v[140:143], v[104:107]
    v_mfma_f32_16x16x32_bf16 v[108:111], a[124:127], v[140:143], v[108:111]
    s_waitcnt vmcnt(10)
    v_mfma_f32_16x16x32_bf16 v[96:99], a[128:131], v[144:147], v[96:99]
    s_add_u32 s58, s58, 1024
    s_cmp_eq_u32 s58, s86
    s_cselect_b32 s58, s66, s58
    v_mfma_f32_16x16x32_bf16 v[100:103], a[132:135], v[144:147], v[100:103]
    buffer_load_dwordx4 v[140:143], v23, s[24:27], s58 offen offset:0 sc1
    v_mfma_f32_16x16x32_bf16 v[104:107], a[136:139], v[144:147], v[104:107]
    v_mfma_f32_16x16x32_bf16 v[108:111], a[140:143], v[144:147], v[108:111]
    s_waitcnt vmcnt(10)
    s_waitcnt lgkmcnt(15)
    v_mfma_f32_16x16x32_bf16 v[96:99], a[144:147], v[148:151], v[96:99]
    s_add_u32 s58, s58, 1024
    s_cmp_eq_u32 s58, s86
    s_cselect_b32 s58, s66, s58
    v_mfma_f32_16x16x32_bf16 v[100:103], a[148:151], v[148:151], v[100:103]
    buffer_load_dwordx4 v[144:147], v23, s[24:27], s58 offen offset:0 sc1
    v_mfma_f32_16x16x32_bf16 v[104:107], a[152:155], v[148:151], v[104:107]
    v_mfma_f32_16x16x32_bf16 v[108:111], a[156:159], v[148:151], v[108:111]
    s_waitcnt vmcnt(10)
    v_mfma_f32_16x16x32_bf16 v[96:99], a[160:163], v[152:155], v[96:99]
    s_add_u32 s58, s58, 1024
    s_cmp_eq_u32 s58, s86
    s_cselect_b32 s58, s66, s58
    v_mfma_f32_16x16x32_bf16 v[100:103], a[164:167], v[152:155], v[100:103]
    buffer_load_dwordx4 v[148:151], v23, s[24:27], s58 offen offset:0 sc1
    v_mfma_f32_16x16x32_bf16 v[104:107], a[168:171], v[152:155], v[104:107]
    v_mfma_f32_16x16x32_bf16 v[108:111], a[172:175], v[152:155], v[108:111]
    s_waitcnt vmcnt(10)
    v_mfma_f32_16x16x32_bf16 v[96:99], a[176:179], v[156:159], v[96:99]
    s_add_u32 s58, s58, 1024
    s_cmp_eq_u32 s58, s86
    s_cselect_b32 s58, s66, s58
    v_mfma_f32_16x16x32_bf16 v[100:103], a[180:183], v[156:159], v[100:103]
    buffer_load_dwordx4 v[152:155], v23, s[24:27], s58 offen offset:0 sc1
    v_mfma_f32_16x16x32_bf16 v[104:107], a[184:187], v[156:159], v[104:107]
    v_mfma_f32_16x16x32_bf16 v[108:111], a[188:191], v[156:159], v[108:111]
    s_waitcnt vmcnt(10)
    v_mfma_f32_16x16x32_bf16 v[96:99], a[192:195], v[112:115], v[96:99]
    s_add_u32 s58, s58, 1024
    s_cmp_eq_u32 s58, s86
    s_cselect_b32 s58, s66, s58
    v_mfma_f32_16x16x32_bf16 v[100:103], a[196:199], v[112:115], v[100:103]
    buffer_load_dwordx4 v[156:159], v23, s[24:27], s58 offen offset:0 sc1
    v_mfma_f32_16x16x32_bf16 v[104:107], a[200:203], v[112:115], v[104:107]
    v_mfma_f32_16x16x32_bf16 v[108:111], a[204:207], v[112:115], v[108:111]
    s_waitcnt vmcnt(10)
    v_mfma_f32_16x16x32_bf16 v[96:99], a[208:211], v[116:119], v[96:99]
    s_add_u32 s58, s58, 1024
    s_cmp_eq_u32 s58, s86
    s_cselect_b32 s58, s66, s58
    v_mfma_f32_16x16x32_bf16 v[100:103], a[212:215], v[116:119], v[100:103]
    buffer_load_dwordx4 v[112:115], v23, s[24:27], s58 offen offset:0 sc1
    v_mfma_f32_16x16x32_bf16 v[104:107], a[216:219], v[116:119], v[104:107]
    v_mfma_f32_16x16x32_bf16 v[108:111], a[220:223], v[116:119], v[108:111]
    s_waitcnt vmcnt(10)
    s_waitcnt lgkmcnt(8)
    v_mfma_f32_16x16x32_bf16 v[96:99], a[224:227], v[120:123], v[96:99]
    s_add_u32 s58, s58, 1024
    s_cmp_eq_u32 s58, s86
    s_cselect_b32 s58, s66, s58
    v_mfma_f32_16x16x32_bf16 v[100:103], a[228:231], v[120:123], v[100:103]
    buffer_load_dwordx4 v[116:119], v23, s[24:27], s58 offen offset:0 sc1
    v_mfma_f32_16x16x32_bf16 v[104:107], a[232:235], v[120:123], v[104:107]
    v_mfma_f32_16x16x32_bf16 v[108:111], a[236:239], v[120:123], v[108:111]
    s_waitcnt vmcnt(10)
    s_waitcnt lgkmcnt(0)
    v_mfma_f32_16x16x32_bf16 v[96:99], a[240:243], v[124:127], v[96:99]
    s_add_u32 s58, s58, 1024
    s_cmp_eq_u32 s58, s86
    s_cselect_b32 s58, s66, s58
    v_mfma_f32_16x16x32_bf16 v[100:103], a[244:247], v[124:127], v[100:103]
    buffer_load_dwordx4 v[120:123], v23, s[24:27], s58 offen offset:0 sc1
    v_mfma_f32_16x16x32_bf16 v[104:107], a[248:251], v[124:127], v[104:107]
    v_mfma_f32_16x16x32_bf16 v[108:111], a[252:255], v[124:127], v[108:111]
L_p2_join:
    s_waitcnt vmcnt(10)
    v_mfma_f32_16x16x32_bf16 v[80:83], a[0:3], v[128:131], 0
    s_add_u32 s58, s58, 1024
    s_cmp_eq_u32 s58, s86
    s_cselect_b32 s58, s66, s58
    v_mfma_f32_16x16x32_bf16 v[84:87], a[4:7], v[128:131], 0
    buffer_load_dwordx4 v[124:127], v23, s[24:27], s58 offen offset:0 sc1
    v_mfma_f32_16x16x32_bf16 v[88:91], a[8:11], v[128:131], 0
    v_mfma_f32_16x16x32_bf16 v[92:95], a[12:15], v[128:131], 0
    buffer_load_dwordx4 v[216:219], v22, s[4:7], s71 offen
    s_waitcnt vmcnt(11)
    v_mfma_f32_16x16x32_bf16 v[80:83], a[16:19], v[132:135], v[80:83]
    ds_write_b128 v232, v[96:99] offset:49152
    v_mfma_f32_16x16x32_bf16 v[84:87], a[20:23], v[132:135], v[84:87]
    v_mfma_f32_16x16x32_bf16 v[88:91], a[24:27], v[132:135], v[88:91]
    v_mfma_f32_16x16x32_bf16 v[92:95], a[28:31], v[132:135], v[92:95]
    s_waitcnt vmcnt(10)
    v_mfma_f32_16x16x32_bf16 v[80:83], a[32:35], v[136:139], v[80:83]
    s_add_u32 s58, s58, 1024
    s_cmp_eq_u32 s58, s86
    s_cselect_b32 s58, s66, s58
    v_mfma_f32_16x16x32_bf16 v[84:87], a[36:39], v[136:139], v[84:87]
    buffer_load_dwordx4 v[128:131], v23, s[24:27], s58 offen offset:0 sc1
    v_mfma_f32_16x16x32_bf16 v[88:91], a[40:43], v[136:139], v[88:91]
    ds_write_b128 v232, v[100:103] offset:50176
    v_mfma_f32_16x16x32_bf16 v[92:95], a[44:47], v[136:139], v[92:95]
    buffer_load_dwordx4 v[220:223], v22, s[4:7], s72 offen
    s_waitcnt vmcnt(11)
    v_mfma_f32_16x16x32_bf16 v[80:83], a[48:51], v[140:143], v[80:83]
    ds_write_b128 v232, v[104:107] offset:51200
    v_mfma_f32_16x16x32_bf16 v[84:87], a[52:55], v[140:143], v[84:87]
    v_mfma_f32_16x16x32_bf16 v[88:91], a[56:59], v[140:143], v[88:91]
    v_mfma_f32_16x16x32_bf16 v[92:95], a[60:63], v[140:143], v[92:95]
    s_waitcnt vmcnt(10)
    v_mfma_f32_16x16x32_bf16 v[80:83], a[64:67], v[144:147], v[80:83]
    s_add_u32 s58, s66, 13312
    v_mfma_f32_16x16x32_bf16 v[84:87], a[68:71], v[144:147], v[84:87]
    buffer_load_dwordx4 v[132:135], v23, s[24:27], s58 offen offset:0 sc1
    v_mfma_f32_16x16x32_bf16 v[88:91], a[72:75], v[144:147], v[88:91]
    ds_write_b128 v232, v[108:111] offset:52224
    v_mfma_f32_16x16x32_bf16 v[92:95], a[76:79], v[144:147], v[92:95]
    buffer_load_dwordx2 v[224:225], v26, s[4:7], s73 offen
    s_waitcnt vmcnt(11)
    v_mfma_f32_16x16x32_bf16 v[80:83], a[80:83], v[148:151], v[80:83]
    v_mfma_f32_16x16x32_bf16 v[84:87], a[84:87], v[148:151], v[84:87]
    v_mfma_f32_16x16x32_bf16 v[88:91], a[88:91], v[148:151], v[88:91]
    v_mfma_f32_16x16x32_bf16 v[92:95], a[92:95], v[148:151], v[92:95]
    s_waitcnt vmcnt(10)
    v_mfma_f32_16x16x32_bf16 v[80:83], a[96:99], v[152:155], v[80:83]
    s_add_u32 s58, s66, 14336
    v_mfma_f32_16x16x32_bf16 v[84:87], a[100:103], v[152:155], v[84:87]
    buffer_load_dwordx4 v[136:139], v23, s[24:27], s58 offen offset:0 sc1
    v_mfma_f32_16x16x32_bf16 v[88:91], a[104:107], v[152:155], v[88:91]
    v_mfma_f32_16x16x32_bf16 v[92:95], a[108:111], v[152:155], v[92:95]
    buffer_load_ushort v228, v25, s[36:39], s74 offen
    s_waitcnt vmcnt(11)
    v_mfma_f32_16x16x32_bf16 v[80:83], a[112:115], v[156:159], v[80:83]
    s_waitcnt lgkmcnt(0)
    s_barrier
    v_mfma_f32_16x16x32_bf16 v[84:87], a[116:119], v[156:159], v[84:87]
    v_mfma_f32_16x16x32_bf16 v[88:91], a[120:123], v[156:159], v[88:91]
    v_mfma_f32_16x16x32_bf16 v[92:95], a[124:127], v[156:159], v[92:95]
    s_waitcnt vmcnt(10)
    v_mfma_f32_16x16x32_bf16 v[80:83], a[128:131], v[112:115], v[80:83]
    s_add_u32 s58, s66, 15360
    v_mfma_f32_16x16x32_bf16 v[84:87], a[132:135], v[112:115], v[84:87]
    buffer_load_dwordx4 v[140:143], v23, s[24:27], s58 offen offset:0 sc1
    v_mfma_f32_16x16x32_bf16 v[88:91], a[136:139], v[112:115], v[88:91]
    ds_read_b128 v[160:163], v243 offset:0
    ds_read_b128 v[164:167], v243 offset:1024
    v_mfma_f32_16x16x32_bf16 v[92:95], a[140:143], v[112:115], v[92:95]
    ds_read_b128 v[168:171], v243 offset:4096
    s_waitcnt vmcnt(10)
    v_mfma_f32_16x16x32_bf16 v[80:83], a[144:147], v[116:119], v[80:83]
    s_xor_b32 s66, s44, 2
    s_lshl2_add_u32 s66, s51, s66
    s_mul_i32 s66, s66, 66816
    s_lshl2_add_u32 s66, s52, s66
    s_lshl_b32 s86, s65, 10
    s_add_u32 s58, s86, s66
    s_add_u32 s86, s66, 13312
    v_mfma_f32_16x16x32_bf16 v[84:87], a[148:151], v[116:119], v[84:87]
    buffer_load_dwordx4 v[144:147], v23, s[24:27], s58 offen offset:0 sc1
    v_mfma_f32_16x16x32_bf16 v[88:91], a[152:155], v[116:119], v[88:91]
    ds_read_b128 v[172:175], v243 offset:5120
    ds_read_b128 v[176:179], v243 offset:8192
    v_mfma_f32_16x16x32_bf16 v[92:95], a[156:159], v[116:119], v[92:95]
    ds_read_b128 v[180:183], v243 offset:9216
    s_waitcnt vmcnt(10)
    v_mfma_f32_16x16x32_bf16 v[80:83], a[160:163], v[120:123], v[80:83]
    s_add_u32 s58, s58, 1024
    s_cmp_eq_u32 s58, s86
    s_cselect_b32 s58, s66, s58
    v_mfma_f32_16x16x32_bf16 v[84:87], a[164:167], v[120:123], v[84:87]
    buffer_load_dwordx4 v[148:151], v23, s[24:27], s58 offen offset:0 sc1
    v_mfma_f32_16x16x32_bf16 v[88:91], a[168:171], v[120:123], v[88:91]
    ds_read_b128 v[184:187], v243 offset:12288
    v_mfma_f32_16x16x32_bf16 v[92:95], a[172:175], v[120:123], v[92:95]
    ds_read_b128 v[188:191], v243 offset:13312
    s_waitcnt vmcnt(10)
    v_mfma_f32_16x16x32_bf16 v[80:83], a[176:179], v[124:127], v[80:83]
    s_add_u32 s58, s58, 1024
    s_cmp_eq_u32 s58, s86
    s_cselect_b32 s58, s66, s58
    v_mfma_f32_16x16x32_bf16 v[84:87], a[180:183], v[124:127], v[84:87]
    buffer_load_dwordx4 v[152:155], v23, s[24:27], s58 offen offset:0 sc1
    v_mfma_f32_16x16x32_bf16 v[88:91], a[184:187], v[124:127], v[88:91]
    v_mfma_f32_16x16x32_bf16 v[92:95], a[188:191], v[124:127], v[92:95]
    s_add_u32 s58, s58, 1024
    s_cmp_eq_u32 s58, s86
    s_cselect_b32 s58, s66, s58
    buffer_load_dwordx4 v[156:159], v23, s[24:27], s58 offen offset:0 sc1
    s_waitcnt vmcnt(10)
    v_mfma_f32_16x16x32_bf16 v[80:83], a[192:195], v[128:131], v[80:83]
    s_add_u32 s58, s58, 1024
    s_cmp_eq_u32 s58, s86
    s_cselect_b32 s58, s66, s58
    v_mfma_f32_16x16x32_bf16 v[84:87], a[196:199], v[128:131], v[84:87]
    buffer_load_dwordx4 v[112:115], v23, s[24:27], s58 offen offset:0 sc1
    v_mfma_f32_16x16x32_bf16 v[88:91], a[200:203], v[128:131], v[88:91]
    s_waitcnt lgkmcnt(0)
    v_add_f32 v160, v160, v168
    v_mfma_f32_16x16x32_bf16 v[92:95], a[204:207], v[128:131], v[92:95]
    v_add_f32 v161, v161, v169
    s_add_u32 s58, s58, 1024
    s_cmp_eq_u32 s58, s86
    s_cselect_b32 s58, s66, s58
    buffer_load_dwordx4 v[116:119], v23, s[24:27], s58 offen offset:0 sc1
    s_waitcnt vmcnt(10)
    v_mfma_f32_16x16x32_bf16 v[80:83], a[208:211], v[132:135], v[80:83]
    s_add_u32 s58, s58, 1024
    s_cmp_eq_u32 s58, s86
    s_cselect_b32 s58, s66, s58
    v_mfma_f32_16x16x32_bf16 v[84:87], a[212:215], v[132:135], v[84:87]
    buffer_load_dwordx4 v[120:123], v23, s[24:27], s58 offen offset:0 sc1
    v_mfma_f32_16x16x32_bf16 v[88:91], a[216:219], v[132:135], v[88:91]
    v_add_f32 v162, v162, v170
    v_add_f32 v163, v163, v171
    v_mfma_f32_16x16x32_bf16 v[92:95], a[220:223], v[132:135], v[92:95]
    v_add_f32 v164, v164, v172
    s_add_u32 s58, s58, 1024
    s_cmp_eq_u32 s58, s86
    s_cselect_b32 s58, s66, s58
    buffer_load_dwordx4 v[124:127], v23, s[24:27], s58 offen offset:0 sc1
    s_waitcnt vmcnt(10)
    v_mfma_f32_16x16x32_bf16 v[80:83], a[224:227], v[136:139], v[80:83]
    s_add_u32 s58, s58, 1024
    s_cmp_eq_u32 s58, s86
    s_cselect_b32 s58, s66, s58
    v_mfma_f32_16x16x32_bf16 v[84:87], a[228:231], v[136:139], v[84:87]
    buffer_load_dwordx4 v[128:131], v23, s[24:27], s58 offen offset:0 sc1
    v_mfma_f32_16x16x32_bf16 v[88:91], a[232:235], v[136:139], v[88:91]
    v_add_f32 v165, v165, v173
    v_add_f32 v166, v166, v174
    v_mfma_f32_16x16x32_bf16 v[92:95], a[236:239], v[136:139], v[92:95]
    v_add_f32 v167, v167, v175
    s_add_u32 s58, s58, 1024
    s_cmp_eq_u32 s58, s86
    s_cselect_b32 s58, s66, s58
    buffer_load_dwordx4 v[132:135], v23, s[24:27], s58 offen offset:0 sc1
    s_waitcnt vmcnt(10)
    v_mfma_f32_16x16x32_bf16 v[80:83], a[240:243], v[140:143], v[80:83]
    s_add_u32 s58, s58, 1024
    s_cmp_eq_u32 s58, s86
    s_cselect_b32 s58, s66, s58
    v_mfma_f32_16x16x32_bf16 v[84:87], a[244:247], v[140:143], v[84:87]
    buffer_load_dwordx4 v[136:139], v23, s[24:27], s58 offen offset:0 sc1
    v_mfma_f32_16x16x32_bf16 v[88:91], a[248:251], v[140:143], v[88:91]
    v_add_f32 v160, v160, v176
    v_add_f32 v161, v161, v177
    v_mfma_f32_16x16x32_bf16 v[92:95], a[252:255], v[140:143], v[92:95]
    v_add_f32 v162, v162, v178
    s_waitcnt vmcnt(10)
    v_mfma_f32_16x16x32_bf16 v[64:67], a[0:3], v[144:147], 0
    s_add_u32 s58, s58, 1024
    s_cmp_eq_u32 s58, s86
    s_cselect_b32 s58, s66, s58
    v_mfma_f32_16x16x32_bf16 v[68:71], a[4:7], v[144:147], 0
    buffer_load_dwordx4 v[140:143], v23, s[24:27], s58 offen offset:0 sc1
    v_mfma_f32_16x16x32_bf16 v[72:75], a[8:11], v[144:147], 0
    v_mfma_f32_16x16x32_bf16 v[76:79], a[12:15], v[144:147], 0
    s_waitcnt vmcnt(10)
    v_mfma_f32_16x16x32_bf16 v[64:67], a[16:19], v[148:151], v[64:67]
    s_add_u32 s58, s58, 1024
    s_cmp_eq_u32 s58, s86
    s_cselect_b32 s58, s66, s58
    v_mfma_f32_16x16x32_bf16 v[68:71], a[20:23], v[148:151], v[68:71]
    buffer_load_dwordx4 v[144:147], v23, s[24:27], s58 offen offset:0 sc1
    v_mfma_f32_16x16x32_bf16 v[72:75], a[24:27], v[148:151], v[72:75]
    ds_write_b128 v232, v[80:83] offset:32768
    v_mfma_f32_16x16x32_bf16 v[76:79], a[28:31], v[148:151], v[76:79]
    s_waitcnt vmcnt(10)
    v_mfma_f32_16x16x32_bf16 v[64:67], a[32:35], v[152:155], v[64:67]
    s_add_u32 s58, s66, 13312
    v_mfma_f32_16x16x32_bf16 v[68:71], a[36:39], v[152:155], v[68:71]
    buffer_load_dwordx4 v[148:151], v23, s[24:27], s58 offen offset:0 sc1
    v_mfma_f32_16x16x32_bf16 v[72:75], a[40:43], v[152:155], v[72:75]
    ds_write_b128 v232, v[84:87] offset:33792
    v_mfma_f32_16x16x32_bf16 v[76:79], a[44:47], v[152:155], v[76:79]
    s_waitcnt vmcnt(10)
    v_mfma_f32_16x16x32_bf16 v[64:67], a[48:51], v[156:159], v[64:67]
    s_add_u32 s58, s66, 14336
    ds_write_b128 v232, v[88:91] offset:34816
    v_mfma_f32_16x16x32_bf16 v[68:71], a[52:55], v[156:159], v[68:71]
    buffer_load_dwordx4 v[152:155], v23, s[24:27], s58 offen offset:0 sc1
    v_mfma_f32_16x16x32_bf16 v[72:75], a[56:59], v[156:159], v[72:75]
    v_add_f32 v163, v163, v179
    v_add_f32 v164, v164, v180
    v_mfma_f32_16x16x32_bf16 v[76:79], a[60:63], v[156:159], v[76:79]
    v_add_f32 v165, v165, v181
    s_waitcnt vmcnt(10)
    v_mfma_f32_16x16x32_bf16 v[64:67], a[64:67], v[112:115], v[64:67]
    s_add_u32 s58, s66, 15360
    ds_write_b128 v232, v[92:95] offset:35840
    v_mfma_f32_16x16x32_bf16 v[68:71], a[68:71], v[112:115], v[68:71]
    buffer_load_dwordx4 v[156:159], v23, s[24:27], s58 offen offset:0 sc1
    v_mfma_f32_16x16x32_bf16 v[72:75], a[72:75], v[112:115], v[72:75]
    v_add_f32 v166, v166, v182
    v_add_f32 v167, v167, v183
    v_mfma_f32_16x16x32_bf16 v[76:79], a[76:79], v[112:115], v[76:79]
    v_add_f32 v160, v160, v184
    s_waitcnt vmcnt(10)
    v_mfma_f32_16x16x32_bf16 v[64:67], a[80:83], v[116:119], v[64:67]
    s_xor_b32 s66, s44, 1
    s_lshl2_add_u32 s66, s51, s66
    s_mul_i32 s66, s66, 66816
    s_lshl2_add_u32 s66, s52, s66
    s_lshl_b32 s86, s65, 10
    s_add_u32 s58, s86, s66
    s_add_u32 s86, s66, 13312
    v_mfma_f32_16x16x32_bf16 v[68:71], a[84:87], v[116:119], v[68:71]
    buffer_load_dwordx4 v[112:115], v23, s[24:27], s58 offen offset:0 sc1
    v_mfma_f32_16x16x32_bf16 v[72:75], a[88:91], v[116:119], v[72:75]
    v_add_f32 v161, v161, v185
    v_add_f32 v162, v162, v186
    v_mfma_f32_16x16x32_bf16 v[76:79], a[92:95], v[116:119], v[76:79]
    v_add_f32 v163, v163, v187
    s_waitcnt vmcnt(10)
    v_mfma_f32_16x16x32_bf16 v[64:67], a[96:99], v[120:123], v[64:67]
    s_add_u32 s58, s58, 1024
    s_cmp_eq_u32 s58, s86
    s_cselect_b32 s58, s66, s58
    v_mfma_f32_16x16x32_bf16 v[68:71], a[100:103], v[120:123], v[68:71]
    buffer_load_dwordx4 v[116:119], v23, s[24:27], s58 offen offset:0 sc1
    v_mfma_f32_16x16x32_bf16 v[72:75], a[104:107], v[120:123], v[72:75]
    v_add_f32 v164, v164, v188
    v_add_f32 v165, v165, v189
    v_mfma_f32_16x16x32_bf16 v[76:79], a[108:111], v[120:123], v[76:79]
    v_add_f32 v166, v166, v190
    s_waitcnt vmcnt(10)
    v_mfma_f32_16x16x32_bf16 v[64:67], a[112:115], v[124:127], v[64:67]
    s_add_u32 s58, s58, 1024
    s_cmp_eq_u32 s58, s86
    s_cselect_b32 s58, s66, s58
    v_mfma_f32_16x16x32_bf16 v[68:71], a[116:119], v[124:127], v[68:71]
    buffer_load_dwordx4 v[120:123], v23, s[24:27], s58 offen offset:0 sc1
    v_mfma_f32_16x16x32_bf16 v[72:75], a[120:123], v[124:127], v[72:75]
    v_add_f32 v167, v167, v191
    v_mul_f32 v192, v160, v160
    v_mfma_f32_16x16x32_bf16 v[76:79], a[124:127], v[124:127], v[76:79]
    v_mul_f32 v193, v161, v161
    s_waitcnt vmcnt(10)
    v_mfma_f32_16x16x32_bf16 v[64:67], a[128:131], v[128:131], v[64:67]
    s_add_u32 s58, s58, 1024
    s_cmp_eq_u32 s58, s86
    s_cselect_b32 s58, s66, s58
    v_mfma_f32_16x16x32_bf16 v[68:71], a[132:135], v[128:131], v[68:71]
    buffer_load_dwordx4 v[124:127], v23, s[24:27], s58 offen offset:0 sc1
    v_mfma_f32_16x16x32_bf16 v[72:75], a[136:139], v[128:131], v[72:75]
    v_mul_f32 v194, v162, v162
    v_mul_f32 v195, v163, v163
    v_mfma_f32_16x16x32_bf16 v[76:79], a[140:143], v[128:131], v[76:79]
    v_mul_f32 v196, v164, v164
    s_waitcnt vmcnt(10)
    v_mfma_f32_16x16x32_bf16 v[64:67], a[144:147], v[132:135], v[64:67]
    s_add_u32 s58, s58, 1024
    s_cmp_eq_u32 s58, s86
    s_cselect_b32 s58, s66, s58
    v_mfma_f32_16x16x32_bf16 v[68:71], a[148:151], v[132:135], v[68:71]
    buffer_load_dwordx4 v[128:131], v23, s[24:27], s58 offen offset:0 sc1
    v_mfma_f32_16x16x32_bf16 v[72:75], a[152:155], v[132:135], v[72:75]
    v_mul_f32 v197, v165, v165
    v_mul_f32 v198, v166, v166
    v_mfma_f32_16x16x32_bf16 v[76:79], a[156:159], v[132:135], v[76:79]
    v_mul_f32 v199, v167, v167
    ds_write_b128 v244, v[216:219]
    s_waitcnt vmcnt(10)
    v_mfma_f32_16x16x32_bf16 v[64:67], a[160:163], v[136:139], v[64:67]
    s_add_u32 s58, s58, 1024
    s_cmp_eq_u32 s58, s86
    s_cselect_b32 s58, s66, s58
    v_mfma_f32_16x16x32_bf16 v[68:71], a[164:167], v[136:139], v[68:71]
    buffer_load_dwordx4 v[132:135], v23, s[24:27], s58 offen offset:0 sc1
    v_mfma_f32_16x16x32_bf16 v[72:75], a[168:171], v[136:139], v[72:75]
    v_fma_f32 v192, v192, v236, v237
    v_fma_f32 v193, v193, v236, v237
    v_mfma_f32_16x16x32_bf16 v[76:79], a[172:175], v[136:139], v[76:79]
    v_fma_f32 v194, v194, v236, v237
    s_waitcnt vmcnt(10)
    v_mfma_f32_16x16x32_bf16 v[64:67], a[176:179], v[140:143], v[64:67]
    s_add_u32 s58, s58, 1024
    s_cmp_eq_u32 s58, s86
    s_cselect_b32 s58, s66, s58
    v_mfma_f32_16x16x32_bf16 v[68:71], a[180:183], v[140:143], v[68:71]
    buffer_load_dwordx4 v[136:139], v23, s[24:27], s58 offen offset:0 sc1
    v_mfma_f32_16x16x32_bf16 v[72:75], a[184:187], v[140:143], v[72:75]
    v_fma_f32 v195, v195, v236, v237
    v_fma_f32 v196, v196, v236, v237
    v_mfma_f32_16x16x32_bf16 v[76:79], a[188:191], v[140:143], v[76:79]
    v_fma_f32 v197, v197, v236, v237
    ds_write_b128 v244, v[220:223] offset:1408
    s_waitcnt vmcnt(10)
    v_mfma_f32_16x16x32_bf16 v[64:67], a[192:195], v[144:147], v[64:67]
    s_add_u32 s58, s58, 1024
    s_cmp_eq_u32 s58, s86
    s_cselect_b32 s58, s66, s58
    v_mfma_f32_16x16x32_bf16 v[68:71], a[196:199], v[144:147], v[68:71]
    buffer_load_dwordx4 v[140:143], v23, s[24:27], s58 offen offset:0 sc1
    v_mfma_f32_16x16x32_bf16 v[72:75], a[200:203], v[144:147], v[72:75]
    v_fma_f32 v198, v198, v236, v237
    v_fma_f32 v199, v199, v236, v237
    v_mfma_f32_16x16x32_bf16 v[76:79], a[204:207], v[144:147], v[76:79]
    v_mul_f32 v192, v192, v160
    s_waitcnt vmcnt(10)
    v_mfma_f32_16x16x32_bf16 v[64:67], a[208:211], v[148:151], v[64:67]
    s_add_u32 s58, s58, 1024
    s_cmp_eq_u32 s58, s86
    s_cselect_b32 s58, s66, s58
    v_mfma_f32_16x16x32_bf16 v[68:71], a[212:215], v[148:151], v[68:71]
    buffer_load_dwordx4 v[144:147], v23, s[24:27], s58 offen offset:0 sc1
    v_mfma_f32_16x16x32_bf16 v[72:75], a[216:219], v[148:151], v[72:75]
    v_mul_f32 v193, v193, v161
    v_mul_f32 v194, v194, v162
    v_mfma_f32_16x16x32_bf16 v[76:79], a[220:223], v[148:151], v[76:79]
    v_mul_f32 v195, v195, v163
    ds_write_b64 v252, v[224:225] offset:128
    s_waitcnt vmcnt(10)
    v_mfma_f32_16x16x32_bf16 v[64:67], a[224:227], v[152:155], v[64:67]
    s_add_u32 s58, s58, 1024
    s_cmp_eq_u32 s58, s86
    s_cselect_b32 s58, s66, s58
    v_mfma_f32_16x16x32_bf16 v[68:71], a[228:231], v[152:155], v[68:71]
    buffer_load_dwordx4 v[148:151], v23, s[24:27], s58 offen offset:0 sc1
    v_mfma_f32_16x16x32_bf16 v[72:75], a[232:235], v[152:155], v[72:75]
    v_mul_f32 v196, v196, v164
    v_mul_f32 v197, v197, v165
    v_mfma_f32_16x16x32_bf16 v[76:79], a[236:239], v[152:155], v[76:79]
    v_mul_f32 v198, v198, v166
    s_waitcnt vmcnt(10)
    v_mfma_f32_16x16x32_bf16 v[64:67], a[240:243], v[156:159], v[64:67]
    s_add_u32 s58, s58, 1024
    s_cmp_eq_u32 s58, s86
    s_cselect_b32 s58, s66, s58
    v_mfma_f32_16x16x32_bf16 v[68:71], a[244:247], v[156:159], v[68:71]
    buffer_load_dwordx4 v[152:155], v23, s[24:27], s58 offen offset:0 sc1
    v_mfma_f32_16x16x32_bf16 v[72:75], a[248:251], v[156:159], v[72:75]
    v_mul_f32 v199, v199, v167
    v_mfma_f32_16x16x32_bf16 v[76:79], a[252:255], v[156:159], v[76:79]
    ds_read_b64 v[216:217], v238 offset:0
    ds_read_b64 v[218:219], v238 offset:32
    ds_read_b64 v[220:221], v238 offset:64
    ds_read_b64 v[222:223], v238 offset:96
    ds_read_b64 v[224:225], v238 offset:128
    s_waitcnt vmcnt(10)
    v_mfma_f32_16x16x32_bf16 v[48:51], a[0:3], v[112:115], 0
    s_add_u32 s58, s58, 1024
    s_cmp_eq_u32 s58, s86
    s_cselect_b32 s58, s66, s58
    v_mfma_f32_16x16x32_bf16 v[52:55], a[4:7], v[112:115], 0
    buffer_load_dwordx4 v[156:159], v23, s[24:27], s58 offen offset:0 sc1
    v_mfma_f32_16x16x32_bf16 v[56:59], a[8:11], v[112:115], 0
    v_mfma_f32_16x16x32_bf16 v[60:63], a[12:15], v[112:115], 0
    s_waitcnt vmcnt(10)
    v_mfma_f32_16x16x32_bf16 v[48:51], a[16:19], v[116:119], v[48:51]
    s_add_u32 s58, s58, 1024
    s_cmp_eq_u32 s58, s86
    s_cselect_b32 s58, s66, s58
    v_mfma_f32_16x16x32_bf16 v[52:55], a[20:23], v[116:119], v[52:55]
    buffer_load_dwordx4 v[112:115], v23, s[24:27], s58 offen offset:0 sc1
    v_mfma_f32_16x16x32_bf16 v[56:59], a[24:27], v[116:119], v[56:59]
    ds_write_b128 v232, v[64:67] offset:16384
    v_mfma_f32_16x16x32_bf16 v[60:63], a[28:31], v[116:119], v[60:63]
    s_waitcnt vmcnt(10)
    v_mfma_f32_16x16x32_bf16 v[48:51], a[32:35], v[120:123], v[48:51]
    s_add_u32 s58, s66, 13312
    v_mfma_f32_16x16x32_bf16 v[52:55], a[36:39], v[120:123], v[52:55]
    buffer_load_dwordx4 v[116:119], v23, s[24:27], s58 offen offset:0 sc1
    v_mfma_f32_16x16x32_bf16 v[56:59], a[40:43], v[120:123], v[56:59]
    ds_write_b128 v232, v[68:71] offset:17408
    v_mfma_f32_16x16x32_bf16 v[60:63], a[44:47], v[120:123], v[60:63]
    s_waitcnt vmcnt(10)
    v_mfma_f32_16x16x32_bf16 v[48:51], a[48:51], v[124:127], v[48:51]
    s_add_u32 s58, s66, 14336
    ds_write_b128 v232, v[72:75] offset:18432
    v_mfma_f32_16x16x32_bf16 v[52:55], a[52:55], v[124:127], v[52:55]
    buffer_load_dwordx4 v[120:123], v23, s[24:27], s58 offen offset:0 sc1
    v_mfma_f32_16x16x32_bf16 v[56:59], a[56:59], v[124:127], v[56:59]
    v_exp_f32 v192, v192
    v_exp_f32 v193, v193
    v_mfma_f32_16x16x32_bf16 v[60:63], a[60:63], v[124:127], v[60:63]
    v_exp_f32 v194, v194
    s_waitcnt vmcnt(10)
    v_mfma_f32_16x16x32_bf16 v[48:51], a[64:67], v[128:131], v[48:51]
    s_add_u32 s58, s66, 15360
    ds_write_b128 v232, v[76:79] offset:19456
    v_mfma_f32_16x16x32_bf16 v[52:55], a[68:71], v[128:131], v[52:55]
    buffer_load_dwordx4 v[124:127], v23, s[24:27], s58 offen offset:0 sc1
    v_mfma_f32_16x16x32_bf16 v[56:59], a[72:75], v[128:131], v[56:59]
    v_exp_f32 v195, v195
    v_exp_f32 v196, v196
    v_mfma_f32_16x16x32_bf16 v[60:63], a[76:79], v[128:131], v[60:63]
    v_exp_f32 v197, v197
    s_waitcnt vmcnt(10)
    v_mfma_f32_16x16x32_bf16 v[48:51], a[80:83], v[132:135], v[48:51]
    s_xor_b32 s66, s44, 0
    s_lshl2_add_u32 s66, s51, s66
    s_mul_i32 s66, s66, 66816
    s_lshl2_add_u32 s66, s52, s66
    s_lshl_b32 s86, s65, 10
    s_add_u32 s58, s86, s66
    s_add_u32 s86, s66, 13312
    v_mfma_f32_16x16x32_bf16 v[52:55], a[84:87], v[132:135], v[52:55]
    buffer_load_dwordx4 v[128:131], v23, s[24:27], s58 offen offset:0 sc1
    v_mfma_f32_16x16x32_bf16 v[56:59], a[88:91], v[132:135], v[56:59]
    v_exp_f32 v198, v198
    v_exp_f32 v199, v199
    v_mfma_f32_16x16x32_bf16 v[60:63], a[92:95], v[132:135], v[60:63]
    v_add_f32 v192, 1.0, v192
    s_waitcnt vmcnt(10)
    v_mfma_f32_16x16x32_bf16 v[48:51], a[96:99], v[136:139], v[48:51]
    s_add_u32 s58, s58, 1024
    s_cmp_eq_u32 s58, s86
    s_cselect_b32 s58, s66, s58
    v_mfma_f32_16x16x32_bf16 v[52:55], a[100:103], v[136:139], v[52:55]
    buffer_load_dwordx4 v[132:135], v23, s[24:27], s58 offen offset:0 sc1
    v_mfma_f32_16x16x32_bf16 v[56:59], a[104:107], v[136:139], v[56:59]
    v_add_f32 v193, 1.0, v193
    v_add_f32 v194, 1.0, v194
    v_mfma_f32_16x16x32_bf16 v[60:63], a[108:111], v[136:139], v[60:63]
    v_add_f32 v195, 1.0, v195
    s_waitcnt vmcnt(10)
    v_mfma_f32_16x16x32_bf16 v[48:51], a[112:115], v[140:143], v[48:51]
    s_add_u32 s58, s58, 1024
    s_cmp_eq_u32 s58, s86
    s_cselect_b32 s58, s66, s58
    v_mfma_f32_16x16x32_bf16 v[52:55], a[116:119], v[140:143], v[52:55]
    buffer_load_dwordx4 v[136:139], v23, s[24:27], s58 offen offset:0 sc1
    v_mfma_f32_16x16x32_bf16 v[56:59], a[120:123], v[140:143], v[56:59]
    v_add_f32 v196, 1.0, v196
    v_add_f32 v197, 1.0, v197
    v_mfma_f32_16x16x32_bf16 v[60:63], a[124:127], v[140:143], v[60:63]
    v_add_f32 v198, 1.0, v198
    s_waitcnt vmcnt(10)
    v_mfma_f32_16x16x32_bf16 v[48:51], a[128:131], v[144:147], v[48:51]
    s_add_u32 s58, s58, 1024
    s_cmp_eq_u32 s58, s86
    s_cselect_b32 s58, s66, s58
    v_mfma_f32_16x16x32_bf16 v[52:55], a[132:135], v[144:147], v[52:55]
    buffer_load_dwordx4 v[140:143], v23, s[24:27], s58 offen offset:0 sc1
    v_mfma_f32_16x16x32_bf16 v[56:59], a[136:139], v[144:147], v[56:59]
    v_add_f32 v199, 1.0, v199
    v_rcp_f32 v192, v192
    v_mfma_f32_16x16x32_bf16 v[60:63], a[140:143], v[144:147], v[60:63]
    v_rcp_f32 v193, v193
    s_waitcnt vmcnt(10)
    v_mfma_f32_16x16x32_bf16 v[48:51], a[144:147], v[148:151], v[48:51]
    s_add_u32 s58, s58, 1024
    s_cmp_eq_u32 s58, s86
    s_cselect_b32 s58, s66, s58
    v_mfma_f32_16x16x32_bf16 v[52:55], a[148:151], v[148:151], v[52:55]
    buffer_load_dwordx4 v[144:147], v23, s[24:27], s58 offen offset:0 sc1
    v_mfma_f32_16x16x32_bf16 v[56:59], a[152:155], v[148:151], v[56:59]
    v_rcp_f32 v194, v194
    v_rcp_f32 v195, v195
    v_mfma_f32_16x16x32_bf16 v[60:63], a[156:159], v[148:151], v[60:63]
    v_rcp_f32 v196, v196
    s_waitcnt vmcnt(10)
    v_mfma_f32_16x16x32_bf16 v[48:51], a[160:163], v[152:155], v[48:51]
    s_add_u32 s58, s58, 1024
    s_cmp_eq_u32 s58, s86
    s_cselect_b32 s58, s66, s58
    v_mfma_f32_16x16x32_bf16 v[52:55], a[164:167], v[152:155], v[52:55]
    buffer_load_dwordx4 v[148:151], v23, s[24:27], s58 offen offset:0 sc1
    v_mfma_f32_16x16x32_bf16 v[56:59], a[168:171], v[152:155], v[56:59]
    v_rcp_f32 v197, v197
    v_rcp_f32 v198, v198
    v_mfma_f32_16x16x32_bf16 v[60:63], a[172:175], v[152:155], v[60:63]
    v_rcp_f32 v199, v199
    s_waitcnt vmcnt(10)
    v_mfma_f32_16x16x32_bf16 v[48:51], a[176:179], v[156:159], v[48:51]
    s_add_u32 s58, s58, 1024
    s_cmp_eq_u32 s58, s86
    s_cselect_b32 s58, s66, s58
    v_mfma_f32_16x16x32_bf16 v[52:55], a[180:183], v[156:159], v[52:55]
    buffer_load_dwordx4 v[152:155], v23, s[24:27], s58 offen offset:0 sc1
    v_mfma_f32_16x16x32_bf16 v[56:59], a[184:187], v[156:159], v[56:59]
    v_mul_f32 v192, v192, v160
    v_mul_f32 v193, v193, v161
    v_mfma_f32_16x16x32_bf16 v[60:63], a[188:191], v[156:159], v[60:63]
    v_mul_f32 v194, v194, v162
    s_waitcnt vmcnt(10)
    v_mfma_f32_16x16x32_bf16 v[48:51], a[192:195], v[112:115], v[48:51]
    s_add_u32 s58, s58, 1024
    s_cmp_eq_u32 s58, s86
    s_cselect_b32 s58, s66, s58
    v_mfma_f32_16x16x32_bf16 v[52:55], a[196:199], v[112:115], v[52:55]
    buffer_load_dwordx4 v[156:159], v23, s[24:27], s58 offen offset:0 sc1
    v_mfma_f32_16x16x32_bf16 v[56:59], a[200:203], v[112:115], v[56:59]
    v_mul_f32 v195, v195, v163
    v_mul_f32 v196, v196, v164
    v_mfma_f32_16x16x32_bf16 v[60:63], a[204:207], v[112:115], v[60:63]
    v_mul_f32 v197, v197, v165
    s_waitcnt vmcnt(10)
    v_mfma_f32_16x16x32_bf16 v[48:51], a[208:211], v[116:119], v[48:51]
    s_add_u32 s58, s58, 1024
    s_cmp_eq_u32 s58, s86
    s_cselect_b32 s58, s66, s58
    v_mfma_f32_16x16x32_bf16 v[52:55], a[212:215], v[116:119], v[52:55]
    buffer_load_dwordx4 v[112:115], v23, s[24:27], s58 offen offset:0 sc1
    v_mfma_f32_16x16x32_bf16 v[56:59], a[216:219], v[116:119], v[56:59]
    v_mul_f32 v198, v198, v166
    v_mul_f32 v199, v199, v167
    v_mfma_f32_16x16x32_bf16 v[60:63], a[220:223], v[116:119], v[60:63]
    v_cvt_pk_bf16_f32 v96, v192, v193
    s_waitcnt vmcnt(10)
    v_mfma_f32_16x16x32_bf16 v[48:51], a[224:227], v[120:123], v[48:51]
    s_add_u32 s58, s58, 1024
    s_cmp_eq_u32 s58, s86
    s_cselect_b32 s58, s66, s58
    v_mfma_f32_16x16x32_bf16 v[52:55], a[228:231], v[120:123], v[52:55]
    buffer_load_dwordx4 v[116:119], v23, s[24:27], s58 offen offset:0 sc1
    v_mfma_f32_16x16x32_bf16 v[56:59], a[232:235], v[120:123], v[56:59]
    v_cvt_pk_bf16_f32 v97, v194, v195
    v_cvt_pk_bf16_f32 v98, v196, v197
    v_mfma_f32_16x16x32_bf16 v[60:63], a[236:239], v[120:123], v[60:63]
    v_cvt_pk_bf16_f32 v99, v198, v199
    s_waitcnt vmcnt(10)
    v_mfma_f32_16x16x32_bf16 v[48:51], a[240:243], v[124:127], v[48:51]
    s_add_u32 s58, s58, 1024
    s_cmp_eq_u32 s58, s86
    s_cselect_b32 s58, s66, s58
    v_mfma_f32_16x16x32_bf16 v[52:55], a[244:247], v[124:127], v[52:55]
    buffer_load_dwordx4 v[120:123], v23, s[24:27], s58 offen offset:0 sc1
    v_mfma_f32_16x16x32_bf16 v[56:59], a[248:251], v[124:127], v[56:59]
    v_mfma_f32_16x16x32_bf16 v[60:63], a[252:255], v[124:127], v[60:63]
    s_waitcnt vmcnt(10)
    v_mfma_f32_16x16x32_bf16 v[32:35], a[0:3], v[128:131], v[32:35]
    s_add_u32 s58, s58, 1024
    s_cmp_eq_u32 s58, s86
    s_cselect_b32 s58, s66, s58
    v_mfma_f32_16x16x32_bf16 v[36:39], a[4:7], v[128:131], v[36:39]
    buffer_load_dwordx4 v[124:127], v23, s[24:27], s58 offen offset:0 sc1
    v_mfma_f32_16x16x32_bf16 v[40:43], a[8:11], v[128:131], v[40:43]
    v_mfma_f32_16x16x32_bf16 v[44:47], a[12:15], v[128:131], v[44:47]
    s_waitcnt vmcnt(10)
    v_mfma_f32_16x16x32_bf16 v[32:35], a[16:19], v[132:135], v[32:35]
    s_add_u32 s58, s58, 1024
    s_cmp_eq_u32 s58, s86
    s_cselect_b32 s58, s66, s58
    v_mfma_f32_16x16x32_bf16 v[36:39], a[20:23], v[132:135], v[36:39]
    buffer_load_dwordx4 v[128:131], v23, s[24:27], s58 offen offset:0 sc1
    v_mfma_f32_16x16x32_bf16 v[40:43], a[24:27], v[132:135], v[40:43]
    ds_write_b128 v232, v[48:51] offset:0
    v_mfma_f32_16x16x32_bf16 v[44:47], a[28:31], v[132:135], v[44:47]
    ds_write_b128 v232, v[52:55] offset:1024
    s_waitcnt vmcnt(10)
    v_mfma_f32_16x16x32_bf16 v[32:35], a[32:35], v[136:139], v[32:35]
    s_add_u32 s58, s66, 13312
    v_mfma_f32_16x16x32_bf16 v[36:39], a[36:39], v[136:139], v[36:39]
    buffer_load_dwordx4 v[132:135], v23, s[24:27], s58 offen offset:0 sc1
    v_mfma_f32_16x16x32_bf16 v[40:43], a[40:43], v[136:139], v[40:43]
    ds_write_b128 v232, v[56:59] offset:2048
    v_mfma_f32_16x16x32_bf16 v[44:47], a[44:47], v[136:139], v[44:47]
    ds_write_b128 v232, v[60:63] offset:3072
    s_waitcnt vmcnt(10)
    v_mfma_f32_16x16x32_bf16 v[32:35], a[48:51], v[140:143], v[32:35]
    s_add_u32 s58, s66, 14336
    v_mfma_f32_16x16x32_bf16 v[36:39], a[52:55], v[140:143], v[36:39]
    buffer_load_dwordx4 v[136:139], v23, s[24:27], s58 offen offset:0 sc1
    v_mfma_f32_16x16x32_bf16 v[40:43], a[56:59], v[140:143], v[40:43]
    v_mfma_f32_16x16x32_bf16 v[44:47], a[60:63], v[140:143], v[44:47]
    s_waitcnt vmcnt(10)
    v_mfma_f32_16x16x32_bf16 v[32:35], a[64:67], v[144:147], v[32:35]
    s_add_u32 s58, s66, 15360
    v_mfma_f32_16x16x32_bf16 v[36:39], a[68:71], v[144:147], v[36:39]
    buffer_load_dwordx4 v[140:143], v23, s[24:27], s58 offen offset:0 sc1
    v_mfma_f32_16x16x32_bf16 v[40:43], a[72:75], v[144:147], v[40:43]
    v_mfma_f32_16x16x32_bf16 v[44:47], a[76:79], v[144:147], v[44:47]
    s_add_u32 m0, s52, 81920
    s_lshl_b32 s57, s76, 7
    buffer_load_dwordx4 v12, s[20:23], s57 offen offset:0 lds
    s_waitcnt vmcnt(11)
    v_mfma_f32_16x16x32_bf16 v[32:35], a[80:83], v[148:151], v[32:35]
    s_waitcnt lgkmcnt(0)
    s_barrier
    v_mfma_f32_16x16x32_bf16 v[36:39], a[84:87], v[148:151], v[36:39]
    v_mfma_f32_16x16x32_bf16 v[40:43], a[88:91], v[148:151], v[40:43]
    v_mfma_f32_16x16x32_bf16 v[44:47], a[92:95], v[148:151], v[44:47]
    s_add_u32 s57, s57, 31744
    buffer_load_dwordx4 v12, s[20:23], s57 offen offset:1024 lds
    s_waitcnt vmcnt(11)
    v_mfma_f32_16x16x32_bf16 v[32:35], a[96:99], v[152:155], v[32:35]
    ds_read_b128 v[160:163], v233 offset:0
    v_mfma_f32_16x16x32_bf16 v[36:39], a[100:103], v[152:155], v[36:39]
    ds_read_b128 v[176:179], v234 offset:16384
    v_mfma_f32_16x16x32_bf16 v[40:43], a[104:107], v[152:155], v[40:43]
    ds_read_b128 v[192:195], v235 offset:32768
    v_mfma_f32_16x16x32_bf16 v[44:47], a[108:111], v[152:155], v[44:47]
    s_add_u32 s57, s57, 31744
    buffer_load_dwordx4 v12, s[20:23], s57 offen offset:2048 lds
    s_waitcnt vmcnt(11)
    v_mfma_f32_16x16x32_bf16 v[32:35], a[112:115], v[156:159], v[32:35]
    ds_read_b128 v[164:167], v233 offset:1024
    v_mfma_f32_16x16x32_bf16 v[36:39], a[116:119], v[156:159], v[36:39]
    ds_read_b128 v[180:183], v234 offset:17408
    v_mfma_f32_16x16x32_bf16 v[40:43], a[120:123], v[156:159], v[40:43]
    ds_read_b128 v[196:199], v235 offset:33792
    v_mfma_f32_16x16x32_bf16 v[44:47], a[124:127], v[156:159], v[44:47]
    s_add_u32 s57, s57, 31744
    buffer_load_dwordx4 v12, s[20:23], s57 offen offset:3072 lds
    s_waitcnt vmcnt(11)
    v_mfma_f32_16x16x32_bf16 v[32:35], a[128:131], v[112:115], v[32:35]
    ds_read_b128 v[168:171], v233 offset:2048
    v_mfma_f32_16x16x32_bf16 v[36:39], a[132:135], v[112:115], v[36:39]
    ds_read_b128 v[184:187], v234 offset:18432
    v_mfma_f32_16x16x32_bf16 v[40:43], a[136:139], v[112:115], v[40:43]
    ds_read_b128 v[200:203], v235 offset:34816
    v_mfma_f32_16x16x32_bf16 v[44:47], a[140:143], v[112:115], v[44:47]
    s_add_u32 m0, s52, 98304
    s_lshl_b32 s57, s76, 7
    s_add_u32 s57, s57, 131072
    buffer_load_dwordx4 v12, s[20:23], s57 offen offset:0 lds
    s_waitcnt vmcnt(11)
    v_mfma_f32_16x16x32_bf16 v[32:35], a[144:147], v[116:119], v[32:35]
    ds_read_b128 v[172:175], v233 offset:3072
    v_mfma_f32_16x16x32_bf16 v[36:39], a[148:151], v[116:119], v[36:39]
    ds_read_b128 v[188:191], v234 offset:19456
    v_mfma_f32_16x16x32_bf16 v[40:43], a[152:155], v[116:119], v[40:43]
    ds_read_b128 v[204:207], v235 offset:35840
    v_mfma_f32_16x16x32_bf16 v[44:47], a[156:159], v[116:119], v[44:47]
    s_add_u32 s57, s57, 31744
    buffer_load_dwordx4 v12, s[20:23], s57 offen offset:1024 lds
    s_waitcnt vmcnt(11)
    v_mfma_f32_16x16x32_bf16 v[32:35], a[160:163], v[120:123], v[32:35]
    v_mfma_f32_16x16x32_bf16 v[36:39], a[164:167], v[120:123], v[36:39]
    v_mfma_f32_16x16x32_bf16 v[40:43], a[168:171], v[120:123], v[40:43]
    v_mfma_f32_16x16x32_bf16 v[44:47], a[172:175], v[120:123], v[44:47]
    s_add_u32 s57, s57, 31744
    buffer_load_dwordx4 v12, s[20:23], s57 offen offset:2048 lds
    s_waitcnt vmcnt(11)
    v_mfma_f32_16x16x32_bf16 v[32:35], a[176:179], v[124:127], v[32:35]
    s_waitcnt lgkmcnt(9)
    v_mfma_f32_16x16x32_bf16 v[36:39], a[180:183], v[124:127], v[36:39]
    v_add_f32 v160, v160, v176
    v_mfma_f32_16x16x32_bf16 v[40:43], a[184:187], v[124:127], v[40:43]
    v_add_f32 v161, v161, v177
    v_mfma_f32_16x16x32_bf16 v[44:47], a[188:191], v[124:127], v[44:47]
    v_add_f32 v162, v162, v178
    s_add_u32 s57, s57, 31744
    buffer_load_dwordx4 v12, s[20:23], s57 offen offset:3072 lds
    s_waitcnt vmcnt(11)
    v_mfma_f32_16x16x32_bf16 v[32:35], a[192:195], v[128:131], v[32:35]
    v_add_f32 v163, v163, v179
    v_mfma_f32_16x16x32_bf16 v[36:39], a[196:199], v[128:131], v[36:39]
    s_waitcnt lgkmcnt(6)
    v_mfma_f32_16x16x32_bf16 v[40:43], a[200:203], v[128:131], v[40:43]
    v_add_f32 v164, v164, v180
    v_mfma_f32_16x16x32_bf16 v[44:47], a[204:207], v[128:131], v[44:47]
    v_add_f32 v165, v165, v181
    s_add_u32 m0, s52, 114688
    s_lshl_b32 s57, s77, 7
    buffer_load_dwordx4 v12, s[20:23], s57 offen offset:0 lds
    s_waitcnt vmcnt(11)
    v_mfma_f32_16x16x32_bf16 v[32:35], a[208:211], v[132:135], v[32:35]
    v_add_f32 v166, v166, v182
    v_mfma_f32_16x16x32_bf16 v[36:39], a[212:215], v[132:135], v[36:39]
    v_add_f32 v167, v167, v183
    v_mfma_f32_16x16x32_bf16 v[40:43], a[216:219], v[132:135], v[40:43]
    s_waitcnt lgkmcnt(3)
    v_mfma_f32_16x16x32_bf16 v[44:47], a[220:223], v[132:135], v[44:47]
    v_add_f32 v168, v168, v184
    s_add_u32 s57, s57, 31744
    buffer_load_dwordx4 v12, s[20:23], s57 offen offset:1024 lds
    s_waitcnt vmcnt(11)
    v_mfma_f32_16x16x32_bf16 v[32:35], a[224:227], v[136:139], v[32:35]
    v_add_f32 v169, v169, v185
    v_mfma_f32_16x16x32_bf16 v[36:39], a[228:231], v[136:139], v[36:39]
    v_add_f32 v170, v170, v186
    v_mfma_f32_16x16x32_bf16 v[40:43], a[232:235], v[136:139], v[40:43]
    v_add_f32 v171, v171, v187
    v_mfma_f32_16x16x32_bf16 v[44:47], a[236:239], v[136:139], v[44:47]
    s_waitcnt lgkmcnt(0)
    s_add_u32 s57, s57, 31744
    buffer_load_dwordx4 v12, s[20:23], s57 offen offset:2048 lds
    s_waitcnt vmcnt(11)
    v_mfma_f32_16x16x32_bf16 v[32:35], a[240:243], v[140:143], v[32:35]
    v_add_f32 v172, v172, v188
    v_mfma_f32_16x16x32_bf16 v[36:39], a[244:247], v[140:143], v[36:39]
    v_add_f32 v173, v173, v189
    v_mfma_f32_16x16x32_bf16 v[40:43], a[248:251], v[140:143], v[40:43]
    v_add_f32 v174, v174, v190
    v_mfma_f32_16x16x32_bf16 v[44:47], a[252:255], v[140:143], v[44:47]
    v_add_f32 v175, v175, v191
    v_pk_add_f32 v[160:161], v[160:161], v[192:193]
    v_pk_add_f32 v[162:163], v[162:163], v[194:195]
    v_pk_add_f32 v[164:165], v[164:165], v[196:197]
    v_pk_add_f32 v[166:167], v[166:167], v[198:199]
    v_pk_add_f32 v[168:169], v[168:169], v[200:201]
    v_pk_add_f32 v[170:171], v[170:171], v[202:203]
    v_pk_add_f32 v[172:173], v[172:173], v[204:205]
    v_pk_add_f32 v[174:175], v[174:175], v[206:207]
    buffer_store_dwordx4 v[96:99], v23, s[24:27], s83 offen sc1
    s_add_u32 s57, s57, 31744
    buffer_load_dwordx4 v12, s[20:23], s57 offen offset:3072 lds
    v_pk_add_f32 v[32:33], v[32:33], v[160:161]
    v_pk_add_f32 v[34:35], v[34:35], v[162:163]
    v_pk_add_f32 v[36:37], v[36:37], v[164:165]
    v_pk_add_f32 v[38:39], v[38:39], v[166:167]
    v_pk_mul_f32 v[48:49], v[32:33], v[32:33]
    v_pk_mul_f32 v[50:51], v[34:35], v[34:35]
    v_pk_mul_f32 v[52:53], v[36:37], v[36:37]
    v_pk_mul_f32 v[54:55], v[38:39], v[38:39]
    s_add_u32 m0, s52, 131072
    s_lshl_b32 s57, s77, 7
    s_add_u32 s57, s57, 131072
    buffer_load_dwordx4 v12, s[20:23], s57 offen offset:0 lds
    v_pk_fma_f32 v[48:49], v[48:49], v[236:237], v[236:237] op_sel:[0,0,1] op_sel_hi:[1,0,1]
    v_pk_fma_f32 v[50:51], v[50:51], v[236:237], v[236:237] op_sel:[0,0,1] op_sel_hi:[1,0,1]
    v_pk_fma_f32 v[52:53], v[52:53], v[236:237], v[236:237] op_sel:[0,0,1] op_sel_hi:[1,0,1]
    v_pk_fma_f32 v[54:55], v[54:55], v[236:237], v[236:237] op_sel:[0,0,1] op_sel_hi:[1,0,1]
    v_pk_mul_f32 v[48:49], v[48:49], v[32:33]
    v_pk_mul_f32 v[50:51], v[50:51], v[34:35]
    v_pk_mul_f32 v[52:53], v[52:53], v[36:37]
    v_pk_mul_f32 v[54:55], v[54:55], v[38:39]
    s_add_u32 s57, s57, 31744
    buffer_load_dwordx4 v12, s[20:23], s57 offen offset:1024 lds
    s_waitcnt vmcnt(11)
    ds_read_b64_tr_b16 a[0:1], v6 offset:32768
    ds_read_b64_tr_b16 a[2:3], v6 offset:34816
    ds_read_b64_tr_b16 a[4:5], v7 offset:32768
    ds_read_b64_tr_b16 a[6:7], v7 offset:34816
    v_exp_f32 v48, v48
    v_exp_f32 v49, v49
    v_exp_f32 v50, v50
    v_exp_f32 v51, v51
    ds_read_b64_tr_b16 a[8:9], v6 offset:33024
    ds_read_b64_tr_b16 a[10:11], v6 offset:35072
    ds_read_b64_tr_b16 a[12:13], v7 offset:33024
    ds_read_b64_tr_b16 a[14:15], v7 offset:35072
    s_add_u32 s57, s57, 31744
    buffer_load_dwordx4 v12, s[20:23], s57 offen offset:2048 lds
    v_exp_f32 v52, v52
    v_exp_f32 v53, v53
    v_exp_f32 v54, v54
    v_exp_f32 v55, v55
    v_pk_add_f32 v[48:49], v[48:49], 1.0 op_sel_hi:[1,0]
    v_pk_add_f32 v[50:51], v[50:51], 1.0 op_sel_hi:[1,0]
    v_pk_add_f32 v[52:53], v[52:53], 1.0 op_sel_hi:[1,0]
    v_pk_add_f32 v[54:55], v[54:55], 1.0 op_sel_hi:[1,0]
    s_add_u32 s57, s57, 31744
    buffer_load_dwordx4 v12, s[20:23], s57 offen offset:3072 lds
    v_rcp_f32 v48, v48
    v_rcp_f32 v49, v49
    v_rcp_f32 v50, v50
    v_rcp_f32 v51, v51
    v_rcp_f32 v52, v52
    v_rcp_f32 v53, v53
    v_rcp_f32 v54, v54
    v_rcp_f32 v55, v55
    v_pk_mul_f32 v[48:49], v[48:49], v[32:33]
    v_pk_mul_f32 v[50:51], v[50:51], v[34:35]
    v_pk_mul_f32 v[52:53], v[52:53], v[36:37]
    v_pk_mul_f32 v[54:55], v[54:55], v[38:39]
    s_add_u32 m0, s52, 147456
    s_lshl_b32 s57, s78, 7
    buffer_load_dwordx4 v12, s[20:23], s57 offen offset:0 lds
    v_cvt_pk_bf16_f32 v56, v48, v49
    v_cvt_pk_bf16_f32 v57, v50, v51
    v_cvt_pk_bf16_f32 v58, v52, v53
    v_cvt_pk_bf16_f32 v59, v54, v55
    buffer_store_dwordx4 v[56:59], v23, s[24:27], s67 offen offset:0 sc1
    v_pk_add_f32 v[40:41], v[40:41], v[168:169]
    v_pk_add_f32 v[42:43], v[42:43], v[170:171]
    v_pk_add_f32 v[44:45], v[44:45], v[172:173]
    v_pk_add_f32 v[46:47], v[46:47], v[174:175]
    s_add_u32 s57, s57, 31744
    buffer_load_dwordx4 v12, s[20:23], s57 offen offset:1024 lds
    s_waitcnt vmcnt(12)
    ds_read_b64_tr_b16 a[16:17], v6 offset:49152
    ds_read_b64_tr_b16 a[18:19], v6 offset:51200
    ds_read_b64_tr_b16 a[20:21], v7 offset:49152
    ds_read_b64_tr_b16 a[22:23], v7 offset:51200
    v_pk_mul_f32 v[48:49], v[40:41], v[40:41]
    v_pk_mul_f32 v[50:51], v[42:43], v[42:43]
    v_pk_mul_f32 v[52:53], v[44:45], v[44:45]
    v_pk_mul_f32 v[54:55], v[46:47], v[46:47]
    ds_read_b64_tr_b16 a[24:25], v6 offset:49408
    ds_read_b64_tr_b16 a[26:27], v6 offset:51456
    ds_read_b64_tr_b16 a[28:29], v7 offset:49408
    ds_read_b64_tr_b16 a[30:31], v7 offset:51456
    s_add_u32 s57, s57, 31744
    buffer_load_dwordx4 v12, s[20:23], s57 offen offset:2048 lds
    v_pk_fma_f32 v[48:49], v[48:49], v[236:237], v[236:237] op_sel:[0,0,1] op_sel_hi:[1,0,1]
    v_pk_fma_f32 v[50:51], v[50:51], v[236:237], v[236:237] op_sel:[0,0,1] op_sel_hi:[1,0,1]
    v_pk_fma_f32 v[52:53], v[52:53], v[236:237], v[236:237] op_sel:[0,0,1] op_sel_hi:[1,0,1]
    v_pk_fma_f32 v[54:55], v[54:55], v[236:237], v[236:237] op_sel:[0,0,1] op_sel_hi:[1,0,1]
    v_pk_mul_f32 v[48:49], v[48:49], v[40:41]
    v_pk_mul_f32 v[50:51], v[50:51], v[42:43]
    v_pk_mul_f32 v[52:53], v[52:53], v[44:45]
    v_pk_mul_f32 v[54:55], v[54:55], v[46:47]
    s_add_u32 s57, s57, 31744
    buffer_load_dwordx4 v12, s[20:23], s57 offen offset:3072 lds
    v_exp_f32 v48, v48
    v_exp_f32 v49, v49
    v_exp_f32 v50, v50
    v_exp_f32 v51, v51
    v_exp_f32 v52, v52
    v_exp_f32 v53, v53
    v_exp_f32 v54, v54
    v_exp_f32 v55, v55
    v_pk_add_f32 v[48:49], v[48:49], 1.0 op_sel_hi:[1,0]
    v_pk_add_f32 v[50:51], v[50:51], 1.0 op_sel_hi:[1,0]
    v_pk_add_f32 v[52:53], v[52:53], 1.0 op_sel_hi:[1,0]
    v_pk_add_f32 v[54:55], v[54:55], 1.0 op_sel_hi:[1,0]
    s_add_u32 m0, s52, 49152
    s_lshl_b32 s57, s78, 7
    s_add_u32 s57, s57, 131072
    buffer_load_dwordx4 v12, s[20:23], s57 offen offset:0 lds
    v_rcp_f32 v48, v48
    v_rcp_f32 v49, v49
    v_rcp_f32 v50, v50
    v_rcp_f32 v51, v51
    v_rcp_f32 v52, v52
    v_rcp_f32 v53, v53
    v_rcp_f32 v54, v54
    v_rcp_f32 v55, v55
    s_add_u32 s57, s57, 31744
    buffer_load_dwordx4 v12, s[20:23], s57 offen offset:1024 lds
    s_waitcnt vmcnt(11)
    ds_read_b64_tr_b16 a[32:33], v8 offset:0
    ds_read_b64_tr_b16 a[34:35], v8 offset:2048
    ds_read_b64_tr_b16 a[36:37], v9 offset:0
    ds_read_b64_tr_b16 a[38:39], v9 offset:2048
    v_pk_mul_f32 v[48:49], v[48:49], v[40:41]
    v_pk_mul_f32 v[50:51], v[50:51], v[42:43]
    v_pk_mul_f32 v[52:53], v[52:53], v[44:45]
    v_pk_mul_f32 v[54:55], v[54:55], v[46:47]
    ds_read_b64_tr_b16 a[40:41], v8 offset:256
    ds_read_b64_tr_b16 a[42:43], v8 offset:2304
    ds_read_b64_tr_b16 a[44:45], v9 offset:256
    ds_read_b64_tr_b16 a[46:47], v9 offset:2304
    s_add_u32 s57, s57, 31744
    buffer_load_dwordx4 v12, s[20:23], s57 offen offset:2048 lds
    v_cvt_pk_bf16_f32 v60, v48, v49
    v_cvt_pk_bf16_f32 v61, v50, v51
    v_cvt_pk_bf16_f32 v62, v52, v53
    v_cvt_pk_bf16_f32 v63, v54, v55
    buffer_store_dwordx4 v[60:63], v23, s[24:27], s67 offen offset:1024 sc1
    s_add_u32 s57, s57, 31744
    buffer_load_dwordx4 v12, s[20:23], s57 offen offset:3072 lds
    s_add_u32 m0, s52, 65536
    s_lshl_b32 s57, s79, 7
    buffer_load_dwordx4 v12, s[20:23], s57 offen offset:0 lds
    s_add_u32 s57, s57, 31744
    buffer_load_dwordx4 v12, s[20:23], s57 offen offset:1024 lds
    s_waitcnt vmcnt(12)
    ds_read_b64_tr_b16 a[48:49], v8 offset:16384
    ds_read_b64_tr_b16 a[50:51], v8 offset:18432
    ds_read_b64_tr_b16 a[52:53], v9 offset:16384
    ds_read_b64_tr_b16 a[54:55], v9 offset:18432
    s_add_u32 s57, s57, 31744
    buffer_load_dwordx4 v12, s[20:23], s57 offen offset:2048 lds
    ds_read_b64_tr_b16 a[56:57], v8 offset:16640
    ds_read_b64_tr_b16 a[58:59], v8 offset:18688
    ds_read_b64_tr_b16 a[60:61], v9 offset:16640
    ds_read_b64_tr_b16 a[62:63], v9 offset:18688
    s_add_u32 s57, s57, 31744
    buffer_load_dwordx4 v12, s[20:23], s57 offen offset:3072 lds
    s_waitcnt lgkmcnt(15)
    s_add_u32 m0, s52, 81920
    s_lshl_b32 s57, s79, 7
    s_add_u32 s57, s57, 131072
    buffer_load_dwordx4 v12, s[20:23], s57 offen offset:0 lds
    s_add_u32 s57, s57, 31744
    buffer_load_dwordx4 v12, s[20:23], s57 offen offset:1024 lds
    s_waitcnt vmcnt(11)
    ds_read_b64_tr_b16 a[64:65], v8 offset:32768
    ds_read_b64_tr_b16 a[66:67], v8 offset:34816
    ds_read_b64_tr_b16 a[68:69], v9 offset:32768
    ds_read_b64_tr_b16 a[70:71], v9 offset:34816
    s_add_u32 s57, s57, 31744
    buffer_load_dwordx4 v12, s[20:23], s57 offen offset:2048 lds
    ds_read_b64_tr_b16 a[72:73], v8 offset:33024
    ds_read_b64_tr_b16 a[74:75], v8 offset:35072
    ds_read_b64_tr_b16 a[76:77], v9 offset:33024
    ds_read_b64_tr_b16 a[78:79], v9 offset:35072
    s_add_u32 s57, s57, 31744
    buffer_load_dwordx4 v12, s[20:23], s57 offen offset:3072 lds
    s_add_u32 m0, s52, 98304
    s_lshl_b32 s57, s80, 7
    buffer_load_dwordx4 v12, s[20:23], s57 offen offset:0 lds
    s_waitcnt vmcnt(10)
    s_barrier
    s_cmp_lg_u32 s44, 0
    s_cbranch_scc1 L_nopub6
    s_lshl_b32 s60, s51, 5
    s_add_u32 s60, s60, s50
    s_lshl_b32 s60, s60, 7
    s_add_u32 s60, s60, 12713984
    v_mov_b32 v30, s47
    s_mov_b64 exec, 1
    buffer_store_dword v30, off, s[24:27], s60 sc1
    s_mov_b64 exec, -1
L_nopub6:
L_p3join:
    v_lshlrev_b32 v228, 16, v228
    v_lshlrev_b32 v32, 16, v216
    v_and_b32 v33, s61, v216
    v_lshlrev_b32 v34, 16, v217
    s_add_u32 s57, s57, 31744
    buffer_load_dwordx4 v12, s[20:23], s57 offen offset:1024 lds
    s_waitcnt vmcnt(10)
    ds_read_b64_tr_b16 a[80:81], v6 offset:0
    ds_read_b64_tr_b16 a[82:83], v6 offset:2048
    ds_read_b64_tr_b16 a[84:85], v7 offset:0
    ds_read_b64_tr_b16 a[86:87], v7 offset:2048
    s_add_u32 s57, s57, 31744
    buffer_load_dwordx4 v12, s[20:23], s57 offen offset:2048 lds
    ds_read_b64_tr_b16 a[88:89], v6 offset:256
    ds_read_b64_tr_b16 a[90:91], v6 offset:2304
    ds_read_b64_tr_b16 a[92:93], v7 offset:256
    ds_read_b64_tr_b16 a[94:95], v7 offset:2304
    s_add_u32 s57, s57, 31744
    buffer_load_dwordx4 v12, s[20:23], s57 offen offset:3072 lds
    v_and_b32 v35, s61, v217
    v_add_f32 v32, v32, v228
    v_add_f32 v33, v33, v228
    v_add_f32 v34, v34, v228
    v_add_f32 v35, v35, v228
    v_lshlrev_b32 v48, 16, v218
    v_and_b32 v49, s61, v218
    v_lshlrev_b32 v50, 16, v219
    s_waitcnt lgkmcnt(15)
    s_add_u32 m0, s52, 114688
    s_lshl_b32 s57, s80, 7
    s_add_u32 s57, s57, 131072
    buffer_load_dwordx4 v12, s[20:23], s57 offen offset:0 lds
    v_and_b32 v51, s61, v219
    v_add_f32 v48, v48, v228
    v_add_f32 v49, v49, v228
    v_add_f32 v50, v50, v228
    s_add_u32 s57, s57, 31744
    buffer_load_dwordx4 v12, s[20:23], s57 offen offset:1024 lds
    s_waitcnt vmcnt(10)
    ds_read_b64_tr_b16 a[96:97], v6 offset:16384
    ds_read_b64_tr_b16 a[98:99], v6 offset:18432
    ds_read_b64_tr_b16 a[100:101], v7 offset:16384
    ds_read_b64_tr_b16 a[102:103], v7 offset:18432
    s_add_u32 s57, s57, 31744
    buffer_load_dwordx4 v12, s[20:23], s57 offen offset:2048 lds
    ds_read_b64_tr_b16 a[104:105], v6 offset:16640
    ds_read_b64_tr_b16 a[106:107], v6 offset:18688
    ds_read_b64_tr_b16 a[108:109], v7 offset:16640
    ds_read_b64_tr_b16 a[110:111], v7 offset:18688
    v_add_f32 v51, v51, v228
    v_lshlrev_b32 v64, 16, v220
    v_and_b32 v65, s61, v220
    v_lshlrev_b32 v66, 16, v221
    s_add_u32 s57, s57, 31744
    buffer_load_dwordx4 v12, s[20:23], s57 offen offset:3072 lds
    v_and_b32 v67, s61, v221
    v_add_f32 v64, v64, v228
    v_add_f32 v65, v65, v228
    v_add_f32 v66, v66, v228
    s_add_u32 m0, s52, 131072
    s_lshl_b32 s57, s81, 7
    buffer_load_dwordx4 v12, s[20:23], s57 offen offset:0 lds
    v_add_f32 v67, v67, v228
    v_lshlrev_b32 v80, 16, v222
    v_and_b32 v81, s61, v222
    v_lshlrev_b32 v82, 16, v223
    s_add_u32 s57, s57, 31744
    buffer_load_dwordx4 v12, s[20:23], s57 offen offset:1024 lds
    s_waitcnt vmcnt(10)
    ds_read_b64_tr_b16 a[112:113], v6 offset:32768
    ds_read_b64_tr_b16 a[114:115], v6 offset:34816
    ds_read_b64_tr_b16 a[116:117], v7 offset:32768
    ds_read_b64_tr_b16 a[118:119], v7 offset:34816
    v_and_b32 v83, s61, v223
    v_add_f32 v80, v80, v228
    v_add_f32 v81, v81, v228
    v_add_f32 v82, v82, v228
    ds_read_b64_tr_b16 a[120:121], v6 offset:33024
    ds_read_b64_tr_b16 a[122:123], v6 offset:35072
    ds_read_b64_tr_b16 a[124:125], v7 offset:33024
    ds_read_b64_tr_b16 a[126:127], v7 offset:35072
    s_add_u32 s57, s57, 31744
    buffer_load_dwordx4 v12, s[20:23], s57 offen offset:2048 lds
    v_add_f32 v83, v83, v228
    v_lshlrev_b32 v96, 16, v224
    v_and_b32 v97, s61, v224
    v_lshlrev_b32 v98, 16, v225
    s_add_u32 s57, s57, 31744
    buffer_load_dwordx4 v12, s[20:23], s57 offen offset:3072 lds
    v_and_b32 v99, s61, v225
    v_add_f32 v96, v96, v228
    v_add_f32 v97, v97, v228
    v_add_f32 v98, v98, v228
    s_waitcnt lgkmcnt(15)
    s_add_u32 m0, s52, 147456
    s_lshl_b32 s57, s81, 7
    s_add_u32 s57, s57, 131072
    buffer_load_dwordx4 v12, s[20:23], s57 offen offset:0 lds
    v_add_f32 v99, v99, v228
    s_add_u32 s57, s57, 31744
    buffer_load_dwordx4 v12, s[20:23], s57 offen offset:1024 lds
    s_waitcnt vmcnt(10)
    ds_read_b64_tr_b16 a[128:129], v6 offset:49152
    ds_read_b64_tr_b16 a[130:131], v6 offset:51200
    ds_read_b64_tr_b16 a[132:133], v7 offset:49152
    ds_read_b64_tr_b16 a[134:135], v7 offset:51200
    s_add_u32 s57, s57, 31744
    buffer_load_dwordx4 v12, s[20:23], s57 offen offset:2048 lds
    ds_read_b64_tr_b16 a[136:137], v6 offset:49408
    ds_read_b64_tr_b16 a[138:139], v6 offset:51456
    ds_read_b64_tr_b16 a[140:141], v7 offset:49408
    ds_read_b64_tr_b16 a[142:143], v7 offset:51456
    s_add_u32 s57, s57, 31744
    buffer_load_dwordx4 v12, s[20:23], s57 offen offset:3072 lds
    s_add_u32 m0, s52, 49152
    s_lshl_b32 s57, s82, 7
    buffer_load_dwordx4 v12, s[20:23], s57 offen offset:0 lds
    s_add_u32 s57, s57, 31744
    buffer_load_dwordx4 v12, s[20:23], s57 offen offset:1024 lds
    s_waitcnt vmcnt(10)
    ds_read_b64_tr_b16 a[144:145], v8 offset:0
    ds_read_b64_tr_b16 a[146:147], v8 offset:2048
    ds_read_b64_tr_b16 a[148:149], v9 offset:0
    ds_read_b64_tr_b16 a[150:151], v9 offset:2048
    s_add_u32 s57, s57, 31744
    buffer_load_dwordx4 v12, s[20:23], s57 offen offset:2048 lds
    ds_read_b64_tr_b16 a[152:153], v8 offset:256
    ds_read_b64_tr_b16 a[154:155], v8 offset:2304
    ds_read_b64_tr_b16 a[156:157], v9 offset:256
    ds_read_b64_tr_b16 a[158:159], v9 offset:2304
    s_add_u32 s57, s57, 31744
    buffer_load_dwordx4 v12, s[20:23], s57 offen offset:3072 lds
    s_waitcnt lgkmcnt(15)
    s_add_u32 m0, s52, 65536
    s_lshl_b32 s57, s82, 7
    s_add_u32 s57, s57, 131072
    buffer_load_dwordx4 v12, s[20:23], s57 offen offset:0 lds
    s_add_u32 s57, s57, 31744
    buffer_load_dwordx4 v12, s[20:23], s57 offen offset:1024 lds
    s_waitcnt vmcnt(10)
    ds_read_b64_tr_b16 a[160:161], v8 offset:16384
    ds_read_b64_tr_b16 a[162:163], v8 offset:18432
    ds_read_b64_tr_b16 a[164:165], v9 offset:16384
    ds_read_b64_tr_b16 a[166:167], v9 offset:18432
    s_add_u32 s57, s57, 31744
    buffer_load_dwordx4 v12, s[20:23], s57 offen offset:2048 lds
    ds_read_b64_tr_b16 a[168:169], v8 offset:16640
    ds_read_b64_tr_b16 a[170:171], v8 offset:18688
    ds_read_b64_tr_b16 a[172:173], v9 offset:16640
    ds_read_b64_tr_b16 a[174:175], v9 offset:18688
    s_add_u32 s57, s57, 31744
    buffer_load_dwordx4 v12, s[20:23], s57 offen offset:3072 lds
    s_add_u32 m0, s52, 81920
    s_mov_b32 s57, s75
    buffer_load_dwordx4 v15, s[12:15], s57 offen offset:0 lds
    s_add_u32 s57, s57, 24064
    buffer_load_dwordx4 v15, s[12:15], s57 offen offset:1024 lds
    s_waitcnt vmcnt(10)
    ds_read_b64_tr_b16 a[176:177], v8 offset:32768
    ds_read_b64_tr_b16 a[178:179], v8 offset:34816
    ds_read_b64_tr_b16 a[180:181], v9 offset:32768
    ds_read_b64_tr_b16 a[182:183], v9 offset:34816
    s_add_u32 s57, s57, 24064
    buffer_load_dwordx4 v15, s[12:15], s57 offen offset:2048 lds
    ds_read_b64_tr_b16 a[184:185], v8 offset:33024
    ds_read_b64_tr_b16 a[186:187], v8 offset:35072
    ds_read_b64_tr_b16 a[188:189], v9 offset:33024
    ds_read_b64_tr_b16 a[190:191], v9 offset:35072
    s_add_u32 s57, s57, 24064
    buffer_load_dwordx4 v15, s[12:15], s57 offen offset:3072 lds
    s_waitcnt lgkmcnt(15)
    s_add_u32 m0, s52, 98304
    s_mov_b32 s57, 0
    buffer_load_dwordx4 v13, s[12:15], s57 offen offset:0 lds
    s_add_u32 s57, s57, 6144
    buffer_load_dwordx4 v14, s[12:15], s57 offen offset:1024 lds
    s_waitcnt vmcnt(10)
    ds_read_b64_tr_b16 a[192:193], v6 offset:0
    ds_read_b64_tr_b16 a[194:195], v6 offset:2048
    ds_read_b64_tr_b16 a[196:197], v7 offset:0
    ds_read_b64_tr_b16 a[198:199], v7 offset:2048
    s_add_u32 s57, s57, 6144
    buffer_load_dwordx4 v13, s[12:15], s57 offen offset:2048 lds
    ds_read_b64_tr_b16 a[200:201], v6 offset:256
    ds_read_b64_tr_b16 a[202:203], v6 offset:2304
    ds_read_b64_tr_b16 a[204:205], v7 offset:256
    ds_read_b64_tr_b16 a[206:207], v7 offset:2304
    s_add_u32 s57, s57, 6144
    buffer_load_dwordx4 v14, s[12:15], s57 offen offset:3072 lds
    s_add_u32 m0, s52, 114688
    s_mov_b32 s57, 25088
    buffer_load_dwordx4 v13, s[12:15], s57 offen offset:0 lds
    s_add_u32 s57, s57, 6144
    buffer_load_dwordx4 v14, s[12:15], s57 offen offset:1024 lds
    s_waitcnt vmcnt(10)
    ds_read_b64_tr_b16 a[208:209], v6 offset:16384
    ds_read_b64_tr_b16 a[210:211], v6 offset:18432
    ds_read_b64_tr_b16 a[212:213], v7 offset:16384
    ds_read_b64_tr_b16 a[214:215], v7 offset:18432
    buffer_load_dword v17, v20, s[24:27], 0 offen sc1
    ds_read_b64_tr_b16 a[216:217], v6 offset:16640
    ds_read_b64_tr_b16 a[218:219], v6 offset:18688
    ds_read_b64_tr_b16 a[220:221], v7 offset:16640
    ds_read_b64_tr_b16 a[222:223], v7 offset:18688
    s_add_u32 s57, s57, 6144
    buffer_load_dwordx4 v13, s[12:15], s57 offen offset:2048 lds
    s_add_u32 s57, s57, 6144
    buffer_load_dwordx4 v14, s[12:15], s57 offen offset:3072 lds
    s_waitcnt lgkmcnt(15)
    s_add_u32 m0, s52, 131072
    s_mov_b32 s57, 50176
    buffer_load_dwordx4 v13, s[12:15], s57 offen offset:0 lds
    s_add_u32 s57, s57, 6144
    buffer_load_dwordx4 v14, s[12:15], s57 offen offset:1024 lds
    s_add_u32 s57, s57, 6144
    buffer_load_dwordx4 v13, s[12:15], s57 offen offset:2048 lds
    s_add_u32 s57, s57, 6144
    buffer_load_dwordx4 v14, s[12:15], s57 offen offset:3072 lds
    s_add_u32 m0, s52, 147456
    s_mov_b32 s57, 75264
    buffer_load_dwordx4 v13, s[12:15], s57 offen offset:0 lds
    s_add_u32 s57, s57, 6144
    buffer_load_dwordx4 v14, s[12:15], s57 offen offset:1024 lds
    s_add_u32 s57, s57, 6144
    buffer_load_dwordx4 v13, s[12:15], s57 offen offset:2048 lds
    s_add_u32 s57, s57, 6144
    buffer_load_dwordx4 v14, s[12:15], s57 offen offset:3072 lds
    s_waitcnt vmcnt(10)
    v_cmp_ne_u32 vcc, s47, v17
    s_nop 0
    s_cbranch_vccz L_ok8
    s_mov_b32 s59, 20000
L_spin7:
    buffer_load_dword v17, v20, s[24:27], 0 offen sc1
    s_waitcnt vmcnt(0)
    v_cmp_ne_u32 vcc, s47, v17
    s_nop 0
    s_cbranch_vccz L_ok8
    s_sub_u32 s59, s59, 1
    s_cbranch_scc0 L_spin7
L_ok8:
    s_cmp_ge_u32 s89, 4
    s_cbranch_scc1 L_p3_alt
    s_mov_b32 s66, s68
    s_add_u32 s58, s66, s76
    buffer_load_dwordx4 v[144:147], v23, s[24:27], s58 offen offset:0 sc1
    buffer_load_dwordx4 v[148:151], v23, s[24:27], s58 offen offset:1024 sc1
    s_add_u32 s58, s66, s77
    buffer_load_dwordx4 v[152:155], v23, s[24:27], s58 offen offset:0 sc1
    buffer_load_dwordx4 v[156:159], v23, s[24:27], s58 offen offset:1024 sc1
    s_add_u32 s58, s66, s78
    buffer_load_dwordx4 v[112:115], v23, s[24:27], s58 offen offset:0 sc1
    buffer_load_dwordx4 v[116:119], v23, s[24:27], s58 offen offset:1024 sc1
    s_add_u32 s58, s66, s79
    buffer_load_dwordx4 v[120:123], v23, s[24:27], s58 offen offset:0 sc1
    buffer_load_dwordx4 v[124:127], v23, s[24:27], s58 offen offset:1024 sc1
    s_add_u32 s58, s66, s80
    buffer_load_dwordx4 v[128:131], v23, s[24:27], s58 offen offset:0 sc1
    buffer_load_dwordx4 v[132:135], v23, s[24:27], s58 offen offset:1024 sc1
    s_add_u32 s58, s66, s81
    buffer_load_dwordx4 v[136:139], v23, s[24:27], s58 offen offset:0 sc1
    s_waitcnt vmcnt(10)
    v_mfma_f32_16x16x32_bf16 v[96:99], v[144:147], a[0:3], v[96:99]
    v_mfma_f32_16x16x32_bf16 v[100:103], v[144:147], a[4:7], 0
    buffer_load_dwordx4 v[140:143], v23, s[24:27], s58 offen offset:1024 sc1
    v_mfma_f32_16x16x32_bf16 v[104:107], v[144:147], a[8:11], 0
    v_mfma_f32_16x16x32_bf16 v[108:111], v[144:147], a[12:15], 0
    s_waitcnt vmcnt(10)
    v_mfma_f32_16x16x32_bf16 v[96:99], v[148:151], a[16:19], v[96:99]
    s_add_u32 s58, s66, s82
    v_mfma_f32_16x16x32_bf16 v[100:103], v[148:151], a[20:23], v[100:103]
    buffer_load_dwordx4 v[144:147], v23, s[24:27], s58 offen offset:0 sc1
    v_mfma_f32_16x16x32_bf16 v[104:107], v[148:151], a[24:27], v[104:107]
    v_mfma_f32_16x16x32_bf16 v[108:111], v[148:151], a[28:31], v[108:111]
    s_waitcnt vmcnt(10)
    v_mfma_f32_16x16x32_bf16 v[96:99], v[152:155], a[32:35], v[96:99]
    v_mfma_f32_16x16x32_bf16 v[100:103], v[152:155], a[36:39], v[100:103]
    buffer_load_dwordx4 v[148:151], v23, s[24:27], s58 offen offset:1024 sc1
    v_mfma_f32_16x16x32_bf16 v[104:107], v[152:155], a[40:43], v[104:107]
    v_mfma_f32_16x16x32_bf16 v[108:111], v[152:155], a[44:47], v[108:111]
    s_waitcnt vmcnt(10)
    v_mfma_f32_16x16x32_bf16 v[96:99], v[156:159], a[48:51], v[96:99]
    s_add_u32 s66, s69, 175872
    s_add_u32 s58, s66, s76
    v_mfma_f32_16x16x32_bf16 v[100:103], v[156:159], a[52:55], v[100:103]
    buffer_load_dwordx4 v[152:155], v23, s[24:27], s58 offen offset:0 sc1
    v_mfma_f32_16x16x32_bf16 v[104:107], v[156:159], a[56:59], v[104:107]
    v_mfma_f32_16x16x32_bf16 v[108:111], v[156:159], a[60:63], v[108:111]
    s_waitcnt vmcnt(10)
    v_mfma_f32_16x16x32_bf16 v[96:99], v[112:115], a[64:67], v[96:99]
    v_mfma_f32_16x16x32_bf16 v[100:103], v[112:115], a[68:71], v[100:103]
    buffer_load_dwordx4 v[156:159], v23, s[24:27], s58 offen offset:1024 sc1
    v_mfma_f32_16x16x32_bf16 v[104:107], v[112:115], a[72:75], v[104:107]
    v_mfma_f32_16x16x32_bf16 v[108:111], v[112:115], a[76:79], v[108:111]
    s_waitcnt vmcnt(10)
    v_mfma_f32_16x16x32_bf16 v[96:99], v[116:119], a[80:83], v[96:99]
    s_add_u32 s58, s66, s77
    v_mfma_f32_16x16x32_bf16 v[100:103], v[116:119], a[84:87], v[100:103]
    buffer_load_dwordx4 v[112:115], v23, s[24:27], s58 offen offset:0 sc1
    v_mfma_f32_16x16x32_bf16 v[104:107], v[116:119], a[88:91], v[104:107]
    v_mfma_f32_16x16x32_bf16 v[108:111], v[116:119], a[92:95], v[108:111]
    s_waitcnt vmcnt(10)
    v_mfma_f32_16x16x32_bf16 v[96:99], v[120:123], a[96:99], v[96:99]
    v_mfma_f32_16x16x32_bf16 v[100:103], v[120:123], a[100:103], v[100:103]
    buffer_load_dwordx4 v[116:119], v23, s[24:27], s58 offen offset:1024 sc1
    v_mfma_f32_16x16x32_bf16 v[104:107], v[120:123], a[104:107], v[104:107]
    v_mfma_f32_16x16x32_bf16 v[108:111], v[120:123], a[108:111], v[108:111]
    s_waitcnt vmcnt(10)
    v_mfma_f32_16x16x32_bf16 v[96:99], v[124:127], a[112:115], v[96:99]
    s_add_u32 s58, s66, s78
    v_mfma_f32_16x16x32_bf16 v[100:103], v[124:127], a[116:119], v[100:103]
    buffer_load_dwordx4 v[120:123], v23, s[24:27], s58 offen offset:0 sc1
    v_mfma_f32_16x16x32_bf16 v[104:107], v[124:127], a[120:123], v[104:107]
    v_mfma_f32_16x16x32_bf16 v[108:111], v[124:127], a[124:127], v[108:111]
    s_waitcnt vmcnt(10)
    v_mfma_f32_16x16x32_bf16 v[96:99], v[128:131], a[128:131], v[96:99]
    v_mfma_f32_16x16x32_bf16 v[100:103], v[128:131], a[132:135], v[100:103]
    buffer_load_dwordx4 v[124:127], v23, s[24:27], s58 offen offset:1024 sc1
    v_mfma_f32_16x16x32_bf16 v[104:107], v[128:131], a[136:139], v[104:107]
    v_mfma_f32_16x16x32_bf16 v[108:111], v[128:131], a[140:143], v[108:111]
    s_waitcnt vmcnt(10)
    v_mfma_f32_16x16x32_bf16 v[96:99], v[132:135], a[144:147], v[96:99]
    s_add_u32 s58, s66, s79
    v_mfma_f32_16x16x32_bf16 v[100:103], v[132:135], a[148:151], v[100:103]
    buffer_load_dwordx4 v[128:131], v23, s[24:27], s58 offen offset:0 sc1
    v_mfma_f32_16x16x32_bf16 v[104:107], v[132:135], a[152:155], v[104:107]
    v_mfma_f32_16x16x32_bf16 v[108:111], v[132:135], a[156:159], v[108:111]
    s_waitcnt vmcnt(10)
    v_mfma_f32_16x16x32_bf16 v[96:99], v[136:139], a[160:163], v[96:99]
    v_mfma_f32_16x16x32_bf16 v[100:103], v[136:139], a[164:167], v[100:103]
    buffer_load_dwordx4 v[132:135], v23, s[24:27], s58 offen offset:1024 sc1
    v_mfma_f32_16x16x32_bf16 v[104:107], v[136:139], a[168:171], v[104:107]
    v_mfma_f32_16x16x32_bf16 v[108:111], v[136:139], a[172:175], v[108:111]
    s_waitcnt vmcnt(10)
    v_mfma_f32_16x16x32_bf16 v[96:99], v[140:143], a[176:179], v[96:99]
    s_add_u32 s58, s66, s80
    v_mfma_f32_16x16x32_bf16 v[100:103], v[140:143], a[180:183], v[100:103]
    buffer_load_dwordx4 v[136:139], v23, s[24:27], s58 offen offset:0 sc1
    v_mfma_f32_16x16x32_bf16 v[104:107], v[140:143], a[184:187], v[104:107]
    v_mfma_f32_16x16x32_bf16 v[108:111], v[140:143], a[188:191], v[108:111]
    s_waitcnt vmcnt(10)
    s_waitcnt lgkmcnt(8)
    v_mfma_f32_16x16x32_bf16 v[96:99], v[144:147], a[192:195], v[96:99]
    v_mfma_f32_16x16x32_bf16 v[100:103], v[144:147], a[196:199], v[100:103]
    buffer_load_dwordx4 v[140:143], v23, s[24:27], s58 offen offset:1024 sc1
    v_mfma_f32_16x16x32_bf16 v[104:107], v[144:147], a[200:203], v[104:107]
    v_mfma_f32_16x16x32_bf16 v[108:111], v[144:147], a[204:207], v[108:111]
    s_waitcnt vmcnt(10)
    s_waitcnt lgkmcnt(0)
    v_mfma_f32_16x16x32_bf16 v[96:99], v[148:151], a[208:211], v[96:99]
    s_add_u32 s58, s66, s81
    v_mfma_f32_16x16x32_bf16 v[100:103], v[148:151], a[212:215], v[100:103]
    buffer_load_dwordx4 v[144:147], v23, s[24:27], s58 offen offset:0 sc1
    v_mfma_f32_16x16x32_bf16 v[104:107], v[148:151], a[216:219], v[104:107]
    v_mfma_f32_16x16x32_bf16 v[108:111], v[148:151], a[220:223], v[108:111]
L_p3_join:
    s_waitcnt vmcnt(10)
    v_mfma_f32_16x16x32_bf16 v[80:83], v[152:155], a[0:3], v[80:83]
    v_mfma_f32_16x16x32_bf16 v[84:87], v[152:155], a[4:7], 0
    buffer_load_dwordx4 v[148:151], v23, s[24:27], s58 offen offset:1024 sc1
    v_mfma_f32_16x16x32_bf16 v[88:91], v[152:155], a[8:11], 0
    v_mfma_f32_16x16x32_bf16 v[92:95], v[152:155], a[12:15], 0
    s_waitcnt vmcnt(10)
    v_mfma_f32_16x16x32_bf16 v[80:83], v[156:159], a[16:19], v[80:83]
    s_add_u32 s58, s66, s82
    v_mfma_f32_16x16x32_bf16 v[84:87], v[156:159], a[20:23], v[84:87]
    buffer_load_dwordx4 v[152:155], v23, s[24:27], s58 offen offset:0 sc1
    v_mfma_f32_16x16x32_bf16 v[88:91], v[156:159], a[24:27], v[88:91]
    ds_write_b128 v232, v[100:103] offset:3072
    v_mfma_f32_16x16x32_bf16 v[92:95], v[156:159], a[28:31], v[92:95]
    s_waitcnt vmcnt(10)
    v_mfma_f32_16x16x32_bf16 v[80:83], v[112:115], a[32:35], v[80:83]
    v_mfma_f32_16x16x32_bf16 v[84:87], v[112:115], a[36:39], v[84:87]
    buffer_load_dwordx4 v[156:159], v23, s[24:27], s58 offen offset:1024 sc1
    v_mfma_f32_16x16x32_bf16 v[88:91], v[112:115], a[40:43], v[88:91]
    ds_write_b128 v232, v[104:107] offset:19456
    v_mfma_f32_16x16x32_bf16 v[92:95], v[112:115], a[44:47], v[92:95]
    s_waitcnt vmcnt(10)
    v_mfma_f32_16x16x32_bf16 v[80:83], v[116:119], a[48:51], v[80:83]
    s_add_u32 s66, s69, 117248
    s_add_u32 s58, s66, s76
    v_mfma_f32_16x16x32_bf16 v[84:87], v[116:119], a[52:55], v[84:87]
    buffer_load_dwordx4 v[112:115], v23, s[24:27], s58 offen offset:0 sc1
    v_mfma_f32_16x16x32_bf16 v[88:91], v[116:119], a[56:59], v[88:91]
    ds_write_b128 v232, v[108:111] offset:35840
    v_mfma_f32_16x16x32_bf16 v[92:95], v[116:119], a[60:63], v[92:95]
    s_waitcnt vmcnt(10)
    v_mfma_f32_16x16x32_bf16 v[80:83], v[120:123], a[64:67], v[80:83]
    v_mfma_f32_16x16x32_bf16 v[84:87], v[120:123], a[68:71], v[84:87]
    buffer_load_dwordx4 v[116:119], v23, s[24:27], s58 offen offset:1024 sc1
    v_mfma_f32_16x16x32_bf16 v[88:91], v[120:123], a[72:75], v[88:91]
    v_mfma_f32_16x16x32_bf16 v[92:95], v[120:123], a[76:79], v[92:95]
    s_waitcnt vmcnt(10)
    v_mfma_f32_16x16x32_bf16 v[80:83], v[124:127], a[80:83], v[80:83]
    s_add_u32 s58, s66, s77
    v_mfma_f32_16x16x32_bf16 v[84:87], v[124:127], a[84:87], v[84:87]
    buffer_load_dwordx4 v[120:123], v23, s[24:27], s58 offen offset:0 sc1
    v_mfma_f32_16x16x32_bf16 v[88:91], v[124:127], a[88:91], v[88:91]
    s_waitcnt lgkmcnt(0)
    s_barrier
    v_mfma_f32_16x16x32_bf16 v[92:95], v[124:127], a[92:95], v[92:95]
    s_waitcnt vmcnt(10)
    v_mfma_f32_16x16x32_bf16 v[80:83], v[128:131], a[96:99], v[80:83]
    v_mfma_f32_16x16x32_bf16 v[84:87], v[128:131], a[100:103], v[84:87]
    buffer_load_dwordx4 v[124:127], v23, s[24:27], s58 offen offset:1024 sc1
    v_mfma_f32_16x16x32_bf16 v[88:91], v[128:131], a[104:107], v[88:91]
    ds_read_b128 v[100:103], v233 offset:3072
    ds_read_b128 v[104:107], v234 offset:19456
    v_mfma_f32_16x16x32_bf16 v[92:95], v[128:131], a[108:111], v[92:95]
    ds_read_b128 v[108:111], v235 offset:35840
    s_waitcnt vmcnt(10)
    v_mfma_f32_16x16x32_bf16 v[80:83], v[132:135], a[112:115], v[80:83]
    s_add_u32 s58, s66, s78
    v_mfma_f32_16x16x32_bf16 v[84:87], v[132:135], a[116:119], v[84:87]
    buffer_load_dwordx4 v[128:131], v23, s[24:27], s58 offen offset:0 sc1
    v_mfma_f32_16x16x32_bf16 v[88:91], v[132:135], a[120:123], v[88:91]
    ds_read_b64_tr_b16 v[160:161], v16 offset:0
    v_mfma_f32_16x16x32_bf16 v[92:95], v[132:135], a[124:127], v[92:95]
    ds_read_b64_tr_b16 v[162:163], v16 offset:512
    s_waitcnt vmcnt(10)
    v_mfma_f32_16x16x32_bf16 v[80:83], v[136:139], a[128:131], v[80:83]
    s_waitcnt lgkmcnt(2)
    v_mfma_f32_16x16x32_bf16 v[84:87], v[136:139], a[132:135], v[84:87]
    buffer_load_dwordx4 v[132:135], v23, s[24:27], s58 offen offset:1024 sc1
    v_mfma_f32_16x16x32_bf16 v[88:91], v[136:139], a[136:139], v[88:91]
    v_add_f32 v96, v96, v100
    v_add_f32 v97, v97, v101
    ds_read_b64_tr_b16 v[164:165], v16 offset:1024
    v_mfma_f32_16x16x32_bf16 v[92:95], v[136:139], a[140:143], v[92:95]
    ds_read_b64_tr_b16 v[166:167], v16 offset:1536
    s_waitcnt vmcnt(10)
    v_mfma_f32_16x16x32_bf16 v[80:83], v[140:143], a[144:147], v[80:83]
    s_add_u32 s58, s66, s79
    v_add_f32 v98, v98, v102
    v_mfma_f32_16x16x32_bf16 v[84:87], v[140:143], a[148:151], v[84:87]
    buffer_load_dwordx4 v[136:139], v23, s[24:27], s58 offen offset:0 sc1
    v_mfma_f32_16x16x32_bf16 v[88:91], v[140:143], a[152:155], v[88:91]
    v_add_f32 v99, v99, v103
    v_add_f32 v96, v96, v104
    ds_read_b64_tr_b16 v[168:169], v16 offset:2048
    v_mfma_f32_16x16x32_bf16 v[92:95], v[140:143], a[156:159], v[92:95]
    ds_read_b64_tr_b16 v[170:171], v16 offset:2560
    s_waitcnt vmcnt(10)
    v_mfma_f32_16x16x32_bf16 v[80:83], v[144:147], a[160:163], v[80:83]
    v_add_f32 v97, v97, v105
    v_mfma_f32_16x16x32_bf16 v[84:87], v[144:147], a[164:167], v[84:87]
    buffer_load_dwordx4 v[140:143], v23, s[24:27], s58 offen offset:1024 sc1
    v_mfma_f32_16x16x32_bf16 v[88:91], v[144:147], a[168:171], v[88:91]
    v_add_f32 v98, v98, v106
    v_add_f32 v99, v99, v107
    ds_read_b64_tr_b16 v[172:173], v16 offset:3072
    v_mfma_f32_16x16x32_bf16 v[92:95], v[144:147], a[172:175], v[92:95]
    ds_read_b64_tr_b16 v[174:175], v16 offset:3584
    s_waitcnt vmcnt(10)
    v_mfma_f32_16x16x32_bf16 v[80:83], v[148:151], a[176:179], v[80:83]
    s_add_u32 s58, s66, s80
    v_mfma_f32_16x16x32_bf16 v[84:87], v[148:151], a[180:183], v[84:87]
    buffer_load_dwordx4 v[144:147], v23, s[24:27], s58 offen offset:0 sc1
    v_mfma_f32_16x16x32_bf16 v[88:91], v[148:151], a[184:187], v[88:91]
    v_add_f32 v96, v96, v108
    v_add_f32 v97, v97, v109
    v_mfma_f32_16x16x32_bf16 v[92:95], v[148:151], a[188:191], v[92:95]
    v_add_f32 v98, v98, v110
    s_waitcnt vmcnt(10)
    v_mfma_f32_16x16x32_bf16 v[80:83], v[152:155], a[192:195], v[80:83]
    v_mfma_f32_16x16x32_bf16 v[84:87], v[152:155], a[196:199], v[84:87]
    buffer_load_dwordx4 v[148:151], v23, s[24:27], s58 offen offset:1024 sc1
    v_mfma_f32_16x16x32_bf16 v[88:91], v[152:155], a[200:203], v[88:91]
    v_add_f32 v99, v99, v111
    v_mfma_f32_16x16x32_bf16 v[92:95], v[152:155], a[204:207], v[92:95]
    s_waitcnt vmcnt(10)
    v_mfma_f32_16x16x32_bf16 v[80:83], v[156:159], a[208:211], v[80:83]
    s_add_u32 s58, s66, s81
    v_mfma_f32_16x16x32_bf16 v[84:87], v[156:159], a[212:215], v[84:87]
    buffer_load_dwordx4 v[152:155], v23, s[24:27], s58 offen offset:0 sc1
    v_mfma_f32_16x16x32_bf16 v[88:91], v[156:159], a[216:219], v[88:91]
    v_mfma_f32_16x16x32_bf16 v[92:95], v[156:159], a[220:223], v[92:95]
    s_waitcnt vmcnt(10)
    v_mfma_f32_16x16x32_bf16 v[64:67], v[112:115], a[0:3], v[64:67]
    v_mfma_f32_16x16x32_bf16 v[68:71], v[112:115], a[4:7], 0
    buffer_load_dwordx4 v[156:159], v23, s[24:27], s58 offen offset:1024 sc1
    v_mfma_f32_16x16x32_bf16 v[72:75], v[112:115], a[8:11], 0
    ds_read_b64_tr_b16 v[192:193], v16 offset:4096
    v_mfma_f32_16x16x32_bf16 v[76:79], v[112:115], a[12:15], 0
    ds_read_b64_tr_b16 v[194:195], v16 offset:4608
    s_waitcnt vmcnt(10)
    v_mfma_f32_16x16x32_bf16 v[64:67], v[116:119], a[16:19], v[64:67]
    s_add_u32 s58, s66, s82
    v_mfma_f32_16x16x32_bf16 v[68:71], v[116:119], a[20:23], v[68:71]
    buffer_load_dwordx4 v[112:115], v23, s[24:27], s58 offen offset:0 sc1
    v_mfma_f32_16x16x32_bf16 v[72:75], v[116:119], a[24:27], v[72:75]
    ds_read_b64_tr_b16 v[196:197], v16 offset:5120
    ds_read_b64_tr_b16 v[198:199], v16 offset:5632
    v_mfma_f32_16x16x32_bf16 v[76:79], v[116:119], a[28:31], v[76:79]
    ds_write_b128 v232, v[84:87] offset:49152
    s_waitcnt vmcnt(10)
    v_mfma_f32_16x16x32_bf16 v[64:67], v[120:123], a[32:35], v[64:67]
    v_mfma_f32_16x16x32_bf16 v[68:71], v[120:123], a[36:39], v[68:71]
    buffer_load_dwordx4 v[116:119], v23, s[24:27], s58 offen offset:1024 sc1
    v_mfma_f32_16x16x32_bf16 v[72:75], v[120:123], a[40:43], v[72:75]
    ds_read_b64_tr_b16 v[200:201], v16 offset:6144
    ds_read_b64_tr_b16 v[202:203], v16 offset:6656
    v_mfma_f32_16x16x32_bf16 v[76:79], v[120:123], a[44:47], v[76:79]
    ds_write_b128 v232, v[88:91] offset:50176
    s_waitcnt vmcnt(10)
    v_mfma_f32_16x16x32_bf16 v[64:67], v[124:127], a[48:51], v[64:67]
    s_add_u32 s66, s69, 58624
    s_add_u32 s58, s66, s76
    v_mfma_f32_16x16x32_bf16 v[68:71], v[124:127], a[52:55], v[68:71]
    buffer_load_dwordx4 v[120:123], v23, s[24:27], s58 offen offset:0 sc1
    v_mfma_f32_16x16x32_bf16 v[72:75], v[124:127], a[56:59], v[72:75]
    ds_read_b64_tr_b16 v[204:205], v16 offset:7168
    ds_read_b64_tr_b16 v[206:207], v16 offset:7680
    v_mfma_f32_16x16x32_bf16 v[76:79], v[124:127], a[60:63], v[76:79]
    ds_write_b128 v232, v[92:95] offset:51200
    s_waitcnt vmcnt(10)
    v_mfma_f32_16x16x32_bf16 v[64:67], v[128:131], a[64:67], v[64:67]
    v_mfma_f32_16x16x32_bf16 v[68:71], v[128:131], a[68:71], v[68:71]
    buffer_load_dwordx4 v[124:127], v23, s[24:27], s58 offen offset:1024 sc1
    v_mfma_f32_16x16x32_bf16 v[72:75], v[128:131], a[72:75], v[72:75]
    ds_read_b64_tr_b16 v[100:101], v16 offset:8192
    v_mfma_f32_16x16x32_bf16 v[76:79], v[128:131], a[76:79], v[76:79]
    ds_read_b64_tr_b16 v[102:103], v16 offset:8704
    s_waitcnt vmcnt(10)
    v_mfma_f32_16x16x32_bf16 v[64:67], v[132:135], a[80:83], v[64:67]
    s_add_u32 s58, s66, s77
    v_mfma_f32_16x16x32_bf16 v[68:71], v[132:135], a[84:87], v[68:71]
    buffer_load_dwordx4 v[128:131], v23, s[24:27], s58 offen offset:0 sc1
    v_mfma_f32_16x16x32_bf16 v[72:75], v[132:135], a[88:91], v[72:75]
    s_waitcnt lgkmcnt(2)
    s_barrier
    v_mfma_f32_16x16x32_bf16 v[76:79], v[132:135], a[92:95], v[76:79]
    s_waitcnt vmcnt(10)
    v_mfma_f32_16x16x32_bf16 v[64:67], v[136:139], a[96:99], v[64:67]
    v_mfma_f32_16x16x32_bf16 v[68:71], v[136:139], a[100:103], v[68:71]
    buffer_load_dwordx4 v[132:135], v23, s[24:27], s58 offen offset:1024 sc1
    v_mfma_f32_16x16x32_bf16 v[72:75], v[136:139], a[104:107], v[72:75]
    ds_read_b128 v[84:87], v233 offset:49152
    ds_read_b128 v[88:91], v234 offset:50176
    v_mfma_f32_16x16x32_bf16 v[76:79], v[136:139], a[108:111], v[76:79]
    ds_read_b128 v[92:95], v235 offset:51200
    s_waitcnt vmcnt(10)
    v_mfma_f32_16x16x32_bf16 v[64:67], v[140:143], a[112:115], v[64:67]
    s_add_u32 s58, s66, s78
    v_mfma_f32_16x16x32_bf16 v[68:71], v[140:143], a[116:119], v[68:71]
    buffer_load_dwordx4 v[136:139], v23, s[24:27], s58 offen offset:0 sc1
    v_mfma_f32_16x16x32_bf16 v[72:75], v[140:143], a[120:123], v[72:75]
    ds_read_b64_tr_b16 a[224:225], v246 offset:0
    v_mfma_f32_16x16x32_bf16 v[76:79], v[140:143], a[124:127], v[76:79]
    ds_read_b64_tr_b16 a[226:227], v246 offset:512
    s_waitcnt vmcnt(10)
    v_mfma_f32_16x16x32_bf16 v[64:67], v[144:147], a[128:131], v[64:67]
    s_waitcnt lgkmcnt(2)
    v_mfma_f32_16x16x32_bf16 v[68:71], v[144:147], a[132:135], v[68:71]
    buffer_load_dwordx4 v[140:143], v23, s[24:27], s58 offen offset:1024 sc1
    v_mfma_f32_16x16x32_bf16 v[72:75], v[144:147], a[136:139], v[72:75]
    v_add_f32 v80, v80, v84
    v_add_f32 v81, v81, v85
    ds_read_b64_tr_b16 a[228:229], v247 offset:0
    v_mfma_f32_16x16x32_bf16 v[76:79], v[144:147], a[140:143], v[76:79]
    ds_read_b64_tr_b16 a[230:231], v247 offset:512
    s_waitcnt vmcnt(10)
    v_mfma_f32_16x16x32_bf16 v[64:67], v[148:151], a[144:147], v[64:67]
    s_add_u32 s58, s66, s79
    v_add_f32 v82, v82, v86
    v_mfma_f32_16x16x32_bf16 v[68:71], v[148:151], a[148:151], v[68:71]
    buffer_load_dwordx4 v[144:147], v23, s[24:27], s58 offen offset:0 sc1
    v_mfma_f32_16x16x32_bf16 v[72:75], v[148:151], a[152:155], v[72:75]
    v_add_f32 v83, v83, v87
    v_add_f32 v80, v80, v88
    ds_read_b64_tr_b16 a[232:233], v246 offset:256
    v_mfma_f32_16x16x32_bf16 v[76:79], v[148:151], a[156:159], v[76:79]
    ds_read_b64_tr_b16 a[234:235], v246 offset:768
    s_waitcnt vmcnt(10)
    v_mfma_f32_16x16x32_bf16 v[64:67], v[152:155], a[160:163], v[64:67]
    v_add_f32 v81, v81, v89
    v_mfma_f32_16x16x32_bf16 v[68:71], v[152:155], a[164:167], v[68:71]
    buffer_load_dwordx4 v[148:151], v23, s[24:27], s58 offen offset:1024 sc1
    v_mfma_f32_16x16x32_bf16 v[72:75], v[152:155], a[168:171], v[72:75]
    v_add_f32 v82, v82, v90
    v_add_f32 v83, v83, v91
    ds_read_b64_tr_b16 a[236:237], v247 offset:256
    v_mfma_f32_16x16x32_bf16 v[76:79], v[152:155], a[172:175], v[76:79]
    ds_read_b64_tr_b16 a[238:239], v247 offset:768
    s_waitcnt vmcnt(10)
    v_mfma_f32_16x16x32_bf16 v[64:67], v[156:159], a[176:179], v[64:67]
    s_add_u32 s58, s66, s80
    v_mfma_f32_16x16x32_bf16 v[68:71], v[156:159], a[180:183], v[68:71]
    buffer_load_dwordx4 v[152:155], v23, s[24:27], s58 offen offset:0 sc1
    v_mfma_f32_16x16x32_bf16 v[72:75], v[156:159], a[184:187], v[72:75]
    v_add_f32 v80, v80, v92
    v_add_f32 v81, v81, v93
    v_mfma_f32_16x16x32_bf16 v[76:79], v[156:159], a[188:191], v[76:79]
    v_add_f32 v82, v82, v94
    s_waitcnt vmcnt(10)
    v_mfma_f32_16x16x32_bf16 v[64:67], v[112:115], a[192:195], v[64:67]
    v_mfma_f32_16x16x32_bf16 v[68:71], v[112:115], a[196:199], v[68:71]
    buffer_load_dwordx4 v[156:159], v23, s[24:27], s58 offen offset:1024 sc1
    v_mfma_f32_16x16x32_bf16 v[72:75], v[112:115], a[200:203], v[72:75]
    v_add_f32 v83, v83, v95
    v_mfma_f32_16x16x32_bf16 v[76:79], v[112:115], a[204:207], v[76:79]
    s_waitcnt vmcnt(10)
    v_mfma_f32_16x16x32_bf16 v[64:67], v[116:119], a[208:211], v[64:67]
    s_add_u32 s58, s66, s81
    v_mfma_f32_16x16x32_bf16 v[68:71], v[116:119], a[212:215], v[68:71]
    buffer_load_dwordx4 v[112:115], v23, s[24:27], s58 offen offset:0 sc1
    v_mfma_f32_16x16x32_bf16 v[72:75], v[116:119], a[216:219], v[72:75]
    v_mfma_f32_16x16x32_bf16 v[76:79], v[116:119], a[220:223], v[76:79]
    s_waitcnt vmcnt(10)
    v_mfma_f32_16x16x32_bf16 v[48:51], v[120:123], a[0:3], v[48:51]
    v_mfma_f32_16x16x32_bf16 v[52:55], v[120:123], a[4:7], 0
    buffer_load_dwordx4 v[116:119], v23, s[24:27], s58 offen offset:1024 sc1
    v_mfma_f32_16x16x32_bf16 v[56:59], v[120:123], a[8:11], 0
    ds_read_b64_tr_b16 v[104:105], v16 offset:9216
    v_mfma_f32_16x16x32_bf16 v[60:63], v[120:123], a[12:15], 0
    ds_read_b64_tr_b16 v[106:107], v16 offset:9728
    s_waitcnt vmcnt(10)
    v_mfma_f32_16x16x32_bf16 v[48:51], v[124:127], a[16:19], v[48:51]
    s_add_u32 s58, s66, s82
    v_mfma_f32_16x16x32_bf16 v[52:55], v[124:127], a[20:23], v[52:55]
    buffer_load_dwordx4 v[120:123], v23, s[24:27], s58 offen offset:0 sc1
    v_mfma_f32_16x16x32_bf16 v[56:59], v[124:127], a[24:27], v[56:59]
    ds_read_b64_tr_b16 v[108:109], v16 offset:10240
    ds_read_b64_tr_b16 v[110:111], v16 offset:10752
    v_mfma_f32_16x16x32_bf16 v[60:63], v[124:127], a[28:31], v[60:63]
    ds_write_b128 v232, v[68:71] offset:32768
    s_waitcnt vmcnt(10)
    v_mfma_f32_16x16x32_bf16 v[48:51], v[128:131], a[32:35], v[48:51]
    v_mfma_f32_16x16x32_bf16 v[52:55], v[128:131], a[36:39], v[52:55]
    buffer_load_dwordx4 v[124:127], v23, s[24:27], s58 offen offset:1024 sc1
    v_mfma_f32_16x16x32_bf16 v[56:59], v[128:131], a[40:43], v[56:59]
    ds_read_b64_tr_b16 v[84:85], v16 offset:11264
    ds_read_b64_tr_b16 v[86:87], v16 offset:11776
    v_mfma_f32_16x16x32_bf16 v[60:63], v[128:131], a[44:47], v[60:63]
    ds_write_b128 v232, v[72:75] offset:33792
    s_waitcnt vmcnt(10)
    v_mfma_f32_16x16x32_bf16 v[48:51], v[132:135], a[48:51], v[48:51]
    s_add_u32 s66, s69, 0
    s_add_u32 s58, s66, s76
    v_mfma_f32_16x16x32_bf16 v[52:55], v[132:135], a[52:55], v[52:55]
    buffer_load_dwordx4 v[128:131], v23, s[24:27], s58 offen offset:0 sc1
    v_mfma_f32_16x16x32_bf16 v[56:59], v[132:135], a[56:59], v[56:59]
    ds_read_b64_tr_b16 v[88:89], v16 offset:12288
    ds_read_b64_tr_b16 v[90:91], v16 offset:12800
    v_mfma_f32_16x16x32_bf16 v[60:63], v[132:135], a[60:63], v[60:63]
    ds_write_b128 v232, v[76:79] offset:34816
    s_waitcnt vmcnt(10)
    v_mfma_f32_16x16x32_bf16 v[48:51], v[136:139], a[64:67], v[48:51]
    v_mfma_f32_16x16x32_bf16 v[52:55], v[136:139], a[68:71], v[52:55]
    buffer_load_dwordx4 v[132:135], v23, s[24:27], s58 offen offset:1024 sc1
    v_mfma_f32_16x16x32_bf16 v[56:59], v[136:139], a[72:75], v[56:59]
    ds_read_b64_tr_b16 v[92:93], v16 offset:13312
    v_mfma_f32_16x16x32_bf16 v[60:63], v[136:139], a[76:79], v[60:63]
    ds_read_b64_tr_b16 v[94:95], v16 offset:13824
    s_waitcnt vmcnt(10)
    v_mfma_f32_16x16x32_bf16 v[48:51], v[140:143], a[80:83], v[48:51]
    s_add_u32 s58, s66, s77
    v_mfma_f32_16x16x32_bf16 v[52:55], v[140:143], a[84:87], v[52:55]
    buffer_load_dwordx4 v[136:139], v23, s[24:27], s58 offen offset:0 sc1
    v_mfma_f32_16x16x32_bf16 v[56:59], v[140:143], a[88:91], v[56:59]
    s_waitcnt lgkmcnt(2)
    s_barrier
    v_mfma_f32_16x16x32_bf16 v[60:63], v[140:143], a[92:95], v[60:63]
    buffer_load_dword v19, v21, s[24:27], 0 offen sc1
    s_waitcnt vmcnt(11)
    v_mfma_f32_16x16x32_bf16 v[48:51], v[144:147], a[96:99], v[48:51]
    ds_read_b128 v[68:71], v233 offset:32768
    v_mfma_f32_16x16x32_bf16 v[52:55], v[144:147], a[100:103], v[52:55]
    ds_read_b128 v[72:75], v234 offset:33792
    v_mfma_f32_16x16x32_bf16 v[56:59], v[144:147], a[104:107], v[56:59]
    ds_read_b128 v[76:79], v235 offset:34816
    v_mfma_f32_16x16x32_bf16 v[60:63], v[144:147], a[108:111], v[60:63]
    s_waitcnt vmcnt(10)
    v_mfma_f32_16x16x32_bf16 v[48:51], v[148:151], a[112:115], v[48:51]
    v_mfma_f32_16x16x32_bf16 v[52:55], v[148:151], a[116:119], v[52:55]
    buffer_load_dwordx4 v[140:143], v23, s[24:27], s58 offen offset:1024 sc1
    v_mfma_f32_16x16x32_bf16 v[56:59], v[148:151], a[120:123], v[56:59]
    ds_read_b64_tr_b16 a[240:241], v246 offset:16384
    v_mfma_f32_16x16x32_bf16 v[60:63], v[148:151], a[124:127], v[60:63]
    ds_read_b64_tr_b16 a[242:243], v246 offset:16896
    s_waitcnt vmcnt(10)
    v_mfma_f32_16x16x32_bf16 v[48:51], v[152:155], a[128:131], v[48:51]
    s_add_u32 s58, s66, s78
    s_waitcnt lgkmcnt(2)
    v_mfma_f32_16x16x32_bf16 v[52:55], v[152:155], a[132:135], v[52:55]
    buffer_load_dwordx4 v[144:147], v23, s[24:27], s58 offen offset:0 sc1
    v_mfma_f32_16x16x32_bf16 v[56:59], v[152:155], a[136:139], v[56:59]
    v_add_f32 v64, v64, v68
    v_add_f32 v65, v65, v69
    ds_read_b64_tr_b16 a[244:245], v247 offset:16384
    v_mfma_f32_16x16x32_bf16 v[60:63], v[152:155], a[140:143], v[60:63]
    ds_read_b64_tr_b16 a[246:247], v247 offset:16896
    s_waitcnt vmcnt(10)
    v_mfma_f32_16x16x32_bf16 v[48:51], v[156:159], a[144:147], v[48:51]
    v_add_f32 v66, v66, v70
    v_mfma_f32_16x16x32_bf16 v[52:55], v[156:159], a[148:151], v[52:55]
    buffer_load_dwordx4 v[148:151], v23, s[24:27], s58 offen offset:1024 sc1
    v_mfma_f32_16x16x32_bf16 v[56:59], v[156:159], a[152:155], v[56:59]
    v_add_f32 v67, v67, v71
    v_add_f32 v64, v64, v72
    ds_read_b64_tr_b16 a[248:249], v246 offset:16640
    v_mfma_f32_16x16x32_bf16 v[60:63], v[156:159], a[156:159], v[60:63]
    ds_read_b64_tr_b16 a[250:251], v246 offset:17152
    s_waitcnt vmcnt(10)
    v_mfma_f32_16x16x32_bf16 v[48:51], v[112:115], a[160:163], v[48:51]
    s_add_u32 s58, s66, s79
    v_add_f32 v65, v65, v73
    v_mfma_f32_16x16x32_bf16 v[52:55], v[112:115], a[164:167], v[52:55]
    buffer_load_dwordx4 v[152:155], v23, s[24:27], s58 offen offset:0 sc1
    v_mfma_f32_16x16x32_bf16 v[56:59], v[112:115], a[168:171], v[56:59]
    v_add_f32 v66, v66, v74
    v_add_f32 v67, v67, v75
    ds_read_b64_tr_b16 a[252:253], v247 offset:16640
    v_mfma_f32_16x16x32_bf16 v[60:63], v[112:115], a[172:175], v[60:63]
    ds_read_b64_tr_b16 a[254:255], v247 offset:17152
    s_waitcnt vmcnt(10)
    v_mfma_f32_16x16x32_bf16 v[48:51], v[116:119], a[176:179], v[48:51]
    v_mfma_f32_16x16x32_bf16 v[52:55], v[116:119], a[180:183], v[52:55]
    buffer_load_dwordx4 v[156:159], v23, s[24:27], s58 offen offset:1024 sc1
    v_mfma_f32_16x16x32_bf16 v[56:59], v[116:119], a[184:187], v[56:59]
    v_add_f32 v64, v64, v76
    v_add_f32 v65, v65, v77
    v_mfma_f32_16x16x32_bf16 v[60:63], v[116:119], a[188:191], v[60:63]
    v_add_f32 v66, v66, v78
    s_waitcnt vmcnt(10)
    v_mfma_f32_16x16x32_bf16 v[48:51], v[120:123], a[192:195], v[48:51]
    s_add_u32 s58, s66, s80
    v_mfma_f32_16x16x32_bf16 v[52:55], v[120:123], a[196:199], v[52:55]
    buffer_load_dwordx4 v[112:115], v23, s[24:27], s58 offen offset:0 sc1
    v_mfma_f32_16x16x32_bf16 v[56:59], v[120:123], a[200:203], v[56:59]
    v_add_f32 v67, v67, v79
    v_mfma_f32_16x16x32_bf16 v[60:63], v[120:123], a[204:207], v[60:63]
    s_waitcnt vmcnt(10)
    v_mfma_f32_16x16x32_bf16 v[48:51], v[124:127], a[208:211], v[48:51]
    v_mfma_f32_16x16x32_bf16 v[52:55], v[124:127], a[212:215], v[52:55]
    buffer_load_dwordx4 v[116:119], v23, s[24:27], s58 offen offset:1024 sc1
    v_mfma_f32_16x16x32_bf16 v[56:59], v[124:127], a[216:219], v[56:59]
    v_mfma_f32_16x16x32_bf16 v[60:63], v[124:127], a[220:223], v[60:63]
    s_waitcnt vmcnt(10)
    v_mfma_f32_16x16x32_bf16 v[32:35], v[128:131], a[0:3], v[32:35]
    s_add_u32 s58, s66, s81
    ds_read_b64_tr_b16 v[68:69], v16 offset:14336
    v_mfma_f32_16x16x32_bf16 v[36:39], v[128:131], a[4:7], 0
    buffer_load_dwordx4 v[120:123], v23, s[24:27], s58 offen offset:0 sc1
    v_mfma_f32_16x16x32_bf16 v[40:43], v[128:131], a[8:11], 0
    ds_read_b64_tr_b16 v[70:71], v16 offset:14848
    ds_read_b64_tr_b16 v[72:73], v16 offset:15360
    v_mfma_f32_16x16x32_bf16 v[44:47], v[128:131], a[12:15], 0
    ds_read_b64_tr_b16 v[74:75], v16 offset:15872
    s_waitcnt vmcnt(10)
    v_mfma_f32_16x16x32_bf16 v[32:35], v[132:135], a[16:19], v[32:35]
    ds_write_b128 v232, v[52:55] offset:16384
    v_mfma_f32_16x16x32_bf16 v[36:39], v[132:135], a[20:23], v[36:39]
    buffer_load_dwordx4 v[124:127], v23, s[24:27], s58 offen offset:1024 sc1
    v_mfma_f32_16x16x32_bf16 v[40:43], v[132:135], a[24:27], v[40:43]
    ds_read_b64_tr_b16 a[0:1], v246 offset:32768
    ds_read_b64_tr_b16 a[2:3], v246 offset:33280
    ds_read_b64_tr_b16 a[4:5], v247 offset:32768
    v_mfma_f32_16x16x32_bf16 v[44:47], v[132:135], a[28:31], v[44:47]
    ds_read_b64_tr_b16 a[6:7], v247 offset:33280
    s_waitcnt vmcnt(10)
    v_mfma_f32_16x16x32_bf16 v[32:35], v[136:139], a[32:35], v[32:35]
    s_add_u32 s58, s66, s82
    ds_write_b128 v232, v[56:59] offset:17408
    v_mfma_f32_16x16x32_bf16 v[36:39], v[136:139], a[36:39], v[36:39]
    buffer_load_dwordx4 v[128:131], v23, s[24:27], s58 offen offset:0 sc1
    v_mfma_f32_16x16x32_bf16 v[40:43], v[136:139], a[40:43], v[40:43]
    ds_read_b64_tr_b16 a[8:9], v246 offset:33024
    ds_read_b64_tr_b16 a[10:11], v246 offset:33536
    ds_read_b64_tr_b16 a[12:13], v247 offset:33024
    v_mfma_f32_16x16x32_bf16 v[44:47], v[136:139], a[44:47], v[44:47]
    ds_read_b64_tr_b16 a[14:15], v247 offset:33536
    buffer_load_dwordx4 v[132:135], v23, s[24:27], s58 offen offset:1024 sc1
    s_waitcnt vmcnt(11)
    v_cmp_ne_u32 vcc, s47, v19
    s_nop 0
    s_cbranch_vccz L_ok10
    s_mov_b32 s59, 20000
L_spin9:
    buffer_load_dword v19, v21, s[24:27], 0 offen sc1
    s_waitcnt vmcnt(0)
    v_cmp_ne_u32 vcc, s47, v19
    s_nop 0
    s_cbranch_vccz L_ok10
    s_sub_u32 s59, s59, 1
    s_cbranch_scc0 L_spin9
L_ok10:
    s_waitcnt vmcnt(10)
    v_mfma_f32_16x16x32_bf16 v[32:35], v[140:143], a[48:51], v[32:35]
    s_add_u32 s58, s70, 0
    ds_write_b128 v232, v[60:63] offset:18432
    v_mfma_f32_16x16x32_bf16 v[36:39], v[140:143], a[52:55], v[36:39]
    buffer_load_dwordx4 v[136:139], v23, s[24:27], s58 offen offset:0 sc1
    v_mfma_f32_16x16x32_bf16 v[40:43], v[140:143], a[56:59], v[40:43]
    ds_read_b64_tr_b16 a[16:17], v246 offset:49152
    ds_read_b64_tr_b16 a[18:19], v246 offset:49664
    ds_read_b64_tr_b16 a[20:21], v247 offset:49152
    v_mfma_f32_16x16x32_bf16 v[44:47], v[140:143], a[60:63], v[44:47]
    ds_read_b64_tr_b16 a[22:23], v247 offset:49664
    s_waitcnt vmcnt(10)
    v_mfma_f32_16x16x32_bf16 v[32:35], v[144:147], a[64:67], v[32:35]
    ds_read_b64_tr_b16 a[24:25], v246 offset:49408
    v_mfma_f32_16x16x32_bf16 v[36:39], v[144:147], a[68:71], v[36:39]
    buffer_load_dwordx4 v[140:143], v23, s[24:27], s58 offen offset:1024 sc1
    v_mfma_f32_16x16x32_bf16 v[40:43], v[144:147], a[72:75], v[40:43]
    ds_read_b64_tr_b16 a[26:27], v246 offset:49920
    ds_read_b64_tr_b16 a[28:29], v247 offset:49408
    v_mfma_f32_16x16x32_bf16 v[44:47], v[144:147], a[76:79], v[44:47]
    ds_read_b64_tr_b16 a[30:31], v247 offset:49920
    s_waitcnt vmcnt(10)
    v_mfma_f32_16x16x32_bf16 v[32:35], v[148:151], a[80:83], v[32:35]
    ds_read_b64_tr_b16 a[32:33], v246 offset:4096
    v_mfma_f32_16x16x32_bf16 v[36:39], v[148:151], a[84:87], v[36:39]
    buffer_load_dwordx4 v[144:147], v23, s[24:27], s58 offen offset:2048 sc1
    v_mfma_f32_16x16x32_bf16 v[40:43], v[148:151], a[88:91], v[40:43]
    ds_read_b64_tr_b16 a[34:35], v246 offset:4608
    ds_read_b64_tr_b16 a[36:37], v247 offset:4096
    v_mfma_f32_16x16x32_bf16 v[44:47], v[148:151], a[92:95], v[44:47]
    ds_read_b64_tr_b16 a[38:39], v247 offset:4608
    s_waitcnt vmcnt(10)
    v_mfma_f32_16x16x32_bf16 v[32:35], v[152:155], a[96:99], v[32:35]
    ds_read_b64_tr_b16 a[40:41], v246 offset:4352
    v_mfma_f32_16x16x32_bf16 v[36:39], v[152:155], a[100:103], v[36:39]
    buffer_load_dwordx4 v[148:151], v23, s[24:27], s58 offen offset:3072 sc1
    v_mfma_f32_16x16x32_bf16 v[40:43], v[152:155], a[104:107], v[40:43]
    ds_read_b64_tr_b16 a[42:43], v246 offset:4864
    ds_read_b64_tr_b16 a[44:45], v247 offset:4352
    v_mfma_f32_16x16x32_bf16 v[44:47], v[152:155], a[108:111], v[44:47]
    ds_read_b64_tr_b16 a[46:47], v247 offset:4864
    s_waitcnt vmcnt(10)
    v_mfma_f32_16x16x32_bf16 v[32:35], v[156:159], a[112:115], v[32:35]
    s_add_u32 s58, s70, 4096
    ds_read_b64_tr_b16 a[48:49], v246 offset:20480
    v_mfma_f32_16x16x32_bf16 v[36:39], v[156:159], a[116:119], v[36:39]
    buffer_load_dwordx4 v[152:155], v23, s[24:27], s58 offen offset:0 sc1
    v_mfma_f32_16x16x32_bf16 v[40:43], v[156:159], a[120:123], v[40:43]
    ds_read_b64_tr_b16 a[50:51], v246 offset:20992
    ds_read_b64_tr_b16 a[52:53], v247 offset:20480
    v_mfma_f32_16x16x32_bf16 v[44:47], v[156:159], a[124:127], v[44:47]
    ds_read_b64_tr_b16 a[54:55], v247 offset:20992
    s_waitcnt vmcnt(10)
    v_mfma_f32_16x16x32_bf16 v[32:35], v[112:115], a[128:131], v[32:35]
    ds_read_b64_tr_b16 a[56:57], v246 offset:20736
    v_mfma_f32_16x16x32_bf16 v[36:39], v[112:115], a[132:135], v[36:39]
    buffer_load_dwordx4 v[156:159], v23, s[24:27], s58 offen offset:1024 sc1
    v_mfma_f32_16x16x32_bf16 v[40:43], v[112:115], a[136:139], v[40:43]
    ds_read_b64_tr_b16 a[58:59], v246 offset:21248
    ds_read_b64_tr_b16 a[60:61], v247 offset:20736
    v_mfma_f32_16x16x32_bf16 v[44:47], v[112:115], a[140:143], v[44:47]
    ds_read_b64_tr_b16 a[62:63], v247 offset:21248
    s_waitcnt vmcnt(10)
    v_mfma_f32_16x16x32_bf16 v[32:35], v[116:119], a[144:147], v[32:35]
    ds_read_b64_tr_b16 a[64:65], v246 offset:36864
    v_mfma_f32_16x16x32_bf16 v[36:39], v[116:119], a[148:151], v[36:39]
    buffer_load_dwordx4 v[112:115], v23, s[24:27], s58 offen offset:2048 sc1
    v_mfma_f32_16x16x32_bf16 v[40:43], v[116:119], a[152:155], v[40:43]
    ds_read_b64_tr_b16 a[66:67], v246 offset:37376
    ds_read_b64_tr_b16 a[68:69], v247 offset:36864
    v_mfma_f32_16x16x32_bf16 v[44:47], v[116:119], a[156:159], v[44:47]
    ds_read_b64_tr_b16 a[70:71], v247 offset:37376
    s_waitcnt vmcnt(10)
    v_mfma_f32_16x16x32_bf16 v[32:35], v[120:123], a[160:163], v[32:35]
    ds_read_b64_tr_b16 a[72:73], v246 offset:37120
    v_mfma_f32_16x16x32_bf16 v[36:39], v[120:123], a[164:167], v[36:39]
    buffer_load_dwordx4 v[116:119], v23, s[24:27], s58 offen offset:3072 sc1
    v_mfma_f32_16x16x32_bf16 v[40:43], v[120:123], a[168:171], v[40:43]
    ds_read_b64_tr_b16 a[74:75], v246 offset:37632
    ds_read_b64_tr_b16 a[76:77], v247 offset:37120
    v_mfma_f32_16x16x32_bf16 v[44:47], v[120:123], a[172:175], v[44:47]
    ds_read_b64_tr_b16 a[78:79], v247 offset:37632
    s_waitcnt vmcnt(10)
    v_mfma_f32_16x16x32_bf16 v[32:35], v[124:127], a[176:179], v[32:35]
    s_add_u32 s58, s70, 8192
    ds_read_b64_tr_b16 a[80:81], v246 offset:53248
    v_mfma_f32_16x16x32_bf16 v[36:39], v[124:127], a[180:183], v[36:39]
    buffer_load_dwordx4 v[120:123], v23, s[24:27], s58 offen offset:0 sc1
    v_mfma_f32_16x16x32_bf16 v[40:43], v[124:127], a[184:187], v[40:43]
    ds_read_b64_tr_b16 a[82:83], v246 offset:53760
    ds_read_b64_tr_b16 a[84:85], v247 offset:53248
    v_mfma_f32_16x16x32_bf16 v[44:47], v[124:127], a[188:191], v[44:47]
    ds_read_b64_tr_b16 a[86:87], v247 offset:53760
    s_waitcnt vmcnt(10)
    v_mfma_f32_16x16x32_bf16 v[32:35], v[128:131], a[192:195], v[32:35]
    ds_read_b64_tr_b16 a[88:89], v246 offset:53504
    v_mfma_f32_16x16x32_bf16 v[36:39], v[128:131], a[196:199], v[36:39]
    buffer_load_dwordx4 v[124:127], v23, s[24:27], s58 offen offset:1024 sc1
    v_mfma_f32_16x16x32_bf16 v[40:43], v[128:131], a[200:203], v[40:43]
    ds_read_b64_tr_b16 a[90:91], v246 offset:54016
    ds_read_b64_tr_b16 a[92:93], v247 offset:53504
    v_mfma_f32_16x16x32_bf16 v[44:47], v[128:131], a[204:207], v[44:47]
    ds_read_b64_tr_b16 a[94:95], v247 offset:54016
    s_waitcnt vmcnt(10)
    v_mfma_f32_16x16x32_bf16 v[32:35], v[132:135], a[208:211], v[32:35]
    ds_read_b64_tr_b16 a[96:97], v246 offset:8192
    v_mfma_f32_16x16x32_bf16 v[36:39], v[132:135], a[212:215], v[36:39]
    buffer_load_dwordx4 v[128:131], v23, s[24:27], s58 offen offset:2048 sc1
    v_mfma_f32_16x16x32_bf16 v[40:43], v[132:135], a[216:219], v[40:43]
    ds_read_b64_tr_b16 a[98:99], v246 offset:8704
    ds_read_b64_tr_b16 a[100:101], v247 offset:8192
    v_mfma_f32_16x16x32_bf16 v[44:47], v[132:135], a[220:223], v[44:47]
    ds_read_b64_tr_b16 a[102:103], v247 offset:8704
    s_waitcnt vmcnt(10)
    v_mfma_f32_16x16x32_bf16 v[32:35], a[224:227], v[136:139], v[32:35]
    ds_read_b64_tr_b16 a[104:105], v246 offset:8448
    v_mfma_f32_16x16x32_bf16 v[48:51], a[228:231], v[136:139], v[48:51]
    buffer_load_dwordx4 v[132:135], v23, s[24:27], s58 offen offset:3072 sc1
    v_mfma_f32_16x16x32_bf16 v[64:67], a[232:235], v[136:139], v[64:67]
    ds_read_b64_tr_b16 a[106:107], v246 offset:8960
    ds_read_b64_tr_b16 a[108:109], v247 offset:8448
    v_mfma_f32_16x16x32_bf16 v[80:83], a[236:239], v[136:139], v[80:83]
    ds_read_b64_tr_b16 a[110:111], v247 offset:8960
    ds_read_b64_tr_b16 a[112:113], v246 offset:24576
    v_mfma_f32_16x16x32_bf16 v[96:99], v[160:163], v[136:139], v[96:99]
    ds_read_b64_tr_b16 a[114:115], v246 offset:25088
    s_waitcnt lgkmcnt(15)
    s_waitcnt vmcnt(10)
    v_mfma_f32_16x16x32_bf16 v[32:35], a[240:243], v[140:143], v[32:35]
    s_add_u32 s58, s70, 12288
    ds_read_b64_tr_b16 a[116:117], v247 offset:24576
    v_mfma_f32_16x16x32_bf16 v[48:51], a[244:247], v[140:143], v[48:51]
    buffer_load_dwordx4 v[136:139], v23, s[24:27], s58 offen offset:0 sc1
    v_mfma_f32_16x16x32_bf16 v[64:67], a[248:251], v[140:143], v[64:67]
    ds_read_b64_tr_b16 a[118:119], v247 offset:25088
    ds_read_b64_tr_b16 a[120:121], v246 offset:24832
    v_mfma_f32_16x16x32_bf16 v[80:83], a[252:255], v[140:143], v[80:83]
    ds_read_b64_tr_b16 a[122:123], v246 offset:25344
    ds_read_b64_tr_b16 a[124:125], v247 offset:24832
    v_mfma_f32_16x16x32_bf16 v[96:99], v[164:167], v[140:143], v[96:99]
    ds_write_b128 v232, v[36:39] offset:0
    s_waitcnt vmcnt(10)
    v_mfma_f32_16x16x32_bf16 v[32:35], a[0:3], v[144:147], v[32:35]
    ds_read_b64_tr_b16 a[126:127], v247 offset:25344
    v_mfma_f32_16x16x32_bf16 v[48:51], a[4:7], v[144:147], v[48:51]
    buffer_load_dwordx4 v[140:143], v23, s[24:27], s58 offen offset:1024 sc1
    v_mfma_f32_16x16x32_bf16 v[64:67], a[8:11], v[144:147], v[64:67]
    ds_read_b64_tr_b16 a[128:129], v246 offset:40960
    ds_read_b64_tr_b16 a[130:131], v246 offset:41472
    v_mfma_f32_16x16x32_bf16 v[80:83], a[12:15], v[144:147], v[80:83]
    ds_read_b64_tr_b16 a[132:133], v247 offset:40960
    ds_read_b64_tr_b16 a[134:135], v247 offset:41472
    v_mfma_f32_16x16x32_bf16 v[96:99], v[168:171], v[144:147], v[96:99]
    ds_write_b128 v232, v[40:43] offset:1024
    s_waitcnt vmcnt(10)
    v_mfma_f32_16x16x32_bf16 v[32:35], a[16:19], v[148:151], v[32:35]
    ds_read_b64_tr_b16 a[136:137], v246 offset:41216
    v_mfma_f32_16x16x32_bf16 v[48:51], a[20:23], v[148:151], v[48:51]
    buffer_load_dwordx4 v[144:147], v23, s[24:27], s58 offen offset:2048 sc1
    v_mfma_f32_16x16x32_bf16 v[64:67], a[24:27], v[148:151], v[64:67]
    ds_read_b64_tr_b16 a[138:139], v246 offset:41728
    ds_read_b64_tr_b16 a[140:141], v247 offset:41216
    v_mfma_f32_16x16x32_bf16 v[80:83], a[28:31], v[148:151], v[80:83]
    ds_read_b64_tr_b16 a[142:143], v247 offset:41728
    ds_read_b64_tr_b16 a[144:145], v246 offset:57344
    v_mfma_f32_16x16x32_bf16 v[96:99], v[172:175], v[148:151], v[96:99]
    ds_write_b128 v232, v[44:47] offset:2048
    s_waitcnt vmcnt(10)
    v_mfma_f32_16x16x32_bf16 v[32:35], a[32:35], v[152:155], v[32:35]
    ds_read_b64_tr_b16 a[146:147], v246 offset:57856
    v_mfma_f32_16x16x32_bf16 v[48:51], a[36:39], v[152:155], v[48:51]
    buffer_load_dwordx4 v[148:151], v23, s[24:27], s58 offen offset:3072 sc1
    v_mfma_f32_16x16x32_bf16 v[64:67], a[40:43], v[152:155], v[64:67]
    ds_read_b64_tr_b16 a[148:149], v247 offset:57344
    ds_read_b64_tr_b16 a[150:151], v247 offset:57856
    v_mfma_f32_16x16x32_bf16 v[80:83], a[44:47], v[152:155], v[80:83]
    ds_read_b64_tr_b16 a[152:153], v246 offset:57600
    ds_read_b64_tr_b16 a[154:155], v246 offset:58112
    v_mfma_f32_16x16x32_bf16 v[96:99], v[192:195], v[152:155], v[96:99]
    ds_read_b64_tr_b16 a[156:157], v247 offset:57600
    s_waitcnt vmcnt(10)
    v_mfma_f32_16x16x32_bf16 v[32:35], a[48:51], v[156:159], v[32:35]
    ds_read_b64_tr_b16 a[158:159], v247 offset:58112
    ds_read_b64_tr_b16 a[160:161], v246 offset:12288
    v_mfma_f32_16x16x32_bf16 v[48:51], a[52:55], v[156:159], v[48:51]
    ds_read_b64_tr_b16 a[162:163], v246 offset:12800
    v_mfma_f32_16x16x32_bf16 v[64:67], a[56:59], v[156:159], v[64:67]
    ds_read_b64_tr_b16 a[164:165], v247 offset:12288
    v_mfma_f32_16x16x32_bf16 v[80:83], a[60:63], v[156:159], v[80:83]
    ds_read_b64_tr_b16 a[166:167], v247 offset:12800
    v_mfma_f32_16x16x32_bf16 v[96:99], v[196:199], v[156:159], v[96:99]
    ds_read_b64_tr_b16 a[168:169], v246 offset:12544
    s_waitcnt vmcnt(9)
    v_mfma_f32_16x16x32_bf16 v[32:35], a[64:67], v[112:115], v[32:35]
    ds_read_b64_tr_b16 a[170:171], v246 offset:13056
    ds_read_b64_tr_b16 a[172:173], v247 offset:12544
    v_mfma_f32_16x16x32_bf16 v[48:51], a[68:71], v[112:115], v[48:51]
    ds_read_b64_tr_b16 a[174:175], v247 offset:13056
    v_mfma_f32_16x16x32_bf16 v[64:67], a[72:75], v[112:115], v[64:67]
    ds_read_b64_tr_b16 a[176:177], v246 offset:28672
    v_mfma_f32_16x16x32_bf16 v[80:83], a[76:79], v[112:115], v[80:83]
    ds_read_b64_tr_b16 a[178:179], v246 offset:29184
    v_mfma_f32_16x16x32_bf16 v[96:99], v[200:203], v[112:115], v[96:99]
    s_waitcnt lgkmcnt(15)
    s_barrier
    s_waitcnt vmcnt(8)
    v_mfma_f32_16x16x32_bf16 v[32:35], a[80:83], v[116:119], v[32:35]
    ds_read_b64_tr_b16 a[180:181], v247 offset:28672
    ds_read_b64_tr_b16 a[182:183], v247 offset:29184
    v_mfma_f32_16x16x32_bf16 v[48:51], a[84:87], v[116:119], v[48:51]
    ds_read_b64_tr_b16 a[184:185], v246 offset:28928
    ds_read_b64_tr_b16 a[186:187], v246 offset:29440
    v_mfma_f32_16x16x32_bf16 v[64:67], a[88:91], v[116:119], v[64:67]
    ds_read_b64_tr_b16 a[188:189], v247 offset:28928
    ds_read_b128 v[52:55], v233 offset:16384
    v_mfma_f32_16x16x32_bf16 v[80:83], a[92:95], v[116:119], v[80:83]
    ds_read_b128 v[56:59], v234 offset:17408
    v_mfma_f32_16x16x32_bf16 v[96:99], v[204:207], v[116:119], v[96:99]
    ds_read_b128 v[60:63], v235 offset:18432
    s_waitcnt vmcnt(7)
    v_mfma_f32_16x16x32_bf16 v[32:35], a[96:99], v[120:123], v[32:35]
    ds_read_b64_tr_b16 a[190:191], v247 offset:29440
    ds_read_b64_tr_b16 a[192:193], v246 offset:45056
    v_mfma_f32_16x16x32_bf16 v[48:51], a[100:103], v[120:123], v[48:51]
    ds_read_b64_tr_b16 a[194:195], v246 offset:45568
    ds_read_b64_tr_b16 a[196:197], v247 offset:45056
    v_mfma_f32_16x16x32_bf16 v[64:67], a[104:107], v[120:123], v[64:67]
    ds_read_b64_tr_b16 a[198:199], v247 offset:45568
    ds_read_b128 v[36:39], v233 offset:0
    v_mfma_f32_16x16x32_bf16 v[80:83], a[108:111], v[120:123], v[80:83]
    ds_read_b128 v[40:43], v234 offset:1024
    v_mfma_f32_16x16x32_bf16 v[96:99], v[100:103], v[120:123], v[96:99]
    ds_read_b128 v[44:47], v235 offset:2048
    s_waitcnt vmcnt(6)
    v_mfma_f32_16x16x32_bf16 v[32:35], a[112:115], v[124:127], v[32:35]
    ds_read_b64_tr_b16 a[200:201], v246 offset:45312
    ds_read_b64_tr_b16 a[202:203], v246 offset:45824
    v_mfma_f32_16x16x32_bf16 v[48:51], a[116:119], v[124:127], v[48:51]
    ds_read_b64_tr_b16 a[204:205], v247 offset:45312
    v_mfma_f32_16x16x32_bf16 v[64:67], a[120:123], v[124:127], v[64:67]
    ds_read_b64_tr_b16 a[206:207], v247 offset:45824
    v_mfma_f32_16x16x32_bf16 v[80:83], a[124:127], v[124:127], v[80:83]
    ds_read_b64_tr_b16 a[208:209], v246 offset:61440
    v_mfma_f32_16x16x32_bf16 v[96:99], v[104:107], v[124:127], v[96:99]
    ds_read_b64_tr_b16 a[210:211], v246 offset:61952
    s_waitcnt vmcnt(5)
    v_mfma_f32_16x16x32_bf16 v[32:35], a[128:131], v[128:131], v[32:35]
    ds_read_b64_tr_b16 a[212:213], v247 offset:61440
    ds_read_b64_tr_b16 a[214:215], v247 offset:61952
    v_mfma_f32_16x16x32_bf16 v[48:51], a[132:135], v[128:131], v[48:51]
    ds_read_b64_tr_b16 a[216:217], v246 offset:61696
    v_mfma_f32_16x16x32_bf16 v[64:67], a[136:139], v[128:131], v[64:67]
    ds_read_b64_tr_b16 a[218:219], v246 offset:62208
    v_mfma_f32_16x16x32_bf16 v[80:83], a[140:143], v[128:131], v[80:83]
    ds_read_b64_tr_b16 a[220:221], v247 offset:61696
    v_mfma_f32_16x16x32_bf16 v[96:99], v[108:111], v[128:131], v[96:99]
    ds_read_b64_tr_b16 a[222:223], v247 offset:62208
    s_waitcnt lgkmcnt(15)
    s_waitcnt vmcnt(4)
    v_mfma_f32_16x16x32_bf16 v[32:35], a[144:147], v[132:135], v[32:35]
    v_mfma_f32_16x16x32_bf16 v[48:51], a[148:151], v[132:135], v[48:51]
    v_add_f32 v52, v52, v56
    v_mfma_f32_16x16x32_bf16 v[64:67], a[152:155], v[132:135], v[64:67]
    v_add_f32 v53, v53, v57
    v_mfma_f32_16x16x32_bf16 v[80:83], a[156:159], v[132:135], v[80:83]
    v_add_f32 v54, v54, v58
    v_mfma_f32_16x16x32_bf16 v[96:99], v[84:87], v[132:135], v[96:99]
    s_waitcnt vmcnt(3)
    v_mfma_f32_16x16x32_bf16 v[32:35], a[160:163], v[136:139], v[32:35]
    v_add_f32 v55, v55, v59
    v_mfma_f32_16x16x32_bf16 v[48:51], a[164:167], v[136:139], v[48:51]
    v_add_f32 v52, v52, v60
    v_mfma_f32_16x16x32_bf16 v[64:67], a[168:171], v[136:139], v[64:67]
    v_add_f32 v53, v53, v61
    v_mfma_f32_16x16x32_bf16 v[80:83], a[172:175], v[136:139], v[80:83]
    v_add_f32 v54, v54, v62
    v_mfma_f32_16x16x32_bf16 v[96:99], v[88:91], v[136:139], v[96:99]
    s_waitcnt vmcnt(2)
    v_mfma_f32_16x16x32_bf16 v[32:35], a[176:179], v[140:143], v[32:35]
    v_add_f32 v55, v55, v63
    v_mfma_f32_16x16x32_bf16 v[48:51], a[180:183], v[140:143], v[48:51]
    s_waitcnt lgkmcnt(12)
    v_mfma_f32_16x16x32_bf16 v[64:67], a[184:187], v[140:143], v[64:67]
    v_add_f32 v36, v36, v40
    v_mfma_f32_16x16x32_bf16 v[80:83], a[188:191], v[140:143], v[80:83]
    v_add_f32 v37, v37, v41
    v_mfma_f32_16x16x32_bf16 v[96:99], v[92:95], v[140:143], v[96:99]
    s_waitcnt lgkmcnt(8)
    s_waitcnt vmcnt(1)
    v_mfma_f32_16x16x32_bf16 v[32:35], a[192:195], v[144:147], v[32:35]
    v_add_f32 v38, v38, v42
    v_mfma_f32_16x16x32_bf16 v[48:51], a[196:199], v[144:147], v[48:51]
    v_add_f32 v39, v39, v43
    v_mfma_f32_16x16x32_bf16 v[64:67], a[200:203], v[144:147], v[64:67]
    v_add_f32 v36, v36, v44
    v_mfma_f32_16x16x32_bf16 v[80:83], a[204:207], v[144:147], v[80:83]
    v_add_f32 v37, v37, v45
    v_mfma_f32_16x16x32_bf16 v[96:99], v[68:71], v[144:147], v[96:99]
    s_waitcnt lgkmcnt(0)
    s_waitcnt vmcnt(0)
    v_mfma_f32_16x16x32_bf16 v[32:35], a[208:211], v[148:151], v[32:35]
    v_add_f32 v38, v38, v46
    v_mfma_f32_16x16x32_bf16 v[48:51], a[212:215], v[148:151], v[48:51]
    v_add_f32 v39, v39, v47
    v_mfma_f32_16x16x32_bf16 v[64:67], a[216:219], v[148:151], v[64:67]
    v_mfma_f32_16x16x32_bf16 v[80:83], a[220:223], v[148:151], v[80:83]
    v_mfma_f32_16x16x32_bf16 v[96:99], v[72:75], v[148:151], v[96:99]
    s_nop 1
    v_pk_add_f32 v[32:33], v[32:33], v[36:37]
    v_pk_add_f32 v[34:35], v[34:35], v[38:39]
    v_pk_add_f32 v[48:49], v[48:49], v[52:53]
    v_pk_add_f32 v[50:51], v[50:51], v[54:55]
    v_cvt_pk_bf16_f32 v176, v32, v33
    v_cvt_pk_bf16_f32 v177, v34, v35
    ds_write_b64 v238, v[176:177] offset:0
    v_cvt_pk_bf16_f32 v178, v48, v49
    v_cvt_pk_bf16_f32 v179, v50, v51
    ds_write_b64 v238, v[178:179] offset:32
    v_cvt_pk_bf16_f32 v180, v64, v65
    v_cvt_pk_bf16_f32 v181, v66, v67
    ds_write_b64 v238, v[180:181] offset:64
    v_cvt_pk_bf16_f32 v182, v80, v81
    v_cvt_pk_bf16_f32 v183, v82, v83
    ds_write_b64 v238, v[182:183] offset:96
    ds_read_b128 v[216:219], v244 offset:0
    ds_read_b128 v[220:223], v244 offset:1408
    v_cvt_pk_bf16_f32 v184, v96, v97
    v_cvt_pk_bf16_f32 v185, v98, v99
    ds_write_b64 v238, v[184:185] offset:128
    ds_read_b64 v[224:225], v252 offset:128
    s_waitcnt lgkmcnt(3)
    buffer_store_dwordx4 v[216:219], v22, s[28:31], s71 offen
    s_waitcnt lgkmcnt(2)
    buffer_store_dwordx4 v[220:223], v22, s[28:31], s72 offen
    s_waitcnt lgkmcnt(0)
    buffer_store_dwordx2 v[224:225], v26, s[28:31], s73 offen
L_end:
    s_endpgm
L_p2_alt:
    s_add_u32 s57, s57, 27648
    buffer_load_dwordx4 v11, s[16:19], s57 offen offset:3072 lds
    s_xor_b32 s66, s44, 3
    s_lshl2_add_u32 s66, s51, s66
    s_mul_i32 s66, s66, 66816
    s_lshl2_add_u32 s66, s52, s66
    s_lshl_b32 s86, s65, 10
    s_add_u32 s58, s86, s66
    s_add_u32 s86, s66, 13312
    buffer_load_dwordx4 v[128:131], v23, s[24:27], s58 offen offset:0 sc1
    s_add_u32 s58, s58, 1024
    s_cmp_eq_u32 s58, s86
    s_cselect_b32 s58, s66, s58
    buffer_load_dwordx4 v[132:135], v23, s[24:27], s58 offen offset:0 sc1
    s_add_u32 s58, s58, 1024
    s_cmp_eq_u32 s58, s86
    s_cselect_b32 s58, s66, s58
    buffer_load_dwordx4 v[136:139], v23, s[24:27], s58 offen offset:0 sc1
    s_add_u32 s58, s58, 1024
    s_cmp_eq_u32 s58, s86
    s_cselect_b32 s58, s66, s58
    buffer_load_dwordx4 v[140:143], v23, s[24:27], s58 offen offset:0 sc1
    s_add_u32 s58, s58, 1024
    s_cmp_eq_u32 s58, s86
    s_cselect_b32 s58, s66, s58
    buffer_load_dwordx4 v[144:147], v23, s[24:27], s58 offen offset:0 sc1
    s_add_u32 s58, s58, 1024
    s_cmp_eq_u32 s58, s86
    s_cselect_b32 s58, s66, s58
    buffer_load_dwordx4 v[148:151], v23, s[24:27], s58 offen offset:0 sc1
    s_add_u32 s58, s58, 1024
    s_cmp_eq_u32 s58, s86
    s_cselect_b32 s58, s66, s58
    buffer_load_dwordx4 v[152:155], v23, s[24:27], s58 offen offset:0 sc1
    s_add_u32 s58, s58, 1024
    s_cmp_eq_u32 s58, s86
    s_cselect_b32 s58, s66, s58
    buffer_load_dwordx4 v[156:159], v23, s[24:27], s58 offen offset:0 sc1
    s_add_u32 s58, s58, 1024
    s_cmp_eq_u32 s58, s86
    s_cselect_b32 s58, s66, s58
    buffer_load_dwordx4 v[112:115], v23, s[24:27], s58 offen offset:0 sc1
    s_add_u32 s58, s58, 1024
    s_cmp_eq_u32 s58, s86
    s_cselect_b32 s58, s66, s58
    buffer_load_dwordx4 v[116:119], v23, s[24:27], s58 offen offset:0 sc1
    s_add_u32 s58, s58, 1024
    s_cmp_eq_u32 s58, s86
    s_cselect_b32 s58, s66, s58
    buffer_load_dwordx4 v[120:123], v23, s[24:27], s58 offen offset:0 sc1
    s_waitcnt vmcnt(19)
    ds_read_b64_tr_b16 a[208:209], v4 offset:32768
    ds_read_b64_tr_b16 a[210:211], v4 offset:33280
    ds_read_b64_tr_b16 a[212:213], v5 offset:32768
    ds_read_b64_tr_b16 a[214:215], v5 offset:33280
    ds_read_b64_tr_b16 a[216:217], v4 offset:33024
    ds_read_b64_tr_b16 a[218:219], v4 offset:33536
    ds_read_b64_tr_b16 a[220:221], v5 offset:33024
    ds_read_b64_tr_b16 a[222:223], v5 offset:33536
    s_waitcnt vmcnt(15)
    ds_read_b64_tr_b16 a[224:225], v2 offset:0
    ds_read_b64_tr_b16 a[226:227], v2 offset:512
    ds_read_b64_tr_b16 a[228:229], v3 offset:0
    ds_read_b64_tr_b16 a[230:231], v3 offset:512
    ds_read_b64_tr_b16 a[232:233], v2 offset:256
    ds_read_b64_tr_b16 a[234:235], v2 offset:768
    ds_read_b64_tr_b16 a[236:237], v3 offset:256
    ds_read_b64_tr_b16 a[238:239], v3 offset:768
    s_waitcnt vmcnt(11)
    ds_read_b64_tr_b16 a[240:241], v2 offset:16384
    ds_read_b64_tr_b16 a[242:243], v2 offset:16896
    ds_read_b64_tr_b16 a[244:245], v3 offset:16384
    ds_read_b64_tr_b16 a[246:247], v3 offset:16896
    ds_read_b64_tr_b16 a[248:249], v2 offset:16640
    ds_read_b64_tr_b16 a[250:251], v2 offset:17152
    ds_read_b64_tr_b16 a[252:253], v3 offset:16640
    ds_read_b64_tr_b16 a[254:255], v3 offset:17152
    s_waitcnt lgkmcnt(0)
    s_branch L_p2_join
L_p3_alt:
    s_add_u32 s66, s69, 175872
    s_add_u32 s58, s66, s76
    buffer_load_dwordx4 v[152:155], v23, s[24:27], s58 offen offset:0 sc1
    buffer_load_dwordx4 v[156:159], v23, s[24:27], s58 offen offset:1024 sc1
    s_add_u32 s58, s66, s77
    buffer_load_dwordx4 v[112:115], v23, s[24:27], s58 offen offset:0 sc1
    buffer_load_dwordx4 v[116:119], v23, s[24:27], s58 offen offset:1024 sc1
    s_add_u32 s58, s66, s78
    buffer_load_dwordx4 v[120:123], v23, s[24:27], s58 offen offset:0 sc1
    buffer_load_dwordx4 v[124:127], v23, s[24:27], s58 offen offset:1024 sc1
    s_add_u32 s58, s66, s79
    buffer_load_dwordx4 v[128:131], v23, s[24:27], s58 offen offset:0 sc1
    buffer_load_dwordx4 v[132:135], v23, s[24:27], s58 offen offset:1024 sc1
    s_add_u32 s58, s66, s80
    buffer_load_dwordx4 v[136:139], v23, s[24:27], s58 offen offset:0 sc1
    buffer_load_dwordx4 v[140:143], v23, s[24:27], s58 offen offset:1024 sc1
    s_add_u32 s58, s66, s81
    buffer_load_dwordx4 v[144:147], v23, s[24:27], s58 offen offset:0 sc1
    s_waitcnt vmcnt(11) lgkmcnt(0)
    s_branch L_p3_join
L_help:
    s_sub_u32 s55, s46, 21
    v_lshlrev_b32 v217, 7, v1
    v_lshrrev_b32 v218, 2, v1
    v_lshlrev_b32 v218, 12, v218
    v_lshl_add_u32 v218, v210, 7, v218
    v_mul_u32_u24 v220, 3584, v1
    s_lshl4_add_u32 s54, s44, s65
    s_mul_i32 s54, s54, 114688
    s_lshl_b32 s56, s50, 7
    s_add_u32 s54, s54, s56
    buffer_load_dword v108, v220, s[16:19], s54 offen
    v_mul_u32_u24 v109, 1088, v25
    v_lshl_add_u32 v109, v26, 4, v109
    v_mul_u32_u24 v110, 1088, v209
    v_lshl_add_u32 v110, v208, 5, v110
    v_lshl_add_u32 v110, v210, 3, v110
    s_lshl_b32 s53, s44, 7
    v_add_u32 v110, s53, v110
    v_mul_u32_u24 v111, 66816, v208
    v_lshl_add_u32 v111, v211, 4, v111
    s_mul_i32 s63, s44, 267264
    s_lshl_b32 s53, s2, 8
    s_add_u32 s63, s63, s53
    s_add_u32 s64, s63, 1069056
    v_cmp_gt_u32 vcc, 208, v0
    v_mov_b32 v100, 2130706432
    v_cmp_le_u32 s[92:93], 24, v26
    v_cndmask_b32 v22, v100, v111, vcc
    s_mov_b32 s62, 0x3f803f80
    s_mov_b32 s61, 0xffff0000
    v_mov_b32 v96, 0
    v_mov_b32 v97, 0
    s_waitcnt vmcnt(3)
    v_dot2c_f32_bf16 v96, s62, v32
    v_dot2c_f32_bf16 v97, v32, v32
    v_lshlrev_b32 v40, 16, v32
    v_and_b32 v41, s61, v32
    v_dot2c_f32_bf16 v96, s62, v33
    v_dot2c_f32_bf16 v97, v33, v33
    v_lshlrev_b32 v42, 16, v33
    v_and_b32 v43, s61, v33
    v_dot2c_f32_bf16 v96, s62, v34
    v_dot2c_f32_bf16 v97, v34, v34
    v_lshlrev_b32 v44, 16, v34
    v_and_b32 v45, s61, v34
    v_dot2c_f32_bf16 v96, s62, v35
    v_dot2c_f32_bf16 v97, v35, v35
    v_lshlrev_b32 v46, 16, v35
    v_and_b32 v47, s61, v35
    s_waitcnt vmcnt(2)
    v_dot2c_f32_bf16 v96, s62, v36
    v_dot2c_f32_bf16 v97, v36, v36
    v_lshlrev_b32 v48, 16, v36
    v_and_b32 v49, s61, v36
    v_dot2c_f32_bf16 v96, s62, v37
    v_dot2c_f32_bf16 v97, v37, v37
    v_lshlrev_b32 v50, 16, v37
    v_and_b32 v51, s61, v37
    v_dot2c_f32_bf16 v96, s62, v38
    v_dot2c_f32_bf16 v97, v38, v38
    v_lshlrev_b32 v52, 16, v38
    v_and_b32 v53, s61, v38
    v_dot2c_f32_bf16 v96, s62, v39
    v_dot2c_f32_bf16 v97, v39, v39
    v_lshlrev_b32 v54, 16, v39
    v_and_b32 v55, s61, v39
    buffer_load_dword v29, off, s[40:43], 0 sc1
    v_add_f32_dpp v96, v96, v96 quad_perm:[1,0,3,2] row_mask:0xf bank_mask:0xf
    v_add_f32_dpp v97, v97, v97 quad_perm:[1,0,3,2] row_mask:0xf bank_mask:0xf
    s_nop 0
    v_add_f32_dpp v96, v96, v96 quad_perm:[2,3,0,1] row_mask:0xf bank_mask:0xf
    v_add_f32_dpp v97, v97, v97 quad_perm:[2,3,0,1] row_mask:0xf bank_mask:0xf
    s_nop 0
    v_add_f32_dpp v96, v96, v96 row_half_mirror row_mask:0xf bank_mask:0xf
    v_add_f32_dpp v97, v97, v97 row_half_mirror row_mask:0xf bank_mask:0xf
    s_nop 0
    v_add_f32_dpp v96, v96, v96 row_mirror row_mask:0xf bank_mask:0xf
    v_add_f32_dpp v97, v97, v97 row_mirror row_mask:0xf bank_mask:0xf
    v_mov_b32 v98, v96
    v_mov_b32 v99, v97
    s_nop 0
    v_permlane16_swap_b32 v96, v98
    v_permlane16_swap_b32 v97, v99
    v_add_f32 v96, v96, v98
    v_add_f32 v97, v97, v99
    v_mul_f32 v98, 0x3b124925, v96
    v_mul_f32 v99, 0x3b124925, v97
    v_fma_f32 v99, -v98, v98, v99
    v_max_f32 v99, 0, v99
    v_cvt_pk_bf16_f32 v100, 0, v99
    v_add_f32 v100, 0x3727c5ac, v100
    v_cvt_pk_bf16_f32 v100, 0, v100
    v_sqrt_f32 v100, v100
    s_nop 0
    v_cvt_pk_bf16_f32 v100, 0, v100
    v_rcp_f32 v100, v100
    s_nop 0
    v_mul_f32 v99, v99, v100
    v_mul_f32 v99, v99, v100
    v_cvt_pk_bf16_f32 v104, 0, v99
    v_add_f32 v104, 0x3727c5ac, v104
    v_cvt_pk_bf16_f32 v104, 0, v104
    v_sqrt_f32 v104, v104
    s_nop 0
    v_cvt_pk_bf16_f32 v102, 0, v104
    v_rcp_f32 v104, v102
    s_nop 0
    v_mul_f32 v104, v104, v100
    v_mul_f32 v106, v98, v104
    v_pk_fma_f32 v[56:57], v[40:41], v[104:105], v[106:107] op_sel_hi:[1,0,0] neg_lo:[0,0,1] neg_hi:[0,0,1]
    v_pk_fma_f32 v[58:59], v[42:43], v[104:105], v[106:107] op_sel_hi:[1,0,0] neg_lo:[0,0,1] neg_hi:[0,0,1]
    v_pk_fma_f32 v[60:61], v[44:45], v[104:105], v[106:107] op_sel_hi:[1,0,0] neg_lo:[0,0,1] neg_hi:[0,0,1]
    v_pk_fma_f32 v[62:63], v[46:47], v[104:105], v[106:107] op_sel_hi:[1,0,0] neg_lo:[0,0,1] neg_hi:[0,0,1]
    v_pk_fma_f32 v[64:65], v[48:49], v[104:105], v[106:107] op_sel_hi:[1,0,0] neg_lo:[0,0,1] neg_hi:[0,0,1]
    v_pk_fma_f32 v[66:67], v[50:51], v[104:105], v[106:107] op_sel_hi:[1,0,0] neg_lo:[0,0,1] neg_hi:[0,0,1]
    v_pk_fma_f32 v[68:69], v[52:53], v[104:105], v[106:107] op_sel_hi:[1,0,0] neg_lo:[0,0,1] neg_hi:[0,0,1]
    v_pk_fma_f32 v[70:71], v[54:55], v[104:105], v[106:107] op_sel_hi:[1,0,0] neg_lo:[0,0,1] neg_hi:[0,0,1]
    v_cvt_pk_bf16_f32 v80, v56, v57
    v_cvt_pk_bf16_f32 v81, v58, v59
    v_cvt_pk_bf16_f32 v82, v60, v61
    v_cvt_pk_bf16_f32 v83, v62, v63
    v_cvt_pk_bf16_f32 v84, v64, v65
    v_cvt_pk_bf16_f32 v85, v66, v67
    v_cvt_pk_bf16_f32 v86, v68, v69
    v_cvt_pk_bf16_f32 v87, v70, v71
    v_lshrrev_b32 v102, 16, v102
    v_cndmask_b32 v84, v84, v102, s[92:93]
    ds_write_b128 v109, v[80:83] offset:0
    ds_write_b128 v109, v[84:87] offset:512
    s_waitcnt lgkmcnt(0)
    s_barrier
    ds_read_b64_tr_b16 v[88:89], v110 offset:0
    ds_read_b64_tr_b16 v[90:91], v110 offset:4352
    ds_read_b64_tr_b16 v[92:93], v110 offset:512
    ds_read_b64_tr_b16 v[94:95], v110 offset:4864
    s_waitcnt lgkmcnt(2)
    buffer_store_dwordx4 v[88:91], v111, s[24:27], s63 offen sc1
    s_waitcnt lgkmcnt(0)
    buffer_store_dwordx4 v[92:95], v22, s[24:27], s64 offen sc1
    v_min_u32 v220, 111104, v220
    s_add_u32 s54, s54, 229376
    buffer_load_dword v108, v220, s[16:19], s54 offen
    s_waitcnt vmcnt(1)
    v_cmp_eq_u32 vcc, 0, v29
    s_nop 0
    s_cbranch_vccz L_ok12
    s_mov_b32 s59, 20000
L_spin11:
    buffer_load_dword v29, off, s[40:43], 0 sc1
    s_waitcnt vmcnt(0)
    v_cmp_eq_u32 vcc, 0, v29
    s_nop 0
    s_cbranch_vccz L_ok12
    s_sub_u32 s59, s59, 1
    s_cbranch_scc0 L_spin11
L_ok12:
    v_readfirstlane_b32 s47, v29
    s_barrier
    s_cmp_lg_u32 s44, 0
    s_cbranch_scc1 L_nopub13
    s_lshl_b32 s60, s2, 5
    s_add_u32 s60, s60, 12582912
    v_mov_b32 v30, s47
    s_mov_b64 exec, 1
    buffer_store_dword v30, off, s[24:27], s60 sc1
    s_mov_b64 exec, -1
L_nopub13:
    buffer_load_dword v108, v217, s[32:35], 0 offen
    v_lshrrev_b32 v219, 2, v1
    v_min_u32 v219, 15, v219
    v_mul_u32_u24 v219, 3584, v219
    v_lshl_add_u32 v219, v210, 7, v219
    s_mul_i32 s54, s55, 16
    s_lshl_b32 s56, s44, 9
    s_add_u32 s54, s54, s56
    s_add_u32 s54, s54, 416
    s_mul_i32 s54, s54, 3584
    s_mul_i32 s56, s45, 7
    s_lshr_b32 s56, s56, 1
    s_lshl_b32 s56, s56, 7
    s_add_u32 s54, s54, s56
    buffer_load_dword v108, v219, s[16:19], s54 offen
    s_add_u32 s54, s54, 172032
    buffer_load_dword v108, v219, s[16:19], s54 offen
    s_add_u32 s54, s54, 172032
    s_lshl_b32 s54, s44, 11
    s_add_u32 s54, s54, 12582912
    v_lshl_add_u32 v221, v1, 5, s54
    buffer_load_dword v222, v221, s[24:27], 0 offen sc1
    s_waitcnt vmcnt(0)
    v_cmp_ne_u32 vcc, s47, v222
    s_nop 0
    s_cbranch_vccz L_ok15
    s_mov_b32 s59, 20000
L_spin14:
    buffer_load_dword v222, v221, s[24:27], 0 offen sc1
    s_waitcnt vmcnt(0)
    v_cmp_ne_u32 vcc, s47, v222
    s_nop 0
    s_cbranch_vccz L_ok15
    s_sub_u32 s59, s59, 1
    s_cbranch_scc0 L_spin14
L_ok15:
    s_add_u32 s54, s55, 0
    s_lshr_b32 s56, s54, 1
    s_add_u32 s56, s56, 24
    s_mul_i32 s56, s56, 66816
    s_lshl2_add_u32 s56, s52, s56
    s_and_b32 s54, s54, 1
    s_lshl_b32 s54, s54, 13
    s_add_u32 s56, s56, s54
    buffer_load_dword v108, v217, s[24:27], s56 offen sc1
    s_add_u32 s54, s55, 3
    s_lshr_b32 s56, s54, 1
    s_add_u32 s56, s56, 24
    s_mul_i32 s56, s56, 66816
    s_lshl2_add_u32 s56, s52, s56
    s_and_b32 s54, s54, 1
    s_lshl_b32 s54, s54, 13
    s_add_u32 s56, s56, s54
    buffer_load_dword v108, v217, s[24:27], s56 offen sc1
    s_add_u32 s54, s55, 6
    s_lshr_b32 s56, s54, 1
    s_add_u32 s56, s56, 24
    s_mul_i32 s56, s56, 66816
    s_lshl2_add_u32 s56, s52, s56
    s_and_b32 s54, s54, 1
    s_lshl_b32 s54, s54, 13
    s_add_u32 s56, s56, s54
    s_cmp_lt_u32 s55, 2
    s_cselect_b32 s56, s56, 2130706432
    buffer_load_dword v108, v217, s[24:27], s56 offen sc1
    s_mul_i32 s54, s44, 28
    s_add_u32 s54, s54, s55
    s_add_u32 s54, s54, 0
    s_lshl_b32 s54, s54, 16
    s_lshl_b32 s56, s45, 9
    s_add_u32 s54, s54, s56
    buffer_load_dword v108, v218, s[20:23], s54 offen
    s_add_u32 s54, s54, 196608
    buffer_load_dword v108, v218, s[20:23], s54 offen
    s_add_u32 s54, s54, 196608
    buffer_load_dword v108, v218, s[20:23], s54 offen
    s_add_u32 s54, s54, 196608
    buffer_load_dword v108, v218, s[20:23], s54 offen
    s_add_u32 s54, s54, 196608
    buffer_load_dword v108, v217, s[36:39], 0 offen
    s_waitcnt vmcnt(0) lgkmcnt(0)
    v_lshlrev_b32 v216, 6, v209
    v_lshl_add_u32 v216, v210, 3, v216
    v_lshl_add_u32 v216, v215, 5, v216
    s_add_u32 s53, s52, 49152
    v_lshl_add_u32 v2, v208, 10, v216
    v_add_u32 v2, s53, v2
    v_xor_b32 v3, 32, v2
    v_add_u32 v4, 65536, v2
    v_add_u32 v5, 65536, v3
    v_lshl_add_u32 v6, v208, 9, v216
    v_add_u32 v6, s53, v6
    v_xor_b32 v7, 32, v6
    v_add_u32 v8, 65536, v6
    v_add_u32 v9, 65536, v7
    s_lshr_b32 s53, s46, 2
    s_and_b32 s89, s46, 3
    s_bfe_u32 s54, s46, 0x20001
    s_and_b32 s55, s46, 1
    s_add_u32 s55, s55, 4
    s_cmp_lt_u32 s46, 16
    s_cselect_b32 s53, s53, s54
    s_cselect_b32 s89, s89, s55
    s_mul_i32 s49, s53, 2
    s_add_u32 s49, s49, s89
    s_sub_u32 s54, s49, 6
    s_min_u32 s49, s49, s54
    s_or_b32 s89, s89, 0
    s_lshl2_add_u32 s48, s45, s53
    s_mul_i32 s53, s44, 1835008
    s_lshl_b32 s74, s48, 7
    s_add_u32 s53, s53, s74
    s_lshl_b32 s56, s44, 5
    v_lshlrev_b32 v217, 5, v212
    v_xor_b32 v217, v217, v214
    v_xor_b32 v217, s56, v217
    s_add_u32 s74, s74, s56
    v_lshlrev_b32 v12, 12, v213
    v_add3_u32 v12, v12, v217, s53
    s_mul_i32 s53, s44, 100352
    s_lshl_b32 s54, s49, 7
    s_add_u32 s55, s53, s54
    v_mul_u32_u24 v13, 896, v213
    v_add3_u32 v13, v13, v214, s55
    v_xor_b32 v14, 32, v13
    s_mul_i32 s73, s48, 57344
    s_add_u32 s71, s73, s54
    s_mul_i32 s55, s44, 14336
    s_add_u32 s71, s71, s55
    s_add_u32 s72, s71, 7168
    v_bfe_u32 v217, v1, 1, 2
    v_lshl_add_u32 v217, v212, 2, v217
    v_and_b32 v218, 24, v1
    v_add_u32 v217, v217, v218
    v_mul_u32_u24 v15, 896, v217
    v_and_b32 v217, 1, v1
    v_lshl_add_u32 v15, v217, 4, v15
    v_add_u32 v15, s53, v15
    s_lshl_b32 s54, s89, 5
    s_add_u32 s54, s54, 768
    s_add_u32 s68, s89, 24
    s_mul_i32 s68, s68, 58624
    s_mul_i32 s69, s44, 14336
    s_add_u32 s69, s69, 2097152
    s_add_u32 s68, s68, s69
    s_mul_i32 s55, s49, 234496
    s_add_u32 s69, s69, s55
    s_add_u32 s73, s73, s54
    s_mov_b32 s76, 0
    s_add_u32 s77, s76, 2048
    s_cmp_eq_u32 s77, 14336
    s_cselect_b32 s77, 0, s77
    s_add_u32 s78, s77, 2048
    s_cmp_eq_u32 s78, 14336
    s_cselect_b32 s78, 0, s78
    s_add_u32 s79, s78, 2048
    s_cmp_eq_u32 s79, 14336
    s_cselect_b32 s79, 0, s79
    s_add_u32 s80, s79, 2048
    s_cmp_eq_u32 s80, 14336
    s_cselect_b32 s80, 0, s80
    s_add_u32 s81, s80, 2048
    s_cmp_eq_u32 s81, 14336
    s_cselect_b32 s81, 0, s81
    s_add_u32 s82, s81, 2048
    s_cmp_eq_u32 s82, 14336
    s_cselect_b32 s82, 0, s82
    s_cmp_lt_u32 s89, 4
    s_cselect_b32 s75, s54, 2130706432
    s_cselect_b32 s68, s68, 2130706432
    s_cselect_b32 s73, s73, 2130706432
    v_lshlrev_b32 v16, 3, v1
    v_add_u32 v16, 81920, v16
    v_and_b32 v217, 7, v1
    v_min_u32 v218, 6, v217
    s_mul_i32 s54, s44, 7
    v_add_u32 v218, s54, v218
    v_mul_u32_u24 v219, 2, v218
    v_add_u32 v219, s89, v219
    v_mul_u32_u24 v220, 43, v219
    v_lshrrev_b32 v220, 8, v220
    v_mul_u32_u24 v220, 6, v220
    v_sub_u32 v219, v219, v220
    v_subrev_u32 v219, s49, v219
    v_bfe_u32 v220, v1, 3, 1
    v_mul_i32_i24 v219, v219, v220
    v_add_u32 v219, s49, v219
    v_lshl_add_u32 v218, v219, 5, v218
    v_lshlrev_b32 v20, 7, v218
    v_add_u32 v20, 12713984, v20
    s_lshr_b32 s53, s48, 1
    s_lshl_b32 s53, s53, 7
    s_add_u32 s53, s53, 12779520
    v_lshl_add_u32 v21, v210, 11, s53
    s_lshl_b32 s70, s48, 16
    s_lshl2_add_u32 s70, s52, s70
    s_add_u32 s70, s70, 4194304
    v_lshrrev_b32 v218, 3, v1
    v_mul_u32_u24 v22, 896, v218
    v_lshl_add_u32 v22, v217, 4, v22
    v_lshlrev_b32 v25, 1, v211
    s_add_u32 s53, s52, 65536
    v_mul_u32_u24 v244, 176, v218
    v_lshl_add_u32 v244, v217, 4, v244
    v_add_u32 v244, s53, v244
    v_mul_u32_u24 v238, 176, v211
    v_lshl_add_u32 v238, v208, 3, v238
    v_add_u32 v238, s53, v238
    v_lshrrev_b32 v218, 2, v0
    v_mul_u32_u24 v26, 896, v218
    v_lshl_add_u32 v26, v210, 3, v26
    v_lshrrev_b32 v218, 2, v1
    v_mul_u32_u24 v252, 176, v218
    v_lshl_add_u32 v252, v210, 3, v252
    v_add_u32 v252, s53, v252
    s_sub_u32 s53, 49152, s52
    v_add_u32 v246, s53, v2
    v_add_u32 v247, s53, v3
    v_add_u32 v232, s52, v23
    v_xor_b32 v233, 4096, v232
    v_xor_b32 v234, 8192, v232
    v_xor_b32 v235, 12288, v232
    buffer_load_dwordx4 v[216:219], v22, s[4:7], s71 offen
    buffer_load_dwordx4 v[220:223], v22, s[4:7], s72 offen
    buffer_load_dwordx2 v[224:225], v26, s[4:7], s73 offen
    buffer_load_ushort v228, v25, s[36:39], s74 offen
    s_waitcnt vmcnt(0)
    ds_write_b128 v244, v[216:219]
    ds_write_b128 v244, v[220:223] offset:1408
    ds_write_b64 v252, v[224:225] offset:128
    ds_read_b64 v[216:217], v238 offset:0
    ds_read_b64 v[218:219], v238 offset:32
    ds_read_b64 v[220:221], v238 offset:64
    ds_read_b64 v[222:223], v238 offset:96
    ds_read_b64 v[224:225], v238 offset:128
    s_add_u32 m0, s52, 81920
    s_lshl_b32 s57, s76, 7
    buffer_load_dwordx4 v12, s[20:23], s57 offen offset:0 lds
    s_add_u32 s57, s57, 31744
    buffer_load_dwordx4 v12, s[20:23], s57 offen offset:1024 lds
    s_add_u32 s57, s57, 31744
    buffer_load_dwordx4 v12, s[20:23], s57 offen offset:2048 lds
    s_add_u32 s57, s57, 31744
    buffer_load_dwordx4 v12, s[20:23], s57 offen offset:3072 lds
    s_add_u32 m0, s52, 98304
    s_lshl_b32 s57, s76, 7
    s_add_u32 s57, s57, 131072
    buffer_load_dwordx4 v12, s[20:23], s57 offen offset:0 lds
    s_add_u32 s57, s57, 31744
    buffer_load_dwordx4 v12, s[20:23], s57 offen offset:1024 lds
    s_add_u32 s57, s57, 31744
    buffer_load_dwordx4 v12, s[20:23], s57 offen offset:2048 lds
    s_add_u32 s57, s57, 31744
    buffer_load_dwordx4 v12, s[20:23], s57 offen offset:3072 lds
    s_add_u32 m0, s52, 114688
    s_lshl_b32 s57, s77, 7
    buffer_load_dwordx4 v12, s[20:23], s57 offen offset:0 lds
    s_add_u32 s57, s57, 31744
    buffer_load_dwordx4 v12, s[20:23], s57 offen offset:1024 lds
    s_add_u32 s57, s57, 31744
    buffer_load_dwordx4 v12, s[20:23], s57 offen offset:2048 lds
    s_add_u32 s57, s57, 31744
    buffer_load_dwordx4 v12, s[20:23], s57 offen offset:3072 lds
    s_add_u32 m0, s52, 131072
    s_lshl_b32 s57, s77, 7
    s_add_u32 s57, s57, 131072
    buffer_load_dwordx4 v12, s[20:23], s57 offen offset:0 lds
    s_add_u32 s57, s57, 31744
    buffer_load_dwordx4 v12, s[20:23], s57 offen offset:1024 lds
    s_waitcnt vmcnt(10)
    ds_read_b64_tr_b16 a[0:1], v6 offset:32768
    ds_read_b64_tr_b16 a[2:3], v6 offset:34816
    ds_read_b64_tr_b16 a[4:5], v7 offset:32768
    ds_read_b64_tr_b16 a[6:7], v7 offset:34816
    ds_read_b64_tr_b16 a[8:9], v6 offset:33024
    ds_read_b64_tr_b16 a[10:11], v6 offset:35072
    ds_read_b64_tr_b16 a[12:13], v7 offset:33024
    ds_read_b64_tr_b16 a[14:15], v7 offset:35072
    s_add_u32 s57, s57, 31744
    buffer_load_dwordx4 v12, s[20:23], s57 offen offset:2048 lds
    s_add_u32 s57, s57, 31744
    buffer_load_dwordx4 v12, s[20:23], s57 offen offset:3072 lds
    s_add_u32 m0, s52, 147456
    s_lshl_b32 s57, s78, 7
    buffer_load_dwordx4 v12, s[20:23], s57 offen offset:0 lds
    s_add_u32 s57, s57, 31744
    buffer_load_dwordx4 v12, s[20:23], s57 offen offset:1024 lds
    s_waitcnt vmcnt(10)
    ds_read_b64_tr_b16 a[16:17], v6 offset:49152
    ds_read_b64_tr_b16 a[18:19], v6 offset:51200
    ds_read_b64_tr_b16 a[20:21], v7 offset:49152
    ds_read_b64_tr_b16 a[22:23], v7 offset:51200
    ds_read_b64_tr_b16 a[24:25], v6 offset:49408
    ds_read_b64_tr_b16 a[26:27], v6 offset:51456
    ds_read_b64_tr_b16 a[28:29], v7 offset:49408
    ds_read_b64_tr_b16 a[30:31], v7 offset:51456
    s_add_u32 s57, s57, 31744
    buffer_load_dwordx4 v12, s[20:23], s57 offen offset:2048 lds
    s_add_u32 s57, s57, 31744
    buffer_load_dwordx4 v12, s[20:23], s57 offen offset:3072 lds
    s_add_u32 m0, s52, 49152
    s_lshl_b32 s57, s78, 7
    s_add_u32 s57, s57, 131072
    buffer_load_dwordx4 v12, s[20:23], s57 offen offset:0 lds
    s_add_u32 s57, s57, 31744
    buffer_load_dwordx4 v12, s[20:23], s57 offen offset:1024 lds
    s_waitcnt vmcnt(10)
    ds_read_b64_tr_b16 a[32:33], v8 offset:0
    ds_read_b64_tr_b16 a[34:35], v8 offset:2048
    ds_read_b64_tr_b16 a[36:37], v9 offset:0
    ds_read_b64_tr_b16 a[38:39], v9 offset:2048
    ds_read_b64_tr_b16 a[40:41], v8 offset:256
    ds_read_b64_tr_b16 a[42:43], v8 offset:2304
    ds_read_b64_tr_b16 a[44:45], v9 offset:256
    ds_read_b64_tr_b16 a[46:47], v9 offset:2304
    s_add_u32 s57, s57, 31744
    buffer_load_dwordx4 v12, s[20:23], s57 offen offset:2048 lds
    s_add_u32 s57, s57, 31744
    buffer_load_dwordx4 v12, s[20:23], s57 offen offset:3072 lds
    s_waitcnt lgkmcnt(15)
    s_add_u32 m0, s52, 65536
    s_lshl_b32 s57, s79, 7
    buffer_load_dwordx4 v12, s[20:23], s57 offen offset:0 lds
    s_add_u32 s57, s57, 31744
    buffer_load_dwordx4 v12, s[20:23], s57 offen offset:1024 lds
    s_waitcnt vmcnt(10)
    ds_read_b64_tr_b16 a[48:49], v8 offset:16384
    ds_read_b64_tr_b16 a[50:51], v8 offset:18432
    ds_read_b64_tr_b16 a[52:53], v9 offset:16384
    ds_read_b64_tr_b16 a[54:55], v9 offset:18432
    s_add_u32 s57, s57, 31744
    buffer_load_dwordx4 v12, s[20:23], s57 offen offset:2048 lds
    ds_read_b64_tr_b16 a[56:57], v8 offset:16640
    ds_read_b64_tr_b16 a[58:59], v8 offset:18688
    ds_read_b64_tr_b16 a[60:61], v9 offset:16640
    ds_read_b64_tr_b16 a[62:63], v9 offset:18688
    s_add_u32 s57, s57, 31744
    buffer_load_dwordx4 v12, s[20:23], s57 offen offset:3072 lds
    s_add_u32 m0, s52, 81920
    s_lshl_b32 s57, s79, 7
    s_add_u32 s57, s57, 131072
    buffer_load_dwordx4 v12, s[20:23], s57 offen offset:0 lds
    s_add_u32 s57, s57, 31744
    buffer_load_dwordx4 v12, s[20:23], s57 offen offset:1024 lds
    s_waitcnt vmcnt(10)
    ds_read_b64_tr_b16 a[64:65], v8 offset:32768
    ds_read_b64_tr_b16 a[66:67], v8 offset:34816
    ds_read_b64_tr_b16 a[68:69], v9 offset:32768
    ds_read_b64_tr_b16 a[70:71], v9 offset:34816
    s_add_u32 s57, s57, 31744
    buffer_load_dwordx4 v12, s[20:23], s57 offen offset:2048 lds
    ds_read_b64_tr_b16 a[72:73], v8 offset:33024
    ds_read_b64_tr_b16 a[74:75], v8 offset:35072
    ds_read_b64_tr_b16 a[76:77], v9 offset:33024
    ds_read_b64_tr_b16 a[78:79], v9 offset:35072
    s_add_u32 s57, s57, 31744
    buffer_load_dwordx4 v12, s[20:23], s57 offen offset:3072 lds
    s_waitcnt lgkmcnt(15)
    s_add_u32 m0, s52, 98304
    s_lshl_b32 s57, s80, 7
    buffer_load_dwordx4 v12, s[20:23], s57 offen offset:0 lds
    s_waitcnt vmcnt(0) lgkmcnt(0)
    s_branch L_p3join
L_role_a:
    v_lshrrev_b32 v112, 4, v1
    v_bfe_u32 v113, v1, 2, 2
    v_and_b32 v114, 3, v1
    v_and_b32 v115, 15, v1
    v_lshrrev_b32 v116, 5, v1
    s_lshr_b32 s48, s45, 1
    s_and_b32 s53, s45, 1
    s_lshl3_add_u32 s49, s53, s46
    s_sub_u32 s49, s49, 24
    s_lshl_b32 s90, s44, 11
    s_and_b32 s53, s44, 1
    s_lshl_b32 s53, s53, 1
    v_lshlrev_b32 v117, 2, v112
    v_sub_u32 v117, v115, v117
    v_and_b32 v117, 15, v117
    v_xor_b32 v117, s53, v117
    v_mul_u32_u24 v2, 2688, v112
    v_lshl_add_u32 v2, v117, 4, v2
    s_mul_i32 s53, s44, 21504
    s_mul_i32 s54, s48, 224
    s_andn2_b32 s54, s54, 63
    s_add_u32 s53, s53, s54
    v_add_u32 v2, s53, v2
    s_add_u32 m0, s90, 65536
    s_mov_b32 s57, 896
    buffer_load_dwordx4 v2, s[8:11], s57 offen offset:0 lds
    s_mov_b32 s57, 10624
    buffer_load_dwordx4 v2, s[8:11], s57 offen offset:1024 lds
    s_add_u32 m0, s90, 73728
    s_mov_b32 s57, 86912
    buffer_load_dwordx4 v2, s[8:11], s57 offen offset:0 lds
    s_mov_b32 s57, 96640
    buffer_load_dwordx4 v2, s[8:11], s57 offen offset:1024 lds
    v_mul_u32_u24 v109, 1088, v25
    v_lshl_add_u32 v109, v26, 4, v109
    v_mul_u32_u24 v110, 1088, v113
    v_lshl_add_u32 v110, v112, 5, v110
    v_lshl_add_u32 v110, v114, 3, v110
    s_lshl_b32 s53, s44, 7
    v_add_u32 v110, s53, v110
    v_mul_u32_u24 v111, 66816, v112
    v_lshl_add_u32 v111, v115, 4, v111
    s_mul_i32 s63, s44, 267264
    s_lshl_b32 s53, s2, 8
    s_add_u32 s63, s63, s53
    s_add_u32 s64, s63, 1069056
    v_cmp_gt_u32 vcc, 208, v0
    v_mov_b32 v100, 2130706432
    v_cmp_le_u32 s[92:93], 24, v26
    v_cndmask_b32 v22, v100, v111, vcc
    s_mov_b32 s62, 0x3f803f80
    s_mov_b32 s61, 0xffff0000
    v_mov_b32 v96, 0
    v_mov_b32 v97, 0
    v_and_b32 v117, 1, v112
    v_lshlrev_b32 v117, 5, v117
    s_mul_i32 s53, s44, 56
    s_and_b32 s54, s48, 1
    s_lshl_b32 s54, s54, 5
    s_add_u32 s53, s53, s54
    v_lshlrev_b32 v118, 11, v112
    v_lshl_add_u32 v118, v113, 8, v118
    v_add_u32 v118, 65536, v118
    v_lshl_add_u32 v119, v114, 3, s53
    v_add_u32 v119, 0, v119
    v_xor_b32 v119, v119, v117
    v_lshl_add_u32 v119, v113, 6, v119
    v_and_b32 v119, 255, v119
    v_add_u32 v6, v118, v119
    v_add_u32 v10, 49152, v6
    v_subrev_u32 v120, 65536, v6
    v_lshl_add_u32 v119, v114, 3, s53
    v_add_u32 v119, 32, v119
    v_xor_b32 v119, v119, v117
    v_lshl_add_u32 v119, v113, 6, v119
    v_and_b32 v119, 255, v119
    v_add_u32 v7, v118, v119
    v_add_u32 v11, 49152, v7
    v_subrev_u32 v121, 65536, v7
    v_lshl_add_u32 v119, v114, 4, s53
    v_add_u32 v119, 0, v119
    v_xor_b32 v119, v119, v117
    v_lshl_add_u32 v119, v113, 6, v119
    v_and_b32 v119, 255, v119
    v_add_u32 v8, v118, v119
    v_add_u32 v12, 49152, v8
    v_subrev_u32 v122, 65536, v8
    v_lshl_add_u32 v119, v114, 4, s53
    v_add_u32 v119, 8, v119
    v_xor_b32 v119, v119, v117
    v_lshl_add_u32 v119, v113, 6, v119
    v_and_b32 v119, 255, v119
    v_add_u32 v9, v118, v119
    v_add_u32 v13, 49152, v9
    v_subrev_u32 v123, 65536, v9
    s_waitcnt vmcnt(6)
    v_dot2c_f32_bf16 v96, s62, v32
    v_dot2c_f32_bf16 v97, v32, v32
    v_lshlrev_b32 v40, 16, v32
    v_and_b32 v41, s61, v32
    v_dot2c_f32_bf16 v96, s62, v33
    v_dot2c_f32_bf16 v97, v33, v33
    v_lshlrev_b32 v42, 16, v33
    v_and_b32 v43, s61, v33
    v_dot2c_f32_bf16 v96, s62, v34
    v_dot2c_f32_bf16 v97, v34, v34
    v_lshlrev_b32 v44, 16, v34
    v_and_b32 v45, s61, v34
    v_dot2c_f32_bf16 v96, s62, v35
    v_dot2c_f32_bf16 v97, v35, v35
    v_lshlrev_b32 v46, 16, v35
    v_and_b32 v47, s61, v35
    s_waitcnt vmcnt(5)
    v_dot2c_f32_bf16 v96, s62, v36
    v_dot2c_f32_bf16 v97, v36, v36
    v_lshlrev_b32 v48, 16, v36
    v_and_b32 v49, s61, v36
    v_dot2c_f32_bf16 v96, s62, v37
    v_dot2c_f32_bf16 v97, v37, v37
    v_lshlrev_b32 v50, 16, v37
    v_and_b32 v51, s61, v37
    v_dot2c_f32_bf16 v96, s62, v38
    v_dot2c_f32_bf16 v97, v38, v38
    v_lshlrev_b32 v52, 16, v38
    v_and_b32 v53, s61, v38
    v_dot2c_f32_bf16 v96, s62, v39
    v_dot2c_f32_bf16 v97, v39, v39
    v_lshlrev_b32 v54, 16, v39
    v_and_b32 v55, s61, v39
    buffer_load_dword v29, off, s[40:43], 0 sc1
    v_add_f32_dpp v96, v96, v96 quad_perm:[1,0,3,2] row_mask:0xf bank_mask:0xf
    v_add_f32_dpp v97, v97, v97 quad_perm:[1,0,3,2] row_mask:0xf bank_mask:0xf
    s_nop 0
    v_add_f32_dpp v96, v96, v96 quad_perm:[2,3,0,1] row_mask:0xf bank_mask:0xf
    v_add_f32_dpp v97, v97, v97 quad_perm:[2,3,0,1] row_mask:0xf bank_mask:0xf
    s_nop 0
    v_add_f32_dpp v96, v96, v96 row_half_mirror row_mask:0xf bank_mask:0xf
    v_add_f32_dpp v97, v97, v97 row_half_mirror row_mask:0xf bank_mask:0xf
    s_nop 0
    v_add_f32_dpp v96, v96, v96 row_mirror row_mask:0xf bank_mask:0xf
    v_add_f32_dpp v97, v97, v97 row_mirror row_mask:0xf bank_mask:0xf
    v_mov_b32 v98, v96
    v_mov_b32 v99, v97
    s_nop 0
    v_permlane16_swap_b32 v96, v98
    v_permlane16_swap_b32 v97, v99
    v_add_f32 v96, v96, v98
    v_add_f32 v97, v97, v99
    v_mul_f32 v98, 0x3b124925, v96
    v_mul_f32 v99, 0x3b124925, v97
    v_fma_f32 v99, -v98, v98, v99
    v_max_f32 v99, 0, v99
    v_cvt_pk_bf16_f32 v100, 0, v99
    v_add_f32 v100, 0x3727c5ac, v100
    v_cvt_pk_bf16_f32 v100, 0, v100
    v_sqrt_f32 v100, v100
    s_nop 0
    v_cvt_pk_bf16_f32 v100, 0, v100
    v_rcp_f32 v100, v100
    s_nop 0
    v_mul_f32 v99, v99, v100
    v_mul_f32 v99, v99, v100
    v_cvt_pk_bf16_f32 v104, 0, v99
    v_add_f32 v104, 0x3727c5ac, v104
    v_cvt_pk_bf16_f32 v104, 0, v104
    v_sqrt_f32 v104, v104
    s_nop 0
    v_cvt_pk_bf16_f32 v102, 0, v104
    v_rcp_f32 v104, v102
    s_nop 0
    v_mul_f32 v104, v104, v100
    v_mul_f32 v106, v98, v104
    v_pk_fma_f32 v[56:57], v[40:41], v[104:105], v[106:107] op_sel_hi:[1,0,0] neg_lo:[0,0,1] neg_hi:[0,0,1]
    v_pk_fma_f32 v[58:59], v[42:43], v[104:105], v[106:107] op_sel_hi:[1,0,0] neg_lo:[0,0,1] neg_hi:[0,0,1]
    v_pk_fma_f32 v[60:61], v[44:45], v[104:105], v[106:107] op_sel_hi:[1,0,0] neg_lo:[0,0,1] neg_hi:[0,0,1]
    v_pk_fma_f32 v[62:63], v[46:47], v[104:105], v[106:107] op_sel_hi:[1,0,0] neg_lo:[0,0,1] neg_hi:[0,0,1]
    v_pk_fma_f32 v[64:65], v[48:49], v[104:105], v[106:107] op_sel_hi:[1,0,0] neg_lo:[0,0,1] neg_hi:[0,0,1]
    v_pk_fma_f32 v[66:67], v[50:51], v[104:105], v[106:107] op_sel_hi:[1,0,0] neg_lo:[0,0,1] neg_hi:[0,0,1]
    v_pk_fma_f32 v[68:69], v[52:53], v[104:105], v[106:107] op_sel_hi:[1,0,0] neg_lo:[0,0,1] neg_hi:[0,0,1]
    v_pk_fma_f32 v[70:71], v[54:55], v[104:105], v[106:107] op_sel_hi:[1,0,0] neg_lo:[0,0,1] neg_hi:[0,0,1]
    v_cvt_pk_bf16_f32 v80, v56, v57
    v_cvt_pk_bf16_f32 v81, v58, v59
    v_cvt_pk_bf16_f32 v82, v60, v61
    v_cvt_pk_bf16_f32 v83, v62, v63
    v_cvt_pk_bf16_f32 v84, v64, v65
    v_cvt_pk_bf16_f32 v85, v66, v67
    v_cvt_pk_bf16_f32 v86, v68, v69
    v_cvt_pk_bf16_f32 v87, v70, v71
    v_lshrrev_b32 v102, 16, v102
    v_cndmask_b32 v84, v84, v102, s[92:93]
    ds_write_b128 v109, v[80:83] offset:49152
    ds_write_b128 v109, v[84:87] offset:49664
    s_waitcnt lgkmcnt(0)
    s_barrier
    ds_read_b64_tr_b16 v[88:89], v110 offset:49152
    ds_read_b64_tr_b16 v[90:91], v110 offset:53504
    ds_read_b64_tr_b16 v[92:93], v110 offset:49664
    ds_read_b64_tr_b16 v[94:95], v110 offset:54016
    s_waitcnt lgkmcnt(2)
    buffer_store_dwordx4 v[88:91], v111, s[24:27], s63 offen sc1
    s_waitcnt lgkmcnt(0)
    buffer_store_dwordx4 v[92:95], v22, s[24:27], s64 offen sc1
    s_add_u32 m0, s90, 81920
    s_mov_b32 s57, 172928
    buffer_load_dwordx4 v2, s[8:11], s57 offen offset:0 lds
    s_movk_i32 s94, 224
    v_mul_u32_u24 v3, 66816, v116
    v_and_b32 v118, 1, v112
    v_lshlrev_b32 v119, 2, v118
    v_xor_b32 v119, v119, v115
    v_lshl_add_u32 v3, v118, 8, v3
    v_lshl_add_u32 v3, v119, 4, v3
    v_cmp_gt_u32 s[92:93], s94, v0
    v_mov_b32 v119, 2130706432
    s_mov_b32 s57, 182656
    buffer_load_dwordx4 v2, s[8:11], s57 offen offset:1024 lds
    v_lshlrev_b32 v4, 9, v116
    v_cndmask_b32 v24, v119, v3, s[92:93]
    v_lshl_add_u32 v4, v118, 7, v4
    v_lshl_add_u32 v4, v113, 4, v4
    v_lshrrev_b32 v118, 1, v114
    v_mul_u32_u24 v118, 320, v118
    v_add_u32 v4, v118, v4
    v_and_b32 v118, 1, v114
    v_lshl_add_u32 v4, v118, 3, v4
    v_xor_b32 v25, 64, v4
    s_lshl_b32 s53, s49, 4
    s_sub_u32 s53, s53, 2
    v_min_u32 v117, 17, v1
    v_add_u32 v117, s53, v117
    v_max_i32 v117, 0, v117
    v_lshlrev_b32 v19, 5, v117
    s_add_u32 m0, s90, 90112
    s_mov_b32 s57, 258944
    buffer_load_dwordx4 v2, s[8:11], s57 offen offset:0 lds
    v_add_u32 v19, 12582912, v19
    v_and_b32 v117, 1, v115
    v_cmp_eq_u32 s[76:77], 1, v117
    v_lshl_add_u32 v117, v112, 2, v117
    v_cmp_le_u32 s[78:79], v117, v115
    v_mul_u32_u24 v118, 304, v116
    v_lshl_add_u32 v93, v117, 1, v118
    v_add_u32 v117, 2, v117
    v_cmp_le_u32 s[80:81], v117, v115
    v_add_u32 v94, 4, v93
    v_mov_b32 v118, 14336
    v_mov_b32 v119, 30720
    v_cndmask_b32 v117, v118, v119, s[78:79]
    v_add_u32 v93, v117, v93
    v_cndmask_b32 v117, v118, v119, s[80:81]
    v_add_u32 v94, v117, v94
    s_mov_b32 s57, 268672
    buffer_load_dwordx4 v2, s[8:11], s57 offen offset:1024 lds
    v_lshrrev_b32 v117, 3, v115
    v_mul_u32_u24 v117, 304, v117
    v_lshl_add_u32 v92, v115, 1, v117
    v_add_u32 v92, v119, v92
    v_cmp_eq_u32 s[82:83], 3, v112
    v_mov_b32 v117, 0xffff
    v_mov_b32 v118, 0xffff0000
    v_cndmask_b32 v117, v117, v118, s[76:77]
    v_cndmask_b32 v14, v117, 0, s[78:79]
    v_cndmask_b32 v15, v117, 0, s[80:81]
    v_cndmask_b32 v16, 0, v117, s[78:79]
    v_cndmask_b32 v17, 0, v117, s[80:81]
    s_mov_b32 s91, 0x3e8b97f6
    v_mov_b32 v18, 0xf149f2ca
    s_lshl_b32 s53, s49, 3
    s_lshl_b32 s72, s53, 9
    s_add_u32 m0, s90, 98304
    s_mov_b32 s57, 344960
    buffer_load_dwordx4 v2, s[8:11], s57 offen offset:0 lds
    s_lshl_b32 s74, s53, 14
    s_lshl2_add_u32 s54, s48, s44
    s_lshl_b32 s54, s54, 10
    s_add_u32 s74, s74, s54
    s_add_u32 s74, s74, 4194304
    s_mul_i32 s68, s44, 534528
    s_add_u32 s68, s68, 0
    s_mul_i32 s69, s44, 534528
    s_add_u32 s69, s69, 132608
    s_mul_i32 s70, s44, 534528
    s_add_u32 s70, s70, 265216
    s_mul_i32 s71, s44, 534528
    s_add_u32 s71, s71, 397824
    s_cmp_eq_u32 s44, 3
    s_cselect_b32 s71, 2130706432, s71
    s_cmp_eq_u32 s49, 0
    s_cselect_b64 s[84:85], -1, 0
    s_andn2_b64 s[86:87], s[84:85], s[80:81]
    s_andn2_b64 s[84:85], s[84:85], s[78:79]
    s_and_b32 s53, s46, 7
    s_mul_i32 s54, s44, 28
    s_add_u32 s54, s54, s53
    s_add_u32 s54, s54, 12
    s_lshl_b32 s73, s54, 16
    s_lshl_b32 s54, s45, 9
    s_add_u32 s73, s73, s54
    s_lshl3_add_u32 s75, s44, s53
    s_lshl_b32 s75, s75, 13
    v_lshrrev_b32 v5, 2, v1
    v_lshlrev_b32 v5, 12, v5
    v_lshl_add_u32 v5, v114, 7, v5
    v_lshlrev_b32 v20, 7, v1
    s_mov_b32 s57, 354688
    buffer_load_dwordx4 v2, s[8:11], s57 offen offset:1024 lds
    s_add_u32 m0, s90, 106496
    s_mov_b32 s57, 430976
    buffer_load_dwordx4 v2, s[8:11], s57 offen offset:0 lds
    s_mov_b32 s57, 440704
    buffer_load_dwordx4 v2, s[8:11], s57 offen offset:1024 lds
    s_add_u32 m0, s90, 114688
    s_mov_b32 s57, 516992
    buffer_load_dwordx4 v2, s[8:11], s57 offen offset:0 lds
    s_mov_b32 s57, 526720
    buffer_load_dwordx4 v2, s[8:11], s57 offen offset:1024 lds
    s_add_u32 m0, s90, 122880
    s_mov_b32 s57, 603008
    buffer_load_dwordx4 v2, s[8:11], s57 offen offset:0 lds
    s_mov_b32 s57, 612736
    buffer_load_dwordx4 v2, s[8:11], s57 offen offset:1024 lds
    s_add_u32 m0, s90, 131072
    s_mov_b32 s57, 689024
    buffer_load_dwordx4 v2, s[8:11], s57 offen offset:0 lds
    s_mov_b32 s57, 698752
    buffer_load_dwordx4 v2, s[8:11], s57 offen offset:1024 lds
    s_add_u32 m0, s90, 139264
    s_mov_b32 s57, 775040
    buffer_load_dwordx4 v2, s[8:11], s57 offen offset:0 lds
    s_mov_b32 s57, 784768
    buffer_load_dwordx4 v2, s[8:11], s57 offen offset:1024 lds
    s_add_u32 m0, s90, 147456
    s_mov_b32 s57, 861056
    buffer_load_dwordx4 v2, s[8:11], s57 offen offset:0 lds
    s_mov_b32 s57, 870784
    buffer_load_dwordx4 v2, s[8:11], s57 offen offset:1024 lds
    s_add_u32 m0, s90, 155648
    s_mov_b32 s57, 947072
    buffer_load_dwordx4 v2, s[8:11], s57 offen offset:0 lds
    s_mov_b32 s57, 956800
    buffer_load_dwordx4 v2, s[8:11], s57 offen offset:1024 lds
    s_waitcnt vmcnt(20)
    v_cmp_eq_u32 vcc, 0, v29
    s_nop 0
    s_cbranch_vccz L_ok17
    s_mov_b32 s59, 20000
L_spin16:
    buffer_load_dword v29, off, s[40:43], 0 sc1
    s_waitcnt vmcnt(0)
    v_cmp_eq_u32 vcc, 0, v29
    s_nop 0
    s_cbranch_vccz L_ok17
    s_sub_u32 s59, s59, 1
    s_cbranch_scc0 L_spin16
L_ok17:
    v_readfirstlane_b32 s47, v29
    s_barrier
    s_cmp_lg_u32 s44, 0
    s_cbranch_scc1 L_nopub18
    s_lshl_b32 s60, s2, 5
    s_add_u32 s60, s60, 12582912
    v_mov_b32 v30, s47
    s_mov_b64 exec, 1
    buffer_store_dword v30, off, s[24:27], s60 sc1
    s_mov_b64 exec, -1
L_nopub18:
    s_waitcnt vmcnt(18)
    s_barrier
    s_add_u32 m0, s90, 0
    s_mov_b32 s57, 1033088
    buffer_load_dwordx4 v2, s[8:11], s57 offen offset:0 lds
    s_mov_b32 s57, 1042816
    buffer_load_dwordx4 v2, s[8:11], s57 offen offset:1024 lds
    ds_read_b64_tr_b16 a[8:9], v6 offset:0
    ds_read_b64_tr_b16 a[10:11], v6 offset:1024
    ds_read_b64_tr_b16 a[12:13], v7 offset:0
    ds_read_b64_tr_b16 a[14:15], v7 offset:1024
    s_add_u32 m0, s90, 8192
    s_mov_b32 s57, 1119104
    buffer_load_dwordx4 v2, s[8:11], s57 offen offset:0 lds
    s_mov_b32 s57, 1128832
    buffer_load_dwordx4 v2, s[8:11], s57 offen offset:1024 lds
    ds_read_b64_tr_b16 a[32:33], v6 offset:8192
    ds_read_b64_tr_b16 a[34:35], v6 offset:9216
    ds_read_b64_tr_b16 a[36:37], v7 offset:8192
    ds_read_b64_tr_b16 a[38:39], v7 offset:9216
    s_add_u32 m0, s90, 16384
    s_mov_b32 s57, 1792
    buffer_load_dwordx4 v2, s[8:11], s57 offen offset:0 lds
    s_mov_b32 s57, 11520
    buffer_load_dwordx4 v2, s[8:11], s57 offen offset:1024 lds
    ds_read_b64_tr_b16 a[56:57], v6 offset:16384
    ds_read_b64_tr_b16 a[58:59], v6 offset:17408
    ds_read_b64_tr_b16 a[60:61], v7 offset:16384
    ds_read_b64_tr_b16 a[62:63], v7 offset:17408
    s_waitcnt vmcnt(18)
    s_waitcnt lgkmcnt(0)
    s_barrier
    s_add_u32 m0, s90, 24576
    s_mov_b32 s57, 87808
    buffer_load_dwordx4 v2, s[8:11], s57 offen offset:0 lds
    s_mov_b32 s57, 97536
    buffer_load_dwordx4 v2, s[8:11], s57 offen offset:1024 lds
    ds_read_b64_tr_b16 a[80:81], v6 offset:24576
    ds_read_b64_tr_b16 a[82:83], v6 offset:25600
    ds_read_b64_tr_b16 a[84:85], v7 offset:24576
    ds_read_b64_tr_b16 a[86:87], v7 offset:25600
    s_add_u32 m0, s90, 32768
    s_mov_b32 s57, 173824
    buffer_load_dwordx4 v2, s[8:11], s57 offen offset:0 lds
    s_mov_b32 s57, 183552
    buffer_load_dwordx4 v2, s[8:11], s57 offen offset:1024 lds
    ds_read_b64_tr_b16 a[104:105], v6 offset:32768
    ds_read_b64_tr_b16 a[106:107], v6 offset:33792
    ds_read_b64_tr_b16 a[108:109], v7 offset:32768
    ds_read_b64_tr_b16 a[110:111], v7 offset:33792
    s_add_u32 m0, s90, 40960
    s_mov_b32 s57, 259840
    buffer_load_dwordx4 v2, s[8:11], s57 offen offset:0 lds
    s_mov_b32 s57, 269568
    buffer_load_dwordx4 v2, s[8:11], s57 offen offset:1024 lds
    ds_read_b64_tr_b16 a[128:129], v6 offset:40960
    ds_read_b64_tr_b16 a[130:131], v6 offset:41984
    ds_read_b64_tr_b16 a[132:133], v7 offset:40960
    ds_read_b64_tr_b16 a[134:135], v7 offset:41984
    s_waitcnt vmcnt(18)
    s_waitcnt lgkmcnt(0)
    s_barrier
    s_add_u32 m0, s90, 65536
    s_mov_b32 s57, 345856
    buffer_load_dwordx4 v2, s[8:11], s57 offen offset:0 lds
    s_mov_b32 s57, 355584
    buffer_load_dwordx4 v2, s[8:11], s57 offen offset:1024 lds
    ds_read_b64_tr_b16 a[152:153], v10 offset:0
    ds_read_b64_tr_b16 a[154:155], v10 offset:1024
    ds_read_b64_tr_b16 a[156:157], v11 offset:0
    ds_read_b64_tr_b16 a[158:159], v11 offset:1024
    s_add_u32 m0, s90, 73728
    s_mov_b32 s57, 431872
    buffer_load_dwordx4 v2, s[8:11], s57 offen offset:0 lds
    s_mov_b32 s57, 441600
    buffer_load_dwordx4 v2, s[8:11], s57 offen offset:1024 lds
    ds_read_b64_tr_b16 a[176:177], v10 offset:8192
    ds_read_b64_tr_b16 a[178:179], v10 offset:9216
    ds_read_b64_tr_b16 a[180:181], v11 offset:8192
    ds_read_b64_tr_b16 a[182:183], v11 offset:9216
    s_add_u32 m0, s90, 81920
    s_mov_b32 s57, 517888
    buffer_load_dwordx4 v2, s[8:11], s57 offen offset:0 lds
    s_mov_b32 s57, 527616
    buffer_load_dwordx4 v2, s[8:11], s57 offen offset:1024 lds
    ds_read_b64_tr_b16 a[200:201], v10 offset:16384
    ds_read_b64_tr_b16 a[202:203], v10 offset:17408
    ds_read_b64_tr_b16 a[204:205], v11 offset:16384
    ds_read_b64_tr_b16 a[206:207], v11 offset:17408
    s_waitcnt vmcnt(18)
    s_waitcnt lgkmcnt(0)
    s_barrier
    s_add_u32 m0, s90, 90112
    s_mov_b32 s57, 603904
    buffer_load_dwordx4 v2, s[8:11], s57 offen offset:0 lds
    s_mov_b32 s57, 613632
    buffer_load_dwordx4 v2, s[8:11], s57 offen offset:1024 lds
    ds_read_b64_tr_b16 a[224:225], v10 offset:24576
    ds_read_b64_tr_b16 a[226:227], v10 offset:25600
    ds_read_b64_tr_b16 a[228:229], v11 offset:24576
    ds_read_b64_tr_b16 a[230:231], v11 offset:25600
    s_add_u32 m0, s90, 98304
    s_mov_b32 s57, 689920
    buffer_load_dwordx4 v2, s[8:11], s57 offen offset:0 lds
    s_mov_b32 s57, 699648
    buffer_load_dwordx4 v2, s[8:11], s57 offen offset:1024 lds
    ds_read_b64_tr_b16 a[248:249], v10 offset:32768
    ds_read_b64_tr_b16 a[250:251], v10 offset:33792
    ds_read_b64_tr_b16 a[252:253], v11 offset:32768
    ds_read_b64_tr_b16 a[254:255], v11 offset:33792
    s_add_u32 m0, s90, 106496
    s_mov_b32 s57, 775936
    buffer_load_dwordx4 v2, s[8:11], s57 offen offset:0 lds
    s_mov_b32 s57, 785664
    buffer_load_dwordx4 v2, s[8:11], s57 offen offset:1024 lds
    ds_read_b64_tr_b16 v[192:193], v10 offset:40960
    ds_read_b64_tr_b16 v[194:195], v10 offset:41984
    ds_read_b64_tr_b16 v[196:197], v11 offset:40960
    ds_read_b64_tr_b16 v[198:199], v11 offset:41984
    s_waitcnt vmcnt(18)
    s_waitcnt lgkmcnt(0)
    s_barrier
    ds_read_b64_tr_b16 v[216:217], v120 offset:0
    ds_read_b64_tr_b16 v[218:219], v120 offset:1024
    ds_read_b64_tr_b16 v[220:221], v121 offset:0
    ds_read_b64_tr_b16 v[222:223], v121 offset:1024
    ds_read_b64_tr_b16 v[240:241], v120 offset:8192
    ds_read_b64_tr_b16 v[242:243], v120 offset:9216
    ds_read_b64_tr_b16 v[244:245], v121 offset:8192
    ds_read_b64_tr_b16 v[246:247], v121 offset:9216
    buffer_load_dword v21, v19, s[24:27], 0 offen sc1
    ds_read_b64_tr_b16 a[16:17], v122 offset:16384
    ds_read_b64_tr_b16 a[18:19], v122 offset:17408
    ds_read_b64_tr_b16 a[20:21], v123 offset:16384
    ds_read_b64_tr_b16 a[22:23], v123 offset:17408
    s_add_u32 m0, s90, 114688
    s_mov_b32 s57, 861952
    buffer_load_dwordx4 v2, s[8:11], s57 offen offset:0 lds
    s_waitcnt vmcnt(14)
    s_waitcnt lgkmcnt(0)
    s_barrier
    ds_read_b64_tr_b16 a[40:41], v122 offset:24576
    ds_read_b64_tr_b16 a[42:43], v122 offset:25600
    ds_read_b64_tr_b16 a[44:45], v123 offset:24576
    ds_read_b64_tr_b16 a[46:47], v123 offset:25600
    ds_read_b64_tr_b16 a[64:65], v122 offset:32768
    ds_read_b64_tr_b16 a[66:67], v122 offset:33792
    ds_read_b64_tr_b16 a[68:69], v123 offset:32768
    ds_read_b64_tr_b16 a[70:71], v123 offset:33792
    ds_read_b64_tr_b16 a[88:89], v122 offset:40960
    ds_read_b64_tr_b16 a[90:91], v122 offset:41984
    ds_read_b64_tr_b16 a[92:93], v123 offset:40960
    ds_read_b64_tr_b16 a[94:95], v123 offset:41984
    s_mov_b32 s57, 871680
    buffer_load_dwordx4 v2, s[8:11], s57 offen offset:1024 lds
    s_add_u32 m0, s90, 122880
    s_mov_b32 s57, 947968
    buffer_load_dwordx4 v2, s[8:11], s57 offen offset:0 lds
    s_mov_b32 s57, 957696
    buffer_load_dwordx4 v2, s[8:11], s57 offen offset:1024 lds
    s_add_u32 m0, s90, 131072
    s_mov_b32 s57, 1033984
    buffer_load_dwordx4 v2, s[8:11], s57 offen offset:0 lds
    s_waitcnt vmcnt(12)
    s_waitcnt lgkmcnt(0)
    s_barrier
    ds_read_b64_tr_b16 a[112:113], v8 offset:0
    ds_read_b64_tr_b16 a[114:115], v8 offset:1024
    ds_read_b64_tr_b16 a[116:117], v9 offset:0
    ds_read_b64_tr_b16 a[118:119], v9 offset:1024
    ds_read_b64_tr_b16 a[136:137], v8 offset:8192
    ds_read_b64_tr_b16 a[138:139], v8 offset:9216
    ds_read_b64_tr_b16 a[140:141], v9 offset:8192
    ds_read_b64_tr_b16 a[142:143], v9 offset:9216
    ds_read_b64_tr_b16 a[160:161], v8 offset:16384
    ds_read_b64_tr_b16 a[162:163], v8 offset:17408
    ds_read_b64_tr_b16 a[164:165], v9 offset:16384
    ds_read_b64_tr_b16 a[166:167], v9 offset:17408
    s_mov_b32 s57, 1043712
    buffer_load_dwordx4 v2, s[8:11], s57 offen offset:1024 lds
    s_waitcnt vmcnt(6)
    v_cmp_ne_u32 vcc, s47, v21
    s_nop 0
    s_cbranch_vccz L_ok20
    s_mov_b32 s59, 20000
L_spin19:
    buffer_load_dword v21, v19, s[24:27], 0 offen sc1
    s_waitcnt vmcnt(0)
    v_cmp_ne_u32 vcc, s47, v21
    s_nop 0
    s_cbranch_vccz L_ok20
    s_sub_u32 s59, s59, 1
    s_cbranch_scc0 L_spin19
L_ok20:
    s_add_u32 m0, s52, 0
    s_sub_u32 s58, s72, 512
    s_max_i32 s58, s58, 0
    s_add_u32 s57, s58, s68
    buffer_load_dwordx4 v3, s[24:27], s57 offen offset:0 sc1 lds
    s_add_u32 s57, s58, s69
    buffer_load_dwordx4 v3, s[24:27], s57 offen offset:1024 sc1 lds
    s_add_u32 s57, s58, s70
    buffer_load_dwordx4 v24, s[24:27], s57 offen offset:2048 sc1 lds
    s_add_u32 s57, s58, s71
    buffer_load_dwordx4 v3, s[24:27], s57 offen offset:3072 sc1 lds
    s_add_u32 m0, s52, 16384
    s_add_u32 s58, s72, 0
    s_add_u32 s57, s58, s68
    buffer_load_dwordx4 v3, s[24:27], s57 offen offset:0 sc1 lds
    s_waitcnt lgkmcnt(0)
    s_barrier
    ds_read_b64_tr_b16 a[184:185], v8 offset:24576
    ds_read_b64_tr_b16 a[186:187], v8 offset:25600
    ds_read_b64_tr_b16 a[188:189], v9 offset:24576
    ds_read_b64_tr_b16 a[190:191], v9 offset:25600
    ds_read_b64_tr_b16 a[208:209], v8 offset:32768
    ds_read_b64_tr_b16 a[210:211], v8 offset:33792
    ds_read_b64_tr_b16 a[212:213], v9 offset:32768
    ds_read_b64_tr_b16 a[214:215], v9 offset:33792
    ds_read_b64_tr_b16 a[232:233], v8 offset:40960
    ds_read_b64_tr_b16 a[234:235], v8 offset:41984
    ds_read_b64_tr_b16 a[236:237], v9 offset:40960
    ds_read_b64_tr_b16 a[238:239], v9 offset:41984
    s_add_u32 s57, s58, s69
    buffer_load_dwordx4 v3, s[24:27], s57 offen offset:1024 sc1 lds
    s_add_u32 s57, s58, s70
    buffer_load_dwordx4 v24, s[24:27], s57 offen offset:2048 sc1 lds
    s_add_u32 s57, s58, s71
    buffer_load_dwordx4 v3, s[24:27], s57 offen offset:3072 sc1 lds
    s_add_u32 m0, s90, 139264
    s_mov_b32 s57, 1120000
    buffer_load_dwordx4 v2, s[8:11], s57 offen offset:0 lds
    s_mov_b32 s57, 1129728
    buffer_load_dwordx4 v2, s[8:11], s57 offen offset:1024 lds
    s_add_u32 m0, s90, 147456
    s_mov_b32 s57, 0
    buffer_load_dwordx4 v2, s[8:11], s57 offen offset:0 lds
    s_mov_b32 s57, 9728
    buffer_load_dwordx4 v2, s[8:11], s57 offen offset:1024 lds
    s_add_u32 m0, s90, 155648
    s_mov_b32 s57, 86016
    buffer_load_dwordx4 v2, s[8:11], s57 offen offset:0 lds
    s_mov_b32 s57, 95744
    buffer_load_dwordx4 v2, s[8:11], s57 offen offset:1024 lds
    s_add_u32 m0, s52, 32768
    s_add_u32 s58, s72, 512
    s_add_u32 s57, s58, s68
    buffer_load_dwordx4 v3, s[24:27], s57 offen offset:0 sc1 lds
    s_add_u32 s57, s58, s69
    buffer_load_dwordx4 v3, s[24:27], s57 offen offset:1024 sc1 lds
    s_waitcnt vmcnt(12)
    s_waitcnt lgkmcnt(0)
    s_barrier
    ds_read_b64_tr_b16 v[120:121], v4 offset:0
    ds_read_b64_tr_b16 v[122:123], v25 offset:0
    ds_read_b64_tr_b16 v[124:125], v4 offset:1024
    ds_read_b64_tr_b16 v[126:127], v25 offset:1024
    ds_read_b64_tr_b16 v[128:129], v4 offset:2048
    ds_read_b64_tr_b16 v[130:131], v25 offset:2048
    ds_read_b64_tr_b16 v[132:133], v4 offset:3072
    ds_read_b64_tr_b16 v[134:135], v25 offset:3072
    ds_read_b64_tr_b16 v[136:137], v4 offset:4096
    ds_read_b64_tr_b16 v[138:139], v25 offset:4096
    ds_read_b64_tr_b16 v[140:141], v4 offset:5120
    ds_read_b64_tr_b16 v[142:143], v25 offset:5120
    ds_read_b64_tr_b16 v[144:145], v4 offset:6144
    ds_read_b64_tr_b16 v[146:147], v25 offset:6144
    ds_read_b64_tr_b16 v[148:149], v4 offset:7168
    ds_read_b64_tr_b16 v[150:151], v25 offset:7168
    ds_read_b64_tr_b16 v[152:153], v4 offset:8192
    ds_read_b64_tr_b16 v[154:155], v25 offset:8192
    ds_read_b64_tr_b16 v[156:157], v4 offset:9216
    ds_read_b64_tr_b16 v[158:159], v25 offset:9216
    ds_read_b64_tr_b16 v[160:161], v4 offset:10240
    ds_read_b64_tr_b16 v[162:163], v25 offset:10240
    ds_read_b64_tr_b16 v[164:165], v4 offset:11264
    ds_read_b64_tr_b16 v[166:167], v25 offset:11264
    ds_read_b64_tr_b16 v[168:169], v4 offset:12288
    ds_read_b64_tr_b16 v[170:171], v25 offset:12288
    ds_read_b64_tr_b16 v[172:173], v4 offset:13312
    ds_read_b64_tr_b16 v[174:175], v25 offset:13312
    s_waitcnt lgkmcnt(15)
    v_mfma_f32_16x16x32_bf16 v[96:99], a[8:11], v[120:123], 0
    s_add_u32 s57, s58, s70
    ds_read_b64_tr_b16 v[176:177], v12 offset:0
    v_mfma_f32_16x16x32_bf16 v[96:99], a[32:35], v[124:127], v[96:99]
    buffer_load_dwordx4 v24, s[24:27], s57 offen offset:2048 sc1 lds
    v_mfma_f32_16x16x32_bf16 v[96:99], a[56:59], v[128:131], v[96:99]
    ds_read_b64_tr_b16 v[178:179], v12 offset:1024
    ds_read_b64_tr_b16 v[180:181], v13 offset:0
    v_mfma_f32_16x16x32_bf16 v[96:99], a[80:83], v[132:135], v[96:99]
    ds_read_b64_tr_b16 v[182:183], v13 offset:1024
    ds_read_b64_tr_b16 v[200:201], v12 offset:8192
    v_mfma_f32_16x16x32_bf16 v[96:99], a[104:107], v[136:139], v[96:99]
    s_add_u32 s57, s58, s71
    ds_read_b64_tr_b16 v[202:203], v12 offset:9216
    v_mfma_f32_16x16x32_bf16 v[96:99], a[128:131], v[140:143], v[96:99]
    buffer_load_dwordx4 v3, s[24:27], s57 offen offset:3072 sc1 lds
    s_waitcnt lgkmcnt(15)
    v_mfma_f32_16x16x32_bf16 v[96:99], a[152:155], v[144:147], v[96:99]
    ds_read_b64_tr_b16 v[204:205], v13 offset:8192
    ds_read_b64_tr_b16 v[206:207], v13 offset:9216
    v_mfma_f32_16x16x32_bf16 v[96:99], a[176:179], v[148:151], v[96:99]
    ds_read_b64_tr_b16 v[224:225], v12 offset:16384
    ds_read_b64_tr_b16 v[226:227], v12 offset:17408
    v_mfma_f32_16x16x32_bf16 v[96:99], a[200:203], v[152:155], v[96:99]
    s_add_u32 m0, s90, 65536
    s_mov_b32 s57, 172032
    ds_read_b64_tr_b16 v[228:229], v13 offset:16384
    s_waitcnt lgkmcnt(15)
    v_mfma_f32_16x16x32_bf16 v[96:99], a[224:227], v[156:159], v[96:99]
    buffer_load_dwordx4 v2, s[8:11], s57 offen offset:0 lds
    v_mfma_f32_16x16x32_bf16 v[96:99], a[248:251], v[160:163], v[96:99]
    ds_read_b64_tr_b16 v[230:231], v13 offset:17408
    v_mfma_f32_16x16x32_bf16 v[96:99], v[192:195], v[164:167], v[96:99]
    s_waitcnt lgkmcnt(12)
    v_mfma_f32_16x16x32_bf16 v[96:99], v[216:219], v[168:171], v[96:99]
    s_mov_b32 s57, 181760
    v_mfma_f32_16x16x32_bf16 v[96:99], v[240:243], v[172:175], v[96:99]
    buffer_load_dwordx4 v2, s[8:11], s57 offen offset:1024 lds
    s_waitcnt vmcnt(12)
    s_barrier
    v_mfma_f32_16x16x32_bf16 v[100:103], a[12:15], v[120:123], 0
    ds_read_b64_tr_b16 v[120:121], v4 offset:16384
    ds_read_b64_tr_b16 v[122:123], v25 offset:16384
    v_mfma_f32_16x16x32_bf16 v[100:103], a[36:39], v[124:127], v[100:103]
    ds_read_b64_tr_b16 v[124:125], v4 offset:17408
    ds_read_b64_tr_b16 v[126:127], v25 offset:17408
    v_mfma_f32_16x16x32_bf16 v[100:103], a[60:63], v[128:131], v[100:103]
    ds_read_b64_tr_b16 v[128:129], v4 offset:18432
    ds_read_b64_tr_b16 v[130:131], v25 offset:18432
    s_add_u32 m0, s90, 73728
    s_mov_b32 s57, 258048
    v_mfma_f32_16x16x32_bf16 v[100:103], a[84:87], v[132:135], v[100:103]
    ds_read_b64_tr_b16 v[132:133], v4 offset:19456
    ds_read_b64_tr_b16 v[134:135], v25 offset:19456
    buffer_load_dwordx4 v2, s[8:11], s57 offen offset:0 lds
    v_mfma_f32_16x16x32_bf16 v[100:103], a[108:111], v[136:139], v[100:103]
    ds_read_b64_tr_b16 v[136:137], v4 offset:20480
    ds_read_b64_tr_b16 v[138:139], v25 offset:20480
    v_mfma_f32_16x16x32_bf16 v[100:103], a[132:135], v[140:143], v[100:103]
    ds_read_b64_tr_b16 v[140:141], v4 offset:21504
    ds_read_b64_tr_b16 v[142:143], v25 offset:21504
    v_mfma_f32_16x16x32_bf16 v[100:103], a[156:159], v[144:147], v[100:103]
    ds_read_b64_tr_b16 v[144:145], v4 offset:22528
    ds_read_b64_tr_b16 v[146:147], v25 offset:22528
    s_mov_b32 s57, 267776
    v_mfma_f32_16x16x32_bf16 v[100:103], a[180:183], v[148:151], v[100:103]
    ds_read_b64_tr_b16 v[148:149], v4 offset:23552
    ds_read_b64_tr_b16 v[150:151], v25 offset:23552
    buffer_load_dwordx4 v2, s[8:11], s57 offen offset:1024 lds
    v_mfma_f32_16x16x32_bf16 v[100:103], a[204:207], v[152:155], v[100:103]
    ds_read_b64_tr_b16 v[152:153], v4 offset:24576
    ds_read_b64_tr_b16 v[154:155], v25 offset:24576
    v_mfma_f32_16x16x32_bf16 v[100:103], a[228:231], v[156:159], v[100:103]
    ds_read_b64_tr_b16 v[156:157], v4 offset:25600
    ds_read_b64_tr_b16 v[158:159], v25 offset:25600
    v_mfma_f32_16x16x32_bf16 v[100:103], a[252:255], v[160:163], v[100:103]
    ds_read_b64_tr_b16 v[160:161], v4 offset:26624
    ds_read_b64_tr_b16 v[162:163], v25 offset:26624
    s_add_u32 m0, s90, 81920
    s_mov_b32 s57, 344064
    v_mfma_f32_16x16x32_bf16 v[100:103], v[196:199], v[164:167], v[100:103]
    ds_read_b64_tr_b16 v[164:165], v4 offset:27648
    ds_read_b64_tr_b16 v[166:167], v25 offset:27648
    buffer_load_dwordx4 v2, s[8:11], s57 offen offset:0 lds
    v_mfma_f32_16x16x32_bf16 v[100:103], v[220:223], v[168:171], v[100:103]
    ds_read_b64_tr_b16 v[168:169], v4 offset:28672
    ds_read_b64_tr_b16 v[170:171], v25 offset:28672
    v_mfma_f32_16x16x32_bf16 v[100:103], v[244:247], v[172:175], v[100:103]
    ds_read_b64_tr_b16 v[172:173], v4 offset:29696
    ds_read_b64_tr_b16 v[174:175], v25 offset:29696
    s_waitcnt lgkmcnt(15)
    v_mfma_f32_16x16x32_bf16 v[104:107], a[8:11], v[120:123], 0
    s_mov_b32 s57, 353792
    v_cvt_pk_bf16_f32 v52, v96, v97
    v_mfma_f32_16x16x32_bf16 v[104:107], a[32:35], v[124:127], v[104:107]
    buffer_load_dwordx4 v2, s[8:11], s57 offen offset:1024 lds
    v_mfma_f32_16x16x32_bf16 v[104:107], a[56:59], v[128:131], v[104:107]
    v_cvt_pk_bf16_f32 v53, v98, v99
    v_mfma_f32_16x16x32_bf16 v[104:107], a[80:83], v[132:135], v[104:107]
    s_waitcnt vmcnt(10)
    s_barrier
    v_mfma_f32_16x16x32_bf16 v[104:107], a[104:107], v[136:139], v[104:107]
    s_add_u32 m0, s90, 90112
    s_mov_b32 s57, 430080
    ds_read_b64_tr_b16 v[248:249], v12 offset:24576
    v_mfma_f32_16x16x32_bf16 v[104:107], a[128:131], v[140:143], v[104:107]
    buffer_load_dwordx4 v2, s[8:11], s57 offen offset:0 lds
    s_waitcnt lgkmcnt(11)
    v_mfma_f32_16x16x32_bf16 v[104:107], a[152:155], v[144:147], v[104:107]
    v_cvt_pk_bf16_f32 v54, v100, v101
    v_cvt_pk_bf16_f32 v55, v102, v103
    v_mfma_f32_16x16x32_bf16 v[104:107], a[176:179], v[148:151], v[104:107]
    v_cndmask_b32 v54, v54, 0, s[82:83]
    v_cndmask_b32 v55, v55, 0, s[82:83]
    v_mfma_f32_16x16x32_bf16 v[104:107], a[200:203], v[152:155], v[104:107]
    s_mov_b32 s57, 439808
    ds_read_b64_tr_b16 v[250:251], v12 offset:25600
    s_waitcnt lgkmcnt(6)
    v_mfma_f32_16x16x32_bf16 v[104:107], a[224:227], v[156:159], v[104:107]
    buffer_load_dwordx4 v2, s[8:11], s57 offen offset:1024 lds
    v_mfma_f32_16x16x32_bf16 v[104:107], a[248:251], v[160:163], v[104:107]
    ds_read_b64_tr_b16 v[252:253], v13 offset:24576
    ds_read_b64_tr_b16 v[254:255], v13 offset:25600
    v_mfma_f32_16x16x32_bf16 v[104:107], v[192:195], v[164:167], v[104:107]
    ds_read_b64_tr_b16 a[0:1], v10 offset:32768
    ds_read_b64_tr_b16 a[2:3], v10 offset:33792
    s_waitcnt lgkmcnt(6)
    v_mfma_f32_16x16x32_bf16 v[104:107], v[216:219], v[168:171], v[104:107]
    s_add_u32 m0, s90, 98304
    s_mov_b32 s57, 516096
    ds_read_b64_tr_b16 a[4:5], v11 offset:32768
    v_mfma_f32_16x16x32_bf16 v[104:107], v[240:243], v[172:175], v[104:107]
    buffer_load_dwordx4 v2, s[8:11], s57 offen offset:0 lds
    s_waitcnt vmcnt(9)
    s_barrier
    v_mfma_f32_16x16x32_bf16 v[108:111], a[12:15], v[120:123], 0
    ds_read_b64_tr_b16 v[120:121], v4 offset:32768
    ds_read_b64_tr_b16 v[122:123], v25 offset:32768
    v_mfma_f32_16x16x32_bf16 v[108:111], a[36:39], v[124:127], v[108:111]
    ds_read_b64_tr_b16 v[124:125], v4 offset:33792
    ds_read_b64_tr_b16 v[126:127], v25 offset:33792
    v_mfma_f32_16x16x32_bf16 v[108:111], a[60:63], v[128:131], v[108:111]
    ds_read_b64_tr_b16 v[128:129], v4 offset:34816
    ds_read_b64_tr_b16 v[130:131], v25 offset:34816
    s_mov_b32 s57, 525824
    v_mfma_f32_16x16x32_bf16 v[108:111], a[84:87], v[132:135], v[108:111]
    ds_read_b64_tr_b16 v[132:133], v4 offset:35840
    ds_read_b64_tr_b16 v[134:135], v25 offset:35840
    buffer_load_dwordx4 v2, s[8:11], s57 offen offset:1024 lds
    v_mfma_f32_16x16x32_bf16 v[108:111], a[108:111], v[136:139], v[108:111]
    ds_read_b64_tr_b16 v[136:137], v4 offset:36864
    ds_read_b64_tr_b16 v[138:139], v25 offset:36864
    v_mfma_f32_16x16x32_bf16 v[108:111], a[132:135], v[140:143], v[108:111]
    ds_read_b64_tr_b16 v[140:141], v4 offset:37888
    ds_read_b64_tr_b16 v[142:143], v25 offset:37888
    v_mfma_f32_16x16x32_bf16 v[108:111], a[156:159], v[144:147], v[108:111]
    ds_read_b64_tr_b16 v[144:145], v4 offset:38912
    ds_read_b64_tr_b16 v[146:147], v25 offset:38912
    s_add_u32 m0, s90, 106496
    s_mov_b32 s57, 602112
    v_mfma_f32_16x16x32_bf16 v[108:111], a[180:183], v[148:151], v[108:111]
    ds_read_b64_tr_b16 v[148:149], v4 offset:39936
    ds_read_b64_tr_b16 v[150:151], v25 offset:39936
    buffer_load_dwordx4 v2, s[8:11], s57 offen offset:0 lds
    v_mfma_f32_16x16x32_bf16 v[108:111], a[204:207], v[152:155], v[108:111]
    ds_read_b64_tr_b16 v[152:153], v4 offset:40960
    ds_read_b64_tr_b16 v[154:155], v25 offset:40960
    v_mfma_f32_16x16x32_bf16 v[108:111], a[228:231], v[156:159], v[108:111]
    ds_read_b64_tr_b16 v[156:157], v4 offset:41984
    ds_read_b64_tr_b16 v[158:159], v25 offset:41984
    v_mfma_f32_16x16x32_bf16 v[108:111], a[252:255], v[160:163], v[108:111]
    ds_read_b64_tr_b16 v[160:161], v4 offset:43008
    ds_read_b64_tr_b16 v[162:163], v25 offset:43008
    s_mov_b32 s57, 611840
    v_mfma_f32_16x16x32_bf16 v[108:111], v[196:199], v[164:167], v[108:111]
    ds_read_b64_tr_b16 v[164:165], v4 offset:44032
    ds_read_b64_tr_b16 v[166:167], v25 offset:44032
    buffer_load_dwordx4 v2, s[8:11], s57 offen offset:1024 lds
    v_mfma_f32_16x16x32_bf16 v[108:111], v[220:223], v[168:171], v[108:111]
    ds_read_b64_tr_b16 v[168:169], v4 offset:45056
    ds_read_b64_tr_b16 v[170:171], v25 offset:45056
    v_mfma_f32_16x16x32_bf16 v[108:111], v[244:247], v[172:175], v[108:111]
    ds_read_b64_tr_b16 v[172:173], v4 offset:46080
    ds_read_b64_tr_b16 v[174:175], v25 offset:46080
    s_waitcnt lgkmcnt(15)
    v_mfma_f32_16x16x32_bf16 v[112:115], a[8:11], v[120:123], 0
    s_add_u32 m0, s90, 114688
    s_mov_b32 s57, 688128
    v_cvt_pk_bf16_f32 v56, v104, v105
    v_mfma_f32_16x16x32_bf16 v[112:115], a[32:35], v[124:127], v[112:115]
    buffer_load_dwordx4 v2, s[8:11], s57 offen offset:0 lds
    v_mfma_f32_16x16x32_bf16 v[112:115], a[56:59], v[128:131], v[112:115]
    v_cvt_pk_bf16_f32 v57, v106, v107
    ds_read_b64_tr_b16 a[6:7], v11 offset:33792
    v_mfma_f32_16x16x32_bf16 v[112:115], a[80:83], v[132:135], v[112:115]
    ds_read_b64_tr_b16 a[24:25], v10 offset:40960
    ds_read_b64_tr_b16 a[26:27], v10 offset:41984
    v_mfma_f32_16x16x32_bf16 v[112:115], a[104:107], v[136:139], v[112:115]
    s_mov_b32 s57, 697856
    ds_read_b64_tr_b16 a[28:29], v11 offset:40960
    v_mfma_f32_16x16x32_bf16 v[112:115], a[128:131], v[140:143], v[112:115]
    buffer_load_dwordx4 v2, s[8:11], s57 offen offset:1024 lds
    s_waitcnt lgkmcnt(14)
    v_mfma_f32_16x16x32_bf16 v[112:115], a[152:155], v[144:147], v[112:115]
    v_cvt_pk_bf16_f32 v58, v108, v109
    v_cvt_pk_bf16_f32 v59, v110, v111
    v_mfma_f32_16x16x32_bf16 v[112:115], a[176:179], v[148:151], v[112:115]
    v_cndmask_b32 v58, v58, 0, s[82:83]
    v_cndmask_b32 v59, v59, 0, s[82:83]
    v_mfma_f32_16x16x32_bf16 v[112:115], a[200:203], v[152:155], v[112:115]
    s_add_u32 m0, s90, 122880
    s_mov_b32 s57, 774144
    ds_read_b64_tr_b16 a[30:31], v11 offset:41984
    s_waitcnt lgkmcnt(9)
    v_mfma_f32_16x16x32_bf16 v[112:115], a[224:227], v[156:159], v[112:115]
    buffer_load_dwordx4 v2, s[8:11], s57 offen offset:0 lds
    v_mfma_f32_16x16x32_bf16 v[112:115], a[248:251], v[160:163], v[112:115]
    v_mfma_f32_16x16x32_bf16 v[112:115], v[192:195], v[164:167], v[112:115]
    s_waitcnt lgkmcnt(5)
    v_mfma_f32_16x16x32_bf16 v[112:115], v[216:219], v[168:171], v[112:115]
    s_mov_b32 s57, 783872
    v_mfma_f32_16x16x32_bf16 v[112:115], v[240:243], v[172:175], v[112:115]
    buffer_load_dwordx4 v2, s[8:11], s57 offen offset:1024 lds
    v_mfma_f32_16x16x32_bf16 v[116:119], a[12:15], v[120:123], 0
    v_mfma_f32_16x16x32_bf16 v[116:119], a[36:39], v[124:127], v[116:119]
    s_waitcnt vmcnt(10)
    s_waitcnt lgkmcnt(0)
    s_barrier
    v_mfma_f32_16x16x32_bf16 v[116:119], a[60:63], v[128:131], v[116:119]
    s_add_u32 m0, s90, 131072
    s_mov_b32 s57, 860160
    ds_read_b64_tr_b16 a[48:49], v6 offset:0
    v_mfma_f32_16x16x32_bf16 v[116:119], a[84:87], v[132:135], v[116:119]
    buffer_load_dwordx4 v2, s[8:11], s57 offen offset:0 lds
    v_mfma_f32_16x16x32_bf16 v[116:119], a[108:111], v[136:139], v[116:119]
    ds_read_b64_tr_b16 a[50:51], v6 offset:1024
    ds_read_b64_tr_b16 a[52:53], v7 offset:0
    v_mfma_f32_16x16x32_bf16 v[116:119], a[132:135], v[140:143], v[116:119]
    ds_read_b64_tr_b16 a[54:55], v7 offset:1024
    ds_read_b64_tr_b16 a[72:73], v6 offset:8192
    v_mfma_f32_16x16x32_bf16 v[116:119], a[156:159], v[144:147], v[116:119]
    s_mov_b32 s57, 869888
    v_cvt_pk_bf16_f32 v60, v112, v113
    v_mfma_f32_16x16x32_bf16 v[116:119], a[180:183], v[148:151], v[116:119]
    buffer_load_dwordx4 v2, s[8:11], s57 offen offset:1024 lds
    v_mfma_f32_16x16x32_bf16 v[116:119], a[204:207], v[152:155], v[116:119]
    v_cvt_pk_bf16_f32 v61, v114, v115
    ds_read_b64_tr_b16 a[74:75], v6 offset:9216
    v_mfma_f32_16x16x32_bf16 v[116:119], a[228:231], v[156:159], v[116:119]
    ds_read_b64_tr_b16 a[76:77], v7 offset:8192
    ds_read_b64_tr_b16 a[78:79], v7 offset:9216
    v_mfma_f32_16x16x32_bf16 v[116:119], a[252:255], v[160:163], v[116:119]
    s_add_u32 m0, s90, 139264
    s_mov_b32 s57, 946176
    ds_read_b64_tr_b16 a[96:97], v6 offset:16384
    v_mfma_f32_16x16x32_bf16 v[116:119], v[196:199], v[164:167], v[116:119]
    buffer_load_dwordx4 v2, s[8:11], s57 offen offset:0 lds
    v_mfma_f32_16x16x32_bf16 v[116:119], v[220:223], v[168:171], v[116:119]
    ds_read_b64_tr_b16 a[98:99], v6 offset:17408
    ds_read_b64_tr_b16 a[100:101], v7 offset:16384
    v_mfma_f32_16x16x32_bf16 v[116:119], v[244:247], v[172:175], v[116:119]
    ds_read_b64_tr_b16 a[102:103], v7 offset:17408
    v_mfma_f32_16x16x32_bf16 v[96:99], v[120:123], a[16:19], 0
    s_mov_b32 s57, 955904
    v_mfma_f32_16x16x32_bf16 v[96:99], v[124:127], a[40:43], v[96:99]
    buffer_load_dwordx4 v2, s[8:11], s57 offen offset:1024 lds
    v_mfma_f32_16x16x32_bf16 v[96:99], v[128:131], a[64:67], v[96:99]
    v_mfma_f32_16x16x32_bf16 v[96:99], v[132:135], a[88:91], v[96:99]
    v_mfma_f32_16x16x32_bf16 v[96:99], v[136:139], a[112:115], v[96:99]
    s_add_u32 m0, s90, 147456
    s_mov_b32 s57, 1032192
    v_mfma_f32_16x16x32_bf16 v[96:99], v[140:143], a[136:139], v[96:99]
    buffer_load_dwordx4 v2, s[8:11], s57 offen offset:0 lds
    v_mfma_f32_16x16x32_bf16 v[96:99], v[144:147], a[160:163], v[96:99]
    v_cvt_pk_bf16_f32 v62, v116, v117
    v_cvt_pk_bf16_f32 v63, v118, v119
    v_mfma_f32_16x16x32_bf16 v[96:99], v[148:151], a[184:187], v[96:99]
    v_cndmask_b32 v62, v62, 0, s[82:83]
    v_cndmask_b32 v63, v63, 0, s[82:83]
    v_mfma_f32_16x16x32_bf16 v[96:99], v[152:155], a[208:211], v[96:99]
    s_mov_b32 s57, 1041920
    v_mfma_f32_16x16x32_bf16 v[96:99], v[156:159], a[232:235], v[96:99]
    buffer_load_dwordx4 v2, s[8:11], s57 offen offset:1024 lds
    v_mfma_f32_16x16x32_bf16 v[96:99], v[160:163], v[176:179], v[96:99]
    v_mfma_f32_16x16x32_bf16 v[96:99], v[164:167], v[200:203], v[96:99]
    s_waitcnt vmcnt(10)
    s_waitcnt lgkmcnt(0)
    s_barrier
    v_mfma_f32_16x16x32_bf16 v[96:99], v[168:171], v[224:227], v[96:99]
    s_add_u32 m0, s90, 155648
    s_mov_b32 s57, 1118208
    ds_read_b64_tr_b16 a[120:121], v6 offset:24576
    v_mfma_f32_16x16x32_bf16 v[96:99], v[172:175], v[248:251], v[96:99]
    buffer_load_dwordx4 v2, s[8:11], s57 offen offset:0 lds
    v_mfma_f32_16x16x32_bf16 v[100:103], v[120:123], a[20:23], 0
    ds_read_b64_tr_b16 v[120:121], v4 offset:16384
    ds_read_b64_tr_b16 v[122:123], v25 offset:16384
    v_mfma_f32_16x16x32_bf16 v[100:103], v[124:127], a[44:47], v[100:103]
    ds_read_b64_tr_b16 v[124:125], v4 offset:17408
    ds_read_b64_tr_b16 v[126:127], v25 offset:17408
    v_mfma_f32_16x16x32_bf16 v[100:103], v[128:131], a[68:71], v[100:103]
    ds_read_b64_tr_b16 v[128:129], v4 offset:18432
    ds_read_b64_tr_b16 v[130:131], v25 offset:18432
    s_mov_b32 s57, 1127936
    v_mfma_f32_16x16x32_bf16 v[100:103], v[132:135], a[92:95], v[100:103]
    ds_read_b64_tr_b16 v[132:133], v4 offset:19456
    ds_read_b64_tr_b16 v[134:135], v25 offset:19456
    buffer_load_dwordx4 v2, s[8:11], s57 offen offset:1024 lds
    v_mfma_f32_16x16x32_bf16 v[100:103], v[136:139], a[116:119], v[100:103]
    ds_read_b64_tr_b16 v[136:137], v4 offset:20480
    ds_read_b64_tr_b16 v[138:139], v25 offset:20480
    v_mfma_f32_16x16x32_bf16 v[100:103], v[140:143], a[140:143], v[100:103]
    ds_read_b64_tr_b16 v[140:141], v4 offset:21504
    ds_read_b64_tr_b16 v[142:143], v25 offset:21504
    v_mfma_f32_16x16x32_bf16 v[100:103], v[144:147], a[164:167], v[100:103]
    ds_read_b64_tr_b16 v[144:145], v4 offset:22528
    ds_read_b64_tr_b16 v[146:147], v25 offset:22528
    s_add_u32 m0, s52, 49152
    s_add_u32 s58, s72, 1024
    s_add_u32 s57, s58, s68
    v_mfma_f32_16x16x32_bf16 v[100:103], v[148:151], a[188:191], v[100:103]
    ds_read_b64_tr_b16 v[148:149], v4 offset:23552
    ds_read_b64_tr_b16 v[150:151], v25 offset:23552
    buffer_load_dwordx4 v3, s[24:27], s57 offen offset:0 sc1 lds
    v_mfma_f32_16x16x32_bf16 v[100:103], v[152:155], a[212:215], v[100:103]
    ds_read_b64_tr_b16 v[152:153], v4 offset:24576
    ds_read_b64_tr_b16 v[154:155], v25 offset:24576
    v_mfma_f32_16x16x32_bf16 v[100:103], v[156:159], a[236:239], v[100:103]
    ds_read_b64_tr_b16 v[156:157], v4 offset:25600
    ds_read_b64_tr_b16 v[158:159], v25 offset:25600
    v_mfma_f32_16x16x32_bf16 v[100:103], v[160:163], v[180:183], v[100:103]
    ds_read_b64_tr_b16 v[160:161], v4 offset:26624
    ds_read_b64_tr_b16 v[162:163], v25 offset:26624
    s_add_u32 s57, s58, s69
    v_mfma_f32_16x16x32_bf16 v[100:103], v[164:167], v[204:207], v[100:103]
    ds_read_b64_tr_b16 v[164:165], v4 offset:27648
    ds_read_b64_tr_b16 v[166:167], v25 offset:27648
    buffer_load_dwordx4 v3, s[24:27], s57 offen offset:1024 sc1 lds
    v_mfma_f32_16x16x32_bf16 v[100:103], v[168:171], v[228:231], v[100:103]
    ds_read_b64_tr_b16 v[168:169], v4 offset:28672
    ds_read_b64_tr_b16 v[170:171], v25 offset:28672
    v_mfma_f32_16x16x32_bf16 v[100:103], v[172:175], v[252:255], v[100:103]
    ds_read_b64_tr_b16 v[172:173], v4 offset:29696
    ds_read_b64_tr_b16 v[174:175], v25 offset:29696
    s_waitcnt lgkmcnt(15)
    v_mfma_f32_16x16x32_bf16 v[104:107], v[120:123], a[16:19], 0
    s_add_u32 s57, s58, s70
    v_cvt_pk_bf16_f32 v36, v96, v97
    v_mfma_f32_16x16x32_bf16 v[104:107], v[124:127], a[40:43], v[104:107]
    buffer_load_dwordx4 v24, s[24:27], s57 offen offset:2048 sc1 lds
    v_mfma_f32_16x16x32_bf16 v[104:107], v[128:131], a[64:67], v[104:107]
    v_cvt_pk_bf16_f32 v37, v98, v99
    ds_read_b64_tr_b16 a[122:123], v6 offset:25600
    v_mfma_f32_16x16x32_bf16 v[104:107], v[132:135], a[88:91], v[104:107]
    ds_read_b64_tr_b16 a[124:125], v7 offset:24576
    ds_read_b64_tr_b16 a[126:127], v7 offset:25600
    v_mfma_f32_16x16x32_bf16 v[104:107], v[136:139], a[112:115], v[104:107]
    s_add_u32 s57, s58, s71
    ds_read_b64_tr_b16 a[144:145], v6 offset:32768
    v_mfma_f32_16x16x32_bf16 v[104:107], v[140:143], a[136:139], v[104:107]
    buffer_load_dwordx4 v3, s[24:27], s57 offen offset:3072 sc1 lds
    s_waitcnt lgkmcnt(14)
    v_mfma_f32_16x16x32_bf16 v[104:107], v[144:147], a[160:163], v[104:107]
    v_cvt_pk_bf16_f32 v46, v100, v101
    v_cvt_pk_bf16_f32 v47, v102, v103
    v_mfma_f32_16x16x32_bf16 v[104:107], v[148:151], a[184:187], v[104:107]
    ds_read_b64_tr_b16 a[146:147], v6 offset:33792
    ds_read_b64_tr_b16 a[148:149], v7 offset:32768
    v_mfma_f32_16x16x32_bf16 v[104:107], v[152:155], a[208:211], v[104:107]
    ds_read_b64_tr_b16 a[150:151], v7 offset:33792
    ds_read_b64_tr_b16 a[168:169], v6 offset:40960
    s_waitcnt lgkmcnt(12)
    v_mfma_f32_16x16x32_bf16 v[104:107], v[156:159], a[232:235], v[104:107]
    ds_read_b64_tr_b16 a[170:171], v6 offset:41984
    ds_read_b64_tr_b16 a[172:173], v7 offset:40960
    v_mfma_f32_16x16x32_bf16 v[104:107], v[160:163], v[176:179], v[104:107]
    ds_read_b64_tr_b16 a[174:175], v7 offset:41984
    s_waitcnt vmcnt(10)
    s_waitcnt lgkmcnt(0)
    s_barrier
    v_mfma_f32_16x16x32_bf16 v[104:107], v[164:167], v[200:203], v[104:107]
    ds_read_b64_tr_b16 a[192:193], v10 offset:0
    ds_read_b64_tr_b16 a[194:195], v10 offset:1024
    v_mfma_f32_16x16x32_bf16 v[104:107], v[168:171], v[224:227], v[104:107]
    ds_read_b64_tr_b16 a[196:197], v11 offset:0
    ds_read_b64_tr_b16 a[198:199], v11 offset:1024
    v_mfma_f32_16x16x32_bf16 v[104:107], v[172:175], v[248:251], v[104:107]
    ds_read_b64_tr_b16 a[216:217], v10 offset:8192
    ds_read_b64_tr_b16 a[218:219], v10 offset:9216
    v_mfma_f32_16x16x32_bf16 v[108:111], v[120:123], a[20:23], 0
    ds_read_b64_tr_b16 v[120:121], v4 offset:0
    ds_read_b64_tr_b16 v[122:123], v25 offset:0
    v_mfma_f32_16x16x32_bf16 v[108:111], v[124:127], a[44:47], v[108:111]
    ds_read_b64_tr_b16 v[124:125], v4 offset:1024
    ds_read_b64_tr_b16 v[126:127], v25 offset:1024
    v_mfma_f32_16x16x32_bf16 v[108:111], v[128:131], a[68:71], v[108:111]
    ds_read_b64_tr_b16 v[128:129], v4 offset:2048
    ds_read_b64_tr_b16 v[130:131], v25 offset:2048
    v_mfma_f32_16x16x32_bf16 v[108:111], v[132:135], a[92:95], v[108:111]
    ds_read_b64_tr_b16 v[132:133], v4 offset:3072
    ds_read_b64_tr_b16 v[134:135], v25 offset:3072
    v_mfma_f32_16x16x32_bf16 v[108:111], v[136:139], a[116:119], v[108:111]
    ds_read_b64_tr_b16 v[136:137], v4 offset:4096
    ds_read_b64_tr_b16 v[138:139], v25 offset:4096
    v_mfma_f32_16x16x32_bf16 v[108:111], v[140:143], a[140:143], v[108:111]
    ds_read_b64_tr_b16 v[140:141], v4 offset:5120
    ds_read_b64_tr_b16 v[142:143], v25 offset:5120
    v_mfma_f32_16x16x32_bf16 v[108:111], v[144:147], a[164:167], v[108:111]
    ds_read_b64_tr_b16 v[144:145], v4 offset:6144
    ds_read_b64_tr_b16 v[146:147], v25 offset:6144
    v_mfma_f32_16x16x32_bf16 v[108:111], v[148:151], a[188:191], v[108:111]
    ds_read_b64_tr_b16 v[148:149], v4 offset:7168
    ds_read_b64_tr_b16 v[150:151], v25 offset:7168
    v_mfma_f32_16x16x32_bf16 v[108:111], v[152:155], a[212:215], v[108:111]
    ds_read_b64_tr_b16 v[152:153], v4 offset:8192
    ds_read_b64_tr_b16 v[154:155], v25 offset:8192
    v_mfma_f32_16x16x32_bf16 v[108:111], v[156:159], a[236:239], v[108:111]
    ds_read_b64_tr_b16 v[156:157], v4 offset:9216
    ds_read_b64_tr_b16 v[158:159], v25 offset:9216
    v_mfma_f32_16x16x32_bf16 v[108:111], v[160:163], v[180:183], v[108:111]
    ds_read_b64_tr_b16 v[160:161], v4 offset:10240
    ds_read_b64_tr_b16 v[162:163], v25 offset:10240
    v_mfma_f32_16x16x32_bf16 v[108:111], v[164:167], v[204:207], v[108:111]
    ds_read_b64_tr_b16 v[164:165], v4 offset:11264
    ds_read_b64_tr_b16 v[166:167], v25 offset:11264
    v_mfma_f32_16x16x32_bf16 v[108:111], v[168:171], v[228:231], v[108:111]
    ds_read_b64_tr_b16 v[168:169], v4 offset:12288
    ds_read_b64_tr_b16 v[170:171], v25 offset:12288
    v_mfma_f32_16x16x32_bf16 v[108:111], v[172:175], v[252:255], v[108:111]
    ds_read_b64_tr_b16 v[172:173], v4 offset:13312
    ds_read_b64_tr_b16 v[174:175], v25 offset:13312
    s_waitcnt lgkmcnt(15)
    v_mfma_f32_16x16x32_bf16 v[112:115], v[120:123], a[16:19], 0
    v_cvt_pk_bf16_f32 v34, v104, v105
    v_cvt_pk_bf16_f32 v35, v106, v107
    v_mfma_f32_16x16x32_bf16 v[112:115], v[124:127], a[40:43], v[112:115]
    ds_read_b64_tr_b16 a[220:221], v11 offset:8192
    ds_read_b64_tr_b16 a[222:223], v11 offset:9216
    v_mfma_f32_16x16x32_bf16 v[112:115], v[128:131], a[64:67], v[112:115]
    ds_read_b64_tr_b16 a[240:241], v10 offset:16384
    ds_read_b64_tr_b16 a[242:243], v10 offset:17408
    v_mfma_f32_16x16x32_bf16 v[112:115], v[132:135], a[88:91], v[112:115]
    ds_read_b64_tr_b16 a[244:245], v11 offset:16384
    ds_read_b64_tr_b16 a[246:247], v11 offset:17408
    s_waitcnt vmcnt(4)
    s_waitcnt lgkmcnt(0)
    s_barrier
    v_mfma_f32_16x16x32_bf16 v[112:115], v[136:139], a[112:115], v[112:115]
    ds_read_b64_tr_b16 v[184:185], v10 offset:24576
    ds_read_b64_tr_b16 v[186:187], v10 offset:25600
    v_mfma_f32_16x16x32_bf16 v[112:115], v[140:143], a[136:139], v[112:115]
    ds_read_b64_tr_b16 v[188:189], v11 offset:24576
    ds_read_b64_tr_b16 v[190:191], v11 offset:25600
    v_mfma_f32_16x16x32_bf16 v[112:115], v[144:147], a[160:163], v[112:115]
    v_cvt_pk_bf16_f32 v44, v108, v109
    v_cvt_pk_bf16_f32 v45, v110, v111
    v_mfma_f32_16x16x32_bf16 v[112:115], v[148:151], a[184:187], v[112:115]
    ds_read_b64_tr_b16 v[208:209], v10 offset:32768
    ds_read_b64_tr_b16 v[210:211], v10 offset:33792
    v_mfma_f32_16x16x32_bf16 v[112:115], v[152:155], a[208:211], v[112:115]
    ds_read_b64_tr_b16 v[212:213], v11 offset:32768
    ds_read_b64_tr_b16 v[214:215], v11 offset:33792
    v_mfma_f32_16x16x32_bf16 v[112:115], v[156:159], a[232:235], v[112:115]
    ds_read_b64_tr_b16 v[232:233], v10 offset:40960
    ds_read_b64_tr_b16 v[234:235], v10 offset:41984
    v_mfma_f32_16x16x32_bf16 v[112:115], v[160:163], v[176:179], v[112:115]
    ds_read_b64_tr_b16 v[236:237], v11 offset:40960
    ds_read_b64_tr_b16 v[238:239], v11 offset:41984
    v_mfma_f32_16x16x32_bf16 v[112:115], v[164:167], v[200:203], v[112:115]
    v_mfma_f32_16x16x32_bf16 v[112:115], v[168:171], v[224:227], v[112:115]
    v_mfma_f32_16x16x32_bf16 v[112:115], v[172:175], v[248:251], v[112:115]
    v_mfma_f32_16x16x32_bf16 v[116:119], v[120:123], a[20:23], 0
    ds_read_b64_tr_b16 v[120:121], v4 offset:16384
    ds_read_b64_tr_b16 v[122:123], v25 offset:16384
    v_mfma_f32_16x16x32_bf16 v[116:119], v[124:127], a[44:47], v[116:119]
    ds_read_b64_tr_b16 v[124:125], v4 offset:17408
    ds_read_b64_tr_b16 v[126:127], v25 offset:17408
    s_waitcnt lgkmcnt(4)
    s_barrier
    v_mfma_f32_16x16x32_bf16 v[116:119], v[128:131], a[68:71], v[116:119]
    ds_read_b64_tr_b16 v[128:129], v4 offset:18432
    ds_read_b64_tr_b16 v[130:131], v25 offset:18432
    s_add_u32 m0, s52, 65536
    s_add_u32 s58, s72, 1536
    s_add_u32 s57, s58, s68
    v_mfma_f32_16x16x32_bf16 v[116:119], v[132:135], a[92:95], v[116:119]
    ds_read_b64_tr_b16 v[132:133], v4 offset:19456
    ds_read_b64_tr_b16 v[134:135], v25 offset:19456
    buffer_load_dwordx4 v3, s[24:27], s57 offen offset:0 sc1 lds
    v_mfma_f32_16x16x32_bf16 v[116:119], v[136:139], a[116:119], v[116:119]
    ds_read_b64_tr_b16 v[136:137], v4 offset:20480
    ds_read_b64_tr_b16 v[138:139], v25 offset:20480
    v_mfma_f32_16x16x32_bf16 v[116:119], v[140:143], a[140:143], v[116:119]
    ds_read_b64_tr_b16 v[140:141], v4 offset:21504
    ds_read_b64_tr_b16 v[142:143], v25 offset:21504
    v_mfma_f32_16x16x32_bf16 v[116:119], v[144:147], a[164:167], v[116:119]
    ds_read_b64_tr_b16 v[144:145], v4 offset:22528
    ds_read_b64_tr_b16 v[146:147], v25 offset:22528
    v_mfma_f32_16x16x32_bf16 v[116:119], v[148:151], a[188:191], v[116:119]
    ds_read_b64_tr_b16 v[148:149], v4 offset:23552
    ds_read_b64_tr_b16 v[150:151], v25 offset:23552
    v_mfma_f32_16x16x32_bf16 v[116:119], v[152:155], a[212:215], v[116:119]
    ds_read_b64_tr_b16 v[152:153], v4 offset:24576
    ds_read_b64_tr_b16 v[154:155], v25 offset:24576
    s_add_u32 s57, s58, s69
    v_mfma_f32_16x16x32_bf16 v[116:119], v[156:159], a[236:239], v[116:119]
    ds_read_b64_tr_b16 v[156:157], v4 offset:25600
    ds_read_b64_tr_b16 v[158:159], v25 offset:25600
    buffer_load_dwordx4 v3, s[24:27], s57 offen offset:1024 sc1 lds
    v_mfma_f32_16x16x32_bf16 v[116:119], v[160:163], v[180:183], v[116:119]
    ds_read_b64_tr_b16 v[160:161], v4 offset:26624
    ds_read_b64_tr_b16 v[162:163], v25 offset:26624
    v_mfma_f32_16x16x32_bf16 v[116:119], v[164:167], v[204:207], v[116:119]
    ds_read_b64_tr_b16 v[164:165], v4 offset:27648
    ds_read_b64_tr_b16 v[166:167], v25 offset:27648
    v_mfma_f32_16x16x32_bf16 v[116:119], v[168:171], v[228:231], v[116:119]
    ds_read_b64_tr_b16 v[168:169], v4 offset:28672
    ds_read_b64_tr_b16 v[170:171], v25 offset:28672
    v_mfma_f32_16x16x32_bf16 v[116:119], v[172:175], v[252:255], v[116:119]
    ds_read_b64_tr_b16 v[172:173], v4 offset:29696
    ds_read_b64_tr_b16 v[174:175], v25 offset:29696
    s_waitcnt lgkmcnt(15)
    v_mfma_f32_16x16x32_bf16 v[96:99], a[0:3], v[120:123], 0
    s_add_u32 s57, s58, s70
    v_cvt_pk_bf16_f32 v32, v112, v113
    v_mfma_f32_16x16x32_bf16 v[96:99], a[24:27], v[124:127], v[96:99]
    buffer_load_dwordx4 v24, s[24:27], s57 offen offset:2048 sc1 lds
    v_mfma_f32_16x16x32_bf16 v[96:99], a[48:51], v[128:131], v[96:99]
    v_cvt_pk_bf16_f32 v33, v114, v115
    v_mfma_f32_16x16x32_bf16 v[96:99], a[72:75], v[132:135], v[96:99]
    v_mfma_f32_16x16x32_bf16 v[96:99], a[96:99], v[136:139], v[96:99]
    v_mfma_f32_16x16x32_bf16 v[96:99], a[120:123], v[140:143], v[96:99]
    s_waitcnt lgkmcnt(10)
    v_mfma_f32_16x16x32_bf16 v[96:99], a[144:147], v[144:147], v[96:99]
    s_add_u32 s57, s58, s71
    v_cvt_pk_bf16_f32 v42, v116, v117
    v_mfma_f32_16x16x32_bf16 v[96:99], a[168:171], v[148:151], v[96:99]
    buffer_load_dwordx4 v3, s[24:27], s57 offen offset:3072 sc1 lds
    v_mfma_f32_16x16x32_bf16 v[96:99], a[192:195], v[152:155], v[96:99]
    v_cvt_pk_bf16_f32 v43, v118, v119
    s_waitcnt lgkmcnt(4)
    v_mfma_f32_16x16x32_bf16 v[96:99], a[216:219], v[156:159], v[96:99]
    v_mfma_f32_16x16x32_bf16 v[96:99], a[240:243], v[160:163], v[96:99]
    v_mfma_f32_16x16x32_bf16 v[96:99], v[184:187], v[164:167], v[96:99]
    s_waitcnt lgkmcnt(0)
    v_mfma_f32_16x16x32_bf16 v[96:99], v[208:211], v[168:171], v[96:99]
    s_add_u32 m0, s52, 81920
    s_add_u32 s58, s72, 2048
    s_add_u32 s57, s58, s68
    v_mfma_f32_16x16x32_bf16 v[96:99], v[232:235], v[172:175], v[96:99]
    buffer_load_dwordx4 v3, s[24:27], s57 offen offset:0 sc1 lds
    v_mfma_f32_16x16x32_bf16 v[100:103], a[4:7], v[120:123], 0
    ds_read_b64_tr_b16 v[120:121], v4 offset:32768
    ds_read_b64_tr_b16 v[122:123], v25 offset:32768
    v_mfma_f32_16x16x32_bf16 v[100:103], a[28:31], v[124:127], v[100:103]
    ds_read_b64_tr_b16 v[124:125], v4 offset:33792
    ds_read_b64_tr_b16 v[126:127], v25 offset:33792
    v_mfma_f32_16x16x32_bf16 v[100:103], a[52:55], v[128:131], v[100:103]
    ds_read_b64_tr_b16 v[128:129], v4 offset:34816
    ds_read_b64_tr_b16 v[130:131], v25 offset:34816
    v_mfma_f32_16x16x32_bf16 v[100:103], a[76:79], v[132:135], v[100:103]
    ds_read_b64_tr_b16 v[132:133], v4 offset:35840
    ds_read_b64_tr_b16 v[134:135], v25 offset:35840
    v_mfma_f32_16x16x32_bf16 v[100:103], a[100:103], v[136:139], v[100:103]
    ds_read_b64_tr_b16 v[136:137], v4 offset:36864
    ds_read_b64_tr_b16 v[138:139], v25 offset:36864
    s_add_u32 s57, s58, s69
    v_mfma_f32_16x16x32_bf16 v[100:103], a[124:127], v[140:143], v[100:103]
    ds_read_b64_tr_b16 v[140:141], v4 offset:37888
    ds_read_b64_tr_b16 v[142:143], v25 offset:37888
    buffer_load_dwordx4 v3, s[24:27], s57 offen offset:1024 sc1 lds
    v_mfma_f32_16x16x32_bf16 v[100:103], a[148:151], v[144:147], v[100:103]
    ds_read_b64_tr_b16 v[144:145], v4 offset:38912
    ds_read_b64_tr_b16 v[146:147], v25 offset:38912
    v_mfma_f32_16x16x32_bf16 v[100:103], a[172:175], v[148:151], v[100:103]
    ds_read_b64_tr_b16 v[148:149], v4 offset:39936
    ds_read_b64_tr_b16 v[150:151], v25 offset:39936
    v_mfma_f32_16x16x32_bf16 v[100:103], a[196:199], v[152:155], v[100:103]
    ds_read_b64_tr_b16 v[152:153], v4 offset:40960
    ds_read_b64_tr_b16 v[154:155], v25 offset:40960
    v_mfma_f32_16x16x32_bf16 v[100:103], a[220:223], v[156:159], v[100:103]
    ds_read_b64_tr_b16 v[156:157], v4 offset:41984
    ds_read_b64_tr_b16 v[158:159], v25 offset:41984
    v_mfma_f32_16x16x32_bf16 v[100:103], a[244:247], v[160:163], v[100:103]
    ds_read_b64_tr_b16 v[160:161], v4 offset:43008
    ds_read_b64_tr_b16 v[162:163], v25 offset:43008
    s_add_u32 s57, s58, s70
    v_mfma_f32_16x16x32_bf16 v[100:103], v[188:191], v[164:167], v[100:103]
    ds_read_b64_tr_b16 v[164:165], v4 offset:44032
    ds_read_b64_tr_b16 v[166:167], v25 offset:44032
    buffer_load_dwordx4 v24, s[24:27], s57 offen offset:2048 sc1 lds
    v_mfma_f32_16x16x32_bf16 v[100:103], v[212:215], v[168:171], v[100:103]
    ds_read_b64_tr_b16 v[168:169], v4 offset:45056
    ds_read_b64_tr_b16 v[170:171], v25 offset:45056
    v_mfma_f32_16x16x32_bf16 v[100:103], v[236:239], v[172:175], v[100:103]
    ds_read_b64_tr_b16 v[172:173], v4 offset:46080
    ds_read_b64_tr_b16 v[174:175], v25 offset:46080
    s_waitcnt lgkmcnt(15)
    v_mfma_f32_16x16x32_bf16 v[104:107], a[0:3], v[120:123], 0
    v_cvt_pk_bf16_f32 v68, v96, v97
    v_cvt_pk_bf16_f32 v69, v98, v99
    v_mfma_f32_16x16x32_bf16 v[104:107], a[24:27], v[124:127], v[104:107]
    v_mfma_f32_16x16x32_bf16 v[104:107], a[48:51], v[128:131], v[104:107]
    s_add_u32 s57, s58, s71
    v_mfma_f32_16x16x32_bf16 v[104:107], a[72:75], v[132:135], v[104:107]
    buffer_load_dwordx4 v3, s[24:27], s57 offen offset:3072 sc1 lds
    v_mfma_f32_16x16x32_bf16 v[104:107], a[96:99], v[136:139], v[104:107]
    v_mfma_f32_16x16x32_bf16 v[104:107], a[120:123], v[140:143], v[104:107]
    s_waitcnt lgkmcnt(10)
    v_mfma_f32_16x16x32_bf16 v[104:107], a[144:147], v[144:147], v[104:107]
    v_cvt_pk_bf16_f32 v70, v100, v101
    v_cvt_pk_bf16_f32 v71, v102, v103
    v_mfma_f32_16x16x32_bf16 v[104:107], a[168:171], v[148:151], v[104:107]
    v_cndmask_b32 v70, v70, 0, s[82:83]
    v_cndmask_b32 v71, v71, 0, s[82:83]
    v_mfma_f32_16x16x32_bf16 v[104:107], a[192:195], v[152:155], v[104:107]
    s_add_u32 m0, s52, 98304
    s_add_u32 s58, s72, 2560
    s_add_u32 s57, s58, s68
    v_mov_b32 v8, 0
    s_waitcnt lgkmcnt(4)
    v_mfma_f32_16x16x32_bf16 v[104:107], a[216:219], v[156:159], v[104:107]
    buffer_load_dwordx4 v3, s[24:27], s57 offen offset:0 sc1 lds
    v_mfma_f32_16x16x32_bf16 v[104:107], a[240:243], v[160:163], v[104:107]
    v_mov_b32 v9, 0
    v_mov_b32 v10, 0
    v_mfma_f32_16x16x32_bf16 v[104:107], v[184:187], v[164:167], v[104:107]
    v_mfma_f32_16x16x32_bf16 v[72:75], v[52:55], v[68:71], 0
    s_waitcnt lgkmcnt(0)
    v_mfma_f32_16x16x32_bf16 v[104:107], v[208:211], v[168:171], v[104:107]
    v_mfma_f32_16x16x32_bf16 v[76:79], v[56:59], v[68:71], 0
    v_mfma_f32_16x16x32_bf16 v[104:107], v[232:235], v[172:175], v[104:107]
    ds_read_u16_d16_hi v8, v93 offset:0
    ds_read_u16_d16_hi v9, v94 offset:0
    s_waitcnt vmcnt(9)
    s_barrier
    v_mfma_f32_16x16x32_bf16 v[108:111], a[4:7], v[120:123], 0
    ds_read_b64_tr_b16 v[120:121], v4 offset:49152
    ds_read_b64_tr_b16 v[122:123], v25 offset:49152
    s_add_u32 s57, s58, s69
    v_mfma_f32_16x16x32_bf16 v[108:111], a[28:31], v[124:127], v[108:111]
    ds_read_b64_tr_b16 v[124:125], v4 offset:50176
    ds_read_b64_tr_b16 v[126:127], v25 offset:50176
    buffer_load_dwordx4 v3, s[24:27], s57 offen offset:1024 sc1 lds
    v_mfma_f32_16x16x32_bf16 v[108:111], a[52:55], v[128:131], v[108:111]
    ds_read_b64_tr_b16 v[128:129], v4 offset:51200
    ds_read_b64_tr_b16 v[130:131], v25 offset:51200
    v_mfma_f32_16x16x32_bf16 v[108:111], a[76:79], v[132:135], v[108:111]
    ds_read_b64_tr_b16 v[132:133], v4 offset:52224
    ds_read_b64_tr_b16 v[134:135], v25 offset:52224
    v_mfma_f32_16x16x32_bf16 v[108:111], a[100:103], v[136:139], v[108:111]
    ds_read_b64_tr_b16 v[136:137], v4 offset:53248
    ds_read_b64_tr_b16 v[138:139], v25 offset:53248
    v_mfma_f32_16x16x32_bf16 v[108:111], a[124:127], v[140:143], v[108:111]
    ds_read_b64_tr_b16 v[140:141], v4 offset:54272
    ds_read_b64_tr_b16 v[142:143], v25 offset:54272
    v_mfma_f32_16x16x32_bf16 v[108:111], a[148:151], v[144:147], v[108:111]
    ds_read_b64_tr_b16 v[144:145], v4 offset:55296
    ds_read_b64_tr_b16 v[146:147], v25 offset:55296
    s_add_u32 s57, s58, s70
    v_mfma_f32_16x16x32_bf16 v[108:111], a[172:175], v[148:151], v[108:111]
    ds_read_b64_tr_b16 v[148:149], v4 offset:56320
    ds_read_b64_tr_b16 v[150:151], v25 offset:56320
    buffer_load_dwordx4 v24, s[24:27], s57 offen offset:2048 sc1 lds
    v_mfma_f32_16x16x32_bf16 v[108:111], a[196:199], v[152:155], v[108:111]
    ds_read_b64_tr_b16 v[152:153], v4 offset:57344
    ds_read_b64_tr_b16 v[154:155], v25 offset:57344
    v_mfma_f32_16x16x32_bf16 v[108:111], a[220:223], v[156:159], v[108:111]
    ds_read_b64_tr_b16 v[156:157], v4 offset:58368
    ds_read_b64_tr_b16 v[158:159], v25 offset:58368
    v_mfma_f32_16x16x32_bf16 v[108:111], a[244:247], v[160:163], v[108:111]
    ds_read_b64_tr_b16 v[160:161], v4 offset:59392
    ds_read_b64_tr_b16 v[162:163], v25 offset:59392
    v_mfma_f32_16x16x32_bf16 v[108:111], v[188:191], v[164:167], v[108:111]
    ds_read_b64_tr_b16 v[164:165], v4 offset:60416
    ds_read_b64_tr_b16 v[166:167], v25 offset:60416
    v_mfma_f32_16x16x32_bf16 v[108:111], v[212:215], v[168:171], v[108:111]
    ds_read_b64_tr_b16 v[168:169], v4 offset:61440
    ds_read_b64_tr_b16 v[170:171], v25 offset:61440
    s_add_u32 s57, s58, s71
    v_mfma_f32_16x16x32_bf16 v[108:111], v[236:239], v[172:175], v[108:111]
    ds_read_b64_tr_b16 v[172:173], v4 offset:62464
    ds_read_b64_tr_b16 v[174:175], v25 offset:62464
    buffer_load_dwordx4 v3, s[24:27], s57 offen offset:3072 sc1 lds
    s_waitcnt lgkmcnt(15)
    v_mfma_f32_16x16x32_bf16 v[112:115], a[8:11], v[120:123], 0
    v_cvt_pk_bf16_f32 v64, v104, v105
    v_cvt_pk_bf16_f32 v65, v106, v107
    v_mfma_f32_16x16x32_bf16 v[112:115], a[32:35], v[124:127], v[112:115]
    ds_read_u16_d16_hi v10, v92 offset:0
    v_mfma_f32_16x16x32_bf16 v[112:115], a[56:59], v[128:131], v[112:115]
    v_mfma_f32_16x16x32_bf16 v[112:115], a[80:83], v[132:135], v[112:115]
    v_mfma_f32_16x16x32_bf16 v[112:115], a[104:107], v[136:139], v[112:115]
    s_add_u32 m0, s52, 114688
    s_add_u32 s58, s72, 3072
    s_add_u32 s57, s58, s68
    v_mfma_f32_16x16x32_bf16 v[112:115], a[128:131], v[140:143], v[112:115]
    buffer_load_dwordx4 v3, s[24:27], s57 offen offset:0 sc1 lds
    s_waitcnt lgkmcnt(11)
    v_mfma_f32_16x16x32_bf16 v[112:115], a[152:155], v[144:147], v[112:115]
    v_cvt_pk_bf16_f32 v66, v108, v109
    v_cvt_pk_bf16_f32 v67, v110, v111
    v_mfma_f32_16x16x32_bf16 v[112:115], a[176:179], v[148:151], v[112:115]
    v_cndmask_b32 v66, v66, 0, s[82:83]
    v_cndmask_b32 v67, v67, 0, s[82:83]
    v_mfma_f32_16x16x32_bf16 v[112:115], a[200:203], v[152:155], v[112:115]
    v_cndmask_b32 v26, v72, v73, s[76:77]
    v_cndmask_b32 v27, v74, v75, s[76:77]
    s_waitcnt lgkmcnt(5)
    v_mfma_f32_16x16x32_bf16 v[112:115], a[224:227], v[156:159], v[112:115]
    v_cndmask_b32 v28, v76, v77, s[76:77]
    v_cndmask_b32 v29, v78, v79, s[76:77]
    v_mfma_f32_16x16x32_bf16 v[112:115], a[248:251], v[160:163], v[112:115]
    s_add_u32 s57, s58, s69
    v_cndmask_b32 v26, v26, v28, s[78:79]
    v_mfma_f32_16x16x32_bf16 v[112:115], v[192:195], v[164:167], v[112:115]
    buffer_load_dwordx4 v3, s[24:27], s57 offen offset:1024 sc1 lds
    s_waitcnt lgkmcnt(1)
    v_mfma_f32_16x16x32_bf16 v[112:115], v[216:219], v[168:171], v[112:115]
    v_cndmask_b32 v27, v27, v29, s[80:81]
    s_waitcnt lgkmcnt(0)
    v_mfma_f32_16x16x32_bf16 v[112:115], v[240:243], v[172:175], v[112:115]
    v_mul_f32 v26, v26, v8
    v_mul_f32 v27, v27, v9
    v_mfma_f32_16x16x32_bf16 v[116:119], a[12:15], v[120:123], 0
    v_mul_f32 v11, s91, v10
    v_cndmask_b32 v26, v26, v18, s[84:85]
    v_mfma_f32_16x16x32_bf16 v[116:119], a[36:39], v[124:127], v[116:119]
    v_cndmask_b32 v27, v27, v18, s[86:87]
    v_max_f32 v28, v26, v27
    v_mfma_f32_16x16x32_bf16 v[116:119], a[60:63], v[128:131], v[116:119]
    s_add_u32 s57, s58, s70
    v_mov_b32 v29, v28
    v_mfma_f32_16x16x32_bf16 v[116:119], a[84:87], v[132:135], v[116:119]
    buffer_load_dwordx4 v24, s[24:27], s57 offen offset:2048 sc1 lds
    v_mfma_f32_16x16x32_bf16 v[116:119], a[108:111], v[136:139], v[116:119]
    v_permlane16_swap_b32 v28, v29
    v_max_f32 v28, v28, v29
    v_mfma_f32_16x16x32_bf16 v[116:119], a[132:135], v[140:143], v[116:119]
    v_mov_b32 v29, v28
    v_mfma_f32_16x16x32_bf16 v[116:119], a[156:159], v[144:147], v[116:119]
    v_cvt_pk_bf16_f32 v52, v112, v113
    v_cvt_pk_bf16_f32 v53, v114, v115
    v_mfma_f32_16x16x32_bf16 v[116:119], a[180:183], v[148:151], v[116:119]
    v_permlane32_swap_b32 v28, v29
    v_max_f32 v28, v28, v29
    v_mfma_f32_16x16x32_bf16 v[116:119], a[204:207], v[152:155], v[116:119]
    s_add_u32 s57, s58, s71
    v_sub_f32 v26, v26, v28
    v_mfma_f32_16x16x32_bf16 v[116:119], a[228:231], v[156:159], v[116:119]
    buffer_load_dwordx4 v3, s[24:27], s57 offen offset:3072 sc1 lds
    v_mfma_f32_16x16x32_bf16 v[116:119], a[252:255], v[160:163], v[116:119]
    v_sub_f32 v27, v27, v28
    v_mul_f32 v26, v11, v26
    v_mfma_f32_16x16x32_bf16 v[116:119], v[196:199], v[164:167], v[116:119]
    v_mul_f32 v27, v11, v27
    v_exp_f32 v26, v26
    v_mfma_f32_16x16x32_bf16 v[116:119], v[220:223], v[168:171], v[116:119]
    v_exp_f32 v27, v27
    v_mfma_f32_16x16x32_bf16 v[116:119], v[244:247], v[172:175], v[116:119]
    v_add_f32 v28, v26, v27
    v_mov_b32 v29, v28
    v_mfma_f32_16x16x32_bf16 v[96:99], v[120:123], a[16:19], 0
    s_add_u32 m0, s52, 131072
    s_add_u32 s58, s72, 3584
    s_add_u32 s57, s58, s68
    v_mfma_f32_16x16x32_bf16 v[96:99], v[124:127], a[40:43], v[96:99]
    buffer_load_dwordx4 v3, s[24:27], s57 offen offset:0 sc1 lds
    v_mfma_f32_16x16x32_bf16 v[96:99], v[128:131], a[64:67], v[96:99]
    v_permlane16_swap_b32 v28, v29
    v_add_f32 v28, v28, v29
    v_mfma_f32_16x16x32_bf16 v[96:99], v[132:135], a[88:91], v[96:99]
    v_mov_b32 v29, v28
    v_mfma_f32_16x16x32_bf16 v[96:99], v[136:139], a[112:115], v[96:99]
    v_mfma_f32_16x16x32_bf16 v[96:99], v[140:143], a[136:139], v[96:99]
    v_permlane32_swap_b32 v28, v29
    v_add_f32 v28, v28, v29
    v_mfma_f32_16x16x32_bf16 v[96:99], v[144:147], a[160:163], v[96:99]
    s_add_u32 s57, s58, s69
    v_cvt_pk_bf16_f32 v54, v116, v117
    v_mfma_f32_16x16x32_bf16 v[96:99], v[148:151], a[184:187], v[96:99]
    buffer_load_dwordx4 v3, s[24:27], s57 offen offset:1024 sc1 lds
    v_mfma_f32_16x16x32_bf16 v[96:99], v[152:155], a[208:211], v[96:99]
    v_cvt_pk_bf16_f32 v55, v118, v119
    v_cndmask_b32 v54, v54, 0, s[82:83]
    v_mfma_f32_16x16x32_bf16 v[96:99], v[156:159], a[232:235], v[96:99]
    v_cndmask_b32 v55, v55, 0, s[82:83]
    v_rcp_f32 v28, v28
    v_mfma_f32_16x16x32_bf16 v[96:99], v[160:163], v[176:179], v[96:99]
    v_mul_f32 v26, v26, v8
    v_mul_f32 v27, v27, v9
    v_mfma_f32_16x16x32_bf16 v[96:99], v[164:167], v[200:203], v[96:99]
    v_mul_f32 v26, v26, v28
    v_mul_f32 v27, v27, v28
    v_mfma_f32_16x16x32_bf16 v[96:99], v[168:171], v[224:227], v[96:99]
    s_add_u32 s57, s58, s70
    v_cvt_pk_bf16_f32 v26, v26, v26
    v_mfma_f32_16x16x32_bf16 v[96:99], v[172:175], v[248:251], v[96:99]
    buffer_load_dwordx4 v24, s[24:27], s57 offen offset:2048 sc1 lds
    v_mfma_f32_16x16x32_bf16 v[100:103], v[120:123], a[20:23], 0
    v_cvt_pk_bf16_f32 v27, v27, v27
    v_and_b32 v80, v26, v14
    v_mfma_f32_16x16x32_bf16 v[100:103], v[124:127], a[44:47], v[100:103]
    v_and_b32 v81, v27, v15
    v_and_b32 v82, v26, v16
    v_mfma_f32_16x16x32_bf16 v[100:103], v[128:131], a[68:71], v[100:103]
    v_and_b32 v83, v27, v17
    v_mfma_f32_16x16x32_bf16 v[100:103], v[132:135], a[92:95], v[100:103]
    v_mfma_f32_16x16x32_bf16 v[100:103], v[136:139], a[116:119], v[100:103]
    s_add_u32 s57, s58, s71
    v_mfma_f32_16x16x32_bf16 v[72:75], v[32:35], v[80:83], 0
    v_mfma_f32_16x16x32_bf16 v[100:103], v[140:143], a[140:143], v[100:103]
    buffer_load_dwordx4 v3, s[24:27], s57 offen offset:3072 sc1 lds
    v_mfma_f32_16x16x32_bf16 v[100:103], v[144:147], a[164:167], v[100:103]
    v_cvt_pk_bf16_f32 v38, v96, v97
    v_cvt_pk_bf16_f32 v39, v98, v99
    v_mfma_f32_16x16x32_bf16 v[100:103], v[148:151], a[188:191], v[100:103]
    v_mfma_f32_16x16x32_bf16 v[76:79], v[42:45], v[80:83], 0
    v_mfma_f32_16x16x32_bf16 v[100:103], v[152:155], a[212:215], v[100:103]
    s_add_u32 s53, s74, 0
    v_mfma_f32_16x16x32_bf16 v[100:103], v[156:159], a[236:239], v[100:103]
    v_mfma_f32_16x16x32_bf16 v[100:103], v[160:163], v[180:183], v[100:103]
    s_add_u32 s57, s73, 0
    v_mfma_f32_16x16x32_bf16 v[100:103], v[164:167], v[204:207], v[100:103]
    buffer_load_dword v22, v5, s[20:23], s57 offen
    v_mfma_f32_16x16x32_bf16 v[100:103], v[168:171], v[228:231], v[100:103]
    v_mfma_f32_16x16x32_bf16 v[100:103], v[172:175], v[252:255], v[100:103]
    v_cvt_pk_bf16_f32 v84, v72, v73
    v_cvt_pk_bf16_f32 v85, v74, v75
    v_mfma_f32_16x16x32_bf16 v[104:107], a[0:3], v[120:123], 0
    v_cvt_pk_bf16_f32 v86, v76, v77
    v_cvt_pk_bf16_f32 v87, v78, v79
    v_mfma_f32_16x16x32_bf16 v[104:107], a[24:27], v[124:127], v[104:107]
    v_cndmask_b32 v86, v86, 0, s[82:83]
    v_cndmask_b32 v87, v87, 0, s[82:83]
    v_mfma_f32_16x16x32_bf16 v[104:107], a[48:51], v[128:131], v[104:107]
    s_add_u32 s57, s73, 524288
    v_mfma_f32_16x16x32_bf16 v[104:107], a[72:75], v[132:135], v[104:107]
    buffer_load_dword v22, v5, s[20:23], s57 offen
    v_mfma_f32_16x16x32_bf16 v[104:107], a[96:99], v[136:139], v[104:107]
    buffer_store_dwordx4 v[84:87], v23, s[24:27], s53 offen sc1
    v_mfma_f32_16x16x32_bf16 v[104:107], a[120:123], v[140:143], v[104:107]
    v_mfma_f32_16x16x32_bf16 v[104:107], a[144:147], v[144:147], v[104:107]
    v_cvt_pk_bf16_f32 v48, v100, v101
    v_cvt_pk_bf16_f32 v49, v102, v103
    v_mfma_f32_16x16x32_bf16 v[104:107], a[168:171], v[148:151], v[104:107]
    v_mfma_f32_16x16x32_bf16 v[72:75], v[56:59], v[64:67], 0
    v_mfma_f32_16x16x32_bf16 v[104:107], a[192:195], v[152:155], v[104:107]
    s_add_u32 s57, s75, 0
    v_mfma_f32_16x16x32_bf16 v[76:79], v[60:63], v[64:67], 0
    v_mfma_f32_16x16x32_bf16 v[104:107], a[216:219], v[156:159], v[104:107]
    buffer_load_dword v22, v20, s[12:15], s57 offen
    v_mfma_f32_16x16x32_bf16 v[104:107], a[240:243], v[160:163], v[104:107]
    ds_read_u16_d16_hi v8, v93 offset:16384
    ds_read_u16_d16_hi v9, v94 offset:16384
    v_mfma_f32_16x16x32_bf16 v[104:107], v[184:187], v[164:167], v[104:107]
    ds_read_u16_d16_hi v10, v92 offset:16384
    v_mfma_f32_16x16x32_bf16 v[104:107], v[208:211], v[168:171], v[104:107]
    v_mfma_f32_16x16x32_bf16 v[104:107], v[232:235], v[172:175], v[104:107]
    s_waitcnt vmcnt(8)
    s_barrier
    v_mfma_f32_16x16x32_bf16 v[108:111], a[4:7], v[120:123], 0
    v_add_u32 v4, 65536, v4
    v_add_u32 v25, 65536, v25
    ds_read_b64_tr_b16 v[120:121], v4 offset:0
    ds_read_b64_tr_b16 v[122:123], v25 offset:0
    s_add_u32 s57, s75, 262144
    v_mfma_f32_16x16x32_bf16 v[108:111], a[28:31], v[124:127], v[108:111]
    ds_read_b64_tr_b16 v[124:125], v4 offset:1024
    ds_read_b64_tr_b16 v[126:127], v25 offset:1024
    buffer_load_dword v22, v20, s[12:15], s57 offen
    v_mfma_f32_16x16x32_bf16 v[108:111], a[52:55], v[128:131], v[108:111]
    ds_read_b64_tr_b16 v[128:129], v4 offset:2048
    ds_read_b64_tr_b16 v[130:131], v25 offset:2048
    v_mfma_f32_16x16x32_bf16 v[108:111], a[76:79], v[132:135], v[108:111]
    ds_read_b64_tr_b16 v[132:133], v4 offset:3072
    ds_read_b64_tr_b16 v[134:135], v25 offset:3072
    v_mfma_f32_16x16x32_bf16 v[108:111], a[100:103], v[136:139], v[108:111]
    ds_read_b64_tr_b16 v[136:137], v4 offset:4096
    ds_read_b64_tr_b16 v[138:139], v25 offset:4096
    v_mfma_f32_16x16x32_bf16 v[108:111], a[124:127], v[140:143], v[108:111]
    ds_read_b64_tr_b16 v[140:141], v4 offset:5120
    ds_read_b64_tr_b16 v[142:143], v25 offset:5120
    v_mfma_f32_16x16x32_bf16 v[108:111], a[148:151], v[144:147], v[108:111]
    ds_read_b64_tr_b16 v[144:145], v4 offset:6144
    ds_read_b64_tr_b16 v[146:147], v25 offset:6144
    v_mfma_f32_16x16x32_bf16 v[108:111], a[172:175], v[148:151], v[108:111]
    ds_read_b64_tr_b16 v[148:149], v4 offset:7168
    ds_read_b64_tr_b16 v[150:151], v25 offset:7168
    v_mfma_f32_16x16x32_bf16 v[108:111], a[196:199], v[152:155], v[108:111]
    ds_read_b64_tr_b16 v[152:153], v4 offset:8192
    ds_read_b64_tr_b16 v[154:155], v25 offset:8192
    v_mfma_f32_16x16x32_bf16 v[108:111], a[220:223], v[156:159], v[108:111]
    ds_read_b64_tr_b16 v[156:157], v4 offset:9216
    ds_read_b64_tr_b16 v[158:159], v25 offset:9216
    v_mfma_f32_16x16x32_bf16 v[108:111], a[244:247], v[160:163], v[108:111]
    ds_read_b64_tr_b16 v[160:161], v4 offset:10240
    ds_read_b64_tr_b16 v[162:163], v25 offset:10240
    v_mfma_f32_16x16x32_bf16 v[108:111], v[188:191], v[164:167], v[108:111]
    ds_read_b64_tr_b16 v[164:165], v4 offset:11264
    ds_read_b64_tr_b16 v[166:167], v25 offset:11264
    v_mfma_f32_16x16x32_bf16 v[108:111], v[212:215], v[168:171], v[108:111]
    ds_read_b64_tr_b16 v[168:169], v4 offset:12288
    ds_read_b64_tr_b16 v[170:171], v25 offset:12288
    v_mfma_f32_16x16x32_bf16 v[108:111], v[236:239], v[172:175], v[108:111]
    ds_read_b64_tr_b16 v[172:173], v4 offset:13312
    ds_read_b64_tr_b16 v[174:175], v25 offset:13312
    s_waitcnt lgkmcnt(15)
    v_mfma_f32_16x16x32_bf16 v[112:115], a[8:11], v[120:123], 0
    v_cvt_pk_bf16_f32 v68, v104, v105
    v_cvt_pk_bf16_f32 v69, v106, v107
    v_mfma_f32_16x16x32_bf16 v[112:115], a[32:35], v[124:127], v[112:115]
    v_cndmask_b32 v26, v72, v73, s[76:77]
    v_cndmask_b32 v27, v74, v75, s[76:77]
    v_mfma_f32_16x16x32_bf16 v[112:115], a[56:59], v[128:131], v[112:115]
    v_cndmask_b32 v28, v76, v77, s[76:77]
    v_cndmask_b32 v29, v78, v79, s[76:77]
    v_mfma_f32_16x16x32_bf16 v[112:115], a[80:83], v[132:135], v[112:115]
    v_cndmask_b32 v26, v26, v28, s[78:79]
    v_cndmask_b32 v27, v27, v29, s[80:81]
    v_mfma_f32_16x16x32_bf16 v[112:115], a[104:107], v[136:139], v[112:115]
    v_mul_f32 v26, v26, v8
    v_mfma_f32_16x16x32_bf16 v[112:115], a[128:131], v[140:143], v[112:115]
    v_mul_f32 v27, v27, v9
    v_mul_f32 v11, s91, v10
    s_waitcnt lgkmcnt(10)
    v_mfma_f32_16x16x32_bf16 v[112:115], a[152:155], v[144:147], v[112:115]
    v_cvt_pk_bf16_f32 v70, v108, v109
    v_cvt_pk_bf16_f32 v71, v110, v111
    v_mfma_f32_16x16x32_bf16 v[112:115], a[176:179], v[148:151], v[112:115]
    v_cndmask_b32 v70, v70, 0, s[82:83]
    v_cndmask_b32 v71, v71, 0, s[82:83]
    v_mfma_f32_16x16x32_bf16 v[112:115], a[200:203], v[152:155], v[112:115]
    v_max_f32 v28, v26, v27
    v_mov_b32 v29, v28
    s_waitcnt lgkmcnt(4)
    v_mfma_f32_16x16x32_bf16 v[112:115], a[224:227], v[156:159], v[112:115]
    v_mfma_f32_16x16x32_bf16 v[112:115], a[248:251], v[160:163], v[112:115]
    v_permlane16_swap_b32 v28, v29
    v_max_f32 v28, v28, v29
    v_mfma_f32_16x16x32_bf16 v[112:115], v[192:195], v[164:167], v[112:115]
    v_mov_b32 v29, v28
    s_waitcnt lgkmcnt(0)
    v_mfma_f32_16x16x32_bf16 v[112:115], v[216:219], v[168:171], v[112:115]
    v_mfma_f32_16x16x32_bf16 v[112:115], v[240:243], v[172:175], v[112:115]
    v_permlane32_swap_b32 v28, v29
    v_max_f32 v28, v28, v29
    v_mfma_f32_16x16x32_bf16 v[116:119], a[12:15], v[120:123], 0
    v_sub_f32 v26, v26, v28
    v_sub_f32 v27, v27, v28
    v_mfma_f32_16x16x32_bf16 v[116:119], a[36:39], v[124:127], v[116:119]
    v_mul_f32 v26, v11, v26
    v_mul_f32 v27, v11, v27
    v_mfma_f32_16x16x32_bf16 v[116:119], a[60:63], v[128:131], v[116:119]
    v_exp_f32 v26, v26
    v_mfma_f32_16x16x32_bf16 v[116:119], a[84:87], v[132:135], v[116:119]
    v_exp_f32 v27, v27
    v_mfma_f32_16x16x32_bf16 v[116:119], a[108:111], v[136:139], v[116:119]
    v_add_f32 v28, v26, v27
    v_mov_b32 v29, v28
    v_mfma_f32_16x16x32_bf16 v[116:119], a[132:135], v[140:143], v[116:119]
    v_mfma_f32_16x16x32_bf16 v[116:119], a[156:159], v[144:147], v[116:119]
    v_cvt_pk_bf16_f32 v56, v112, v113
    v_cvt_pk_bf16_f32 v57, v114, v115
    v_mfma_f32_16x16x32_bf16 v[116:119], a[180:183], v[148:151], v[116:119]
    v_permlane16_swap_b32 v28, v29
    v_add_f32 v28, v28, v29
    v_mfma_f32_16x16x32_bf16 v[116:119], a[204:207], v[152:155], v[116:119]
    v_mov_b32 v29, v28
    v_mfma_f32_16x16x32_bf16 v[116:119], a[228:231], v[156:159], v[116:119]
    v_mfma_f32_16x16x32_bf16 v[116:119], a[252:255], v[160:163], v[116:119]
    v_permlane32_swap_b32 v28, v29
    v_add_f32 v28, v28, v29
    v_mfma_f32_16x16x32_bf16 v[116:119], v[196:199], v[164:167], v[116:119]
    v_rcp_f32 v28, v28
    v_mfma_f32_16x16x32_bf16 v[116:119], v[220:223], v[168:171], v[116:119]
    v_mul_f32 v26, v26, v8
    v_mul_f32 v27, v27, v9
    v_mfma_f32_16x16x32_bf16 v[116:119], v[244:247], v[172:175], v[116:119]
    v_mul_f32 v26, v26, v28
    v_mul_f32 v27, v27, v28
    v_mfma_f32_16x16x32_bf16 v[96:99], v[120:123], a[16:19], 0
    v_cvt_pk_bf16_f32 v26, v26, v26
    v_cvt_pk_bf16_f32 v27, v27, v27
    v_mfma_f32_16x16x32_bf16 v[96:99], v[124:127], a[40:43], v[96:99]
    v_and_b32 v80, v26, v14
    v_and_b32 v81, v27, v15
    v_mfma_f32_16x16x32_bf16 v[96:99], v[128:131], a[64:67], v[96:99]
    v_and_b32 v82, v26, v16
    v_and_b32 v83, v27, v17
    v_mfma_f32_16x16x32_bf16 v[96:99], v[132:135], a[88:91], v[96:99]
    v_mfma_f32_16x16x32_bf16 v[96:99], v[136:139], a[112:115], v[96:99]
    v_mfma_f32_16x16x32_bf16 v[72:75], v[34:37], v[80:83], 0
    v_mfma_f32_16x16x32_bf16 v[96:99], v[140:143], a[136:139], v[96:99]
    v_mfma_f32_16x16x32_bf16 v[76:79], v[44:47], v[80:83], 0
    v_mfma_f32_16x16x32_bf16 v[96:99], v[144:147], a[160:163], v[96:99]
    v_cvt_pk_bf16_f32 v58, v116, v117
    v_cvt_pk_bf16_f32 v59, v118, v119
    v_mfma_f32_16x16x32_bf16 v[96:99], v[148:151], a[184:187], v[96:99]
    v_cndmask_b32 v58, v58, 0, s[82:83]
    v_cndmask_b32 v59, v59, 0, s[82:83]
    v_mfma_f32_16x16x32_bf16 v[96:99], v[152:155], a[208:211], v[96:99]
    s_add_u32 s53, s74, 16384
    v_mfma_f32_16x16x32_bf16 v[96:99], v[156:159], a[232:235], v[96:99]
    v_mfma_f32_16x16x32_bf16 v[96:99], v[160:163], v[176:179], v[96:99]
    v_mfma_f32_16x16x32_bf16 v[96:99], v[164:167], v[200:203], v[96:99]
    v_mfma_f32_16x16x32_bf16 v[96:99], v[168:171], v[224:227], v[96:99]
    v_mfma_f32_16x16x32_bf16 v[96:99], v[172:175], v[248:251], v[96:99]
    v_cvt_pk_bf16_f32 v84, v72, v73
    v_cvt_pk_bf16_f32 v85, v74, v75
    v_mfma_f32_16x16x32_bf16 v[100:103], v[120:123], a[20:23], 0
    v_cvt_pk_bf16_f32 v86, v76, v77
    v_cvt_pk_bf16_f32 v87, v78, v79
    v_mfma_f32_16x16x32_bf16 v[100:103], v[124:127], a[44:47], v[100:103]
    v_cndmask_b32 v86, v86, 0, s[82:83]
    v_cndmask_b32 v87, v87, 0, s[82:83]
    v_mfma_f32_16x16x32_bf16 v[100:103], v[128:131], a[68:71], v[100:103]
    buffer_store_dwordx4 v[84:87], v23, s[24:27], s53 offen sc1
    v_mfma_f32_16x16x32_bf16 v[100:103], v[132:135], a[92:95], v[100:103]
    v_mfma_f32_16x16x32_bf16 v[100:103], v[136:139], a[116:119], v[100:103]
    v_mfma_f32_16x16x32_bf16 v[72:75], v[60:63], v[68:71], 0
    v_mfma_f32_16x16x32_bf16 v[100:103], v[140:143], a[140:143], v[100:103]
    v_mfma_f32_16x16x32_bf16 v[76:79], v[52:55], v[68:71], 0
    v_mfma_f32_16x16x32_bf16 v[100:103], v[144:147], a[164:167], v[100:103]
    v_cvt_pk_bf16_f32 v40, v96, v97
    v_cvt_pk_bf16_f32 v41, v98, v99
    v_mfma_f32_16x16x32_bf16 v[100:103], v[148:151], a[188:191], v[100:103]
    v_cvt_pk_bf16_f32 v32, v96, v97
    v_cvt_pk_bf16_f32 v33, v98, v99
    v_mfma_f32_16x16x32_bf16 v[100:103], v[152:155], a[212:215], v[100:103]
    ds_read_u16_d16_hi v8, v93 offset:32768
    ds_read_u16_d16_hi v9, v94 offset:32768
    v_mfma_f32_16x16x32_bf16 v[100:103], v[156:159], a[236:239], v[100:103]
    ds_read_u16_d16_hi v10, v92 offset:32768
    v_mfma_f32_16x16x32_bf16 v[100:103], v[160:163], v[180:183], v[100:103]
    v_mfma_f32_16x16x32_bf16 v[100:103], v[164:167], v[204:207], v[100:103]
    v_mfma_f32_16x16x32_bf16 v[100:103], v[168:171], v[228:231], v[100:103]
    v_mfma_f32_16x16x32_bf16 v[100:103], v[172:175], v[252:255], v[100:103]
    v_cndmask_b32 v26, v72, v73, s[76:77]
    v_cndmask_b32 v27, v74, v75, s[76:77]
    v_mfma_f32_16x16x32_bf16 v[104:107], a[0:3], v[120:123], 0
    v_cndmask_b32 v28, v76, v77, s[76:77]
    v_cndmask_b32 v29, v78, v79, s[76:77]
    v_mfma_f32_16x16x32_bf16 v[104:107], a[24:27], v[124:127], v[104:107]
    v_cndmask_b32 v26, v26, v28, s[78:79]
    v_cndmask_b32 v27, v27, v29, s[80:81]
    v_mfma_f32_16x16x32_bf16 v[104:107], a[48:51], v[128:131], v[104:107]
    s_waitcnt lgkmcnt(0)
    v_mul_f32 v26, v26, v8
    v_mfma_f32_16x16x32_bf16 v[104:107], a[72:75], v[132:135], v[104:107]
    v_mul_f32 v27, v27, v9
    v_mul_f32 v11, s91, v10
    v_mfma_f32_16x16x32_bf16 v[104:107], a[96:99], v[136:139], v[104:107]
    v_max_f32 v28, v26, v27
    v_mov_b32 v29, v28
    v_mfma_f32_16x16x32_bf16 v[104:107], a[120:123], v[140:143], v[104:107]
    v_mfma_f32_16x16x32_bf16 v[104:107], a[144:147], v[144:147], v[104:107]
    v_cvt_pk_bf16_f32 v50, v100, v101
    v_cvt_pk_bf16_f32 v51, v102, v103
    v_mfma_f32_16x16x32_bf16 v[104:107], a[168:171], v[148:151], v[104:107]
    v_cvt_pk_bf16_f32 v42, v100, v101
    v_cvt_pk_bf16_f32 v43, v102, v103
    v_mfma_f32_16x16x32_bf16 v[104:107], a[192:195], v[152:155], v[104:107]
    v_permlane16_swap_b32 v28, v29
    v_max_f32 v28, v28, v29
    v_mfma_f32_16x16x32_bf16 v[104:107], a[216:219], v[156:159], v[104:107]
    v_mov_b32 v29, v28
    v_mfma_f32_16x16x32_bf16 v[104:107], a[240:243], v[160:163], v[104:107]
    v_mfma_f32_16x16x32_bf16 v[104:107], v[184:187], v[164:167], v[104:107]
    v_permlane32_swap_b32 v28, v29
    v_max_f32 v28, v28, v29
    v_mfma_f32_16x16x32_bf16 v[104:107], v[208:211], v[168:171], v[104:107]
    v_sub_f32 v26, v26, v28
    v_sub_f32 v27, v27, v28
    v_mfma_f32_16x16x32_bf16 v[104:107], v[232:235], v[172:175], v[104:107]
    v_mul_f32 v26, v11, v26
    v_mul_f32 v27, v11, v27
    v_mfma_f32_16x16x32_bf16 v[108:111], a[4:7], v[120:123], 0
    ds_read_b64_tr_b16 v[120:121], v4 offset:16384
    ds_read_b64_tr_b16 v[122:123], v25 offset:16384
    v_mfma_f32_16x16x32_bf16 v[108:111], a[28:31], v[124:127], v[108:111]
    ds_read_b64_tr_b16 v[124:125], v4 offset:17408
    ds_read_b64_tr_b16 v[126:127], v25 offset:17408
    v_mfma_f32_16x16x32_bf16 v[108:111], a[52:55], v[128:131], v[108:111]
    ds_read_b64_tr_b16 v[128:129], v4 offset:18432
    ds_read_b64_tr_b16 v[130:131], v25 offset:18432
    v_mfma_f32_16x16x32_bf16 v[108:111], a[76:79], v[132:135], v[108:111]
    ds_read_b64_tr_b16 v[132:133], v4 offset:19456
    ds_read_b64_tr_b16 v[134:135], v25 offset:19456
    v_mfma_f32_16x16x32_bf16 v[108:111], a[100:103], v[136:139], v[108:111]
    ds_read_b64_tr_b16 v[136:137], v4 offset:20480
    ds_read_b64_tr_b16 v[138:139], v25 offset:20480
    v_mfma_f32_16x16x32_bf16 v[108:111], a[124:127], v[140:143], v[108:111]
    ds_read_b64_tr_b16 v[140:141], v4 offset:21504
    ds_read_b64_tr_b16 v[142:143], v25 offset:21504
    v_mfma_f32_16x16x32_bf16 v[108:111], a[148:151], v[144:147], v[108:111]
    ds_read_b64_tr_b16 v[144:145], v4 offset:22528
    ds_read_b64_tr_b16 v[146:147], v25 offset:22528
    v_mfma_f32_16x16x32_bf16 v[108:111], a[172:175], v[148:151], v[108:111]
    ds_read_b64_tr_b16 v[148:149], v4 offset:23552
    ds_read_b64_tr_b16 v[150:151], v25 offset:23552
    v_mfma_f32_16x16x32_bf16 v[108:111], a[196:199], v[152:155], v[108:111]
    ds_read_b64_tr_b16 v[152:153], v4 offset:24576
    ds_read_b64_tr_b16 v[154:155], v25 offset:24576
    v_mfma_f32_16x16x32_bf16 v[108:111], a[220:223], v[156:159], v[108:111]
    ds_read_b64_tr_b16 v[156:157], v4 offset:25600
    ds_read_b64_tr_b16 v[158:159], v25 offset:25600
    v_mfma_f32_16x16x32_bf16 v[108:111], a[244:247], v[160:163], v[108:111]
    ds_read_b64_tr_b16 v[160:161], v4 offset:26624
    ds_read_b64_tr_b16 v[162:163], v25 offset:26624
    v_mfma_f32_16x16x32_bf16 v[108:111], v[188:191], v[164:167], v[108:111]
    ds_read_b64_tr_b16 v[164:165], v4 offset:27648
    ds_read_b64_tr_b16 v[166:167], v25 offset:27648
    v_mfma_f32_16x16x32_bf16 v[108:111], v[212:215], v[168:171], v[108:111]
    ds_read_b64_tr_b16 v[168:169], v4 offset:28672
    ds_read_b64_tr_b16 v[170:171], v25 offset:28672
    v_mfma_f32_16x16x32_bf16 v[108:111], v[236:239], v[172:175], v[108:111]
    ds_read_b64_tr_b16 v[172:173], v4 offset:29696
    ds_read_b64_tr_b16 v[174:175], v25 offset:29696
    s_waitcnt lgkmcnt(15)
    v_mfma_f32_16x16x32_bf16 v[112:115], a[8:11], v[120:123], 0
    v_cvt_pk_bf16_f32 v64, v104, v105
    v_cvt_pk_bf16_f32 v65, v106, v107
    v_mfma_f32_16x16x32_bf16 v[112:115], a[32:35], v[124:127], v[112:115]
    v_exp_f32 v26, v26
    v_mfma_f32_16x16x32_bf16 v[112:115], a[56:59], v[128:131], v[112:115]
    v_exp_f32 v27, v27
    v_mfma_f32_16x16x32_bf16 v[112:115], a[80:83], v[132:135], v[112:115]
    v_add_f32 v28, v26, v27
    v_mov_b32 v29, v28
    v_mfma_f32_16x16x32_bf16 v[112:115], a[104:107], v[136:139], v[112:115]
    v_mfma_f32_16x16x32_bf16 v[112:115], a[128:131], v[140:143], v[112:115]
    v_permlane16_swap_b32 v28, v29
    v_add_f32 v28, v28, v29
    s_waitcnt lgkmcnt(10)
    v_mfma_f32_16x16x32_bf16 v[112:115], a[152:155], v[144:147], v[112:115]
    v_cvt_pk_bf16_f32 v66, v108, v109
    v_cvt_pk_bf16_f32 v67, v110, v111
    v_mfma_f32_16x16x32_bf16 v[112:115], a[176:179], v[148:151], v[112:115]
    v_cndmask_b32 v66, v66, 0, s[82:83]
    v_cndmask_b32 v67, v67, 0, s[82:83]
    v_mfma_f32_16x16x32_bf16 v[112:115], a[200:203], v[152:155], v[112:115]
    v_mov_b32 v29, v28
    s_waitcnt lgkmcnt(4)
    v_mfma_f32_16x16x32_bf16 v[112:115], a[224:227], v[156:159], v[112:115]
    v_mfma_f32_16x16x32_bf16 v[112:115], a[248:251], v[160:163], v[112:115]
    v_permlane32_swap_b32 v28, v29
    v_add_f32 v28, v28, v29
    v_mfma_f32_16x16x32_bf16 v[112:115], v[192:195], v[164:167], v[112:115]
    v_rcp_f32 v28, v28
    s_waitcnt lgkmcnt(0)
    v_mfma_f32_16x16x32_bf16 v[112:115], v[216:219], v[168:171], v[112:115]
    v_mul_f32 v26, v26, v8
    v_mul_f32 v27, v27, v9
    v_mfma_f32_16x16x32_bf16 v[112:115], v[240:243], v[172:175], v[112:115]
    v_mul_f32 v26, v26, v28
    v_mul_f32 v27, v27, v28
    v_mfma_f32_16x16x32_bf16 v[116:119], a[12:15], v[120:123], 0
    v_cvt_pk_bf16_f32 v26, v26, v26
    v_cvt_pk_bf16_f32 v27, v27, v27
    v_mfma_f32_16x16x32_bf16 v[116:119], a[36:39], v[124:127], v[116:119]
    v_and_b32 v80, v26, v14
    v_and_b32 v81, v27, v15
    v_mfma_f32_16x16x32_bf16 v[116:119], a[60:63], v[128:131], v[116:119]
    v_and_b32 v82, v26, v16
    v_and_b32 v83, v27, v17
    v_mfma_f32_16x16x32_bf16 v[116:119], a[84:87], v[132:135], v[116:119]
    v_mfma_f32_16x16x32_bf16 v[116:119], a[108:111], v[136:139], v[116:119]
    v_mfma_f32_16x16x32_bf16 v[72:75], v[36:39], v[80:83], 0
    v_mfma_f32_16x16x32_bf16 v[116:119], a[132:135], v[140:143], v[116:119]
    v_mfma_f32_16x16x32_bf16 v[76:79], v[46:49], v[80:83], 0
    v_mfma_f32_16x16x32_bf16 v[116:119], a[156:159], v[144:147], v[116:119]
    v_cvt_pk_bf16_f32 v60, v112, v113
    v_cvt_pk_bf16_f32 v61, v114, v115
    v_mfma_f32_16x16x32_bf16 v[116:119], a[180:183], v[148:151], v[116:119]
    s_add_u32 s53, s74, 32768
    v_mfma_f32_16x16x32_bf16 v[116:119], a[204:207], v[152:155], v[116:119]
    v_mfma_f32_16x16x32_bf16 v[116:119], a[228:231], v[156:159], v[116:119]
    v_mfma_f32_16x16x32_bf16 v[116:119], a[252:255], v[160:163], v[116:119]
    v_mfma_f32_16x16x32_bf16 v[116:119], v[196:199], v[164:167], v[116:119]
    v_mfma_f32_16x16x32_bf16 v[116:119], v[220:223], v[168:171], v[116:119]
    v_cvt_pk_bf16_f32 v84, v72, v73
    v_cvt_pk_bf16_f32 v85, v74, v75
    v_mfma_f32_16x16x32_bf16 v[116:119], v[244:247], v[172:175], v[116:119]
    v_cvt_pk_bf16_f32 v86, v76, v77
    v_cvt_pk_bf16_f32 v87, v78, v79
    v_mfma_f32_16x16x32_bf16 v[96:99], v[120:123], a[16:19], 0
    v_cndmask_b32 v86, v86, 0, s[82:83]
    v_cndmask_b32 v87, v87, 0, s[82:83]
    v_mfma_f32_16x16x32_bf16 v[96:99], v[124:127], a[40:43], v[96:99]
    buffer_store_dwordx4 v[84:87], v23, s[24:27], s53 offen sc1
    v_mfma_f32_16x16x32_bf16 v[96:99], v[128:131], a[64:67], v[96:99]
    v_mfma_f32_16x16x32_bf16 v[96:99], v[132:135], a[88:91], v[96:99]
    v_mfma_f32_16x16x32_bf16 v[72:75], v[52:55], v[64:67], 0
    v_mfma_f32_16x16x32_bf16 v[96:99], v[136:139], a[112:115], v[96:99]
    v_mfma_f32_16x16x32_bf16 v[76:79], v[56:59], v[64:67], 0
    v_mfma_f32_16x16x32_bf16 v[96:99], v[140:143], a[136:139], v[96:99]
    ds_read_u16_d16_hi v8, v93 offset:49152
    ds_read_u16_d16_hi v9, v94 offset:49152
    v_mfma_f32_16x16x32_bf16 v[96:99], v[144:147], a[160:163], v[96:99]
    v_cvt_pk_bf16_f32 v62, v116, v117
    v_cvt_pk_bf16_f32 v63, v118, v119
    v_mfma_f32_16x16x32_bf16 v[96:99], v[148:151], a[184:187], v[96:99]
    v_cndmask_b32 v62, v62, 0, s[82:83]
    v_cndmask_b32 v63, v63, 0, s[82:83]
    v_mfma_f32_16x16x32_bf16 v[96:99], v[152:155], a[208:211], v[96:99]
    ds_read_u16_d16_hi v10, v92 offset:49152
    v_mfma_f32_16x16x32_bf16 v[96:99], v[156:159], a[232:235], v[96:99]
    v_mfma_f32_16x16x32_bf16 v[96:99], v[160:163], v[176:179], v[96:99]
    v_mfma_f32_16x16x32_bf16 v[96:99], v[164:167], v[200:203], v[96:99]
    v_mfma_f32_16x16x32_bf16 v[96:99], v[168:171], v[224:227], v[96:99]
    v_cndmask_b32 v26, v72, v73, s[76:77]
    v_cndmask_b32 v27, v74, v75, s[76:77]
    v_mfma_f32_16x16x32_bf16 v[96:99], v[172:175], v[248:251], v[96:99]
    v_cndmask_b32 v28, v76, v77, s[76:77]
    v_cndmask_b32 v29, v78, v79, s[76:77]
    v_mfma_f32_16x16x32_bf16 v[100:103], v[120:123], a[20:23], 0
    v_cndmask_b32 v26, v26, v28, s[78:79]
    v_cndmask_b32 v27, v27, v29, s[80:81]
    v_mfma_f32_16x16x32_bf16 v[100:103], v[124:127], a[44:47], v[100:103]
    s_waitcnt lgkmcnt(0)
    v_mul_f32 v26, v26, v8
    v_mfma_f32_16x16x32_bf16 v[100:103], v[128:131], a[68:71], v[100:103]
    v_mul_f32 v27, v27, v9
    v_mul_f32 v11, s91, v10
    v_mfma_f32_16x16x32_bf16 v[100:103], v[132:135], a[92:95], v[100:103]
    v_max_f32 v28, v26, v27
    v_mov_b32 v29, v28
    v_mfma_f32_16x16x32_bf16 v[100:103], v[136:139], a[116:119], v[100:103]
    v_mfma_f32_16x16x32_bf16 v[100:103], v[140:143], a[140:143], v[100:103]
    v_permlane16_swap_b32 v28, v29
    v_max_f32 v28, v28, v29
    v_mfma_f32_16x16x32_bf16 v[100:103], v[144:147], a[164:167], v[100:103]
    v_cvt_pk_bf16_f32 v34, v96, v97
    v_cvt_pk_bf16_f32 v35, v98, v99
    v_mfma_f32_16x16x32_bf16 v[100:103], v[148:151], a[188:191], v[100:103]
    v_mov_b32 v29, v28
    v_mfma_f32_16x16x32_bf16 v[100:103], v[152:155], a[212:215], v[100:103]
    v_mfma_f32_16x16x32_bf16 v[100:103], v[156:159], a[236:239], v[100:103]
    v_permlane32_swap_b32 v28, v29
    v_max_f32 v28, v28, v29
    v_mfma_f32_16x16x32_bf16 v[100:103], v[160:163], v[180:183], v[100:103]
    v_sub_f32 v26, v26, v28
    v_sub_f32 v27, v27, v28
    v_mfma_f32_16x16x32_bf16 v[100:103], v[164:167], v[204:207], v[100:103]
    v_mul_f32 v26, v11, v26
    v_mul_f32 v27, v11, v27
    v_mfma_f32_16x16x32_bf16 v[100:103], v[168:171], v[228:231], v[100:103]
    v_exp_f32 v26, v26
    v_mfma_f32_16x16x32_bf16 v[100:103], v[172:175], v[252:255], v[100:103]
    v_exp_f32 v27, v27
    v_mfma_f32_16x16x32_bf16 v[104:107], a[0:3], v[120:123], 0
    v_add_f32 v28, v26, v27
    v_mov_b32 v29, v28
    v_mfma_f32_16x16x32_bf16 v[104:107], a[24:27], v[124:127], v[104:107]
    v_mfma_f32_16x16x32_bf16 v[104:107], a[48:51], v[128:131], v[104:107]
    v_permlane16_swap_b32 v28, v29
    v_add_f32 v28, v28, v29
    v_mfma_f32_16x16x32_bf16 v[104:107], a[72:75], v[132:135], v[104:107]
    v_mov_b32 v29, v28
    v_mfma_f32_16x16x32_bf16 v[104:107], a[96:99], v[136:139], v[104:107]
    v_mfma_f32_16x16x32_bf16 v[104:107], a[120:123], v[140:143], v[104:107]
    v_permlane32_swap_b32 v28, v29
    v_add_f32 v28, v28, v29
    v_mfma_f32_16x16x32_bf16 v[104:107], a[144:147], v[144:147], v[104:107]
    v_cvt_pk_bf16_f32 v44, v100, v101
    v_cvt_pk_bf16_f32 v45, v102, v103
    v_mfma_f32_16x16x32_bf16 v[104:107], a[168:171], v[148:151], v[104:107]
    v_rcp_f32 v28, v28
    v_mfma_f32_16x16x32_bf16 v[104:107], a[192:195], v[152:155], v[104:107]
    v_mul_f32 v26, v26, v8
    v_mul_f32 v27, v27, v9
    v_mfma_f32_16x16x32_bf16 v[104:107], a[216:219], v[156:159], v[104:107]
    v_mul_f32 v26, v26, v28
    v_mul_f32 v27, v27, v28
    v_mfma_f32_16x16x32_bf16 v[104:107], a[240:243], v[160:163], v[104:107]
    v_cvt_pk_bf16_f32 v26, v26, v26
    v_cvt_pk_bf16_f32 v27, v27, v27
    v_mfma_f32_16x16x32_bf16 v[104:107], v[184:187], v[164:167], v[104:107]
    v_and_b32 v80, v26, v14
    v_and_b32 v81, v27, v15
    v_mfma_f32_16x16x32_bf16 v[104:107], v[208:211], v[168:171], v[104:107]
    v_and_b32 v82, v26, v16
    v_and_b32 v83, v27, v17
    v_mfma_f32_16x16x32_bf16 v[104:107], v[232:235], v[172:175], v[104:107]
    v_mfma_f32_16x16x32_bf16 v[108:111], a[4:7], v[120:123], 0
    ds_read_b64_tr_b16 v[120:121], v4 offset:32768
    ds_read_b64_tr_b16 v[122:123], v25 offset:32768
    v_mfma_f32_16x16x32_bf16 v[108:111], a[28:31], v[124:127], v[108:111]
    ds_read_b64_tr_b16 v[124:125], v4 offset:33792
    ds_read_b64_tr_b16 v[126:127], v25 offset:33792
    v_mfma_f32_16x16x32_bf16 v[108:111], a[52:55], v[128:131], v[108:111]
    ds_read_b64_tr_b16 v[128:129], v4 offset:34816
    ds_read_b64_tr_b16 v[130:131], v25 offset:34816
    v_mfma_f32_16x16x32_bf16 v[108:111], a[76:79], v[132:135], v[108:111]
    ds_read_b64_tr_b16 v[132:133], v4 offset:35840
    ds_read_b64_tr_b16 v[134:135], v25 offset:35840
    v_mfma_f32_16x16x32_bf16 v[108:111], a[100:103], v[136:139], v[108:111]
    ds_read_b64_tr_b16 v[136:137], v4 offset:36864
    ds_read_b64_tr_b16 v[138:139], v25 offset:36864
    v_mfma_f32_16x16x32_bf16 v[108:111], a[124:127], v[140:143], v[108:111]
    ds_read_b64_tr_b16 v[140:141], v4 offset:37888
    ds_read_b64_tr_b16 v[142:143], v25 offset:37888
    v_mfma_f32_16x16x32_bf16 v[108:111], a[148:151], v[144:147], v[108:111]
    ds_read_b64_tr_b16 v[144:145], v4 offset:38912
    ds_read_b64_tr_b16 v[146:147], v25 offset:38912
    v_mfma_f32_16x16x32_bf16 v[108:111], a[172:175], v[148:151], v[108:111]
    ds_read_b64_tr_b16 v[148:149], v4 offset:39936
    ds_read_b64_tr_b16 v[150:151], v25 offset:39936
    v_mfma_f32_16x16x32_bf16 v[108:111], a[196:199], v[152:155], v[108:111]
    ds_read_b64_tr_b16 v[152:153], v4 offset:40960
    ds_read_b64_tr_b16 v[154:155], v25 offset:40960
    v_mfma_f32_16x16x32_bf16 v[108:111], a[220:223], v[156:159], v[108:111]
    ds_read_b64_tr_b16 v[156:157], v4 offset:41984
    ds_read_b64_tr_b16 v[158:159], v25 offset:41984
    v_mfma_f32_16x16x32_bf16 v[108:111], a[244:247], v[160:163], v[108:111]
    ds_read_b64_tr_b16 v[160:161], v4 offset:43008
    ds_read_b64_tr_b16 v[162:163], v25 offset:43008
    v_mfma_f32_16x16x32_bf16 v[108:111], v[188:191], v[164:167], v[108:111]
    ds_read_b64_tr_b16 v[164:165], v4 offset:44032
    ds_read_b64_tr_b16 v[166:167], v25 offset:44032
    v_mfma_f32_16x16x32_bf16 v[108:111], v[212:215], v[168:171], v[108:111]
    ds_read_b64_tr_b16 v[168:169], v4 offset:45056
    ds_read_b64_tr_b16 v[170:171], v25 offset:45056
    v_mfma_f32_16x16x32_bf16 v[108:111], v[236:239], v[172:175], v[108:111]
    ds_read_b64_tr_b16 v[172:173], v4 offset:46080
    ds_read_b64_tr_b16 v[174:175], v25 offset:46080
    s_waitcnt lgkmcnt(15)
    v_mfma_f32_16x16x32_bf16 v[112:115], a[8:11], v[120:123], 0
    v_cvt_pk_bf16_f32 v68, v104, v105
    v_cvt_pk_bf16_f32 v69, v106, v107
    v_mfma_f32_16x16x32_bf16 v[112:115], a[32:35], v[124:127], v[112:115]
    v_mfma_f32_16x16x32_bf16 v[72:75], v[38:41], v[80:83], 0
    v_mfma_f32_16x16x32_bf16 v[112:115], a[56:59], v[128:131], v[112:115]
    v_mfma_f32_16x16x32_bf16 v[76:79], v[48:51], v[80:83], 0
    v_mfma_f32_16x16x32_bf16 v[112:115], a[80:83], v[132:135], v[112:115]
    s_add_u32 s53, s74, 49152
    v_mfma_f32_16x16x32_bf16 v[112:115], a[104:107], v[136:139], v[112:115]
    v_mfma_f32_16x16x32_bf16 v[112:115], a[128:131], v[140:143], v[112:115]
    s_waitcnt lgkmcnt(10)
    v_mfma_f32_16x16x32_bf16 v[112:115], a[152:155], v[144:147], v[112:115]
    v_cvt_pk_bf16_f32 v70, v108, v109
    v_cvt_pk_bf16_f32 v71, v110, v111
    v_mfma_f32_16x16x32_bf16 v[112:115], a[176:179], v[148:151], v[112:115]
    v_cndmask_b32 v70, v70, 0, s[82:83]
    v_cndmask_b32 v71, v71, 0, s[82:83]
    v_mfma_f32_16x16x32_bf16 v[112:115], a[200:203], v[152:155], v[112:115]
    v_cvt_pk_bf16_f32 v84, v72, v73
    v_cvt_pk_bf16_f32 v85, v74, v75
    s_waitcnt lgkmcnt(4)
    v_mfma_f32_16x16x32_bf16 v[112:115], a[224:227], v[156:159], v[112:115]
    v_cvt_pk_bf16_f32 v86, v76, v77
    v_cvt_pk_bf16_f32 v87, v78, v79
    v_mfma_f32_16x16x32_bf16 v[112:115], a[248:251], v[160:163], v[112:115]
    v_cndmask_b32 v86, v86, 0, s[82:83]
    v_cndmask_b32 v87, v87, 0, s[82:83]
    v_mfma_f32_16x16x32_bf16 v[112:115], v[192:195], v[164:167], v[112:115]
    buffer_store_dwordx4 v[84:87], v23, s[24:27], s53 offen sc1
    s_waitcnt lgkmcnt(0)
    v_mfma_f32_16x16x32_bf16 v[112:115], v[216:219], v[168:171], v[112:115]
    v_add_u32 v92, 65536, v92
    v_add_u32 v93, 65536, v93
    v_mfma_f32_16x16x32_bf16 v[112:115], v[240:243], v[172:175], v[112:115]
    v_add_u32 v94, 65536, v94
    v_mfma_f32_16x16x32_bf16 v[116:119], a[12:15], v[120:123], 0
    v_mfma_f32_16x16x32_bf16 v[72:75], v[56:59], v[68:71], 0
    v_mfma_f32_16x16x32_bf16 v[116:119], a[36:39], v[124:127], v[116:119]
    v_mfma_f32_16x16x32_bf16 v[76:79], v[60:63], v[68:71], 0
    v_mfma_f32_16x16x32_bf16 v[116:119], a[60:63], v[128:131], v[116:119]
    ds_read_u16_d16_hi v8, v93 offset:0
    ds_read_u16_d16_hi v9, v94 offset:0
    v_mfma_f32_16x16x32_bf16 v[116:119], a[84:87], v[132:135], v[116:119]
    ds_read_u16_d16_hi v10, v92 offset:0
    v_mfma_f32_16x16x32_bf16 v[116:119], a[108:111], v[136:139], v[116:119]
    v_mfma_f32_16x16x32_bf16 v[116:119], a[132:135], v[140:143], v[116:119]
    v_mfma_f32_16x16x32_bf16 v[116:119], a[156:159], v[144:147], v[116:119]
    v_cvt_pk_bf16_f32 v52, v112, v113
    v_cvt_pk_bf16_f32 v53, v114, v115
    v_mfma_f32_16x16x32_bf16 v[116:119], a[180:183], v[148:151], v[116:119]
    v_cndmask_b32 v26, v72, v73, s[76:77]
    v_cndmask_b32 v27, v74, v75, s[76:77]
    v_mfma_f32_16x16x32_bf16 v[116:119], a[204:207], v[152:155], v[116:119]
    v_cndmask_b32 v28, v76, v77, s[76:77]
    v_cndmask_b32 v29, v78, v79, s[76:77]
    v_mfma_f32_16x16x32_bf16 v[116:119], a[228:231], v[156:159], v[116:119]
    v_cndmask_b32 v26, v26, v28, s[78:79]
    v_cndmask_b32 v27, v27, v29, s[80:81]
    v_mfma_f32_16x16x32_bf16 v[116:119], a[252:255], v[160:163], v[116:119]
    s_waitcnt lgkmcnt(0)
    v_mul_f32 v26, v26, v8
    v_mfma_f32_16x16x32_bf16 v[116:119], v[196:199], v[164:167], v[116:119]
    v_mul_f32 v27, v27, v9
    v_mul_f32 v11, s91, v10
    v_mfma_f32_16x16x32_bf16 v[116:119], v[220:223], v[168:171], v[116:119]
    v_max_f32 v28, v26, v27
    v_mov_b32 v29, v28
    v_mfma_f32_16x16x32_bf16 v[116:119], v[244:247], v[172:175], v[116:119]
    v_mfma_f32_16x16x32_bf16 v[96:99], v[120:123], a[16:19], 0
    v_permlane16_swap_b32 v28, v29
    v_max_f32 v28, v28, v29
    v_mfma_f32_16x16x32_bf16 v[96:99], v[124:127], a[40:43], v[96:99]
    v_mov_b32 v29, v28
    v_mfma_f32_16x16x32_bf16 v[96:99], v[128:131], a[64:67], v[96:99]
    v_mfma_f32_16x16x32_bf16 v[96:99], v[132:135], a[88:91], v[96:99]
    v_permlane32_swap_b32 v28, v29
    v_max_f32 v28, v28, v29
    v_mfma_f32_16x16x32_bf16 v[96:99], v[136:139], a[112:115], v[96:99]
    v_sub_f32 v26, v26, v28
    v_sub_f32 v27, v27, v28
    v_mfma_f32_16x16x32_bf16 v[96:99], v[140:143], a[136:139], v[96:99]
    v_mul_f32 v26, v11, v26
    v_mul_f32 v27, v11, v27
    v_mfma_f32_16x16x32_bf16 v[96:99], v[144:147], a[160:163], v[96:99]
    v_cvt_pk_bf16_f32 v54, v116, v117
    v_cvt_pk_bf16_f32 v55, v118, v119
    v_mfma_f32_16x16x32_bf16 v[96:99], v[148:151], a[184:187], v[96:99]
    v_cndmask_b32 v54, v54, 0, s[82:83]
    v_cndmask_b32 v55, v55, 0, s[82:83]
    v_mfma_f32_16x16x32_bf16 v[96:99], v[152:155], a[208:211], v[96:99]
    v_exp_f32 v26, v26
    v_mfma_f32_16x16x32_bf16 v[96:99], v[156:159], a[232:235], v[96:99]
    v_exp_f32 v27, v27
    v_mfma_f32_16x16x32_bf16 v[96:99], v[160:163], v[176:179], v[96:99]
    v_add_f32 v28, v26, v27
    v_mov_b32 v29, v28
    v_mfma_f32_16x16x32_bf16 v[96:99], v[164:167], v[200:203], v[96:99]
    v_mfma_f32_16x16x32_bf16 v[96:99], v[168:171], v[224:227], v[96:99]
    v_permlane16_swap_b32 v28, v29
    v_add_f32 v28, v28, v29
    v_mfma_f32_16x16x32_bf16 v[96:99], v[172:175], v[248:251], v[96:99]
    v_mov_b32 v29, v28
    v_mfma_f32_16x16x32_bf16 v[100:103], v[120:123], a[20:23], 0
    v_mfma_f32_16x16x32_bf16 v[100:103], v[124:127], a[44:47], v[100:103]
    v_permlane32_swap_b32 v28, v29
    v_add_f32 v28, v28, v29
    v_mfma_f32_16x16x32_bf16 v[100:103], v[128:131], a[68:71], v[100:103]
    v_rcp_f32 v28, v28
    v_mfma_f32_16x16x32_bf16 v[100:103], v[132:135], a[92:95], v[100:103]
    v_mul_f32 v26, v26, v8
    v_mul_f32 v27, v27, v9
    v_mfma_f32_16x16x32_bf16 v[100:103], v[136:139], a[116:119], v[100:103]
    v_mul_f32 v26, v26, v28
    v_mul_f32 v27, v27, v28
    v_mfma_f32_16x16x32_bf16 v[100:103], v[140:143], a[140:143], v[100:103]
    v_cvt_pk_bf16_f32 v26, v26, v26
    v_cvt_pk_bf16_f32 v27, v27, v27
    v_mfma_f32_16x16x32_bf16 v[100:103], v[144:147], a[164:167], v[100:103]
    v_cvt_pk_bf16_f32 v36, v96, v97
    v_cvt_pk_bf16_f32 v37, v98, v99
    v_mfma_f32_16x16x32_bf16 v[100:103], v[148:151], a[188:191], v[100:103]
    v_and_b32 v80, v26, v14
    v_and_b32 v81, v27, v15
    v_mfma_f32_16x16x32_bf16 v[100:103], v[152:155], a[212:215], v[100:103]
    v_and_b32 v82, v26, v16
    v_and_b32 v83, v27, v17
    v_mfma_f32_16x16x32_bf16 v[100:103], v[156:159], a[236:239], v[100:103]
    v_mfma_f32_16x16x32_bf16 v[100:103], v[160:163], v[180:183], v[100:103]
    v_mfma_f32_16x16x32_bf16 v[72:75], v[32:35], v[80:83], 0
    v_mfma_f32_16x16x32_bf16 v[100:103], v[164:167], v[204:207], v[100:103]
    v_mfma_f32_16x16x32_bf16 v[76:79], v[42:45], v[80:83], 0
    v_mfma_f32_16x16x32_bf16 v[100:103], v[168:171], v[228:231], v[100:103]
    s_add_u32 s53, s74, 65536
    v_mfma_f32_16x16x32_bf16 v[100:103], v[172:175], v[252:255], v[100:103]
    v_mfma_f32_16x16x32_bf16 v[104:107], a[0:3], v[120:123], 0
    v_mfma_f32_16x16x32_bf16 v[104:107], a[24:27], v[124:127], v[104:107]
    v_mfma_f32_16x16x32_bf16 v[104:107], a[48:51], v[128:131], v[104:107]
    v_mfma_f32_16x16x32_bf16 v[104:107], a[72:75], v[132:135], v[104:107]
    v_cvt_pk_bf16_f32 v84, v72, v73
    v_cvt_pk_bf16_f32 v85, v74, v75
    v_mfma_f32_16x16x32_bf16 v[104:107], a[96:99], v[136:139], v[104:107]
    v_cvt_pk_bf16_f32 v86, v76, v77
    v_cvt_pk_bf16_f32 v87, v78, v79
    v_mfma_f32_16x16x32_bf16 v[104:107], a[120:123], v[140:143], v[104:107]
    v_cndmask_b32 v86, v86, 0, s[82:83]
    v_cndmask_b32 v87, v87, 0, s[82:83]
    v_mfma_f32_16x16x32_bf16 v[104:107], a[144:147], v[144:147], v[104:107]
    v_cvt_pk_bf16_f32 v46, v100, v101
    v_cvt_pk_bf16_f32 v47, v102, v103
    v_mfma_f32_16x16x32_bf16 v[104:107], a[168:171], v[148:151], v[104:107]
    buffer_store_dwordx4 v[84:87], v23, s[24:27], s53 offen sc1
    v_mfma_f32_16x16x32_bf16 v[104:107], a[192:195], v[152:155], v[104:107]
    v_mfma_f32_16x16x32_bf16 v[104:107], a[216:219], v[156:159], v[104:107]
    v_mfma_f32_16x16x32_bf16 v[104:107], a[240:243], v[160:163], v[104:107]
    v_mfma_f32_16x16x32_bf16 v[104:107], v[184:187], v[164:167], v[104:107]
    v_mfma_f32_16x16x32_bf16 v[104:107], v[208:211], v[168:171], v[104:107]
    v_mfma_f32_16x16x32_bf16 v[104:107], v[232:235], v[172:175], v[104:107]
    v_mfma_f32_16x16x32_bf16 v[108:111], a[4:7], v[120:123], 0
    ds_read_b64_tr_b16 v[120:121], v4 offset:49152
    ds_read_b64_tr_b16 v[122:123], v25 offset:49152
    v_mfma_f32_16x16x32_bf16 v[108:111], a[28:31], v[124:127], v[108:111]
    ds_read_b64_tr_b16 v[124:125], v4 offset:50176
    ds_read_b64_tr_b16 v[126:127], v25 offset:50176
    v_mfma_f32_16x16x32_bf16 v[108:111], a[52:55], v[128:131], v[108:111]
    ds_read_b64_tr_b16 v[128:129], v4 offset:51200
    ds_read_b64_tr_b16 v[130:131], v25 offset:51200
    v_mfma_f32_16x16x32_bf16 v[108:111], a[76:79], v[132:135], v[108:111]
    ds_read_b64_tr_b16 v[132:133], v4 offset:52224
    ds_read_b64_tr_b16 v[134:135], v25 offset:52224
    v_mfma_f32_16x16x32_bf16 v[108:111], a[100:103], v[136:139], v[108:111]
    ds_read_b64_tr_b16 v[136:137], v4 offset:53248
    ds_read_b64_tr_b16 v[138:139], v25 offset:53248
    v_mfma_f32_16x16x32_bf16 v[108:111], a[124:127], v[140:143], v[108:111]
    ds_read_b64_tr_b16 v[140:141], v4 offset:54272
    ds_read_b64_tr_b16 v[142:143], v25 offset:54272
    v_mfma_f32_16x16x32_bf16 v[108:111], a[148:151], v[144:147], v[108:111]
    ds_read_b64_tr_b16 v[144:145], v4 offset:55296
    ds_read_b64_tr_b16 v[146:147], v25 offset:55296
    v_mfma_f32_16x16x32_bf16 v[108:111], a[172:175], v[148:151], v[108:111]
    ds_read_b64_tr_b16 v[148:149], v4 offset:56320
    ds_read_b64_tr_b16 v[150:151], v25 offset:56320
    v_mfma_f32_16x16x32_bf16 v[108:111], a[196:199], v[152:155], v[108:111]
    ds_read_b64_tr_b16 v[152:153], v4 offset:57344
    ds_read_b64_tr_b16 v[154:155], v25 offset:57344
    v_mfma_f32_16x16x32_bf16 v[108:111], a[220:223], v[156:159], v[108:111]
    ds_read_b64_tr_b16 v[156:157], v4 offset:58368
    ds_read_b64_tr_b16 v[158:159], v25 offset:58368
    v_mfma_f32_16x16x32_bf16 v[108:111], a[244:247], v[160:163], v[108:111]
    ds_read_b64_tr_b16 v[160:161], v4 offset:59392
    ds_read_b64_tr_b16 v[162:163], v25 offset:59392
    v_mfma_f32_16x16x32_bf16 v[108:111], v[188:191], v[164:167], v[108:111]
    ds_read_b64_tr_b16 v[164:165], v4 offset:60416
    ds_read_b64_tr_b16 v[166:167], v25 offset:60416
    v_mfma_f32_16x16x32_bf16 v[108:111], v[212:215], v[168:171], v[108:111]
    ds_read_b64_tr_b16 v[168:169], v4 offset:61440
    ds_read_b64_tr_b16 v[170:171], v25 offset:61440
    v_mfma_f32_16x16x32_bf16 v[108:111], v[236:239], v[172:175], v[108:111]
    ds_read_b64_tr_b16 v[172:173], v4 offset:62464
    ds_read_b64_tr_b16 v[174:175], v25 offset:62464
    s_waitcnt lgkmcnt(15)
    v_mfma_f32_16x16x32_bf16 v[112:115], a[8:11], v[120:123], 0
    v_cvt_pk_bf16_f32 v64, v104, v105
    v_cvt_pk_bf16_f32 v65, v106, v107
    v_mfma_f32_16x16x32_bf16 v[112:115], a[32:35], v[124:127], v[112:115]
    v_mfma_f32_16x16x32_bf16 v[112:115], a[56:59], v[128:131], v[112:115]
    v_mfma_f32_16x16x32_bf16 v[112:115], a[80:83], v[132:135], v[112:115]
    v_mfma_f32_16x16x32_bf16 v[112:115], a[104:107], v[136:139], v[112:115]
    v_mfma_f32_16x16x32_bf16 v[112:115], a[128:131], v[140:143], v[112:115]
    s_waitcnt lgkmcnt(10)
    v_mfma_f32_16x16x32_bf16 v[112:115], a[152:155], v[144:147], v[112:115]
    v_cvt_pk_bf16_f32 v66, v108, v109
    v_cvt_pk_bf16_f32 v67, v110, v111
    v_mfma_f32_16x16x32_bf16 v[112:115], a[176:179], v[148:151], v[112:115]
    v_cndmask_b32 v66, v66, 0, s[82:83]
    v_cndmask_b32 v67, v67, 0, s[82:83]
    v_mfma_f32_16x16x32_bf16 v[112:115], a[200:203], v[152:155], v[112:115]
    s_waitcnt lgkmcnt(4)
    v_mfma_f32_16x16x32_bf16 v[112:115], a[224:227], v[156:159], v[112:115]
    v_mfma_f32_16x16x32_bf16 v[72:75], v[60:63], v[64:67], 0
    v_mfma_f32_16x16x32_bf16 v[112:115], a[248:251], v[160:163], v[112:115]
    v_mfma_f32_16x16x32_bf16 v[76:79], v[52:55], v[64:67], 0
    v_mfma_f32_16x16x32_bf16 v[112:115], v[192:195], v[164:167], v[112:115]
    ds_read_u16_d16_hi v8, v93 offset:16384
    ds_read_u16_d16_hi v9, v94 offset:16384
    s_waitcnt lgkmcnt(2)
    v_mfma_f32_16x16x32_bf16 v[112:115], v[216:219], v[168:171], v[112:115]
    ds_read_u16_d16_hi v10, v92 offset:16384
    v_mfma_f32_16x16x32_bf16 v[112:115], v[240:243], v[172:175], v[112:115]
    v_mfma_f32_16x16x32_bf16 v[116:119], a[12:15], v[120:123], 0
    v_mfma_f32_16x16x32_bf16 v[116:119], a[36:39], v[124:127], v[116:119]
    v_mfma_f32_16x16x32_bf16 v[116:119], a[60:63], v[128:131], v[116:119]
    v_cndmask_b32 v26, v72, v73, s[76:77]
    v_cndmask_b32 v27, v74, v75, s[76:77]
    v_mfma_f32_16x16x32_bf16 v[116:119], a[84:87], v[132:135], v[116:119]
    v_cndmask_b32 v28, v76, v77, s[76:77]
    v_cndmask_b32 v29, v78, v79, s[76:77]
    v_mfma_f32_16x16x32_bf16 v[116:119], a[108:111], v[136:139], v[116:119]
    v_cndmask_b32 v26, v26, v28, s[78:79]
    v_cndmask_b32 v27, v27, v29, s[80:81]
    v_mfma_f32_16x16x32_bf16 v[116:119], a[132:135], v[140:143], v[116:119]
    s_waitcnt lgkmcnt(0)
    v_mul_f32 v26, v26, v8
    v_mfma_f32_16x16x32_bf16 v[116:119], a[156:159], v[144:147], v[116:119]
    v_cvt_pk_bf16_f32 v56, v112, v113
    v_cvt_pk_bf16_f32 v57, v114, v115
    v_mfma_f32_16x16x32_bf16 v[116:119], a[180:183], v[148:151], v[116:119]
    v_mul_f32 v27, v27, v9
    v_mul_f32 v11, s91, v10
    v_mfma_f32_16x16x32_bf16 v[116:119], a[204:207], v[152:155], v[116:119]
    v_max_f32 v28, v26, v27
    v_mov_b32 v29, v28
    v_mfma_f32_16x16x32_bf16 v[116:119], a[228:231], v[156:159], v[116:119]
    v_mfma_f32_16x16x32_bf16 v[116:119], a[252:255], v[160:163], v[116:119]
    v_permlane16_swap_b32 v28, v29
    v_max_f32 v28, v28, v29
    v_mfma_f32_16x16x32_bf16 v[116:119], v[196:199], v[164:167], v[116:119]
    v_mov_b32 v29, v28
    v_mfma_f32_16x16x32_bf16 v[116:119], v[220:223], v[168:171], v[116:119]
    v_mfma_f32_16x16x32_bf16 v[116:119], v[244:247], v[172:175], v[116:119]
    v_permlane32_swap_b32 v28, v29
    v_max_f32 v28, v28, v29
    v_mfma_f32_16x16x32_bf16 v[96:99], v[120:123], a[16:19], 0
    v_sub_f32 v26, v26, v28
    v_sub_f32 v27, v27, v28
    v_mfma_f32_16x16x32_bf16 v[96:99], v[124:127], a[40:43], v[96:99]
    v_mul_f32 v26, v11, v26
    v_mul_f32 v27, v11, v27
    v_mfma_f32_16x16x32_bf16 v[96:99], v[128:131], a[64:67], v[96:99]
    v_exp_f32 v26, v26
    v_mfma_f32_16x16x32_bf16 v[96:99], v[132:135], a[88:91], v[96:99]
    v_exp_f32 v27, v27
    v_mfma_f32_16x16x32_bf16 v[96:99], v[136:139], a[112:115], v[96:99]
    v_add_f32 v28, v26, v27
    v_mov_b32 v29, v28
    v_mfma_f32_16x16x32_bf16 v[96:99], v[140:143], a[136:139], v[96:99]
    v_mfma_f32_16x16x32_bf16 v[96:99], v[144:147], a[160:163], v[96:99]
    v_cvt_pk_bf16_f32 v58, v116, v117
    v_cvt_pk_bf16_f32 v59, v118, v119
    v_mfma_f32_16x16x32_bf16 v[96:99], v[148:151], a[184:187], v[96:99]
    v_cndmask_b32 v58, v58, 0, s[82:83]
    v_cndmask_b32 v59, v59, 0, s[82:83]
    v_mfma_f32_16x16x32_bf16 v[96:99], v[152:155], a[208:211], v[96:99]
    v_permlane16_swap_b32 v28, v29
    v_add_f32 v28, v28, v29
    v_mfma_f32_16x16x32_bf16 v[96:99], v[156:159], a[232:235], v[96:99]
    v_mov_b32 v29, v28
    v_mfma_f32_16x16x32_bf16 v[96:99], v[160:163], v[176:179], v[96:99]
    v_mfma_f32_16x16x32_bf16 v[96:99], v[164:167], v[200:203], v[96:99]
    v_permlane32_swap_b32 v28, v29
    v_add_f32 v28, v28, v29
    v_mfma_f32_16x16x32_bf16 v[96:99], v[168:171], v[224:227], v[96:99]
    v_rcp_f32 v28, v28
    v_mfma_f32_16x16x32_bf16 v[96:99], v[172:175], v[248:251], v[96:99]
    v_mul_f32 v26, v26, v8
    v_mul_f32 v27, v27, v9
    v_mfma_f32_16x16x32_bf16 v[100:103], v[120:123], a[20:23], 0
    v_mul_f32 v26, v26, v28
    v_mul_f32 v27, v27, v28
    v_mfma_f32_16x16x32_bf16 v[100:103], v[124:127], a[44:47], v[100:103]
    v_cvt_pk_bf16_f32 v26, v26, v26
    v_cvt_pk_bf16_f32 v27, v27, v27
    v_mfma_f32_16x16x32_bf16 v[100:103], v[128:131], a[68:71], v[100:103]
    v_and_b32 v80, v26, v14
    v_and_b32 v81, v27, v15
    v_mfma_f32_16x16x32_bf16 v[100:103], v[132:135], a[92:95], v[100:103]
    v_and_b32 v82, v26, v16
    v_and_b32 v83, v27, v17
    v_mfma_f32_16x16x32_bf16 v[100:103], v[136:139], a[116:119], v[100:103]
    v_mfma_f32_16x16x32_bf16 v[100:103], v[140:143], a[140:143], v[100:103]
    v_mfma_f32_16x16x32_bf16 v[72:75], v[34:37], v[80:83], 0
    v_mfma_f32_16x16x32_bf16 v[100:103], v[144:147], a[164:167], v[100:103]
    v_cvt_pk_bf16_f32 v38, v96, v97
    v_cvt_pk_bf16_f32 v39, v98, v99
    v_mfma_f32_16x16x32_bf16 v[100:103], v[148:151], a[188:191], v[100:103]
    v_mfma_f32_16x16x32_bf16 v[76:79], v[44:47], v[80:83], 0
    v_mfma_f32_16x16x32_bf16 v[100:103], v[152:155], a[212:215], v[100:103]
    s_add_u32 s53, s74, 81920
    v_mfma_f32_16x16x32_bf16 v[100:103], v[156:159], a[236:239], v[100:103]
    v_mfma_f32_16x16x32_bf16 v[100:103], v[160:163], v[180:183], v[100:103]
    v_mfma_f32_16x16x32_bf16 v[100:103], v[164:167], v[204:207], v[100:103]
    v_mfma_f32_16x16x32_bf16 v[100:103], v[168:171], v[228:231], v[100:103]
    v_mfma_f32_16x16x32_bf16 v[100:103], v[172:175], v[252:255], v[100:103]
    v_cvt_pk_bf16_f32 v84, v72, v73
    v_cvt_pk_bf16_f32 v85, v74, v75
    v_mfma_f32_16x16x32_bf16 v[104:107], a[0:3], v[120:123], 0
    v_cvt_pk_bf16_f32 v86, v76, v77
    v_cvt_pk_bf16_f32 v87, v78, v79
    v_mfma_f32_16x16x32_bf16 v[104:107], a[24:27], v[124:127], v[104:107]
    v_cndmask_b32 v86, v86, 0, s[82:83]
    v_cndmask_b32 v87, v87, 0, s[82:83]
    v_mfma_f32_16x16x32_bf16 v[104:107], a[48:51], v[128:131], v[104:107]
    buffer_store_dwordx4 v[84:87], v23, s[24:27], s53 offen sc1
    v_mfma_f32_16x16x32_bf16 v[104:107], a[72:75], v[132:135], v[104:107]
    v_mfma_f32_16x16x32_bf16 v[104:107], a[96:99], v[136:139], v[104:107]
    v_mfma_f32_16x16x32_bf16 v[104:107], a[120:123], v[140:143], v[104:107]
    v_mfma_f32_16x16x32_bf16 v[104:107], a[144:147], v[144:147], v[104:107]
    v_cvt_pk_bf16_f32 v48, v100, v101
    v_cvt_pk_bf16_f32 v49, v102, v103
    v_mfma_f32_16x16x32_bf16 v[104:107], a[168:171], v[148:151], v[104:107]
    v_mfma_f32_16x16x32_bf16 v[104:107], a[192:195], v[152:155], v[104:107]
    v_mfma_f32_16x16x32_bf16 v[104:107], a[216:219], v[156:159], v[104:107]
    v_mfma_f32_16x16x32_bf16 v[104:107], a[240:243], v[160:163], v[104:107]
    v_mfma_f32_16x16x32_bf16 v[104:107], v[184:187], v[164:167], v[104:107]
    v_mfma_f32_16x16x32_bf16 v[104:107], v[208:211], v[168:171], v[104:107]
    v_mfma_f32_16x16x32_bf16 v[104:107], v[232:235], v[172:175], v[104:107]
    s_waitcnt vmcnt(10)
    s_barrier
    v_mfma_f32_16x16x32_bf16 v[108:111], a[4:7], v[120:123], 0
    v_add_u32 v4, 65536, v4
    v_add_u32 v25, 65536, v25
    ds_read_b64_tr_b16 v[120:121], v4 offset:0
    ds_read_b64_tr_b16 v[122:123], v25 offset:0
    v_mfma_f32_16x16x32_bf16 v[108:111], a[28:31], v[124:127], v[108:111]
    ds_read_b64_tr_b16 v[124:125], v4 offset:1024
    ds_read_b64_tr_b16 v[126:127], v25 offset:1024
    v_mfma_f32_16x16x32_bf16 v[108:111], a[52:55], v[128:131], v[108:111]
    ds_read_b64_tr_b16 v[128:129], v4 offset:2048
    ds_read_b64_tr_b16 v[130:131], v25 offset:2048
    v_mfma_f32_16x16x32_bf16 v[108:111], a[76:79], v[132:135], v[108:111]
    ds_read_b64_tr_b16 v[132:133], v4 offset:3072
    ds_read_b64_tr_b16 v[134:135], v25 offset:3072
    v_mfma_f32_16x16x32_bf16 v[108:111], a[100:103], v[136:139], v[108:111]
    ds_read_b64_tr_b16 v[136:137], v4 offset:4096
    ds_read_b64_tr_b16 v[138:139], v25 offset:4096
    v_mfma_f32_16x16x32_bf16 v[108:111], a[124:127], v[140:143], v[108:111]
    ds_read_b64_tr_b16 v[140:141], v4 offset:5120
    ds_read_b64_tr_b16 v[142:143], v25 offset:5120
    v_mfma_f32_16x16x32_bf16 v[108:111], a[148:151], v[144:147], v[108:111]
    ds_read_b64_tr_b16 v[144:145], v4 offset:6144
    ds_read_b64_tr_b16 v[146:147], v25 offset:6144
    v_mfma_f32_16x16x32_bf16 v[108:111], a[172:175], v[148:151], v[108:111]
    ds_read_b64_tr_b16 v[148:149], v4 offset:7168
    ds_read_b64_tr_b16 v[150:151], v25 offset:7168
    v_mfma_f32_16x16x32_bf16 v[108:111], a[196:199], v[152:155], v[108:111]
    ds_read_b64_tr_b16 v[152:153], v4 offset:8192
    ds_read_b64_tr_b16 v[154:155], v25 offset:8192
    v_mfma_f32_16x16x32_bf16 v[108:111], a[220:223], v[156:159], v[108:111]
    ds_read_b64_tr_b16 v[156:157], v4 offset:9216
    ds_read_b64_tr_b16 v[158:159], v25 offset:9216
    v_mfma_f32_16x16x32_bf16 v[108:111], a[244:247], v[160:163], v[108:111]
    ds_read_b64_tr_b16 v[160:161], v4 offset:10240
    ds_read_b64_tr_b16 v[162:163], v25 offset:10240
    v_mfma_f32_16x16x32_bf16 v[108:111], v[188:191], v[164:167], v[108:111]
    ds_read_b64_tr_b16 v[164:165], v4 offset:11264
    ds_read_b64_tr_b16 v[166:167], v25 offset:11264
    v_mfma_f32_16x16x32_bf16 v[108:111], v[212:215], v[168:171], v[108:111]
    ds_read_b64_tr_b16 v[168:169], v4 offset:12288
    ds_read_b64_tr_b16 v[170:171], v25 offset:12288
    v_mfma_f32_16x16x32_bf16 v[108:111], v[236:239], v[172:175], v[108:111]
    ds_read_b64_tr_b16 v[172:173], v4 offset:13312
    ds_read_b64_tr_b16 v[174:175], v25 offset:13312
    s_waitcnt lgkmcnt(15)
    v_mfma_f32_16x16x32_bf16 v[112:115], a[0:3], v[120:123], 0
    v_cvt_pk_bf16_f32 v68, v104, v105
    v_cvt_pk_bf16_f32 v69, v106, v107
    v_mfma_f32_16x16x32_bf16 v[112:115], a[24:27], v[124:127], v[112:115]
    v_mfma_f32_16x16x32_bf16 v[112:115], a[48:51], v[128:131], v[112:115]
    v_mfma_f32_16x16x32_bf16 v[112:115], a[72:75], v[132:135], v[112:115]
    v_mfma_f32_16x16x32_bf16 v[112:115], a[96:99], v[136:139], v[112:115]
    v_mfma_f32_16x16x32_bf16 v[112:115], a[120:123], v[140:143], v[112:115]
    s_waitcnt lgkmcnt(10)
    v_mfma_f32_16x16x32_bf16 v[112:115], a[144:147], v[144:147], v[112:115]
    v_cvt_pk_bf16_f32 v70, v108, v109
    v_cvt_pk_bf16_f32 v71, v110, v111
    v_mfma_f32_16x16x32_bf16 v[112:115], a[168:171], v[148:151], v[112:115]
    v_cndmask_b32 v70, v70, 0, s[82:83]
    v_cndmask_b32 v71, v71, 0, s[82:83]
    v_mfma_f32_16x16x32_bf16 v[112:115], a[192:195], v[152:155], v[112:115]
    s_waitcnt lgkmcnt(4)
    v_mfma_f32_16x16x32_bf16 v[112:115], a[216:219], v[156:159], v[112:115]
    v_mfma_f32_16x16x32_bf16 v[72:75], v[52:55], v[68:71], 0
    v_mfma_f32_16x16x32_bf16 v[112:115], a[240:243], v[160:163], v[112:115]
    v_mfma_f32_16x16x32_bf16 v[76:79], v[56:59], v[68:71], 0
    v_mfma_f32_16x16x32_bf16 v[112:115], v[184:187], v[164:167], v[112:115]
    ds_read_u16_d16_hi v8, v93 offset:32768
    ds_read_u16_d16_hi v9, v94 offset:32768
    s_waitcnt lgkmcnt(2)
    v_mfma_f32_16x16x32_bf16 v[112:115], v[208:211], v[168:171], v[112:115]
    ds_read_u16_d16_hi v10, v92 offset:32768
    v_mfma_f32_16x16x32_bf16 v[112:115], v[232:235], v[172:175], v[112:115]
    v_mfma_f32_16x16x32_bf16 v[116:119], a[4:7], v[120:123], 0
    v_mfma_f32_16x16x32_bf16 v[116:119], a[28:31], v[124:127], v[116:119]
    v_mfma_f32_16x16x32_bf16 v[116:119], a[52:55], v[128:131], v[116:119]
    v_cndmask_b32 v26, v72, v73, s[76:77]
    v_cndmask_b32 v27, v74, v75, s[76:77]
    v_mfma_f32_16x16x32_bf16 v[116:119], a[76:79], v[132:135], v[116:119]
    v_cndmask_b32 v28, v76, v77, s[76:77]
    v_cndmask_b32 v29, v78, v79, s[76:77]
    v_mfma_f32_16x16x32_bf16 v[116:119], a[100:103], v[136:139], v[116:119]
    v_cndmask_b32 v26, v26, v28, s[78:79]
    v_cndmask_b32 v27, v27, v29, s[80:81]
    v_mfma_f32_16x16x32_bf16 v[116:119], a[124:127], v[140:143], v[116:119]
    s_waitcnt lgkmcnt(0)
    v_mul_f32 v26, v26, v8
    v_mfma_f32_16x16x32_bf16 v[116:119], a[148:151], v[144:147], v[116:119]
    v_cvt_pk_bf16_f32 v64, v112, v113
    v_cvt_pk_bf16_f32 v65, v114, v115
    v_mfma_f32_16x16x32_bf16 v[116:119], a[172:175], v[148:151], v[116:119]
    v_mul_f32 v27, v27, v9
    v_mul_f32 v11, s91, v10
    v_mfma_f32_16x16x32_bf16 v[116:119], a[196:199], v[152:155], v[116:119]
    v_max_f32 v28, v26, v27
    v_mov_b32 v29, v28
    v_mfma_f32_16x16x32_bf16 v[116:119], a[220:223], v[156:159], v[116:119]
    v_mfma_f32_16x16x32_bf16 v[116:119], a[244:247], v[160:163], v[116:119]
    v_permlane16_swap_b32 v28, v29
    v_max_f32 v28, v28, v29
    v_mfma_f32_16x16x32_bf16 v[116:119], v[188:191], v[164:167], v[116:119]
    v_mov_b32 v29, v28
    v_mfma_f32_16x16x32_bf16 v[116:119], v[212:215], v[168:171], v[116:119]
    v_mfma_f32_16x16x32_bf16 v[116:119], v[236:239], v[172:175], v[116:119]
    v_permlane32_swap_b32 v28, v29
    v_max_f32 v28, v28, v29
    v_mfma_f32_16x16x32_bf16 v[96:99], a[8:11], v[120:123], 0
    v_sub_f32 v26, v26, v28
    v_sub_f32 v27, v27, v28
    v_mfma_f32_16x16x32_bf16 v[96:99], a[32:35], v[124:127], v[96:99]
    v_mul_f32 v26, v11, v26
    v_mul_f32 v27, v11, v27
    v_mfma_f32_16x16x32_bf16 v[96:99], a[56:59], v[128:131], v[96:99]
    v_exp_f32 v26, v26
    v_mfma_f32_16x16x32_bf16 v[96:99], a[80:83], v[132:135], v[96:99]
    v_exp_f32 v27, v27
    v_mfma_f32_16x16x32_bf16 v[96:99], a[104:107], v[136:139], v[96:99]
    v_add_f32 v28, v26, v27
    v_mov_b32 v29, v28
    v_mfma_f32_16x16x32_bf16 v[96:99], a[128:131], v[140:143], v[96:99]
    v_mfma_f32_16x16x32_bf16 v[96:99], a[152:155], v[144:147], v[96:99]
    v_cvt_pk_bf16_f32 v66, v116, v117
    v_cvt_pk_bf16_f32 v67, v118, v119
    v_mfma_f32_16x16x32_bf16 v[96:99], a[176:179], v[148:151], v[96:99]
    v_cndmask_b32 v66, v66, 0, s[82:83]
    v_cndmask_b32 v67, v67, 0, s[82:83]
    v_mfma_f32_16x16x32_bf16 v[96:99], a[200:203], v[152:155], v[96:99]
    v_permlane16_swap_b32 v28, v29
    v_add_f32 v28, v28, v29
    v_mfma_f32_16x16x32_bf16 v[96:99], a[224:227], v[156:159], v[96:99]
    v_mov_b32 v29, v28
    v_mfma_f32_16x16x32_bf16 v[96:99], a[248:251], v[160:163], v[96:99]
    v_mfma_f32_16x16x32_bf16 v[96:99], v[192:195], v[164:167], v[96:99]
    v_permlane32_swap_b32 v28, v29
    v_add_f32 v28, v28, v29
    v_mfma_f32_16x16x32_bf16 v[96:99], v[216:219], v[168:171], v[96:99]
    v_rcp_f32 v28, v28
    v_mfma_f32_16x16x32_bf16 v[96:99], v[240:243], v[172:175], v[96:99]
    v_mul_f32 v26, v26, v8
    v_mul_f32 v27, v27, v9
    v_mfma_f32_16x16x32_bf16 v[100:103], a[12:15], v[120:123], 0
    v_mul_f32 v26, v26, v28
    v_mul_f32 v27, v27, v28
    v_mfma_f32_16x16x32_bf16 v[100:103], a[36:39], v[124:127], v[100:103]
    v_cvt_pk_bf16_f32 v26, v26, v26
    v_cvt_pk_bf16_f32 v27, v27, v27
    v_mfma_f32_16x16x32_bf16 v[100:103], a[60:63], v[128:131], v[100:103]
    v_and_b32 v80, v26, v14
    v_and_b32 v81, v27, v15
    v_mfma_f32_16x16x32_bf16 v[100:103], a[84:87], v[132:135], v[100:103]
    v_and_b32 v82, v26, v16
    v_and_b32 v83, v27, v17
    v_mfma_f32_16x16x32_bf16 v[100:103], a[108:111], v[136:139], v[100:103]
    v_mfma_f32_16x16x32_bf16 v[100:103], a[132:135], v[140:143], v[100:103]
    v_mfma_f32_16x16x32_bf16 v[72:75], v[36:39], v[80:83], 0
    v_mfma_f32_16x16x32_bf16 v[100:103], a[156:159], v[144:147], v[100:103]
    v_cvt_pk_bf16_f32 v60, v96, v97
    v_cvt_pk_bf16_f32 v61, v98, v99
    v_mfma_f32_16x16x32_bf16 v[100:103], a[180:183], v[148:151], v[100:103]
    v_mfma_f32_16x16x32_bf16 v[76:79], v[46:49], v[80:83], 0
    v_mfma_f32_16x16x32_bf16 v[100:103], a[204:207], v[152:155], v[100:103]
    s_add_u32 s53, s74, 98304
    v_mfma_f32_16x16x32_bf16 v[100:103], a[228:231], v[156:159], v[100:103]
    v_mfma_f32_16x16x32_bf16 v[100:103], a[252:255], v[160:163], v[100:103]
    v_mfma_f32_16x16x32_bf16 v[100:103], v[196:199], v[164:167], v[100:103]
    v_mfma_f32_16x16x32_bf16 v[100:103], v[220:223], v[168:171], v[100:103]
    v_mfma_f32_16x16x32_bf16 v[100:103], v[244:247], v[172:175], v[100:103]
    v_cvt_pk_bf16_f32 v84, v72, v73
    v_cvt_pk_bf16_f32 v85, v74, v75
    v_mfma_f32_16x16x32_bf16 v[104:107], v[120:123], a[16:19], 0
    v_cvt_pk_bf16_f32 v86, v76, v77
    v_cvt_pk_bf16_f32 v87, v78, v79
    v_mfma_f32_16x16x32_bf16 v[104:107], v[124:127], a[40:43], v[104:107]
    v_cndmask_b32 v86, v86, 0, s[82:83]
    v_cndmask_b32 v87, v87, 0, s[82:83]
    v_mfma_f32_16x16x32_bf16 v[104:107], v[128:131], a[64:67], v[104:107]
    buffer_store_dwordx4 v[84:87], v23, s[24:27], s53 offen sc1
    v_mfma_f32_16x16x32_bf16 v[104:107], v[132:135], a[88:91], v[104:107]
    v_mfma_f32_16x16x32_bf16 v[104:107], v[136:139], a[112:115], v[104:107]
    v_mfma_f32_16x16x32_bf16 v[104:107], v[140:143], a[136:139], v[104:107]
    v_mfma_f32_16x16x32_bf16 v[104:107], v[144:147], a[160:163], v[104:107]
    v_cvt_pk_bf16_f32 v62, v100, v101
    v_cvt_pk_bf16_f32 v63, v102, v103
    v_mfma_f32_16x16x32_bf16 v[104:107], v[148:151], a[184:187], v[104:107]
    v_cndmask_b32 v62, v62, 0, s[82:83]
    v_cndmask_b32 v63, v63, 0, s[82:83]
    v_mfma_f32_16x16x32_bf16 v[104:107], v[152:155], a[208:211], v[104:107]
    v_mfma_f32_16x16x32_bf16 v[104:107], v[156:159], a[232:235], v[104:107]
    v_mfma_f32_16x16x32_bf16 v[72:75], v[56:59], v[64:67], 0
    v_mfma_f32_16x16x32_bf16 v[104:107], v[160:163], v[176:179], v[104:107]
    v_mfma_f32_16x16x32_bf16 v[76:79], v[60:63], v[64:67], 0
    v_mfma_f32_16x16x32_bf16 v[104:107], v[164:167], v[200:203], v[104:107]
    ds_read_u16_d16_hi v8, v93 offset:49152
    ds_read_u16_d16_hi v9, v94 offset:49152
    v_mfma_f32_16x16x32_bf16 v[104:107], v[168:171], v[224:227], v[104:107]
    ds_read_u16_d16_hi v10, v92 offset:49152
    v_mfma_f32_16x16x32_bf16 v[104:107], v[172:175], v[248:251], v[104:107]
    v_mfma_f32_16x16x32_bf16 v[108:111], v[120:123], a[20:23], 0
    v_mfma_f32_16x16x32_bf16 v[108:111], v[124:127], a[44:47], v[108:111]
    v_mfma_f32_16x16x32_bf16 v[108:111], v[128:131], a[68:71], v[108:111]
    v_cndmask_b32 v26, v72, v73, s[76:77]
    v_cndmask_b32 v27, v74, v75, s[76:77]
    v_mfma_f32_16x16x32_bf16 v[108:111], v[132:135], a[92:95], v[108:111]
    v_cndmask_b32 v28, v76, v77, s[76:77]
    v_cndmask_b32 v29, v78, v79, s[76:77]
    v_mfma_f32_16x16x32_bf16 v[108:111], v[136:139], a[116:119], v[108:111]
    v_cndmask_b32 v26, v26, v28, s[78:79]
    v_cndmask_b32 v27, v27, v29, s[80:81]
    v_mfma_f32_16x16x32_bf16 v[108:111], v[140:143], a[140:143], v[108:111]
    s_waitcnt lgkmcnt(0)
    v_mul_f32 v26, v26, v8
    v_mfma_f32_16x16x32_bf16 v[108:111], v[144:147], a[164:167], v[108:111]
    v_cvt_pk_bf16_f32 v40, v104, v105
    v_cvt_pk_bf16_f32 v41, v106, v107
    v_mfma_f32_16x16x32_bf16 v[108:111], v[148:151], a[188:191], v[108:111]
    v_mul_f32 v27, v27, v9
    v_mul_f32 v11, s91, v10
    v_mfma_f32_16x16x32_bf16 v[108:111], v[152:155], a[212:215], v[108:111]
    v_max_f32 v28, v26, v27
    v_mov_b32 v29, v28
    v_mfma_f32_16x16x32_bf16 v[108:111], v[156:159], a[236:239], v[108:111]
    v_mfma_f32_16x16x32_bf16 v[108:111], v[160:163], v[180:183], v[108:111]
    v_permlane16_swap_b32 v28, v29
    v_max_f32 v28, v28, v29
    v_mfma_f32_16x16x32_bf16 v[108:111], v[164:167], v[204:207], v[108:111]
    v_mov_b32 v29, v28
    v_mfma_f32_16x16x32_bf16 v[108:111], v[168:171], v[228:231], v[108:111]
    v_mfma_f32_16x16x32_bf16 v[108:111], v[172:175], v[252:255], v[108:111]
    v_permlane32_swap_b32 v28, v29
    v_max_f32 v28, v28, v29
    s_nop 5
    v_cvt_pk_bf16_f32 v50, v108, v109
    v_cvt_pk_bf16_f32 v51, v110, v111
    v_sub_f32 v26, v26, v28
    v_sub_f32 v27, v27, v28
    v_mul_f32 v26, v11, v26
    v_mul_f32 v27, v11, v27
    v_exp_f32 v26, v26
    v_exp_f32 v27, v27
    s_nop 0
    v_add_f32 v28, v26, v27
    v_mov_b32 v29, v28
    s_nop 1
    v_permlane16_swap_b32 v28, v29
    v_add_f32 v28, v28, v29
    v_mov_b32 v29, v28
    s_nop 1
    v_permlane32_swap_b32 v28, v29
    v_add_f32 v28, v28, v29
    v_rcp_f32 v28, v28
    v_mul_f32 v26, v26, v8
    v_mul_f32 v27, v27, v9
    v_mul_f32 v26, v26, v28
    v_mul_f32 v27, v27, v28
    v_cvt_pk_bf16_f32 v26, v26, v26
    v_cvt_pk_bf16_f32 v27, v27, v27
    v_and_b32 v80, v26, v14
    v_and_b32 v81, v27, v15
    v_and_b32 v82, v26, v16
    v_and_b32 v83, v27, v17
    s_nop 1
    v_mfma_f32_16x16x32_bf16 v[72:75], v[38:41], v[80:83], 0
    v_mfma_f32_16x16x32_bf16 v[76:79], v[48:51], v[80:83], 0
    s_add_u32 s53, s74, 114688
    s_nop 5
    v_cvt_pk_bf16_f32 v84, v72, v73
    v_cvt_pk_bf16_f32 v85, v74, v75
    v_cvt_pk_bf16_f32 v86, v76, v77
    v_cvt_pk_bf16_f32 v87, v78, v79
    v_cndmask_b32 v86, v86, 0, s[82:83]
    v_cndmask_b32 v87, v87, 0, s[82:83]
    buffer_store_dwordx4 v[84:87], v23, s[24:27], s53 offen sc1
    s_waitcnt vmcnt(0) lgkmcnt(0)
    s_barrier
    s_cmp_lg_u32 s44, 0
    s_cbranch_scc1 L_nopub21
    s_lshl_b32 s60, s48, 4
    s_add_u32 s60, s60, s49
    s_lshl_b32 s60, s60, 7
    s_add_u32 s60, s60, 12779520
    v_mov_b32 v30, s47
    s_mov_b64 exec, 1
    buffer_store_dword v30, off, s[24:27], s60 sc1
    s_mov_b64 exec, -1
L_nopub21:
    s_endpgm
L_codeend:
.section .rodata,"a"
.p2align 6
.amdhsa_kernel parallel_sum__sliding_local_dilated__mixer_token_mlp__prompt_kernel
  .amdhsa_next_free_vgpr 512
  .amdhsa_next_free_sgpr 102
  .amdhsa_accum_offset 256
  .amdhsa_group_segment_fixed_size 0
  .amdhsa_kernarg_size 88
  .amdhsa_user_sgpr_count 2
  .amdhsa_user_sgpr_kernarg_segment_ptr 1
  .amdhsa_system_sgpr_workgroup_id_x 1
  .amdhsa_float_denorm_mode_32 3
.end_amdhsa_kernel
```

```asm
; @launch grid=(256,1,1) block=(256,1,1) lds=163840
.amdgcn_target "amdgcn-amd-amdhsa--gfx950"
.text
.globl parallel_sum__sliding_local_dilated__mixer_token_mlp__prompt_kernel
.p2align 8
.type parallel_sum__sliding_local_dilated__mixer_token_mlp__prompt_kernel,@function
parallel_sum__sliding_local_dilated__mixer_token_mlp__prompt_kernel:
    s_cmp_ge_u32 s2, 256
    s_cbranch_scc1 L_end
    s_load_dwordx2 s[4:5], s[0:1], 0
    s_load_dwordx16 s[76:91], s[0:1], 0
    s_load_dwordx4 s[92:95], s[0:1], 64
    s_load_dwordx2 s[24:25], s[0:1], 80
    s_lshr_b32 s46, s2, 3
    s_getpc_b64 s[98:99]
L_pc:
    s_mul_i32 s53, s46, 1408
    v_lshrrev_b32 v26, 4, v0
    v_min_u32 v26, 10, v26
    v_lshl_add_u32 v26, v26, 7, s53
    v_lshrrev_b32 v25, 5, v0
    v_min_u32 v26, L_codeend-L_pc-4, v26
    v_mov_b32 v29, s99
    v_add_co_u32 v28, vcc, s98, v26
    s_nop 1
    v_addc_co_u32 v29, vcc, 0, v29, vcc
    global_load_dword v108, v[28:29], off
    v_and_b32 v26, 31, v0
    v_mul_u32_u24 v24, 896, v25
    v_lshl_add_u32 v24, v26, 4, v24
    s_mul_i32 s53, s2, 7168
    v_add_u32 v24, s53, v24
    v_cmp_gt_u32 vcc, 24, v26
    v_mov_b32 v27, 2130706432
    s_mov_b32 s6, 1835008
    s_mov_b32 s7, 0x20000
    v_cndmask_b32 v22, v27, v24, vcc
    v_lshrrev_b32 v27, 6, v0
    v_and_b32 v1, 63, v0
    s_waitcnt lgkmcnt(0)
    buffer_load_dwordx4 v[32:35], v24, s[4:7], 0 offen
    buffer_load_dwordx4 v[36:39], v22, s[4:7], 0 offen offset:512
    v_readfirstlane_b32 s44, v27
    s_and_b32 s45, s2, 7
    s_mov_b64 s[8:9], s[78:79]
    s_mov_b32 s10, 1204224
    s_mov_b32 s11, s7
    s_lshr_b32 s53, s45, 1
    s_add_u32 s54, s53, 1
    s_bfe_u32 s54, s54, 0x10001
    s_add_u32 s54, s54, 1
    s_mul_i32 s53, s53, 224
    s_andn2_b32 s53, s53, 127
    s_sub_u32 s55, s46, 3
    s_cmp_lt_u32 s46, 24
    s_cselect_b32 s55, 63, s55
    s_cmp_lt_u32 s46, 21
    s_cselect_b32 s55, s46, s55
    s_mul_i32 s55, s55, 43008
    s_add_u32 s53, s53, s55
    v_and_b32 v27, 3, v0
    v_min_u32 v27, s54, v27
    v_bfe_u32 v28, v0, 2, 2
    v_min_u32 v28, 2, v28
    v_mul_u32_u24 v28, 7, v28
    v_add_u32 v27, v27, v28
    v_lshrrev_b32 v28, 4, v0
    v_min_u32 v28, 15, v28
    v_mul_u32_u24 v28, 21, v28
    v_add_lshl_u32 v27, v27, v28, 7
    buffer_load_dword v108, v27, s[8:11], s53 offen
    s_mov_b64 s[40:41], s[94:95]
    s_mov_b32 s42, 256
    s_mov_b32 s43, s7
    s_or_b32 s53, s2, s44
    s_cbranch_scc1 L_nononce
    s_memrealtime s[98:99]
    s_waitcnt lgkmcnt(0)
    s_or_b32 s98, s98, 1
    v_mov_b32 v28, s98
    s_mov_b64 exec, 1
    buffer_store_dword v28, off, s[40:43], 0 sc1
    s_mov_b64 exec, -1
L_nononce:
    s_mov_b64 s[16:17], s[84:85]
    s_mov_b32 s18, 7340032
    s_mov_b32 s19, s7
    s_mov_b32 s26, 16777216
    s_mov_b32 s27, s7
    s_mov_b64 s[20:21], s[88:89]
    s_mov_b32 s22, 7340032
    s_mov_b32 s23, s7
    s_mov_b64 s[12:13], s[80:81]
    s_mov_b32 s14, 401408
    s_mov_b32 s15, s7
    s_mov_b64 s[28:29], s[92:93]
    s_mov_b32 s30, 1835008
    s_mov_b32 s31, s7
    s_mov_b64 s[32:33], s[86:87]
    s_mov_b32 s34, 3584
    s_mov_b32 s35, s7
    s_mov_b64 s[36:37], s[90:91]
    s_mov_b32 s38, 4096
    s_mov_b32 s39, s7
    s_lshl_b32 s52, s44, 12
    v_lshlrev_b32 v23, 4, v1
    s_cmp_ge_u32 s46, 24
    s_cbranch_scc1 L_role_a
    v_lshrrev_b32 v208, 4, v1
    v_bfe_u32 v209, v1, 2, 2
    v_and_b32 v210, 3, v1
    v_and_b32 v211, 15, v1
    v_lshrrev_b32 v212, 5, v1
    s_mul_i32 s55, s45, 3
    s_max_u32 s55, s55, 1
    s_add_u32 s55, s55, s46
    s_sub_u32 s55, s55, 1
    s_sub_u32 s56, s55, 21
    s_min_u32 s55, s55, s56
    s_and_b32 s54, s45, 1
    s_mul_i32 s54, s54, 24
    s_sub_u32 s54, s46, s54
    s_cmp_ge_u32 s46, 21
    s_cselect_b32 s54, s54, s55
    s_mul_i32 s53, s45, 21
    s_add_u32 s53, s53, s54
    s_mul_i32 s50, s53, 171
    s_lshr_b32 s50, s50, 10
    s_mul_i32 s54, s50, 6
    s_sub_u32 s88, s53, s54
    s_mul_i32 s51, s50, 2
    s_add_u32 s51, s51, s88
    s_mul_i32 s54, s51, 43
    s_lshr_b32 s54, s54, 8
    s_mul_i32 s54, s54, 6
    s_sub_u32 s51, s51, s54
    s_mul_i32 s65, s51, 13
    s_add_u32 s65, s65, 2
    s_mul_i32 s65, s65, 171
    s_lshr_b32 s65, s65, 10
    v_lshl_add_u32 v213, v212, 2, v209
    v_and_b32 v215, 1, v208
    v_lshlrev_b32 v214, 4, v210
    v_lshl_add_u32 v214, v215, 6, v214
    s_mul_i32 s53, s44, 1835008
    s_lshl_b32 s54, s50, 7
    s_add_u32 s53, s53, s54
    v_mul_u32_u24 v10, 3584, v213
    v_add3_u32 v10, v10, v214, s53
    v_xor_b32 v11, 32, v10
    s_cmp_ge_u32 s46, 21
    s_cbranch_scc1 L_help
    s_add_u32 m0, s52, 49152
    s_add_u32 s57, s65, 0
    s_sub_u32 s3, s57, 13
    s_min_u32 s57, s57, s3
    s_mul_i32 s57, s57, 114688
    buffer_load_dwordx4 v10, s[16:19], s57 offen offset:0 lds
    s_add_u32 s57, s57, 27648
    buffer_load_dwordx4 v11, s[16:19], s57 offen offset:1024 lds
    v_mul_u32_u24 v109, 1088, v25
    v_lshl_add_u32 v109, v26, 4, v109
    v_mul_u32_u24 v110, 1088, v209
    v_lshl_add_u32 v110, v208, 5, v110
    v_lshl_add_u32 v110, v210, 3, v110
    s_lshl_b32 s53, s44, 7
    v_add_u32 v110, s53, v110
    v_mul_u32_u24 v111, 66816, v208
    v_lshl_add_u32 v111, v211, 4, v111
    s_mul_i32 s63, s44, 267264
    s_lshl_b32 s53, s2, 8
    s_add_u32 s63, s63, s53
    s_add_u32 s64, s63, 1069056
    v_cmp_gt_u32 vcc, 208, v0
    v_mov_b32 v100, 2130706432
    v_cmp_le_u32 s[92:93], 24, v26
    v_cndmask_b32 v22, v100, v111, vcc
    s_mov_b32 s62, 0x3f803f80
    s_mov_b32 s61, 0xffff0000
    v_mov_b32 v96, 0
    v_mov_b32 v97, 0
    v_lshlrev_b32 v216, 6, v209
    v_lshl_add_u32 v216, v210, 3, v216
    v_lshl_add_u32 v216, v215, 5, v216
    s_add_u32 s53, s52, 49152
    v_lshl_add_u32 v2, v208, 10, v216
    v_add_u32 v2, s53, v2
    v_xor_b32 v3, 32, v2
    v_add_u32 v4, 65536, v2
    v_add_u32 v5, 65536, v3
    v_lshl_add_u32 v6, v208, 9, v216
    v_add_u32 v6, s53, v6
    v_xor_b32 v7, 32, v6
    v_add_u32 v8, 65536, v6
    v_add_u32 v9, 65536, v7
    s_waitcnt vmcnt(4)
    v_dot2c_f32_bf16 v96, s62, v32
    v_dot2c_f32_bf16 v97, v32, v32
    v_lshlrev_b32 v40, 16, v32
    v_and_b32 v41, s61, v32
    v_dot2c_f32_bf16 v96, s62, v33
    v_dot2c_f32_bf16 v97, v33, v33
    v_lshlrev_b32 v42, 16, v33
    v_and_b32 v43, s61, v33
    v_dot2c_f32_bf16 v96, s62, v34
    v_dot2c_f32_bf16 v97, v34, v34
    v_lshlrev_b32 v44, 16, v34
    v_and_b32 v45, s61, v34
    v_dot2c_f32_bf16 v96, s62, v35
    v_dot2c_f32_bf16 v97, v35, v35
    v_lshlrev_b32 v46, 16, v35
    v_and_b32 v47, s61, v35
    s_waitcnt vmcnt(3)
    v_dot2c_f32_bf16 v96, s62, v36
    v_dot2c_f32_bf16 v97, v36, v36
    v_lshlrev_b32 v48, 16, v36
    v_and_b32 v49, s61, v36
    v_dot2c_f32_bf16 v96, s62, v37
    v_dot2c_f32_bf16 v97, v37, v37
    v_lshlrev_b32 v50, 16, v37
    v_and_b32 v51, s61, v37
    v_dot2c_f32_bf16 v96, s62, v38
    v_dot2c_f32_bf16 v97, v38, v38
    v_lshlrev_b32 v52, 16, v38
    v_and_b32 v53, s61, v38
    v_dot2c_f32_bf16 v96, s62, v39
    v_dot2c_f32_bf16 v97, v39, v39
    v_lshlrev_b32 v54, 16, v39
    v_and_b32 v55, s61, v39
    buffer_load_dword v29, off, s[40:43], 0 sc1
    v_add_f32_dpp v96, v96, v96 quad_perm:[1,0,3,2] row_mask:0xf bank_mask:0xf
    v_add_f32_dpp v97, v97, v97 quad_perm:[1,0,3,2] row_mask:0xf bank_mask:0xf
    s_nop 0
    v_add_f32_dpp v96, v96, v96 quad_perm:[2,3,0,1] row_mask:0xf bank_mask:0xf
    v_add_f32_dpp v97, v97, v97 quad_perm:[2,3,0,1] row_mask:0xf bank_mask:0xf
    s_nop 0
    v_add_f32_dpp v96, v96, v96 row_half_mirror row_mask:0xf bank_mask:0xf
    v_add_f32_dpp v97, v97, v97 row_half_mirror row_mask:0xf bank_mask:0xf
    s_nop 0
    v_add_f32_dpp v96, v96, v96 row_mirror row_mask:0xf bank_mask:0xf
    v_add_f32_dpp v97, v97, v97 row_mirror row_mask:0xf bank_mask:0xf
    v_mov_b32 v98, v96
    v_mov_b32 v99, v97
    s_nop 0
    v_permlane16_swap_b32 v96, v98
    v_permlane16_swap_b32 v97, v99
    v_add_f32 v96, v96, v98
    v_add_f32 v97, v97, v99
    v_mul_f32 v98, 0x3b124925, v96
    v_mul_f32 v99, 0x3b124925, v97
    v_fma_f32 v99, -v98, v98, v99
    v_max_f32 v99, 0, v99
    v_cvt_pk_bf16_f32 v100, 0, v99
    v_add_f32 v100, 0x3727c5ac, v100
    v_cvt_pk_bf16_f32 v100, 0, v100
    v_sqrt_f32 v100, v100
    s_nop 0
    v_cvt_pk_bf16_f32 v100, 0, v100
    v_rcp_f32 v100, v100
    s_nop 0
    v_mul_f32 v99, v99, v100
    v_mul_f32 v99, v99, v100
    v_cvt_pk_bf16_f32 v104, 0, v99
    v_add_f32 v104, 0x3727c5ac, v104
    v_cvt_pk_bf16_f32 v104, 0, v104
    v_sqrt_f32 v104, v104
    s_nop 0
    v_cvt_pk_bf16_f32 v102, 0, v104
    v_rcp_f32 v104, v102
    s_nop 0
    v_mul_f32 v104, v104, v100
    v_mul_f32 v106, v98, v104
    v_pk_fma_f32 v[56:57], v[40:41], v[104:105], v[106:107] op_sel_hi:[1,0,0] neg_lo:[0,0,1] neg_hi:[0,0,1]
    v_pk_fma_f32 v[58:59], v[42:43], v[104:105], v[106:107] op_sel_hi:[1,0,0] neg_lo:[0,0,1] neg_hi:[0,0,1]
    v_pk_fma_f32 v[60:61], v[44:45], v[104:105], v[106:107] op_sel_hi:[1,0,0] neg_lo:[0,0,1] neg_hi:[0,0,1]
    v_pk_fma_f32 v[62:63], v[46:47], v[104:105], v[106:107] op_sel_hi:[1,0,0] neg_lo:[0,0,1] neg_hi:[0,0,1]
    v_pk_fma_f32 v[64:65], v[48:49], v[104:105], v[106:107] op_sel_hi:[1,0,0] neg_lo:[0,0,1] neg_hi:[0,0,1]
    v_pk_fma_f32 v[66:67], v[50:51], v[104:105], v[106:107] op_sel_hi:[1,0,0] neg_lo:[0,0,1] neg_hi:[0,0,1]
    v_pk_fma_f32 v[68:69], v[52:53], v[104:105], v[106:107] op_sel_hi:[1,0,0] neg_lo:[0,0,1] neg_hi:[0,0,1]
    v_pk_fma_f32 v[70:71], v[54:55], v[104:105], v[106:107] op_sel_hi:[1,0,0] neg_lo:[0,0,1] neg_hi:[0,0,1]
    v_cvt_pk_bf16_f32 v80, v56, v57
    v_cvt_pk_bf16_f32 v81, v58, v59
    v_cvt_pk_bf16_f32 v82, v60, v61
    v_cvt_pk_bf16_f32 v83, v62, v63
    v_cvt_pk_bf16_f32 v84, v64, v65
    v_cvt_pk_bf16_f32 v85, v66, v67
    v_cvt_pk_bf16_f32 v86, v68, v69
    v_cvt_pk_bf16_f32 v87, v70, v71
    v_lshrrev_b32 v102, 16, v102
    v_cndmask_b32 v84, v84, v102, s[92:93]
    ds_write_b128 v109, v[80:83] offset:0
    ds_write_b128 v109, v[84:87] offset:512
    s_waitcnt lgkmcnt(0)
    s_barrier
    ds_read_b64_tr_b16 v[88:89], v110 offset:0
    ds_read_b64_tr_b16 v[90:91], v110 offset:4352
    ds_read_b64_tr_b16 v[92:93], v110 offset:512
    ds_read_b64_tr_b16 v[94:95], v110 offset:4864
    s_waitcnt lgkmcnt(2)
    buffer_store_dwordx4 v[88:91], v111, s[24:27], s63 offen sc1
    s_waitcnt lgkmcnt(0)
    buffer_store_dwordx4 v[92:95], v22, s[24:27], s64 offen sc1
    s_add_u32 s57, s57, 27648
    buffer_load_dwordx4 v10, s[16:19], s57 offen offset:2048 lds
    s_add_u32 s57, s57, 27648
    buffer_load_dwordx4 v11, s[16:19], s57 offen offset:3072 lds
    s_add_u32 m0, s52, 65536
    s_add_u32 s57, s65, 1
    s_sub_u32 s3, s57, 13
    s_min_u32 s57, s57, s3
    s_mul_i32 s57, s57, 114688
    buffer_load_dwordx4 v10, s[16:19], s57 offen offset:0 lds
    s_add_u32 s57, s57, 27648
    buffer_load_dwordx4 v11, s[16:19], s57 offen offset:1024 lds
    s_add_u32 s57, s57, 27648
    buffer_load_dwordx4 v10, s[16:19], s57 offen offset:2048 lds
    s_add_u32 s57, s57, 27648
    buffer_load_dwordx4 v11, s[16:19], s57 offen offset:3072 lds
    s_waitcnt vmcnt(6)
    v_cmp_eq_u32 vcc, 0, v29
    s_nop 0
    s_cbranch_vccz L_ok2
    s_mov_b32 s59, 20000
L_spin1:
    buffer_load_dword v29, off, s[40:43], 0 sc1
    s_waitcnt vmcnt(0)
    v_cmp_eq_u32 vcc, 0, v29
    s_nop 0
    s_cbranch_vccz L_ok2
    s_sub_u32 s59, s59, 1
    s_cbranch_scc0 L_spin1
L_ok2:
    v_readfirstlane_b32 s47, v29
    s_barrier
    s_cmp_lg_u32 s44, 0
    s_cbranch_scc1 L_nopub3
    s_lshl_b32 s60, s2, 5
    s_add_u32 s60, s60, 12582912
    v_mov_b32 v30, s47
    s_mov_b64 exec, 1
    buffer_store_dword v30, off, s[24:27], s60 sc1
    s_mov_b64 exec, -1
L_nopub3:
    s_lshl_b32 s53, s44, 11
    s_add_u32 s53, s53, 12582912
    v_lshl_add_u32 v18, v1, 5, s53
    s_lshl_b32 s53, s50, 7
    s_add_u32 m0, s52, 81920
    s_add_u32 s57, s65, 2
    s_sub_u32 s3, s57, 13
    s_min_u32 s57, s57, s3
    s_mul_i32 s57, s57, 114688
    buffer_load_dwordx4 v10, s[16:19], s57 offen offset:0 lds
    v_lshl_add_u32 v19, v208, 3, s53
    s_lshl2_add_u32 s67, s51, s44
    s_mul_i32 s67, s67, 58624
    s_lshl_b32 s53, s50, 11
    s_add_u32 s57, s57, 27648
    buffer_load_dwordx4 v11, s[16:19], s57 offen offset:1024 lds
    s_add_u32 s67, s67, s53
    s_add_u32 s67, s67, 2097152
    v_mov_b32 v236, 0xbdd2d3e8
    v_mov_b32 v237, 0xc0135761
    s_add_u32 s57, s57, 27648
    buffer_load_dwordx4 v10, s[16:19], s57 offen offset:2048 lds
    s_or_b32 s88, s88, 0
    s_add_u32 s54, s88, 24
    s_mul_i32 s84, s54, 66816
    s_lshl2_add_u32 s84, s52, s84
    s_mul_i32 s83, s54, 58624
    s_add_u32 s83, s83, s53
    s_and_b32 s54, s44, 1
    s_lshl_b32 s54, s54, 10
    s_add_u32 s57, s57, 27648
    buffer_load_dwordx4 v11, s[16:19], s57 offen offset:3072 lds
    s_add_u32 s83, s83, s54
    s_add_u32 s83, s83, 2097152
    s_lshl1_add_u32 s54, s54, 49152
    v_add_u32 v243, s54, v23
    s_add_u32 m0, s52, 98304
    s_add_u32 s57, s65, 3
    s_sub_u32 s3, s57, 13
    s_min_u32 s57, s57, s3
    s_mul_i32 s57, s57, 114688
    buffer_load_dwordx4 v10, s[16:19], s57 offen offset:0 lds
    s_cmp_lt_u32 s88, 4
    s_cselect_b32 s84, s84, 2130706432
    s_cselect_b32 s83, s83, 2130706432
    s_cmp_lt_u32 s44, 2
    s_cselect_b32 s83, s83, 2130706432
    s_cmp_eq_u32 s44, 0
    s_cselect_b32 s85, 1.0, 0
    s_mul_i32 s53, s45, 7
    s_lshr_b32 s53, s53, 1
    s_sub_u32 s53, s50, s53
    s_lshl1_add_u32 s53, s53, s88
    s_sub_u32 s53, s53, 4
    s_mul_i32 s54, s44, 28
    s_add_u32 s54, s54, s53
    s_lshl_b32 s87, s54, 16
    s_lshl_b32 s54, s45, 9
    s_add_u32 s87, s87, s54
    s_cmp_ge_u32 s88, 4
    s_cselect_b32 s87, s87, 2130706432
    v_lshrrev_b32 v254, 2, v1
    v_lshlrev_b32 v254, 12, v254
    v_lshl_add_u32 v254, v210, 7, v254
    s_add_u32 s57, s57, 27648
    buffer_load_dwordx4 v11, s[16:19], s57 offen offset:1024 lds
    s_waitcnt vmcnt(10)
    ds_read_b64_tr_b16 a[0:1], v2 offset:0
    ds_read_b64_tr_b16 a[2:3], v2 offset:512
    ds_read_b64_tr_b16 a[4:5], v3 offset:0
    ds_read_b64_tr_b16 a[6:7], v3 offset:512
    s_add_u32 s57, s57, 27648
    buffer_load_dwordx4 v10, s[16:19], s57 offen offset:2048 lds
    ds_read_b64_tr_b16 a[8:9], v2 offset:256
    ds_read_b64_tr_b16 a[10:11], v2 offset:768
    ds_read_b64_tr_b16 a[12:13], v3 offset:256
    ds_read_b64_tr_b16 a[14:15], v3 offset:768
    s_add_u32 s57, s57, 27648
    buffer_load_dwordx4 v11, s[16:19], s57 offen offset:3072 lds
    s_lshr_b32 s53, s46, 2
    s_and_b32 s89, s46, 3
    s_bfe_u32 s54, s46, 0x20001
    s_and_b32 s55, s46, 1
    s_add_u32 s55, s55, 4
    s_cmp_lt_u32 s46, 16
    s_cselect_b32 s53, s53, s54
    s_cselect_b32 s89, s89, s55
    s_mul_i32 s49, s53, 2
    s_add_u32 s49, s49, s89
    s_sub_u32 s54, s49, 6
    s_min_u32 s49, s49, s54
    s_or_b32 s89, s89, 0
    s_add_u32 m0, s52, 114688
    s_add_u32 s57, s65, 4
    s_sub_u32 s3, s57, 13
    s_min_u32 s57, s57, s3
    s_mul_i32 s57, s57, 114688
    buffer_load_dwordx4 v10, s[16:19], s57 offen offset:0 lds
    s_lshl2_add_u32 s48, s45, s53
    s_mul_i32 s53, s44, 1835008
    s_lshl_b32 s74, s48, 7
    s_add_u32 s53, s53, s74
    s_add_u32 s57, s57, 27648
    buffer_load_dwordx4 v11, s[16:19], s57 offen offset:1024 lds
    s_waitcnt vmcnt(10)
    ds_read_b64_tr_b16 a[16:17], v2 offset:16384
    ds_read_b64_tr_b16 a[18:19], v2 offset:16896
    ds_read_b64_tr_b16 a[20:21], v3 offset:16384
    ds_read_b64_tr_b16 a[22:23], v3 offset:16896
    s_add_u32 s57, s57, 27648
    buffer_load_dwordx4 v10, s[16:19], s57 offen offset:2048 lds
    ds_read_b64_tr_b16 a[24:25], v2 offset:16640
    ds_read_b64_tr_b16 a[26:27], v2 offset:17152
    ds_read_b64_tr_b16 a[28:29], v3 offset:16640
    ds_read_b64_tr_b16 a[30:31], v3 offset:17152
    s_lshl_b32 s56, s44, 5
    v_lshlrev_b32 v217, 5, v212
    v_xor_b32 v217, v217, v214
    v_xor_b32 v217, s56, v217
    s_add_u32 s57, s57, 27648
    buffer_load_dwordx4 v11, s[16:19], s57 offen offset:3072 lds
    s_add_u32 s74, s74, s56
    v_lshlrev_b32 v12, 12, v213
    v_add3_u32 v12, v12, v217, s53
    s_mul_i32 s53, s44, 28672
    s_add_u32 m0, s52, 131072
    s_add_u32 s57, s65, 5
    s_sub_u32 s3, s57, 13
    s_min_u32 s57, s57, s3
    s_mul_i32 s57, s57, 114688
    buffer_load_dwordx4 v10, s[16:19], s57 offen offset:0 lds
    s_lshl_b32 s54, s49, 7
    s_add_u32 s55, s53, s54
    v_mul_u32_u24 v13, 896, v213
    v_add3_u32 v13, v13, v214, s55
    s_add_u32 s57, s57, 27648
    buffer_load_dwordx4 v11, s[16:19], s57 offen offset:1024 lds
    s_waitcnt vmcnt(10)
    ds_read_b64_tr_b16 a[32:33], v2 offset:32768
    ds_read_b64_tr_b16 a[34:35], v2 offset:33280
    ds_read_b64_tr_b16 a[36:37], v3 offset:32768
    ds_read_b64_tr_b16 a[38:39], v3 offset:33280
    v_xor_b32 v14, 32, v13
    s_mul_i32 s55, s44, 21504
    v_subrev_u32 v239, s55, v13
    s_and_b32 s55, s56, 32
    ds_read_b64_tr_b16 a[40:41], v2 offset:33024
    ds_read_b64_tr_b16 a[42:43], v2 offset:33536
    ds_read_b64_tr_b16 a[44:45], v3 offset:33024
    ds_read_b64_tr_b16 a[46:47], v3 offset:33536
    s_add_u32 s57, s57, 27648
    buffer_load_dwordx4 v10, s[16:19], s57 offen offset:2048 lds
    v_xor_b32 v239, s55, v239
    s_mul_i32 s73, s48, 57344
    s_add_u32 s71, s73, s54
    s_mul_i32 s55, s44, 14336
    s_add_u32 s57, s57, 27648
    buffer_load_dwordx4 v11, s[16:19], s57 offen offset:3072 lds
    s_add_u32 s71, s71, s55
    s_add_u32 s72, s71, 7168
    v_bfe_u32 v217, v1, 1, 2
    v_lshl_add_u32 v217, v212, 2, v217
    s_add_u32 m0, s52, 147456
    s_add_u32 s57, s65, 6
    s_sub_u32 s3, s57, 13
    s_min_u32 s57, s57, s3
    s_mul_i32 s57, s57, 114688
    buffer_load_dwordx4 v10, s[16:19], s57 offen offset:0 lds
    v_and_b32 v218, 24, v1
    v_add_u32 v217, v217, v218
    v_mul_u32_u24 v15, 896, v217
    v_and_b32 v217, 1, v1
    v_lshl_add_u32 v15, v217, 4, v15
    v_add_u32 v15, s53, v15
    s_lshl_b32 s54, s89, 5
    s_add_u32 s54, s54, 768
    s_add_u32 s57, s57, 27648
    buffer_load_dwordx4 v11, s[16:19], s57 offen offset:1024 lds
    s_waitcnt vmcnt(10)
    ds_read_b64_tr_b16 a[48:49], v2 offset:49152
    ds_read_b64_tr_b16 a[50:51], v2 offset:49664
    ds_read_b64_tr_b16 a[52:53], v3 offset:49152
    ds_read_b64_tr_b16 a[54:55], v3 offset:49664
    s_add_u32 s57, s57, 27648
    buffer_load_dwordx4 v10, s[16:19], s57 offen offset:2048 lds
    ds_read_b64_tr_b16 a[56:57], v2 offset:49408
    ds_read_b64_tr_b16 a[58:59], v2 offset:49920
    ds_read_b64_tr_b16 a[60:61], v3 offset:49408
    ds_read_b64_tr_b16 a[62:63], v3 offset:49920
    s_add_u32 s57, s57, 27648
    buffer_load_dwordx4 v11, s[16:19], s57 offen offset:3072 lds
    s_add_u32 s68, s89, 24
    s_mul_i32 s68, s68, 58624
    s_mul_i32 s69, s44, 14336
    s_add_u32 s69, s69, 2097152
    s_add_u32 s68, s68, s69
    s_mul_i32 s55, s49, 234496
    s_add_u32 s69, s69, s55
    s_add_u32 s73, s73, s54
    s_waitcnt lgkmcnt(15)
    s_add_u32 m0, s52, 49152
    s_add_u32 s57, s65, 7
    s_sub_u32 s3, s57, 13
    s_min_u32 s57, s57, s3
    s_mul_i32 s57, s57, 114688
    buffer_load_dwordx4 v10, s[16:19], s57 offen offset:0 lds
    s_mov_b32 s76, 0
    s_add_u32 s77, s76, 2048
    s_cmp_eq_u32 s77, 14336
    s_cselect_b32 s77, 0, s77
    s_add_u32 s78, s77, 2048
    s_cmp_eq_u32 s78, 14336
    s_cselect_b32 s78, 0, s78
    s_add_u32 s79, s78, 2048
    s_cmp_eq_u32 s79, 14336
    s_cselect_b32 s79, 0, s79
    s_add_u32 s80, s79, 2048
    s_cmp_eq_u32 s80, 14336
    s_cselect_b32 s80, 0, s80
    s_add_u32 s81, s80, 2048
    s_cmp_eq_u32 s81, 14336
    s_cselect_b32 s81, 0, s81
    s_add_u32 s82, s81, 2048
    s_cmp_eq_u32 s82, 14336
    s_cselect_b32 s82, 0, s82
    s_add_u32 s57, s57, 27648
    buffer_load_dwordx4 v11, s[16:19], s57 offen offset:1024 lds
    s_waitcnt vmcnt(10)
    ds_read_b64_tr_b16 a[64:65], v4 offset:0
    ds_read_b64_tr_b16 a[66:67], v4 offset:512
    ds_read_b64_tr_b16 a[68:69], v5 offset:0
    ds_read_b64_tr_b16 a[70:71], v5 offset:512
    s_add_u32 s57, s57, 27648
    buffer_load_dwordx4 v10, s[16:19], s57 offen offset:2048 lds
    ds_read_b64_tr_b16 a[72:73], v4 offset:256
    ds_read_b64_tr_b16 a[74:75], v4 offset:768
    ds_read_b64_tr_b16 a[76:77], v5 offset:256
    ds_read_b64_tr_b16 a[78:79], v5 offset:768
    s_add_u32 s57, s57, 27648
    buffer_load_dwordx4 v11, s[16:19], s57 offen offset:3072 lds
    s_cmp_lt_u32 s89, 4
    s_cselect_b32 s75, s54, 2130706432
    s_cselect_b32 s68, s68, 2130706432
    s_cselect_b32 s73, s73, 2130706432
    v_lshlrev_b32 v16, 3, v1
    v_add_u32 v16, 81920, v16
    v_and_b32 v217, 7, v1
    v_min_u32 v218, 6, v217
    s_add_u32 m0, s52, 65536
    s_add_u32 s57, s65, 8
    s_sub_u32 s3, s57, 13
    s_min_u32 s57, s57, s3
    s_mul_i32 s57, s57, 114688
    buffer_load_dwordx4 v10, s[16:19], s57 offen offset:0 lds
    s_mul_i32 s54, s44, 7
    v_add_u32 v218, s54, v218
    v_mul_u32_u24 v219, 2, v218
    v_add_u32 v219, s89, v219
    s_add_u32 s57, s57, 27648
    buffer_load_dwordx4 v11, s[16:19], s57 offen offset:1024 lds
    s_waitcnt vmcnt(10)
    ds_read_b64_tr_b16 a[80:81], v4 offset:16384
    ds_read_b64_tr_b16 a[82:83], v4 offset:16896
    ds_read_b64_tr_b16 a[84:85], v5 offset:16384
    ds_read_b64_tr_b16 a[86:87], v5 offset:16896
    s_add_u32 s57, s57, 27648
    buffer_load_dwordx4 v10, s[16:19], s57 offen offset:2048 lds
    ds_read_b64_tr_b16 a[88:89], v4 offset:16640
    ds_read_b64_tr_b16 a[90:91], v4 offset:17152
    ds_read_b64_tr_b16 a[92:93], v5 offset:16640
    ds_read_b64_tr_b16 a[94:95], v5 offset:17152
    v_mul_u32_u24 v220, 43, v219
    v_lshrrev_b32 v220, 8, v220
    v_mul_u32_u24 v220, 6, v220
    v_sub_u32 v219, v219, v220
    s_add_u32 s57, s57, 27648
    buffer_load_dwordx4 v11, s[16:19], s57 offen offset:3072 lds
    v_subrev_u32 v219, s49, v219
    v_bfe_u32 v220, v1, 3, 1
    v_mul_i32_i24 v219, v219, v220
    v_add_u32 v219, s49, v219
    s_waitcnt lgkmcnt(15)
    s_add_u32 m0, s52, 81920
    s_add_u32 s57, s65, 9
    s_sub_u32 s3, s57, 13
    s_min_u32 s57, s57, s3
    s_mul_i32 s57, s57, 114688
    buffer_load_dwordx4 v10, s[16:19], s57 offen offset:0 lds
    v_lshl_add_u32 v218, v219, 5, v218
    v_lshlrev_b32 v20, 7, v218
    v_add_u32 v20, 12713984, v20
    s_lshr_b32 s53, s48, 1
    s_add_u32 s57, s57, 27648
    buffer_load_dwordx4 v11, s[16:19], s57 offen offset:1024 lds
    s_waitcnt vmcnt(10)
    ds_read_b64_tr_b16 a[96:97], v4 offset:32768
    ds_read_b64_tr_b16 a[98:99], v4 offset:33280
    ds_read_b64_tr_b16 a[100:101], v5 offset:32768
    ds_read_b64_tr_b16 a[102:103], v5 offset:33280
    s_lshl_b32 s53, s53, 7
    s_add_u32 s53, s53, 12779520
    v_lshl_add_u32 v21, v210, 11, s53
    s_lshl_b32 s70, s48, 16
    ds_read_b64_tr_b16 a[104:105], v4 offset:33024
    ds_read_b64_tr_b16 a[106:107], v4 offset:33536
    ds_read_b64_tr_b16 a[108:109], v5 offset:33024
    ds_read_b64_tr_b16 a[110:111], v5 offset:33536
    s_add_u32 s57, s57, 27648
    buffer_load_dwordx4 v10, s[16:19], s57 offen offset:2048 lds
    s_lshl2_add_u32 s70, s52, s70
    s_add_u32 s70, s70, 4194304
    v_lshrrev_b32 v218, 3, v1
    v_mul_u32_u24 v22, 896, v218
    s_add_u32 s57, s57, 27648
    buffer_load_dwordx4 v11, s[16:19], s57 offen offset:3072 lds
    v_lshl_add_u32 v22, v217, 4, v22
    v_lshlrev_b32 v25, 1, v211
    s_add_u32 s53, s52, 65536
    v_mul_u32_u24 v244, 176, v218
    buffer_load_dwordx2 v[224:225], v19, s[32:35], 0 offen offset:0
    v_lshl_add_u32 v244, v217, 4, v244
    v_add_u32 v244, s53, v244
    v_mul_u32_u24 v238, 176, v211
    v_lshl_add_u32 v238, v208, 3, v238
    buffer_load_dwordx2 v[226:227], v19, s[32:35], 0 offen offset:32
    s_waitcnt vmcnt(10)
    ds_read_b64_tr_b16 a[112:113], v2 offset:0
    ds_read_b64_tr_b16 a[114:115], v2 offset:512
    ds_read_b64_tr_b16 a[116:117], v3 offset:0
    ds_read_b64_tr_b16 a[118:119], v3 offset:512
    buffer_load_dwordx2 v[228:229], v19, s[32:35], 0 offen offset:64
    ds_read_b64_tr_b16 a[120:121], v2 offset:256
    ds_read_b64_tr_b16 a[122:123], v2 offset:768
    ds_read_b64_tr_b16 a[124:125], v3 offset:256
    ds_read_b64_tr_b16 a[126:127], v3 offset:768
    buffer_load_dwordx2 v[230:231], v19, s[32:35], 0 offen offset:96
    v_add_u32 v238, s53, v238
    v_lshrrev_b32 v218, 2, v0
    v_mul_u32_u24 v26, 896, v218
    v_lshl_add_u32 v26, v210, 3, v26
    s_add_u32 m0, s52, 98304
    s_add_u32 s57, s65, 10
    s_sub_u32 s3, s57, 13
    s_min_u32 s57, s57, s3
    s_mul_i32 s57, s57, 114688
    buffer_load_dwordx4 v10, s[16:19], s57 offen offset:0 lds
    v_lshrrev_b32 v218, 2, v1
    v_mul_u32_u24 v252, 176, v218
    v_lshl_add_u32 v252, v210, 3, v252
    v_add_u32 v252, s53, v252
    s_sub_u32 s53, 49152, s52
    v_add_u32 v246, s53, v2
    v_add_u32 v247, s53, v3
    v_mul_u32_u24 v218, 3072, v208
    s_add_u32 s57, s57, 27648
    buffer_load_dwordx4 v11, s[16:19], s57 offen offset:1024 lds
    s_waitcnt vmcnt(10)
    ds_read_b64_tr_b16 a[128:129], v2 offset:16384
    ds_read_b64_tr_b16 a[130:131], v2 offset:16896
    ds_read_b64_tr_b16 a[132:133], v3 offset:16384
    ds_read_b64_tr_b16 a[134:135], v3 offset:16896
    s_add_u32 s57, s57, 27648
    buffer_load_dwordx4 v10, s[16:19], s57 offen offset:2048 lds
    ds_read_b64_tr_b16 a[136:137], v2 offset:16640
    ds_read_b64_tr_b16 a[138:139], v2 offset:17152
    ds_read_b64_tr_b16 a[140:141], v3 offset:16640
    ds_read_b64_tr_b16 a[142:143], v3 offset:17152
    s_add_u32 s57, s57, 27648
    buffer_load_dwordx4 v11, s[16:19], s57 offen offset:3072 lds
    v_add_u32 v248, v218, v246
    v_add_u32 v249, v218, v247
    v_add_u32 v232, s52, v23
    v_xor_b32 v233, 4096, v232
    v_xor_b32 v234, 8192, v232
    v_xor_b32 v235, 12288, v232
    s_waitcnt lgkmcnt(15)
    s_add_u32 m0, s52, 114688
    s_add_u32 s57, s65, 11
    s_sub_u32 s3, s57, 13
    s_min_u32 s57, s57, s3
    s_mul_i32 s57, s57, 114688
    buffer_load_dwordx4 v10, s[16:19], s57 offen offset:0 lds
    s_add_u32 s57, s57, 27648
    buffer_load_dwordx4 v11, s[16:19], s57 offen offset:1024 lds
    s_waitcnt vmcnt(10)
    ds_read_b64_tr_b16 a[144:145], v2 offset:32768
    ds_read_b64_tr_b16 a[146:147], v2 offset:33280
    ds_read_b64_tr_b16 a[148:149], v3 offset:32768
    ds_read_b64_tr_b16 a[150:151], v3 offset:33280
    s_add_u32 s57, s57, 27648
    buffer_load_dwordx4 v10, s[16:19], s57 offen offset:2048 lds
    ds_read_b64_tr_b16 a[152:153], v2 offset:33024
    ds_read_b64_tr_b16 a[154:155], v2 offset:33536
    ds_read_b64_tr_b16 a[156:157], v3 offset:33024
    ds_read_b64_tr_b16 a[158:159], v3 offset:33536
    s_add_u32 s57, s57, 27648
    buffer_load_dwordx4 v11, s[16:19], s57 offen offset:3072 lds
    s_add_u32 m0, s52, 131072
    s_add_u32 s57, s65, 12
    s_sub_u32 s3, s57, 13
    s_min_u32 s57, s57, s3
    s_mul_i32 s57, s57, 114688
    buffer_load_dwordx4 v10, s[16:19], s57 offen offset:0 lds
    s_add_u32 s57, s57, 27648
    buffer_load_dwordx4 v11, s[16:19], s57 offen offset:1024 lds
    s_add_u32 s57, s57, 27648
    buffer_load_dwordx4 v10, s[16:19], s57 offen offset:2048 lds
    s_waitcnt vmcnt(11)
    v_lshlrev_b32 v32, 16, v224
    v_and_b32 v33, s61, v224
    v_lshlrev_b32 v34, 16, v225
    v_and_b32 v35, s61, v225
    v_lshlrev_b32 v36, 16, v226
    v_and_b32 v37, s61, v226
    v_lshlrev_b32 v38, 16, v227
    v_and_b32 v39, s61, v227
    s_add_u32 s57, s57, 27648
    buffer_load_dwordx4 v11, s[16:19], s57 offen offset:3072 lds
    v_lshlrev_b32 v40, 16, v228
    v_and_b32 v41, s61, v228
    v_lshlrev_b32 v42, 16, v229
    v_and_b32 v43, s61, v229
    buffer_load_dword v17, v18, s[24:27], 0 offen sc1
    v_lshlrev_b32 v44, 16, v230
    v_and_b32 v45, s61, v230
    v_lshlrev_b32 v46, 16, v231
    v_and_b32 v47, s61, v231
    v_mul_f32 v96, s85, v32
    v_mul_f32 v97, s85, v33
    v_mul_f32 v98, s85, v34
    v_mul_f32 v99, s85, v35
    s_add_u32 m0, s52, 147456
    s_mov_b32 s57, 1490944
    buffer_load_dwordx4 v10, s[16:19], s57 offen offset:0 lds
    s_waitcnt vmcnt(10)
    ds_read_b64_tr_b16 a[160:161], v2 offset:49152
    ds_read_b64_tr_b16 a[162:163], v2 offset:49664
    ds_read_b64_tr_b16 a[164:165], v3 offset:49152
    ds_read_b64_tr_b16 a[166:167], v3 offset:49664
    v_mul_f32 v100, s85, v36
    v_mul_f32 v101, s85, v37
    v_mul_f32 v102, s85, v38
    v_mul_f32 v103, s85, v39
    ds_read_b64_tr_b16 a[168:169], v2 offset:49408
    ds_read_b64_tr_b16 a[170:171], v2 offset:49920
    ds_read_b64_tr_b16 a[172:173], v3 offset:49408
    ds_read_b64_tr_b16 a[174:175], v3 offset:49920
    s_add_u32 s57, s57, 27648
    buffer_load_dwordx4 v11, s[16:19], s57 offen offset:1024 lds
    v_mul_f32 v104, s85, v40
    v_mul_f32 v105, s85, v41
    v_mul_f32 v106, s85, v42
    v_mul_f32 v107, s85, v43
    s_add_u32 s57, s57, 27648
    buffer_load_dwordx4 v10, s[16:19], s57 offen offset:2048 lds
    v_mul_f32 v108, s85, v44
    v_mul_f32 v109, s85, v45
    v_mul_f32 v110, s85, v46
    v_mul_f32 v111, s85, v47
    s_add_u32 s57, s57, 27648
    buffer_load_dwordx4 v11, s[16:19], s57 offen offset:3072 lds
    s_waitcnt lgkmcnt(15)
    s_add_u32 m0, s52, 49152
    s_mov_b32 s57, 1605632
    buffer_load_dwordx4 v10, s[16:19], s57 offen offset:0 lds
    s_waitcnt vmcnt(10)
    ds_read_b64_tr_b16 a[176:177], v4 offset:0
    ds_read_b64_tr_b16 a[178:179], v4 offset:512
    ds_read_b64_tr_b16 a[180:181], v5 offset:0
    ds_read_b64_tr_b16 a[182:183], v5 offset:512
    s_add_u32 s57, s57, 27648
    buffer_load_dwordx4 v11, s[16:19], s57 offen offset:1024 lds
    ds_read_b64_tr_b16 a[184:185], v4 offset:256
    ds_read_b64_tr_b16 a[186:187], v4 offset:768
    ds_read_b64_tr_b16 a[188:189], v5 offset:256
    ds_read_b64_tr_b16 a[190:191], v5 offset:768
    s_add_u32 s57, s57, 27648
    buffer_load_dwordx4 v10, s[16:19], s57 offen offset:2048 lds
    s_add_u32 s57, s57, 27648
    buffer_load_dwordx4 v11, s[16:19], s57 offen offset:3072 lds
    s_add_u32 m0, s52, 65536
    s_mov_b32 s57, 1720320
    buffer_load_dwordx4 v10, s[16:19], s57 offen offset:0 lds
    s_waitcnt vmcnt(10)
    ds_read_b64_tr_b16 a[192:193], v4 offset:16384
    ds_read_b64_tr_b16 a[194:195], v4 offset:16896
    ds_read_b64_tr_b16 a[196:197], v5 offset:16384
    ds_read_b64_tr_b16 a[198:199], v5 offset:16896
    s_add_u32 s57, s57, 27648
    buffer_load_dwordx4 v11, s[16:19], s57 offen offset:1024 lds
    ds_read_b64_tr_b16 a[200:201], v4 offset:16640
    ds_read_b64_tr_b16 a[202:203], v4 offset:17152
    ds_read_b64_tr_b16 a[204:205], v5 offset:16640
    ds_read_b64_tr_b16 a[206:207], v5 offset:17152
    s_add_u32 s57, s57, 27648
    buffer_load_dwordx4 v10, s[16:19], s57 offen offset:2048 lds
    s_waitcnt vmcnt(11)
    v_cmp_ne_u32 vcc, s47, v17
    s_nop 0
    s_cbranch_vccz L_ok5
    s_mov_b32 s59, 20000
L_spin4:
    buffer_load_dword v17, v18, s[24:27], 0 offen sc1
    s_waitcnt vmcnt(0)
    v_cmp_ne_u32 vcc, s47, v17
    s_nop 0
    s_cbranch_vccz L_ok5
    s_sub_u32 s59, s59, 1
    s_cbranch_scc0 L_spin4
L_ok5:
    s_cmp_ge_u32 s88, 4
    s_cbranch_scc1 L_p2_alt
    s_add_u32 s57, s57, 27648
    buffer_load_dwordx4 v11, s[16:19], s57 offen offset:3072 lds
    s_mov_b32 s66, s84
    s_lshl_b32 s86, s65, 10
    s_add_u32 s58, s86, s66
    s_add_u32 s86, s66, 13312
    buffer_load_dwordx4 v[112:115], v23, s[24:27], s58 offen offset:0 sc1
    s_add_u32 s58, s58, 1024
    s_cmp_eq_u32 s58, s86
    s_cselect_b32 s58, s66, s58
    buffer_load_dwordx4 v[116:119], v23, s[24:27], s58 offen offset:0 sc1
    s_waitcnt vmcnt(10)
    ds_read_b64_tr_b16 a[208:209], v4 offset:32768
    ds_read_b64_tr_b16 a[210:211], v4 offset:33280
    ds_read_b64_tr_b16 a[212:213], v5 offset:32768
    ds_read_b64_tr_b16 a[214:215], v5 offset:33280
    s_add_u32 s58, s58, 1024
    s_cmp_eq_u32 s58, s86
    s_cselect_b32 s58, s66, s58
    buffer_load_dwordx4 v[120:123], v23, s[24:27], s58 offen offset:0 sc1
    ds_read_b64_tr_b16 a[216:217], v4 offset:33024
    ds_read_b64_tr_b16 a[218:219], v4 offset:33536
    ds_read_b64_tr_b16 a[220:221], v5 offset:33024
    ds_read_b64_tr_b16 a[222:223], v5 offset:33536
    s_add_u32 s58, s58, 1024
    s_cmp_eq_u32 s58, s86
    s_cselect_b32 s58, s66, s58
    buffer_load_dwordx4 v[124:127], v23, s[24:27], s58 offen offset:0 sc1
    s_add_u32 s58, s58, 1024
    s_cmp_eq_u32 s58, s86
    s_cselect_b32 s58, s66, s58
    buffer_load_dwordx4 v[128:131], v23, s[24:27], s58 offen offset:0 sc1
    s_add_u32 s58, s58, 1024
    s_cmp_eq_u32 s58, s86
    s_cselect_b32 s58, s66, s58
    buffer_load_dwordx4 v[132:135], v23, s[24:27], s58 offen offset:0 sc1
    s_waitcnt vmcnt(10)
    ds_read_b64_tr_b16 a[224:225], v2 offset:0
    ds_read_b64_tr_b16 a[226:227], v2 offset:512
    ds_read_b64_tr_b16 a[228:229], v3 offset:0
    ds_read_b64_tr_b16 a[230:231], v3 offset:512
    s_add_u32 s58, s58, 1024
    s_cmp_eq_u32 s58, s86
    s_cselect_b32 s58, s66, s58
    buffer_load_dwordx4 v[136:139], v23, s[24:27], s58 offen offset:0 sc1
    ds_read_b64_tr_b16 a[232:233], v2 offset:256
    ds_read_b64_tr_b16 a[234:235], v2 offset:768
    ds_read_b64_tr_b16 a[236:237], v3 offset:256
    ds_read_b64_tr_b16 a[238:239], v3 offset:768
    s_add_u32 s58, s58, 1024
    s_cmp_eq_u32 s58, s86
    s_cselect_b32 s58, s66, s58
    buffer_load_dwordx4 v[140:143], v23, s[24:27], s58 offen offset:0 sc1
    s_add_u32 s58, s58, 1024
    s_cmp_eq_u32 s58, s86
    s_cselect_b32 s58, s66, s58
    buffer_load_dwordx4 v[144:147], v23, s[24:27], s58 offen offset:0 sc1
    s_add_u32 s58, s58, 1024
    s_cmp_eq_u32 s58, s86
    s_cselect_b32 s58, s66, s58
    buffer_load_dwordx4 v[148:151], v23, s[24:27], s58 offen offset:0 sc1
    s_waitcnt vmcnt(10)
    ds_read_b64_tr_b16 a[240:241], v2 offset:16384
    ds_read_b64_tr_b16 a[242:243], v2 offset:16896
    ds_read_b64_tr_b16 a[244:245], v3 offset:16384
    ds_read_b64_tr_b16 a[246:247], v3 offset:16896
    s_add_u32 s58, s58, 1024
    s_cmp_eq_u32 s58, s86
    s_cselect_b32 s58, s66, s58
    buffer_load_dwordx4 v[152:155], v23, s[24:27], s58 offen offset:0 sc1
    ds_read_b64_tr_b16 a[248:249], v2 offset:16640
    ds_read_b64_tr_b16 a[250:251], v2 offset:17152
    ds_read_b64_tr_b16 a[252:253], v3 offset:16640
    ds_read_b64_tr_b16 a[254:255], v3 offset:17152
    s_waitcnt vmcnt(10)
    v_mfma_f32_16x16x32_bf16 v[96:99], a[0:3], v[112:115], v[96:99]
    s_add_u32 s58, s58, 1024
    s_cmp_eq_u32 s58, s86
    s_cselect_b32 s58, s66, s58
    v_mfma_f32_16x16x32_bf16 v[100:103], a[4:7], v[112:115], v[100:103]
    buffer_load_dwordx4 v[156:159], v23, s[24:27], s58 offen offset:0 sc1
    v_mfma_f32_16x16x32_bf16 v[104:107], a[8:11], v[112:115], v[104:107]
    v_mfma_f32_16x16x32_bf16 v[108:111], a[12:15], v[112:115], v[108:111]
    s_waitcnt vmcnt(10)
    v_mfma_f32_16x16x32_bf16 v[96:99], a[16:19], v[116:119], v[96:99]
    s_add_u32 s58, s58, 1024
    s_cmp_eq_u32 s58, s86
    s_cselect_b32 s58, s66, s58
    v_mfma_f32_16x16x32_bf16 v[100:103], a[20:23], v[116:119], v[100:103]
    buffer_load_dwordx4 v[112:115], v23, s[24:27], s58 offen offset:0 sc1
    v_mfma_f32_16x16x32_bf16 v[104:107], a[24:27], v[116:119], v[104:107]
    v_mfma_f32_16x16x32_bf16 v[108:111], a[28:31], v[116:119], v[108:111]
    s_waitcnt vmcnt(10)
    v_mfma_f32_16x16x32_bf16 v[96:99], a[32:35], v[120:123], v[96:99]
    s_add_u32 s58, s66, 13312
    v_mfma_f32_16x16x32_bf16 v[100:103], a[36:39], v[120:123], v[100:103]
    buffer_load_dwordx4 v[116:119], v23, s[24:27], s58 offen offset:0 sc1
    v_mfma_f32_16x16x32_bf16 v[104:107], a[40:43], v[120:123], v[104:107]
    v_mfma_f32_16x16x32_bf16 v[108:111], a[44:47], v[120:123], v[108:111]
    s_waitcnt vmcnt(10)
    v_mfma_f32_16x16x32_bf16 v[96:99], a[48:51], v[124:127], v[96:99]
    s_add_u32 s58, s66, 14336
    v_mfma_f32_16x16x32_bf16 v[100:103], a[52:55], v[124:127], v[100:103]
    buffer_load_dwordx4 v[120:123], v23, s[24:27], s58 offen offset:0 sc1
    v_mfma_f32_16x16x32_bf16 v[104:107], a[56:59], v[124:127], v[104:107]
    v_mfma_f32_16x16x32_bf16 v[108:111], a[60:63], v[124:127], v[108:111]
    s_waitcnt vmcnt(10)
    v_mfma_f32_16x16x32_bf16 v[96:99], a[64:67], v[128:131], v[96:99]
    s_add_u32 s58, s66, 15360
    v_mfma_f32_16x16x32_bf16 v[100:103], a[68:71], v[128:131], v[100:103]
    buffer_load_dwordx4 v[124:127], v23, s[24:27], s58 offen offset:0 sc1
    v_mfma_f32_16x16x32_bf16 v[104:107], a[72:75], v[128:131], v[104:107]
    v_mfma_f32_16x16x32_bf16 v[108:111], a[76:79], v[128:131], v[108:111]
    s_waitcnt vmcnt(10)
    v_mfma_f32_16x16x32_bf16 v[96:99], a[80:83], v[132:135], v[96:99]
    s_xor_b32 s66, s44, 3
    s_lshl2_add_u32 s66, s51, s66
    s_mul_i32 s66, s66, 66816
    s_lshl2_add_u32 s66, s52, s66
    s_lshl_b32 s86, s65, 10
    s_add_u32 s58, s86, s66
    s_add_u32 s86, s66, 13312
    v_mfma_f32_16x16x32_bf16 v[100:103], a[84:87], v[132:135], v[100:103]
    buffer_load_dwordx4 v[128:131], v23, s[24:27], s58 offen offset:0 sc1
    v_mfma_f32_16x16x32_bf16 v[104:107], a[88:91], v[132:135], v[104:107]
    v_mfma_f32_16x16x32_bf16 v[108:111], a[92:95], v[132:135], v[108:111]
    s_waitcnt vmcnt(10)
    v_mfma_f32_16x16x32_bf16 v[96:99], a[96:99], v[136:139], v[96:99]
    s_add_u32 s58, s58, 1024
    s_cmp_eq_u32 s58, s86
    s_cselect_b32 s58, s66, s58
    v_mfma_f32_16x16x32_bf16 v[100:103], a[100:103], v[136:139], v[100:103]
    buffer_load_dwordx4 v[132:135], v23, s[24:27], s58 offen offset:0 sc1
    v_mfma_f32_16x16x32_bf16 v[104:107], a[104:107], v[136:139], v[104:107]
    v_mfma_f32_16x16x32_bf16 v[108:111], a[108:111], v[136:139], v[108:111]
    s_waitcnt vmcnt(10)
    v_mfma_f32_16x16x32_bf16 v[96:99], a[112:115], v[140:143], v[96:99]
    s_add_u32 s58, s58, 1024
    s_cmp_eq_u32 s58, s86
    s_cselect_b32 s58, s66, s58
    v_mfma_f32_16x16x32_bf16 v[100:103], a[116:119], v[140:143], v[100:103]
    buffer_load_dwordx4 v[136:139], v23, s[24:27], s58 offen offset:0 sc1
    v_mfma_f32_16x16x32_bf16 v[104:107], a[120:123], v[140:143], v[104:107]
    v_mfma_f32_16x16x32_bf16 v[108:111], a[124:127], v[140:143], v[108:111]
    s_waitcnt vmcnt(10)
    v_mfma_f32_16x16x32_bf16 v[96:99], a[128:131], v[144:147], v[96:99]
    s_add_u32 s58, s58, 1024
    s_cmp_eq_u32 s58, s86
    s_cselect_b32 s58, s66, s58
    v_mfma_f32_16x16x32_bf16 v[100:103], a[132:135], v[144:147], v[100:103]
    buffer_load_dwordx4 v[140:143], v23, s[24:27], s58 offen offset:0 sc1
    v_mfma_f32_16x16x32_bf16 v[104:107], a[136:139], v[144:147], v[104:107]
    v_mfma_f32_16x16x32_bf16 v[108:111], a[140:143], v[144:147], v[108:111]
    s_waitcnt vmcnt(10)
    s_waitcnt lgkmcnt(15)
    v_mfma_f32_16x16x32_bf16 v[96:99], a[144:147], v[148:151], v[96:99]
    s_add_u32 s58, s58, 1024
    s_cmp_eq_u32 s58, s86
    s_cselect_b32 s58, s66, s58
    v_mfma_f32_16x16x32_bf16 v[100:103], a[148:151], v[148:151], v[100:103]
    buffer_load_dwordx4 v[144:147], v23, s[24:27], s58 offen offset:0 sc1
    v_mfma_f32_16x16x32_bf16 v[104:107], a[152:155], v[148:151], v[104:107]
    v_mfma_f32_16x16x32_bf16 v[108:111], a[156:159], v[148:151], v[108:111]
    s_waitcnt vmcnt(10)
    v_mfma_f32_16x16x32_bf16 v[96:99], a[160:163], v[152:155], v[96:99]
    s_add_u32 s58, s58, 1024
    s_cmp_eq_u32 s58, s86
    s_cselect_b32 s58, s66, s58
    v_mfma_f32_16x16x32_bf16 v[100:103], a[164:167], v[152:155], v[100:103]
    buffer_load_dwordx4 v[148:151], v23, s[24:27], s58 offen offset:0 sc1
    v_mfma_f32_16x16x32_bf16 v[104:107], a[168:171], v[152:155], v[104:107]
    v_mfma_f32_16x16x32_bf16 v[108:111], a[172:175], v[152:155], v[108:111]
    s_waitcnt vmcnt(10)
    v_mfma_f32_16x16x32_bf16 v[96:99], a[176:179], v[156:159], v[96:99]
    s_add_u32 s58, s58, 1024
    s_cmp_eq_u32 s58, s86
    s_cselect_b32 s58, s66, s58
    v_mfma_f32_16x16x32_bf16 v[100:103], a[180:183], v[156:159], v[100:103]
    buffer_load_dwordx4 v[152:155], v23, s[24:27], s58 offen offset:0 sc1
    v_mfma_f32_16x16x32_bf16 v[104:107], a[184:187], v[156:159], v[104:107]
    v_mfma_f32_16x16x32_bf16 v[108:111], a[188:191], v[156:159], v[108:111]
    s_waitcnt vmcnt(10)
    v_mfma_f32_16x16x32_bf16 v[96:99], a[192:195], v[112:115], v[96:99]
    s_add_u32 s58, s58, 1024
    s_cmp_eq_u32 s58, s86
    s_cselect_b32 s58, s66, s58
    v_mfma_f32_16x16x32_bf16 v[100:103], a[196:199], v[112:115], v[100:103]
    buffer_load_dwordx4 v[156:159], v23, s[24:27], s58 offen offset:0 sc1
    v_mfma_f32_16x16x32_bf16 v[104:107], a[200:203], v[112:115], v[104:107]
    v_mfma_f32_16x16x32_bf16 v[108:111], a[204:207], v[112:115], v[108:111]
    s_waitcnt vmcnt(10)
    v_mfma_f32_16x16x32_bf16 v[96:99], a[208:211], v[116:119], v[96:99]
    s_add_u32 s58, s58, 1024
    s_cmp_eq_u32 s58, s86
    s_cselect_b32 s58, s66, s58
    v_mfma_f32_16x16x32_bf16 v[100:103], a[212:215], v[116:119], v[100:103]
    buffer_load_dwordx4 v[112:115], v23, s[24:27], s58 offen offset:0 sc1
    v_mfma_f32_16x16x32_bf16 v[104:107], a[216:219], v[116:119], v[104:107]
    v_mfma_f32_16x16x32_bf16 v[108:111], a[220:223], v[116:119], v[108:111]
    s_waitcnt vmcnt(10)
    s_waitcnt lgkmcnt(8)
    v_mfma_f32_16x16x32_bf16 v[96:99], a[224:227], v[120:123], v[96:99]
    s_add_u32 s58, s58, 1024
    s_cmp_eq_u32 s58, s86
    s_cselect_b32 s58, s66, s58
    v_mfma_f32_16x16x32_bf16 v[100:103], a[228:231], v[120:123], v[100:103]
    buffer_load_dwordx4 v[116:119], v23, s[24:27], s58 offen offset:0 sc1
    v_mfma_f32_16x16x32_bf16 v[104:107], a[232:235], v[120:123], v[104:107]
    v_mfma_f32_16x16x32_bf16 v[108:111], a[236:239], v[120:123], v[108:111]
    s_waitcnt vmcnt(10)
    s_waitcnt lgkmcnt(0)
    v_mfma_f32_16x16x32_bf16 v[96:99], a[240:243], v[124:127], v[96:99]
    s_add_u32 s58, s58, 1024
    s_cmp_eq_u32 s58, s86
    s_cselect_b32 s58, s66, s58
    v_mfma_f32_16x16x32_bf16 v[100:103], a[244:247], v[124:127], v[100:103]
    buffer_load_dwordx4 v[120:123], v23, s[24:27], s58 offen offset:0 sc1
    v_mfma_f32_16x16x32_bf16 v[104:107], a[248:251], v[124:127], v[104:107]
    v_mfma_f32_16x16x32_bf16 v[108:111], a[252:255], v[124:127], v[108:111]
L_p2_join:
    s_waitcnt vmcnt(10)
    v_mfma_f32_16x16x32_bf16 v[80:83], a[0:3], v[128:131], 0
    s_add_u32 s58, s58, 1024
    s_cmp_eq_u32 s58, s86
    s_cselect_b32 s58, s66, s58
    v_mfma_f32_16x16x32_bf16 v[84:87], a[4:7], v[128:131], 0
    buffer_load_dwordx4 v[124:127], v23, s[24:27], s58 offen offset:0 sc1
    v_mfma_f32_16x16x32_bf16 v[88:91], a[8:11], v[128:131], 0
    v_mfma_f32_16x16x32_bf16 v[92:95], a[12:15], v[128:131], 0
    buffer_load_dwordx4 v[216:219], v22, s[4:7], s71 offen
    s_waitcnt vmcnt(11)
    v_mfma_f32_16x16x32_bf16 v[80:83], a[16:19], v[132:135], v[80:83]
    ds_write_b128 v232, v[96:99] offset:49152
    v_mfma_f32_16x16x32_bf16 v[84:87], a[20:23], v[132:135], v[84:87]
    v_mfma_f32_16x16x32_bf16 v[88:91], a[24:27], v[132:135], v[88:91]
    v_mfma_f32_16x16x32_bf16 v[92:95], a[28:31], v[132:135], v[92:95]
    s_waitcnt vmcnt(10)
    v_mfma_f32_16x16x32_bf16 v[80:83], a[32:35], v[136:139], v[80:83]
    s_add_u32 s58, s58, 1024
    s_cmp_eq_u32 s58, s86
    s_cselect_b32 s58, s66, s58
    v_mfma_f32_16x16x32_bf16 v[84:87], a[36:39], v[136:139], v[84:87]
    buffer_load_dwordx4 v[128:131], v23, s[24:27], s58 offen offset:0 sc1
    v_mfma_f32_16x16x32_bf16 v[88:91], a[40:43], v[136:139], v[88:91]
    ds_write_b128 v232, v[100:103] offset:50176
    v_mfma_f32_16x16x32_bf16 v[92:95], a[44:47], v[136:139], v[92:95]
    buffer_load_dwordx4 v[220:223], v22, s[4:7], s72 offen
    s_waitcnt vmcnt(11)
    v_mfma_f32_16x16x32_bf16 v[80:83], a[48:51], v[140:143], v[80:83]
    ds_write_b128 v232, v[104:107] offset:51200
    v_mfma_f32_16x16x32_bf16 v[84:87], a[52:55], v[140:143], v[84:87]
    v_mfma_f32_16x16x32_bf16 v[88:91], a[56:59], v[140:143], v[88:91]
    v_mfma_f32_16x16x32_bf16 v[92:95], a[60:63], v[140:143], v[92:95]
    s_waitcnt vmcnt(10)
    v_mfma_f32_16x16x32_bf16 v[80:83], a[64:67], v[144:147], v[80:83]
    s_add_u32 s58, s66, 13312
    v_mfma_f32_16x16x32_bf16 v[84:87], a[68:71], v[144:147], v[84:87]
    buffer_load_dwordx4 v[132:135], v23, s[24:27], s58 offen offset:0 sc1
    v_mfma_f32_16x16x32_bf16 v[88:91], a[72:75], v[144:147], v[88:91]
    ds_write_b128 v232, v[108:111] offset:52224
    v_mfma_f32_16x16x32_bf16 v[92:95], a[76:79], v[144:147], v[92:95]
    buffer_load_dwordx2 v[224:225], v26, s[4:7], s73 offen
    s_waitcnt vmcnt(11)
    v_mfma_f32_16x16x32_bf16 v[80:83], a[80:83], v[148:151], v[80:83]
    v_mfma_f32_16x16x32_bf16 v[84:87], a[84:87], v[148:151], v[84:87]
    v_mfma_f32_16x16x32_bf16 v[88:91], a[88:91], v[148:151], v[88:91]
    v_mfma_f32_16x16x32_bf16 v[92:95], a[92:95], v[148:151], v[92:95]
    s_waitcnt vmcnt(10)
    v_mfma_f32_16x16x32_bf16 v[80:83], a[96:99], v[152:155], v[80:83]
    s_add_u32 s58, s66, 14336
    v_mfma_f32_16x16x32_bf16 v[84:87], a[100:103], v[152:155], v[84:87]
    buffer_load_dwordx4 v[136:139], v23, s[24:27], s58 offen offset:0 sc1
    v_mfma_f32_16x16x32_bf16 v[88:91], a[104:107], v[152:155], v[88:91]
    v_mfma_f32_16x16x32_bf16 v[92:95], a[108:111], v[152:155], v[92:95]
    buffer_load_ushort v228, v25, s[36:39], s74 offen
    s_waitcnt vmcnt(11)
    v_mfma_f32_16x16x32_bf16 v[80:83], a[112:115], v[156:159], v[80:83]
    s_waitcnt lgkmcnt(0)
    s_barrier
    v_mfma_f32_16x16x32_bf16 v[84:87], a[116:119], v[156:159], v[84:87]
    v_mfma_f32_16x16x32_bf16 v[88:91], a[120:123], v[156:159], v[88:91]
    v_mfma_f32_16x16x32_bf16 v[92:95], a[124:127], v[156:159], v[92:95]
    s_waitcnt vmcnt(10)
    v_mfma_f32_16x16x32_bf16 v[80:83], a[128:131], v[112:115], v[80:83]
    s_add_u32 s58, s66, 15360
    v_mfma_f32_16x16x32_bf16 v[84:87], a[132:135], v[112:115], v[84:87]
    buffer_load_dwordx4 v[140:143], v23, s[24:27], s58 offen offset:0 sc1
    v_mfma_f32_16x16x32_bf16 v[88:91], a[136:139], v[112:115], v[88:91]
    ds_read_b128 v[160:163], v243 offset:0
    ds_read_b128 v[164:167], v243 offset:1024
    v_mfma_f32_16x16x32_bf16 v[92:95], a[140:143], v[112:115], v[92:95]
    ds_read_b128 v[168:171], v243 offset:4096
    s_waitcnt vmcnt(10)
    v_mfma_f32_16x16x32_bf16 v[80:83], a[144:147], v[116:119], v[80:83]
    s_xor_b32 s66, s44, 2
    s_lshl2_add_u32 s66, s51, s66
    s_mul_i32 s66, s66, 66816
    s_lshl2_add_u32 s66, s52, s66
    s_lshl_b32 s86, s65, 10
    s_add_u32 s58, s86, s66
    s_add_u32 s86, s66, 13312
    v_mfma_f32_16x16x32_bf16 v[84:87], a[148:151], v[116:119], v[84:87]
    buffer_load_dwordx4 v[144:147], v23, s[24:27], s58 offen offset:0 sc1
    v_mfma_f32_16x16x32_bf16 v[88:91], a[152:155], v[116:119], v[88:91]
    ds_read_b128 v[172:175], v243 offset:5120
    ds_read_b128 v[176:179], v243 offset:8192
    v_mfma_f32_16x16x32_bf16 v[92:95], a[156:159], v[116:119], v[92:95]
    ds_read_b128 v[180:183], v243 offset:9216
    s_waitcnt vmcnt(10)
    v_mfma_f32_16x16x32_bf16 v[80:83], a[160:163], v[120:123], v[80:83]
    s_add_u32 s58, s58, 1024
    s_cmp_eq_u32 s58, s86
    s_cselect_b32 s58, s66, s58
    v_mfma_f32_16x16x32_bf16 v[84:87], a[164:167], v[120:123], v[84:87]
    buffer_load_dwordx4 v[148:151], v23, s[24:27], s58 offen offset:0 sc1
    v_mfma_f32_16x16x32_bf16 v[88:91], a[168:171], v[120:123], v[88:91]
    ds_read_b128 v[184:187], v243 offset:12288
    v_mfma_f32_16x16x32_bf16 v[92:95], a[172:175], v[120:123], v[92:95]
    ds_read_b128 v[188:191], v243 offset:13312
    s_waitcnt vmcnt(10)
    v_mfma_f32_16x16x32_bf16 v[80:83], a[176:179], v[124:127], v[80:83]
    s_add_u32 s58, s58, 1024
    s_cmp_eq_u32 s58, s86
    s_cselect_b32 s58, s66, s58
    v_mfma_f32_16x16x32_bf16 v[84:87], a[180:183], v[124:127], v[84:87]
    buffer_load_dwordx4 v[152:155], v23, s[24:27], s58 offen offset:0 sc1
    v_mfma_f32_16x16x32_bf16 v[88:91], a[184:187], v[124:127], v[88:91]
    v_mfma_f32_16x16x32_bf16 v[92:95], a[188:191], v[124:127], v[92:95]
    s_add_u32 s58, s58, 1024
    s_cmp_eq_u32 s58, s86
    s_cselect_b32 s58, s66, s58
    buffer_load_dwordx4 v[156:159], v23, s[24:27], s58 offen offset:0 sc1
    s_waitcnt vmcnt(10)
    v_mfma_f32_16x16x32_bf16 v[80:83], a[192:195], v[128:131], v[80:83]
    s_add_u32 s58, s58, 1024
    s_cmp_eq_u32 s58, s86
    s_cselect_b32 s58, s66, s58
    v_mfma_f32_16x16x32_bf16 v[84:87], a[196:199], v[128:131], v[84:87]
    buffer_load_dwordx4 v[112:115], v23, s[24:27], s58 offen offset:0 sc1
    v_mfma_f32_16x16x32_bf16 v[88:91], a[200:203], v[128:131], v[88:91]
    s_waitcnt lgkmcnt(0)
    v_add_f32 v160, v160, v168
    v_mfma_f32_16x16x32_bf16 v[92:95], a[204:207], v[128:131], v[92:95]
    v_add_f32 v161, v161, v169
    s_add_u32 s58, s58, 1024
    s_cmp_eq_u32 s58, s86
    s_cselect_b32 s58, s66, s58
    buffer_load_dwordx4 v[116:119], v23, s[24:27], s58 offen offset:0 sc1
    s_waitcnt vmcnt(10)
    v_mfma_f32_16x16x32_bf16 v[80:83], a[208:211], v[132:135], v[80:83]
    s_add_u32 s58, s58, 1024
    s_cmp_eq_u32 s58, s86
    s_cselect_b32 s58, s66, s58
    v_mfma_f32_16x16x32_bf16 v[84:87], a[212:215], v[132:135], v[84:87]
    buffer_load_dwordx4 v[120:123], v23, s[24:27], s58 offen offset:0 sc1
    v_mfma_f32_16x16x32_bf16 v[88:91], a[216:219], v[132:135], v[88:91]
    v_add_f32 v162, v162, v170
    v_add_f32 v163, v163, v171
    v_mfma_f32_16x16x32_bf16 v[92:95], a[220:223], v[132:135], v[92:95]
    v_add_f32 v164, v164, v172
    s_add_u32 s58, s58, 1024
    s_cmp_eq_u32 s58, s86
    s_cselect_b32 s58, s66, s58
    buffer_load_dwordx4 v[124:127], v23, s[24:27], s58 offen offset:0 sc1
    s_waitcnt vmcnt(10)
    v_mfma_f32_16x16x32_bf16 v[80:83], a[224:227], v[136:139], v[80:83]
    s_add_u32 s58, s58, 1024
    s_cmp_eq_u32 s58, s86
    s_cselect_b32 s58, s66, s58
    v_mfma_f32_16x16x32_bf16 v[84:87], a[228:231], v[136:139], v[84:87]
    buffer_load_dwordx4 v[128:131], v23, s[24:27], s58 offen offset:0 sc1
    v_mfma_f32_16x16x32_bf16 v[88:91], a[232:235], v[136:139], v[88:91]
    v_add_f32 v165, v165, v173
    v_add_f32 v166, v166, v174
    v_mfma_f32_16x16x32_bf16 v[92:95], a[236:239], v[136:139], v[92:95]
    v_add_f32 v167, v167, v175
    s_add_u32 s58, s58, 1024
    s_cmp_eq_u32 s58, s86
    s_cselect_b32 s58, s66, s58
    buffer_load_dwordx4 v[132:135], v23, s[24:27], s58 offen offset:0 sc1
    s_waitcnt vmcnt(10)
    v_mfma_f32_16x16x32_bf16 v[80:83], a[240:243], v[140:143], v[80:83]
    s_add_u32 s58, s58, 1024
    s_cmp_eq_u32 s58, s86
    s_cselect_b32 s58, s66, s58
    v_mfma_f32_16x16x32_bf16 v[84:87], a[244:247], v[140:143], v[84:87]
    buffer_load_dwordx4 v[136:139], v23, s[24:27], s58 offen offset:0 sc1
    v_mfma_f32_16x16x32_bf16 v[88:91], a[248:251], v[140:143], v[88:91]
    v_add_f32 v160, v160, v176
    v_add_f32 v161, v161, v177
    v_mfma_f32_16x16x32_bf16 v[92:95], a[252:255], v[140:143], v[92:95]
    v_add_f32 v162, v162, v178
    s_waitcnt vmcnt(10)
    v_mfma_f32_16x16x32_bf16 v[64:67], a[0:3], v[144:147], 0
    s_add_u32 s58, s58, 1024
    s_cmp_eq_u32 s58, s86
    s_cselect_b32 s58, s66, s58
    v_mfma_f32_16x16x32_bf16 v[68:71], a[4:7], v[144:147], 0
    buffer_load_dwordx4 v[140:143], v23, s[24:27], s58 offen offset:0 sc1
    v_mfma_f32_16x16x32_bf16 v[72:75], a[8:11], v[144:147], 0
    v_mfma_f32_16x16x32_bf16 v[76:79], a[12:15], v[144:147], 0
    s_waitcnt vmcnt(10)
    v_mfma_f32_16x16x32_bf16 v[64:67], a[16:19], v[148:151], v[64:67]
    s_add_u32 s58, s58, 1024
    s_cmp_eq_u32 s58, s86
    s_cselect_b32 s58, s66, s58
    v_mfma_f32_16x16x32_bf16 v[68:71], a[20:23], v[148:151], v[68:71]
    buffer_load_dwordx4 v[144:147], v23, s[24:27], s58 offen offset:0 sc1
    v_mfma_f32_16x16x32_bf16 v[72:75], a[24:27], v[148:151], v[72:75]
    ds_write_b128 v232, v[80:83] offset:32768
    v_mfma_f32_16x16x32_bf16 v[76:79], a[28:31], v[148:151], v[76:79]
    s_waitcnt vmcnt(10)
    v_mfma_f32_16x16x32_bf16 v[64:67], a[32:35], v[152:155], v[64:67]
    s_add_u32 s58, s66, 13312
    v_mfma_f32_16x16x32_bf16 v[68:71], a[36:39], v[152:155], v[68:71]
    buffer_load_dwordx4 v[148:151], v23, s[24:27], s58 offen offset:0 sc1
    v_mfma_f32_16x16x32_bf16 v[72:75], a[40:43], v[152:155], v[72:75]
    ds_write_b128 v232, v[84:87] offset:33792
    v_mfma_f32_16x16x32_bf16 v[76:79], a[44:47], v[152:155], v[76:79]
    s_waitcnt vmcnt(10)
    v_mfma_f32_16x16x32_bf16 v[64:67], a[48:51], v[156:159], v[64:67]
    s_add_u32 s58, s66, 14336
    ds_write_b128 v232, v[88:91] offset:34816
    v_mfma_f32_16x16x32_bf16 v[68:71], a[52:55], v[156:159], v[68:71]
    buffer_load_dwordx4 v[152:155], v23, s[24:27], s58 offen offset:0 sc1
    v_mfma_f32_16x16x32_bf16 v[72:75], a[56:59], v[156:159], v[72:75]
    v_add_f32 v163, v163, v179
    v_add_f32 v164, v164, v180
    v_mfma_f32_16x16x32_bf16 v[76:79], a[60:63], v[156:159], v[76:79]
    v_add_f32 v165, v165, v181
    s_waitcnt vmcnt(10)
    v_mfma_f32_16x16x32_bf16 v[64:67], a[64:67], v[112:115], v[64:67]
    s_add_u32 s58, s66, 15360
    ds_write_b128 v232, v[92:95] offset:35840
    v_mfma_f32_16x16x32_bf16 v[68:71], a[68:71], v[112:115], v[68:71]
    buffer_load_dwordx4 v[156:159], v23, s[24:27], s58 offen offset:0 sc1
    v_mfma_f32_16x16x32_bf16 v[72:75], a[72:75], v[112:115], v[72:75]
    v_add_f32 v166, v166, v182
    v_add_f32 v167, v167, v183
    v_mfma_f32_16x16x32_bf16 v[76:79], a[76:79], v[112:115], v[76:79]
    v_add_f32 v160, v160, v184
    s_waitcnt vmcnt(10)
    v_mfma_f32_16x16x32_bf16 v[64:67], a[80:83], v[116:119], v[64:67]
    s_xor_b32 s66, s44, 1
    s_lshl2_add_u32 s66, s51, s66
    s_mul_i32 s66, s66, 66816
    s_lshl2_add_u32 s66, s52, s66
    s_lshl_b32 s86, s65, 10
    s_add_u32 s58, s86, s66
    s_add_u32 s86, s66, 13312
    v_mfma_f32_16x16x32_bf16 v[68:71], a[84:87], v[116:119], v[68:71]
    buffer_load_dwordx4 v[112:115], v23, s[24:27], s58 offen offset:0 sc1
    v_mfma_f32_16x16x32_bf16 v[72:75], a[88:91], v[116:119], v[72:75]
    v_add_f32 v161, v161, v185
    v_add_f32 v162, v162, v186
    v_mfma_f32_16x16x32_bf16 v[76:79], a[92:95], v[116:119], v[76:79]
    v_add_f32 v163, v163, v187
    s_waitcnt vmcnt(10)
    v_mfma_f32_16x16x32_bf16 v[64:67], a[96:99], v[120:123], v[64:67]
    s_add_u32 s58, s58, 1024
    s_cmp_eq_u32 s58, s86
    s_cselect_b32 s58, s66, s58
    v_mfma_f32_16x16x32_bf16 v[68:71], a[100:103], v[120:123], v[68:71]
    buffer_load_dwordx4 v[116:119], v23, s[24:27], s58 offen offset:0 sc1
    v_mfma_f32_16x16x32_bf16 v[72:75], a[104:107], v[120:123], v[72:75]
    v_add_f32 v164, v164, v188
    v_add_f32 v165, v165, v189
    v_mfma_f32_16x16x32_bf16 v[76:79], a[108:111], v[120:123], v[76:79]
    v_add_f32 v166, v166, v190
    s_waitcnt vmcnt(10)
    v_mfma_f32_16x16x32_bf16 v[64:67], a[112:115], v[124:127], v[64:67]
    s_add_u32 s58, s58, 1024
    s_cmp_eq_u32 s58, s86
    s_cselect_b32 s58, s66, s58
    v_mfma_f32_16x16x32_bf16 v[68:71], a[116:119], v[124:127], v[68:71]
    buffer_load_dwordx4 v[120:123], v23, s[24:27], s58 offen offset:0 sc1
    v_mfma_f32_16x16x32_bf16 v[72:75], a[120:123], v[124:127], v[72:75]
    v_add_f32 v167, v167, v191
    v_mul_f32 v192, v160, v160
    v_mfma_f32_16x16x32_bf16 v[76:79], a[124:127], v[124:127], v[76:79]
    v_mul_f32 v193, v161, v161
    s_waitcnt vmcnt(10)
    v_mfma_f32_16x16x32_bf16 v[64:67], a[128:131], v[128:131], v[64:67]
    s_add_u32 s58, s58, 1024
    s_cmp_eq_u32 s58, s86
    s_cselect_b32 s58, s66, s58
    v_mfma_f32_16x16x32_bf16 v[68:71], a[132:135], v[128:131], v[68:71]
    buffer_load_dwordx4 v[124:127], v23, s[24:27], s58 offen offset:0 sc1
    v_mfma_f32_16x16x32_bf16 v[72:75], a[136:139], v[128:131], v[72:75]
    v_mul_f32 v194, v162, v162
    v_mul_f32 v195, v163, v163
    v_mfma_f32_16x16x32_bf16 v[76:79], a[140:143], v[128:131], v[76:79]
    v_mul_f32 v196, v164, v164
    s_waitcnt vmcnt(10)
    v_mfma_f32_16x16x32_bf16 v[64:67], a[144:147], v[132:135], v[64:67]
    s_add_u32 s58, s58, 1024
    s_cmp_eq_u32 s58, s86
    s_cselect_b32 s58, s66, s58
    v_mfma_f32_16x16x32_bf16 v[68:71], a[148:151], v[132:135], v[68:71]
    buffer_load_dwordx4 v[128:131], v23, s[24:27], s58 offen offset:0 sc1
    v_mfma_f32_16x16x32_bf16 v[72:75], a[152:155], v[132:135], v[72:75]
    v_mul_f32 v197, v165, v165
    v_mul_f32 v198, v166, v166
    v_mfma_f32_16x16x32_bf16 v[76:79], a[156:159], v[132:135], v[76:79]
    v_mul_f32 v199, v167, v167
    ds_write_b128 v244, v[216:219]
    s_waitcnt vmcnt(10)
    v_mfma_f32_16x16x32_bf16 v[64:67], a[160:163], v[136:139], v[64:67]
    s_add_u32 s58, s58, 1024
    s_cmp_eq_u32 s58, s86
    s_cselect_b32 s58, s66, s58
    v_mfma_f32_16x16x32_bf16 v[68:71], a[164:167], v[136:139], v[68:71]
    buffer_load_dwordx4 v[132:135], v23, s[24:27], s58 offen offset:0 sc1
    v_mfma_f32_16x16x32_bf16 v[72:75], a[168:171], v[136:139], v[72:75]
    v_fma_f32 v192, v192, v236, v237
    v_fma_f32 v193, v193, v236, v237
    v_mfma_f32_16x16x32_bf16 v[76:79], a[172:175], v[136:139], v[76:79]
    v_fma_f32 v194, v194, v236, v237
    s_waitcnt vmcnt(10)
    v_mfma_f32_16x16x32_bf16 v[64:67], a[176:179], v[140:143], v[64:67]
    s_add_u32 s58, s58, 1024
    s_cmp_eq_u32 s58, s86
    s_cselect_b32 s58, s66, s58
    v_mfma_f32_16x16x32_bf16 v[68:71], a[180:183], v[140:143], v[68:71]
    buffer_load_dwordx4 v[136:139], v23, s[24:27], s58 offen offset:0 sc1
    v_mfma_f32_16x16x32_bf16 v[72:75], a[184:187], v[140:143], v[72:75]
    v_fma_f32 v195, v195, v236, v237
    v_fma_f32 v196, v196, v236, v237
    v_mfma_f32_16x16x32_bf16 v[76:79], a[188:191], v[140:143], v[76:79]
    v_fma_f32 v197, v197, v236, v237
    ds_write_b128 v244, v[220:223] offset:1408
    s_waitcnt vmcnt(10)
    v_mfma_f32_16x16x32_bf16 v[64:67], a[192:195], v[144:147], v[64:67]
    s_add_u32 s58, s58, 1024
    s_cmp_eq_u32 s58, s86
    s_cselect_b32 s58, s66, s58
    v_mfma_f32_16x16x32_bf16 v[68:71], a[196:199], v[144:147], v[68:71]
    buffer_load_dwordx4 v[140:143], v23, s[24:27], s58 offen offset:0 sc1
    v_mfma_f32_16x16x32_bf16 v[72:75], a[200:203], v[144:147], v[72:75]
    v_fma_f32 v198, v198, v236, v237
    v_fma_f32 v199, v199, v236, v237
    v_mfma_f32_16x16x32_bf16 v[76:79], a[204:207], v[144:147], v[76:79]
    v_mul_f32 v192, v192, v160
    s_waitcnt vmcnt(10)
    v_mfma_f32_16x16x32_bf16 v[64:67], a[208:211], v[148:151], v[64:67]
    s_add_u32 s58, s58, 1024
    s_cmp_eq_u32 s58, s86
    s_cselect_b32 s58, s66, s58
    v_mfma_f32_16x16x32_bf16 v[68:71], a[212:215], v[148:151], v[68:71]
    buffer_load_dwordx4 v[144:147], v23, s[24:27], s58 offen offset:0 sc1
    v_mfma_f32_16x16x32_bf16 v[72:75], a[216:219], v[148:151], v[72:75]
    v_mul_f32 v193, v193, v161
    v_mul_f32 v194, v194, v162
    v_mfma_f32_16x16x32_bf16 v[76:79], a[220:223], v[148:151], v[76:79]
    v_mul_f32 v195, v195, v163
    ds_write_b64 v252, v[224:225] offset:128
    s_waitcnt vmcnt(10)
    v_mfma_f32_16x16x32_bf16 v[64:67], a[224:227], v[152:155], v[64:67]
    s_add_u32 s58, s58, 1024
    s_cmp_eq_u32 s58, s86
    s_cselect_b32 s58, s66, s58
    v_mfma_f32_16x16x32_bf16 v[68:71], a[228:231], v[152:155], v[68:71]
    buffer_load_dwordx4 v[148:151], v23, s[24:27], s58 offen offset:0 sc1
    v_mfma_f32_16x16x32_bf16 v[72:75], a[232:235], v[152:155], v[72:75]
    v_mul_f32 v196, v196, v164
    v_mul_f32 v197, v197, v165
    v_mfma_f32_16x16x32_bf16 v[76:79], a[236:239], v[152:155], v[76:79]
    v_mul_f32 v198, v198, v166
    s_waitcnt vmcnt(10)
    v_mfma_f32_16x16x32_bf16 v[64:67], a[240:243], v[156:159], v[64:67]
    s_add_u32 s58, s58, 1024
    s_cmp_eq_u32 s58, s86
    s_cselect_b32 s58, s66, s58
    v_mfma_f32_16x16x32_bf16 v[68:71], a[244:247], v[156:159], v[68:71]
    buffer_load_dwordx4 v[152:155], v23, s[24:27], s58 offen offset:0 sc1
    v_mfma_f32_16x16x32_bf16 v[72:75], a[248:251], v[156:159], v[72:75]
    v_mul_f32 v199, v199, v167
    v_mfma_f32_16x16x32_bf16 v[76:79], a[252:255], v[156:159], v[76:79]
    ds_read_b64 v[216:217], v238 offset:0
    ds_read_b64 v[218:219], v238 offset:32
    ds_read_b64 v[220:221], v238 offset:64
    ds_read_b64 v[222:223], v238 offset:96
    ds_read_b64 v[224:225], v238 offset:128
    s_waitcnt vmcnt(10)
    v_mfma_f32_16x16x32_bf16 v[48:51], a[0:3], v[112:115], 0
    s_add_u32 s58, s58, 1024
    s_cmp_eq_u32 s58, s86
    s_cselect_b32 s58, s66, s58
    v_mfma_f32_16x16x32_bf16 v[52:55], a[4:7], v[112:115], 0
    buffer_load_dwordx4 v[156:159], v23, s[24:27], s58 offen offset:0 sc1
    v_mfma_f32_16x16x32_bf16 v[56:59], a[8:11], v[112:115], 0
    v_mfma_f32_16x16x32_bf16 v[60:63], a[12:15], v[112:115], 0
    s_waitcnt vmcnt(10)
    v_mfma_f32_16x16x32_bf16 v[48:51], a[16:19], v[116:119], v[48:51]
    s_add_u32 s58, s58, 1024
    s_cmp_eq_u32 s58, s86
    s_cselect_b32 s58, s66, s58
    v_mfma_f32_16x16x32_bf16 v[52:55], a[20:23], v[116:119], v[52:55]
    buffer_load_dwordx4 v[112:115], v23, s[24:27], s58 offen offset:0 sc1
    v_mfma_f32_16x16x32_bf16 v[56:59], a[24:27], v[116:119], v[56:59]
    ds_write_b128 v232, v[64:67] offset:16384
    v_mfma_f32_16x16x32_bf16 v[60:63], a[28:31], v[116:119], v[60:63]
    s_waitcnt vmcnt(10)
    v_mfma_f32_16x16x32_bf16 v[48:51], a[32:35], v[120:123], v[48:51]
    s_add_u32 s58, s66, 13312
    v_mfma_f32_16x16x32_bf16 v[52:55], a[36:39], v[120:123], v[52:55]
    buffer_load_dwordx4 v[116:119], v23, s[24:27], s58 offen offset:0 sc1
    v_mfma_f32_16x16x32_bf16 v[56:59], a[40:43], v[120:123], v[56:59]
    ds_write_b128 v232, v[68:71] offset:17408
    v_mfma_f32_16x16x32_bf16 v[60:63], a[44:47], v[120:123], v[60:63]
    s_waitcnt vmcnt(10)
    v_mfma_f32_16x16x32_bf16 v[48:51], a[48:51], v[124:127], v[48:51]
    s_add_u32 s58, s66, 14336
    ds_write_b128 v232, v[72:75] offset:18432
    v_mfma_f32_16x16x32_bf16 v[52:55], a[52:55], v[124:127], v[52:55]
    buffer_load_dwordx4 v[120:123], v23, s[24:27], s58 offen offset:0 sc1
    v_mfma_f32_16x16x32_bf16 v[56:59], a[56:59], v[124:127], v[56:59]
    v_exp_f32 v192, v192
    v_exp_f32 v193, v193
    v_mfma_f32_16x16x32_bf16 v[60:63], a[60:63], v[124:127], v[60:63]
    v_exp_f32 v194, v194
    s_waitcnt vmcnt(10)
    v_mfma_f32_16x16x32_bf16 v[48:51], a[64:67], v[128:131], v[48:51]
    s_add_u32 s58, s66, 15360
    ds_write_b128 v232, v[76:79] offset:19456
    v_mfma_f32_16x16x32_bf16 v[52:55], a[68:71], v[128:131], v[52:55]
    buffer_load_dwordx4 v[124:127], v23, s[24:27], s58 offen offset:0 sc1
    v_mfma_f32_16x16x32_bf16 v[56:59], a[72:75], v[128:131], v[56:59]
    v_exp_f32 v195, v195
    v_exp_f32 v196, v196
    v_mfma_f32_16x16x32_bf16 v[60:63], a[76:79], v[128:131], v[60:63]
    v_exp_f32 v197, v197
    s_waitcnt vmcnt(10)
    v_mfma_f32_16x16x32_bf16 v[48:51], a[80:83], v[132:135], v[48:51]
    s_xor_b32 s66, s44, 0
    s_lshl2_add_u32 s66, s51, s66
    s_mul_i32 s66, s66, 66816
    s_lshl2_add_u32 s66, s52, s66
    s_lshl_b32 s86, s65, 10
    s_add_u32 s58, s86, s66
    s_add_u32 s86, s66, 13312
    v_mfma_f32_16x16x32_bf16 v[52:55], a[84:87], v[132:135], v[52:55]
    buffer_load_dwordx4 v[128:131], v23, s[24:27], s58 offen offset:0 sc1
    v_mfma_f32_16x16x32_bf16 v[56:59], a[88:91], v[132:135], v[56:59]
    v_exp_f32 v198, v198
    v_exp_f32 v199, v199
    v_mfma_f32_16x16x32_bf16 v[60:63], a[92:95], v[132:135], v[60:63]
    v_add_f32 v192, 1.0, v192
    s_waitcnt vmcnt(10)
    v_mfma_f32_16x16x32_bf16 v[48:51], a[96:99], v[136:139], v[48:51]
    s_add_u32 s58, s58, 1024
    s_cmp_eq_u32 s58, s86
    s_cselect_b32 s58, s66, s58
    v_mfma_f32_16x16x32_bf16 v[52:55], a[100:103], v[136:139], v[52:55]
    buffer_load_dwordx4 v[132:135], v23, s[24:27], s58 offen offset:0 sc1
    v_mfma_f32_16x16x32_bf16 v[56:59], a[104:107], v[136:139], v[56:59]
    v_add_f32 v193, 1.0, v193
    v_add_f32 v194, 1.0, v194
    v_mfma_f32_16x16x32_bf16 v[60:63], a[108:111], v[136:139], v[60:63]
    v_add_f32 v195, 1.0, v195
    s_waitcnt vmcnt(10)
    v_mfma_f32_16x16x32_bf16 v[48:51], a[112:115], v[140:143], v[48:51]
    s_add_u32 s58, s58, 1024
    s_cmp_eq_u32 s58, s86
    s_cselect_b32 s58, s66, s58
    v_mfma_f32_16x16x32_bf16 v[52:55], a[116:119], v[140:143], v[52:55]
    buffer_load_dwordx4 v[136:139], v23, s[24:27], s58 offen offset:0 sc1
    v_mfma_f32_16x16x32_bf16 v[56:59], a[120:123], v[140:143], v[56:59]
    v_add_f32 v196, 1.0, v196
    v_add_f32 v197, 1.0, v197
    v_mfma_f32_16x16x32_bf16 v[60:63], a[124:127], v[140:143], v[60:63]
    v_add_f32 v198, 1.0, v198
    s_waitcnt vmcnt(10)
    v_mfma_f32_16x16x32_bf16 v[48:51], a[128:131], v[144:147], v[48:51]
    s_add_u32 s58, s58, 1024
    s_cmp_eq_u32 s58, s86
    s_cselect_b32 s58, s66, s58
    v_mfma_f32_16x16x32_bf16 v[52:55], a[132:135], v[144:147], v[52:55]
    buffer_load_dwordx4 v[140:143], v23, s[24:27], s58 offen offset:0 sc1
    v_mfma_f32_16x16x32_bf16 v[56:59], a[136:139], v[144:147], v[56:59]
    v_add_f32 v199, 1.0, v199
    v_rcp_f32 v192, v192
    v_mfma_f32_16x16x32_bf16 v[60:63], a[140:143], v[144:147], v[60:63]
    v_rcp_f32 v193, v193
    s_waitcnt vmcnt(10)
    v_mfma_f32_16x16x32_bf16 v[48:51], a[144:147], v[148:151], v[48:51]
    s_add_u32 s58, s58, 1024
    s_cmp_eq_u32 s58, s86
    s_cselect_b32 s58, s66, s58
    v_mfma_f32_16x16x32_bf16 v[52:55], a[148:151], v[148:151], v[52:55]
    buffer_load_dwordx4 v[144:147], v23, s[24:27], s58 offen offset:0 sc1
    v_mfma_f32_16x16x32_bf16 v[56:59], a[152:155], v[148:151], v[56:59]
    v_rcp_f32 v194, v194
    v_rcp_f32 v195, v195
    v_mfma_f32_16x16x32_bf16 v[60:63], a[156:159], v[148:151], v[60:63]
    v_rcp_f32 v196, v196
    s_waitcnt vmcnt(10)
    v_mfma_f32_16x16x32_bf16 v[48:51], a[160:163], v[152:155], v[48:51]
    s_add_u32 s58, s58, 1024
    s_cmp_eq_u32 s58, s86
    s_cselect_b32 s58, s66, s58
    v_mfma_f32_16x16x32_bf16 v[52:55], a[164:167], v[152:155], v[52:55]
    buffer_load_dwordx4 v[148:151], v23, s[24:27], s58 offen offset:0 sc1
    v_mfma_f32_16x16x32_bf16 v[56:59], a[168:171], v[152:155], v[56:59]
    v_rcp_f32 v197, v197
    v_rcp_f32 v198, v198
    v_mfma_f32_16x16x32_bf16 v[60:63], a[172:175], v[152:155], v[60:63]
    v_rcp_f32 v199, v199
    s_waitcnt vmcnt(10)
    v_mfma_f32_16x16x32_bf16 v[48:51], a[176:179], v[156:159], v[48:51]
    s_add_u32 s58, s58, 1024
    s_cmp_eq_u32 s58, s86
    s_cselect_b32 s58, s66, s58
    v_mfma_f32_16x16x32_bf16 v[52:55], a[180:183], v[156:159], v[52:55]
    buffer_load_dwordx4 v[152:155], v23, s[24:27], s58 offen offset:0 sc1
    v_mfma_f32_16x16x32_bf16 v[56:59], a[184:187], v[156:159], v[56:59]
    v_mul_f32 v192, v192, v160
    v_mul_f32 v193, v193, v161
    v_mfma_f32_16x16x32_bf16 v[60:63], a[188:191], v[156:159], v[60:63]
    v_mul_f32 v194, v194, v162
    s_waitcnt vmcnt(10)
    v_mfma_f32_16x16x32_bf16 v[48:51], a[192:195], v[112:115], v[48:51]
    s_add_u32 s58, s58, 1024
    s_cmp_eq_u32 s58, s86
    s_cselect_b32 s58, s66, s58
    v_mfma_f32_16x16x32_bf16 v[52:55], a[196:199], v[112:115], v[52:55]
    buffer_load_dwordx4 v[156:159], v23, s[24:27], s58 offen offset:0 sc1
    v_mfma_f32_16x16x32_bf16 v[56:59], a[200:203], v[112:115], v[56:59]
    v_mul_f32 v195, v195, v163
    v_mul_f32 v196, v196, v164
    v_mfma_f32_16x16x32_bf16 v[60:63], a[204:207], v[112:115], v[60:63]
    v_mul_f32 v197, v197, v165
    s_waitcnt vmcnt(10)
    v_mfma_f32_16x16x32_bf16 v[48:51], a[208:211], v[116:119], v[48:51]
    s_add_u32 s58, s58, 1024
    s_cmp_eq_u32 s58, s86
    s_cselect_b32 s58, s66, s58
    v_mfma_f32_16x16x32_bf16 v[52:55], a[212:215], v[116:119], v[52:55]
    buffer_load_dwordx4 v[112:115], v23, s[24:27], s58 offen offset:0 sc1
    v_mfma_f32_16x16x32_bf16 v[56:59], a[216:219], v[116:119], v[56:59]
    v_mul_f32 v198, v198, v166
    v_mul_f32 v199, v199, v167
    v_mfma_f32_16x16x32_bf16 v[60:63], a[220:223], v[116:119], v[60:63]
    v_cvt_pk_bf16_f32 v96, v192, v193
    s_waitcnt vmcnt(10)
    v_mfma_f32_16x16x32_bf16 v[48:51], a[224:227], v[120:123], v[48:51]
    s_add_u32 s58, s58, 1024
    s_cmp_eq_u32 s58, s86
    s_cselect_b32 s58, s66, s58
    v_mfma_f32_16x16x32_bf16 v[52:55], a[228:231], v[120:123], v[52:55]
    buffer_load_dwordx4 v[116:119], v23, s[24:27], s58 offen offset:0 sc1
    v_mfma_f32_16x16x32_bf16 v[56:59], a[232:235], v[120:123], v[56:59]
    v_cvt_pk_bf16_f32 v97, v194, v195
    v_cvt_pk_bf16_f32 v98, v196, v197
    v_mfma_f32_16x16x32_bf16 v[60:63], a[236:239], v[120:123], v[60:63]
    v_cvt_pk_bf16_f32 v99, v198, v199
    s_waitcnt vmcnt(10)
    v_mfma_f32_16x16x32_bf16 v[48:51], a[240:243], v[124:127], v[48:51]
    s_add_u32 s58, s58, 1024
    s_cmp_eq_u32 s58, s86
    s_cselect_b32 s58, s66, s58
    v_mfma_f32_16x16x32_bf16 v[52:55], a[244:247], v[124:127], v[52:55]
    buffer_load_dwordx4 v[120:123], v23, s[24:27], s58 offen offset:0 sc1
    v_mfma_f32_16x16x32_bf16 v[56:59], a[248:251], v[124:127], v[56:59]
    v_mfma_f32_16x16x32_bf16 v[60:63], a[252:255], v[124:127], v[60:63]
    s_waitcnt vmcnt(10)
    v_mfma_f32_16x16x32_bf16 v[32:35], a[0:3], v[128:131], v[32:35]
    s_add_u32 s58, s58, 1024
    s_cmp_eq_u32 s58, s86
    s_cselect_b32 s58, s66, s58
    v_mfma_f32_16x16x32_bf16 v[36:39], a[4:7], v[128:131], v[36:39]
    buffer_load_dwordx4 v[124:127], v23, s[24:27], s58 offen offset:0 sc1
    v_mfma_f32_16x16x32_bf16 v[40:43], a[8:11], v[128:131], v[40:43]
    v_mfma_f32_16x16x32_bf16 v[44:47], a[12:15], v[128:131], v[44:47]
    s_waitcnt vmcnt(10)
    v_mfma_f32_16x16x32_bf16 v[32:35], a[16:19], v[132:135], v[32:35]
    s_add_u32 s58, s58, 1024
    s_cmp_eq_u32 s58, s86
    s_cselect_b32 s58, s66, s58
    v_mfma_f32_16x16x32_bf16 v[36:39], a[20:23], v[132:135], v[36:39]
    buffer_load_dwordx4 v[128:131], v23, s[24:27], s58 offen offset:0 sc1
    v_mfma_f32_16x16x32_bf16 v[40:43], a[24:27], v[132:135], v[40:43]
    ds_write_b128 v232, v[48:51] offset:0
    v_mfma_f32_16x16x32_bf16 v[44:47], a[28:31], v[132:135], v[44:47]
    ds_write_b128 v232, v[52:55] offset:1024
    s_waitcnt vmcnt(10)
    v_mfma_f32_16x16x32_bf16 v[32:35], a[32:35], v[136:139], v[32:35]
    s_add_u32 s58, s66, 13312
    v_mfma_f32_16x16x32_bf16 v[36:39], a[36:39], v[136:139], v[36:39]
    buffer_load_dwordx4 v[132:135], v23, s[24:27], s58 offen offset:0 sc1
    v_mfma_f32_16x16x32_bf16 v[40:43], a[40:43], v[136:139], v[40:43]
    ds_write_b128 v232, v[56:59] offset:2048
    v_mfma_f32_16x16x32_bf16 v[44:47], a[44:47], v[136:139], v[44:47]
    ds_write_b128 v232, v[60:63] offset:3072
    s_waitcnt vmcnt(10)
    v_mfma_f32_16x16x32_bf16 v[32:35], a[48:51], v[140:143], v[32:35]
    s_add_u32 s58, s66, 14336
    v_mfma_f32_16x16x32_bf16 v[36:39], a[52:55], v[140:143], v[36:39]
    buffer_load_dwordx4 v[136:139], v23, s[24:27], s58 offen offset:0 sc1
    v_mfma_f32_16x16x32_bf16 v[40:43], a[56:59], v[140:143], v[40:43]
    v_mfma_f32_16x16x32_bf16 v[44:47], a[60:63], v[140:143], v[44:47]
    s_waitcnt vmcnt(10)
    v_mfma_f32_16x16x32_bf16 v[32:35], a[64:67], v[144:147], v[32:35]
    s_add_u32 s58, s66, 15360
    v_mfma_f32_16x16x32_bf16 v[36:39], a[68:71], v[144:147], v[36:39]
    buffer_load_dwordx4 v[140:143], v23, s[24:27], s58 offen offset:0 sc1
    v_mfma_f32_16x16x32_bf16 v[40:43], a[72:75], v[144:147], v[40:43]
    v_mfma_f32_16x16x32_bf16 v[44:47], a[76:79], v[144:147], v[44:47]
    s_add_u32 m0, s52, 81920
    s_lshl_b32 s57, s76, 7
    buffer_load_dwordx4 v12, s[20:23], s57 offen offset:0 lds
    s_waitcnt vmcnt(11)
    v_mfma_f32_16x16x32_bf16 v[32:35], a[80:83], v[148:151], v[32:35]
    s_waitcnt lgkmcnt(0)
    s_barrier
    v_mfma_f32_16x16x32_bf16 v[36:39], a[84:87], v[148:151], v[36:39]
    v_mfma_f32_16x16x32_bf16 v[40:43], a[88:91], v[148:151], v[40:43]
    v_mfma_f32_16x16x32_bf16 v[44:47], a[92:95], v[148:151], v[44:47]
    s_add_u32 s57, s57, 31744
    buffer_load_dwordx4 v12, s[20:23], s57 offen offset:1024 lds
    s_waitcnt vmcnt(11)
    v_mfma_f32_16x16x32_bf16 v[32:35], a[96:99], v[152:155], v[32:35]
    ds_read_b128 v[160:163], v233 offset:0
    v_mfma_f32_16x16x32_bf16 v[36:39], a[100:103], v[152:155], v[36:39]
    ds_read_b128 v[176:179], v234 offset:16384
    v_mfma_f32_16x16x32_bf16 v[40:43], a[104:107], v[152:155], v[40:43]
    ds_read_b128 v[192:195], v235 offset:32768
    v_mfma_f32_16x16x32_bf16 v[44:47], a[108:111], v[152:155], v[44:47]
    s_add_u32 s57, s57, 31744
    buffer_load_dwordx4 v12, s[20:23], s57 offen offset:2048 lds
    s_waitcnt vmcnt(11)
    v_mfma_f32_16x16x32_bf16 v[32:35], a[112:115], v[156:159], v[32:35]
    ds_read_b128 v[164:167], v233 offset:1024
    v_mfma_f32_16x16x32_bf16 v[36:39], a[116:119], v[156:159], v[36:39]
    ds_read_b128 v[180:183], v234 offset:17408
    v_mfma_f32_16x16x32_bf16 v[40:43], a[120:123], v[156:159], v[40:43]
    ds_read_b128 v[196:199], v235 offset:33792
    v_mfma_f32_16x16x32_bf16 v[44:47], a[124:127], v[156:159], v[44:47]
    s_add_u32 s57, s57, 31744
    buffer_load_dwordx4 v12, s[20:23], s57 offen offset:3072 lds
    s_waitcnt vmcnt(11)
    v_mfma_f32_16x16x32_bf16 v[32:35], a[128:131], v[112:115], v[32:35]
    ds_read_b128 v[168:171], v233 offset:2048
    v_mfma_f32_16x16x32_bf16 v[36:39], a[132:135], v[112:115], v[36:39]
    ds_read_b128 v[184:187], v234 offset:18432
    v_mfma_f32_16x16x32_bf16 v[40:43], a[136:139], v[112:115], v[40:43]
    ds_read_b128 v[200:203], v235 offset:34816
    v_mfma_f32_16x16x32_bf16 v[44:47], a[140:143], v[112:115], v[44:47]
    s_add_u32 m0, s52, 98304
    s_lshl_b32 s57, s76, 7
    s_add_u32 s57, s57, 131072
    buffer_load_dwordx4 v12, s[20:23], s57 offen offset:0 lds
    s_waitcnt vmcnt(11)
    v_mfma_f32_16x16x32_bf16 v[32:35], a[144:147], v[116:119], v[32:35]
    ds_read_b128 v[172:175], v233 offset:3072
    v_mfma_f32_16x16x32_bf16 v[36:39], a[148:151], v[116:119], v[36:39]
    ds_read_b128 v[188:191], v234 offset:19456
    v_mfma_f32_16x16x32_bf16 v[40:43], a[152:155], v[116:119], v[40:43]
    ds_read_b128 v[204:207], v235 offset:35840
    v_mfma_f32_16x16x32_bf16 v[44:47], a[156:159], v[116:119], v[44:47]
    s_add_u32 s57, s57, 31744
    buffer_load_dwordx4 v12, s[20:23], s57 offen offset:1024 lds
    s_waitcnt vmcnt(11)
    v_mfma_f32_16x16x32_bf16 v[32:35], a[160:163], v[120:123], v[32:35]
    v_mfma_f32_16x16x32_bf16 v[36:39], a[164:167], v[120:123], v[36:39]
    v_mfma_f32_16x16x32_bf16 v[40:43], a[168:171], v[120:123], v[40:43]
    v_mfma_f32_16x16x32_bf16 v[44:47], a[172:175], v[120:123], v[44:47]
    s_add_u32 s57, s57, 31744
    buffer_load_dwordx4 v12, s[20:23], s57 offen offset:2048 lds
    s_waitcnt vmcnt(11)
    v_mfma_f32_16x16x32_bf16 v[32:35], a[176:179], v[124:127], v[32:35]
    s_waitcnt lgkmcnt(9)
    v_mfma_f32_16x16x32_bf16 v[36:39], a[180:183], v[124:127], v[36:39]
    v_add_f32 v160, v160, v176
    v_mfma_f32_16x16x32_bf16 v[40:43], a[184:187], v[124:127], v[40:43]
    v_add_f32 v161, v161, v177
    v_mfma_f32_16x16x32_bf16 v[44:47], a[188:191], v[124:127], v[44:47]
    v_add_f32 v162, v162, v178
    s_add_u32 s57, s57, 31744
    buffer_load_dwordx4 v12, s[20:23], s57 offen offset:3072 lds
    s_waitcnt vmcnt(11)
    v_mfma_f32_16x16x32_bf16 v[32:35], a[192:195], v[128:131], v[32:35]
    v_add_f32 v163, v163, v179
    v_mfma_f32_16x16x32_bf16 v[36:39], a[196:199], v[128:131], v[36:39]
    s_waitcnt lgkmcnt(6)
    v_mfma_f32_16x16x32_bf16 v[40:43], a[200:203], v[128:131], v[40:43]
    v_add_f32 v164, v164, v180
    v_mfma_f32_16x16x32_bf16 v[44:47], a[204:207], v[128:131], v[44:47]
    v_add_f32 v165, v165, v181
    s_add_u32 m0, s52, 114688
    s_lshl_b32 s57, s77, 7
    buffer_load_dwordx4 v12, s[20:23], s57 offen offset:0 lds
    s_waitcnt vmcnt(11)
    v_mfma_f32_16x16x32_bf16 v[32:35], a[208:211], v[132:135], v[32:35]
    v_add_f32 v166, v166, v182
    v_mfma_f32_16x16x32_bf16 v[36:39], a[212:215], v[132:135], v[36:39]
    v_add_f32 v167, v167, v183
    v_mfma_f32_16x16x32_bf16 v[40:43], a[216:219], v[132:135], v[40:43]
    s_waitcnt lgkmcnt(3)
    v_mfma_f32_16x16x32_bf16 v[44:47], a[220:223], v[132:135], v[44:47]
    v_add_f32 v168, v168, v184
    s_add_u32 s57, s57, 31744
    buffer_load_dwordx4 v12, s[20:23], s57 offen offset:1024 lds
    s_waitcnt vmcnt(11)
    v_mfma_f32_16x16x32_bf16 v[32:35], a[224:227], v[136:139], v[32:35]
    v_add_f32 v169, v169, v185
    v_mfma_f32_16x16x32_bf16 v[36:39], a[228:231], v[136:139], v[36:39]
    v_add_f32 v170, v170, v186
    v_mfma_f32_16x16x32_bf16 v[40:43], a[232:235], v[136:139], v[40:43]
    v_add_f32 v171, v171, v187
    v_mfma_f32_16x16x32_bf16 v[44:47], a[236:239], v[136:139], v[44:47]
    s_waitcnt lgkmcnt(0)
    s_add_u32 s57, s57, 31744
    buffer_load_dwordx4 v12, s[20:23], s57 offen offset:2048 lds
    s_waitcnt vmcnt(11)
    v_mfma_f32_16x16x32_bf16 v[32:35], a[240:243], v[140:143], v[32:35]
    v_add_f32 v172, v172, v188
    v_mfma_f32_16x16x32_bf16 v[36:39], a[244:247], v[140:143], v[36:39]
    v_add_f32 v173, v173, v189
    v_mfma_f32_16x16x32_bf16 v[40:43], a[248:251], v[140:143], v[40:43]
    v_add_f32 v174, v174, v190
    v_mfma_f32_16x16x32_bf16 v[44:47], a[252:255], v[140:143], v[44:47]
    v_add_f32 v175, v175, v191
    v_pk_add_f32 v[160:161], v[160:161], v[192:193]
    v_pk_add_f32 v[162:163], v[162:163], v[194:195]
    v_pk_add_f32 v[164:165], v[164:165], v[196:197]
    v_pk_add_f32 v[166:167], v[166:167], v[198:199]
    v_pk_add_f32 v[168:169], v[168:169], v[200:201]
    v_pk_add_f32 v[170:171], v[170:171], v[202:203]
    v_pk_add_f32 v[172:173], v[172:173], v[204:205]
    v_pk_add_f32 v[174:175], v[174:175], v[206:207]
    buffer_store_dwordx4 v[96:99], v23, s[24:27], s83 offen sc1
    s_add_u32 s57, s57, 31744
    buffer_load_dwordx4 v12, s[20:23], s57 offen offset:3072 lds
    v_pk_add_f32 v[32:33], v[32:33], v[160:161]
    v_pk_add_f32 v[34:35], v[34:35], v[162:163]
    v_pk_add_f32 v[36:37], v[36:37], v[164:165]
    v_pk_add_f32 v[38:39], v[38:39], v[166:167]
    v_pk_mul_f32 v[48:49], v[32:33], v[32:33]
    v_pk_mul_f32 v[50:51], v[34:35], v[34:35]
    v_pk_mul_f32 v[52:53], v[36:37], v[36:37]
    v_pk_mul_f32 v[54:55], v[38:39], v[38:39]
    s_add_u32 m0, s52, 131072
    s_lshl_b32 s57, s77, 7
    s_add_u32 s57, s57, 131072
    buffer_load_dwordx4 v12, s[20:23], s57 offen offset:0 lds
    v_pk_fma_f32 v[48:49], v[48:49], v[236:237], v[236:237] op_sel:[0,0,1] op_sel_hi:[1,0,1]
    v_pk_fma_f32 v[50:51], v[50:51], v[236:237], v[236:237] op_sel:[0,0,1] op_sel_hi:[1,0,1]
    v_pk_fma_f32 v[52:53], v[52:53], v[236:237], v[236:237] op_sel:[0,0,1] op_sel_hi:[1,0,1]
    v_pk_fma_f32 v[54:55], v[54:55], v[236:237], v[236:237] op_sel:[0,0,1] op_sel_hi:[1,0,1]
    v_pk_mul_f32 v[48:49], v[48:49], v[32:33]
    v_pk_mul_f32 v[50:51], v[50:51], v[34:35]
    v_pk_mul_f32 v[52:53], v[52:53], v[36:37]
    v_pk_mul_f32 v[54:55], v[54:55], v[38:39]
    s_add_u32 s57, s57, 31744
    buffer_load_dwordx4 v12, s[20:23], s57 offen offset:1024 lds
    s_waitcnt vmcnt(11)
    ds_read_b64_tr_b16 a[0:1], v6 offset:32768
    ds_read_b64_tr_b16 a[2:3], v6 offset:34816
    ds_read_b64_tr_b16 a[4:5], v7 offset:32768
    ds_read_b64_tr_b16 a[6:7], v7 offset:34816
    v_exp_f32 v48, v48
    v_exp_f32 v49, v49
    v_exp_f32 v50, v50
    v_exp_f32 v51, v51
    ds_read_b64_tr_b16 a[8:9], v6 offset:33024
    ds_read_b64_tr_b16 a[10:11], v6 offset:35072
    ds_read_b64_tr_b16 a[12:13], v7 offset:33024
    ds_read_b64_tr_b16 a[14:15], v7 offset:35072
    s_add_u32 s57, s57, 31744
    buffer_load_dwordx4 v12, s[20:23], s57 offen offset:2048 lds
    v_exp_f32 v52, v52
    v_exp_f32 v53, v53
    v_exp_f32 v54, v54
    v_exp_f32 v55, v55
    v_pk_add_f32 v[48:49], v[48:49], 1.0 op_sel_hi:[1,0]
    v_pk_add_f32 v[50:51], v[50:51], 1.0 op_sel_hi:[1,0]
    v_pk_add_f32 v[52:53], v[52:53], 1.0 op_sel_hi:[1,0]
    v_pk_add_f32 v[54:55], v[54:55], 1.0 op_sel_hi:[1,0]
    s_add_u32 s57, s57, 31744
    buffer_load_dwordx4 v12, s[20:23], s57 offen offset:3072 lds
    v_rcp_f32 v48, v48
    v_rcp_f32 v49, v49
    v_rcp_f32 v50, v50
    v_rcp_f32 v51, v51
    v_rcp_f32 v52, v52
    v_rcp_f32 v53, v53
    v_rcp_f32 v54, v54
    v_rcp_f32 v55, v55
    v_pk_mul_f32 v[48:49], v[48:49], v[32:33]
    v_pk_mul_f32 v[50:51], v[50:51], v[34:35]
    v_pk_mul_f32 v[52:53], v[52:53], v[36:37]
    v_pk_mul_f32 v[54:55], v[54:55], v[38:39]
    s_add_u32 m0, s52, 147456
    s_lshl_b32 s57, s78, 7
    buffer_load_dwordx4 v12, s[20:23], s57 offen offset:0 lds
    v_cvt_pk_bf16_f32 v56, v48, v49
    v_cvt_pk_bf16_f32 v57, v50, v51
    v_cvt_pk_bf16_f32 v58, v52, v53
    v_cvt_pk_bf16_f32 v59, v54, v55
    buffer_store_dwordx4 v[56:59], v23, s[24:27], s67 offen offset:0 sc1
    v_pk_add_f32 v[40:41], v[40:41], v[168:169]
    v_pk_add_f32 v[42:43], v[42:43], v[170:171]
    v_pk_add_f32 v[44:45], v[44:45], v[172:173]
    v_pk_add_f32 v[46:47], v[46:47], v[174:175]
    s_add_u32 s57, s57, 31744
    buffer_load_dwordx4 v12, s[20:23], s57 offen offset:1024 lds
    s_waitcnt vmcnt(12)
    ds_read_b64_tr_b16 a[16:17], v6 offset:49152
    ds_read_b64_tr_b16 a[18:19], v6 offset:51200
    ds_read_b64_tr_b16 a[20:21], v7 offset:49152
    ds_read_b64_tr_b16 a[22:23], v7 offset:51200
    v_pk_mul_f32 v[48:49], v[40:41], v[40:41]
    v_pk_mul_f32 v[50:51], v[42:43], v[42:43]
    v_pk_mul_f32 v[52:53], v[44:45], v[44:45]
    v_pk_mul_f32 v[54:55], v[46:47], v[46:47]
    ds_read_b64_tr_b16 a[24:25], v6 offset:49408
    ds_read_b64_tr_b16 a[26:27], v6 offset:51456
    ds_read_b64_tr_b16 a[28:29], v7 offset:49408
    ds_read_b64_tr_b16 a[30:31], v7 offset:51456
    s_add_u32 s57, s57, 31744
    buffer_load_dwordx4 v12, s[20:23], s57 offen offset:2048 lds
    v_pk_fma_f32 v[48:49], v[48:49], v[236:237], v[236:237] op_sel:[0,0,1] op_sel_hi:[1,0,1]
    v_pk_fma_f32 v[50:51], v[50:51], v[236:237], v[236:237] op_sel:[0,0,1] op_sel_hi:[1,0,1]
    v_pk_fma_f32 v[52:53], v[52:53], v[236:237], v[236:237] op_sel:[0,0,1] op_sel_hi:[1,0,1]
    v_pk_fma_f32 v[54:55], v[54:55], v[236:237], v[236:237] op_sel:[0,0,1] op_sel_hi:[1,0,1]
    v_pk_mul_f32 v[48:49], v[48:49], v[40:41]
    v_pk_mul_f32 v[50:51], v[50:51], v[42:43]
    v_pk_mul_f32 v[52:53], v[52:53], v[44:45]
    v_pk_mul_f32 v[54:55], v[54:55], v[46:47]
    s_add_u32 s57, s57, 31744
    buffer_load_dwordx4 v12, s[20:23], s57 offen offset:3072 lds
    v_exp_f32 v48, v48
    v_exp_f32 v49, v49
    v_exp_f32 v50, v50
    v_exp_f32 v51, v51
    v_exp_f32 v52, v52
    v_exp_f32 v53, v53
    v_exp_f32 v54, v54
    v_exp_f32 v55, v55
    v_pk_add_f32 v[48:49], v[48:49], 1.0 op_sel_hi:[1,0]
    v_pk_add_f32 v[50:51], v[50:51], 1.0 op_sel_hi:[1,0]
    v_pk_add_f32 v[52:53], v[52:53], 1.0 op_sel_hi:[1,0]
    v_pk_add_f32 v[54:55], v[54:55], 1.0 op_sel_hi:[1,0]
    s_add_u32 m0, s52, 49152
    s_lshl_b32 s57, s78, 7
    s_add_u32 s57, s57, 131072
    buffer_load_dwordx4 v12, s[20:23], s57 offen offset:0 lds
    v_rcp_f32 v48, v48
    v_rcp_f32 v49, v49
    v_rcp_f32 v50, v50
    v_rcp_f32 v51, v51
    v_rcp_f32 v52, v52
    v_rcp_f32 v53, v53
    v_rcp_f32 v54, v54
    v_rcp_f32 v55, v55
    s_add_u32 s57, s57, 31744
    buffer_load_dwordx4 v12, s[20:23], s57 offen offset:1024 lds
    s_waitcnt vmcnt(11)
    ds_read_b64_tr_b16 a[32:33], v8 offset:0
    ds_read_b64_tr_b16 a[34:35], v8 offset:2048
    ds_read_b64_tr_b16 a[36:37], v9 offset:0
    ds_read_b64_tr_b16 a[38:39], v9 offset:2048
    v_pk_mul_f32 v[48:49], v[48:49], v[40:41]
    v_pk_mul_f32 v[50:51], v[50:51], v[42:43]
    v_pk_mul_f32 v[52:53], v[52:53], v[44:45]
    v_pk_mul_f32 v[54:55], v[54:55], v[46:47]
    ds_read_b64_tr_b16 a[40:41], v8 offset:256
    ds_read_b64_tr_b16 a[42:43], v8 offset:2304
    ds_read_b64_tr_b16 a[44:45], v9 offset:256
    ds_read_b64_tr_b16 a[46:47], v9 offset:2304
    s_add_u32 s57, s57, 31744
    buffer_load_dwordx4 v12, s[20:23], s57 offen offset:2048 lds
    v_cvt_pk_bf16_f32 v60, v48, v49
    v_cvt_pk_bf16_f32 v61, v50, v51
    v_cvt_pk_bf16_f32 v62, v52, v53
    v_cvt_pk_bf16_f32 v63, v54, v55
    buffer_store_dwordx4 v[60:63], v23, s[24:27], s67 offen offset:1024 sc1
    s_add_u32 s57, s57, 31744
    buffer_load_dwordx4 v12, s[20:23], s57 offen offset:3072 lds
    s_add_u32 m0, s52, 65536
    s_lshl_b32 s57, s79, 7
    buffer_load_dwordx4 v12, s[20:23], s57 offen offset:0 lds
    s_add_u32 s57, s57, 31744
    buffer_load_dwordx4 v12, s[20:23], s57 offen offset:1024 lds
    s_waitcnt vmcnt(12)
    ds_read_b64_tr_b16 a[48:49], v8 offset:16384
    ds_read_b64_tr_b16 a[50:51], v8 offset:18432
    ds_read_b64_tr_b16 a[52:53], v9 offset:16384
    ds_read_b64_tr_b16 a[54:55], v9 offset:18432
    s_add_u32 s57, s57, 31744
    buffer_load_dwordx4 v12, s[20:23], s57 offen offset:2048 lds
    ds_read_b64_tr_b16 a[56:57], v8 offset:16640
    ds_read_b64_tr_b16 a[58:59], v8 offset:18688
    ds_read_b64_tr_b16 a[60:61], v9 offset:16640
    ds_read_b64_tr_b16 a[62:63], v9 offset:18688
    s_add_u32 s57, s57, 31744
    buffer_load_dwordx4 v12, s[20:23], s57 offen offset:3072 lds
    s_waitcnt lgkmcnt(15)
    s_add_u32 m0, s52, 81920
    s_lshl_b32 s57, s79, 7
    s_add_u32 s57, s57, 131072
    buffer_load_dwordx4 v12, s[20:23], s57 offen offset:0 lds
    s_add_u32 s57, s57, 31744
    buffer_load_dwordx4 v12, s[20:23], s57 offen offset:1024 lds
    s_waitcnt vmcnt(11)
    ds_read_b64_tr_b16 a[64:65], v8 offset:32768
    ds_read_b64_tr_b16 a[66:67], v8 offset:34816
    ds_read_b64_tr_b16 a[68:69], v9 offset:32768
    ds_read_b64_tr_b16 a[70:71], v9 offset:34816
    s_add_u32 s57, s57, 31744
    buffer_load_dwordx4 v12, s[20:23], s57 offen offset:2048 lds
    ds_read_b64_tr_b16 a[72:73], v8 offset:33024
    ds_read_b64_tr_b16 a[74:75], v8 offset:35072
    ds_read_b64_tr_b16 a[76:77], v9 offset:33024
    ds_read_b64_tr_b16 a[78:79], v9 offset:35072
    s_add_u32 s57, s57, 31744
    buffer_load_dwordx4 v12, s[20:23], s57 offen offset:3072 lds
    s_add_u32 m0, s52, 98304
    s_lshl_b32 s57, s80, 7
    buffer_load_dwordx4 v12, s[20:23], s57 offen offset:0 lds
    s_waitcnt vmcnt(10)
    s_barrier
    s_cmp_lg_u32 s44, 0
    s_cbranch_scc1 L_nopub6
    s_lshl_b32 s60, s51, 5
    s_add_u32 s60, s60, s50
    s_lshl_b32 s60, s60, 7
    s_add_u32 s60, s60, 12713984
    v_mov_b32 v30, s47
    s_mov_b64 exec, 1
    buffer_store_dword v30, off, s[24:27], s60 sc1
    s_mov_b64 exec, -1
L_nopub6:
L_p3join:
    v_lshlrev_b32 v228, 16, v228
    v_lshlrev_b32 v32, 16, v216
    v_and_b32 v33, s61, v216
    v_lshlrev_b32 v34, 16, v217
    s_add_u32 s57, s57, 31744
    buffer_load_dwordx4 v12, s[20:23], s57 offen offset:1024 lds
    s_waitcnt vmcnt(10)
    ds_read_b64_tr_b16 a[80:81], v6 offset:0
    ds_read_b64_tr_b16 a[82:83], v6 offset:2048
    ds_read_b64_tr_b16 a[84:85], v7 offset:0
    ds_read_b64_tr_b16 a[86:87], v7 offset:2048
    s_add_u32 s57, s57, 31744
    buffer_load_dwordx4 v12, s[20:23], s57 offen offset:2048 lds
    ds_read_b64_tr_b16 a[88:89], v6 offset:256
    ds_read_b64_tr_b16 a[90:91], v6 offset:2304
    ds_read_b64_tr_b16 a[92:93], v7 offset:256
    ds_read_b64_tr_b16 a[94:95], v7 offset:2304
    s_add_u32 s57, s57, 31744
    buffer_load_dwordx4 v12, s[20:23], s57 offen offset:3072 lds
    v_and_b32 v35, s61, v217
    v_add_f32 v32, v32, v228
    v_add_f32 v33, v33, v228
    v_add_f32 v34, v34, v228
    v_add_f32 v35, v35, v228
    v_lshlrev_b32 v48, 16, v218
    v_and_b32 v49, s61, v218
    v_lshlrev_b32 v50, 16, v219
    s_waitcnt lgkmcnt(15)
    s_add_u32 m0, s52, 114688
    s_lshl_b32 s57, s80, 7
    s_add_u32 s57, s57, 131072
    buffer_load_dwordx4 v12, s[20:23], s57 offen offset:0 lds
    v_and_b32 v51, s61, v219
    v_add_f32 v48, v48, v228
    v_add_f32 v49, v49, v228
    v_add_f32 v50, v50, v228
    s_add_u32 s57, s57, 31744
    buffer_load_dwordx4 v12, s[20:23], s57 offen offset:1024 lds
    s_waitcnt vmcnt(10)
    ds_read_b64_tr_b16 a[96:97], v6 offset:16384
    ds_read_b64_tr_b16 a[98:99], v6 offset:18432
    ds_read_b64_tr_b16 a[100:101], v7 offset:16384
    ds_read_b64_tr_b16 a[102:103], v7 offset:18432
    s_add_u32 s57, s57, 31744
    buffer_load_dwordx4 v12, s[20:23], s57 offen offset:2048 lds
    ds_read_b64_tr_b16 a[104:105], v6 offset:16640
    ds_read_b64_tr_b16 a[106:107], v6 offset:18688
    ds_read_b64_tr_b16 a[108:109], v7 offset:16640
    ds_read_b64_tr_b16 a[110:111], v7 offset:18688
    v_add_f32 v51, v51, v228
    v_lshlrev_b32 v64, 16, v220
    v_and_b32 v65, s61, v220
    v_lshlrev_b32 v66, 16, v221
    s_add_u32 s57, s57, 31744
    buffer_load_dwordx4 v12, s[20:23], s57 offen offset:3072 lds
    v_and_b32 v67, s61, v221
    v_add_f32 v64, v64, v228
    v_add_f32 v65, v65, v228
    v_add_f32 v66, v66, v228
    s_add_u32 m0, s52, 131072
    s_lshl_b32 s57, s81, 7
    buffer_load_dwordx4 v12, s[20:23], s57 offen offset:0 lds
    v_add_f32 v67, v67, v228
    v_lshlrev_b32 v80, 16, v222
    v_and_b32 v81, s61, v222
    v_lshlrev_b32 v82, 16, v223
    s_add_u32 s57, s57, 31744
    buffer_load_dwordx4 v12, s[20:23], s57 offen offset:1024 lds
    s_waitcnt vmcnt(10)
    ds_read_b64_tr_b16 a[112:113], v6 offset:32768
    ds_read_b64_tr_b16 a[114:115], v6 offset:34816
    ds_read_b64_tr_b16 a[116:117], v7 offset:32768
    ds_read_b64_tr_b16 a[118:119], v7 offset:34816
    v_and_b32 v83, s61, v223
    v_add_f32 v80, v80, v228
    v_add_f32 v81, v81, v228
    v_add_f32 v82, v82, v228
    ds_read_b64_tr_b16 a[120:121], v6 offset:33024
    ds_read_b64_tr_b16 a[122:123], v6 offset:35072
    ds_read_b64_tr_b16 a[124:125], v7 offset:33024
    ds_read_b64_tr_b16 a[126:127], v7 offset:35072
    s_add_u32 s57, s57, 31744
    buffer_load_dwordx4 v12, s[20:23], s57 offen offset:2048 lds
    v_add_f32 v83, v83, v228
    v_lshlrev_b32 v96, 16, v224
    v_and_b32 v97, s61, v224
    v_lshlrev_b32 v98, 16, v225
    s_add_u32 s57, s57, 31744
    buffer_load_dwordx4 v12, s[20:23], s57 offen offset:3072 lds
    v_and_b32 v99, s61, v225
    v_add_f32 v96, v96, v228
    v_add_f32 v97, v97, v228
    v_add_f32 v98, v98, v228
    s_waitcnt lgkmcnt(15)
    s_add_u32 m0, s52, 147456
    s_lshl_b32 s57, s81, 7
    s_add_u32 s57, s57, 131072
    buffer_load_dwordx4 v12, s[20:23], s57 offen offset:0 lds
    v_add_f32 v99, v99, v228
    s_add_u32 s57, s57, 31744
    buffer_load_dwordx4 v12, s[20:23], s57 offen offset:1024 lds
    s_waitcnt vmcnt(10)
    ds_read_b64_tr_b16 a[128:129], v6 offset:49152
    ds_read_b64_tr_b16 a[130:131], v6 offset:51200
    ds_read_b64_tr_b16 a[132:133], v7 offset:49152
    ds_read_b64_tr_b16 a[134:135], v7 offset:51200
    s_add_u32 s57, s57, 31744
    buffer_load_dwordx4 v12, s[20:23], s57 offen offset:2048 lds
    ds_read_b64_tr_b16 a[136:137], v6 offset:49408
    ds_read_b64_tr_b16 a[138:139], v6 offset:51456
    ds_read_b64_tr_b16 a[140:141], v7 offset:49408
    ds_read_b64_tr_b16 a[142:143], v7 offset:51456
    s_add_u32 s57, s57, 31744
    buffer_load_dwordx4 v12, s[20:23], s57 offen offset:3072 lds
    s_add_u32 m0, s52, 49152
    s_lshl_b32 s57, s82, 7
    buffer_load_dwordx4 v12, s[20:23], s57 offen offset:0 lds
    s_add_u32 s57, s57, 31744
    buffer_load_dwordx4 v12, s[20:23], s57 offen offset:1024 lds
    s_waitcnt vmcnt(10)
    ds_read_b64_tr_b16 a[144:145], v8 offset:0
    ds_read_b64_tr_b16 a[146:147], v8 offset:2048
    ds_read_b64_tr_b16 a[148:149], v9 offset:0
    ds_read_b64_tr_b16 a[150:151], v9 offset:2048
    s_add_u32 s57, s57, 31744
    buffer_load_dwordx4 v12, s[20:23], s57 offen offset:2048 lds
    ds_read_b64_tr_b16 a[152:153], v8 offset:256
    ds_read_b64_tr_b16 a[154:155], v8 offset:2304
    ds_read_b64_tr_b16 a[156:157], v9 offset:256
    ds_read_b64_tr_b16 a[158:159], v9 offset:2304
    s_add_u32 s57, s57, 31744
    buffer_load_dwordx4 v12, s[20:23], s57 offen offset:3072 lds
    s_waitcnt lgkmcnt(15)
    s_add_u32 m0, s52, 65536
    s_lshl_b32 s57, s82, 7
    s_add_u32 s57, s57, 131072
    buffer_load_dwordx4 v12, s[20:23], s57 offen offset:0 lds
    s_add_u32 s57, s57, 31744
    buffer_load_dwordx4 v12, s[20:23], s57 offen offset:1024 lds
    s_waitcnt vmcnt(10)
    ds_read_b64_tr_b16 a[160:161], v8 offset:16384
    ds_read_b64_tr_b16 a[162:163], v8 offset:18432
    ds_read_b64_tr_b16 a[164:165], v9 offset:16384
    ds_read_b64_tr_b16 a[166:167], v9 offset:18432
    s_add_u32 s57, s57, 31744
    buffer_load_dwordx4 v12, s[20:23], s57 offen offset:2048 lds
    ds_read_b64_tr_b16 a[168:169], v8 offset:16640
    ds_read_b64_tr_b16 a[170:171], v8 offset:18688
    ds_read_b64_tr_b16 a[172:173], v9 offset:16640
    ds_read_b64_tr_b16 a[174:175], v9 offset:18688
    s_add_u32 s57, s57, 31744
    buffer_load_dwordx4 v12, s[20:23], s57 offen offset:3072 lds
    s_add_u32 m0, s52, 81920
    s_mov_b32 s57, s75
    buffer_load_dwordx4 v15, s[12:15], s57 offen offset:0 lds
    s_add_u32 s57, s57, 113664
    buffer_load_dwordx4 v15, s[12:15], s57 offen offset:1024 lds
    s_waitcnt vmcnt(10)
    ds_read_b64_tr_b16 a[176:177], v8 offset:32768
    ds_read_b64_tr_b16 a[178:179], v8 offset:34816
    ds_read_b64_tr_b16 a[180:181], v9 offset:32768
    ds_read_b64_tr_b16 a[182:183], v9 offset:34816
    s_add_u32 s57, s57, 113664
    buffer_load_dwordx4 v15, s[12:15], s57 offen offset:2048 lds
    ds_read_b64_tr_b16 a[184:185], v8 offset:33024
    ds_read_b64_tr_b16 a[186:187], v8 offset:35072
    ds_read_b64_tr_b16 a[188:189], v9 offset:33024
    ds_read_b64_tr_b16 a[190:191], v9 offset:35072
    s_add_u32 s57, s57, 113664
    buffer_load_dwordx4 v15, s[12:15], s57 offen offset:3072 lds
    s_waitcnt lgkmcnt(15)
    s_add_u32 m0, s52, 98304
    s_mov_b32 s57, 0
    buffer_load_dwordx4 v13, s[12:15], s57 offen offset:0 lds
    s_add_u32 s57, s57, 6144
    buffer_load_dwordx4 v14, s[12:15], s57 offen offset:1024 lds
    s_waitcnt vmcnt(10)
    ds_read_b64_tr_b16 a[192:193], v6 offset:0
    ds_read_b64_tr_b16 a[194:195], v6 offset:2048
    ds_read_b64_tr_b16 a[196:197], v7 offset:0
    ds_read_b64_tr_b16 a[198:199], v7 offset:2048
    s_add_u32 s57, s57, 6144
    buffer_load_dwordx4 v13, s[12:15], s57 offen offset:2048 lds
    ds_read_b64_tr_b16 a[200:201], v6 offset:256
    ds_read_b64_tr_b16 a[202:203], v6 offset:2304
    ds_read_b64_tr_b16 a[204:205], v7 offset:256
    ds_read_b64_tr_b16 a[206:207], v7 offset:2304
    s_add_u32 s57, s57, 6144
    buffer_load_dwordx4 v14, s[12:15], s57 offen offset:3072 lds
    buffer_load_dword v17, v20, s[24:27], 0 offen sc1
    s_add_u32 m0, s52, 114688
    s_mov_b32 s57, 114688
    buffer_load_dwordx4 v13, s[12:15], s57 offen offset:0 lds
    s_waitcnt vmcnt(10)
    ds_read_b64_tr_b16 a[208:209], v6 offset:16384
    ds_read_b64_tr_b16 a[210:211], v6 offset:18432
    ds_read_b64_tr_b16 a[212:213], v7 offset:16384
    ds_read_b64_tr_b16 a[214:215], v7 offset:18432
    s_add_u32 s57, s57, 6144
    buffer_load_dwordx4 v14, s[12:15], s57 offen offset:1024 lds
    ds_read_b64_tr_b16 a[216:217], v6 offset:16640
    ds_read_b64_tr_b16 a[218:219], v6 offset:18688
    ds_read_b64_tr_b16 a[220:221], v7 offset:16640
    ds_read_b64_tr_b16 a[222:223], v7 offset:18688
    s_add_u32 s57, s57, 6144
    buffer_load_dwordx4 v13, s[12:15], s57 offen offset:2048 lds
    s_add_u32 s57, s57, 6144
    buffer_load_dwordx4 v14, s[12:15], s57 offen offset:3072 lds
    s_waitcnt lgkmcnt(15)
    s_add_u32 m0, s52, 131072
    s_mov_b32 s57, 229376
    buffer_load_dwordx4 v13, s[12:15], s57 offen offset:0 lds
    s_add_u32 s57, s57, 6144
    buffer_load_dwordx4 v14, s[12:15], s57 offen offset:1024 lds
    s_add_u32 s57, s57, 6144
    buffer_load_dwordx4 v13, s[12:15], s57 offen offset:2048 lds
    s_add_u32 s57, s57, 6144
    buffer_load_dwordx4 v14, s[12:15], s57 offen offset:3072 lds
    s_add_u32 m0, s52, 147456
    s_mov_b32 s57, 344064
    buffer_load_dwordx4 v239, s[12:15], s57 offen offset:0 lds
    s_add_u32 s57, s57, 27648
    buffer_load_dwordx4 v239, s[12:15], s57 offen offset:1024 lds
    s_waitcnt vmcnt(10)
    v_cmp_ne_u32 vcc, s47, v17
    s_nop 0
    s_cbranch_vccz L_ok8
    s_mov_b32 s59, 20000
L_spin7:
    buffer_load_dword v17, v20, s[24:27], 0 offen sc1
    s_waitcnt vmcnt(0)
    v_cmp_ne_u32 vcc, s47, v17
    s_nop 0
    s_cbranch_vccz L_ok8
    s_sub_u32 s59, s59, 1
    s_cbranch_scc0 L_spin7
L_ok8:
    s_cmp_ge_u32 s89, 4
    s_cbranch_scc1 L_p3_alt
    s_mov_b32 s66, s68
    s_add_u32 s58, s66, s76
    buffer_load_dwordx4 v[144:147], v23, s[24:27], s58 offen offset:0 sc1
    buffer_load_dwordx4 v[148:151], v23, s[24:27], s58 offen offset:1024 sc1
    s_add_u32 s58, s66, s77
    buffer_load_dwordx4 v[152:155], v23, s[24:27], s58 offen offset:0 sc1
    buffer_load_dwordx4 v[156:159], v23, s[24:27], s58 offen offset:1024 sc1
    s_add_u32 s58, s66, s78
    buffer_load_dwordx4 v[112:115], v23, s[24:27], s58 offen offset:0 sc1
    buffer_load_dwordx4 v[116:119], v23, s[24:27], s58 offen offset:1024 sc1
    s_add_u32 s58, s66, s79
    buffer_load_dwordx4 v[120:123], v23, s[24:27], s58 offen offset:0 sc1
    buffer_load_dwordx4 v[124:127], v23, s[24:27], s58 offen offset:1024 sc1
    s_add_u32 s58, s66, s80
    buffer_load_dwordx4 v[128:131], v23, s[24:27], s58 offen offset:0 sc1
    buffer_load_dwordx4 v[132:135], v23, s[24:27], s58 offen offset:1024 sc1
    s_add_u32 s58, s66, s81
    buffer_load_dwordx4 v[136:139], v23, s[24:27], s58 offen offset:0 sc1
    s_waitcnt vmcnt(10)
    v_mfma_f32_16x16x32_bf16 v[96:99], v[144:147], a[0:3], v[96:99]
    v_mfma_f32_16x16x32_bf16 v[100:103], v[144:147], a[4:7], 0
    buffer_load_dwordx4 v[140:143], v23, s[24:27], s58 offen offset:1024 sc1
    v_mfma_f32_16x16x32_bf16 v[104:107], v[144:147], a[8:11], 0
    v_mfma_f32_16x16x32_bf16 v[108:111], v[144:147], a[12:15], 0
    s_waitcnt vmcnt(10)
    v_mfma_f32_16x16x32_bf16 v[96:99], v[148:151], a[16:19], v[96:99]
    s_add_u32 s58, s66, s82
    v_mfma_f32_16x16x32_bf16 v[100:103], v[148:151], a[20:23], v[100:103]
    buffer_load_dwordx4 v[144:147], v23, s[24:27], s58 offen offset:0 sc1
    v_mfma_f32_16x16x32_bf16 v[104:107], v[148:151], a[24:27], v[104:107]
    v_mfma_f32_16x16x32_bf16 v[108:111], v[148:151], a[28:31], v[108:111]
    s_waitcnt vmcnt(10)
    v_mfma_f32_16x16x32_bf16 v[96:99], v[152:155], a[32:35], v[96:99]
    v_mfma_f32_16x16x32_bf16 v[100:103], v[152:155], a[36:39], v[100:103]
    buffer_load_dwordx4 v[148:151], v23, s[24:27], s58 offen offset:1024 sc1
    v_mfma_f32_16x16x32_bf16 v[104:107], v[152:155], a[40:43], v[104:107]
    v_mfma_f32_16x16x32_bf16 v[108:111], v[152:155], a[44:47], v[108:111]
    s_waitcnt vmcnt(10)
    v_mfma_f32_16x16x32_bf16 v[96:99], v[156:159], a[48:51], v[96:99]
    s_add_u32 s66, s69, 175872
    s_add_u32 s58, s66, s76
    v_mfma_f32_16x16x32_bf16 v[100:103], v[156:159], a[52:55], v[100:103]
    buffer_load_dwordx4 v[152:155], v23, s[24:27], s58 offen offset:0 sc1
    v_mfma_f32_16x16x32_bf16 v[104:107], v[156:159], a[56:59], v[104:107]
    v_mfma_f32_16x16x32_bf16 v[108:111], v[156:159], a[60:63], v[108:111]
    s_waitcnt vmcnt(10)
    v_mfma_f32_16x16x32_bf16 v[96:99], v[112:115], a[64:67], v[96:99]
    v_mfma_f32_16x16x32_bf16 v[100:103], v[112:115], a[68:71], v[100:103]
    buffer_load_dwordx4 v[156:159], v23, s[24:27], s58 offen offset:1024 sc1
    v_mfma_f32_16x16x32_bf16 v[104:107], v[112:115], a[72:75], v[104:107]
    v_mfma_f32_16x16x32_bf16 v[108:111], v[112:115], a[76:79], v[108:111]
    s_waitcnt vmcnt(10)
    v_mfma_f32_16x16x32_bf16 v[96:99], v[116:119], a[80:83], v[96:99]
    s_add_u32 s58, s66, s77
    v_mfma_f32_16x16x32_bf16 v[100:103], v[116:119], a[84:87], v[100:103]
    buffer_load_dwordx4 v[112:115], v23, s[24:27], s58 offen offset:0 sc1
    v_mfma_f32_16x16x32_bf16 v[104:107], v[116:119], a[88:91], v[104:107]
    v_mfma_f32_16x16x32_bf16 v[108:111], v[116:119], a[92:95], v[108:111]
    s_waitcnt vmcnt(10)
    v_mfma_f32_16x16x32_bf16 v[96:99], v[120:123], a[96:99], v[96:99]
    v_mfma_f32_16x16x32_bf16 v[100:103], v[120:123], a[100:103], v[100:103]
    buffer_load_dwordx4 v[116:119], v23, s[24:27], s58 offen offset:1024 sc1
    v_mfma_f32_16x16x32_bf16 v[104:107], v[120:123], a[104:107], v[104:107]
    v_mfma_f32_16x16x32_bf16 v[108:111], v[120:123], a[108:111], v[108:111]
    s_waitcnt vmcnt(10)
    v_mfma_f32_16x16x32_bf16 v[96:99], v[124:127], a[112:115], v[96:99]
    s_add_u32 s58, s66, s78
    v_mfma_f32_16x16x32_bf16 v[100:103], v[124:127], a[116:119], v[100:103]
    buffer_load_dwordx4 v[120:123], v23, s[24:27], s58 offen offset:0 sc1
    v_mfma_f32_16x16x32_bf16 v[104:107], v[124:127], a[120:123], v[104:107]
    v_mfma_f32_16x16x32_bf16 v[108:111], v[124:127], a[124:127], v[108:111]
    s_waitcnt vmcnt(10)
    v_mfma_f32_16x16x32_bf16 v[96:99], v[128:131], a[128:131], v[96:99]
    v_mfma_f32_16x16x32_bf16 v[100:103], v[128:131], a[132:135], v[100:103]
    buffer_load_dwordx4 v[124:127], v23, s[24:27], s58 offen offset:1024 sc1
    v_mfma_f32_16x16x32_bf16 v[104:107], v[128:131], a[136:139], v[104:107]
    v_mfma_f32_16x16x32_bf16 v[108:111], v[128:131], a[140:143], v[108:111]
    s_waitcnt vmcnt(10)
    v_mfma_f32_16x16x32_bf16 v[96:99], v[132:135], a[144:147], v[96:99]
    s_add_u32 s58, s66, s79
    v_mfma_f32_16x16x32_bf16 v[100:103], v[132:135], a[148:151], v[100:103]
    buffer_load_dwordx4 v[128:131], v23, s[24:27], s58 offen offset:0 sc1
    v_mfma_f32_16x16x32_bf16 v[104:107], v[132:135], a[152:155], v[104:107]
    v_mfma_f32_16x16x32_bf16 v[108:111], v[132:135], a[156:159], v[108:111]
    s_waitcnt vmcnt(10)
    v_mfma_f32_16x16x32_bf16 v[96:99], v[136:139], a[160:163], v[96:99]
    v_mfma_f32_16x16x32_bf16 v[100:103], v[136:139], a[164:167], v[100:103]
    buffer_load_dwordx4 v[132:135], v23, s[24:27], s58 offen offset:1024 sc1
    v_mfma_f32_16x16x32_bf16 v[104:107], v[136:139], a[168:171], v[104:107]
    v_mfma_f32_16x16x32_bf16 v[108:111], v[136:139], a[172:175], v[108:111]
    s_waitcnt vmcnt(10)
    v_mfma_f32_16x16x32_bf16 v[96:99], v[140:143], a[176:179], v[96:99]
    s_add_u32 s58, s66, s80
    v_mfma_f32_16x16x32_bf16 v[100:103], v[140:143], a[180:183], v[100:103]
    buffer_load_dwordx4 v[136:139], v23, s[24:27], s58 offen offset:0 sc1
    v_mfma_f32_16x16x32_bf16 v[104:107], v[140:143], a[184:187], v[104:107]
    v_mfma_f32_16x16x32_bf16 v[108:111], v[140:143], a[188:191], v[108:111]
    s_waitcnt vmcnt(10)
    s_waitcnt lgkmcnt(8)
    v_mfma_f32_16x16x32_bf16 v[96:99], v[144:147], a[192:195], v[96:99]
    v_mfma_f32_16x16x32_bf16 v[100:103], v[144:147], a[196:199], v[100:103]
    buffer_load_dwordx4 v[140:143], v23, s[24:27], s58 offen offset:1024 sc1
    v_mfma_f32_16x16x32_bf16 v[104:107], v[144:147], a[200:203], v[104:107]
    v_mfma_f32_16x16x32_bf16 v[108:111], v[144:147], a[204:207], v[108:111]
    s_waitcnt vmcnt(10)
    s_waitcnt lgkmcnt(0)
    v_mfma_f32_16x16x32_bf16 v[96:99], v[148:151], a[208:211], v[96:99]
    s_add_u32 s58, s66, s81
    v_mfma_f32_16x16x32_bf16 v[100:103], v[148:151], a[212:215], v[100:103]
    buffer_load_dwordx4 v[144:147], v23, s[24:27], s58 offen offset:0 sc1
    v_mfma_f32_16x16x32_bf16 v[104:107], v[148:151], a[216:219], v[104:107]
    v_mfma_f32_16x16x32_bf16 v[108:111], v[148:151], a[220:223], v[108:111]
L_p3_join:
    s_waitcnt vmcnt(10)
    v_mfma_f32_16x16x32_bf16 v[80:83], v[152:155], a[0:3], v[80:83]
    v_mfma_f32_16x16x32_bf16 v[84:87], v[152:155], a[4:7], 0
    buffer_load_dwordx4 v[148:151], v23, s[24:27], s58 offen offset:1024 sc1
    v_mfma_f32_16x16x32_bf16 v[88:91], v[152:155], a[8:11], 0
    v_mfma_f32_16x16x32_bf16 v[92:95], v[152:155], a[12:15], 0
    s_waitcnt vmcnt(10)
    v_mfma_f32_16x16x32_bf16 v[80:83], v[156:159], a[16:19], v[80:83]
    s_add_u32 s58, s66, s82
    v_mfma_f32_16x16x32_bf16 v[84:87], v[156:159], a[20:23], v[84:87]
    buffer_load_dwordx4 v[152:155], v23, s[24:27], s58 offen offset:0 sc1
    v_mfma_f32_16x16x32_bf16 v[88:91], v[156:159], a[24:27], v[88:91]
    ds_write_b128 v232, v[100:103] offset:3072
    v_mfma_f32_16x16x32_bf16 v[92:95], v[156:159], a[28:31], v[92:95]
    s_waitcnt vmcnt(10)
    v_mfma_f32_16x16x32_bf16 v[80:83], v[112:115], a[32:35], v[80:83]
    v_mfma_f32_16x16x32_bf16 v[84:87], v[112:115], a[36:39], v[84:87]
    buffer_load_dwordx4 v[156:159], v23, s[24:27], s58 offen offset:1024 sc1
    v_mfma_f32_16x16x32_bf16 v[88:91], v[112:115], a[40:43], v[88:91]
    ds_write_b128 v232, v[104:107] offset:19456
    v_mfma_f32_16x16x32_bf16 v[92:95], v[112:115], a[44:47], v[92:95]
    s_waitcnt vmcnt(10)
    v_mfma_f32_16x16x32_bf16 v[80:83], v[116:119], a[48:51], v[80:83]
    s_add_u32 s66, s69, 117248
    s_add_u32 s58, s66, s76
    v_mfma_f32_16x16x32_bf16 v[84:87], v[116:119], a[52:55], v[84:87]
    buffer_load_dwordx4 v[112:115], v23, s[24:27], s58 offen offset:0 sc1
    v_mfma_f32_16x16x32_bf16 v[88:91], v[116:119], a[56:59], v[88:91]
    ds_write_b128 v232, v[108:111] offset:35840
    v_mfma_f32_16x16x32_bf16 v[92:95], v[116:119], a[60:63], v[92:95]
    s_waitcnt vmcnt(10)
    v_mfma_f32_16x16x32_bf16 v[80:83], v[120:123], a[64:67], v[80:83]
    v_mfma_f32_16x16x32_bf16 v[84:87], v[120:123], a[68:71], v[84:87]
    buffer_load_dwordx4 v[116:119], v23, s[24:27], s58 offen offset:1024 sc1
    v_mfma_f32_16x16x32_bf16 v[88:91], v[120:123], a[72:75], v[88:91]
    v_mfma_f32_16x16x32_bf16 v[92:95], v[120:123], a[76:79], v[92:95]
    s_waitcnt vmcnt(10)
    v_mfma_f32_16x16x32_bf16 v[80:83], v[124:127], a[80:83], v[80:83]
    s_add_u32 s58, s66, s77
    v_mfma_f32_16x16x32_bf16 v[84:87], v[124:127], a[84:87], v[84:87]
    buffer_load_dwordx4 v[120:123], v23, s[24:27], s58 offen offset:0 sc1
    v_mfma_f32_16x16x32_bf16 v[88:91], v[124:127], a[88:91], v[88:91]
    s_waitcnt lgkmcnt(0)
    s_barrier
    v_mfma_f32_16x16x32_bf16 v[92:95], v[124:127], a[92:95], v[92:95]
    s_waitcnt vmcnt(10)
    v_mfma_f32_16x16x32_bf16 v[80:83], v[128:131], a[96:99], v[80:83]
    v_mfma_f32_16x16x32_bf16 v[84:87], v[128:131], a[100:103], v[84:87]
    buffer_load_dwordx4 v[124:127], v23, s[24:27], s58 offen offset:1024 sc1
    v_mfma_f32_16x16x32_bf16 v[88:91], v[128:131], a[104:107], v[88:91]
    ds_read_b128 v[100:103], v233 offset:3072
    ds_read_b128 v[104:107], v234 offset:19456
    v_mfma_f32_16x16x32_bf16 v[92:95], v[128:131], a[108:111], v[92:95]
    ds_read_b128 v[108:111], v235 offset:35840
    s_waitcnt vmcnt(10)
    v_mfma_f32_16x16x32_bf16 v[80:83], v[132:135], a[112:115], v[80:83]
    s_add_u32 s58, s66, s78
    v_mfma_f32_16x16x32_bf16 v[84:87], v[132:135], a[116:119], v[84:87]
    buffer_load_dwordx4 v[128:131], v23, s[24:27], s58 offen offset:0 sc1
    v_mfma_f32_16x16x32_bf16 v[88:91], v[132:135], a[120:123], v[88:91]
    ds_read_b64_tr_b16 v[160:161], v16 offset:0
    v_mfma_f32_16x16x32_bf16 v[92:95], v[132:135], a[124:127], v[92:95]
    ds_read_b64_tr_b16 v[162:163], v16 offset:512
    s_waitcnt vmcnt(10)
    v_mfma_f32_16x16x32_bf16 v[80:83], v[136:139], a[128:131], v[80:83]
    s_waitcnt lgkmcnt(2)
    v_mfma_f32_16x16x32_bf16 v[84:87], v[136:139], a[132:135], v[84:87]
    buffer_load_dwordx4 v[132:135], v23, s[24:27], s58 offen offset:1024 sc1
    v_mfma_f32_16x16x32_bf16 v[88:91], v[136:139], a[136:139], v[88:91]
    v_add_f32 v96, v96, v100
    v_add_f32 v97, v97, v101
    ds_read_b64_tr_b16 v[164:165], v16 offset:4096
    v_mfma_f32_16x16x32_bf16 v[92:95], v[136:139], a[140:143], v[92:95]
    ds_read_b64_tr_b16 v[166:167], v16 offset:4608
    s_waitcnt vmcnt(10)
    v_mfma_f32_16x16x32_bf16 v[80:83], v[140:143], a[144:147], v[80:83]
    s_add_u32 s58, s66, s79
    v_add_f32 v98, v98, v102
    v_mfma_f32_16x16x32_bf16 v[84:87], v[140:143], a[148:151], v[84:87]
    buffer_load_dwordx4 v[136:139], v23, s[24:27], s58 offen offset:0 sc1
    v_mfma_f32_16x16x32_bf16 v[88:91], v[140:143], a[152:155], v[88:91]
    v_add_f32 v99, v99, v103
    v_add_f32 v96, v96, v104
    ds_read_b64_tr_b16 v[168:169], v16 offset:8192
    v_mfma_f32_16x16x32_bf16 v[92:95], v[140:143], a[156:159], v[92:95]
    ds_read_b64_tr_b16 v[170:171], v16 offset:8704
    s_waitcnt vmcnt(10)
    v_mfma_f32_16x16x32_bf16 v[80:83], v[144:147], a[160:163], v[80:83]
    v_add_f32 v97, v97, v105
    v_mfma_f32_16x16x32_bf16 v[84:87], v[144:147], a[164:167], v[84:87]
    buffer_load_dwordx4 v[140:143], v23, s[24:27], s58 offen offset:1024 sc1
    v_mfma_f32_16x16x32_bf16 v[88:91], v[144:147], a[168:171], v[88:91]
    v_add_f32 v98, v98, v106
    v_add_f32 v99, v99, v107
    ds_read_b64_tr_b16 v[172:173], v16 offset:12288
    v_mfma_f32_16x16x32_bf16 v[92:95], v[144:147], a[172:175], v[92:95]
    ds_read_b64_tr_b16 v[174:175], v16 offset:12800
    s_waitcnt vmcnt(10)
    v_mfma_f32_16x16x32_bf16 v[80:83], v[148:151], a[176:179], v[80:83]
    s_add_u32 s58, s66, s80
    v_mfma_f32_16x16x32_bf16 v[84:87], v[148:151], a[180:183], v[84:87]
    buffer_load_dwordx4 v[144:147], v23, s[24:27], s58 offen offset:0 sc1
    v_mfma_f32_16x16x32_bf16 v[88:91], v[148:151], a[184:187], v[88:91]
    v_add_f32 v96, v96, v108
    v_add_f32 v97, v97, v109
    v_mfma_f32_16x16x32_bf16 v[92:95], v[148:151], a[188:191], v[92:95]
    v_add_f32 v98, v98, v110
    s_waitcnt vmcnt(10)
    v_mfma_f32_16x16x32_bf16 v[80:83], v[152:155], a[192:195], v[80:83]
    v_mfma_f32_16x16x32_bf16 v[84:87], v[152:155], a[196:199], v[84:87]
    buffer_load_dwordx4 v[148:151], v23, s[24:27], s58 offen offset:1024 sc1
    v_mfma_f32_16x16x32_bf16 v[88:91], v[152:155], a[200:203], v[88:91]
    v_add_f32 v99, v99, v111
    v_mfma_f32_16x16x32_bf16 v[92:95], v[152:155], a[204:207], v[92:95]
    s_waitcnt vmcnt(10)
    v_mfma_f32_16x16x32_bf16 v[80:83], v[156:159], a[208:211], v[80:83]
    s_add_u32 s58, s66, s81
    v_mfma_f32_16x16x32_bf16 v[84:87], v[156:159], a[212:215], v[84:87]
    buffer_load_dwordx4 v[152:155], v23, s[24:27], s58 offen offset:0 sc1
    v_mfma_f32_16x16x32_bf16 v[88:91], v[156:159], a[216:219], v[88:91]
    v_mfma_f32_16x16x32_bf16 v[92:95], v[156:159], a[220:223], v[92:95]
    s_waitcnt vmcnt(10)
    v_mfma_f32_16x16x32_bf16 v[64:67], v[112:115], a[0:3], v[64:67]
    v_mfma_f32_16x16x32_bf16 v[68:71], v[112:115], a[4:7], 0
    buffer_load_dwordx4 v[156:159], v23, s[24:27], s58 offen offset:1024 sc1
    v_mfma_f32_16x16x32_bf16 v[72:75], v[112:115], a[8:11], 0
    ds_read_b64_tr_b16 v[192:193], v16 offset:1024
    v_mfma_f32_16x16x32_bf16 v[76:79], v[112:115], a[12:15], 0
    ds_read_b64_tr_b16 v[194:195], v16 offset:1536
    s_waitcnt vmcnt(10)
    v_mfma_f32_16x16x32_bf16 v[64:67], v[116:119], a[16:19], v[64:67]
    s_add_u32 s58, s66, s82
    v_mfma_f32_16x16x32_bf16 v[68:71], v[116:119], a[20:23], v[68:71]
    buffer_load_dwordx4 v[112:115], v23, s[24:27], s58 offen offset:0 sc1
    v_mfma_f32_16x16x32_bf16 v[72:75], v[116:119], a[24:27], v[72:75]
    ds_read_b64_tr_b16 v[196:197], v16 offset:5120
    ds_read_b64_tr_b16 v[198:199], v16 offset:5632
    v_mfma_f32_16x16x32_bf16 v[76:79], v[116:119], a[28:31], v[76:79]
    ds_write_b128 v232, v[84:87] offset:49152
    s_waitcnt vmcnt(10)
    v_mfma_f32_16x16x32_bf16 v[64:67], v[120:123], a[32:35], v[64:67]
    v_mfma_f32_16x16x32_bf16 v[68:71], v[120:123], a[36:39], v[68:71]
    buffer_load_dwordx4 v[116:119], v23, s[24:27], s58 offen offset:1024 sc1
    v_mfma_f32_16x16x32_bf16 v[72:75], v[120:123], a[40:43], v[72:75]
    ds_read_b64_tr_b16 v[200:201], v16 offset:9216
    ds_read_b64_tr_b16 v[202:203], v16 offset:9728
    v_mfma_f32_16x16x32_bf16 v[76:79], v[120:123], a[44:47], v[76:79]
    ds_write_b128 v232, v[88:91] offset:50176
    s_waitcnt vmcnt(10)
    v_mfma_f32_16x16x32_bf16 v[64:67], v[124:127], a[48:51], v[64:67]
    s_add_u32 s66, s69, 58624
    s_add_u32 s58, s66, s76
    v_mfma_f32_16x16x32_bf16 v[68:71], v[124:127], a[52:55], v[68:71]
    buffer_load_dwordx4 v[120:123], v23, s[24:27], s58 offen offset:0 sc1
    v_mfma_f32_16x16x32_bf16 v[72:75], v[124:127], a[56:59], v[72:75]
    ds_read_b64_tr_b16 v[204:205], v16 offset:13312
    ds_read_b64_tr_b16 v[206:207], v16 offset:13824
    v_mfma_f32_16x16x32_bf16 v[76:79], v[124:127], a[60:63], v[76:79]
    ds_write_b128 v232, v[92:95] offset:51200
    s_waitcnt vmcnt(10)
    v_mfma_f32_16x16x32_bf16 v[64:67], v[128:131], a[64:67], v[64:67]
    v_mfma_f32_16x16x32_bf16 v[68:71], v[128:131], a[68:71], v[68:71]
    buffer_load_dwordx4 v[124:127], v23, s[24:27], s58 offen offset:1024 sc1
    v_mfma_f32_16x16x32_bf16 v[72:75], v[128:131], a[72:75], v[72:75]
    ds_read_b64_tr_b16 v[100:101], v16 offset:2048
    v_mfma_f32_16x16x32_bf16 v[76:79], v[128:131], a[76:79], v[76:79]
    ds_read_b64_tr_b16 v[102:103], v16 offset:2560
    s_waitcnt vmcnt(10)
    v_mfma_f32_16x16x32_bf16 v[64:67], v[132:135], a[80:83], v[64:67]
    s_add_u32 s58, s66, s77
    v_mfma_f32_16x16x32_bf16 v[68:71], v[132:135], a[84:87], v[68:71]
    buffer_load_dwordx4 v[128:131], v23, s[24:27], s58 offen offset:0 sc1
    v_mfma_f32_16x16x32_bf16 v[72:75], v[132:135], a[88:91], v[72:75]
    s_waitcnt lgkmcnt(2)
    s_barrier
    v_mfma_f32_16x16x32_bf16 v[76:79], v[132:135], a[92:95], v[76:79]
    s_waitcnt vmcnt(10)
    v_mfma_f32_16x16x32_bf16 v[64:67], v[136:139], a[96:99], v[64:67]
    v_mfma_f32_16x16x32_bf16 v[68:71], v[136:139], a[100:103], v[68:71]
    buffer_load_dwordx4 v[132:135], v23, s[24:27], s58 offen offset:1024 sc1
    v_mfma_f32_16x16x32_bf16 v[72:75], v[136:139], a[104:107], v[72:75]
    ds_read_b128 v[84:87], v233 offset:49152
    ds_read_b128 v[88:91], v234 offset:50176
    v_mfma_f32_16x16x32_bf16 v[76:79], v[136:139], a[108:111], v[76:79]
    ds_read_b128 v[92:95], v235 offset:51200
    s_waitcnt vmcnt(10)
    v_mfma_f32_16x16x32_bf16 v[64:67], v[140:143], a[112:115], v[64:67]
    s_add_u32 s58, s66, s78
    v_mfma_f32_16x16x32_bf16 v[68:71], v[140:143], a[116:119], v[68:71]
    buffer_load_dwordx4 v[136:139], v23, s[24:27], s58 offen offset:0 sc1
    v_mfma_f32_16x16x32_bf16 v[72:75], v[140:143], a[120:123], v[72:75]
    ds_read_b64_tr_b16 a[224:225], v246 offset:0
    v_mfma_f32_16x16x32_bf16 v[76:79], v[140:143], a[124:127], v[76:79]
    ds_read_b64_tr_b16 a[226:227], v246 offset:512
    s_waitcnt vmcnt(10)
    v_mfma_f32_16x16x32_bf16 v[64:67], v[144:147], a[128:131], v[64:67]
    s_waitcnt lgkmcnt(2)
    v_mfma_f32_16x16x32_bf16 v[68:71], v[144:147], a[132:135], v[68:71]
    buffer_load_dwordx4 v[140:143], v23, s[24:27], s58 offen offset:1024 sc1
    v_mfma_f32_16x16x32_bf16 v[72:75], v[144:147], a[136:139], v[72:75]
    v_add_f32 v80, v80, v84
    v_add_f32 v81, v81, v85
    ds_read_b64_tr_b16 a[228:229], v247 offset:0
    v_mfma_f32_16x16x32_bf16 v[76:79], v[144:147], a[140:143], v[76:79]
    ds_read_b64_tr_b16 a[230:231], v247 offset:512
    s_waitcnt vmcnt(10)
    v_mfma_f32_16x16x32_bf16 v[64:67], v[148:151], a[144:147], v[64:67]
    s_add_u32 s58, s66, s79
    v_add_f32 v82, v82, v86
    v_mfma_f32_16x16x32_bf16 v[68:71], v[148:151], a[148:151], v[68:71]
    buffer_load_dwordx4 v[144:147], v23, s[24:27], s58 offen offset:0 sc1
    v_mfma_f32_16x16x32_bf16 v[72:75], v[148:151], a[152:155], v[72:75]
    v_add_f32 v83, v83, v87
    v_add_f32 v80, v80, v88
    ds_read_b64_tr_b16 a[232:233], v246 offset:256
    v_mfma_f32_16x16x32_bf16 v[76:79], v[148:151], a[156:159], v[76:79]
    ds_read_b64_tr_b16 a[234:235], v246 offset:768
    s_waitcnt vmcnt(10)
    v_mfma_f32_16x16x32_bf16 v[64:67], v[152:155], a[160:163], v[64:67]
    v_add_f32 v81, v81, v89
    v_mfma_f32_16x16x32_bf16 v[68:71], v[152:155], a[164:167], v[68:71]
    buffer_load_dwordx4 v[148:151], v23, s[24:27], s58 offen offset:1024 sc1
    v_mfma_f32_16x16x32_bf16 v[72:75], v[152:155], a[168:171], v[72:75]
    v_add_f32 v82, v82, v90
    v_add_f32 v83, v83, v91
    ds_read_b64_tr_b16 a[236:237], v247 offset:256
    v_mfma_f32_16x16x32_bf16 v[76:79], v[152:155], a[172:175], v[76:79]
    ds_read_b64_tr_b16 a[238:239], v247 offset:768
    s_waitcnt vmcnt(10)
    v_mfma_f32_16x16x32_bf16 v[64:67], v[156:159], a[176:179], v[64:67]
    s_add_u32 s58, s66, s80
    v_mfma_f32_16x16x32_bf16 v[68:71], v[156:159], a[180:183], v[68:71]
    buffer_load_dwordx4 v[152:155], v23, s[24:27], s58 offen offset:0 sc1
    v_mfma_f32_16x16x32_bf16 v[72:75], v[156:159], a[184:187], v[72:75]
    v_add_f32 v80, v80, v92
    v_add_f32 v81, v81, v93
    v_mfma_f32_16x16x32_bf16 v[76:79], v[156:159], a[188:191], v[76:79]
    v_add_f32 v82, v82, v94
    s_waitcnt vmcnt(10)
    v_mfma_f32_16x16x32_bf16 v[64:67], v[112:115], a[192:195], v[64:67]
    v_mfma_f32_16x16x32_bf16 v[68:71], v[112:115], a[196:199], v[68:71]
    buffer_load_dwordx4 v[156:159], v23, s[24:27], s58 offen offset:1024 sc1
    v_mfma_f32_16x16x32_bf16 v[72:75], v[112:115], a[200:203], v[72:75]
    v_add_f32 v83, v83, v95
    v_mfma_f32_16x16x32_bf16 v[76:79], v[112:115], a[204:207], v[76:79]
    s_waitcnt vmcnt(10)
    v_mfma_f32_16x16x32_bf16 v[64:67], v[116:119], a[208:211], v[64:67]
    s_add_u32 s58, s66, s81
    v_mfma_f32_16x16x32_bf16 v[68:71], v[116:119], a[212:215], v[68:71]
    buffer_load_dwordx4 v[112:115], v23, s[24:27], s58 offen offset:0 sc1
    v_mfma_f32_16x16x32_bf16 v[72:75], v[116:119], a[216:219], v[72:75]
    v_mfma_f32_16x16x32_bf16 v[76:79], v[116:119], a[220:223], v[76:79]
    s_waitcnt vmcnt(10)
    v_mfma_f32_16x16x32_bf16 v[48:51], v[120:123], a[0:3], v[48:51]
    v_mfma_f32_16x16x32_bf16 v[52:55], v[120:123], a[4:7], 0
    buffer_load_dwordx4 v[116:119], v23, s[24:27], s58 offen offset:1024 sc1
    v_mfma_f32_16x16x32_bf16 v[56:59], v[120:123], a[8:11], 0
    ds_read_b64_tr_b16 v[104:105], v16 offset:6144
    v_mfma_f32_16x16x32_bf16 v[60:63], v[120:123], a[12:15], 0
    ds_read_b64_tr_b16 v[106:107], v16 offset:6656
    s_waitcnt vmcnt(10)
    v_mfma_f32_16x16x32_bf16 v[48:51], v[124:127], a[16:19], v[48:51]
    s_add_u32 s58, s66, s82
    v_mfma_f32_16x16x32_bf16 v[52:55], v[124:127], a[20:23], v[52:55]
    buffer_load_dwordx4 v[120:123], v23, s[24:27], s58 offen offset:0 sc1
    v_mfma_f32_16x16x32_bf16 v[56:59], v[124:127], a[24:27], v[56:59]
    ds_read_b64_tr_b16 v[108:109], v16 offset:10240
    ds_read_b64_tr_b16 v[110:111], v16 offset:10752
    v_mfma_f32_16x16x32_bf16 v[60:63], v[124:127], a[28:31], v[60:63]
    ds_write_b128 v232, v[68:71] offset:32768
    s_waitcnt vmcnt(10)
    v_mfma_f32_16x16x32_bf16 v[48:51], v[128:131], a[32:35], v[48:51]
    v_mfma_f32_16x16x32_bf16 v[52:55], v[128:131], a[36:39], v[52:55]
    buffer_load_dwordx4 v[124:127], v23, s[24:27], s58 offen offset:1024 sc1
    v_mfma_f32_16x16x32_bf16 v[56:59], v[128:131], a[40:43], v[56:59]
    ds_read_b64_tr_b16 v[84:85], v16 offset:14336
    ds_read_b64_tr_b16 v[86:87], v16 offset:14848
    v_mfma_f32_16x16x32_bf16 v[60:63], v[128:131], a[44:47], v[60:63]
    ds_write_b128 v232, v[72:75] offset:33792
    s_waitcnt vmcnt(10)
    v_mfma_f32_16x16x32_bf16 v[48:51], v[132:135], a[48:51], v[48:51]
    s_add_u32 s66, s69, 0
    s_add_u32 s58, s66, s76
    v_mfma_f32_16x16x32_bf16 v[52:55], v[132:135], a[52:55], v[52:55]
    buffer_load_dwordx4 v[128:131], v23, s[24:27], s58 offen offset:0 sc1
    v_mfma_f32_16x16x32_bf16 v[56:59], v[132:135], a[56:59], v[56:59]
    ds_read_b64_tr_b16 v[88:89], v16 offset:3072
    ds_read_b64_tr_b16 v[90:91], v16 offset:3584
    v_mfma_f32_16x16x32_bf16 v[60:63], v[132:135], a[60:63], v[60:63]
    ds_write_b128 v232, v[76:79] offset:34816
    s_waitcnt vmcnt(10)
    v_mfma_f32_16x16x32_bf16 v[48:51], v[136:139], a[64:67], v[48:51]
    v_mfma_f32_16x16x32_bf16 v[52:55], v[136:139], a[68:71], v[52:55]
    buffer_load_dwordx4 v[132:135], v23, s[24:27], s58 offen offset:1024 sc1
    v_mfma_f32_16x16x32_bf16 v[56:59], v[136:139], a[72:75], v[56:59]
    ds_read_b64_tr_b16 v[92:93], v16 offset:7168
    v_mfma_f32_16x16x32_bf16 v[60:63], v[136:139], a[76:79], v[60:63]
    ds_read_b64_tr_b16 v[94:95], v16 offset:7680
    s_waitcnt vmcnt(10)
    v_mfma_f32_16x16x32_bf16 v[48:51], v[140:143], a[80:83], v[48:51]
    s_add_u32 s58, s66, s77
    v_mfma_f32_16x16x32_bf16 v[52:55], v[140:143], a[84:87], v[52:55]
    buffer_load_dwordx4 v[136:139], v23, s[24:27], s58 offen offset:0 sc1
    v_mfma_f32_16x16x32_bf16 v[56:59], v[140:143], a[88:91], v[56:59]
    s_waitcnt lgkmcnt(2)
    s_barrier
    v_mfma_f32_16x16x32_bf16 v[60:63], v[140:143], a[92:95], v[60:63]
    buffer_load_dword v19, v21, s[24:27], 0 offen sc1
    s_waitcnt vmcnt(11)
    v_mfma_f32_16x16x32_bf16 v[48:51], v[144:147], a[96:99], v[48:51]
    ds_read_b128 v[68:71], v233 offset:32768
    v_mfma_f32_16x16x32_bf16 v[52:55], v[144:147], a[100:103], v[52:55]
    ds_read_b128 v[72:75], v234 offset:33792
    v_mfma_f32_16x16x32_bf16 v[56:59], v[144:147], a[104:107], v[56:59]
    ds_read_b128 v[76:79], v235 offset:34816
    v_mfma_f32_16x16x32_bf16 v[60:63], v[144:147], a[108:111], v[60:63]
    s_waitcnt vmcnt(10)
    v_mfma_f32_16x16x32_bf16 v[48:51], v[148:151], a[112:115], v[48:51]
    v_mfma_f32_16x16x32_bf16 v[52:55], v[148:151], a[116:119], v[52:55]
    buffer_load_dwordx4 v[140:143], v23, s[24:27], s58 offen offset:1024 sc1
    v_mfma_f32_16x16x32_bf16 v[56:59], v[148:151], a[120:123], v[56:59]
    ds_read_b64_tr_b16 a[240:241], v246 offset:4096
    v_mfma_f32_16x16x32_bf16 v[60:63], v[148:151], a[124:127], v[60:63]
    ds_read_b64_tr_b16 a[242:243], v246 offset:4608
    s_waitcnt vmcnt(10)
    v_mfma_f32_16x16x32_bf16 v[48:51], v[152:155], a[128:131], v[48:51]
    s_add_u32 s58, s66, s78
    s_waitcnt lgkmcnt(2)
    v_mfma_f32_16x16x32_bf16 v[52:55], v[152:155], a[132:135], v[52:55]
    buffer_load_dwordx4 v[144:147], v23, s[24:27], s58 offen offset:0 sc1
    v_mfma_f32_16x16x32_bf16 v[56:59], v[152:155], a[136:139], v[56:59]
    v_add_f32 v64, v64, v68
    v_add_f32 v65, v65, v69
    ds_read_b64_tr_b16 a[244:245], v247 offset:4096
    v_mfma_f32_16x16x32_bf16 v[60:63], v[152:155], a[140:143], v[60:63]
    ds_read_b64_tr_b16 a[246:247], v247 offset:4608
    s_waitcnt vmcnt(10)
    v_mfma_f32_16x16x32_bf16 v[48:51], v[156:159], a[144:147], v[48:51]
    v_add_f32 v66, v66, v70
    v_mfma_f32_16x16x32_bf16 v[52:55], v[156:159], a[148:151], v[52:55]
    buffer_load_dwordx4 v[148:151], v23, s[24:27], s58 offen offset:1024 sc1
    v_mfma_f32_16x16x32_bf16 v[56:59], v[156:159], a[152:155], v[56:59]
    v_add_f32 v67, v67, v71
    v_add_f32 v64, v64, v72
    ds_read_b64_tr_b16 a[248:249], v246 offset:4352
    v_mfma_f32_16x16x32_bf16 v[60:63], v[156:159], a[156:159], v[60:63]
    ds_read_b64_tr_b16 a[250:251], v246 offset:4864
    s_waitcnt vmcnt(10)
    v_mfma_f32_16x16x32_bf16 v[48:51], v[112:115], a[160:163], v[48:51]
    s_add_u32 s58, s66, s79
    v_add_f32 v65, v65, v73
    v_mfma_f32_16x16x32_bf16 v[52:55], v[112:115], a[164:167], v[52:55]
    buffer_load_dwordx4 v[152:155], v23, s[24:27], s58 offen offset:0 sc1
    v_mfma_f32_16x16x32_bf16 v[56:59], v[112:115], a[168:171], v[56:59]
    v_add_f32 v66, v66, v74
    v_add_f32 v67, v67, v75
    ds_read_b64_tr_b16 a[252:253], v247 offset:4352
    v_mfma_f32_16x16x32_bf16 v[60:63], v[112:115], a[172:175], v[60:63]
    ds_read_b64_tr_b16 a[254:255], v247 offset:4864
    s_waitcnt vmcnt(10)
    v_mfma_f32_16x16x32_bf16 v[48:51], v[116:119], a[176:179], v[48:51]
    v_mfma_f32_16x16x32_bf16 v[52:55], v[116:119], a[180:183], v[52:55]
    buffer_load_dwordx4 v[156:159], v23, s[24:27], s58 offen offset:1024 sc1
    v_mfma_f32_16x16x32_bf16 v[56:59], v[116:119], a[184:187], v[56:59]
    v_add_f32 v64, v64, v76
    v_add_f32 v65, v65, v77
    v_mfma_f32_16x16x32_bf16 v[60:63], v[116:119], a[188:191], v[60:63]
    v_add_f32 v66, v66, v78
    s_waitcnt vmcnt(10)
    v_mfma_f32_16x16x32_bf16 v[48:51], v[120:123], a[192:195], v[48:51]
    s_add_u32 s58, s66, s80
    v_mfma_f32_16x16x32_bf16 v[52:55], v[120:123], a[196:199], v[52:55]
    buffer_load_dwordx4 v[112:115], v23, s[24:27], s58 offen offset:0 sc1
    v_mfma_f32_16x16x32_bf16 v[56:59], v[120:123], a[200:203], v[56:59]
    v_add_f32 v67, v67, v79
    v_mfma_f32_16x16x32_bf16 v[60:63], v[120:123], a[204:207], v[60:63]
    s_waitcnt vmcnt(10)
    v_mfma_f32_16x16x32_bf16 v[48:51], v[124:127], a[208:211], v[48:51]
    v_mfma_f32_16x16x32_bf16 v[52:55], v[124:127], a[212:215], v[52:55]
    buffer_load_dwordx4 v[116:119], v23, s[24:27], s58 offen offset:1024 sc1
    v_mfma_f32_16x16x32_bf16 v[56:59], v[124:127], a[216:219], v[56:59]
    v_mfma_f32_16x16x32_bf16 v[60:63], v[124:127], a[220:223], v[60:63]
    s_waitcnt vmcnt(10)
    v_mfma_f32_16x16x32_bf16 v[32:35], v[128:131], a[0:3], v[32:35]
    s_add_u32 s58, s66, s81
    v_mfma_f32_16x16x32_bf16 v[36:39], v[128:131], a[4:7], 0
    buffer_load_dwordx4 v[120:123], v23, s[24:27], s58 offen offset:0 sc1
    v_mfma_f32_16x16x32_bf16 v[40:43], v[128:131], a[8:11], 0
    v_mfma_f32_16x16x32_bf16 v[44:47], v[128:131], a[12:15], 0
    s_waitcnt vmcnt(10)
    v_mfma_f32_16x16x32_bf16 v[32:35], v[132:135], a[16:19], v[32:35]
    ds_write_b128 v232, v[52:55] offset:16384
    v_mfma_f32_16x16x32_bf16 v[36:39], v[132:135], a[20:23], v[36:39]
    buffer_load_dwordx4 v[124:127], v23, s[24:27], s58 offen offset:1024 sc1
    v_mfma_f32_16x16x32_bf16 v[40:43], v[132:135], a[24:27], v[40:43]
    ds_read_b64_tr_b16 a[0:1], v246 offset:8192
    ds_read_b64_tr_b16 a[2:3], v246 offset:8704
    ds_read_b64_tr_b16 a[4:5], v247 offset:8192
    v_mfma_f32_16x16x32_bf16 v[44:47], v[132:135], a[28:31], v[44:47]
    ds_read_b64_tr_b16 a[6:7], v247 offset:8704
    s_waitcnt vmcnt(10)
    v_mfma_f32_16x16x32_bf16 v[32:35], v[136:139], a[32:35], v[32:35]
    s_add_u32 s58, s66, s82
    ds_write_b128 v232, v[56:59] offset:17408
    v_mfma_f32_16x16x32_bf16 v[36:39], v[136:139], a[36:39], v[36:39]
    buffer_load_dwordx4 v[128:131], v23, s[24:27], s58 offen offset:0 sc1
    v_mfma_f32_16x16x32_bf16 v[40:43], v[136:139], a[40:43], v[40:43]
    ds_read_b64_tr_b16 a[8:9], v246 offset:8448
    ds_read_b64_tr_b16 a[10:11], v246 offset:8960
    ds_read_b64_tr_b16 a[12:13], v247 offset:8448
    v_mfma_f32_16x16x32_bf16 v[44:47], v[136:139], a[44:47], v[44:47]
    ds_read_b64_tr_b16 a[14:15], v247 offset:8960
    buffer_load_dwordx4 v[132:135], v23, s[24:27], s58 offen offset:1024 sc1
    s_waitcnt vmcnt(11)
    v_cmp_ne_u32 vcc, s47, v19
    s_nop 0
    s_cbranch_vccz L_ok10
    s_mov_b32 s59, 20000
L_spin9:
    buffer_load_dword v19, v21, s[24:27], 0 offen sc1
    s_waitcnt vmcnt(0)
    v_cmp_ne_u32 vcc, s47, v19
    s_nop 0
    s_cbranch_vccz L_ok10
    s_sub_u32 s59, s59, 1
    s_cbranch_scc0 L_spin9
L_ok10:
    s_waitcnt vmcnt(10)
    v_mfma_f32_16x16x32_bf16 v[32:35], v[140:143], a[48:51], v[32:35]
    s_add_u32 s58, s70, 0
    ds_write_b128 v232, v[60:63] offset:18432
    v_mfma_f32_16x16x32_bf16 v[36:39], v[140:143], a[52:55], v[36:39]
    buffer_load_dwordx4 v[136:139], v23, s[24:27], s58 offen offset:0 sc1
    v_mfma_f32_16x16x32_bf16 v[40:43], v[140:143], a[56:59], v[40:43]
    ds_read_b64_tr_b16 a[16:17], v246 offset:12288
    ds_read_b64_tr_b16 a[18:19], v246 offset:12800
    ds_read_b64_tr_b16 a[20:21], v247 offset:12288
    v_mfma_f32_16x16x32_bf16 v[44:47], v[140:143], a[60:63], v[44:47]
    ds_read_b64_tr_b16 a[22:23], v247 offset:12800
    s_waitcnt vmcnt(10)
    v_mfma_f32_16x16x32_bf16 v[32:35], v[144:147], a[64:67], v[32:35]
    ds_read_b64_tr_b16 a[24:25], v246 offset:12544
    v_mfma_f32_16x16x32_bf16 v[36:39], v[144:147], a[68:71], v[36:39]
    buffer_load_dwordx4 v[140:143], v23, s[24:27], s58 offen offset:1024 sc1
    v_mfma_f32_16x16x32_bf16 v[40:43], v[144:147], a[72:75], v[40:43]
    ds_read_b64_tr_b16 a[26:27], v246 offset:13056
    ds_read_b64_tr_b16 a[28:29], v247 offset:12544
    v_mfma_f32_16x16x32_bf16 v[44:47], v[144:147], a[76:79], v[44:47]
    ds_read_b64_tr_b16 a[30:31], v247 offset:13056
    s_waitcnt vmcnt(10)
    v_mfma_f32_16x16x32_bf16 v[32:35], v[148:151], a[80:83], v[32:35]
    ds_read_b64_tr_b16 a[32:33], v246 offset:16384
    v_mfma_f32_16x16x32_bf16 v[36:39], v[148:151], a[84:87], v[36:39]
    buffer_load_dwordx4 v[144:147], v23, s[24:27], s58 offen offset:2048 sc1
    v_mfma_f32_16x16x32_bf16 v[40:43], v[148:151], a[88:91], v[40:43]
    ds_read_b64_tr_b16 a[34:35], v246 offset:16896
    ds_read_b64_tr_b16 a[36:37], v247 offset:16384
    v_mfma_f32_16x16x32_bf16 v[44:47], v[148:151], a[92:95], v[44:47]
    ds_read_b64_tr_b16 a[38:39], v247 offset:16896
    s_waitcnt vmcnt(10)
    v_mfma_f32_16x16x32_bf16 v[32:35], v[152:155], a[96:99], v[32:35]
    ds_read_b64_tr_b16 a[40:41], v246 offset:16640
    v_mfma_f32_16x16x32_bf16 v[36:39], v[152:155], a[100:103], v[36:39]
    buffer_load_dwordx4 v[148:151], v23, s[24:27], s58 offen offset:3072 sc1
    v_mfma_f32_16x16x32_bf16 v[40:43], v[152:155], a[104:107], v[40:43]
    ds_read_b64_tr_b16 a[42:43], v246 offset:17152
    ds_read_b64_tr_b16 a[44:45], v247 offset:16640
    v_mfma_f32_16x16x32_bf16 v[44:47], v[152:155], a[108:111], v[44:47]
    ds_read_b64_tr_b16 a[46:47], v247 offset:17152
    s_waitcnt vmcnt(10)
    v_mfma_f32_16x16x32_bf16 v[32:35], v[156:159], a[112:115], v[32:35]
    s_add_u32 s58, s70, 4096
    ds_read_b64_tr_b16 a[48:49], v246 offset:20480
    v_mfma_f32_16x16x32_bf16 v[36:39], v[156:159], a[116:119], v[36:39]
    buffer_load_dwordx4 v[152:155], v23, s[24:27], s58 offen offset:0 sc1
    v_mfma_f32_16x16x32_bf16 v[40:43], v[156:159], a[120:123], v[40:43]
    ds_read_b64_tr_b16 a[50:51], v246 offset:20992
    ds_read_b64_tr_b16 a[52:53], v247 offset:20480
    v_mfma_f32_16x16x32_bf16 v[44:47], v[156:159], a[124:127], v[44:47]
    ds_read_b64_tr_b16 a[54:55], v247 offset:20992
    s_waitcnt vmcnt(10)
    v_mfma_f32_16x16x32_bf16 v[32:35], v[112:115], a[128:131], v[32:35]
    ds_read_b64_tr_b16 a[56:57], v246 offset:20736
    v_mfma_f32_16x16x32_bf16 v[36:39], v[112:115], a[132:135], v[36:39]
    buffer_load_dwordx4 v[156:159], v23, s[24:27], s58 offen offset:1024 sc1
    v_mfma_f32_16x16x32_bf16 v[40:43], v[112:115], a[136:139], v[40:43]
    ds_read_b64_tr_b16 a[58:59], v246 offset:21248
    ds_read_b64_tr_b16 a[60:61], v247 offset:20736
    v_mfma_f32_16x16x32_bf16 v[44:47], v[112:115], a[140:143], v[44:47]
    ds_read_b64_tr_b16 a[62:63], v247 offset:21248
    s_waitcnt vmcnt(10)
    v_mfma_f32_16x16x32_bf16 v[32:35], v[116:119], a[144:147], v[32:35]
    ds_read_b64_tr_b16 a[64:65], v246 offset:24576
    v_mfma_f32_16x16x32_bf16 v[36:39], v[116:119], a[148:151], v[36:39]
    buffer_load_dwordx4 v[112:115], v23, s[24:27], s58 offen offset:2048 sc1
    v_mfma_f32_16x16x32_bf16 v[40:43], v[116:119], a[152:155], v[40:43]
    ds_read_b64_tr_b16 a[66:67], v246 offset:25088
    ds_read_b64_tr_b16 a[68:69], v247 offset:24576
    v_mfma_f32_16x16x32_bf16 v[44:47], v[116:119], a[156:159], v[44:47]
    ds_read_b64_tr_b16 a[70:71], v247 offset:25088
    s_waitcnt vmcnt(10)
    v_mfma_f32_16x16x32_bf16 v[32:35], v[120:123], a[160:163], v[32:35]
    ds_read_b64_tr_b16 a[72:73], v246 offset:24832
    v_mfma_f32_16x16x32_bf16 v[36:39], v[120:123], a[164:167], v[36:39]
    buffer_load_dwordx4 v[116:119], v23, s[24:27], s58 offen offset:3072 sc1
    v_mfma_f32_16x16x32_bf16 v[40:43], v[120:123], a[168:171], v[40:43]
    ds_read_b64_tr_b16 a[74:75], v246 offset:25344
    ds_read_b64_tr_b16 a[76:77], v247 offset:24832
    v_mfma_f32_16x16x32_bf16 v[44:47], v[120:123], a[172:175], v[44:47]
    ds_read_b64_tr_b16 a[78:79], v247 offset:25344
    s_waitcnt vmcnt(10)
    v_mfma_f32_16x16x32_bf16 v[32:35], v[124:127], a[176:179], v[32:35]
    s_add_u32 s58, s70, 8192
    ds_read_b64_tr_b16 a[80:81], v246 offset:28672
    v_mfma_f32_16x16x32_bf16 v[36:39], v[124:127], a[180:183], v[36:39]
    buffer_load_dwordx4 v[120:123], v23, s[24:27], s58 offen offset:0 sc1
    v_mfma_f32_16x16x32_bf16 v[40:43], v[124:127], a[184:187], v[40:43]
    ds_read_b64_tr_b16 a[82:83], v246 offset:29184
    ds_read_b64_tr_b16 a[84:85], v247 offset:28672
    v_mfma_f32_16x16x32_bf16 v[44:47], v[124:127], a[188:191], v[44:47]
    ds_read_b64_tr_b16 a[86:87], v247 offset:29184
    s_waitcnt vmcnt(10)
    v_mfma_f32_16x16x32_bf16 v[32:35], v[128:131], a[192:195], v[32:35]
    ds_read_b64_tr_b16 a[88:89], v246 offset:28928
    v_mfma_f32_16x16x32_bf16 v[36:39], v[128:131], a[196:199], v[36:39]
    buffer_load_dwordx4 v[124:127], v23, s[24:27], s58 offen offset:1024 sc1
    v_mfma_f32_16x16x32_bf16 v[40:43], v[128:131], a[200:203], v[40:43]
    ds_read_b64_tr_b16 a[90:91], v246 offset:29440
    ds_read_b64_tr_b16 a[92:93], v247 offset:28928
    v_mfma_f32_16x16x32_bf16 v[44:47], v[128:131], a[204:207], v[44:47]
    ds_read_b64_tr_b16 a[94:95], v247 offset:29440
    s_waitcnt vmcnt(10)
    v_mfma_f32_16x16x32_bf16 v[32:35], v[132:135], a[208:211], v[32:35]
    ds_read_b64_tr_b16 a[96:97], v246 offset:32768
    v_mfma_f32_16x16x32_bf16 v[36:39], v[132:135], a[212:215], v[36:39]
    buffer_load_dwordx4 v[128:131], v23, s[24:27], s58 offen offset:2048 sc1
    v_mfma_f32_16x16x32_bf16 v[40:43], v[132:135], a[216:219], v[40:43]
    ds_read_b64_tr_b16 a[98:99], v246 offset:33280
    ds_read_b64_tr_b16 a[100:101], v247 offset:32768
    v_mfma_f32_16x16x32_bf16 v[44:47], v[132:135], a[220:223], v[44:47]
    ds_read_b64_tr_b16 a[102:103], v247 offset:33280
    s_waitcnt vmcnt(10)
    v_mfma_f32_16x16x32_bf16 v[32:35], a[224:227], v[136:139], v[32:35]
    v_mfma_f32_16x16x32_bf16 v[48:51], a[228:231], v[136:139], v[48:51]
    buffer_load_dwordx4 v[132:135], v23, s[24:27], s58 offen offset:3072 sc1
    v_mfma_f32_16x16x32_bf16 v[64:67], a[232:235], v[136:139], v[64:67]
    ds_read_b64_tr_b16 a[104:105], v246 offset:33024
    ds_read_b64_tr_b16 a[106:107], v246 offset:33536
    v_mfma_f32_16x16x32_bf16 v[80:83], a[236:239], v[136:139], v[80:83]
    ds_read_b64_tr_b16 a[108:109], v247 offset:33024
    ds_read_b64_tr_b16 a[110:111], v247 offset:33536
    v_mfma_f32_16x16x32_bf16 v[96:99], v[160:163], v[136:139], v[96:99]
    ds_read_b64_tr_b16 a[112:113], v246 offset:36864
    s_waitcnt lgkmcnt(15)
    s_waitcnt vmcnt(10)
    v_mfma_f32_16x16x32_bf16 v[32:35], a[240:243], v[140:143], v[32:35]
    s_add_u32 s58, s70, 12288
    v_mfma_f32_16x16x32_bf16 v[48:51], a[244:247], v[140:143], v[48:51]
    buffer_load_dwordx4 v[136:139], v23, s[24:27], s58 offen offset:0 sc1
    v_mfma_f32_16x16x32_bf16 v[64:67], a[248:251], v[140:143], v[64:67]
    ds_read_b64_tr_b16 a[114:115], v246 offset:37376
    ds_read_b64_tr_b16 a[116:117], v247 offset:36864
    v_mfma_f32_16x16x32_bf16 v[80:83], a[252:255], v[140:143], v[80:83]
    ds_read_b64_tr_b16 a[118:119], v247 offset:37376
    ds_read_b64_tr_b16 a[120:121], v246 offset:37120
    v_mfma_f32_16x16x32_bf16 v[96:99], v[164:167], v[140:143], v[96:99]
    ds_write_b128 v232, v[36:39] offset:0
    s_waitcnt vmcnt(10)
    v_mfma_f32_16x16x32_bf16 v[32:35], a[0:3], v[144:147], v[32:35]
    v_mfma_f32_16x16x32_bf16 v[48:51], a[4:7], v[144:147], v[48:51]
    buffer_load_dwordx4 v[140:143], v23, s[24:27], s58 offen offset:1024 sc1
    v_mfma_f32_16x16x32_bf16 v[64:67], a[8:11], v[144:147], v[64:67]
    ds_read_b64_tr_b16 a[122:123], v246 offset:37632
    ds_read_b64_tr_b16 a[124:125], v247 offset:37120
    v_mfma_f32_16x16x32_bf16 v[80:83], a[12:15], v[144:147], v[80:83]
    ds_read_b64_tr_b16 a[126:127], v247 offset:37632
    ds_read_b64_tr_b16 a[128:129], v246 offset:40960
    v_mfma_f32_16x16x32_bf16 v[96:99], v[168:171], v[144:147], v[96:99]
    ds_write_b128 v232, v[40:43] offset:1024
    s_waitcnt vmcnt(10)
    v_mfma_f32_16x16x32_bf16 v[32:35], a[16:19], v[148:151], v[32:35]
    ds_read_b64_tr_b16 a[130:131], v246 offset:41472
    v_mfma_f32_16x16x32_bf16 v[48:51], a[20:23], v[148:151], v[48:51]
    ds_read_b64_tr_b16 a[132:133], v247 offset:40960
    v_mfma_f32_16x16x32_bf16 v[64:67], a[24:27], v[148:151], v[64:67]
    ds_read_b64_tr_b16 a[134:135], v247 offset:41472
    v_mfma_f32_16x16x32_bf16 v[80:83], a[28:31], v[148:151], v[80:83]
    ds_read_b64_tr_b16 a[136:137], v246 offset:41216
    v_mfma_f32_16x16x32_bf16 v[96:99], v[172:175], v[148:151], v[96:99]
    ds_write_b128 v232, v[44:47] offset:2048
    s_waitcnt vmcnt(9)
    v_mfma_f32_16x16x32_bf16 v[32:35], a[32:35], v[152:155], v[32:35]
    ds_read_b64_tr_b16 a[138:139], v246 offset:41728
    v_mfma_f32_16x16x32_bf16 v[48:51], a[36:39], v[152:155], v[48:51]
    ds_read_b64_tr_b16 a[140:141], v247 offset:41216
    v_mfma_f32_16x16x32_bf16 v[64:67], a[40:43], v[152:155], v[64:67]
    ds_read_b64_tr_b16 a[142:143], v247 offset:41728
    v_mfma_f32_16x16x32_bf16 v[80:83], a[44:47], v[152:155], v[80:83]
    ds_read_b64_tr_b16 a[144:145], v246 offset:45056
    v_mfma_f32_16x16x32_bf16 v[96:99], v[192:195], v[152:155], v[96:99]
    ds_read_b64_tr_b16 a[146:147], v246 offset:45568
    s_waitcnt vmcnt(8)
    v_mfma_f32_16x16x32_bf16 v[32:35], a[48:51], v[156:159], v[32:35]
    ds_read_b64_tr_b16 a[148:149], v247 offset:45056
    v_mfma_f32_16x16x32_bf16 v[48:51], a[52:55], v[156:159], v[48:51]
    ds_read_b64_tr_b16 a[150:151], v247 offset:45568
    v_mfma_f32_16x16x32_bf16 v[64:67], a[56:59], v[156:159], v[64:67]
    ds_read_b64_tr_b16 a[152:153], v246 offset:45312
    v_mfma_f32_16x16x32_bf16 v[80:83], a[60:63], v[156:159], v[80:83]
    ds_read_b64_tr_b16 a[154:155], v246 offset:45824
    v_mfma_f32_16x16x32_bf16 v[96:99], v[196:199], v[156:159], v[96:99]
    s_waitcnt lgkmcnt(9)
    s_barrier
    s_waitcnt vmcnt(7)
    v_mfma_f32_16x16x32_bf16 v[32:35], a[64:67], v[112:115], v[32:35]
    ds_read_b64_tr_b16 a[156:157], v247 offset:45312
    ds_read_b64_tr_b16 a[158:159], v247 offset:45824
    v_mfma_f32_16x16x32_bf16 v[48:51], a[68:71], v[112:115], v[48:51]
    ds_read_b64_tr_b16 a[160:161], v248 offset:49152
    ds_read_b64_tr_b16 a[162:163], v248 offset:49664
    v_mfma_f32_16x16x32_bf16 v[64:67], a[72:75], v[112:115], v[64:67]
    ds_read_b128 v[52:55], v233 offset:16384
    v_mfma_f32_16x16x32_bf16 v[80:83], a[76:79], v[112:115], v[80:83]
    ds_read_b128 v[56:59], v234 offset:17408
    v_mfma_f32_16x16x32_bf16 v[96:99], v[200:203], v[112:115], v[96:99]
    ds_read_b128 v[60:63], v235 offset:18432
    s_waitcnt vmcnt(6)
    v_mfma_f32_16x16x32_bf16 v[32:35], a[80:83], v[116:119], v[32:35]
    ds_read_b64_tr_b16 a[164:165], v249 offset:49152
    ds_read_b64_tr_b16 a[166:167], v249 offset:49664
    v_mfma_f32_16x16x32_bf16 v[48:51], a[84:87], v[116:119], v[48:51]
    ds_read_b64_tr_b16 a[168:169], v248 offset:49408
    ds_read_b64_tr_b16 a[170:171], v248 offset:49920
    v_mfma_f32_16x16x32_bf16 v[64:67], a[88:91], v[116:119], v[64:67]
    ds_read_b128 v[36:39], v233 offset:0
    v_mfma_f32_16x16x32_bf16 v[80:83], a[92:95], v[116:119], v[80:83]
    ds_read_b128 v[40:43], v234 offset:1024
    v_mfma_f32_16x16x32_bf16 v[96:99], v[204:207], v[116:119], v[96:99]
    ds_read_b128 v[44:47], v235 offset:2048
    s_waitcnt vmcnt(5)
    v_mfma_f32_16x16x32_bf16 v[32:35], a[96:99], v[120:123], v[32:35]
    ds_read_b64_tr_b16 a[172:173], v249 offset:49408
    v_mfma_f32_16x16x32_bf16 v[48:51], a[100:103], v[120:123], v[48:51]
    ds_read_b64_tr_b16 a[174:175], v249 offset:49920
    v_mfma_f32_16x16x32_bf16 v[64:67], a[104:107], v[120:123], v[64:67]
    ds_read_b64_tr_b16 a[176:177], v248 offset:50176
    v_mfma_f32_16x16x32_bf16 v[80:83], a[108:111], v[120:123], v[80:83]
    ds_read_b64_tr_b16 a[178:179], v248 offset:50688
    v_mfma_f32_16x16x32_bf16 v[96:99], v[100:103], v[120:123], v[96:99]
    ds_read_b64_tr_b16 a[180:181], v249 offset:50176
    s_waitcnt vmcnt(4)
    v_mfma_f32_16x16x32_bf16 v[32:35], a[112:115], v[124:127], v[32:35]
    ds_read_b64_tr_b16 a[182:183], v249 offset:50688
    v_mfma_f32_16x16x32_bf16 v[48:51], a[116:119], v[124:127], v[48:51]
    ds_read_b64_tr_b16 a[184:185], v248 offset:50432
    v_mfma_f32_16x16x32_bf16 v[64:67], a[120:123], v[124:127], v[64:67]
    ds_read_b64_tr_b16 a[186:187], v248 offset:50944
    v_mfma_f32_16x16x32_bf16 v[80:83], a[124:127], v[124:127], v[80:83]
    ds_read_b64_tr_b16 a[188:189], v249 offset:50432
    v_mfma_f32_16x16x32_bf16 v[96:99], v[104:107], v[124:127], v[96:99]
    ds_read_b64_tr_b16 a[190:191], v249 offset:50944
    s_waitcnt lgkmcnt(15)
    s_waitcnt vmcnt(3)
    v_mfma_f32_16x16x32_bf16 v[32:35], a[128:131], v[128:131], v[32:35]
    v_mfma_f32_16x16x32_bf16 v[48:51], a[132:135], v[128:131], v[48:51]
    v_add_f32 v52, v52, v56
    v_mfma_f32_16x16x32_bf16 v[64:67], a[136:139], v[128:131], v[64:67]
    v_add_f32 v53, v53, v57
    v_mfma_f32_16x16x32_bf16 v[80:83], a[140:143], v[128:131], v[80:83]
    v_add_f32 v54, v54, v58
    v_mfma_f32_16x16x32_bf16 v[96:99], v[108:111], v[128:131], v[96:99]
    v_add_f32 v55, v55, v59
    s_waitcnt vmcnt(2)
    v_mfma_f32_16x16x32_bf16 v[32:35], a[144:147], v[132:135], v[32:35]
    v_add_f32 v52, v52, v60
    v_mfma_f32_16x16x32_bf16 v[48:51], a[148:151], v[132:135], v[48:51]
    v_add_f32 v53, v53, v61
    v_mfma_f32_16x16x32_bf16 v[64:67], a[152:155], v[132:135], v[64:67]
    v_add_f32 v54, v54, v62
    v_mfma_f32_16x16x32_bf16 v[80:83], a[156:159], v[132:135], v[80:83]
    v_add_f32 v55, v55, v63
    v_mfma_f32_16x16x32_bf16 v[96:99], v[84:87], v[132:135], v[96:99]
    s_waitcnt lgkmcnt(10)
    s_waitcnt lgkmcnt(8)
    s_waitcnt vmcnt(1)
    v_mfma_f32_16x16x32_bf16 v[32:35], a[160:163], v[136:139], v[32:35]
    v_add_f32 v36, v36, v40
    v_mfma_f32_16x16x32_bf16 v[48:51], a[164:167], v[136:139], v[48:51]
    v_add_f32 v37, v37, v41
    v_mfma_f32_16x16x32_bf16 v[64:67], a[168:171], v[136:139], v[64:67]
    v_add_f32 v38, v38, v42
    v_mfma_f32_16x16x32_bf16 v[80:83], a[172:175], v[136:139], v[80:83]
    v_add_f32 v39, v39, v43
    v_mfma_f32_16x16x32_bf16 v[96:99], v[88:91], v[136:139], v[96:99]
    v_add_f32 v36, v36, v44
    s_waitcnt lgkmcnt(0)
    s_waitcnt vmcnt(0)
    v_mfma_f32_16x16x32_bf16 v[32:35], a[176:179], v[140:143], v[32:35]
    v_add_f32 v37, v37, v45
    v_mfma_f32_16x16x32_bf16 v[48:51], a[180:183], v[140:143], v[48:51]
    v_add_f32 v38, v38, v46
    v_mfma_f32_16x16x32_bf16 v[64:67], a[184:187], v[140:143], v[64:67]
    v_add_f32 v39, v39, v47
    v_mfma_f32_16x16x32_bf16 v[80:83], a[188:191], v[140:143], v[80:83]
    v_mfma_f32_16x16x32_bf16 v[96:99], v[92:95], v[140:143], v[96:99]
    s_nop 0
    v_pk_add_f32 v[32:33], v[32:33], v[36:37]
    v_pk_add_f32 v[34:35], v[34:35], v[38:39]
    v_pk_add_f32 v[48:49], v[48:49], v[52:53]
    v_pk_add_f32 v[50:51], v[50:51], v[54:55]
    v_cvt_pk_bf16_f32 v176, v32, v33
    v_cvt_pk_bf16_f32 v177, v34, v35
    ds_write_b64 v238, v[176:177] offset:0
    v_cvt_pk_bf16_f32 v178, v48, v49
    v_cvt_pk_bf16_f32 v179, v50, v51
    ds_write_b64 v238, v[178:179] offset:32
    v_cvt_pk_bf16_f32 v180, v64, v65
    v_cvt_pk_bf16_f32 v181, v66, v67
    ds_write_b64 v238, v[180:181] offset:64
    v_cvt_pk_bf16_f32 v182, v80, v81
    v_cvt_pk_bf16_f32 v183, v82, v83
    ds_write_b64 v238, v[182:183] offset:96
    ds_read_b128 v[216:219], v244 offset:0
    ds_read_b128 v[220:223], v244 offset:1408
    v_cvt_pk_bf16_f32 v184, v96, v97
    v_cvt_pk_bf16_f32 v185, v98, v99
    ds_write_b64 v238, v[184:185] offset:128
    ds_read_b64 v[224:225], v252 offset:128
    s_waitcnt lgkmcnt(3)
    buffer_store_dwordx4 v[216:219], v22, s[28:31], s71 offen
    s_waitcnt lgkmcnt(2)
    buffer_store_dwordx4 v[220:223], v22, s[28:31], s72 offen
    s_waitcnt lgkmcnt(0)
    buffer_store_dwordx2 v[224:225], v26, s[28:31], s73 offen
L_end:
    s_endpgm
L_p2_alt:
    s_add_u32 s57, s57, 27648
    buffer_load_dwordx4 v11, s[16:19], s57 offen offset:3072 lds
    s_xor_b32 s66, s44, 3
    s_lshl2_add_u32 s66, s51, s66
    s_mul_i32 s66, s66, 66816
    s_lshl2_add_u32 s66, s52, s66
    s_lshl_b32 s86, s65, 10
    s_add_u32 s58, s86, s66
    s_add_u32 s86, s66, 13312
    buffer_load_dwordx4 v[128:131], v23, s[24:27], s58 offen offset:0 sc1
    s_add_u32 s58, s58, 1024
    s_cmp_eq_u32 s58, s86
    s_cselect_b32 s58, s66, s58
    buffer_load_dwordx4 v[132:135], v23, s[24:27], s58 offen offset:0 sc1
    s_add_u32 s58, s58, 1024
    s_cmp_eq_u32 s58, s86
    s_cselect_b32 s58, s66, s58
    buffer_load_dwordx4 v[136:139], v23, s[24:27], s58 offen offset:0 sc1
    s_add_u32 s58, s58, 1024
    s_cmp_eq_u32 s58, s86
    s_cselect_b32 s58, s66, s58
    buffer_load_dwordx4 v[140:143], v23, s[24:27], s58 offen offset:0 sc1
    s_add_u32 s58, s58, 1024
    s_cmp_eq_u32 s58, s86
    s_cselect_b32 s58, s66, s58
    buffer_load_dwordx4 v[144:147], v23, s[24:27], s58 offen offset:0 sc1
    s_add_u32 s58, s58, 1024
    s_cmp_eq_u32 s58, s86
    s_cselect_b32 s58, s66, s58
    buffer_load_dwordx4 v[148:151], v23, s[24:27], s58 offen offset:0 sc1
    s_add_u32 s58, s58, 1024
    s_cmp_eq_u32 s58, s86
    s_cselect_b32 s58, s66, s58
    buffer_load_dwordx4 v[152:155], v23, s[24:27], s58 offen offset:0 sc1
    s_add_u32 s58, s58, 1024
    s_cmp_eq_u32 s58, s86
    s_cselect_b32 s58, s66, s58
    buffer_load_dwordx4 v[156:159], v23, s[24:27], s58 offen offset:0 sc1
    s_add_u32 s58, s58, 1024
    s_cmp_eq_u32 s58, s86
    s_cselect_b32 s58, s66, s58
    buffer_load_dwordx4 v[112:115], v23, s[24:27], s58 offen offset:0 sc1
    s_add_u32 s58, s58, 1024
    s_cmp_eq_u32 s58, s86
    s_cselect_b32 s58, s66, s58
    buffer_load_dwordx4 v[116:119], v23, s[24:27], s58 offen offset:0 sc1
    s_add_u32 s58, s58, 1024
    s_cmp_eq_u32 s58, s86
    s_cselect_b32 s58, s66, s58
    buffer_load_dwordx4 v[120:123], v23, s[24:27], s58 offen offset:0 sc1
    s_waitcnt vmcnt(19)
    ds_read_b64_tr_b16 a[208:209], v4 offset:32768
    ds_read_b64_tr_b16 a[210:211], v4 offset:33280
    ds_read_b64_tr_b16 a[212:213], v5 offset:32768
    ds_read_b64_tr_b16 a[214:215], v5 offset:33280
    ds_read_b64_tr_b16 a[216:217], v4 offset:33024
    ds_read_b64_tr_b16 a[218:219], v4 offset:33536
    ds_read_b64_tr_b16 a[220:221], v5 offset:33024
    ds_read_b64_tr_b16 a[222:223], v5 offset:33536
    s_waitcnt vmcnt(15)
    ds_read_b64_tr_b16 a[224:225], v2 offset:0
    ds_read_b64_tr_b16 a[226:227], v2 offset:512
    ds_read_b64_tr_b16 a[228:229], v3 offset:0
    ds_read_b64_tr_b16 a[230:231], v3 offset:512
    ds_read_b64_tr_b16 a[232:233], v2 offset:256
    ds_read_b64_tr_b16 a[234:235], v2 offset:768
    ds_read_b64_tr_b16 a[236:237], v3 offset:256
    ds_read_b64_tr_b16 a[238:239], v3 offset:768
    s_waitcnt vmcnt(11)
    ds_read_b64_tr_b16 a[240:241], v2 offset:16384
    ds_read_b64_tr_b16 a[242:243], v2 offset:16896
    ds_read_b64_tr_b16 a[244:245], v3 offset:16384
    ds_read_b64_tr_b16 a[246:247], v3 offset:16896
    ds_read_b64_tr_b16 a[248:249], v2 offset:16640
    ds_read_b64_tr_b16 a[250:251], v2 offset:17152
    ds_read_b64_tr_b16 a[252:253], v3 offset:16640
    ds_read_b64_tr_b16 a[254:255], v3 offset:17152
    s_waitcnt lgkmcnt(0)
    s_branch L_p2_join
L_p3_alt:
    s_add_u32 s66, s69, 175872
    s_add_u32 s58, s66, s76
    buffer_load_dwordx4 v[152:155], v23, s[24:27], s58 offen offset:0 sc1
    buffer_load_dwordx4 v[156:159], v23, s[24:27], s58 offen offset:1024 sc1
    s_add_u32 s58, s66, s77
    buffer_load_dwordx4 v[112:115], v23, s[24:27], s58 offen offset:0 sc1
    buffer_load_dwordx4 v[116:119], v23, s[24:27], s58 offen offset:1024 sc1
    s_add_u32 s58, s66, s78
    buffer_load_dwordx4 v[120:123], v23, s[24:27], s58 offen offset:0 sc1
    buffer_load_dwordx4 v[124:127], v23, s[24:27], s58 offen offset:1024 sc1
    s_add_u32 s58, s66, s79
    buffer_load_dwordx4 v[128:131], v23, s[24:27], s58 offen offset:0 sc1
    buffer_load_dwordx4 v[132:135], v23, s[24:27], s58 offen offset:1024 sc1
    s_add_u32 s58, s66, s80
    buffer_load_dwordx4 v[136:139], v23, s[24:27], s58 offen offset:0 sc1
    buffer_load_dwordx4 v[140:143], v23, s[24:27], s58 offen offset:1024 sc1
    s_add_u32 s58, s66, s81
    buffer_load_dwordx4 v[144:147], v23, s[24:27], s58 offen offset:0 sc1
    s_waitcnt vmcnt(11) lgkmcnt(0)
    s_branch L_p3_join
L_help:
    s_sub_u32 s55, s46, 21
    v_lshlrev_b32 v217, 7, v1
    v_lshrrev_b32 v218, 2, v1
    v_lshlrev_b32 v218, 12, v218
    v_lshl_add_u32 v218, v210, 7, v218
    v_mul_u32_u24 v220, 3584, v1
    s_lshl4_add_u32 s54, s44, s65
    s_mul_i32 s54, s54, 114688
    s_lshl_b32 s56, s50, 7
    s_add_u32 s54, s54, s56
    buffer_load_dword v108, v220, s[16:19], s54 offen
    v_mul_u32_u24 v109, 1088, v25
    v_lshl_add_u32 v109, v26, 4, v109
    v_mul_u32_u24 v110, 1088, v209
    v_lshl_add_u32 v110, v208, 5, v110
    v_lshl_add_u32 v110, v210, 3, v110
    s_lshl_b32 s53, s44, 7
    v_add_u32 v110, s53, v110
    v_mul_u32_u24 v111, 66816, v208
    v_lshl_add_u32 v111, v211, 4, v111
    s_mul_i32 s63, s44, 267264
    s_lshl_b32 s53, s2, 8
    s_add_u32 s63, s63, s53
    s_add_u32 s64, s63, 1069056
    v_cmp_gt_u32 vcc, 208, v0
    v_mov_b32 v100, 2130706432
    v_cmp_le_u32 s[92:93], 24, v26
    v_cndmask_b32 v22, v100, v111, vcc
    s_mov_b32 s62, 0x3f803f80
    s_mov_b32 s61, 0xffff0000
    v_mov_b32 v96, 0
    v_mov_b32 v97, 0
    s_waitcnt vmcnt(3)
    v_dot2c_f32_bf16 v96, s62, v32
    v_dot2c_f32_bf16 v97, v32, v32
    v_lshlrev_b32 v40, 16, v32
    v_and_b32 v41, s61, v32
    v_dot2c_f32_bf16 v96, s62, v33
    v_dot2c_f32_bf16 v97, v33, v33
    v_lshlrev_b32 v42, 16, v33
    v_and_b32 v43, s61, v33
    v_dot2c_f32_bf16 v96, s62, v34
    v_dot2c_f32_bf16 v97, v34, v34
    v_lshlrev_b32 v44, 16, v34
    v_and_b32 v45, s61, v34
    v_dot2c_f32_bf16 v96, s62, v35
    v_dot2c_f32_bf16 v97, v35, v35
    v_lshlrev_b32 v46, 16, v35
    v_and_b32 v47, s61, v35
    s_waitcnt vmcnt(2)
    v_dot2c_f32_bf16 v96, s62, v36
    v_dot2c_f32_bf16 v97, v36, v36
    v_lshlrev_b32 v48, 16, v36
    v_and_b32 v49, s61, v36
    v_dot2c_f32_bf16 v96, s62, v37
    v_dot2c_f32_bf16 v97, v37, v37
    v_lshlrev_b32 v50, 16, v37
    v_and_b32 v51, s61, v37
    v_dot2c_f32_bf16 v96, s62, v38
    v_dot2c_f32_bf16 v97, v38, v38
    v_lshlrev_b32 v52, 16, v38
    v_and_b32 v53, s61, v38
    v_dot2c_f32_bf16 v96, s62, v39
    v_dot2c_f32_bf16 v97, v39, v39
    v_lshlrev_b32 v54, 16, v39
    v_and_b32 v55, s61, v39
    buffer_load_dword v29, off, s[40:43], 0 sc1
    v_add_f32_dpp v96, v96, v96 quad_perm:[1,0,3,2] row_mask:0xf bank_mask:0xf
    v_add_f32_dpp v97, v97, v97 quad_perm:[1,0,3,2] row_mask:0xf bank_mask:0xf
    s_nop 0
    v_add_f32_dpp v96, v96, v96 quad_perm:[2,3,0,1] row_mask:0xf bank_mask:0xf
    v_add_f32_dpp v97, v97, v97 quad_perm:[2,3,0,1] row_mask:0xf bank_mask:0xf
    s_nop 0
    v_add_f32_dpp v96, v96, v96 row_half_mirror row_mask:0xf bank_mask:0xf
    v_add_f32_dpp v97, v97, v97 row_half_mirror row_mask:0xf bank_mask:0xf
    s_nop 0
    v_add_f32_dpp v96, v96, v96 row_mirror row_mask:0xf bank_mask:0xf
    v_add_f32_dpp v97, v97, v97 row_mirror row_mask:0xf bank_mask:0xf
    v_mov_b32 v98, v96
    v_mov_b32 v99, v97
    s_nop 0
    v_permlane16_swap_b32 v96, v98
    v_permlane16_swap_b32 v97, v99
    v_add_f32 v96, v96, v98
    v_add_f32 v97, v97, v99
    v_mul_f32 v98, 0x3b124925, v96
    v_mul_f32 v99, 0x3b124925, v97
    v_fma_f32 v99, -v98, v98, v99
    v_max_f32 v99, 0, v99
    v_cvt_pk_bf16_f32 v100, 0, v99
    v_add_f32 v100, 0x3727c5ac, v100
    v_cvt_pk_bf16_f32 v100, 0, v100
    v_sqrt_f32 v100, v100
    s_nop 0
    v_cvt_pk_bf16_f32 v100, 0, v100
    v_rcp_f32 v100, v100
    s_nop 0
    v_mul_f32 v99, v99, v100
    v_mul_f32 v99, v99, v100
    v_cvt_pk_bf16_f32 v104, 0, v99
    v_add_f32 v104, 0x3727c5ac, v104
    v_cvt_pk_bf16_f32 v104, 0, v104
    v_sqrt_f32 v104, v104
    s_nop 0
    v_cvt_pk_bf16_f32 v102, 0, v104
    v_rcp_f32 v104, v102
    s_nop 0
    v_mul_f32 v104, v104, v100
    v_mul_f32 v106, v98, v104
    v_pk_fma_f32 v[56:57], v[40:41], v[104:105], v[106:107] op_sel_hi:[1,0,0] neg_lo:[0,0,1] neg_hi:[0,0,1]
    v_pk_fma_f32 v[58:59], v[42:43], v[104:105], v[106:107] op_sel_hi:[1,0,0] neg_lo:[0,0,1] neg_hi:[0,0,1]
    v_pk_fma_f32 v[60:61], v[44:45], v[104:105], v[106:107] op_sel_hi:[1,0,0] neg_lo:[0,0,1] neg_hi:[0,0,1]
    v_pk_fma_f32 v[62:63], v[46:47], v[104:105], v[106:107] op_sel_hi:[1,0,0] neg_lo:[0,0,1] neg_hi:[0,0,1]
    v_pk_fma_f32 v[64:65], v[48:49], v[104:105], v[106:107] op_sel_hi:[1,0,0] neg_lo:[0,0,1] neg_hi:[0,0,1]
    v_pk_fma_f32 v[66:67], v[50:51], v[104:105], v[106:107] op_sel_hi:[1,0,0] neg_lo:[0,0,1] neg_hi:[0,0,1]
    v_pk_fma_f32 v[68:69], v[52:53], v[104:105], v[106:107] op_sel_hi:[1,0,0] neg_lo:[0,0,1] neg_hi:[0,0,1]
    v_pk_fma_f32 v[70:71], v[54:55], v[104:105], v[106:107] op_sel_hi:[1,0,0] neg_lo:[0,0,1] neg_hi:[0,0,1]
    v_cvt_pk_bf16_f32 v80, v56, v57
    v_cvt_pk_bf16_f32 v81, v58, v59
    v_cvt_pk_bf16_f32 v82, v60, v61
    v_cvt_pk_bf16_f32 v83, v62, v63
    v_cvt_pk_bf16_f32 v84, v64, v65
    v_cvt_pk_bf16_f32 v85, v66, v67
    v_cvt_pk_bf16_f32 v86, v68, v69
    v_cvt_pk_bf16_f32 v87, v70, v71
    v_lshrrev_b32 v102, 16, v102
    v_cndmask_b32 v84, v84, v102, s[92:93]
    ds_write_b128 v109, v[80:83] offset:0
    ds_write_b128 v109, v[84:87] offset:512
    s_waitcnt lgkmcnt(0)
    s_barrier
    ds_read_b64_tr_b16 v[88:89], v110 offset:0
    ds_read_b64_tr_b16 v[90:91], v110 offset:4352
    ds_read_b64_tr_b16 v[92:93], v110 offset:512
    ds_read_b64_tr_b16 v[94:95], v110 offset:4864
    s_waitcnt lgkmcnt(2)
    buffer_store_dwordx4 v[88:91], v111, s[24:27], s63 offen sc1
    s_waitcnt lgkmcnt(0)
    buffer_store_dwordx4 v[92:95], v22, s[24:27], s64 offen sc1
    v_min_u32 v220, 111104, v220
    s_add_u32 s54, s54, 229376
    buffer_load_dword v108, v220, s[16:19], s54 offen
    s_waitcnt vmcnt(1)
    v_cmp_eq_u32 vcc, 0, v29
    s_nop 0
    s_cbranch_vccz L_ok12
    s_mov_b32 s59, 20000
L_spin11:
    buffer_load_dword v29, off, s[40:43], 0 sc1
    s_waitcnt vmcnt(0)
    v_cmp_eq_u32 vcc, 0, v29
    s_nop 0
    s_cbranch_vccz L_ok12
    s_sub_u32 s59, s59, 1
    s_cbranch_scc0 L_spin11
L_ok12:
    v_readfirstlane_b32 s47, v29
    s_barrier
    s_cmp_lg_u32 s44, 0
    s_cbranch_scc1 L_nopub13
    s_lshl_b32 s60, s2, 5
    s_add_u32 s60, s60, 12582912
    v_mov_b32 v30, s47
    s_mov_b64 exec, 1
    buffer_store_dword v30, off, s[24:27], s60 sc1
    s_mov_b64 exec, -1
L_nopub13:
    buffer_load_dword v108, v217, s[32:35], 0 offen
    v_lshrrev_b32 v219, 2, v1
    v_min_u32 v219, 15, v219
    v_mul_u32_u24 v219, 3584, v219
    v_lshl_add_u32 v219, v210, 7, v219
    s_mul_i32 s54, s55, 16
    s_lshl_b32 s56, s44, 9
    s_add_u32 s54, s54, s56
    s_add_u32 s54, s54, 416
    s_mul_i32 s54, s54, 3584
    s_mul_i32 s56, s45, 7
    s_lshr_b32 s56, s56, 1
    s_lshl_b32 s56, s56, 7
    s_add_u32 s54, s54, s56
    buffer_load_dword v108, v219, s[16:19], s54 offen
    s_add_u32 s54, s54, 172032
    buffer_load_dword v108, v219, s[16:19], s54 offen
    s_add_u32 s54, s54, 172032
    s_lshl_b32 s54, s44, 11
    s_add_u32 s54, s54, 12582912
    v_lshl_add_u32 v221, v1, 5, s54
    buffer_load_dword v222, v221, s[24:27], 0 offen sc1
    s_waitcnt vmcnt(0)
    v_cmp_ne_u32 vcc, s47, v222
    s_nop 0
    s_cbranch_vccz L_ok15
    s_mov_b32 s59, 20000
L_spin14:
    buffer_load_dword v222, v221, s[24:27], 0 offen sc1
    s_waitcnt vmcnt(0)
    v_cmp_ne_u32 vcc, s47, v222
    s_nop 0
    s_cbranch_vccz L_ok15
    s_sub_u32 s59, s59, 1
    s_cbranch_scc0 L_spin14
L_ok15:
    s_add_u32 s54, s55, 0
    s_lshr_b32 s56, s54, 1
    s_add_u32 s56, s56, 24
    s_mul_i32 s56, s56, 66816
    s_lshl2_add_u32 s56, s52, s56
    s_and_b32 s54, s54, 1
    s_lshl_b32 s54, s54, 13
    s_add_u32 s56, s56, s54
    buffer_load_dword v108, v217, s[24:27], s56 offen sc1
    s_add_u32 s54, s55, 3
    s_lshr_b32 s56, s54, 1
    s_add_u32 s56, s56, 24
    s_mul_i32 s56, s56, 66816
    s_lshl2_add_u32 s56, s52, s56
    s_and_b32 s54, s54, 1
    s_lshl_b32 s54, s54, 13
    s_add_u32 s56, s56, s54
    buffer_load_dword v108, v217, s[24:27], s56 offen sc1
    s_add_u32 s54, s55, 6
    s_lshr_b32 s56, s54, 1
    s_add_u32 s56, s56, 24
    s_mul_i32 s56, s56, 66816
    s_lshl2_add_u32 s56, s52, s56
    s_and_b32 s54, s54, 1
    s_lshl_b32 s54, s54, 13
    s_add_u32 s56, s56, s54
    s_cmp_lt_u32 s55, 2
    s_cselect_b32 s56, s56, 2130706432
    buffer_load_dword v108, v217, s[24:27], s56 offen sc1
    s_mul_i32 s54, s44, 28
    s_add_u32 s54, s54, s55
    s_add_u32 s54, s54, 0
    s_lshl_b32 s54, s54, 16
    s_lshl_b32 s56, s45, 9
    s_add_u32 s54, s54, s56
    buffer_load_dword v108, v218, s[20:23], s54 offen
    s_add_u32 s54, s54, 196608
    buffer_load_dword v108, v218, s[20:23], s54 offen
    s_add_u32 s54, s54, 196608
    buffer_load_dword v108, v218, s[20:23], s54 offen
    s_add_u32 s54, s54, 196608
    buffer_load_dword v108, v218, s[20:23], s54 offen
    s_add_u32 s54, s54, 196608
    buffer_load_dword v108, v217, s[36:39], 0 offen
    s_waitcnt vmcnt(0) lgkmcnt(0)
    v_lshlrev_b32 v216, 6, v209
    v_lshl_add_u32 v216, v210, 3, v216
    v_lshl_add_u32 v216, v215, 5, v216
    s_add_u32 s53, s52, 49152
    v_lshl_add_u32 v2, v208, 10, v216
    v_add_u32 v2, s53, v2
    v_xor_b32 v3, 32, v2
    v_add_u32 v4, 65536, v2
    v_add_u32 v5, 65536, v3
    v_lshl_add_u32 v6, v208, 9, v216
    v_add_u32 v6, s53, v6
    v_xor_b32 v7, 32, v6
    v_add_u32 v8, 65536, v6
    v_add_u32 v9, 65536, v7
    s_lshr_b32 s53, s46, 2
    s_and_b32 s89, s46, 3
    s_bfe_u32 s54, s46, 0x20001
    s_and_b32 s55, s46, 1
    s_add_u32 s55, s55, 4
    s_cmp_lt_u32 s46, 16
    s_cselect_b32 s53, s53, s54
    s_cselect_b32 s89, s89, s55
    s_mul_i32 s49, s53, 2
    s_add_u32 s49, s49, s89
    s_sub_u32 s54, s49, 6
    s_min_u32 s49, s49, s54
    s_or_b32 s89, s89, 0
    s_lshl2_add_u32 s48, s45, s53
    s_mul_i32 s53, s44, 1835008
    s_lshl_b32 s74, s48, 7
    s_add_u32 s53, s53, s74
    s_lshl_b32 s56, s44, 5
    v_lshlrev_b32 v217, 5, v212
    v_xor_b32 v217, v217, v214
    v_xor_b32 v217, s56, v217
    s_add_u32 s74, s74, s56
    v_lshlrev_b32 v12, 12, v213
    v_add3_u32 v12, v12, v217, s53
    s_mul_i32 s53, s44, 28672
    s_lshl_b32 s54, s49, 7
    s_add_u32 s55, s53, s54
    v_mul_u32_u24 v13, 896, v213
    v_add3_u32 v13, v13, v214, s55
    v_xor_b32 v14, 32, v13
    s_mul_i32 s55, s44, 21504
    v_subrev_u32 v239, s55, v13
    s_and_b32 s55, s56, 32
    v_xor_b32 v239, s55, v239
    s_mul_i32 s73, s48, 57344
    s_add_u32 s71, s73, s54
    s_mul_i32 s55, s44, 14336
    s_add_u32 s71, s71, s55
    s_add_u32 s72, s71, 7168
    v_bfe_u32 v217, v1, 1, 2
    v_lshl_add_u32 v217, v212, 2, v217
    v_and_b32 v218, 24, v1
    v_add_u32 v217, v217, v218
    v_mul_u32_u24 v15, 896, v217
    v_and_b32 v217, 1, v1
    v_lshl_add_u32 v15, v217, 4, v15
    v_add_u32 v15, s53, v15
    s_lshl_b32 s54, s89, 5
    s_add_u32 s54, s54, 768
    s_add_u32 s68, s89, 24
    s_mul_i32 s68, s68, 58624
    s_mul_i32 s69, s44, 14336
    s_add_u32 s69, s69, 2097152
    s_add_u32 s68, s68, s69
    s_mul_i32 s55, s49, 234496
    s_add_u32 s69, s69, s55
    s_add_u32 s73, s73, s54
    s_mov_b32 s76, 0
    s_add_u32 s77, s76, 2048
    s_cmp_eq_u32 s77, 14336
    s_cselect_b32 s77, 0, s77
    s_add_u32 s78, s77, 2048
    s_cmp_eq_u32 s78, 14336
    s_cselect_b32 s78, 0, s78
    s_add_u32 s79, s78, 2048
    s_cmp_eq_u32 s79, 14336
    s_cselect_b32 s79, 0, s79
    s_add_u32 s80, s79, 2048
    s_cmp_eq_u32 s80, 14336
    s_cselect_b32 s80, 0, s80
    s_add_u32 s81, s80, 2048
    s_cmp_eq_u32 s81, 14336
    s_cselect_b32 s81, 0, s81
    s_add_u32 s82, s81, 2048
    s_cmp_eq_u32 s82, 14336
    s_cselect_b32 s82, 0, s82
    s_cmp_lt_u32 s89, 4
    s_cselect_b32 s75, s54, 2130706432
    s_cselect_b32 s68, s68, 2130706432
    s_cselect_b32 s73, s73, 2130706432
    v_lshlrev_b32 v16, 3, v1
    v_add_u32 v16, 81920, v16
    v_and_b32 v217, 7, v1
    v_min_u32 v218, 6, v217
    s_mul_i32 s54, s44, 7
    v_add_u32 v218, s54, v218
    v_mul_u32_u24 v219, 2, v218
    v_add_u32 v219, s89, v219
    v_mul_u32_u24 v220, 43, v219
    v_lshrrev_b32 v220, 8, v220
    v_mul_u32_u24 v220, 6, v220
    v_sub_u32 v219, v219, v220
    v_subrev_u32 v219, s49, v219
    v_bfe_u32 v220, v1, 3, 1
    v_mul_i32_i24 v219, v219, v220
    v_add_u32 v219, s49, v219
    v_lshl_add_u32 v218, v219, 5, v218
    v_lshlrev_b32 v20, 7, v218
    v_add_u32 v20, 12713984, v20
    s_lshr_b32 s53, s48, 1
    s_lshl_b32 s53, s53, 7
    s_add_u32 s53, s53, 12779520
    v_lshl_add_u32 v21, v210, 11, s53
    s_lshl_b32 s70, s48, 16
    s_lshl2_add_u32 s70, s52, s70
    s_add_u32 s70, s70, 4194304
    v_lshrrev_b32 v218, 3, v1
    v_mul_u32_u24 v22, 896, v218
    v_lshl_add_u32 v22, v217, 4, v22
    v_lshlrev_b32 v25, 1, v211
    s_add_u32 s53, s52, 65536
    v_mul_u32_u24 v244, 176, v218
    v_lshl_add_u32 v244, v217, 4, v244
    v_add_u32 v244, s53, v244
    v_mul_u32_u24 v238, 176, v211
    v_lshl_add_u32 v238, v208, 3, v238
    v_add_u32 v238, s53, v238
    v_lshrrev_b32 v218, 2, v0
    v_mul_u32_u24 v26, 896, v218
    v_lshl_add_u32 v26, v210, 3, v26
    v_lshrrev_b32 v218, 2, v1
    v_mul_u32_u24 v252, 176, v218
    v_lshl_add_u32 v252, v210, 3, v252
    v_add_u32 v252, s53, v252
    s_sub_u32 s53, 49152, s52
    v_add_u32 v246, s53, v2
    v_add_u32 v247, s53, v3
    v_mul_u32_u24 v218, 3072, v208
    v_add_u32 v248, v218, v246
    v_add_u32 v249, v218, v247
    v_add_u32 v232, s52, v23
    v_xor_b32 v233, 4096, v232
    v_xor_b32 v234, 8192, v232
    v_xor_b32 v235, 12288, v232
    buffer_load_dwordx4 v[216:219], v22, s[4:7], s71 offen
    buffer_load_dwordx4 v[220:223], v22, s[4:7], s72 offen
    buffer_load_dwordx2 v[224:225], v26, s[4:7], s73 offen
    buffer_load_ushort v228, v25, s[36:39], s74 offen
    s_waitcnt vmcnt(0)
    ds_write_b128 v244, v[216:219]
    ds_write_b128 v244, v[220:223] offset:1408
    ds_write_b64 v252, v[224:225] offset:128
    ds_read_b64 v[216:217], v238 offset:0
    ds_read_b64 v[218:219], v238 offset:32
    ds_read_b64 v[220:221], v238 offset:64
    ds_read_b64 v[222:223], v238 offset:96
    ds_read_b64 v[224:225], v238 offset:128
    s_add_u32 m0, s52, 81920
    s_lshl_b32 s57, s76, 7
    buffer_load_dwordx4 v12, s[20:23], s57 offen offset:0 lds
    s_add_u32 s57, s57, 31744
    buffer_load_dwordx4 v12, s[20:23], s57 offen offset:1024 lds
    s_add_u32 s57, s57, 31744
    buffer_load_dwordx4 v12, s[20:23], s57 offen offset:2048 lds
    s_add_u32 s57, s57, 31744
    buffer_load_dwordx4 v12, s[20:23], s57 offen offset:3072 lds
    s_add_u32 m0, s52, 98304
    s_lshl_b32 s57, s76, 7
    s_add_u32 s57, s57, 131072
    buffer_load_dwordx4 v12, s[20:23], s57 offen offset:0 lds
    s_add_u32 s57, s57, 31744
    buffer_load_dwordx4 v12, s[20:23], s57 offen offset:1024 lds
    s_add_u32 s57, s57, 31744
    buffer_load_dwordx4 v12, s[20:23], s57 offen offset:2048 lds
    s_add_u32 s57, s57, 31744
    buffer_load_dwordx4 v12, s[20:23], s57 offen offset:3072 lds
    s_add_u32 m0, s52, 114688
    s_lshl_b32 s57, s77, 7
    buffer_load_dwordx4 v12, s[20:23], s57 offen offset:0 lds
    s_add_u32 s57, s57, 31744
    buffer_load_dwordx4 v12, s[20:23], s57 offen offset:1024 lds
    s_add_u32 s57, s57, 31744
    buffer_load_dwordx4 v12, s[20:23], s57 offen offset:2048 lds
    s_add_u32 s57, s57, 31744
    buffer_load_dwordx4 v12, s[20:23], s57 offen offset:3072 lds
    s_add_u32 m0, s52, 131072
    s_lshl_b32 s57, s77, 7
    s_add_u32 s57, s57, 131072
    buffer_load_dwordx4 v12, s[20:23], s57 offen offset:0 lds
    s_add_u32 s57, s57, 31744
    buffer_load_dwordx4 v12, s[20:23], s57 offen offset:1024 lds
    s_waitcnt vmcnt(10)
    ds_read_b64_tr_b16 a[0:1], v6 offset:32768
    ds_read_b64_tr_b16 a[2:3], v6 offset:34816
    ds_read_b64_tr_b16 a[4:5], v7 offset:32768
    ds_read_b64_tr_b16 a[6:7], v7 offset:34816
    ds_read_b64_tr_b16 a[8:9], v6 offset:33024
    ds_read_b64_tr_b16 a[10:11], v6 offset:35072
    ds_read_b64_tr_b16 a[12:13], v7 offset:33024
    ds_read_b64_tr_b16 a[14:15], v7 offset:35072
    s_add_u32 s57, s57, 31744
    buffer_load_dwordx4 v12, s[20:23], s57 offen offset:2048 lds
    s_add_u32 s57, s57, 31744
    buffer_load_dwordx4 v12, s[20:23], s57 offen offset:3072 lds
    s_add_u32 m0, s52, 147456
    s_lshl_b32 s57, s78, 7
    buffer_load_dwordx4 v12, s[20:23], s57 offen offset:0 lds
    s_add_u32 s57, s57, 31744
    buffer_load_dwordx4 v12, s[20:23], s57 offen offset:1024 lds
    s_waitcnt vmcnt(10)
    ds_read_b64_tr_b16 a[16:17], v6 offset:49152
    ds_read_b64_tr_b16 a[18:19], v6 offset:51200
    ds_read_b64_tr_b16 a[20:21], v7 offset:49152
    ds_read_b64_tr_b16 a[22:23], v7 offset:51200
    ds_read_b64_tr_b16 a[24:25], v6 offset:49408
    ds_read_b64_tr_b16 a[26:27], v6 offset:51456
    ds_read_b64_tr_b16 a[28:29], v7 offset:49408
    ds_read_b64_tr_b16 a[30:31], v7 offset:51456
    s_add_u32 s57, s57, 31744
    buffer_load_dwordx4 v12, s[20:23], s57 offen offset:2048 lds
    s_add_u32 s57, s57, 31744
    buffer_load_dwordx4 v12, s[20:23], s57 offen offset:3072 lds
    s_add_u32 m0, s52, 49152
    s_lshl_b32 s57, s78, 7
    s_add_u32 s57, s57, 131072
    buffer_load_dwordx4 v12, s[20:23], s57 offen offset:0 lds
    s_add_u32 s57, s57, 31744
    buffer_load_dwordx4 v12, s[20:23], s57 offen offset:1024 lds
    s_waitcnt vmcnt(10)
    ds_read_b64_tr_b16 a[32:33], v8 offset:0
    ds_read_b64_tr_b16 a[34:35], v8 offset:2048
    ds_read_b64_tr_b16 a[36:37], v9 offset:0
    ds_read_b64_tr_b16 a[38:39], v9 offset:2048
    ds_read_b64_tr_b16 a[40:41], v8 offset:256
    ds_read_b64_tr_b16 a[42:43], v8 offset:2304
    ds_read_b64_tr_b16 a[44:45], v9 offset:256
    ds_read_b64_tr_b16 a[46:47], v9 offset:2304
    s_add_u32 s57, s57, 31744
    buffer_load_dwordx4 v12, s[20:23], s57 offen offset:2048 lds
    s_add_u32 s57, s57, 31744
    buffer_load_dwordx4 v12, s[20:23], s57 offen offset:3072 lds
    s_waitcnt lgkmcnt(15)
    s_add_u32 m0, s52, 65536
    s_lshl_b32 s57, s79, 7
    buffer_load_dwordx4 v12, s[20:23], s57 offen offset:0 lds
    s_add_u32 s57, s57, 31744
    buffer_load_dwordx4 v12, s[20:23], s57 offen offset:1024 lds
    s_waitcnt vmcnt(10)
    ds_read_b64_tr_b16 a[48:49], v8 offset:16384
    ds_read_b64_tr_b16 a[50:51], v8 offset:18432
    ds_read_b64_tr_b16 a[52:53], v9 offset:16384
    ds_read_b64_tr_b16 a[54:55], v9 offset:18432
    s_add_u32 s57, s57, 31744
    buffer_load_dwordx4 v12, s[20:23], s57 offen offset:2048 lds
    ds_read_b64_tr_b16 a[56:57], v8 offset:16640
    ds_read_b64_tr_b16 a[58:59], v8 offset:18688
    ds_read_b64_tr_b16 a[60:61], v9 offset:16640
    ds_read_b64_tr_b16 a[62:63], v9 offset:18688
    s_add_u32 s57, s57, 31744
    buffer_load_dwordx4 v12, s[20:23], s57 offen offset:3072 lds
    s_add_u32 m0, s52, 81920
    s_lshl_b32 s57, s79, 7
    s_add_u32 s57, s57, 131072
    buffer_load_dwordx4 v12, s[20:23], s57 offen offset:0 lds
    s_add_u32 s57, s57, 31744
    buffer_load_dwordx4 v12, s[20:23], s57 offen offset:1024 lds
    s_waitcnt vmcnt(10)
    ds_read_b64_tr_b16 a[64:65], v8 offset:32768
    ds_read_b64_tr_b16 a[66:67], v8 offset:34816
    ds_read_b64_tr_b16 a[68:69], v9 offset:32768
    ds_read_b64_tr_b16 a[70:71], v9 offset:34816
    s_add_u32 s57, s57, 31744
    buffer_load_dwordx4 v12, s[20:23], s57 offen offset:2048 lds
    ds_read_b64_tr_b16 a[72:73], v8 offset:33024
    ds_read_b64_tr_b16 a[74:75], v8 offset:35072
    ds_read_b64_tr_b16 a[76:77], v9 offset:33024
    ds_read_b64_tr_b16 a[78:79], v9 offset:35072
    s_add_u32 s57, s57, 31744
    buffer_load_dwordx4 v12, s[20:23], s57 offen offset:3072 lds
    s_waitcnt lgkmcnt(15)
    s_add_u32 m0, s52, 98304
    s_lshl_b32 s57, s80, 7
    buffer_load_dwordx4 v12, s[20:23], s57 offen offset:0 lds
    s_waitcnt vmcnt(0) lgkmcnt(0)
    s_branch L_p3join
L_role_a:
    v_lshrrev_b32 v112, 4, v1
    v_bfe_u32 v113, v1, 2, 2
    v_and_b32 v114, 3, v1
    v_and_b32 v115, 15, v1
    v_lshrrev_b32 v116, 5, v1
    s_lshr_b32 s48, s45, 1
    s_and_b32 s53, s45, 1
    s_lshl3_add_u32 s49, s53, s46
    s_sub_u32 s49, s49, 24
    s_lshl_b32 s90, s44, 11
    s_and_b32 s53, s44, 1
    s_lshl_b32 s53, s53, 1
    v_lshlrev_b32 v117, 2, v112
    v_sub_u32 v117, v115, v117
    v_and_b32 v117, 15, v117
    v_xor_b32 v117, s53, v117
    v_mul_u32_u24 v2, 2688, v112
    v_lshl_add_u32 v2, v117, 4, v2
    s_mul_i32 s53, s44, 21504
    s_mul_i32 s54, s48, 224
    s_andn2_b32 s54, s54, 63
    s_add_u32 s53, s53, s54
    v_add_u32 v2, s53, v2
    s_add_u32 m0, s90, 65536
    s_mov_b32 s57, 896
    buffer_load_dwordx4 v2, s[8:11], s57 offen offset:0 lds
    s_mov_b32 s57, 10624
    buffer_load_dwordx4 v2, s[8:11], s57 offen offset:1024 lds
    s_add_u32 m0, s90, 73728
    s_mov_b32 s57, 86912
    buffer_load_dwordx4 v2, s[8:11], s57 offen offset:0 lds
    s_mov_b32 s57, 96640
    buffer_load_dwordx4 v2, s[8:11], s57 offen offset:1024 lds
    v_mul_u32_u24 v109, 1088, v25
    v_lshl_add_u32 v109, v26, 4, v109
    v_mul_u32_u24 v110, 1088, v113
    v_lshl_add_u32 v110, v112, 5, v110
    v_lshl_add_u32 v110, v114, 3, v110
    s_lshl_b32 s53, s44, 7
    v_add_u32 v110, s53, v110
    v_mul_u32_u24 v111, 66816, v112
    v_lshl_add_u32 v111, v115, 4, v111
    s_mul_i32 s63, s44, 267264
    s_lshl_b32 s53, s2, 8
    s_add_u32 s63, s63, s53
    s_add_u32 s64, s63, 1069056
    v_cmp_gt_u32 vcc, 208, v0
    v_mov_b32 v100, 2130706432
    v_cmp_le_u32 s[92:93], 24, v26
    v_cndmask_b32 v22, v100, v111, vcc
    s_mov_b32 s62, 0x3f803f80
    s_mov_b32 s61, 0xffff0000
    v_mov_b32 v96, 0
    v_mov_b32 v97, 0
    v_and_b32 v117, 1, v112
    v_lshlrev_b32 v117, 5, v117
    s_mul_i32 s53, s44, 56
    s_and_b32 s54, s48, 1
    s_lshl_b32 s54, s54, 5
    s_add_u32 s53, s53, s54
    v_lshlrev_b32 v118, 11, v112
    v_lshl_add_u32 v118, v113, 8, v118
    v_add_u32 v118, 65536, v118
    v_lshl_add_u32 v119, v114, 3, s53
    v_add_u32 v119, 0, v119
    v_xor_b32 v119, v119, v117
    v_lshl_add_u32 v119, v113, 6, v119
    v_and_b32 v119, 255, v119
    v_add_u32 v6, v118, v119
    v_add_u32 v10, 49152, v6
    v_subrev_u32 v120, 65536, v6
    v_lshl_add_u32 v119, v114, 3, s53
    v_add_u32 v119, 32, v119
    v_xor_b32 v119, v119, v117
    v_lshl_add_u32 v119, v113, 6, v119
    v_and_b32 v119, 255, v119
    v_add_u32 v7, v118, v119
    v_add_u32 v11, 49152, v7
    v_subrev_u32 v121, 65536, v7
    s_and_b32 s54, s44, 1
    s_lshl_b32 s54, s54, 3
    s_sub_u32 s53, s53, s54
    v_lshl_add_u32 v119, v114, 4, s53
    v_add_u32 v119, 0, v119
    v_xor_b32 v119, v119, v117
    v_lshl_add_u32 v119, v113, 6, v119
    v_and_b32 v119, 255, v119
    v_add_u32 v8, v118, v119
    v_add_u32 v12, 49152, v8
    v_subrev_u32 v122, 65536, v8
    v_lshl_add_u32 v119, v114, 4, s53
    v_add_u32 v119, 8, v119
    v_xor_b32 v119, v119, v117
    v_lshl_add_u32 v119, v113, 6, v119
    v_and_b32 v119, 255, v119
    v_add_u32 v9, v118, v119
    v_add_u32 v13, 49152, v9
    v_subrev_u32 v123, 65536, v9
    s_waitcnt vmcnt(6)
    v_dot2c_f32_bf16 v96, s62, v32
    v_dot2c_f32_bf16 v97, v32, v32
    v_lshlrev_b32 v40, 16, v32
    v_and_b32 v41, s61, v32
    v_dot2c_f32_bf16 v96, s62, v33
    v_dot2c_f32_bf16 v97, v33, v33
    v_lshlrev_b32 v42, 16, v33
    v_and_b32 v43, s61, v33
    v_dot2c_f32_bf16 v96, s62, v34
    v_dot2c_f32_bf16 v97, v34, v34
    v_lshlrev_b32 v44, 16, v34
    v_and_b32 v45, s61, v34
    v_dot2c_f32_bf16 v96, s62, v35
    v_dot2c_f32_bf16 v97, v35, v35
    v_lshlrev_b32 v46, 16, v35
    v_and_b32 v47, s61, v35
    s_waitcnt vmcnt(5)
    v_dot2c_f32_bf16 v96, s62, v36
    v_dot2c_f32_bf16 v97, v36, v36
    v_lshlrev_b32 v48, 16, v36
    v_and_b32 v49, s61, v36
    v_dot2c_f32_bf16 v96, s62, v37
    v_dot2c_f32_bf16 v97, v37, v37
    v_lshlrev_b32 v50, 16, v37
    v_and_b32 v51, s61, v37
    v_dot2c_f32_bf16 v96, s62, v38
    v_dot2c_f32_bf16 v97, v38, v38
    v_lshlrev_b32 v52, 16, v38
    v_and_b32 v53, s61, v38
    v_dot2c_f32_bf16 v96, s62, v39
    v_dot2c_f32_bf16 v97, v39, v39
    v_lshlrev_b32 v54, 16, v39
    v_and_b32 v55, s61, v39
    buffer_load_dword v29, off, s[40:43], 0 sc1
    v_add_f32_dpp v96, v96, v96 quad_perm:[1,0,3,2] row_mask:0xf bank_mask:0xf
    v_add_f32_dpp v97, v97, v97 quad_perm:[1,0,3,2] row_mask:0xf bank_mask:0xf
    s_nop 0
    v_add_f32_dpp v96, v96, v96 quad_perm:[2,3,0,1] row_mask:0xf bank_mask:0xf
    v_add_f32_dpp v97, v97, v97 quad_perm:[2,3,0,1] row_mask:0xf bank_mask:0xf
    s_nop 0
    v_add_f32_dpp v96, v96, v96 row_half_mirror row_mask:0xf bank_mask:0xf
    v_add_f32_dpp v97, v97, v97 row_half_mirror row_mask:0xf bank_mask:0xf
    s_nop 0
    v_add_f32_dpp v96, v96, v96 row_mirror row_mask:0xf bank_mask:0xf
    v_add_f32_dpp v97, v97, v97 row_mirror row_mask:0xf bank_mask:0xf
    v_mov_b32 v98, v96
    v_mov_b32 v99, v97
    s_nop 0
    v_permlane16_swap_b32 v96, v98
    v_permlane16_swap_b32 v97, v99
    v_add_f32 v96, v96, v98
    v_add_f32 v97, v97, v99
    v_mul_f32 v98, 0x3b124925, v96
    v_mul_f32 v99, 0x3b124925, v97
    v_fma_f32 v99, -v98, v98, v99
    v_max_f32 v99, 0, v99
    v_cvt_pk_bf16_f32 v100, 0, v99
    v_add_f32 v100, 0x3727c5ac, v100
    v_cvt_pk_bf16_f32 v100, 0, v100
    v_sqrt_f32 v100, v100
    s_nop 0
    v_cvt_pk_bf16_f32 v100, 0, v100
    v_rcp_f32 v100, v100
    s_nop 0
    v_mul_f32 v99, v99, v100
    v_mul_f32 v99, v99, v100
    v_cvt_pk_bf16_f32 v104, 0, v99
    v_add_f32 v104, 0x3727c5ac, v104
    v_cvt_pk_bf16_f32 v104, 0, v104
    v_sqrt_f32 v104, v104
    s_nop 0
    v_cvt_pk_bf16_f32 v102, 0, v104
    v_rcp_f32 v104, v102
    s_nop 0
    v_mul_f32 v104, v104, v100
    v_mul_f32 v106, v98, v104
    v_pk_fma_f32 v[56:57], v[40:41], v[104:105], v[106:107] op_sel_hi:[1,0,0] neg_lo:[0,0,1] neg_hi:[0,0,1]
    v_pk_fma_f32 v[58:59], v[42:43], v[104:105], v[106:107] op_sel_hi:[1,0,0] neg_lo:[0,0,1] neg_hi:[0,0,1]
    v_pk_fma_f32 v[60:61], v[44:45], v[104:105], v[106:107] op_sel_hi:[1,0,0] neg_lo:[0,0,1] neg_hi:[0,0,1]
    v_pk_fma_f32 v[62:63], v[46:47], v[104:105], v[106:107] op_sel_hi:[1,0,0] neg_lo:[0,0,1] neg_hi:[0,0,1]
    v_pk_fma_f32 v[64:65], v[48:49], v[104:105], v[106:107] op_sel_hi:[1,0,0] neg_lo:[0,0,1] neg_hi:[0,0,1]
    v_pk_fma_f32 v[66:67], v[50:51], v[104:105], v[106:107] op_sel_hi:[1,0,0] neg_lo:[0,0,1] neg_hi:[0,0,1]
    v_pk_fma_f32 v[68:69], v[52:53], v[104:105], v[106:107] op_sel_hi:[1,0,0] neg_lo:[0,0,1] neg_hi:[0,0,1]
    v_pk_fma_f32 v[70:71], v[54:55], v[104:105], v[106:107] op_sel_hi:[1,0,0] neg_lo:[0,0,1] neg_hi:[0,0,1]
    v_cvt_pk_bf16_f32 v80, v56, v57
    v_cvt_pk_bf16_f32 v81, v58, v59
    v_cvt_pk_bf16_f32 v82, v60, v61
    v_cvt_pk_bf16_f32 v83, v62, v63
    v_cvt_pk_bf16_f32 v84, v64, v65
    v_cvt_pk_bf16_f32 v85, v66, v67
    v_cvt_pk_bf16_f32 v86, v68, v69
    v_cvt_pk_bf16_f32 v87, v70, v71
    v_lshrrev_b32 v102, 16, v102
    v_cndmask_b32 v84, v84, v102, s[92:93]
    ds_write_b128 v109, v[80:83] offset:49152
    ds_write_b128 v109, v[84:87] offset:49664
    s_waitcnt lgkmcnt(0)
    s_barrier
    ds_read_b64_tr_b16 v[88:89], v110 offset:49152
    ds_read_b64_tr_b16 v[90:91], v110 offset:53504
    ds_read_b64_tr_b16 v[92:93], v110 offset:49664
    ds_read_b64_tr_b16 v[94:95], v110 offset:54016
    s_waitcnt lgkmcnt(2)
    buffer_store_dwordx4 v[88:91], v111, s[24:27], s63 offen sc1
    s_waitcnt lgkmcnt(0)
    buffer_store_dwordx4 v[92:95], v22, s[24:27], s64 offen sc1
    s_add_u32 m0, s90, 81920
    s_mov_b32 s57, 172928
    buffer_load_dwordx4 v2, s[8:11], s57 offen offset:0 lds
    s_movk_i32 s94, 224
    v_mul_u32_u24 v3, 66816, v116
    v_and_b32 v118, 1, v112
    v_lshlrev_b32 v119, 2, v118
    v_xor_b32 v119, v119, v115
    v_lshl_add_u32 v3, v118, 8, v3
    v_lshl_add_u32 v3, v119, 4, v3
    v_cmp_gt_u32 s[92:93], s94, v0
    v_mov_b32 v119, 2130706432
    s_mov_b32 s57, 182656
    buffer_load_dwordx4 v2, s[8:11], s57 offen offset:1024 lds
    v_lshlrev_b32 v4, 9, v116
    v_cndmask_b32 v24, v119, v3, s[92:93]
    v_lshl_add_u32 v4, v118, 7, v4
    v_lshl_add_u32 v4, v113, 4, v4
    v_lshrrev_b32 v118, 1, v114
    v_mul_u32_u24 v118, 320, v118
    v_add_u32 v4, v118, v4
    v_and_b32 v118, 1, v114
    v_lshl_add_u32 v4, v118, 3, v4
    v_xor_b32 v25, 64, v4
    s_lshl_b32 s53, s49, 4
    s_sub_u32 s53, s53, 2
    v_min_u32 v117, 17, v1
    v_add_u32 v117, s53, v117
    v_max_i32 v117, 0, v117
    v_lshlrev_b32 v19, 5, v117
    s_add_u32 m0, s90, 90112
    s_mov_b32 s57, 258944
    buffer_load_dwordx4 v2, s[8:11], s57 offen offset:0 lds
    v_add_u32 v19, 12582912, v19
    v_and_b32 v117, 1, v115
    v_cmp_eq_u32 s[76:77], 1, v117
    v_lshl_add_u32 v117, v112, 2, v117
    v_cmp_le_u32 s[78:79], v117, v115
    v_mul_u32_u24 v118, 304, v116
    v_lshl_add_u32 v93, v117, 1, v118
    v_add_u32 v117, 2, v117
    v_cmp_le_u32 s[80:81], v117, v115
    v_add_u32 v94, 4, v93
    v_mov_b32 v118, 14336
    v_mov_b32 v119, 30720
    v_cndmask_b32 v117, v118, v119, s[78:79]
    v_add_u32 v93, v117, v93
    v_cndmask_b32 v117, v118, v119, s[80:81]
    v_add_u32 v94, v117, v94
    s_mov_b32 s57, 268672
    buffer_load_dwordx4 v2, s[8:11], s57 offen offset:1024 lds
    v_lshrrev_b32 v117, 3, v115
    v_mul_u32_u24 v117, 304, v117
    v_lshl_add_u32 v92, v115, 1, v117
    v_add_u32 v92, v119, v92
    v_cmp_eq_u32 s[82:83], 3, v112
    v_mov_b32 v117, 0xffff
    v_mov_b32 v118, 0xffff0000
    v_cndmask_b32 v117, v117, v118, s[76:77]
    v_cndmask_b32 v14, v117, 0, s[78:79]
    v_cndmask_b32 v15, v117, 0, s[80:81]
    v_cndmask_b32 v16, 0, v117, s[78:79]
    v_cndmask_b32 v17, 0, v117, s[80:81]
    s_mov_b32 s91, 0x3e8b97f6
    v_mov_b32 v18, 0xf149f2ca
    s_lshl_b32 s53, s49, 3
    s_lshl_b32 s72, s53, 9
    s_add_u32 m0, s90, 98304
    s_mov_b32 s57, 344960
    buffer_load_dwordx4 v2, s[8:11], s57 offen offset:0 lds
    s_lshl_b32 s74, s53, 14
    s_lshl2_add_u32 s54, s48, s44
    s_mul_i32 s54, s54, 7
    s_lshr_b32 s54, s54, 1
    s_lshl_b32 s54, s54, 8
    s_add_u32 s74, s74, s54
    s_add_u32 s74, s74, 4194304
    s_mul_i32 s68, s44, 534528
    s_add_u32 s68, s68, 0
    s_mul_i32 s69, s44, 534528
    s_add_u32 s69, s69, 132608
    s_mul_i32 s70, s44, 534528
    s_add_u32 s70, s70, 265216
    s_mul_i32 s71, s44, 534528
    s_add_u32 s71, s71, 397824
    s_cmp_eq_u32 s44, 3
    s_cselect_b32 s71, 2130706432, s71
    s_cmp_eq_u32 s49, 0
    s_cselect_b64 s[84:85], -1, 0
    s_andn2_b64 s[86:87], s[84:85], s[80:81]
    s_andn2_b64 s[84:85], s[84:85], s[78:79]
    s_bitcmp1_b32 s44, 0
    s_cselect_b64 s[88:89], -1, 0
    s_cselect_b32 s53, 0, 3
    s_cselect_b32 s54, 8, 0
    v_cmp_eq_u32 vcc, s53, v112
    s_lshr_b32 s53, s44, 1
    s_lshl_b32 s55, s53, 11
    s_add_u32 s54, s54, s55
    s_add_u32 s54, s54, 147456
    v_lshl_add_u32 v118, v115, 4, s54
    v_add_u32 v117, 151552, v23
    v_cndmask_b32 v95, v117, v118, vcc
    v_mov_b32 v117, 2130706432
    v_cndmask_b32 v23, v23, v117, vcc
    s_lshl1_add_u32 s53, s48, s53
    s_mul_i32 s53, s53, 1792
    s_and_b32 s54, s44, 1
    s_lshl1_add_u32 s54, s49, s54
    s_lshl_b32 s54, s54, 16
    s_add_u32 s53, s53, s54
    s_add_u32 s95, s53, 4195072
    s_and_b32 s53, s46, 7
    s_mul_i32 s54, s44, 28
    s_add_u32 s54, s54, s53
    s_add_u32 s54, s54, 12
    s_lshl_b32 s73, s54, 16
    s_lshl_b32 s54, s45, 9
    s_add_u32 s73, s73, s54
    s_lshl3_add_u32 s75, s44, s53
    s_lshl_b32 s75, s75, 13
    v_lshrrev_b32 v5, 2, v1
    v_lshlrev_b32 v5, 12, v5
    v_lshl_add_u32 v5, v114, 7, v5
    v_lshlrev_b32 v20, 7, v1
    s_mov_b32 s57, 354688
    buffer_load_dwordx4 v2, s[8:11], s57 offen offset:1024 lds
    s_add_u32 m0, s90, 106496
    s_mov_b32 s57, 430976
    buffer_load_dwordx4 v2, s[8:11], s57 offen offset:0 lds
    s_mov_b32 s57, 440704
    buffer_load_dwordx4 v2, s[8:11], s57 offen offset:1024 lds
    s_add_u32 m0, s90, 114688
    s_mov_b32 s57, 516992
    buffer_load_dwordx4 v2, s[8:11], s57 offen offset:0 lds
    s_mov_b32 s57, 526720
    buffer_load_dwordx4 v2, s[8:11], s57 offen offset:1024 lds
    s_add_u32 m0, s90, 122880
    s_mov_b32 s57, 603008
    buffer_load_dwordx4 v2, s[8:11], s57 offen offset:0 lds
    s_mov_b32 s57, 612736
    buffer_load_dwordx4 v2, s[8:11], s57 offen offset:1024 lds
    s_add_u32 m0, s90, 131072
    s_mov_b32 s57, 689024
    buffer_load_dwordx4 v2, s[8:11], s57 offen offset:0 lds
    s_mov_b32 s57, 698752
    buffer_load_dwordx4 v2, s[8:11], s57 offen offset:1024 lds
    s_add_u32 m0, s90, 139264
    s_mov_b32 s57, 775040
    buffer_load_dwordx4 v2, s[8:11], s57 offen offset:0 lds
    s_mov_b32 s57, 784768
    buffer_load_dwordx4 v2, s[8:11], s57 offen offset:1024 lds
    s_add_u32 m0, s90, 147456
    s_mov_b32 s57, 861056
    buffer_load_dwordx4 v2, s[8:11], s57 offen offset:0 lds
    s_mov_b32 s57, 870784
    buffer_load_dwordx4 v2, s[8:11], s57 offen offset:1024 lds
    s_add_u32 m0, s90, 155648
    s_mov_b32 s57, 947072
    buffer_load_dwordx4 v2, s[8:11], s57 offen offset:0 lds
    s_mov_b32 s57, 956800
    buffer_load_dwordx4 v2, s[8:11], s57 offen offset:1024 lds
    s_waitcnt vmcnt(20)
    v_cmp_eq_u32 vcc, 0, v29
    s_nop 0
    s_cbranch_vccz L_ok17
    s_mov_b32 s59, 20000
L_spin16:
    buffer_load_dword v29, off, s[40:43], 0 sc1
    s_waitcnt vmcnt(0)
    v_cmp_eq_u32 vcc, 0, v29
    s_nop 0
    s_cbranch_vccz L_ok17
    s_sub_u32 s59, s59, 1
    s_cbranch_scc0 L_spin16
L_ok17:
    v_readfirstlane_b32 s47, v29
    s_barrier
    s_cmp_lg_u32 s44, 0
    s_cbranch_scc1 L_nopub18
    s_lshl_b32 s60, s2, 5
    s_add_u32 s60, s60, 12582912
    v_mov_b32 v30, s47
    s_mov_b64 exec, 1
    buffer_store_dword v30, off, s[24:27], s60 sc1
    s_mov_b64 exec, -1
L_nopub18:
    s_waitcnt vmcnt(18)
    s_barrier
    s_add_u32 m0, s90, 0
    s_mov_b32 s57, 1033088
    buffer_load_dwordx4 v2, s[8:11], s57 offen offset:0 lds
    s_mov_b32 s57, 1042816
    buffer_load_dwordx4 v2, s[8:11], s57 offen offset:1024 lds
    ds_read_b64_tr_b16 a[8:9], v6 offset:0
    ds_read_b64_tr_b16 a[10:11], v6 offset:1024
    ds_read_b64_tr_b16 a[12:13], v7 offset:0
    ds_read_b64_tr_b16 a[14:15], v7 offset:1024
    s_add_u32 m0, s90, 8192
    s_mov_b32 s57, 1119104
    buffer_load_dwordx4 v2, s[8:11], s57 offen offset:0 lds
    s_mov_b32 s57, 1128832
    buffer_load_dwordx4 v2, s[8:11], s57 offen offset:1024 lds
    ds_read_b64_tr_b16 a[32:33], v6 offset:8192
    ds_read_b64_tr_b16 a[34:35], v6 offset:9216
    ds_read_b64_tr_b16 a[36:37], v7 offset:8192
    ds_read_b64_tr_b16 a[38:39], v7 offset:9216
    s_add_u32 m0, s90, 16384
    s_mov_b32 s57, 1792
    buffer_load_dwordx4 v2, s[8:11], s57 offen offset:0 lds
    s_mov_b32 s57, 11520
    buffer_load_dwordx4 v2, s[8:11], s57 offen offset:1024 lds
    ds_read_b64_tr_b16 a[56:57], v6 offset:16384
    ds_read_b64_tr_b16 a[58:59], v6 offset:17408
    ds_read_b64_tr_b16 a[60:61], v7 offset:16384
    ds_read_b64_tr_b16 a[62:63], v7 offset:17408
    s_waitcnt vmcnt(18)
    s_waitcnt lgkmcnt(0)
    s_barrier
    s_add_u32 m0, s90, 24576
    s_mov_b32 s57, 87808
    buffer_load_dwordx4 v2, s[8:11], s57 offen offset:0 lds
    s_mov_b32 s57, 97536
    buffer_load_dwordx4 v2, s[8:11], s57 offen offset:1024 lds
    ds_read_b64_tr_b16 a[80:81], v6 offset:24576
    ds_read_b64_tr_b16 a[82:83], v6 offset:25600
    ds_read_b64_tr_b16 a[84:85], v7 offset:24576
    ds_read_b64_tr_b16 a[86:87], v7 offset:25600
    s_add_u32 m0, s90, 32768
    s_mov_b32 s57, 173824
    buffer_load_dwordx4 v2, s[8:11], s57 offen offset:0 lds
    s_mov_b32 s57, 183552
    buffer_load_dwordx4 v2, s[8:11], s57 offen offset:1024 lds
    ds_read_b64_tr_b16 a[104:105], v6 offset:32768
    ds_read_b64_tr_b16 a[106:107], v6 offset:33792
    ds_read_b64_tr_b16 a[108:109], v7 offset:32768
    ds_read_b64_tr_b16 a[110:111], v7 offset:33792
    s_add_u32 m0, s90, 40960
    s_mov_b32 s57, 259840
    buffer_load_dwordx4 v2, s[8:11], s57 offen offset:0 lds
    s_mov_b32 s57, 269568
    buffer_load_dwordx4 v2, s[8:11], s57 offen offset:1024 lds
    ds_read_b64_tr_b16 a[128:129], v6 offset:40960
    ds_read_b64_tr_b16 a[130:131], v6 offset:41984
    ds_read_b64_tr_b16 a[132:133], v7 offset:40960
    ds_read_b64_tr_b16 a[134:135], v7 offset:41984
    s_waitcnt vmcnt(18)
    s_waitcnt lgkmcnt(0)
    s_barrier
    s_add_u32 m0, s90, 65536
    s_mov_b32 s57, 345856
    buffer_load_dwordx4 v2, s[8:11], s57 offen offset:0 lds
    s_mov_b32 s57, 355584
    buffer_load_dwordx4 v2, s[8:11], s57 offen offset:1024 lds
    ds_read_b64_tr_b16 a[152:153], v10 offset:0
    ds_read_b64_tr_b16 a[154:155], v10 offset:1024
    ds_read_b64_tr_b16 a[156:157], v11 offset:0
    ds_read_b64_tr_b16 a[158:159], v11 offset:1024
    s_add_u32 m0, s90, 73728
    s_mov_b32 s57, 431872
    buffer_load_dwordx4 v2, s[8:11], s57 offen offset:0 lds
    s_mov_b32 s57, 441600
    buffer_load_dwordx4 v2, s[8:11], s57 offen offset:1024 lds
    ds_read_b64_tr_b16 a[176:177], v10 offset:8192
    ds_read_b64_tr_b16 a[178:179], v10 offset:9216
    ds_read_b64_tr_b16 a[180:181], v11 offset:8192
    ds_read_b64_tr_b16 a[182:183], v11 offset:9216
    s_add_u32 m0, s90, 81920
    s_mov_b32 s57, 517888
    buffer_load_dwordx4 v2, s[8:11], s57 offen offset:0 lds
    s_mov_b32 s57, 527616
    buffer_load_dwordx4 v2, s[8:11], s57 offen offset:1024 lds
    ds_read_b64_tr_b16 a[200:201], v10 offset:16384
    ds_read_b64_tr_b16 a[202:203], v10 offset:17408
    ds_read_b64_tr_b16 a[204:205], v11 offset:16384
    ds_read_b64_tr_b16 a[206:207], v11 offset:17408
    s_waitcnt vmcnt(18)
    s_waitcnt lgkmcnt(0)
    s_barrier
    s_add_u32 m0, s90, 90112
    s_mov_b32 s57, 603904
    buffer_load_dwordx4 v2, s[8:11], s57 offen offset:0 lds
    s_mov_b32 s57, 613632
    buffer_load_dwordx4 v2, s[8:11], s57 offen offset:1024 lds
    ds_read_b64_tr_b16 a[224:225], v10 offset:24576
    ds_read_b64_tr_b16 a[226:227], v10 offset:25600
    ds_read_b64_tr_b16 a[228:229], v11 offset:24576
    ds_read_b64_tr_b16 a[230:231], v11 offset:25600
    s_add_u32 m0, s90, 98304
    s_mov_b32 s57, 689920
    buffer_load_dwordx4 v2, s[8:11], s57 offen offset:0 lds
    s_mov_b32 s57, 699648
    buffer_load_dwordx4 v2, s[8:11], s57 offen offset:1024 lds
    ds_read_b64_tr_b16 a[248:249], v10 offset:32768
    ds_read_b64_tr_b16 a[250:251], v10 offset:33792
    ds_read_b64_tr_b16 a[252:253], v11 offset:32768
    ds_read_b64_tr_b16 a[254:255], v11 offset:33792
    s_add_u32 m0, s90, 106496
    s_mov_b32 s57, 775936
    buffer_load_dwordx4 v2, s[8:11], s57 offen offset:0 lds
    s_mov_b32 s57, 785664
    buffer_load_dwordx4 v2, s[8:11], s57 offen offset:1024 lds
    ds_read_b64_tr_b16 v[192:193], v10 offset:40960
    ds_read_b64_tr_b16 v[194:195], v10 offset:41984
    ds_read_b64_tr_b16 v[196:197], v11 offset:40960
    ds_read_b64_tr_b16 v[198:199], v11 offset:41984
    s_waitcnt vmcnt(18)
    s_waitcnt lgkmcnt(0)
    s_barrier
    ds_read_b64_tr_b16 v[216:217], v120 offset:0
    ds_read_b64_tr_b16 v[218:219], v120 offset:1024
    ds_read_b64_tr_b16 v[220:221], v121 offset:0
    ds_read_b64_tr_b16 v[222:223], v121 offset:1024
    ds_read_b64_tr_b16 v[240:241], v120 offset:8192
    ds_read_b64_tr_b16 v[242:243], v120 offset:9216
    ds_read_b64_tr_b16 v[244:245], v121 offset:8192
    ds_read_b64_tr_b16 v[246:247], v121 offset:9216
    buffer_load_dword v21, v19, s[24:27], 0 offen sc1
    ds_read_b64_tr_b16 a[16:17], v122 offset:16384
    ds_read_b64_tr_b16 a[18:19], v122 offset:17408
    ds_read_b64_tr_b16 a[20:21], v123 offset:16384
    ds_read_b64_tr_b16 a[22:23], v123 offset:17408
    s_add_u32 m0, s90, 114688
    s_mov_b32 s57, 861952
    buffer_load_dwordx4 v2, s[8:11], s57 offen offset:0 lds
    s_waitcnt vmcnt(14)
    s_waitcnt lgkmcnt(0)
    s_barrier
    ds_read_b64_tr_b16 a[40:41], v122 offset:24576
    ds_read_b64_tr_b16 a[42:43], v122 offset:25600
    ds_read_b64_tr_b16 a[44:45], v123 offset:24576
    ds_read_b64_tr_b16 a[46:47], v123 offset:25600
    ds_read_b64_tr_b16 a[64:65], v122 offset:32768
    ds_read_b64_tr_b16 a[66:67], v122 offset:33792
    ds_read_b64_tr_b16 a[68:69], v123 offset:32768
    ds_read_b64_tr_b16 a[70:71], v123 offset:33792
    ds_read_b64_tr_b16 a[88:89], v122 offset:40960
    ds_read_b64_tr_b16 a[90:91], v122 offset:41984
    ds_read_b64_tr_b16 a[92:93], v123 offset:40960
    ds_read_b64_tr_b16 a[94:95], v123 offset:41984
    s_mov_b32 s57, 871680
    buffer_load_dwordx4 v2, s[8:11], s57 offen offset:1024 lds
    s_add_u32 m0, s90, 122880
    s_mov_b32 s57, 947968
    buffer_load_dwordx4 v2, s[8:11], s57 offen offset:0 lds
    s_mov_b32 s57, 957696
    buffer_load_dwordx4 v2, s[8:11], s57 offen offset:1024 lds
    s_add_u32 m0, s90, 131072
    s_mov_b32 s57, 1033984
    buffer_load_dwordx4 v2, s[8:11], s57 offen offset:0 lds
    s_waitcnt vmcnt(12)
    s_waitcnt lgkmcnt(0)
    s_barrier
    ds_read_b64_tr_b16 a[112:113], v8 offset:0
    ds_read_b64_tr_b16 a[114:115], v8 offset:1024
    ds_read_b64_tr_b16 a[116:117], v9 offset:0
    ds_read_b64_tr_b16 a[118:119], v9 offset:1024
    ds_read_b64_tr_b16 a[136:137], v8 offset:8192
    ds_read_b64_tr_b16 a[138:139], v8 offset:9216
    ds_read_b64_tr_b16 a[140:141], v9 offset:8192
    ds_read_b64_tr_b16 a[142:143], v9 offset:9216
    ds_read_b64_tr_b16 a[160:161], v8 offset:16384
    ds_read_b64_tr_b16 a[162:163], v8 offset:17408
    ds_read_b64_tr_b16 a[164:165], v9 offset:16384
    ds_read_b64_tr_b16 a[166:167], v9 offset:17408
    s_mov_b32 s57, 1043712
    buffer_load_dwordx4 v2, s[8:11], s57 offen offset:1024 lds
    s_waitcnt vmcnt(6)
    v_cmp_ne_u32 vcc, s47, v21
    s_nop 0
    s_cbranch_vccz L_ok20
    s_mov_b32 s59, 20000
L_spin19:
    buffer_load_dword v21, v19, s[24:27], 0 offen sc1
    s_waitcnt vmcnt(0)
    v_cmp_ne_u32 vcc, s47, v21
    s_nop 0
    s_cbranch_vccz L_ok20
    s_sub_u32 s59, s59, 1
    s_cbranch_scc0 L_spin19
L_ok20:
    s_add_u32 m0, s52, 0
    s_sub_u32 s58, s72, 512
    s_max_i32 s58, s58, 0
    s_add_u32 s57, s58, s68
    buffer_load_dwordx4 v3, s[24:27], s57 offen offset:0 sc1 lds
    s_add_u32 s57, s58, s69
    buffer_load_dwordx4 v3, s[24:27], s57 offen offset:1024 sc1 lds
    s_add_u32 s57, s58, s70
    buffer_load_dwordx4 v24, s[24:27], s57 offen offset:2048 sc1 lds
    s_add_u32 s57, s58, s71
    buffer_load_dwordx4 v3, s[24:27], s57 offen offset:3072 sc1 lds
    s_add_u32 m0, s52, 16384
    s_add_u32 s58, s72, 0
    s_add_u32 s57, s58, s68
    buffer_load_dwordx4 v3, s[24:27], s57 offen offset:0 sc1 lds
    s_waitcnt lgkmcnt(0)
    s_barrier
    ds_read_b64_tr_b16 a[184:185], v8 offset:24576
    ds_read_b64_tr_b16 a[186:187], v8 offset:25600
    ds_read_b64_tr_b16 a[188:189], v9 offset:24576
    ds_read_b64_tr_b16 a[190:191], v9 offset:25600
    ds_read_b64_tr_b16 a[208:209], v8 offset:32768
    ds_read_b64_tr_b16 a[210:211], v8 offset:33792
    ds_read_b64_tr_b16 a[212:213], v9 offset:32768
    ds_read_b64_tr_b16 a[214:215], v9 offset:33792
    ds_read_b64_tr_b16 a[232:233], v8 offset:40960
    ds_read_b64_tr_b16 a[234:235], v8 offset:41984
    ds_read_b64_tr_b16 a[236:237], v9 offset:40960
    ds_read_b64_tr_b16 a[238:239], v9 offset:41984
    s_add_u32 s57, s58, s69
    buffer_load_dwordx4 v3, s[24:27], s57 offen offset:1024 sc1 lds
    s_add_u32 s57, s58, s70
    buffer_load_dwordx4 v24, s[24:27], s57 offen offset:2048 sc1 lds
    s_add_u32 s57, s58, s71
    buffer_load_dwordx4 v3, s[24:27], s57 offen offset:3072 sc1 lds
    s_add_u32 m0, s90, 139264
    s_mov_b32 s57, 1120000
    buffer_load_dwordx4 v2, s[8:11], s57 offen offset:0 lds
    s_mov_b32 s57, 1129728
    buffer_load_dwordx4 v2, s[8:11], s57 offen offset:1024 lds
    s_add_u32 m0, s90, 147456
    s_mov_b32 s57, 0
    buffer_load_dwordx4 v2, s[8:11], s57 offen offset:0 lds
    s_mov_b32 s57, 9728
    buffer_load_dwordx4 v2, s[8:11], s57 offen offset:1024 lds
    s_add_u32 m0, s90, 155648
    s_mov_b32 s57, 86016
    buffer_load_dwordx4 v2, s[8:11], s57 offen offset:0 lds
    s_mov_b32 s57, 95744
    buffer_load_dwordx4 v2, s[8:11], s57 offen offset:1024 lds
    s_add_u32 m0, s52, 32768
    s_add_u32 s58, s72, 512
    s_add_u32 s57, s58, s68
    buffer_load_dwordx4 v3, s[24:27], s57 offen offset:0 sc1 lds
    s_add_u32 s57, s58, s69
    buffer_load_dwordx4 v3, s[24:27], s57 offen offset:1024 sc1 lds
    s_waitcnt vmcnt(12)
    s_waitcnt lgkmcnt(0)
    s_barrier
    ds_read_b64_tr_b16 v[120:121], v4 offset:0
    ds_read_b64_tr_b16 v[122:123], v25 offset:0
    ds_read_b64_tr_b16 v[124:125], v4 offset:1024
    ds_read_b64_tr_b16 v[126:127], v25 offset:1024
    ds_read_b64_tr_b16 v[128:129], v4 offset:2048
    ds_read_b64_tr_b16 v[130:131], v25 offset:2048
    ds_read_b64_tr_b16 v[132:133], v4 offset:3072
    ds_read_b64_tr_b16 v[134:135], v25 offset:3072
    ds_read_b64_tr_b16 v[136:137], v4 offset:4096
    ds_read_b64_tr_b16 v[138:139], v25 offset:4096
    ds_read_b64_tr_b16 v[140:141], v4 offset:5120
    ds_read_b64_tr_b16 v[142:143], v25 offset:5120
    ds_read_b64_tr_b16 v[144:145], v4 offset:6144
    ds_read_b64_tr_b16 v[146:147], v25 offset:6144
    ds_read_b64_tr_b16 v[148:149], v4 offset:7168
    ds_read_b64_tr_b16 v[150:151], v25 offset:7168
    ds_read_b64_tr_b16 v[152:153], v4 offset:8192
    ds_read_b64_tr_b16 v[154:155], v25 offset:8192
    ds_read_b64_tr_b16 v[156:157], v4 offset:9216
    ds_read_b64_tr_b16 v[158:159], v25 offset:9216
    ds_read_b64_tr_b16 v[160:161], v4 offset:10240
    ds_read_b64_tr_b16 v[162:163], v25 offset:10240
    ds_read_b64_tr_b16 v[164:165], v4 offset:11264
    ds_read_b64_tr_b16 v[166:167], v25 offset:11264
    ds_read_b64_tr_b16 v[168:169], v4 offset:12288
    ds_read_b64_tr_b16 v[170:171], v25 offset:12288
    ds_read_b64_tr_b16 v[172:173], v4 offset:13312
    ds_read_b64_tr_b16 v[174:175], v25 offset:13312
    s_waitcnt lgkmcnt(15)
    v_mfma_f32_16x16x32_bf16 v[96:99], a[8:11], v[120:123], 0
    s_add_u32 s57, s58, s70
    ds_read_b64_tr_b16 v[176:177], v12 offset:0
    v_mfma_f32_16x16x32_bf16 v[96:99], a[32:35], v[124:127], v[96:99]
    buffer_load_dwordx4 v24, s[24:27], s57 offen offset:2048 sc1 lds
    v_mfma_f32_16x16x32_bf16 v[96:99], a[56:59], v[128:131], v[96:99]
    ds_read_b64_tr_b16 v[178:179], v12 offset:1024
    ds_read_b64_tr_b16 v[180:181], v13 offset:0
    v_mfma_f32_16x16x32_bf16 v[96:99], a[80:83], v[132:135], v[96:99]
    ds_read_b64_tr_b16 v[182:183], v13 offset:1024
    ds_read_b64_tr_b16 v[200:201], v12 offset:8192
    v_mfma_f32_16x16x32_bf16 v[96:99], a[104:107], v[136:139], v[96:99]
    s_add_u32 s57, s58, s71
    ds_read_b64_tr_b16 v[202:203], v12 offset:9216
    v_mfma_f32_16x16x32_bf16 v[96:99], a[128:131], v[140:143], v[96:99]
    buffer_load_dwordx4 v3, s[24:27], s57 offen offset:3072 sc1 lds
    s_waitcnt lgkmcnt(15)
    v_mfma_f32_16x16x32_bf16 v[96:99], a[152:155], v[144:147], v[96:99]
    ds_read_b64_tr_b16 v[204:205], v13 offset:8192
    ds_read_b64_tr_b16 v[206:207], v13 offset:9216
    v_mfma_f32_16x16x32_bf16 v[96:99], a[176:179], v[148:151], v[96:99]
    ds_read_b64_tr_b16 v[224:225], v12 offset:16384
    ds_read_b64_tr_b16 v[226:227], v12 offset:17408
    v_mfma_f32_16x16x32_bf16 v[96:99], a[200:203], v[152:155], v[96:99]
    s_add_u32 m0, s90, 65536
    s_mov_b32 s57, 172032
    ds_read_b64_tr_b16 v[228:229], v13 offset:16384
    s_waitcnt lgkmcnt(15)
    v_mfma_f32_16x16x32_bf16 v[96:99], a[224:227], v[156:159], v[96:99]
    buffer_load_dwordx4 v2, s[8:11], s57 offen offset:0 lds
    v_mfma_f32_16x16x32_bf16 v[96:99], a[248:251], v[160:163], v[96:99]
    ds_read_b64_tr_b16 v[230:231], v13 offset:17408
    v_mfma_f32_16x16x32_bf16 v[96:99], v[192:195], v[164:167], v[96:99]
    s_waitcnt lgkmcnt(12)
    v_mfma_f32_16x16x32_bf16 v[96:99], v[216:219], v[168:171], v[96:99]
    s_mov_b32 s57, 181760
    v_mfma_f32_16x16x32_bf16 v[96:99], v[240:243], v[172:175], v[96:99]
    buffer_load_dwordx4 v2, s[8:11], s57 offen offset:1024 lds
    s_waitcnt vmcnt(12)
    s_barrier
    v_mfma_f32_16x16x32_bf16 v[100:103], a[12:15], v[120:123], 0
    ds_read_b64_tr_b16 v[120:121], v4 offset:16384
    ds_read_b64_tr_b16 v[122:123], v25 offset:16384
    v_mfma_f32_16x16x32_bf16 v[100:103], a[36:39], v[124:127], v[100:103]
    ds_read_b64_tr_b16 v[124:125], v4 offset:17408
    ds_read_b64_tr_b16 v[126:127], v25 offset:17408
    v_mfma_f32_16x16x32_bf16 v[100:103], a[60:63], v[128:131], v[100:103]
    ds_read_b64_tr_b16 v[128:129], v4 offset:18432
    ds_read_b64_tr_b16 v[130:131], v25 offset:18432
    s_add_u32 m0, s90, 73728
    s_mov_b32 s57, 258048
    v_mfma_f32_16x16x32_bf16 v[100:103], a[84:87], v[132:135], v[100:103]
    ds_read_b64_tr_b16 v[132:133], v4 offset:19456
    ds_read_b64_tr_b16 v[134:135], v25 offset:19456
    buffer_load_dwordx4 v2, s[8:11], s57 offen offset:0 lds
    v_mfma_f32_16x16x32_bf16 v[100:103], a[108:111], v[136:139], v[100:103]
    ds_read_b64_tr_b16 v[136:137], v4 offset:20480
    ds_read_b64_tr_b16 v[138:139], v25 offset:20480
    v_mfma_f32_16x16x32_bf16 v[100:103], a[132:135], v[140:143], v[100:103]
    ds_read_b64_tr_b16 v[140:141], v4 offset:21504
    ds_read_b64_tr_b16 v[142:143], v25 offset:21504
    v_mfma_f32_16x16x32_bf16 v[100:103], a[156:159], v[144:147], v[100:103]
    ds_read_b64_tr_b16 v[144:145], v4 offset:22528
    ds_read_b64_tr_b16 v[146:147], v25 offset:22528
    s_mov_b32 s57, 267776
    v_mfma_f32_16x16x32_bf16 v[100:103], a[180:183], v[148:151], v[100:103]
    ds_read_b64_tr_b16 v[148:149], v4 offset:23552
    ds_read_b64_tr_b16 v[150:151], v25 offset:23552
    buffer_load_dwordx4 v2, s[8:11], s57 offen offset:1024 lds
    v_mfma_f32_16x16x32_bf16 v[100:103], a[204:207], v[152:155], v[100:103]
    ds_read_b64_tr_b16 v[152:153], v4 offset:24576
    ds_read_b64_tr_b16 v[154:155], v25 offset:24576
    v_cvt_pk_bf16_f32 v52, v96, v97
    v_mfma_f32_16x16x32_bf16 v[100:103], a[228:231], v[156:159], v[100:103]
    ds_read_b64_tr_b16 v[156:157], v4 offset:25600
    ds_read_b64_tr_b16 v[158:159], v25 offset:25600
    v_cvt_pk_bf16_f32 v53, v98, v99
    v_mfma_f32_16x16x32_bf16 v[100:103], a[252:255], v[160:163], v[100:103]
    ds_read_b64_tr_b16 v[160:161], v4 offset:26624
    ds_read_b64_tr_b16 v[162:163], v25 offset:26624
    s_add_u32 m0, s90, 81920
    s_mov_b32 s57, 344064
    v_mfma_f32_16x16x32_bf16 v[100:103], v[196:199], v[164:167], v[100:103]
    ds_read_b64_tr_b16 v[164:165], v4 offset:27648
    ds_read_b64_tr_b16 v[166:167], v25 offset:27648
    buffer_load_dwordx4 v2, s[8:11], s57 offen offset:0 lds
    v_mfma_f32_16x16x32_bf16 v[100:103], v[220:223], v[168:171], v[100:103]
    ds_read_b64_tr_b16 v[168:169], v4 offset:28672
    ds_read_b64_tr_b16 v[170:171], v25 offset:28672
    v_mfma_f32_16x16x32_bf16 v[100:103], v[244:247], v[172:175], v[100:103]
    ds_read_b64_tr_b16 v[172:173], v4 offset:29696
    ds_read_b64_tr_b16 v[174:175], v25 offset:29696
    s_waitcnt lgkmcnt(15)
    v_mfma_f32_16x16x32_bf16 v[104:107], a[8:11], v[120:123], 0
    s_mov_b32 s57, 353792
    v_mfma_f32_16x16x32_bf16 v[104:107], a[32:35], v[124:127], v[104:107]
    buffer_load_dwordx4 v2, s[8:11], s57 offen offset:1024 lds
    v_mfma_f32_16x16x32_bf16 v[104:107], a[56:59], v[128:131], v[104:107]
    v_mfma_f32_16x16x32_bf16 v[104:107], a[80:83], v[132:135], v[104:107]
    s_waitcnt vmcnt(10)
    s_barrier
    v_mfma_f32_16x16x32_bf16 v[104:107], a[104:107], v[136:139], v[104:107]
    s_add_u32 m0, s90, 90112
    s_mov_b32 s57, 430080
    ds_read_b64_tr_b16 v[248:249], v12 offset:24576
    v_mfma_f32_16x16x32_bf16 v[104:107], a[128:131], v[140:143], v[104:107]
    buffer_load_dwordx4 v2, s[8:11], s57 offen offset:0 lds
    s_waitcnt lgkmcnt(11)
    v_mfma_f32_16x16x32_bf16 v[104:107], a[152:155], v[144:147], v[104:107]
    v_cvt_pk_bf16_f32 v54, v100, v101
    v_cvt_pk_bf16_f32 v55, v102, v103
    v_mfma_f32_16x16x32_bf16 v[104:107], a[176:179], v[148:151], v[104:107]
    v_cndmask_b32 v54, v54, 0, s[82:83]
    v_cndmask_b32 v55, v55, 0, s[82:83]
    v_mfma_f32_16x16x32_bf16 v[104:107], a[200:203], v[152:155], v[104:107]
    s_mov_b32 s57, 439808
    ds_read_b64_tr_b16 v[250:251], v12 offset:25600
    s_waitcnt lgkmcnt(6)
    v_mfma_f32_16x16x32_bf16 v[104:107], a[224:227], v[156:159], v[104:107]
    buffer_load_dwordx4 v2, s[8:11], s57 offen offset:1024 lds
    v_mfma_f32_16x16x32_bf16 v[104:107], a[248:251], v[160:163], v[104:107]
    ds_read_b64_tr_b16 v[252:253], v13 offset:24576
    ds_read_b64_tr_b16 v[254:255], v13 offset:25600
    v_mfma_f32_16x16x32_bf16 v[104:107], v[192:195], v[164:167], v[104:107]
    ds_read_b64_tr_b16 a[0:1], v10 offset:32768
    ds_read_b64_tr_b16 a[2:3], v10 offset:33792
    s_waitcnt lgkmcnt(6)
    v_mfma_f32_16x16x32_bf16 v[104:107], v[216:219], v[168:171], v[104:107]
    s_add_u32 m0, s90, 98304
    s_mov_b32 s57, 516096
    ds_read_b64_tr_b16 a[4:5], v11 offset:32768
    v_mfma_f32_16x16x32_bf16 v[104:107], v[240:243], v[172:175], v[104:107]
    buffer_load_dwordx4 v2, s[8:11], s57 offen offset:0 lds
    s_waitcnt vmcnt(9)
    s_barrier
    v_mfma_f32_16x16x32_bf16 v[108:111], a[12:15], v[120:123], 0
    ds_read_b64_tr_b16 v[120:121], v4 offset:32768
    ds_read_b64_tr_b16 v[122:123], v25 offset:32768
    ds_read_b64_tr_b16 a[6:7], v11 offset:33792
    v_mfma_f32_16x16x32_bf16 v[108:111], a[36:39], v[124:127], v[108:111]
    ds_read_b64_tr_b16 v[124:125], v4 offset:33792
    ds_read_b64_tr_b16 v[126:127], v25 offset:33792
    ds_read_b64_tr_b16 a[24:25], v10 offset:40960
    v_mfma_f32_16x16x32_bf16 v[108:111], a[60:63], v[128:131], v[108:111]
    ds_read_b64_tr_b16 v[128:129], v4 offset:34816
    ds_read_b64_tr_b16 v[130:131], v25 offset:34816
    s_mov_b32 s57, 525824
    v_mfma_f32_16x16x32_bf16 v[108:111], a[84:87], v[132:135], v[108:111]
    ds_read_b64_tr_b16 v[132:133], v4 offset:35840
    ds_read_b64_tr_b16 v[134:135], v25 offset:35840
    buffer_load_dwordx4 v2, s[8:11], s57 offen offset:1024 lds
    v_mfma_f32_16x16x32_bf16 v[108:111], a[108:111], v[136:139], v[108:111]
    ds_read_b64_tr_b16 v[136:137], v4 offset:36864
    ds_read_b64_tr_b16 v[138:139], v25 offset:36864
    ds_read_b64_tr_b16 a[26:27], v10 offset:41984
    v_mfma_f32_16x16x32_bf16 v[108:111], a[132:135], v[140:143], v[108:111]
    ds_read_b64_tr_b16 v[140:141], v4 offset:37888
    ds_read_b64_tr_b16 v[142:143], v25 offset:37888
    ds_read_b64_tr_b16 a[28:29], v11 offset:40960
    v_mfma_f32_16x16x32_bf16 v[108:111], a[156:159], v[144:147], v[108:111]
    ds_read_b64_tr_b16 v[144:145], v4 offset:38912
    ds_read_b64_tr_b16 v[146:147], v25 offset:38912
    s_add_u32 m0, s90, 106496
    s_mov_b32 s57, 602112
    v_mfma_f32_16x16x32_bf16 v[108:111], a[180:183], v[148:151], v[108:111]
    ds_read_b64_tr_b16 v[148:149], v4 offset:39936
    ds_read_b64_tr_b16 v[150:151], v25 offset:39936
    buffer_load_dwordx4 v2, s[8:11], s57 offen offset:0 lds
    v_mfma_f32_16x16x32_bf16 v[108:111], a[204:207], v[152:155], v[108:111]
    ds_read_b64_tr_b16 v[152:153], v4 offset:40960
    ds_read_b64_tr_b16 v[154:155], v25 offset:40960
    v_cvt_pk_bf16_f32 v56, v104, v105
    v_mfma_f32_16x16x32_bf16 v[108:111], a[228:231], v[156:159], v[108:111]
    ds_read_b64_tr_b16 v[156:157], v4 offset:41984
    ds_read_b64_tr_b16 v[158:159], v25 offset:41984
    v_cvt_pk_bf16_f32 v57, v106, v107
    v_mfma_f32_16x16x32_bf16 v[108:111], a[252:255], v[160:163], v[108:111]
    ds_read_b64_tr_b16 v[160:161], v4 offset:43008
    ds_read_b64_tr_b16 v[162:163], v25 offset:43008
    s_mov_b32 s57, 611840
    v_mfma_f32_16x16x32_bf16 v[108:111], v[196:199], v[164:167], v[108:111]
    ds_read_b64_tr_b16 v[164:165], v4 offset:44032
    ds_read_b64_tr_b16 v[166:167], v25 offset:44032
    buffer_load_dwordx4 v2, s[8:11], s57 offen offset:1024 lds
    v_mfma_f32_16x16x32_bf16 v[108:111], v[220:223], v[168:171], v[108:111]
    ds_read_b64_tr_b16 v[168:169], v4 offset:45056
    ds_read_b64_tr_b16 v[170:171], v25 offset:45056
    ds_read_b64_tr_b16 a[30:31], v11 offset:41984
    v_mfma_f32_16x16x32_bf16 v[108:111], v[244:247], v[172:175], v[108:111]
    ds_read_b64_tr_b16 v[172:173], v4 offset:46080
    ds_read_b64_tr_b16 v[174:175], v25 offset:46080
    s_waitcnt lgkmcnt(15)
    v_mfma_f32_16x16x32_bf16 v[112:115], a[8:11], v[120:123], 0
    s_add_u32 m0, s90, 114688
    s_mov_b32 s57, 688128
    v_mfma_f32_16x16x32_bf16 v[112:115], a[32:35], v[124:127], v[112:115]
    buffer_load_dwordx4 v2, s[8:11], s57 offen offset:0 lds
    v_mfma_f32_16x16x32_bf16 v[112:115], a[56:59], v[128:131], v[112:115]
    v_mfma_f32_16x16x32_bf16 v[112:115], a[80:83], v[132:135], v[112:115]
    v_mfma_f32_16x16x32_bf16 v[112:115], a[104:107], v[136:139], v[112:115]
    s_mov_b32 s57, 697856
    v_mfma_f32_16x16x32_bf16 v[112:115], a[128:131], v[140:143], v[112:115]
    buffer_load_dwordx4 v2, s[8:11], s57 offen offset:1024 lds
    s_waitcnt lgkmcnt(11)
    v_mfma_f32_16x16x32_bf16 v[112:115], a[152:155], v[144:147], v[112:115]
    v_cvt_pk_bf16_f32 v58, v108, v109
    v_cvt_pk_bf16_f32 v59, v110, v111
    v_mfma_f32_16x16x32_bf16 v[112:115], a[176:179], v[148:151], v[112:115]
    v_cndmask_b32 v58, v58, 0, s[82:83]
    v_cndmask_b32 v59, v59, 0, s[82:83]
    v_mfma_f32_16x16x32_bf16 v[112:115], a[200:203], v[152:155], v[112:115]
    s_add_u32 m0, s90, 122880
    s_mov_b32 s57, 774144
    s_waitcnt lgkmcnt(5)
    v_mfma_f32_16x16x32_bf16 v[112:115], a[224:227], v[156:159], v[112:115]
    buffer_load_dwordx4 v2, s[8:11], s57 offen offset:0 lds
    v_mfma_f32_16x16x32_bf16 v[112:115], a[248:251], v[160:163], v[112:115]
    v_mfma_f32_16x16x32_bf16 v[112:115], v[192:195], v[164:167], v[112:115]
    s_waitcnt lgkmcnt(0)
    v_mfma_f32_16x16x32_bf16 v[112:115], v[216:219], v[168:171], v[112:115]
    s_mov_b32 s57, 783872
    v_mfma_f32_16x16x32_bf16 v[112:115], v[240:243], v[172:175], v[112:115]
    buffer_load_dwordx4 v2, s[8:11], s57 offen offset:1024 lds
    v_mfma_f32_16x16x32_bf16 v[116:119], a[12:15], v[120:123], 0
    v_mfma_f32_16x16x32_bf16 v[116:119], a[36:39], v[124:127], v[116:119]
    s_waitcnt vmcnt(10)
    s_barrier
    v_mfma_f32_16x16x32_bf16 v[116:119], a[60:63], v[128:131], v[116:119]
    s_add_u32 m0, s90, 131072
    s_mov_b32 s57, 860160
    ds_read_b64_tr_b16 a[48:49], v6 offset:0
    v_mfma_f32_16x16x32_bf16 v[116:119], a[84:87], v[132:135], v[116:119]
    buffer_load_dwordx4 v2, s[8:11], s57 offen offset:0 lds
    v_mfma_f32_16x16x32_bf16 v[116:119], a[108:111], v[136:139], v[116:119]
    ds_read_b64_tr_b16 a[50:51], v6 offset:1024
    ds_read_b64_tr_b16 a[52:53], v7 offset:0
    v_mfma_f32_16x16x32_bf16 v[116:119], a[132:135], v[140:143], v[116:119]
    ds_read_b64_tr_b16 a[54:55], v7 offset:1024
    ds_read_b64_tr_b16 a[72:73], v6 offset:8192
    v_mfma_f32_16x16x32_bf16 v[116:119], a[156:159], v[144:147], v[116:119]
    s_mov_b32 s57, 869888
    v_cvt_pk_bf16_f32 v60, v112, v113
    v_mfma_f32_16x16x32_bf16 v[116:119], a[180:183], v[148:151], v[116:119]
    buffer_load_dwordx4 v2, s[8:11], s57 offen offset:1024 lds
    v_mfma_f32_16x16x32_bf16 v[116:119], a[204:207], v[152:155], v[116:119]
    v_cvt_pk_bf16_f32 v61, v114, v115
    ds_read_b64_tr_b16 a[74:75], v6 offset:9216
    v_mfma_f32_16x16x32_bf16 v[116:119], a[228:231], v[156:159], v[116:119]
    ds_read_b64_tr_b16 a[76:77], v7 offset:8192
    ds_read_b64_tr_b16 a[78:79], v7 offset:9216
    v_mfma_f32_16x16x32_bf16 v[116:119], a[252:255], v[160:163], v[116:119]
    s_add_u32 m0, s90, 139264
    s_mov_b32 s57, 946176
    ds_read_b64_tr_b16 a[96:97], v6 offset:16384
    v_mfma_f32_16x16x32_bf16 v[116:119], v[196:199], v[164:167], v[116:119]
    buffer_load_dwordx4 v2, s[8:11], s57 offen offset:0 lds
    v_mfma_f32_16x16x32_bf16 v[116:119], v[220:223], v[168:171], v[116:119]
    ds_read_b64_tr_b16 a[98:99], v6 offset:17408
    ds_read_b64_tr_b16 a[100:101], v7 offset:16384
    v_mfma_f32_16x16x32_bf16 v[116:119], v[244:247], v[172:175], v[116:119]
    ds_read_b64_tr_b16 a[102:103], v7 offset:17408
    v_mfma_f32_16x16x32_bf16 v[96:99], v[120:123], a[16:19], 0
    s_mov_b32 s57, 955904
    v_mfma_f32_16x16x32_bf16 v[96:99], v[124:127], a[40:43], v[96:99]
    buffer_load_dwordx4 v2, s[8:11], s57 offen offset:1024 lds
    v_mfma_f32_16x16x32_bf16 v[96:99], v[128:131], a[64:67], v[96:99]
    v_mfma_f32_16x16x32_bf16 v[96:99], v[132:135], a[88:91], v[96:99]
    v_mfma_f32_16x16x32_bf16 v[96:99], v[136:139], a[112:115], v[96:99]
    s_add_u32 m0, s90, 147456
    s_mov_b32 s57, 1032192
    v_mfma_f32_16x16x32_bf16 v[96:99], v[140:143], a[136:139], v[96:99]
    buffer_load_dwordx4 v2, s[8:11], s57 offen offset:0 lds
    v_mfma_f32_16x16x32_bf16 v[96:99], v[144:147], a[160:163], v[96:99]
    v_cvt_pk_bf16_f32 v62, v116, v117
    v_cvt_pk_bf16_f32 v63, v118, v119
    v_mfma_f32_16x16x32_bf16 v[96:99], v[148:151], a[184:187], v[96:99]
    v_cndmask_b32 v62, v62, 0, s[82:83]
    v_cndmask_b32 v63, v63, 0, s[82:83]
    v_mfma_f32_16x16x32_bf16 v[96:99], v[152:155], a[208:211], v[96:99]
    s_mov_b32 s57, 1041920
    v_mfma_f32_16x16x32_bf16 v[96:99], v[156:159], a[232:235], v[96:99]
    buffer_load_dwordx4 v2, s[8:11], s57 offen offset:1024 lds
    v_mfma_f32_16x16x32_bf16 v[96:99], v[160:163], v[176:179], v[96:99]
    v_mfma_f32_16x16x32_bf16 v[96:99], v[164:167], v[200:203], v[96:99]
    s_waitcnt vmcnt(10)
    s_waitcnt lgkmcnt(0)
    s_barrier
    v_mfma_f32_16x16x32_bf16 v[96:99], v[168:171], v[224:227], v[96:99]
    s_add_u32 m0, s90, 155648
    s_mov_b32 s57, 1118208
    ds_read_b64_tr_b16 a[120:121], v6 offset:24576
    v_mfma_f32_16x16x32_bf16 v[96:99], v[172:175], v[248:251], v[96:99]
    buffer_load_dwordx4 v2, s[8:11], s57 offen offset:0 lds
    v_mfma_f32_16x16x32_bf16 v[100:103], v[120:123], a[20:23], 0
    ds_read_b64_tr_b16 v[120:121], v4 offset:16384
    ds_read_b64_tr_b16 v[122:123], v25 offset:16384
    ds_read_b64_tr_b16 a[122:123], v6 offset:25600
    v_mfma_f32_16x16x32_bf16 v[100:103], v[124:127], a[44:47], v[100:103]
    ds_read_b64_tr_b16 v[124:125], v4 offset:17408
    ds_read_b64_tr_b16 v[126:127], v25 offset:17408
    ds_read_b64_tr_b16 a[124:125], v7 offset:24576
    v_mfma_f32_16x16x32_bf16 v[100:103], v[128:131], a[68:71], v[100:103]
    ds_read_b64_tr_b16 v[128:129], v4 offset:18432
    ds_read_b64_tr_b16 v[130:131], v25 offset:18432
    s_mov_b32 s57, 1127936
    v_mfma_f32_16x16x32_bf16 v[100:103], v[132:135], a[92:95], v[100:103]
    ds_read_b64_tr_b16 v[132:133], v4 offset:19456
    ds_read_b64_tr_b16 v[134:135], v25 offset:19456
    buffer_load_dwordx4 v2, s[8:11], s57 offen offset:1024 lds
    v_mfma_f32_16x16x32_bf16 v[100:103], v[136:139], a[116:119], v[100:103]
    ds_read_b64_tr_b16 v[136:137], v4 offset:20480
    ds_read_b64_tr_b16 v[138:139], v25 offset:20480
    ds_read_b64_tr_b16 a[126:127], v7 offset:25600
    v_mfma_f32_16x16x32_bf16 v[100:103], v[140:143], a[140:143], v[100:103]
    ds_read_b64_tr_b16 v[140:141], v4 offset:21504
    ds_read_b64_tr_b16 v[142:143], v25 offset:21504
    ds_read_b64_tr_b16 a[144:145], v6 offset:32768
    v_mfma_f32_16x16x32_bf16 v[100:103], v[144:147], a[164:167], v[100:103]
    ds_read_b64_tr_b16 v[144:145], v4 offset:22528
    ds_read_b64_tr_b16 v[146:147], v25 offset:22528
    s_add_u32 m0, s52, 49152
    s_add_u32 s58, s72, 1024
    s_add_u32 s57, s58, s68
    v_mfma_f32_16x16x32_bf16 v[100:103], v[148:151], a[188:191], v[100:103]
    ds_read_b64_tr_b16 v[148:149], v4 offset:23552
    ds_read_b64_tr_b16 v[150:151], v25 offset:23552
    buffer_load_dwordx4 v3, s[24:27], s57 offen offset:0 sc1 lds
    v_mfma_f32_16x16x32_bf16 v[100:103], v[152:155], a[212:215], v[100:103]
    ds_read_b64_tr_b16 v[152:153], v4 offset:24576
    ds_read_b64_tr_b16 v[154:155], v25 offset:24576
    v_cvt_pk_bf16_f32 v36, v96, v97
    v_mfma_f32_16x16x32_bf16 v[100:103], v[156:159], a[236:239], v[100:103]
    ds_read_b64_tr_b16 v[156:157], v4 offset:25600
    ds_read_b64_tr_b16 v[158:159], v25 offset:25600
    v_cvt_pk_bf16_f32 v37, v98, v99
    v_mfma_f32_16x16x32_bf16 v[100:103], v[160:163], v[180:183], v[100:103]
    ds_read_b64_tr_b16 v[160:161], v4 offset:26624
    ds_read_b64_tr_b16 v[162:163], v25 offset:26624
    s_add_u32 s57, s58, s69
    v_mfma_f32_16x16x32_bf16 v[100:103], v[164:167], v[204:207], v[100:103]
    ds_read_b64_tr_b16 v[164:165], v4 offset:27648
    ds_read_b64_tr_b16 v[166:167], v25 offset:27648
    buffer_load_dwordx4 v3, s[24:27], s57 offen offset:1024 sc1 lds
    v_mfma_f32_16x16x32_bf16 v[100:103], v[168:171], v[228:231], v[100:103]
    ds_read_b64_tr_b16 v[168:169], v4 offset:28672
    ds_read_b64_tr_b16 v[170:171], v25 offset:28672
    ds_read_b64_tr_b16 a[146:147], v6 offset:33792
    v_mfma_f32_16x16x32_bf16 v[100:103], v[172:175], v[252:255], v[100:103]
    ds_read_b64_tr_b16 v[172:173], v4 offset:29696
    ds_read_b64_tr_b16 v[174:175], v25 offset:29696
    ds_read_b64_tr_b16 a[148:149], v7 offset:32768
    s_waitcnt lgkmcnt(15)
    v_mfma_f32_16x16x32_bf16 v[104:107], v[120:123], a[16:19], 0
    s_add_u32 s57, s58, s70
    ds_read_b64_tr_b16 a[150:151], v7 offset:33792
    v_mfma_f32_16x16x32_bf16 v[104:107], v[124:127], a[40:43], v[104:107]
    buffer_load_dwordx4 v24, s[24:27], s57 offen offset:2048 sc1 lds
    v_mfma_f32_16x16x32_bf16 v[104:107], v[128:131], a[64:67], v[104:107]
    ds_read_b64_tr_b16 a[168:169], v6 offset:40960
    ds_read_b64_tr_b16 a[170:171], v6 offset:41984
    v_mfma_f32_16x16x32_bf16 v[104:107], v[132:135], a[88:91], v[104:107]
    ds_read_b64_tr_b16 a[172:173], v7 offset:40960
    ds_read_b64_tr_b16 a[174:175], v7 offset:41984
    v_mfma_f32_16x16x32_bf16 v[104:107], v[136:139], a[112:115], v[104:107]
    s_add_u32 s57, s58, s71
    v_mfma_f32_16x16x32_bf16 v[104:107], v[140:143], a[136:139], v[104:107]
    buffer_load_dwordx4 v3, s[24:27], s57 offen offset:3072 sc1 lds
    s_waitcnt lgkmcnt(15)
    v_mfma_f32_16x16x32_bf16 v[104:107], v[144:147], a[160:163], v[104:107]
    v_cvt_pk_bf16_f32 v46, v100, v101
    v_cvt_pk_bf16_f32 v47, v102, v103
    v_mfma_f32_16x16x32_bf16 v[104:107], v[148:151], a[184:187], v[104:107]
    s_waitcnt vmcnt(10)
    s_waitcnt lgkmcnt(0)
    s_barrier
    v_mfma_f32_16x16x32_bf16 v[104:107], v[152:155], a[208:211], v[104:107]
    ds_read_b64_tr_b16 a[192:193], v10 offset:0
    ds_read_b64_tr_b16 a[194:195], v10 offset:1024
    v_mfma_f32_16x16x32_bf16 v[104:107], v[156:159], a[232:235], v[104:107]
    ds_read_b64_tr_b16 a[196:197], v11 offset:0
    ds_read_b64_tr_b16 a[198:199], v11 offset:1024
    v_mfma_f32_16x16x32_bf16 v[104:107], v[160:163], v[176:179], v[104:107]
    ds_read_b64_tr_b16 a[216:217], v10 offset:8192
    ds_read_b64_tr_b16 a[218:219], v10 offset:9216
    v_mfma_f32_16x16x32_bf16 v[104:107], v[164:167], v[200:203], v[104:107]
    ds_read_b64_tr_b16 a[220:221], v11 offset:8192
    ds_read_b64_tr_b16 a[222:223], v11 offset:9216
    v_mfma_f32_16x16x32_bf16 v[104:107], v[168:171], v[224:227], v[104:107]
    ds_read_b64_tr_b16 a[240:241], v10 offset:16384
    ds_read_b64_tr_b16 a[242:243], v10 offset:17408
    v_mfma_f32_16x16x32_bf16 v[104:107], v[172:175], v[248:251], v[104:107]
    ds_read_b64_tr_b16 a[244:245], v11 offset:16384
    ds_read_b64_tr_b16 a[246:247], v11 offset:17408
    v_mfma_f32_16x16x32_bf16 v[108:111], v[120:123], a[20:23], 0
    ds_read_b64_tr_b16 v[120:121], v4 offset:0
    ds_read_b64_tr_b16 v[122:123], v25 offset:0
    v_mfma_f32_16x16x32_bf16 v[108:111], v[124:127], a[44:47], v[108:111]
    ds_read_b64_tr_b16 v[124:125], v4 offset:1024
    ds_read_b64_tr_b16 v[126:127], v25 offset:1024
    v_mfma_f32_16x16x32_bf16 v[108:111], v[128:131], a[68:71], v[108:111]
    ds_read_b64_tr_b16 v[128:129], v4 offset:2048
    ds_read_b64_tr_b16 v[130:131], v25 offset:2048
    v_mfma_f32_16x16x32_bf16 v[108:111], v[132:135], a[92:95], v[108:111]
    ds_read_b64_tr_b16 v[132:133], v4 offset:3072
    ds_read_b64_tr_b16 v[134:135], v25 offset:3072
    v_mfma_f32_16x16x32_bf16 v[108:111], v[136:139], a[116:119], v[108:111]
    ds_read_b64_tr_b16 v[136:137], v4 offset:4096
    ds_read_b64_tr_b16 v[138:139], v25 offset:4096
    v_mfma_f32_16x16x32_bf16 v[108:111], v[140:143], a[140:143], v[108:111]
    ds_read_b64_tr_b16 v[140:141], v4 offset:5120
    ds_read_b64_tr_b16 v[142:143], v25 offset:5120
    v_mfma_f32_16x16x32_bf16 v[108:111], v[144:147], a[164:167], v[108:111]
    ds_read_b64_tr_b16 v[144:145], v4 offset:6144
    ds_read_b64_tr_b16 v[146:147], v25 offset:6144
    v_cvt_pk_bf16_f32 v34, v104, v105
    v_mfma_f32_16x16x32_bf16 v[108:111], v[148:151], a[188:191], v[108:111]
    ds_read_b64_tr_b16 v[148:149], v4 offset:7168
    ds_read_b64_tr_b16 v[150:151], v25 offset:7168
    v_cvt_pk_bf16_f32 v35, v106, v107
    v_mfma_f32_16x16x32_bf16 v[108:111], v[152:155], a[212:215], v[108:111]
    ds_read_b64_tr_b16 v[152:153], v4 offset:8192
    ds_read_b64_tr_b16 v[154:155], v25 offset:8192
    v_mfma_f32_16x16x32_bf16 v[108:111], v[156:159], a[236:239], v[108:111]
    ds_read_b64_tr_b16 v[156:157], v4 offset:9216
    ds_read_b64_tr_b16 v[158:159], v25 offset:9216
    v_mfma_f32_16x16x32_bf16 v[108:111], v[160:163], v[180:183], v[108:111]
    ds_read_b64_tr_b16 v[160:161], v4 offset:10240
    ds_read_b64_tr_b16 v[162:163], v25 offset:10240
    v_mfma_f32_16x16x32_bf16 v[108:111], v[164:167], v[204:207], v[108:111]
    ds_read_b64_tr_b16 v[164:165], v4 offset:11264
    ds_read_b64_tr_b16 v[166:167], v25 offset:11264
    v_mfma_f32_16x16x32_bf16 v[108:111], v[168:171], v[228:231], v[108:111]
    ds_read_b64_tr_b16 v[168:169], v4 offset:12288
    ds_read_b64_tr_b16 v[170:171], v25 offset:12288
    v_mfma_f32_16x16x32_bf16 v[108:111], v[172:175], v[252:255], v[108:111]
    ds_read_b64_tr_b16 v[172:173], v4 offset:13312
    ds_read_b64_tr_b16 v[174:175], v25 offset:13312
    s_waitcnt lgkmcnt(15)
    v_mfma_f32_16x16x32_bf16 v[112:115], v[120:123], a[16:19], 0
    v_mfma_f32_16x16x32_bf16 v[112:115], v[124:127], a[40:43], v[112:115]
    v_mfma_f32_16x16x32_bf16 v[112:115], v[128:131], a[64:67], v[112:115]
    v_mfma_f32_16x16x32_bf16 v[112:115], v[132:135], a[88:91], v[112:115]
    s_waitcnt vmcnt(4)
    s_barrier
    v_mfma_f32_16x16x32_bf16 v[112:115], v[136:139], a[112:115], v[112:115]
    ds_read_b64_tr_b16 v[184:185], v10 offset:24576
    ds_read_b64_tr_b16 v[186:187], v10 offset:25600
    v_mfma_f32_16x16x32_bf16 v[112:115], v[140:143], a[136:139], v[112:115]
    ds_read_b64_tr_b16 v[188:189], v11 offset:24576
    ds_read_b64_tr_b16 v[190:191], v11 offset:25600
    s_waitcnt lgkmcnt(14)
    v_mfma_f32_16x16x32_bf16 v[112:115], v[144:147], a[160:163], v[112:115]
    v_cvt_pk_bf16_f32 v44, v108, v109
    v_cvt_pk_bf16_f32 v45, v110, v111
    v_mfma_f32_16x16x32_bf16 v[112:115], v[148:151], a[184:187], v[112:115]
    ds_read_b64_tr_b16 v[208:209], v10 offset:32768
    ds_read_b64_tr_b16 v[210:211], v10 offset:33792
    v_mfma_f32_16x16x32_bf16 v[112:115], v[152:155], a[208:211], v[112:115]
    ds_read_b64_tr_b16 v[212:213], v11 offset:32768
    ds_read_b64_tr_b16 v[214:215], v11 offset:33792
    s_waitcnt lgkmcnt(12)
    v_mfma_f32_16x16x32_bf16 v[112:115], v[156:159], a[232:235], v[112:115]
    ds_read_b64_tr_b16 v[232:233], v10 offset:40960
    ds_read_b64_tr_b16 v[234:235], v10 offset:41984
    v_mfma_f32_16x16x32_bf16 v[112:115], v[160:163], v[176:179], v[112:115]
    ds_read_b64_tr_b16 v[236:237], v11 offset:40960
    ds_read_b64_tr_b16 v[238:239], v11 offset:41984
    v_mfma_f32_16x16x32_bf16 v[112:115], v[164:167], v[200:203], v[112:115]
    s_waitcnt lgkmcnt(12)
    v_mfma_f32_16x16x32_bf16 v[112:115], v[168:171], v[224:227], v[112:115]
    v_mfma_f32_16x16x32_bf16 v[112:115], v[172:175], v[248:251], v[112:115]
    v_mfma_f32_16x16x32_bf16 v[116:119], v[120:123], a[20:23], 0
    ds_read_b64_tr_b16 v[120:121], v4 offset:16384
    ds_read_b64_tr_b16 v[122:123], v25 offset:16384
    v_mfma_f32_16x16x32_bf16 v[116:119], v[124:127], a[44:47], v[116:119]
    ds_read_b64_tr_b16 v[124:125], v4 offset:17408
    ds_read_b64_tr_b16 v[126:127], v25 offset:17408
    s_waitcnt lgkmcnt(4)
    s_barrier
    v_mfma_f32_16x16x32_bf16 v[116:119], v[128:131], a[68:71], v[116:119]
    ds_read_b64_tr_b16 v[128:129], v4 offset:18432
    ds_read_b64_tr_b16 v[130:131], v25 offset:18432
    s_add_u32 m0, s52, 65536
    s_add_u32 s58, s72, 1536
    s_add_u32 s57, s58, s68
    v_mfma_f32_16x16x32_bf16 v[116:119], v[132:135], a[92:95], v[116:119]
    ds_read_b64_tr_b16 v[132:133], v4 offset:19456
    ds_read_b64_tr_b16 v[134:135], v25 offset:19456
    buffer_load_dwordx4 v3, s[24:27], s57 offen offset:0 sc1 lds
    v_mfma_f32_16x16x32_bf16 v[116:119], v[136:139], a[116:119], v[116:119]
    ds_read_b64_tr_b16 v[136:137], v4 offset:20480
    ds_read_b64_tr_b16 v[138:139], v25 offset:20480
    v_mfma_f32_16x16x32_bf16 v[116:119], v[140:143], a[140:143], v[116:119]
    ds_read_b64_tr_b16 v[140:141], v4 offset:21504
    ds_read_b64_tr_b16 v[142:143], v25 offset:21504
    v_mfma_f32_16x16x32_bf16 v[116:119], v[144:147], a[164:167], v[116:119]
    ds_read_b64_tr_b16 v[144:145], v4 offset:22528
    ds_read_b64_tr_b16 v[146:147], v25 offset:22528
    v_cvt_pk_bf16_f32 v32, v112, v113
    v_mfma_f32_16x16x32_bf16 v[116:119], v[148:151], a[188:191], v[116:119]
    ds_read_b64_tr_b16 v[148:149], v4 offset:23552
    ds_read_b64_tr_b16 v[150:151], v25 offset:23552
    v_cvt_pk_bf16_f32 v33, v114, v115
    v_mfma_f32_16x16x32_bf16 v[116:119], v[152:155], a[212:215], v[116:119]
    ds_read_b64_tr_b16 v[152:153], v4 offset:24576
    ds_read_b64_tr_b16 v[154:155], v25 offset:24576
    s_add_u32 s57, s58, s69
    v_mfma_f32_16x16x32_bf16 v[116:119], v[156:159], a[236:239], v[116:119]
    ds_read_b64_tr_b16 v[156:157], v4 offset:25600
    ds_read_b64_tr_b16 v[158:159], v25 offset:25600
    buffer_load_dwordx4 v3, s[24:27], s57 offen offset:1024 sc1 lds
    v_mfma_f32_16x16x32_bf16 v[116:119], v[160:163], v[180:183], v[116:119]
    ds_read_b64_tr_b16 v[160:161], v4 offset:26624
    ds_read_b64_tr_b16 v[162:163], v25 offset:26624
    v_mfma_f32_16x16x32_bf16 v[116:119], v[164:167], v[204:207], v[116:119]
    ds_read_b64_tr_b16 v[164:165], v4 offset:27648
    ds_read_b64_tr_b16 v[166:167], v25 offset:27648
    v_mfma_f32_16x16x32_bf16 v[116:119], v[168:171], v[228:231], v[116:119]
    ds_read_b64_tr_b16 v[168:169], v4 offset:28672
    ds_read_b64_tr_b16 v[170:171], v25 offset:28672
    v_mfma_f32_16x16x32_bf16 v[116:119], v[172:175], v[252:255], v[116:119]
    ds_read_b64_tr_b16 v[172:173], v4 offset:29696
    ds_read_b64_tr_b16 v[174:175], v25 offset:29696
    s_waitcnt lgkmcnt(15)
    v_mfma_f32_16x16x32_bf16 v[96:99], a[0:3], v[120:123], 0
    s_add_u32 s57, s58, s70
    v_mfma_f32_16x16x32_bf16 v[96:99], a[24:27], v[124:127], v[96:99]
    buffer_load_dwordx4 v24, s[24:27], s57 offen offset:2048 sc1 lds
    v_mfma_f32_16x16x32_bf16 v[96:99], a[48:51], v[128:131], v[96:99]
    v_mfma_f32_16x16x32_bf16 v[96:99], a[72:75], v[132:135], v[96:99]
    v_mfma_f32_16x16x32_bf16 v[96:99], a[96:99], v[136:139], v[96:99]
    v_mfma_f32_16x16x32_bf16 v[96:99], a[120:123], v[140:143], v[96:99]
    s_waitcnt lgkmcnt(10)
    v_mfma_f32_16x16x32_bf16 v[96:99], a[144:147], v[144:147], v[96:99]
    s_add_u32 s57, s58, s71
    v_cvt_pk_bf16_f32 v42, v116, v117
    v_mfma_f32_16x16x32_bf16 v[96:99], a[168:171], v[148:151], v[96:99]
    buffer_load_dwordx4 v3, s[24:27], s57 offen offset:3072 sc1 lds
    v_mfma_f32_16x16x32_bf16 v[96:99], a[192:195], v[152:155], v[96:99]
    v_cvt_pk_bf16_f32 v43, v118, v119
    s_waitcnt lgkmcnt(4)
    v_mfma_f32_16x16x32_bf16 v[96:99], a[216:219], v[156:159], v[96:99]
    v_mfma_f32_16x16x32_bf16 v[96:99], a[240:243], v[160:163], v[96:99]
    v_mfma_f32_16x16x32_bf16 v[96:99], v[184:187], v[164:167], v[96:99]
    s_waitcnt lgkmcnt(0)
    v_mfma_f32_16x16x32_bf16 v[96:99], v[208:211], v[168:171], v[96:99]
    s_add_u32 m0, s52, 81920
    s_add_u32 s58, s72, 2048
    s_add_u32 s57, s58, s68
    v_mfma_f32_16x16x32_bf16 v[96:99], v[232:235], v[172:175], v[96:99]
    buffer_load_dwordx4 v3, s[24:27], s57 offen offset:0 sc1 lds
    v_mfma_f32_16x16x32_bf16 v[100:103], a[4:7], v[120:123], 0
    ds_read_b64_tr_b16 v[120:121], v4 offset:32768
    ds_read_b64_tr_b16 v[122:123], v25 offset:32768
    v_mfma_f32_16x16x32_bf16 v[100:103], a[28:31], v[124:127], v[100:103]
    ds_read_b64_tr_b16 v[124:125], v4 offset:33792
    ds_read_b64_tr_b16 v[126:127], v25 offset:33792
    v_mfma_f32_16x16x32_bf16 v[100:103], a[52:55], v[128:131], v[100:103]
    ds_read_b64_tr_b16 v[128:129], v4 offset:34816
    ds_read_b64_tr_b16 v[130:131], v25 offset:34816
    v_mfma_f32_16x16x32_bf16 v[100:103], a[76:79], v[132:135], v[100:103]
    ds_read_b64_tr_b16 v[132:133], v4 offset:35840
    ds_read_b64_tr_b16 v[134:135], v25 offset:35840
    v_mfma_f32_16x16x32_bf16 v[100:103], a[100:103], v[136:139], v[100:103]
    ds_read_b64_tr_b16 v[136:137], v4 offset:36864
    ds_read_b64_tr_b16 v[138:139], v25 offset:36864
    s_add_u32 s57, s58, s69
    v_mfma_f32_16x16x32_bf16 v[100:103], a[124:127], v[140:143], v[100:103]
    ds_read_b64_tr_b16 v[140:141], v4 offset:37888
    ds_read_b64_tr_b16 v[142:143], v25 offset:37888
    buffer_load_dwordx4 v3, s[24:27], s57 offen offset:1024 sc1 lds
    v_mfma_f32_16x16x32_bf16 v[100:103], a[148:151], v[144:147], v[100:103]
    ds_read_b64_tr_b16 v[144:145], v4 offset:38912
    ds_read_b64_tr_b16 v[146:147], v25 offset:38912
    v_cvt_pk_bf16_f32 v68, v96, v97
    v_mfma_f32_16x16x32_bf16 v[100:103], a[172:175], v[148:151], v[100:103]
    ds_read_b64_tr_b16 v[148:149], v4 offset:39936
    ds_read_b64_tr_b16 v[150:151], v25 offset:39936
    v_cvt_pk_bf16_f32 v69, v98, v99
    v_mfma_f32_16x16x32_bf16 v[100:103], a[196:199], v[152:155], v[100:103]
    ds_read_b64_tr_b16 v[152:153], v4 offset:40960
    ds_read_b64_tr_b16 v[154:155], v25 offset:40960
    v_mfma_f32_16x16x32_bf16 v[100:103], a[220:223], v[156:159], v[100:103]
    ds_read_b64_tr_b16 v[156:157], v4 offset:41984
    ds_read_b64_tr_b16 v[158:159], v25 offset:41984
    v_mfma_f32_16x16x32_bf16 v[100:103], a[244:247], v[160:163], v[100:103]
    ds_read_b64_tr_b16 v[160:161], v4 offset:43008
    ds_read_b64_tr_b16 v[162:163], v25 offset:43008
    s_add_u32 s57, s58, s70
    v_mfma_f32_16x16x32_bf16 v[100:103], v[188:191], v[164:167], v[100:103]
    ds_read_b64_tr_b16 v[164:165], v4 offset:44032
    ds_read_b64_tr_b16 v[166:167], v25 offset:44032
    buffer_load_dwordx4 v24, s[24:27], s57 offen offset:2048 sc1 lds
    v_mfma_f32_16x16x32_bf16 v[100:103], v[212:215], v[168:171], v[100:103]
    ds_read_b64_tr_b16 v[168:169], v4 offset:45056
    ds_read_b64_tr_b16 v[170:171], v25 offset:45056
    v_mfma_f32_16x16x32_bf16 v[100:103], v[236:239], v[172:175], v[100:103]
    ds_read_b64_tr_b16 v[172:173], v4 offset:46080
    ds_read_b64_tr_b16 v[174:175], v25 offset:46080
    s_waitcnt lgkmcnt(15)
    v_mfma_f32_16x16x32_bf16 v[104:107], a[0:3], v[120:123], 0
    v_mfma_f32_16x16x32_bf16 v[104:107], a[24:27], v[124:127], v[104:107]
    v_mfma_f32_16x16x32_bf16 v[104:107], a[48:51], v[128:131], v[104:107]
    s_add_u32 s57, s58, s71
    v_mfma_f32_16x16x32_bf16 v[104:107], a[72:75], v[132:135], v[104:107]
    buffer_load_dwordx4 v3, s[24:27], s57 offen offset:3072 sc1 lds
    v_mfma_f32_16x16x32_bf16 v[104:107], a[96:99], v[136:139], v[104:107]
    v_mfma_f32_16x16x32_bf16 v[104:107], a[120:123], v[140:143], v[104:107]
    s_waitcnt lgkmcnt(10)
    v_mfma_f32_16x16x32_bf16 v[104:107], a[144:147], v[144:147], v[104:107]
    v_cvt_pk_bf16_f32 v70, v100, v101
    v_cvt_pk_bf16_f32 v71, v102, v103
    v_mfma_f32_16x16x32_bf16 v[104:107], a[168:171], v[148:151], v[104:107]
    v_cndmask_b32 v70, v70, 0, s[82:83]
    v_cndmask_b32 v71, v71, 0, s[82:83]
    v_mfma_f32_16x16x32_bf16 v[104:107], a[192:195], v[152:155], v[104:107]
    s_add_u32 m0, s52, 98304
    s_add_u32 s58, s72, 2560
    s_add_u32 s57, s58, s68
    v_mov_b32 v8, 0
    s_waitcnt lgkmcnt(4)
    v_mfma_f32_16x16x32_bf16 v[104:107], a[216:219], v[156:159], v[104:107]
    buffer_load_dwordx4 v3, s[24:27], s57 offen offset:0 sc1 lds
    v_mfma_f32_16x16x32_bf16 v[104:107], a[240:243], v[160:163], v[104:107]
    v_mov_b32 v9, 0
    v_mov_b32 v10, 0
    v_mfma_f32_16x16x32_bf16 v[104:107], v[184:187], v[164:167], v[104:107]
    v_mfma_f32_16x16x32_bf16 v[72:75], v[52:55], v[68:71], 0
    s_waitcnt lgkmcnt(0)
    v_mfma_f32_16x16x32_bf16 v[104:107], v[208:211], v[168:171], v[104:107]
    v_mfma_f32_16x16x32_bf16 v[76:79], v[56:59], v[68:71], 0
    v_mfma_f32_16x16x32_bf16 v[104:107], v[232:235], v[172:175], v[104:107]
    ds_read_u16_d16_hi v8, v93 offset:0
    ds_read_u16_d16_hi v9, v94 offset:0
    s_waitcnt vmcnt(9)
    s_barrier
    v_mfma_f32_16x16x32_bf16 v[108:111], a[4:7], v[120:123], 0
    ds_read_b64_tr_b16 v[120:121], v4 offset:49152
    ds_read_b64_tr_b16 v[122:123], v25 offset:49152
    s_add_u32 s57, s58, s69
    v_mfma_f32_16x16x32_bf16 v[108:111], a[28:31], v[124:127], v[108:111]
    ds_read_b64_tr_b16 v[124:125], v4 offset:50176
    ds_read_b64_tr_b16 v[126:127], v25 offset:50176
    buffer_load_dwordx4 v3, s[24:27], s57 offen offset:1024 sc1 lds
    v_mfma_f32_16x16x32_bf16 v[108:111], a[52:55], v[128:131], v[108:111]
    ds_read_b64_tr_b16 v[128:129], v4 offset:51200
    ds_read_b64_tr_b16 v[130:131], v25 offset:51200
    ds_read_u16_d16_hi v10, v92 offset:0
    v_mfma_f32_16x16x32_bf16 v[108:111], a[76:79], v[132:135], v[108:111]
    ds_read_b64_tr_b16 v[132:133], v4 offset:52224
    ds_read_b64_tr_b16 v[134:135], v25 offset:52224
    v_mfma_f32_16x16x32_bf16 v[108:111], a[100:103], v[136:139], v[108:111]
    ds_read_b64_tr_b16 v[136:137], v4 offset:53248
    ds_read_b64_tr_b16 v[138:139], v25 offset:53248
    v_mfma_f32_16x16x32_bf16 v[108:111], a[124:127], v[140:143], v[108:111]
    ds_read_b64_tr_b16 v[140:141], v4 offset:54272
    ds_read_b64_tr_b16 v[142:143], v25 offset:54272
    v_mfma_f32_16x16x32_bf16 v[108:111], a[148:151], v[144:147], v[108:111]
    ds_read_b64_tr_b16 v[144:145], v4 offset:55296
    ds_read_b64_tr_b16 v[146:147], v25 offset:55296
    s_add_u32 s57, s58, s70
    v_mfma_f32_16x16x32_bf16 v[108:111], a[172:175], v[148:151], v[108:111]
    ds_read_b64_tr_b16 v[148:149], v4 offset:56320
    ds_read_b64_tr_b16 v[150:151], v25 offset:56320
    buffer_load_dwordx4 v24, s[24:27], s57 offen offset:2048 sc1 lds
    v_mfma_f32_16x16x32_bf16 v[108:111], a[196:199], v[152:155], v[108:111]
    ds_read_b64_tr_b16 v[152:153], v4 offset:57344
    ds_read_b64_tr_b16 v[154:155], v25 offset:57344
    v_cvt_pk_bf16_f32 v64, v104, v105
    v_mfma_f32_16x16x32_bf16 v[108:111], a[220:223], v[156:159], v[108:111]
    ds_read_b64_tr_b16 v[156:157], v4 offset:58368
    ds_read_b64_tr_b16 v[158:159], v25 offset:58368
    v_cvt_pk_bf16_f32 v65, v106, v107
    v_mfma_f32_16x16x32_bf16 v[108:111], a[244:247], v[160:163], v[108:111]
    ds_read_b64_tr_b16 v[160:161], v4 offset:59392
    ds_read_b64_tr_b16 v[162:163], v25 offset:59392
    v_cndmask_b32 v26, v72, v73, s[76:77]
    v_mfma_f32_16x16x32_bf16 v[108:111], v[188:191], v[164:167], v[108:111]
    ds_read_b64_tr_b16 v[164:165], v4 offset:60416
    ds_read_b64_tr_b16 v[166:167], v25 offset:60416
    v_cndmask_b32 v27, v74, v75, s[76:77]
    v_mfma_f32_16x16x32_bf16 v[108:111], v[212:215], v[168:171], v[108:111]
    ds_read_b64_tr_b16 v[168:169], v4 offset:61440
    ds_read_b64_tr_b16 v[170:171], v25 offset:61440
    s_add_u32 s57, s58, s71
    v_mfma_f32_16x16x32_bf16 v[108:111], v[236:239], v[172:175], v[108:111]
    ds_read_b64_tr_b16 v[172:173], v4 offset:62464
    ds_read_b64_tr_b16 v[174:175], v25 offset:62464
    buffer_load_dwordx4 v3, s[24:27], s57 offen offset:3072 sc1 lds
    s_waitcnt lgkmcnt(15)
    v_mfma_f32_16x16x32_bf16 v[112:115], a[8:11], v[120:123], 0
    v_cndmask_b32 v28, v76, v77, s[76:77]
    v_cndmask_b32 v29, v78, v79, s[76:77]
    v_mfma_f32_16x16x32_bf16 v[112:115], a[32:35], v[124:127], v[112:115]
    v_cndmask_b32 v26, v26, v28, s[78:79]
    v_cndmask_b32 v27, v27, v29, s[80:81]
    v_mfma_f32_16x16x32_bf16 v[112:115], a[56:59], v[128:131], v[112:115]
    v_mul_f32 v26, v26, v8
    v_mfma_f32_16x16x32_bf16 v[112:115], a[80:83], v[132:135], v[112:115]
    v_mul_f32 v27, v27, v9
    v_mul_f32 v11, s91, v10
    v_mfma_f32_16x16x32_bf16 v[112:115], a[104:107], v[136:139], v[112:115]
    s_add_u32 m0, s52, 114688
    s_add_u32 s58, s72, 3072
    s_add_u32 s57, s58, s68
    v_cndmask_b32 v26, v26, v18, s[84:85]
    v_mfma_f32_16x16x32_bf16 v[112:115], a[128:131], v[140:143], v[112:115]
    buffer_load_dwordx4 v3, s[24:27], s57 offen offset:0 sc1 lds
    s_waitcnt lgkmcnt(10)
    v_mfma_f32_16x16x32_bf16 v[112:115], a[152:155], v[144:147], v[112:115]
    v_cvt_pk_bf16_f32 v66, v108, v109
    v_cvt_pk_bf16_f32 v67, v110, v111
    v_mfma_f32_16x16x32_bf16 v[112:115], a[176:179], v[148:151], v[112:115]
    v_cndmask_b32 v66, v66, 0, s[82:83]
    v_cndmask_b32 v67, v67, 0, s[82:83]
    v_mfma_f32_16x16x32_bf16 v[112:115], a[200:203], v[152:155], v[112:115]
    v_cndmask_b32 v27, v27, v18, s[86:87]
    v_max_f32 v28, v26, v27
    s_waitcnt lgkmcnt(4)
    v_mfma_f32_16x16x32_bf16 v[112:115], a[224:227], v[156:159], v[112:115]
    v_mov_b32 v29, v28
    v_mfma_f32_16x16x32_bf16 v[112:115], a[248:251], v[160:163], v[112:115]
    s_add_u32 s57, s58, s69
    v_mfma_f32_16x16x32_bf16 v[112:115], v[192:195], v[164:167], v[112:115]
    buffer_load_dwordx4 v3, s[24:27], s57 offen offset:1024 sc1 lds
    s_waitcnt lgkmcnt(0)
    v_mfma_f32_16x16x32_bf16 v[112:115], v[216:219], v[168:171], v[112:115]
    v_permlane16_swap_b32 v28, v29
    v_max_f32 v28, v28, v29
    v_mfma_f32_16x16x32_bf16 v[112:115], v[240:243], v[172:175], v[112:115]
    v_mov_b32 v29, v28
    v_mfma_f32_16x16x32_bf16 v[116:119], a[12:15], v[120:123], 0
    v_mfma_f32_16x16x32_bf16 v[116:119], a[36:39], v[124:127], v[116:119]
    v_permlane32_swap_b32 v28, v29
    v_max_f32 v28, v28, v29
    v_mfma_f32_16x16x32_bf16 v[116:119], a[60:63], v[128:131], v[116:119]
    s_add_u32 s57, s58, s70
    v_sub_f32 v26, v26, v28
    v_mfma_f32_16x16x32_bf16 v[116:119], a[84:87], v[132:135], v[116:119]
    buffer_load_dwordx4 v24, s[24:27], s57 offen offset:2048 sc1 lds
    v_mfma_f32_16x16x32_bf16 v[116:119], a[108:111], v[136:139], v[116:119]
    v_sub_f32 v27, v27, v28
    v_mul_f32 v26, v11, v26
    v_mfma_f32_16x16x32_bf16 v[116:119], a[132:135], v[140:143], v[116:119]
    v_mul_f32 v27, v11, v27
    v_exp_f32 v26, v26
    v_mfma_f32_16x16x32_bf16 v[116:119], a[156:159], v[144:147], v[116:119]
    v_cvt_pk_bf16_f32 v52, v112, v113
    v_cvt_pk_bf16_f32 v53, v114, v115
    v_mfma_f32_16x16x32_bf16 v[116:119], a[180:183], v[148:151], v[116:119]
    v_exp_f32 v27, v27
    v_mfma_f32_16x16x32_bf16 v[116:119], a[204:207], v[152:155], v[116:119]
    s_add_u32 s57, s58, s71
    v_add_f32 v28, v26, v27
    v_mfma_f32_16x16x32_bf16 v[116:119], a[228:231], v[156:159], v[116:119]
    buffer_load_dwordx4 v3, s[24:27], s57 offen offset:3072 sc1 lds
    v_mfma_f32_16x16x32_bf16 v[116:119], a[252:255], v[160:163], v[116:119]
    v_mov_b32 v29, v28
    v_mfma_f32_16x16x32_bf16 v[116:119], v[196:199], v[164:167], v[116:119]
    v_mfma_f32_16x16x32_bf16 v[116:119], v[220:223], v[168:171], v[116:119]
    v_permlane16_swap_b32 v28, v29
    v_add_f32 v28, v28, v29
    v_mfma_f32_16x16x32_bf16 v[116:119], v[244:247], v[172:175], v[116:119]
    v_mov_b32 v29, v28
    v_mfma_f32_16x16x32_bf16 v[96:99], v[120:123], a[16:19], 0
    s_add_u32 m0, s52, 131072
    s_add_u32 s58, s72, 3584
    s_add_u32 s57, s58, s68
    v_mfma_f32_16x16x32_bf16 v[96:99], v[124:127], a[40:43], v[96:99]
    buffer_load_dwordx4 v3, s[24:27], s57 offen offset:0 sc1 lds
    v_mfma_f32_16x16x32_bf16 v[96:99], v[128:131], a[64:67], v[96:99]
    v_permlane32_swap_b32 v28, v29
    v_add_f32 v28, v28, v29
    v_mfma_f32_16x16x32_bf16 v[96:99], v[132:135], a[88:91], v[96:99]
    v_rcp_f32 v28, v28
    v_mfma_f32_16x16x32_bf16 v[96:99], v[136:139], a[112:115], v[96:99]
    v_mul_f32 v26, v26, v8
    v_mul_f32 v27, v27, v9
    v_mfma_f32_16x16x32_bf16 v[96:99], v[140:143], a[136:139], v[96:99]
    v_mul_f32 v26, v26, v28
    v_mul_f32 v27, v27, v28
    v_mfma_f32_16x16x32_bf16 v[96:99], v[144:147], a[160:163], v[96:99]
    s_add_u32 s57, s58, s69
    v_cvt_pk_bf16_f32 v54, v116, v117
    v_mfma_f32_16x16x32_bf16 v[96:99], v[148:151], a[184:187], v[96:99]
    buffer_load_dwordx4 v3, s[24:27], s57 offen offset:1024 sc1 lds
    v_mfma_f32_16x16x32_bf16 v[96:99], v[152:155], a[208:211], v[96:99]
    v_cvt_pk_bf16_f32 v55, v118, v119
    v_cndmask_b32 v54, v54, 0, s[82:83]
    v_mfma_f32_16x16x32_bf16 v[96:99], v[156:159], a[232:235], v[96:99]
    v_cndmask_b32 v55, v55, 0, s[82:83]
    v_cvt_pk_bf16_f32 v26, v26, v26
    v_mfma_f32_16x16x32_bf16 v[96:99], v[160:163], v[176:179], v[96:99]
    v_cvt_pk_bf16_f32 v27, v27, v27
    v_and_b32 v80, v26, v14
    v_mfma_f32_16x16x32_bf16 v[96:99], v[164:167], v[200:203], v[96:99]
    v_and_b32 v81, v27, v15
    v_and_b32 v82, v26, v16
    v_mfma_f32_16x16x32_bf16 v[96:99], v[168:171], v[224:227], v[96:99]
    s_add_u32 s57, s58, s70
    v_and_b32 v83, v27, v17
    v_mfma_f32_16x16x32_bf16 v[96:99], v[172:175], v[248:251], v[96:99]
    buffer_load_dwordx4 v24, s[24:27], s57 offen offset:2048 sc1 lds
    v_mfma_f32_16x16x32_bf16 v[100:103], v[120:123], a[20:23], 0
    v_mfma_f32_16x16x32_bf16 v[72:75], v[32:35], v[80:83], 0
    v_mfma_f32_16x16x32_bf16 v[100:103], v[124:127], a[44:47], v[100:103]
    v_mfma_f32_16x16x32_bf16 v[76:79], v[42:45], v[80:83], 0
    v_mfma_f32_16x16x32_bf16 v[100:103], v[128:131], a[68:71], v[100:103]
    s_add_u32 s53, s74, 0
    v_mfma_f32_16x16x32_bf16 v[100:103], v[132:135], a[92:95], v[100:103]
    v_mfma_f32_16x16x32_bf16 v[100:103], v[136:139], a[116:119], v[100:103]
    s_add_u32 s57, s58, s71
    v_mfma_f32_16x16x32_bf16 v[100:103], v[140:143], a[140:143], v[100:103]
    buffer_load_dwordx4 v3, s[24:27], s57 offen offset:3072 sc1 lds
    v_mfma_f32_16x16x32_bf16 v[100:103], v[144:147], a[164:167], v[100:103]
    v_cvt_pk_bf16_f32 v38, v96, v97
    v_cvt_pk_bf16_f32 v39, v98, v99
    v_mfma_f32_16x16x32_bf16 v[100:103], v[148:151], a[188:191], v[100:103]
    v_cvt_pk_bf16_f32 v84, v72, v73
    v_cvt_pk_bf16_f32 v85, v74, v75
    v_mfma_f32_16x16x32_bf16 v[100:103], v[152:155], a[212:215], v[100:103]
    v_cvt_pk_bf16_f32 v86, v76, v77
    v_cvt_pk_bf16_f32 v87, v78, v79
    v_mfma_f32_16x16x32_bf16 v[100:103], v[156:159], a[236:239], v[100:103]
    buffer_store_dwordx4 v[84:87], v23, s[24:27], s53 offen sc1
    v_mfma_f32_16x16x32_bf16 v[100:103], v[160:163], v[180:183], v[100:103]
    s_add_u32 s57, s73, 0
    v_cndmask_b32 v80, v84, v86, s[88:89]
    v_mfma_f32_16x16x32_bf16 v[100:103], v[164:167], v[204:207], v[100:103]
    buffer_load_dword v22, v5, s[20:23], s57 offen
    v_mfma_f32_16x16x32_bf16 v[100:103], v[168:171], v[228:231], v[100:103]
    v_cndmask_b32 v81, v85, v87, s[88:89]
    ds_write_b64 v95, v[80:81] offset:0
    v_mfma_f32_16x16x32_bf16 v[100:103], v[172:175], v[252:255], v[100:103]
    v_mfma_f32_16x16x32_bf16 v[104:107], a[0:3], v[120:123], 0
    v_mfma_f32_16x16x32_bf16 v[72:75], v[56:59], v[64:67], 0
    v_mfma_f32_16x16x32_bf16 v[104:107], a[24:27], v[124:127], v[104:107]
    v_mfma_f32_16x16x32_bf16 v[76:79], v[60:63], v[64:67], 0
    v_mfma_f32_16x16x32_bf16 v[104:107], a[48:51], v[128:131], v[104:107]
    ds_read_u16_d16_hi v8, v93 offset:16384
    ds_read_u16_d16_hi v9, v94 offset:16384
    v_mfma_f32_16x16x32_bf16 v[104:107], a[72:75], v[132:135], v[104:107]
    ds_read_u16_d16_hi v10, v92 offset:16384
    v_mfma_f32_16x16x32_bf16 v[104:107], a[96:99], v[136:139], v[104:107]
    v_mfma_f32_16x16x32_bf16 v[104:107], a[120:123], v[140:143], v[104:107]
    v_mfma_f32_16x16x32_bf16 v[104:107], a[144:147], v[144:147], v[104:107]
    v_cvt_pk_bf16_f32 v48, v100, v101
    v_cvt_pk_bf16_f32 v49, v102, v103
    v_mfma_f32_16x16x32_bf16 v[104:107], a[168:171], v[148:151], v[104:107]
    v_cndmask_b32 v26, v72, v73, s[76:77]
    v_cndmask_b32 v27, v74, v75, s[76:77]
    v_mfma_f32_16x16x32_bf16 v[104:107], a[192:195], v[152:155], v[104:107]
    v_cndmask_b32 v28, v76, v77, s[76:77]
    v_cndmask_b32 v29, v78, v79, s[76:77]
    v_mfma_f32_16x16x32_bf16 v[104:107], a[216:219], v[156:159], v[104:107]
    v_cndmask_b32 v26, v26, v28, s[78:79]
    v_cndmask_b32 v27, v27, v29, s[80:81]
    v_mfma_f32_16x16x32_bf16 v[104:107], a[240:243], v[160:163], v[104:107]
    s_waitcnt lgkmcnt(0)
    v_mul_f32 v26, v26, v8
    v_mfma_f32_16x16x32_bf16 v[104:107], v[184:187], v[164:167], v[104:107]
    v_mul_f32 v27, v27, v9
    v_mul_f32 v11, s91, v10
    v_mfma_f32_16x16x32_bf16 v[104:107], v[208:211], v[168:171], v[104:107]
    v_max_f32 v28, v26, v27
    v_mov_b32 v29, v28
    v_mfma_f32_16x16x32_bf16 v[104:107], v[232:235], v[172:175], v[104:107]
    s_waitcnt vmcnt(6)
    s_barrier
    v_mfma_f32_16x16x32_bf16 v[108:111], a[4:7], v[120:123], 0
    v_add_u32 v4, 65536, v4
    v_add_u32 v25, 65536, v25
    ds_read_b64_tr_b16 v[120:121], v4 offset:0
    ds_read_b64_tr_b16 v[122:123], v25 offset:0
    v_permlane16_swap_b32 v28, v29
    v_mfma_f32_16x16x32_bf16 v[108:111], a[28:31], v[124:127], v[108:111]
    ds_read_b64_tr_b16 v[124:125], v4 offset:1024
    ds_read_b64_tr_b16 v[126:127], v25 offset:1024
    v_max_f32 v28, v28, v29
    v_mfma_f32_16x16x32_bf16 v[108:111], a[52:55], v[128:131], v[108:111]
    ds_read_b64_tr_b16 v[128:129], v4 offset:2048
    ds_read_b64_tr_b16 v[130:131], v25 offset:2048
    v_mov_b32 v29, v28
    v_mfma_f32_16x16x32_bf16 v[108:111], a[76:79], v[132:135], v[108:111]
    ds_read_b64_tr_b16 v[132:133], v4 offset:3072
    ds_read_b64_tr_b16 v[134:135], v25 offset:3072
    v_mfma_f32_16x16x32_bf16 v[108:111], a[100:103], v[136:139], v[108:111]
    ds_read_b64_tr_b16 v[136:137], v4 offset:4096
    ds_read_b64_tr_b16 v[138:139], v25 offset:4096
    v_permlane32_swap_b32 v28, v29
    v_mfma_f32_16x16x32_bf16 v[108:111], a[124:127], v[140:143], v[108:111]
    ds_read_b64_tr_b16 v[140:141], v4 offset:5120
    ds_read_b64_tr_b16 v[142:143], v25 offset:5120
    v_max_f32 v28, v28, v29
    v_mfma_f32_16x16x32_bf16 v[108:111], a[148:151], v[144:147], v[108:111]
    ds_read_b64_tr_b16 v[144:145], v4 offset:6144
    ds_read_b64_tr_b16 v[146:147], v25 offset:6144
    v_cvt_pk_bf16_f32 v68, v104, v105
    v_mfma_f32_16x16x32_bf16 v[108:111], a[172:175], v[148:151], v[108:111]
    ds_read_b64_tr_b16 v[148:149], v4 offset:7168
    ds_read_b64_tr_b16 v[150:151], v25 offset:7168
    v_cvt_pk_bf16_f32 v69, v106, v107
    v_mfma_f32_16x16x32_bf16 v[108:111], a[196:199], v[152:155], v[108:111]
    ds_read_b64_tr_b16 v[152:153], v4 offset:8192
    ds_read_b64_tr_b16 v[154:155], v25 offset:8192
    v_sub_f32 v26, v26, v28
    v_mfma_f32_16x16x32_bf16 v[108:111], a[220:223], v[156:159], v[108:111]
    ds_read_b64_tr_b16 v[156:157], v4 offset:9216
    ds_read_b64_tr_b16 v[158:159], v25 offset:9216
    v_sub_f32 v27, v27, v28
    v_mfma_f32_16x16x32_bf16 v[108:111], a[244:247], v[160:163], v[108:111]
    ds_read_b64_tr_b16 v[160:161], v4 offset:10240
    ds_read_b64_tr_b16 v[162:163], v25 offset:10240
    v_mul_f32 v26, v11, v26
    v_mfma_f32_16x16x32_bf16 v[108:111], v[188:191], v[164:167], v[108:111]
    ds_read_b64_tr_b16 v[164:165], v4 offset:11264
    ds_read_b64_tr_b16 v[166:167], v25 offset:11264
    v_mul_f32 v27, v11, v27
    v_mfma_f32_16x16x32_bf16 v[108:111], v[212:215], v[168:171], v[108:111]
    ds_read_b64_tr_b16 v[168:169], v4 offset:12288
    ds_read_b64_tr_b16 v[170:171], v25 offset:12288
    v_exp_f32 v26, v26
    v_mfma_f32_16x16x32_bf16 v[108:111], v[236:239], v[172:175], v[108:111]
    ds_read_b64_tr_b16 v[172:173], v4 offset:13312
    ds_read_b64_tr_b16 v[174:175], v25 offset:13312
    v_exp_f32 v27, v27
    s_waitcnt lgkmcnt(15)
    v_mfma_f32_16x16x32_bf16 v[112:115], a[8:11], v[120:123], 0
    v_add_f32 v28, v26, v27
    v_mov_b32 v29, v28
    v_mfma_f32_16x16x32_bf16 v[112:115], a[32:35], v[124:127], v[112:115]
    v_mfma_f32_16x16x32_bf16 v[112:115], a[56:59], v[128:131], v[112:115]
    v_permlane16_swap_b32 v28, v29
    v_add_f32 v28, v28, v29
    v_mfma_f32_16x16x32_bf16 v[112:115], a[80:83], v[132:135], v[112:115]
    v_mov_b32 v29, v28
    v_mfma_f32_16x16x32_bf16 v[112:115], a[104:107], v[136:139], v[112:115]
    v_mfma_f32_16x16x32_bf16 v[112:115], a[128:131], v[140:143], v[112:115]
    v_permlane32_swap_b32 v28, v29
    v_add_f32 v28, v28, v29
    s_waitcnt lgkmcnt(10)
    v_mfma_f32_16x16x32_bf16 v[112:115], a[152:155], v[144:147], v[112:115]
    v_cvt_pk_bf16_f32 v70, v108, v109
    v_cvt_pk_bf16_f32 v71, v110, v111
    v_mfma_f32_16x16x32_bf16 v[112:115], a[176:179], v[148:151], v[112:115]
    v_cndmask_b32 v70, v70, 0, s[82:83]
    v_cndmask_b32 v71, v71, 0, s[82:83]
    v_mfma_f32_16x16x32_bf16 v[112:115], a[200:203], v[152:155], v[112:115]
    s_add_u32 s57, s73, 524288
    v_rcp_f32 v28, v28
    s_waitcnt lgkmcnt(4)
    v_mfma_f32_16x16x32_bf16 v[112:115], a[224:227], v[156:159], v[112:115]
    buffer_load_dword v22, v5, s[20:23], s57 offen
    v_mfma_f32_16x16x32_bf16 v[112:115], a[248:251], v[160:163], v[112:115]
    v_mul_f32 v26, v26, v8
    v_mul_f32 v27, v27, v9
    v_mfma_f32_16x16x32_bf16 v[112:115], v[192:195], v[164:167], v[112:115]
    v_mul_f32 v26, v26, v28
    v_mul_f32 v27, v27, v28
    s_waitcnt lgkmcnt(0)
    v_mfma_f32_16x16x32_bf16 v[112:115], v[216:219], v[168:171], v[112:115]
    v_cvt_pk_bf16_f32 v26, v26, v26
    v_cvt_pk_bf16_f32 v27, v27, v27
    v_mfma_f32_16x16x32_bf16 v[112:115], v[240:243], v[172:175], v[112:115]
    v_and_b32 v80, v26, v14
    v_and_b32 v81, v27, v15
    v_mfma_f32_16x16x32_bf16 v[116:119], a[12:15], v[120:123], 0
    v_and_b32 v82, v26, v16
    v_and_b32 v83, v27, v17
    v_mfma_f32_16x16x32_bf16 v[116:119], a[36:39], v[124:127], v[116:119]
    v_mfma_f32_16x16x32_bf16 v[116:119], a[60:63], v[128:131], v[116:119]
    v_mfma_f32_16x16x32_bf16 v[72:75], v[34:37], v[80:83], 0
    v_mfma_f32_16x16x32_bf16 v[116:119], a[84:87], v[132:135], v[116:119]
    v_mfma_f32_16x16x32_bf16 v[76:79], v[44:47], v[80:83], 0
    v_mfma_f32_16x16x32_bf16 v[116:119], a[108:111], v[136:139], v[116:119]
    s_add_u32 s53, s74, 16384
    v_mfma_f32_16x16x32_bf16 v[116:119], a[132:135], v[140:143], v[116:119]
    v_mfma_f32_16x16x32_bf16 v[116:119], a[156:159], v[144:147], v[116:119]
    v_cvt_pk_bf16_f32 v56, v112, v113
    v_cvt_pk_bf16_f32 v57, v114, v115
    v_mfma_f32_16x16x32_bf16 v[116:119], a[180:183], v[148:151], v[116:119]
    v_mfma_f32_16x16x32_bf16 v[116:119], a[204:207], v[152:155], v[116:119]
    v_mfma_f32_16x16x32_bf16 v[116:119], a[228:231], v[156:159], v[116:119]
    v_cvt_pk_bf16_f32 v84, v72, v73
    v_cvt_pk_bf16_f32 v85, v74, v75
    v_mfma_f32_16x16x32_bf16 v[116:119], a[252:255], v[160:163], v[116:119]
    v_cvt_pk_bf16_f32 v86, v76, v77
    v_cvt_pk_bf16_f32 v87, v78, v79
    v_mfma_f32_16x16x32_bf16 v[116:119], v[196:199], v[164:167], v[116:119]
    buffer_store_dwordx4 v[84:87], v23, s[24:27], s53 offen sc1
    v_mfma_f32_16x16x32_bf16 v[116:119], v[220:223], v[168:171], v[116:119]
    v_cndmask_b32 v80, v84, v86, s[88:89]
    v_cndmask_b32 v81, v85, v87, s[88:89]
    v_mfma_f32_16x16x32_bf16 v[116:119], v[244:247], v[172:175], v[116:119]
    ds_write_b64 v95, v[80:81] offset:256
    v_mfma_f32_16x16x32_bf16 v[96:99], v[120:123], a[16:19], 0
    v_mfma_f32_16x16x32_bf16 v[72:75], v[60:63], v[68:71], 0
    v_mfma_f32_16x16x32_bf16 v[96:99], v[124:127], a[40:43], v[96:99]
    v_mfma_f32_16x16x32_bf16 v[76:79], v[52:55], v[68:71], 0
    v_mfma_f32_16x16x32_bf16 v[96:99], v[128:131], a[64:67], v[96:99]
    ds_read_u16_d16_hi v8, v93 offset:32768
    ds_read_u16_d16_hi v9, v94 offset:32768
    v_mfma_f32_16x16x32_bf16 v[96:99], v[132:135], a[88:91], v[96:99]
    ds_read_u16_d16_hi v10, v92 offset:32768
    v_mfma_f32_16x16x32_bf16 v[96:99], v[136:139], a[112:115], v[96:99]
    v_mfma_f32_16x16x32_bf16 v[96:99], v[140:143], a[136:139], v[96:99]
    v_mfma_f32_16x16x32_bf16 v[96:99], v[144:147], a[160:163], v[96:99]
    v_cvt_pk_bf16_f32 v58, v116, v117
    v_cvt_pk_bf16_f32 v59, v118, v119
    v_mfma_f32_16x16x32_bf16 v[96:99], v[148:151], a[184:187], v[96:99]
    v_cndmask_b32 v58, v58, 0, s[82:83]
    v_cndmask_b32 v59, v59, 0, s[82:83]
    v_mfma_f32_16x16x32_bf16 v[96:99], v[152:155], a[208:211], v[96:99]
    v_cndmask_b32 v26, v72, v73, s[76:77]
    v_cndmask_b32 v27, v74, v75, s[76:77]
    v_mfma_f32_16x16x32_bf16 v[96:99], v[156:159], a[232:235], v[96:99]
    v_cndmask_b32 v28, v76, v77, s[76:77]
    v_cndmask_b32 v29, v78, v79, s[76:77]
    v_mfma_f32_16x16x32_bf16 v[96:99], v[160:163], v[176:179], v[96:99]
    v_cndmask_b32 v26, v26, v28, s[78:79]
    v_cndmask_b32 v27, v27, v29, s[80:81]
    v_mfma_f32_16x16x32_bf16 v[96:99], v[164:167], v[200:203], v[96:99]
    s_waitcnt lgkmcnt(0)
    v_mul_f32 v26, v26, v8
    v_mfma_f32_16x16x32_bf16 v[96:99], v[168:171], v[224:227], v[96:99]
    v_mul_f32 v27, v27, v9
    v_mul_f32 v11, s91, v10
    v_mfma_f32_16x16x32_bf16 v[96:99], v[172:175], v[248:251], v[96:99]
    v_max_f32 v28, v26, v27
    v_mov_b32 v29, v28
    v_mfma_f32_16x16x32_bf16 v[100:103], v[120:123], a[20:23], 0
    v_mfma_f32_16x16x32_bf16 v[100:103], v[124:127], a[44:47], v[100:103]
    v_permlane16_swap_b32 v28, v29
    v_max_f32 v28, v28, v29
    v_mfma_f32_16x16x32_bf16 v[100:103], v[128:131], a[68:71], v[100:103]
    v_mov_b32 v29, v28
    v_mfma_f32_16x16x32_bf16 v[100:103], v[132:135], a[92:95], v[100:103]
    v_mfma_f32_16x16x32_bf16 v[100:103], v[136:139], a[116:119], v[100:103]
    v_permlane32_swap_b32 v28, v29
    v_max_f32 v28, v28, v29
    v_mfma_f32_16x16x32_bf16 v[100:103], v[140:143], a[140:143], v[100:103]
    v_sub_f32 v26, v26, v28
    v_sub_f32 v27, v27, v28
    v_mfma_f32_16x16x32_bf16 v[100:103], v[144:147], a[164:167], v[100:103]
    s_add_u32 s57, s75, 0
    v_cvt_pk_bf16_f32 v40, v96, v97
    v_mfma_f32_16x16x32_bf16 v[100:103], v[148:151], a[188:191], v[100:103]
    buffer_load_dword v22, v20, s[12:15], s57 offen
    v_mfma_f32_16x16x32_bf16 v[100:103], v[152:155], a[212:215], v[100:103]
    v_cvt_pk_bf16_f32 v41, v98, v99
    v_cvt_pk_bf16_f32 v32, v96, v97
    v_mfma_f32_16x16x32_bf16 v[100:103], v[156:159], a[236:239], v[100:103]
    v_cvt_pk_bf16_f32 v33, v98, v99
    v_mul_f32 v26, v11, v26
    v_mfma_f32_16x16x32_bf16 v[100:103], v[160:163], v[180:183], v[100:103]
    v_mul_f32 v27, v11, v27
    v_exp_f32 v26, v26
    v_mfma_f32_16x16x32_bf16 v[100:103], v[164:167], v[204:207], v[100:103]
    v_exp_f32 v27, v27
    v_mfma_f32_16x16x32_bf16 v[100:103], v[168:171], v[228:231], v[100:103]
    v_add_f32 v28, v26, v27
    v_mov_b32 v29, v28
    v_mfma_f32_16x16x32_bf16 v[100:103], v[172:175], v[252:255], v[100:103]
    v_mfma_f32_16x16x32_bf16 v[104:107], a[0:3], v[120:123], 0
    v_permlane16_swap_b32 v28, v29
    v_add_f32 v28, v28, v29
    v_mfma_f32_16x16x32_bf16 v[104:107], a[24:27], v[124:127], v[104:107]
    v_mov_b32 v29, v28
    v_mfma_f32_16x16x32_bf16 v[104:107], a[48:51], v[128:131], v[104:107]
    v_mfma_f32_16x16x32_bf16 v[104:107], a[72:75], v[132:135], v[104:107]
    v_permlane32_swap_b32 v28, v29
    v_add_f32 v28, v28, v29
    v_mfma_f32_16x16x32_bf16 v[104:107], a[96:99], v[136:139], v[104:107]
    v_rcp_f32 v28, v28
    v_mfma_f32_16x16x32_bf16 v[104:107], a[120:123], v[140:143], v[104:107]
    v_mul_f32 v26, v26, v8
    v_mul_f32 v27, v27, v9
    v_mfma_f32_16x16x32_bf16 v[104:107], a[144:147], v[144:147], v[104:107]
    v_cvt_pk_bf16_f32 v50, v100, v101
    v_cvt_pk_bf16_f32 v51, v102, v103
    v_mfma_f32_16x16x32_bf16 v[104:107], a[168:171], v[148:151], v[104:107]
    v_cvt_pk_bf16_f32 v42, v100, v101
    v_cvt_pk_bf16_f32 v43, v102, v103
    v_mfma_f32_16x16x32_bf16 v[104:107], a[192:195], v[152:155], v[104:107]
    v_mul_f32 v26, v26, v28
    v_mul_f32 v27, v27, v28
    v_mfma_f32_16x16x32_bf16 v[104:107], a[216:219], v[156:159], v[104:107]
    v_cvt_pk_bf16_f32 v26, v26, v26
    v_cvt_pk_bf16_f32 v27, v27, v27
    v_mfma_f32_16x16x32_bf16 v[104:107], a[240:243], v[160:163], v[104:107]
    v_and_b32 v80, v26, v14
    v_and_b32 v81, v27, v15
    v_mfma_f32_16x16x32_bf16 v[104:107], v[184:187], v[164:167], v[104:107]
    v_and_b32 v82, v26, v16
    v_and_b32 v83, v27, v17
    v_mfma_f32_16x16x32_bf16 v[104:107], v[208:211], v[168:171], v[104:107]
    v_mfma_f32_16x16x32_bf16 v[104:107], v[232:235], v[172:175], v[104:107]
    v_mfma_f32_16x16x32_bf16 v[72:75], v[36:39], v[80:83], 0
    v_mfma_f32_16x16x32_bf16 v[108:111], a[4:7], v[120:123], 0
    ds_read_b64_tr_b16 v[120:121], v4 offset:16384
    ds_read_b64_tr_b16 v[122:123], v25 offset:16384
    v_mfma_f32_16x16x32_bf16 v[76:79], v[46:49], v[80:83], 0
    v_mfma_f32_16x16x32_bf16 v[108:111], a[28:31], v[124:127], v[108:111]
    ds_read_b64_tr_b16 v[124:125], v4 offset:17408
    ds_read_b64_tr_b16 v[126:127], v25 offset:17408
    s_add_u32 s53, s74, 32768
    v_mfma_f32_16x16x32_bf16 v[108:111], a[52:55], v[128:131], v[108:111]
    ds_read_b64_tr_b16 v[128:129], v4 offset:18432
    ds_read_b64_tr_b16 v[130:131], v25 offset:18432
    v_mfma_f32_16x16x32_bf16 v[108:111], a[76:79], v[132:135], v[108:111]
    ds_read_b64_tr_b16 v[132:133], v4 offset:19456
    ds_read_b64_tr_b16 v[134:135], v25 offset:19456
    v_mfma_f32_16x16x32_bf16 v[108:111], a[100:103], v[136:139], v[108:111]
    ds_read_b64_tr_b16 v[136:137], v4 offset:20480
    ds_read_b64_tr_b16 v[138:139], v25 offset:20480
    v_mfma_f32_16x16x32_bf16 v[108:111], a[124:127], v[140:143], v[108:111]
    ds_read_b64_tr_b16 v[140:141], v4 offset:21504
    ds_read_b64_tr_b16 v[142:143], v25 offset:21504
    v_mfma_f32_16x16x32_bf16 v[108:111], a[148:151], v[144:147], v[108:111]
    ds_read_b64_tr_b16 v[144:145], v4 offset:22528
    ds_read_b64_tr_b16 v[146:147], v25 offset:22528
    v_cvt_pk_bf16_f32 v64, v104, v105
    v_mfma_f32_16x16x32_bf16 v[108:111], a[172:175], v[148:151], v[108:111]
    ds_read_b64_tr_b16 v[148:149], v4 offset:23552
    ds_read_b64_tr_b16 v[150:151], v25 offset:23552
    v_cvt_pk_bf16_f32 v65, v106, v107
    v_mfma_f32_16x16x32_bf16 v[108:111], a[196:199], v[152:155], v[108:111]
    ds_read_b64_tr_b16 v[152:153], v4 offset:24576
    ds_read_b64_tr_b16 v[154:155], v25 offset:24576
    v_cvt_pk_bf16_f32 v84, v72, v73
    v_mfma_f32_16x16x32_bf16 v[108:111], a[220:223], v[156:159], v[108:111]
    ds_read_b64_tr_b16 v[156:157], v4 offset:25600
    ds_read_b64_tr_b16 v[158:159], v25 offset:25600
    v_cvt_pk_bf16_f32 v85, v74, v75
    v_mfma_f32_16x16x32_bf16 v[108:111], a[244:247], v[160:163], v[108:111]
    ds_read_b64_tr_b16 v[160:161], v4 offset:26624
    ds_read_b64_tr_b16 v[162:163], v25 offset:26624
    v_cvt_pk_bf16_f32 v86, v76, v77
    v_mfma_f32_16x16x32_bf16 v[108:111], v[188:191], v[164:167], v[108:111]
    ds_read_b64_tr_b16 v[164:165], v4 offset:27648
    ds_read_b64_tr_b16 v[166:167], v25 offset:27648
    v_cvt_pk_bf16_f32 v87, v78, v79
    v_mfma_f32_16x16x32_bf16 v[108:111], v[212:215], v[168:171], v[108:111]
    ds_read_b64_tr_b16 v[168:169], v4 offset:28672
    ds_read_b64_tr_b16 v[170:171], v25 offset:28672
    buffer_store_dwordx4 v[84:87], v23, s[24:27], s53 offen sc1
    v_mfma_f32_16x16x32_bf16 v[108:111], v[236:239], v[172:175], v[108:111]
    ds_read_b64_tr_b16 v[172:173], v4 offset:29696
    ds_read_b64_tr_b16 v[174:175], v25 offset:29696
    v_cndmask_b32 v80, v84, v86, s[88:89]
    s_waitcnt lgkmcnt(15)
    v_mfma_f32_16x16x32_bf16 v[112:115], a[8:11], v[120:123], 0
    v_cndmask_b32 v81, v85, v87, s[88:89]
    ds_write_b64 v95, v[80:81] offset:512
    v_mfma_f32_16x16x32_bf16 v[112:115], a[32:35], v[124:127], v[112:115]
    v_mfma_f32_16x16x32_bf16 v[112:115], a[56:59], v[128:131], v[112:115]
    v_mfma_f32_16x16x32_bf16 v[112:115], a[80:83], v[132:135], v[112:115]
    v_mfma_f32_16x16x32_bf16 v[112:115], a[104:107], v[136:139], v[112:115]
    s_add_u32 s57, s75, 262144
    v_mfma_f32_16x16x32_bf16 v[112:115], a[128:131], v[140:143], v[112:115]
    buffer_load_dword v22, v20, s[12:15], s57 offen
    s_waitcnt lgkmcnt(11)
    v_mfma_f32_16x16x32_bf16 v[112:115], a[152:155], v[144:147], v[112:115]
    v_cvt_pk_bf16_f32 v66, v108, v109
    v_cvt_pk_bf16_f32 v67, v110, v111
    v_mfma_f32_16x16x32_bf16 v[112:115], a[176:179], v[148:151], v[112:115]
    v_cndmask_b32 v66, v66, 0, s[82:83]
    v_cndmask_b32 v67, v67, 0, s[82:83]
    v_mfma_f32_16x16x32_bf16 v[112:115], a[200:203], v[152:155], v[112:115]
    s_waitcnt lgkmcnt(5)
    v_mfma_f32_16x16x32_bf16 v[112:115], a[224:227], v[156:159], v[112:115]
    v_mfma_f32_16x16x32_bf16 v[72:75], v[52:55], v[64:67], 0
    v_mfma_f32_16x16x32_bf16 v[112:115], a[248:251], v[160:163], v[112:115]
    v_mfma_f32_16x16x32_bf16 v[76:79], v[56:59], v[64:67], 0
    v_mfma_f32_16x16x32_bf16 v[112:115], v[192:195], v[164:167], v[112:115]
    ds_read_u16_d16_hi v8, v93 offset:49152
    ds_read_u16_d16_hi v9, v94 offset:49152
    s_waitcnt lgkmcnt(3)
    v_mfma_f32_16x16x32_bf16 v[112:115], v[216:219], v[168:171], v[112:115]
    ds_read_u16_d16_hi v10, v92 offset:49152
    v_mfma_f32_16x16x32_bf16 v[112:115], v[240:243], v[172:175], v[112:115]
    v_mfma_f32_16x16x32_bf16 v[116:119], a[12:15], v[120:123], 0
    v_mfma_f32_16x16x32_bf16 v[116:119], a[36:39], v[124:127], v[116:119]
    v_mfma_f32_16x16x32_bf16 v[116:119], a[60:63], v[128:131], v[116:119]
    v_cndmask_b32 v26, v72, v73, s[76:77]
    v_cndmask_b32 v27, v74, v75, s[76:77]
    v_mfma_f32_16x16x32_bf16 v[116:119], a[84:87], v[132:135], v[116:119]
    v_cndmask_b32 v28, v76, v77, s[76:77]
    v_cndmask_b32 v29, v78, v79, s[76:77]
    v_mfma_f32_16x16x32_bf16 v[116:119], a[108:111], v[136:139], v[116:119]
    v_cndmask_b32 v26, v26, v28, s[78:79]
    v_cndmask_b32 v27, v27, v29, s[80:81]
    v_mfma_f32_16x16x32_bf16 v[116:119], a[132:135], v[140:143], v[116:119]
    s_waitcnt lgkmcnt(0)
    v_mul_f32 v26, v26, v8
    v_mfma_f32_16x16x32_bf16 v[116:119], a[156:159], v[144:147], v[116:119]
    v_cvt_pk_bf16_f32 v60, v112, v113
    v_cvt_pk_bf16_f32 v61, v114, v115
    v_mfma_f32_16x16x32_bf16 v[116:119], a[180:183], v[148:151], v[116:119]
    v_mul_f32 v27, v27, v9
    v_mul_f32 v11, s91, v10
    v_mfma_f32_16x16x32_bf16 v[116:119], a[204:207], v[152:155], v[116:119]
    v_max_f32 v28, v26, v27
    v_mov_b32 v29, v28
    v_mfma_f32_16x16x32_bf16 v[116:119], a[228:231], v[156:159], v[116:119]
    v_mfma_f32_16x16x32_bf16 v[116:119], a[252:255], v[160:163], v[116:119]
    v_permlane16_swap_b32 v28, v29
    v_max_f32 v28, v28, v29
    v_mfma_f32_16x16x32_bf16 v[116:119], v[196:199], v[164:167], v[116:119]
    v_mov_b32 v29, v28
    v_mfma_f32_16x16x32_bf16 v[116:119], v[220:223], v[168:171], v[116:119]
    v_mfma_f32_16x16x32_bf16 v[116:119], v[244:247], v[172:175], v[116:119]
    v_permlane32_swap_b32 v28, v29
    v_max_f32 v28, v28, v29
    v_mfma_f32_16x16x32_bf16 v[96:99], v[120:123], a[16:19], 0
    v_sub_f32 v26, v26, v28
    v_sub_f32 v27, v27, v28
    v_mfma_f32_16x16x32_bf16 v[96:99], v[124:127], a[40:43], v[96:99]
    v_mul_f32 v26, v11, v26
    v_mul_f32 v27, v11, v27
    v_mfma_f32_16x16x32_bf16 v[96:99], v[128:131], a[64:67], v[96:99]
    v_exp_f32 v26, v26
    v_mfma_f32_16x16x32_bf16 v[96:99], v[132:135], a[88:91], v[96:99]
    v_exp_f32 v27, v27
    v_mfma_f32_16x16x32_bf16 v[96:99], v[136:139], a[112:115], v[96:99]
    v_add_f32 v28, v26, v27
    v_mov_b32 v29, v28
    v_mfma_f32_16x16x32_bf16 v[96:99], v[140:143], a[136:139], v[96:99]
    v_mfma_f32_16x16x32_bf16 v[96:99], v[144:147], a[160:163], v[96:99]
    v_cvt_pk_bf16_f32 v62, v116, v117
    v_cvt_pk_bf16_f32 v63, v118, v119
    v_mfma_f32_16x16x32_bf16 v[96:99], v[148:151], a[184:187], v[96:99]
    v_cndmask_b32 v62, v62, 0, s[82:83]
    v_cndmask_b32 v63, v63, 0, s[82:83]
    v_mfma_f32_16x16x32_bf16 v[96:99], v[152:155], a[208:211], v[96:99]
    v_permlane16_swap_b32 v28, v29
    v_add_f32 v28, v28, v29
    v_mfma_f32_16x16x32_bf16 v[96:99], v[156:159], a[232:235], v[96:99]
    v_mov_b32 v29, v28
    v_mfma_f32_16x16x32_bf16 v[96:99], v[160:163], v[176:179], v[96:99]
    v_mfma_f32_16x16x32_bf16 v[96:99], v[164:167], v[200:203], v[96:99]
    v_permlane32_swap_b32 v28, v29
    v_add_f32 v28, v28, v29
    v_mfma_f32_16x16x32_bf16 v[96:99], v[168:171], v[224:227], v[96:99]
    v_rcp_f32 v28, v28
    v_mfma_f32_16x16x32_bf16 v[96:99], v[172:175], v[248:251], v[96:99]
    v_mul_f32 v26, v26, v8
    v_mul_f32 v27, v27, v9
    v_mfma_f32_16x16x32_bf16 v[100:103], v[120:123], a[20:23], 0
    v_mul_f32 v26, v26, v28
    v_mul_f32 v27, v27, v28
    v_mfma_f32_16x16x32_bf16 v[100:103], v[124:127], a[44:47], v[100:103]
    v_cvt_pk_bf16_f32 v26, v26, v26
    v_cvt_pk_bf16_f32 v27, v27, v27
    v_mfma_f32_16x16x32_bf16 v[100:103], v[128:131], a[68:71], v[100:103]
    v_and_b32 v80, v26, v14
    v_and_b32 v81, v27, v15
    v_mfma_f32_16x16x32_bf16 v[100:103], v[132:135], a[92:95], v[100:103]
    v_and_b32 v82, v26, v16
    v_and_b32 v83, v27, v17
    v_mfma_f32_16x16x32_bf16 v[100:103], v[136:139], a[116:119], v[100:103]
    v_mfma_f32_16x16x32_bf16 v[100:103], v[140:143], a[140:143], v[100:103]
    v_mfma_f32_16x16x32_bf16 v[72:75], v[38:41], v[80:83], 0
    v_mfma_f32_16x16x32_bf16 v[100:103], v[144:147], a[164:167], v[100:103]
    v_cvt_pk_bf16_f32 v34, v96, v97
    v_cvt_pk_bf16_f32 v35, v98, v99
    v_mfma_f32_16x16x32_bf16 v[100:103], v[148:151], a[188:191], v[100:103]
    v_mfma_f32_16x16x32_bf16 v[76:79], v[48:51], v[80:83], 0
    v_mfma_f32_16x16x32_bf16 v[100:103], v[152:155], a[212:215], v[100:103]
    s_add_u32 s53, s74, 49152
    v_mfma_f32_16x16x32_bf16 v[100:103], v[156:159], a[236:239], v[100:103]
    v_mfma_f32_16x16x32_bf16 v[100:103], v[160:163], v[180:183], v[100:103]
    v_mfma_f32_16x16x32_bf16 v[100:103], v[164:167], v[204:207], v[100:103]
    v_mfma_f32_16x16x32_bf16 v[100:103], v[168:171], v[228:231], v[100:103]
    v_mfma_f32_16x16x32_bf16 v[100:103], v[172:175], v[252:255], v[100:103]
    v_cvt_pk_bf16_f32 v84, v72, v73
    v_cvt_pk_bf16_f32 v85, v74, v75
    v_mfma_f32_16x16x32_bf16 v[104:107], a[0:3], v[120:123], 0
    v_cvt_pk_bf16_f32 v86, v76, v77
    v_cvt_pk_bf16_f32 v87, v78, v79
    v_mfma_f32_16x16x32_bf16 v[104:107], a[24:27], v[124:127], v[104:107]
    buffer_store_dwordx4 v[84:87], v23, s[24:27], s53 offen sc1
    v_mfma_f32_16x16x32_bf16 v[104:107], a[48:51], v[128:131], v[104:107]
    v_cndmask_b32 v80, v84, v86, s[88:89]
    v_cndmask_b32 v81, v85, v87, s[88:89]
    v_mfma_f32_16x16x32_bf16 v[104:107], a[72:75], v[132:135], v[104:107]
    ds_write_b64 v95, v[80:81] offset:768
    v_mfma_f32_16x16x32_bf16 v[104:107], a[96:99], v[136:139], v[104:107]
    v_mfma_f32_16x16x32_bf16 v[104:107], a[120:123], v[140:143], v[104:107]
    v_mfma_f32_16x16x32_bf16 v[104:107], a[144:147], v[144:147], v[104:107]
    v_cvt_pk_bf16_f32 v44, v100, v101
    v_cvt_pk_bf16_f32 v45, v102, v103
    v_mfma_f32_16x16x32_bf16 v[104:107], a[168:171], v[148:151], v[104:107]
    v_mfma_f32_16x16x32_bf16 v[104:107], a[192:195], v[152:155], v[104:107]
    v_mfma_f32_16x16x32_bf16 v[104:107], a[216:219], v[156:159], v[104:107]
    v_mfma_f32_16x16x32_bf16 v[104:107], a[240:243], v[160:163], v[104:107]
    v_mfma_f32_16x16x32_bf16 v[104:107], v[184:187], v[164:167], v[104:107]
    v_mfma_f32_16x16x32_bf16 v[104:107], v[208:211], v[168:171], v[104:107]
    v_mfma_f32_16x16x32_bf16 v[104:107], v[232:235], v[172:175], v[104:107]
    v_mfma_f32_16x16x32_bf16 v[108:111], a[4:7], v[120:123], 0
    ds_read_b64_tr_b16 v[120:121], v4 offset:32768
    ds_read_b64_tr_b16 v[122:123], v25 offset:32768
    v_mfma_f32_16x16x32_bf16 v[108:111], a[28:31], v[124:127], v[108:111]
    ds_read_b64_tr_b16 v[124:125], v4 offset:33792
    ds_read_b64_tr_b16 v[126:127], v25 offset:33792
    v_mfma_f32_16x16x32_bf16 v[108:111], a[52:55], v[128:131], v[108:111]
    ds_read_b64_tr_b16 v[128:129], v4 offset:34816
    ds_read_b64_tr_b16 v[130:131], v25 offset:34816
    v_mfma_f32_16x16x32_bf16 v[108:111], a[76:79], v[132:135], v[108:111]
    ds_read_b64_tr_b16 v[132:133], v4 offset:35840
    ds_read_b64_tr_b16 v[134:135], v25 offset:35840
    v_mfma_f32_16x16x32_bf16 v[108:111], a[100:103], v[136:139], v[108:111]
    ds_read_b64_tr_b16 v[136:137], v4 offset:36864
    ds_read_b64_tr_b16 v[138:139], v25 offset:36864
    v_mfma_f32_16x16x32_bf16 v[108:111], a[124:127], v[140:143], v[108:111]
    ds_read_b64_tr_b16 v[140:141], v4 offset:37888
    ds_read_b64_tr_b16 v[142:143], v25 offset:37888
    v_mfma_f32_16x16x32_bf16 v[108:111], a[148:151], v[144:147], v[108:111]
    ds_read_b64_tr_b16 v[144:145], v4 offset:38912
    ds_read_b64_tr_b16 v[146:147], v25 offset:38912
    v_cvt_pk_bf16_f32 v68, v104, v105
    v_mfma_f32_16x16x32_bf16 v[108:111], a[172:175], v[148:151], v[108:111]
    ds_read_b64_tr_b16 v[148:149], v4 offset:39936
    ds_read_b64_tr_b16 v[150:151], v25 offset:39936
    v_cvt_pk_bf16_f32 v69, v106, v107
    v_mfma_f32_16x16x32_bf16 v[108:111], a[196:199], v[152:155], v[108:111]
    ds_read_b64_tr_b16 v[152:153], v4 offset:40960
    ds_read_b64_tr_b16 v[154:155], v25 offset:40960
    v_mfma_f32_16x16x32_bf16 v[108:111], a[220:223], v[156:159], v[108:111]
    ds_read_b64_tr_b16 v[156:157], v4 offset:41984
    ds_read_b64_tr_b16 v[158:159], v25 offset:41984
    v_mfma_f32_16x16x32_bf16 v[108:111], a[244:247], v[160:163], v[108:111]
    ds_read_b64_tr_b16 v[160:161], v4 offset:43008
    ds_read_b64_tr_b16 v[162:163], v25 offset:43008
    v_mfma_f32_16x16x32_bf16 v[108:111], v[188:191], v[164:167], v[108:111]
    ds_read_b64_tr_b16 v[164:165], v4 offset:44032
    ds_read_b64_tr_b16 v[166:167], v25 offset:44032
    v_mfma_f32_16x16x32_bf16 v[108:111], v[212:215], v[168:171], v[108:111]
    ds_read_b64_tr_b16 v[168:169], v4 offset:45056
    ds_read_b64_tr_b16 v[170:171], v25 offset:45056
    v_mfma_f32_16x16x32_bf16 v[108:111], v[236:239], v[172:175], v[108:111]
    ds_read_b64_tr_b16 v[172:173], v4 offset:46080
    ds_read_b64_tr_b16 v[174:175], v25 offset:46080
    s_waitcnt lgkmcnt(15)
    v_mfma_f32_16x16x32_bf16 v[112:115], a[8:11], v[120:123], 0
    v_mfma_f32_16x16x32_bf16 v[112:115], a[32:35], v[124:127], v[112:115]
    v_mfma_f32_16x16x32_bf16 v[112:115], a[56:59], v[128:131], v[112:115]
    v_mfma_f32_16x16x32_bf16 v[112:115], a[80:83], v[132:135], v[112:115]
    v_mfma_f32_16x16x32_bf16 v[112:115], a[104:107], v[136:139], v[112:115]
    v_mfma_f32_16x16x32_bf16 v[112:115], a[128:131], v[140:143], v[112:115]
    s_waitcnt lgkmcnt(10)
    v_mfma_f32_16x16x32_bf16 v[112:115], a[152:155], v[144:147], v[112:115]
    v_cvt_pk_bf16_f32 v70, v108, v109
    v_cvt_pk_bf16_f32 v71, v110, v111
    v_mfma_f32_16x16x32_bf16 v[112:115], a[176:179], v[148:151], v[112:115]
    v_cndmask_b32 v70, v70, 0, s[82:83]
    v_cndmask_b32 v71, v71, 0, s[82:83]
    v_mfma_f32_16x16x32_bf16 v[112:115], a[200:203], v[152:155], v[112:115]
    v_add_u32 v92, 65536, v92
    v_add_u32 v93, 65536, v93
    s_waitcnt lgkmcnt(4)
    v_mfma_f32_16x16x32_bf16 v[112:115], a[224:227], v[156:159], v[112:115]
    v_add_u32 v94, 65536, v94
    v_mfma_f32_16x16x32_bf16 v[112:115], a[248:251], v[160:163], v[112:115]
    v_mfma_f32_16x16x32_bf16 v[72:75], v[56:59], v[68:71], 0
    v_mfma_f32_16x16x32_bf16 v[112:115], v[192:195], v[164:167], v[112:115]
    v_mfma_f32_16x16x32_bf16 v[76:79], v[60:63], v[68:71], 0
    s_waitcnt lgkmcnt(0)
    v_mfma_f32_16x16x32_bf16 v[112:115], v[216:219], v[168:171], v[112:115]
    ds_read_u16_d16_hi v8, v93 offset:0
    ds_read_u16_d16_hi v9, v94 offset:0
    v_mfma_f32_16x16x32_bf16 v[112:115], v[240:243], v[172:175], v[112:115]
    ds_read_u16_d16_hi v10, v92 offset:0
    v_mfma_f32_16x16x32_bf16 v[116:119], a[12:15], v[120:123], 0
    v_mfma_f32_16x16x32_bf16 v[116:119], a[36:39], v[124:127], v[116:119]
    v_mfma_f32_16x16x32_bf16 v[116:119], a[60:63], v[128:131], v[116:119]
    v_mfma_f32_16x16x32_bf16 v[116:119], a[84:87], v[132:135], v[116:119]
    v_cndmask_b32 v26, v72, v73, s[76:77]
    v_cndmask_b32 v27, v74, v75, s[76:77]
    v_mfma_f32_16x16x32_bf16 v[116:119], a[108:111], v[136:139], v[116:119]
    v_cndmask_b32 v28, v76, v77, s[76:77]
    v_cndmask_b32 v29, v78, v79, s[76:77]
    v_mfma_f32_16x16x32_bf16 v[116:119], a[132:135], v[140:143], v[116:119]
    v_cndmask_b32 v26, v26, v28, s[78:79]
    v_cndmask_b32 v27, v27, v29, s[80:81]
    v_mfma_f32_16x16x32_bf16 v[116:119], a[156:159], v[144:147], v[116:119]
    v_cvt_pk_bf16_f32 v52, v112, v113
    v_cvt_pk_bf16_f32 v53, v114, v115
    v_mfma_f32_16x16x32_bf16 v[116:119], a[180:183], v[148:151], v[116:119]
    s_waitcnt lgkmcnt(0)
    v_mul_f32 v26, v26, v8
    v_mfma_f32_16x16x32_bf16 v[116:119], a[204:207], v[152:155], v[116:119]
    v_mul_f32 v27, v27, v9
    v_mul_f32 v11, s91, v10
    v_mfma_f32_16x16x32_bf16 v[116:119], a[228:231], v[156:159], v[116:119]
    v_max_f32 v28, v26, v27
    v_mov_b32 v29, v28
    v_mfma_f32_16x16x32_bf16 v[116:119], a[252:255], v[160:163], v[116:119]
    v_mfma_f32_16x16x32_bf16 v[116:119], v[196:199], v[164:167], v[116:119]
    v_permlane16_swap_b32 v28, v29
    v_max_f32 v28, v28, v29
    v_mfma_f32_16x16x32_bf16 v[116:119], v[220:223], v[168:171], v[116:119]
    v_mov_b32 v29, v28
    v_mfma_f32_16x16x32_bf16 v[116:119], v[244:247], v[172:175], v[116:119]
    v_mfma_f32_16x16x32_bf16 v[96:99], v[120:123], a[16:19], 0
    v_permlane32_swap_b32 v28, v29
    v_max_f32 v28, v28, v29
    v_mfma_f32_16x16x32_bf16 v[96:99], v[124:127], a[40:43], v[96:99]
    v_sub_f32 v26, v26, v28
    v_sub_f32 v27, v27, v28
    v_mfma_f32_16x16x32_bf16 v[96:99], v[128:131], a[64:67], v[96:99]
    v_mul_f32 v26, v11, v26
    v_mul_f32 v27, v11, v27
    v_mfma_f32_16x16x32_bf16 v[96:99], v[132:135], a[88:91], v[96:99]
    v_exp_f32 v26, v26
    v_mfma_f32_16x16x32_bf16 v[96:99], v[136:139], a[112:115], v[96:99]
    v_exp_f32 v27, v27
    v_mfma_f32_16x16x32_bf16 v[96:99], v[140:143], a[136:139], v[96:99]
    v_add_f32 v28, v26, v27
    v_mov_b32 v29, v28
    v_mfma_f32_16x16x32_bf16 v[96:99], v[144:147], a[160:163], v[96:99]
    v_cvt_pk_bf16_f32 v54, v116, v117
    v_cvt_pk_bf16_f32 v55, v118, v119
    v_mfma_f32_16x16x32_bf16 v[96:99], v[148:151], a[184:187], v[96:99]
    v_cndmask_b32 v54, v54, 0, s[82:83]
    v_cndmask_b32 v55, v55, 0, s[82:83]
    v_mfma_f32_16x16x32_bf16 v[96:99], v[152:155], a[208:211], v[96:99]
    v_permlane16_swap_b32 v28, v29
    v_add_f32 v28, v28, v29
    v_mfma_f32_16x16x32_bf16 v[96:99], v[156:159], a[232:235], v[96:99]
    v_mov_b32 v29, v28
    v_mfma_f32_16x16x32_bf16 v[96:99], v[160:163], v[176:179], v[96:99]
    v_mfma_f32_16x16x32_bf16 v[96:99], v[164:167], v[200:203], v[96:99]
    v_permlane32_swap_b32 v28, v29
    v_add_f32 v28, v28, v29
    v_mfma_f32_16x16x32_bf16 v[96:99], v[168:171], v[224:227], v[96:99]
    v_rcp_f32 v28, v28
    v_mfma_f32_16x16x32_bf16 v[96:99], v[172:175], v[248:251], v[96:99]
    v_mul_f32 v26, v26, v8
    v_mul_f32 v27, v27, v9
    v_mfma_f32_16x16x32_bf16 v[100:103], v[120:123], a[20:23], 0
    v_mul_f32 v26, v26, v28
    v_mul_f32 v27, v27, v28
    v_mfma_f32_16x16x32_bf16 v[100:103], v[124:127], a[44:47], v[100:103]
    v_cvt_pk_bf16_f32 v26, v26, v26
    v_cvt_pk_bf16_f32 v27, v27, v27
    v_mfma_f32_16x16x32_bf16 v[100:103], v[128:131], a[68:71], v[100:103]
    v_and_b32 v80, v26, v14
    v_and_b32 v81, v27, v15
    v_mfma_f32_16x16x32_bf16 v[100:103], v[132:135], a[92:95], v[100:103]
    v_and_b32 v82, v26, v16
    v_and_b32 v83, v27, v17
    v_mfma_f32_16x16x32_bf16 v[100:103], v[136:139], a[116:119], v[100:103]
    v_mfma_f32_16x16x32_bf16 v[100:103], v[140:143], a[140:143], v[100:103]
    v_mfma_f32_16x16x32_bf16 v[72:75], v[32:35], v[80:83], 0
    v_mfma_f32_16x16x32_bf16 v[100:103], v[144:147], a[164:167], v[100:103]
    v_cvt_pk_bf16_f32 v36, v96, v97
    v_cvt_pk_bf16_f32 v37, v98, v99
    v_mfma_f32_16x16x32_bf16 v[100:103], v[148:151], a[188:191], v[100:103]
    v_mfma_f32_16x16x32_bf16 v[76:79], v[42:45], v[80:83], 0
    v_mfma_f32_16x16x32_bf16 v[100:103], v[152:155], a[212:215], v[100:103]
    s_add_u32 s53, s74, 65536
    v_mfma_f32_16x16x32_bf16 v[100:103], v[156:159], a[236:239], v[100:103]
    v_mfma_f32_16x16x32_bf16 v[100:103], v[160:163], v[180:183], v[100:103]
    v_mfma_f32_16x16x32_bf16 v[100:103], v[164:167], v[204:207], v[100:103]
    v_mfma_f32_16x16x32_bf16 v[100:103], v[168:171], v[228:231], v[100:103]
    v_mfma_f32_16x16x32_bf16 v[100:103], v[172:175], v[252:255], v[100:103]
    v_cvt_pk_bf16_f32 v84, v72, v73
    v_cvt_pk_bf16_f32 v85, v74, v75
    v_mfma_f32_16x16x32_bf16 v[104:107], a[0:3], v[120:123], 0
    v_cvt_pk_bf16_f32 v86, v76, v77
    v_cvt_pk_bf16_f32 v87, v78, v79
    v_mfma_f32_16x16x32_bf16 v[104:107], a[24:27], v[124:127], v[104:107]
    buffer_store_dwordx4 v[84:87], v23, s[24:27], s53 offen sc1
    v_mfma_f32_16x16x32_bf16 v[104:107], a[48:51], v[128:131], v[104:107]
    v_cndmask_b32 v80, v84, v86, s[88:89]
    v_cndmask_b32 v81, v85, v87, s[88:89]
    v_mfma_f32_16x16x32_bf16 v[104:107], a[72:75], v[132:135], v[104:107]
    ds_write_b64 v95, v[80:81] offset:1024
    v_mfma_f32_16x16x32_bf16 v[104:107], a[96:99], v[136:139], v[104:107]
    v_mfma_f32_16x16x32_bf16 v[104:107], a[120:123], v[140:143], v[104:107]
    v_mfma_f32_16x16x32_bf16 v[104:107], a[144:147], v[144:147], v[104:107]
    v_cvt_pk_bf16_f32 v46, v100, v101
    v_cvt_pk_bf16_f32 v47, v102, v103
    v_mfma_f32_16x16x32_bf16 v[104:107], a[168:171], v[148:151], v[104:107]
    v_mfma_f32_16x16x32_bf16 v[104:107], a[192:195], v[152:155], v[104:107]
    v_mfma_f32_16x16x32_bf16 v[104:107], a[216:219], v[156:159], v[104:107]
    v_mfma_f32_16x16x32_bf16 v[104:107], a[240:243], v[160:163], v[104:107]
    v_mfma_f32_16x16x32_bf16 v[104:107], v[184:187], v[164:167], v[104:107]
    v_mfma_f32_16x16x32_bf16 v[104:107], v[208:211], v[168:171], v[104:107]
    v_mfma_f32_16x16x32_bf16 v[104:107], v[232:235], v[172:175], v[104:107]
    v_mfma_f32_16x16x32_bf16 v[108:111], a[4:7], v[120:123], 0
    ds_read_b64_tr_b16 v[120:121], v4 offset:49152
    ds_read_b64_tr_b16 v[122:123], v25 offset:49152
    v_mfma_f32_16x16x32_bf16 v[108:111], a[28:31], v[124:127], v[108:111]
    ds_read_b64_tr_b16 v[124:125], v4 offset:50176
    ds_read_b64_tr_b16 v[126:127], v25 offset:50176
    v_mfma_f32_16x16x32_bf16 v[108:111], a[52:55], v[128:131], v[108:111]
    ds_read_b64_tr_b16 v[128:129], v4 offset:51200
    ds_read_b64_tr_b16 v[130:131], v25 offset:51200
    v_mfma_f32_16x16x32_bf16 v[108:111], a[76:79], v[132:135], v[108:111]
    ds_read_b64_tr_b16 v[132:133], v4 offset:52224
    ds_read_b64_tr_b16 v[134:135], v25 offset:52224
    v_mfma_f32_16x16x32_bf16 v[108:111], a[100:103], v[136:139], v[108:111]
    ds_read_b64_tr_b16 v[136:137], v4 offset:53248
    ds_read_b64_tr_b16 v[138:139], v25 offset:53248
    v_mfma_f32_16x16x32_bf16 v[108:111], a[124:127], v[140:143], v[108:111]
    ds_read_b64_tr_b16 v[140:141], v4 offset:54272
    ds_read_b64_tr_b16 v[142:143], v25 offset:54272
    v_mfma_f32_16x16x32_bf16 v[108:111], a[148:151], v[144:147], v[108:111]
    ds_read_b64_tr_b16 v[144:145], v4 offset:55296
    ds_read_b64_tr_b16 v[146:147], v25 offset:55296
    v_cvt_pk_bf16_f32 v64, v104, v105
    v_mfma_f32_16x16x32_bf16 v[108:111], a[172:175], v[148:151], v[108:111]
    ds_read_b64_tr_b16 v[148:149], v4 offset:56320
    ds_read_b64_tr_b16 v[150:151], v25 offset:56320
    v_cvt_pk_bf16_f32 v65, v106, v107
    v_mfma_f32_16x16x32_bf16 v[108:111], a[196:199], v[152:155], v[108:111]
    ds_read_b64_tr_b16 v[152:153], v4 offset:57344
    ds_read_b64_tr_b16 v[154:155], v25 offset:57344
    v_mfma_f32_16x16x32_bf16 v[108:111], a[220:223], v[156:159], v[108:111]
    ds_read_b64_tr_b16 v[156:157], v4 offset:58368
    ds_read_b64_tr_b16 v[158:159], v25 offset:58368
    v_mfma_f32_16x16x32_bf16 v[108:111], a[244:247], v[160:163], v[108:111]
    ds_read_b64_tr_b16 v[160:161], v4 offset:59392
    ds_read_b64_tr_b16 v[162:163], v25 offset:59392
    v_mfma_f32_16x16x32_bf16 v[108:111], v[188:191], v[164:167], v[108:111]
    ds_read_b64_tr_b16 v[164:165], v4 offset:60416
    ds_read_b64_tr_b16 v[166:167], v25 offset:60416
    v_mfma_f32_16x16x32_bf16 v[108:111], v[212:215], v[168:171], v[108:111]
    ds_read_b64_tr_b16 v[168:169], v4 offset:61440
    ds_read_b64_tr_b16 v[170:171], v25 offset:61440
    v_mfma_f32_16x16x32_bf16 v[108:111], v[236:239], v[172:175], v[108:111]
    ds_read_b64_tr_b16 v[172:173], v4 offset:62464
    ds_read_b64_tr_b16 v[174:175], v25 offset:62464
    s_waitcnt lgkmcnt(15)
    v_mfma_f32_16x16x32_bf16 v[112:115], a[8:11], v[120:123], 0
    v_mfma_f32_16x16x32_bf16 v[112:115], a[32:35], v[124:127], v[112:115]
    v_mfma_f32_16x16x32_bf16 v[112:115], a[56:59], v[128:131], v[112:115]
    v_mfma_f32_16x16x32_bf16 v[112:115], a[80:83], v[132:135], v[112:115]
    v_mfma_f32_16x16x32_bf16 v[112:115], a[104:107], v[136:139], v[112:115]
    v_mfma_f32_16x16x32_bf16 v[112:115], a[128:131], v[140:143], v[112:115]
    s_waitcnt lgkmcnt(10)
    v_mfma_f32_16x16x32_bf16 v[112:115], a[152:155], v[144:147], v[112:115]
    v_cvt_pk_bf16_f32 v66, v108, v109
    v_cvt_pk_bf16_f32 v67, v110, v111
    v_mfma_f32_16x16x32_bf16 v[112:115], a[176:179], v[148:151], v[112:115]
    v_cndmask_b32 v66, v66, 0, s[82:83]
    v_cndmask_b32 v67, v67, 0, s[82:83]
    v_mfma_f32_16x16x32_bf16 v[112:115], a[200:203], v[152:155], v[112:115]
    s_waitcnt lgkmcnt(4)
    v_mfma_f32_16x16x32_bf16 v[112:115], a[224:227], v[156:159], v[112:115]
    v_mfma_f32_16x16x32_bf16 v[72:75], v[60:63], v[64:67], 0
    v_mfma_f32_16x16x32_bf16 v[112:115], a[248:251], v[160:163], v[112:115]
    v_mfma_f32_16x16x32_bf16 v[76:79], v[52:55], v[64:67], 0
    v_mfma_f32_16x16x32_bf16 v[112:115], v[192:195], v[164:167], v[112:115]
    ds_read_u16_d16_hi v8, v93 offset:16384
    ds_read_u16_d16_hi v9, v94 offset:16384
    s_waitcnt lgkmcnt(2)
    v_mfma_f32_16x16x32_bf16 v[112:115], v[216:219], v[168:171], v[112:115]
    ds_read_u16_d16_hi v10, v92 offset:16384
    v_mfma_f32_16x16x32_bf16 v[112:115], v[240:243], v[172:175], v[112:115]
    v_mfma_f32_16x16x32_bf16 v[116:119], a[12:15], v[120:123], 0
    v_mfma_f32_16x16x32_bf16 v[116:119], a[36:39], v[124:127], v[116:119]
    v_mfma_f32_16x16x32_bf16 v[116:119], a[60:63], v[128:131], v[116:119]
    v_cndmask_b32 v26, v72, v73, s[76:77]
    v_cndmask_b32 v27, v74, v75, s[76:77]
    v_mfma_f32_16x16x32_bf16 v[116:119], a[84:87], v[132:135], v[116:119]
    v_cndmask_b32 v28, v76, v77, s[76:77]
    v_cndmask_b32 v29, v78, v79, s[76:77]
    v_mfma_f32_16x16x32_bf16 v[116:119], a[108:111], v[136:139], v[116:119]
    v_cndmask_b32 v26, v26, v28, s[78:79]
    v_cndmask_b32 v27, v27, v29, s[80:81]
    v_mfma_f32_16x16x32_bf16 v[116:119], a[132:135], v[140:143], v[116:119]
    s_waitcnt lgkmcnt(0)
    v_mul_f32 v26, v26, v8
    v_mfma_f32_16x16x32_bf16 v[116:119], a[156:159], v[144:147], v[116:119]
    v_cvt_pk_bf16_f32 v56, v112, v113
    v_cvt_pk_bf16_f32 v57, v114, v115
    v_mfma_f32_16x16x32_bf16 v[116:119], a[180:183], v[148:151], v[116:119]
    v_mul_f32 v27, v27, v9
    v_mul_f32 v11, s91, v10
    v_mfma_f32_16x16x32_bf16 v[116:119], a[204:207], v[152:155], v[116:119]
    v_max_f32 v28, v26, v27
    v_mov_b32 v29, v28
    v_mfma_f32_16x16x32_bf16 v[116:119], a[228:231], v[156:159], v[116:119]
    v_mfma_f32_16x16x32_bf16 v[116:119], a[252:255], v[160:163], v[116:119]
    v_permlane16_swap_b32 v28, v29
    v_max_f32 v28, v28, v29
    v_mfma_f32_16x16x32_bf16 v[116:119], v[196:199], v[164:167], v[116:119]
    v_mov_b32 v29, v28
    v_mfma_f32_16x16x32_bf16 v[116:119], v[220:223], v[168:171], v[116:119]
    v_mfma_f32_16x16x32_bf16 v[116:119], v[244:247], v[172:175], v[116:119]
    v_permlane32_swap_b32 v28, v29
    v_max_f32 v28, v28, v29
    v_mfma_f32_16x16x32_bf16 v[96:99], v[120:123], a[16:19], 0
    v_sub_f32 v26, v26, v28
    v_sub_f32 v27, v27, v28
    v_mfma_f32_16x16x32_bf16 v[96:99], v[124:127], a[40:43], v[96:99]
    v_mul_f32 v26, v11, v26
    v_mul_f32 v27, v11, v27
    v_mfma_f32_16x16x32_bf16 v[96:99], v[128:131], a[64:67], v[96:99]
    v_exp_f32 v26, v26
    v_mfma_f32_16x16x32_bf16 v[96:99], v[132:135], a[88:91], v[96:99]
    v_exp_f32 v27, v27
    v_mfma_f32_16x16x32_bf16 v[96:99], v[136:139], a[112:115], v[96:99]
    v_add_f32 v28, v26, v27
    v_mov_b32 v29, v28
    v_mfma_f32_16x16x32_bf16 v[96:99], v[140:143], a[136:139], v[96:99]
    v_mfma_f32_16x16x32_bf16 v[96:99], v[144:147], a[160:163], v[96:99]
    v_cvt_pk_bf16_f32 v58, v116, v117
    v_cvt_pk_bf16_f32 v59, v118, v119
    v_mfma_f32_16x16x32_bf16 v[96:99], v[148:151], a[184:187], v[96:99]
    v_cndmask_b32 v58, v58, 0, s[82:83]
    v_cndmask_b32 v59, v59, 0, s[82:83]
    v_mfma_f32_16x16x32_bf16 v[96:99], v[152:155], a[208:211], v[96:99]
    v_permlane16_swap_b32 v28, v29
    v_add_f32 v28, v28, v29
    v_mfma_f32_16x16x32_bf16 v[96:99], v[156:159], a[232:235], v[96:99]
    v_mov_b32 v29, v28
    v_mfma_f32_16x16x32_bf16 v[96:99], v[160:163], v[176:179], v[96:99]
    v_mfma_f32_16x16x32_bf16 v[96:99], v[164:167], v[200:203], v[96:99]
    v_permlane32_swap_b32 v28, v29
    v_add_f32 v28, v28, v29
    v_mfma_f32_16x16x32_bf16 v[96:99], v[168:171], v[224:227], v[96:99]
    v_rcp_f32 v28, v28
    v_mfma_f32_16x16x32_bf16 v[96:99], v[172:175], v[248:251], v[96:99]
    v_mul_f32 v26, v26, v8
    v_mul_f32 v27, v27, v9
    v_mfma_f32_16x16x32_bf16 v[100:103], v[120:123], a[20:23], 0
    v_mul_f32 v26, v26, v28
    v_mul_f32 v27, v27, v28
    v_mfma_f32_16x16x32_bf16 v[100:103], v[124:127], a[44:47], v[100:103]
    v_cvt_pk_bf16_f32 v26, v26, v26
    v_cvt_pk_bf16_f32 v27, v27, v27
    v_mfma_f32_16x16x32_bf16 v[100:103], v[128:131], a[68:71], v[100:103]
    v_and_b32 v80, v26, v14
    v_and_b32 v81, v27, v15
    v_mfma_f32_16x16x32_bf16 v[100:103], v[132:135], a[92:95], v[100:103]
    v_and_b32 v82, v26, v16
    v_and_b32 v83, v27, v17
    v_mfma_f32_16x16x32_bf16 v[100:103], v[136:139], a[116:119], v[100:103]
    v_mfma_f32_16x16x32_bf16 v[100:103], v[140:143], a[140:143], v[100:103]
    v_mfma_f32_16x16x32_bf16 v[72:75], v[34:37], v[80:83], 0
    v_mfma_f32_16x16x32_bf16 v[100:103], v[144:147], a[164:167], v[100:103]
    v_cvt_pk_bf16_f32 v38, v96, v97
    v_cvt_pk_bf16_f32 v39, v98, v99
    v_mfma_f32_16x16x32_bf16 v[100:103], v[148:151], a[188:191], v[100:103]
    v_mfma_f32_16x16x32_bf16 v[76:79], v[44:47], v[80:83], 0
    v_mfma_f32_16x16x32_bf16 v[100:103], v[152:155], a[212:215], v[100:103]
    s_add_u32 s53, s74, 81920
    v_mfma_f32_16x16x32_bf16 v[100:103], v[156:159], a[236:239], v[100:103]
    v_mfma_f32_16x16x32_bf16 v[100:103], v[160:163], v[180:183], v[100:103]
    v_mfma_f32_16x16x32_bf16 v[100:103], v[164:167], v[204:207], v[100:103]
    v_mfma_f32_16x16x32_bf16 v[100:103], v[168:171], v[228:231], v[100:103]
    v_mfma_f32_16x16x32_bf16 v[100:103], v[172:175], v[252:255], v[100:103]
    v_cvt_pk_bf16_f32 v84, v72, v73
    v_cvt_pk_bf16_f32 v85, v74, v75
    v_mfma_f32_16x16x32_bf16 v[104:107], a[0:3], v[120:123], 0
    v_cvt_pk_bf16_f32 v86, v76, v77
    v_cvt_pk_bf16_f32 v87, v78, v79
    v_mfma_f32_16x16x32_bf16 v[104:107], a[24:27], v[124:127], v[104:107]
    buffer_store_dwordx4 v[84:87], v23, s[24:27], s53 offen sc1
    v_mfma_f32_16x16x32_bf16 v[104:107], a[48:51], v[128:131], v[104:107]
    v_cndmask_b32 v80, v84, v86, s[88:89]
    v_cndmask_b32 v81, v85, v87, s[88:89]
    v_mfma_f32_16x16x32_bf16 v[104:107], a[72:75], v[132:135], v[104:107]
    ds_write_b64 v95, v[80:81] offset:1280
    v_mfma_f32_16x16x32_bf16 v[104:107], a[96:99], v[136:139], v[104:107]
    v_mfma_f32_16x16x32_bf16 v[104:107], a[120:123], v[140:143], v[104:107]
    v_mfma_f32_16x16x32_bf16 v[104:107], a[144:147], v[144:147], v[104:107]
    v_cvt_pk_bf16_f32 v48, v100, v101
    v_cvt_pk_bf16_f32 v49, v102, v103
    v_mfma_f32_16x16x32_bf16 v[104:107], a[168:171], v[148:151], v[104:107]
    v_mfma_f32_16x16x32_bf16 v[104:107], a[192:195], v[152:155], v[104:107]
    v_mfma_f32_16x16x32_bf16 v[104:107], a[216:219], v[156:159], v[104:107]
    v_mfma_f32_16x16x32_bf16 v[104:107], a[240:243], v[160:163], v[104:107]
    v_mfma_f32_16x16x32_bf16 v[104:107], v[184:187], v[164:167], v[104:107]
    v_mfma_f32_16x16x32_bf16 v[104:107], v[208:211], v[168:171], v[104:107]
    v_mfma_f32_16x16x32_bf16 v[104:107], v[232:235], v[172:175], v[104:107]
    s_waitcnt vmcnt(10)
    s_barrier
    v_mfma_f32_16x16x32_bf16 v[108:111], a[4:7], v[120:123], 0
    v_add_u32 v4, 65536, v4
    v_add_u32 v25, 65536, v25
    ds_read_b64_tr_b16 v[120:121], v4 offset:0
    ds_read_b64_tr_b16 v[122:123], v25 offset:0
    v_mfma_f32_16x16x32_bf16 v[108:111], a[28:31], v[124:127], v[108:111]
    ds_read_b64_tr_b16 v[124:125], v4 offset:1024
    ds_read_b64_tr_b16 v[126:127], v25 offset:1024
    v_mfma_f32_16x16x32_bf16 v[108:111], a[52:55], v[128:131], v[108:111]
    ds_read_b64_tr_b16 v[128:129], v4 offset:2048
    ds_read_b64_tr_b16 v[130:131], v25 offset:2048
    v_mfma_f32_16x16x32_bf16 v[108:111], a[76:79], v[132:135], v[108:111]
    ds_read_b64_tr_b16 v[132:133], v4 offset:3072
    ds_read_b64_tr_b16 v[134:135], v25 offset:3072
    v_mfma_f32_16x16x32_bf16 v[108:111], a[100:103], v[136:139], v[108:111]
    ds_read_b64_tr_b16 v[136:137], v4 offset:4096
    ds_read_b64_tr_b16 v[138:139], v25 offset:4096
    v_mfma_f32_16x16x32_bf16 v[108:111], a[124:127], v[140:143], v[108:111]
    ds_read_b64_tr_b16 v[140:141], v4 offset:5120
    ds_read_b64_tr_b16 v[142:143], v25 offset:5120
    v_mfma_f32_16x16x32_bf16 v[108:111], a[148:151], v[144:147], v[108:111]
    ds_read_b64_tr_b16 v[144:145], v4 offset:6144
    ds_read_b64_tr_b16 v[146:147], v25 offset:6144
    v_cvt_pk_bf16_f32 v68, v104, v105
    v_mfma_f32_16x16x32_bf16 v[108:111], a[172:175], v[148:151], v[108:111]
    ds_read_b64_tr_b16 v[148:149], v4 offset:7168
    ds_read_b64_tr_b16 v[150:151], v25 offset:7168
    v_cvt_pk_bf16_f32 v69, v106, v107
    v_mfma_f32_16x16x32_bf16 v[108:111], a[196:199], v[152:155], v[108:111]
    ds_read_b64_tr_b16 v[152:153], v4 offset:8192
    ds_read_b64_tr_b16 v[154:155], v25 offset:8192
    v_mfma_f32_16x16x32_bf16 v[108:111], a[220:223], v[156:159], v[108:111]
    ds_read_b64_tr_b16 v[156:157], v4 offset:9216
    ds_read_b64_tr_b16 v[158:159], v25 offset:9216
    v_mfma_f32_16x16x32_bf16 v[108:111], a[244:247], v[160:163], v[108:111]
    ds_read_b64_tr_b16 v[160:161], v4 offset:10240
    ds_read_b64_tr_b16 v[162:163], v25 offset:10240
    v_mfma_f32_16x16x32_bf16 v[108:111], v[188:191], v[164:167], v[108:111]
    ds_read_b64_tr_b16 v[164:165], v4 offset:11264
    ds_read_b64_tr_b16 v[166:167], v25 offset:11264
    v_mfma_f32_16x16x32_bf16 v[108:111], v[212:215], v[168:171], v[108:111]
    ds_read_b64_tr_b16 v[168:169], v4 offset:12288
    ds_read_b64_tr_b16 v[170:171], v25 offset:12288
    v_mfma_f32_16x16x32_bf16 v[108:111], v[236:239], v[172:175], v[108:111]
    ds_read_b64_tr_b16 v[172:173], v4 offset:13312
    ds_read_b64_tr_b16 v[174:175], v25 offset:13312
    s_waitcnt lgkmcnt(15)
    v_mfma_f32_16x16x32_bf16 v[112:115], a[0:3], v[120:123], 0
    v_mfma_f32_16x16x32_bf16 v[112:115], a[24:27], v[124:127], v[112:115]
    v_mfma_f32_16x16x32_bf16 v[112:115], a[48:51], v[128:131], v[112:115]
    v_mfma_f32_16x16x32_bf16 v[112:115], a[72:75], v[132:135], v[112:115]
    v_mfma_f32_16x16x32_bf16 v[112:115], a[96:99], v[136:139], v[112:115]
    v_mfma_f32_16x16x32_bf16 v[112:115], a[120:123], v[140:143], v[112:115]
    s_waitcnt lgkmcnt(10)
    v_mfma_f32_16x16x32_bf16 v[112:115], a[144:147], v[144:147], v[112:115]
    v_cvt_pk_bf16_f32 v70, v108, v109
    v_cvt_pk_bf16_f32 v71, v110, v111
    v_mfma_f32_16x16x32_bf16 v[112:115], a[168:171], v[148:151], v[112:115]
    v_cndmask_b32 v70, v70, 0, s[82:83]
    v_cndmask_b32 v71, v71, 0, s[82:83]
    v_mfma_f32_16x16x32_bf16 v[112:115], a[192:195], v[152:155], v[112:115]
    s_waitcnt lgkmcnt(4)
    v_mfma_f32_16x16x32_bf16 v[112:115], a[216:219], v[156:159], v[112:115]
    v_mfma_f32_16x16x32_bf16 v[72:75], v[52:55], v[68:71], 0
    v_mfma_f32_16x16x32_bf16 v[112:115], a[240:243], v[160:163], v[112:115]
    v_mfma_f32_16x16x32_bf16 v[76:79], v[56:59], v[68:71], 0
    v_mfma_f32_16x16x32_bf16 v[112:115], v[184:187], v[164:167], v[112:115]
    ds_read_u16_d16_hi v8, v93 offset:32768
    ds_read_u16_d16_hi v9, v94 offset:32768
    s_waitcnt lgkmcnt(2)
    v_mfma_f32_16x16x32_bf16 v[112:115], v[208:211], v[168:171], v[112:115]
    ds_read_u16_d16_hi v10, v92 offset:32768
    v_mfma_f32_16x16x32_bf16 v[112:115], v[232:235], v[172:175], v[112:115]
    v_mfma_f32_16x16x32_bf16 v[116:119], a[4:7], v[120:123], 0
    v_mfma_f32_16x16x32_bf16 v[116:119], a[28:31], v[124:127], v[116:119]
    v_mfma_f32_16x16x32_bf16 v[116:119], a[52:55], v[128:131], v[116:119]
    v_cndmask_b32 v26, v72, v73, s[76:77]
    v_cndmask_b32 v27, v74, v75, s[76:77]
    v_mfma_f32_16x16x32_bf16 v[116:119], a[76:79], v[132:135], v[116:119]
    v_cndmask_b32 v28, v76, v77, s[76:77]
    v_cndmask_b32 v29, v78, v79, s[76:77]
    v_mfma_f32_16x16x32_bf16 v[116:119], a[100:103], v[136:139], v[116:119]
    v_cndmask_b32 v26, v26, v28, s[78:79]
    v_cndmask_b32 v27, v27, v29, s[80:81]
    v_mfma_f32_16x16x32_bf16 v[116:119], a[124:127], v[140:143], v[116:119]
    s_waitcnt lgkmcnt(0)
    v_mul_f32 v26, v26, v8
    v_mfma_f32_16x16x32_bf16 v[116:119], a[148:151], v[144:147], v[116:119]
    v_cvt_pk_bf16_f32 v64, v112, v113
    v_cvt_pk_bf16_f32 v65, v114, v115
    v_mfma_f32_16x16x32_bf16 v[116:119], a[172:175], v[148:151], v[116:119]
    v_mul_f32 v27, v27, v9
    v_mul_f32 v11, s91, v10
    v_mfma_f32_16x16x32_bf16 v[116:119], a[196:199], v[152:155], v[116:119]
    v_max_f32 v28, v26, v27
    v_mov_b32 v29, v28
    v_mfma_f32_16x16x32_bf16 v[116:119], a[220:223], v[156:159], v[116:119]
    v_mfma_f32_16x16x32_bf16 v[116:119], a[244:247], v[160:163], v[116:119]
    v_permlane16_swap_b32 v28, v29
    v_max_f32 v28, v28, v29
    v_mfma_f32_16x16x32_bf16 v[116:119], v[188:191], v[164:167], v[116:119]
    v_mov_b32 v29, v28
    v_mfma_f32_16x16x32_bf16 v[116:119], v[212:215], v[168:171], v[116:119]
    v_mfma_f32_16x16x32_bf16 v[116:119], v[236:239], v[172:175], v[116:119]
    v_permlane32_swap_b32 v28, v29
    v_max_f32 v28, v28, v29
    v_mfma_f32_16x16x32_bf16 v[96:99], a[8:11], v[120:123], 0
    v_sub_f32 v26, v26, v28
    v_sub_f32 v27, v27, v28
    v_mfma_f32_16x16x32_bf16 v[96:99], a[32:35], v[124:127], v[96:99]
    v_mul_f32 v26, v11, v26
    v_mul_f32 v27, v11, v27
    v_mfma_f32_16x16x32_bf16 v[96:99], a[56:59], v[128:131], v[96:99]
    v_exp_f32 v26, v26
    v_mfma_f32_16x16x32_bf16 v[96:99], a[80:83], v[132:135], v[96:99]
    v_exp_f32 v27, v27
    v_mfma_f32_16x16x32_bf16 v[96:99], a[104:107], v[136:139], v[96:99]
    v_add_f32 v28, v26, v27
    v_mov_b32 v29, v28
    v_mfma_f32_16x16x32_bf16 v[96:99], a[128:131], v[140:143], v[96:99]
    v_mfma_f32_16x16x32_bf16 v[96:99], a[152:155], v[144:147], v[96:99]
    v_cvt_pk_bf16_f32 v66, v116, v117
    v_cvt_pk_bf16_f32 v67, v118, v119
    v_mfma_f32_16x16x32_bf16 v[96:99], a[176:179], v[148:151], v[96:99]
    v_cndmask_b32 v66, v66, 0, s[82:83]
    v_cndmask_b32 v67, v67, 0, s[82:83]
    v_mfma_f32_16x16x32_bf16 v[96:99], a[200:203], v[152:155], v[96:99]
    v_permlane16_swap_b32 v28, v29
    v_add_f32 v28, v28, v29
    v_mfma_f32_16x16x32_bf16 v[96:99], a[224:227], v[156:159], v[96:99]
    v_mov_b32 v29, v28
    v_mfma_f32_16x16x32_bf16 v[96:99], a[248:251], v[160:163], v[96:99]
    v_mfma_f32_16x16x32_bf16 v[96:99], v[192:195], v[164:167], v[96:99]
    v_permlane32_swap_b32 v28, v29
    v_add_f32 v28, v28, v29
    v_mfma_f32_16x16x32_bf16 v[96:99], v[216:219], v[168:171], v[96:99]
    v_rcp_f32 v28, v28
    v_mfma_f32_16x16x32_bf16 v[96:99], v[240:243], v[172:175], v[96:99]
    v_mul_f32 v26, v26, v8
    v_mul_f32 v27, v27, v9
    v_mfma_f32_16x16x32_bf16 v[100:103], a[12:15], v[120:123], 0
    v_mul_f32 v26, v26, v28
    v_mul_f32 v27, v27, v28
    v_mfma_f32_16x16x32_bf16 v[100:103], a[36:39], v[124:127], v[100:103]
    v_cvt_pk_bf16_f32 v26, v26, v26
    v_cvt_pk_bf16_f32 v27, v27, v27
    v_mfma_f32_16x16x32_bf16 v[100:103], a[60:63], v[128:131], v[100:103]
    v_and_b32 v80, v26, v14
    v_and_b32 v81, v27, v15
    v_mfma_f32_16x16x32_bf16 v[100:103], a[84:87], v[132:135], v[100:103]
    v_and_b32 v82, v26, v16
    v_and_b32 v83, v27, v17
    v_mfma_f32_16x16x32_bf16 v[100:103], a[108:111], v[136:139], v[100:103]
    v_mfma_f32_16x16x32_bf16 v[100:103], a[132:135], v[140:143], v[100:103]
    v_mfma_f32_16x16x32_bf16 v[72:75], v[36:39], v[80:83], 0
    v_mfma_f32_16x16x32_bf16 v[100:103], a[156:159], v[144:147], v[100:103]
    v_cvt_pk_bf16_f32 v60, v96, v97
    v_cvt_pk_bf16_f32 v61, v98, v99
    v_mfma_f32_16x16x32_bf16 v[100:103], a[180:183], v[148:151], v[100:103]
    v_mfma_f32_16x16x32_bf16 v[76:79], v[46:49], v[80:83], 0
    v_mfma_f32_16x16x32_bf16 v[100:103], a[204:207], v[152:155], v[100:103]
    s_add_u32 s53, s74, 98304
    v_mfma_f32_16x16x32_bf16 v[100:103], a[228:231], v[156:159], v[100:103]
    v_mfma_f32_16x16x32_bf16 v[100:103], a[252:255], v[160:163], v[100:103]
    v_mfma_f32_16x16x32_bf16 v[100:103], v[196:199], v[164:167], v[100:103]
    v_mfma_f32_16x16x32_bf16 v[100:103], v[220:223], v[168:171], v[100:103]
    v_mfma_f32_16x16x32_bf16 v[100:103], v[244:247], v[172:175], v[100:103]
    v_cvt_pk_bf16_f32 v84, v72, v73
    v_cvt_pk_bf16_f32 v85, v74, v75
    v_mfma_f32_16x16x32_bf16 v[104:107], v[120:123], a[16:19], 0
    v_cvt_pk_bf16_f32 v86, v76, v77
    v_cvt_pk_bf16_f32 v87, v78, v79
    v_mfma_f32_16x16x32_bf16 v[104:107], v[124:127], a[40:43], v[104:107]
    buffer_store_dwordx4 v[84:87], v23, s[24:27], s53 offen sc1
    v_mfma_f32_16x16x32_bf16 v[104:107], v[128:131], a[64:67], v[104:107]
    v_cndmask_b32 v80, v84, v86, s[88:89]
    v_cndmask_b32 v81, v85, v87, s[88:89]
    v_mfma_f32_16x16x32_bf16 v[104:107], v[132:135], a[88:91], v[104:107]
    ds_write_b64 v95, v[80:81] offset:1536
    v_mfma_f32_16x16x32_bf16 v[104:107], v[136:139], a[112:115], v[104:107]
    v_mfma_f32_16x16x32_bf16 v[104:107], v[140:143], a[136:139], v[104:107]
    v_mfma_f32_16x16x32_bf16 v[104:107], v[144:147], a[160:163], v[104:107]
    v_cvt_pk_bf16_f32 v62, v100, v101
    v_cvt_pk_bf16_f32 v63, v102, v103
    v_mfma_f32_16x16x32_bf16 v[104:107], v[148:151], a[184:187], v[104:107]
    v_cndmask_b32 v62, v62, 0, s[82:83]
    v_cndmask_b32 v63, v63, 0, s[82:83]
    v_mfma_f32_16x16x32_bf16 v[104:107], v[152:155], a[208:211], v[104:107]
    v_mfma_f32_16x16x32_bf16 v[104:107], v[156:159], a[232:235], v[104:107]
    v_mfma_f32_16x16x32_bf16 v[72:75], v[56:59], v[64:67], 0
    v_mfma_f32_16x16x32_bf16 v[104:107], v[160:163], v[176:179], v[104:107]
    v_mfma_f32_16x16x32_bf16 v[76:79], v[60:63], v[64:67], 0
    v_mfma_f32_16x16x32_bf16 v[104:107], v[164:167], v[200:203], v[104:107]
    ds_read_u16_d16_hi v8, v93 offset:49152
    ds_read_u16_d16_hi v9, v94 offset:49152
    v_mfma_f32_16x16x32_bf16 v[104:107], v[168:171], v[224:227], v[104:107]
    ds_read_u16_d16_hi v10, v92 offset:49152
    v_mfma_f32_16x16x32_bf16 v[104:107], v[172:175], v[248:251], v[104:107]
    v_mfma_f32_16x16x32_bf16 v[108:111], v[120:123], a[20:23], 0
    v_mfma_f32_16x16x32_bf16 v[108:111], v[124:127], a[44:47], v[108:111]
    v_mfma_f32_16x16x32_bf16 v[108:111], v[128:131], a[68:71], v[108:111]
    v_cndmask_b32 v26, v72, v73, s[76:77]
    v_cndmask_b32 v27, v74, v75, s[76:77]
    v_mfma_f32_16x16x32_bf16 v[108:111], v[132:135], a[92:95], v[108:111]
    v_cndmask_b32 v28, v76, v77, s[76:77]
    v_cndmask_b32 v29, v78, v79, s[76:77]
    v_mfma_f32_16x16x32_bf16 v[108:111], v[136:139], a[116:119], v[108:111]
    v_cndmask_b32 v26, v26, v28, s[78:79]
    v_cndmask_b32 v27, v27, v29, s[80:81]
    v_mfma_f32_16x16x32_bf16 v[108:111], v[140:143], a[140:143], v[108:111]
    s_waitcnt lgkmcnt(0)
    v_mul_f32 v26, v26, v8
    v_mfma_f32_16x16x32_bf16 v[108:111], v[144:147], a[164:167], v[108:111]
    v_cvt_pk_bf16_f32 v40, v104, v105
    v_cvt_pk_bf16_f32 v41, v106, v107
    v_mfma_f32_16x16x32_bf16 v[108:111], v[148:151], a[188:191], v[108:111]
    v_mul_f32 v27, v27, v9
    v_mul_f32 v11, s91, v10
    v_mfma_f32_16x16x32_bf16 v[108:111], v[152:155], a[212:215], v[108:111]
    v_max_f32 v28, v26, v27
    v_mov_b32 v29, v28
    v_mfma_f32_16x16x32_bf16 v[108:111], v[156:159], a[236:239], v[108:111]
    v_mfma_f32_16x16x32_bf16 v[108:111], v[160:163], v[180:183], v[108:111]
    v_permlane16_swap_b32 v28, v29
    v_max_f32 v28, v28, v29
    v_mfma_f32_16x16x32_bf16 v[108:111], v[164:167], v[204:207], v[108:111]
    v_mov_b32 v29, v28
    v_mfma_f32_16x16x32_bf16 v[108:111], v[168:171], v[228:231], v[108:111]
    v_mfma_f32_16x16x32_bf16 v[108:111], v[172:175], v[252:255], v[108:111]
    v_permlane32_swap_b32 v28, v29
    v_max_f32 v28, v28, v29
    s_nop 5
    v_cvt_pk_bf16_f32 v50, v108, v109
    v_cvt_pk_bf16_f32 v51, v110, v111
    v_sub_f32 v26, v26, v28
    v_sub_f32 v27, v27, v28
    v_mul_f32 v26, v11, v26
    v_mul_f32 v27, v11, v27
    v_exp_f32 v26, v26
    v_exp_f32 v27, v27
    s_nop 0
    v_add_f32 v28, v26, v27
    v_mov_b32 v29, v28
    s_nop 1
    v_permlane16_swap_b32 v28, v29
    v_add_f32 v28, v28, v29
    v_mov_b32 v29, v28
    s_nop 1
    v_permlane32_swap_b32 v28, v29
    v_add_f32 v28, v28, v29
    v_rcp_f32 v28, v28
    v_mul_f32 v26, v26, v8
    v_mul_f32 v27, v27, v9
    v_mul_f32 v26, v26, v28
    v_mul_f32 v27, v27, v28
    v_cvt_pk_bf16_f32 v26, v26, v26
    v_cvt_pk_bf16_f32 v27, v27, v27
    v_and_b32 v80, v26, v14
    v_and_b32 v81, v27, v15
    v_and_b32 v82, v26, v16
    v_and_b32 v83, v27, v17
    s_nop 1
    v_mfma_f32_16x16x32_bf16 v[72:75], v[38:41], v[80:83], 0
    v_mfma_f32_16x16x32_bf16 v[76:79], v[48:51], v[80:83], 0
    s_add_u32 s53, s74, 114688
    s_nop 5
    v_cvt_pk_bf16_f32 v84, v72, v73
    v_cvt_pk_bf16_f32 v85, v74, v75
    v_cvt_pk_bf16_f32 v86, v76, v77
    v_cvt_pk_bf16_f32 v87, v78, v79
    buffer_store_dwordx4 v[84:87], v23, s[24:27], s53 offen sc1
    v_cndmask_b32 v80, v84, v86, s[88:89]
    v_cndmask_b32 v81, v85, v87, s[88:89]
    ds_write_b64 v95, v[80:81] offset:1792
    v_lshlrev_b32 v6, 4, v0
    v_add_u32 v6, 147456, v6
    v_lshrrev_b32 v7, 4, v1
    v_and_b32 v12, 15, v1
    v_lshlrev_b32 v7, 14, v7
    v_lshl_add_u32 v7, v12, 4, v7
    s_waitcnt lgkmcnt(0)
    s_barrier
    ds_read_b128 v[72:75], v6
    s_waitcnt lgkmcnt(0)
    buffer_store_dwordx4 v[72:75], v7, s[24:27], s95 offen sc1
    s_waitcnt vmcnt(0) lgkmcnt(0)
    s_barrier
    s_cmp_lg_u32 s44, 0
    s_cbranch_scc1 L_nopub21
    s_lshl_b32 s60, s48, 4
    s_add_u32 s60, s60, s49
    s_lshl_b32 s60, s60, 7
    s_add_u32 s60, s60, 12779520
    v_mov_b32 v30, s47
    s_mov_b64 exec, 1
    buffer_store_dword v30, off, s[24:27], s60 sc1
    s_mov_b64 exec, -1
L_nopub21:
    s_endpgm
L_codeend:
.section .rodata,"a"
.p2align 6
.amdhsa_kernel parallel_sum__sliding_local_dilated__mixer_token_mlp__prompt_kernel
  .amdhsa_next_free_vgpr 512
  .amdhsa_next_free_sgpr 102
  .amdhsa_accum_offset 256
  .amdhsa_group_segment_fixed_size 0
  .amdhsa_kernarg_size 88
  .amdhsa_user_sgpr_count 2
  .amdhsa_user_sgpr_kernarg_segment_ptr 1
  .amdhsa_system_sgpr_workgroup_id_x 1
  .amdhsa_float_denorm_mode_32 3
.end_amdhsa_kernel
```

```asm
; @launch grid=(256,1,1) block=(256,1,1) lds=163840
.amdgcn_target "amdgcn-amd-amdhsa--gfx950"
.text
.globl parallel_sum__sliding_local_dilated__mixer_token_mlp__prompt_kernel
.p2align 8
.type parallel_sum__sliding_local_dilated__mixer_token_mlp__prompt_kernel,@function
parallel_sum__sliding_local_dilated__mixer_token_mlp__prompt_kernel:
    s_cmp_ge_u32 s2, 256
    s_cbranch_scc1 L_end
    s_load_dwordx2 s[4:5], s[0:1], 0
    s_load_dwordx16 s[76:91], s[0:1], 0
    s_load_dwordx4 s[92:95], s[0:1], 64
    s_load_dwordx2 s[24:25], s[0:1], 80
    s_lshr_b32 s46, s2, 3
    s_getpc_b64 s[98:99]
L_pc:
    s_mul_i32 s53, s46, 1408
    v_lshrrev_b32 v26, 4, v0
    v_min_u32 v26, 10, v26
    v_lshl_add_u32 v26, v26, 7, s53
    v_lshrrev_b32 v25, 5, v0
    v_min_u32 v26, L_codeend-L_pc-4, v26
    v_mov_b32 v29, s99
    v_add_co_u32 v28, vcc, s98, v26
    s_nop 1
    v_addc_co_u32 v29, vcc, 0, v29, vcc
    global_load_dword v108, v[28:29], off
    v_and_b32 v26, 31, v0
    v_mul_u32_u24 v24, 896, v25
    v_lshl_add_u32 v24, v26, 4, v24
    s_mul_i32 s53, s2, 7168
    v_add_u32 v24, s53, v24
    v_cmp_gt_u32 vcc, 24, v26
    v_mov_b32 v27, 2130706432
    s_mov_b32 s6, 1835008
    s_mov_b32 s7, 0x20000
    v_cndmask_b32 v22, v27, v24, vcc
    v_lshrrev_b32 v27, 6, v0
    v_and_b32 v1, 63, v0
    s_waitcnt lgkmcnt(0)
    buffer_load_dwordx4 v[32:35], v24, s[4:7], 0 offen
    buffer_load_dwordx4 v[36:39], v22, s[4:7], 0 offen offset:512
    v_readfirstlane_b32 s44, v27
    s_and_b32 s45, s2, 7
    s_mov_b64 s[8:9], s[78:79]
    s_mov_b32 s10, 1204224
    s_mov_b32 s11, s7
    s_lshr_b32 s53, s45, 1
    s_add_u32 s54, s53, 1
    s_bfe_u32 s54, s54, 0x10001
    s_add_u32 s54, s54, 1
    s_mul_i32 s53, s53, 224
    s_andn2_b32 s53, s53, 127
    s_sub_u32 s55, s46, 3
    s_cmp_lt_u32 s46, 24
    s_cselect_b32 s55, 63, s55
    s_cmp_lt_u32 s46, 21
    s_cselect_b32 s55, s46, s55
    s_mul_i32 s55, s55, 43008
    s_add_u32 s53, s53, s55
    v_and_b32 v27, 3, v0
    v_min_u32 v27, s54, v27
    v_bfe_u32 v28, v0, 2, 2
    v_min_u32 v28, 2, v28
    v_mul_u32_u24 v28, 7, v28
    v_add_u32 v27, v27, v28
    v_lshrrev_b32 v28, 4, v0
    v_min_u32 v28, 15, v28
    v_mul_u32_u24 v28, 21, v28
    v_add_lshl_u32 v27, v27, v28, 7
    buffer_load_dword v108, v27, s[8:11], s53 offen
    s_mov_b64 s[40:41], s[94:95]
    s_mov_b32 s42, 256
    s_mov_b32 s43, s7
    s_or_b32 s53, s2, s44
    s_cbranch_scc1 L_nononce
    s_memrealtime s[98:99]
    s_waitcnt lgkmcnt(0)
    s_or_b32 s98, s98, 1
    v_mov_b32 v28, s98
    s_mov_b64 exec, 1
    buffer_store_dword v28, off, s[40:43], 0 sc1
    s_mov_b64 exec, -1
L_nononce:
    s_mov_b64 s[16:17], s[84:85]
    s_mov_b32 s18, 7340032
    s_mov_b32 s19, s7
    s_mov_b32 s26, 16777216
    s_mov_b32 s27, s7
    s_mov_b64 s[20:21], s[88:89]
    s_mov_b32 s22, 7340032
    s_mov_b32 s23, s7
    s_mov_b64 s[12:13], s[80:81]
    s_mov_b32 s14, 401408
    s_mov_b32 s15, s7
    s_mov_b64 s[28:29], s[92:93]
    s_mov_b32 s30, 1835008
    s_mov_b32 s31, s7
    s_mov_b64 s[32:33], s[86:87]
    s_mov_b32 s34, 3584
    s_mov_b32 s35, s7
    s_mov_b64 s[36:37], s[90:91]
    s_mov_b32 s38, 4096
    s_mov_b32 s39, s7
    s_lshl_b32 s52, s44, 12
    v_lshlrev_b32 v23, 4, v1
    s_cmp_ge_u32 s46, 24
    s_cbranch_scc1 L_role_a
    v_lshrrev_b32 v208, 4, v1
    v_bfe_u32 v209, v1, 2, 2
    v_and_b32 v210, 3, v1
    v_and_b32 v211, 15, v1
    v_lshrrev_b32 v212, 5, v1
    s_mul_i32 s55, s45, 3
    s_max_u32 s55, s55, 1
    s_add_u32 s55, s55, s46
    s_sub_u32 s55, s55, 1
    s_sub_u32 s56, s55, 21
    s_min_u32 s55, s55, s56
    s_and_b32 s54, s45, 1
    s_mul_i32 s54, s54, 24
    s_sub_u32 s54, s46, s54
    s_cmp_ge_u32 s46, 21
    s_cselect_b32 s54, s54, s55
    s_mul_i32 s53, s45, 21
    s_add_u32 s53, s53, s54
    s_mul_i32 s50, s53, 171
    s_lshr_b32 s50, s50, 10
    s_mul_i32 s54, s50, 6
    s_sub_u32 s88, s53, s54
    s_mul_i32 s51, s50, 2
    s_add_u32 s51, s51, s88
    s_mul_i32 s54, s51, 43
    s_lshr_b32 s54, s54, 8
    s_mul_i32 s54, s54, 6
    s_sub_u32 s51, s51, s54
    s_mul_i32 s65, s51, 13
    s_add_u32 s65, s65, 2
    s_mul_i32 s65, s65, 171
    s_lshr_b32 s65, s65, 10
    v_lshl_add_u32 v213, v212, 2, v209
    v_and_b32 v215, 1, v208
    v_lshlrev_b32 v214, 4, v210
    v_lshl_add_u32 v214, v215, 6, v214
    s_mul_i32 s53, s44, 1835008
    s_lshl_b32 s54, s50, 7
    s_add_u32 s53, s53, s54
    v_mul_u32_u24 v10, 3584, v213
    v_add3_u32 v10, v10, v214, s53
    v_xor_b32 v11, 32, v10
    s_cmp_ge_u32 s46, 21
    s_cbranch_scc1 L_help
    s_add_u32 m0, s52, 49152
    s_add_u32 s57, s65, 0
    s_sub_u32 s3, s57, 13
    s_min_u32 s57, s57, s3
    s_mul_i32 s57, s57, 114688
    buffer_load_dwordx4 v10, s[16:19], s57 offen offset:0 lds
    s_add_u32 s57, s57, 27648
    buffer_load_dwordx4 v11, s[16:19], s57 offen offset:1024 lds
    v_mul_u32_u24 v109, 1088, v25
    v_lshl_add_u32 v109, v26, 4, v109
    v_mul_u32_u24 v110, 1088, v209
    v_lshl_add_u32 v110, v208, 5, v110
    v_lshl_add_u32 v110, v210, 3, v110
    s_lshl_b32 s53, s44, 7
    v_add_u32 v110, s53, v110
    v_mul_u32_u24 v111, 66816, v208
    v_lshl_add_u32 v111, v211, 4, v111
    s_mul_i32 s63, s44, 267264
    s_lshl_b32 s53, s2, 8
    s_add_u32 s63, s63, s53
    s_add_u32 s64, s63, 1069056
    v_cmp_gt_u32 vcc, 208, v0
    v_mov_b32 v100, 2130706432
    v_cmp_le_u32 s[92:93], 24, v26
    v_cndmask_b32 v22, v100, v111, vcc
    s_mov_b32 s62, 0x3f803f80
    s_mov_b32 s61, 0xffff0000
    v_mov_b32 v96, 0
    v_mov_b32 v97, 0
    v_lshlrev_b32 v216, 6, v209
    v_lshl_add_u32 v216, v210, 3, v216
    v_lshl_add_u32 v216, v215, 5, v216
    s_add_u32 s53, s52, 49152
    v_lshl_add_u32 v2, v208, 10, v216
    v_add_u32 v2, s53, v2
    v_xor_b32 v3, 32, v2
    v_add_u32 v4, 65536, v2
    v_add_u32 v5, 65536, v3
    v_lshl_add_u32 v6, v208, 9, v216
    v_add_u32 v6, s53, v6
    v_xor_b32 v7, 32, v6
    v_add_u32 v8, 65536, v6
    v_add_u32 v9, 65536, v7
    s_waitcnt vmcnt(4)
    v_dot2c_f32_bf16 v96, s62, v32
    v_dot2c_f32_bf16 v97, v32, v32
    v_lshlrev_b32 v40, 16, v32
    v_and_b32 v41, s61, v32
    v_dot2c_f32_bf16 v96, s62, v33
    v_dot2c_f32_bf16 v97, v33, v33
    v_lshlrev_b32 v42, 16, v33
    v_and_b32 v43, s61, v33
    v_dot2c_f32_bf16 v96, s62, v34
    v_dot2c_f32_bf16 v97, v34, v34
    v_lshlrev_b32 v44, 16, v34
    v_and_b32 v45, s61, v34
    v_dot2c_f32_bf16 v96, s62, v35
    v_dot2c_f32_bf16 v97, v35, v35
    v_lshlrev_b32 v46, 16, v35
    v_and_b32 v47, s61, v35
    s_waitcnt vmcnt(3)
    v_dot2c_f32_bf16 v96, s62, v36
    v_dot2c_f32_bf16 v97, v36, v36
    v_lshlrev_b32 v48, 16, v36
    v_and_b32 v49, s61, v36
    v_dot2c_f32_bf16 v96, s62, v37
    v_dot2c_f32_bf16 v97, v37, v37
    v_lshlrev_b32 v50, 16, v37
    v_and_b32 v51, s61, v37
    v_dot2c_f32_bf16 v96, s62, v38
    v_dot2c_f32_bf16 v97, v38, v38
    v_lshlrev_b32 v52, 16, v38
    v_and_b32 v53, s61, v38
    v_dot2c_f32_bf16 v96, s62, v39
    v_dot2c_f32_bf16 v97, v39, v39
    v_lshlrev_b32 v54, 16, v39
    v_and_b32 v55, s61, v39
    buffer_load_dword v29, off, s[40:43], 0 sc1
    v_add_f32_dpp v96, v96, v96 quad_perm:[1,0,3,2] row_mask:0xf bank_mask:0xf
    v_add_f32_dpp v97, v97, v97 quad_perm:[1,0,3,2] row_mask:0xf bank_mask:0xf
    s_nop 0
    v_add_f32_dpp v96, v96, v96 quad_perm:[2,3,0,1] row_mask:0xf bank_mask:0xf
    v_add_f32_dpp v97, v97, v97 quad_perm:[2,3,0,1] row_mask:0xf bank_mask:0xf
    s_nop 0
    v_add_f32_dpp v96, v96, v96 row_half_mirror row_mask:0xf bank_mask:0xf
    v_add_f32_dpp v97, v97, v97 row_half_mirror row_mask:0xf bank_mask:0xf
    s_nop 0
    v_add_f32_dpp v96, v96, v96 row_mirror row_mask:0xf bank_mask:0xf
    v_add_f32_dpp v97, v97, v97 row_mirror row_mask:0xf bank_mask:0xf
    v_mov_b32 v98, v96
    v_mov_b32 v99, v97
    s_nop 0
    v_permlane16_swap_b32 v96, v98
    v_permlane16_swap_b32 v97, v99
    v_add_f32 v96, v96, v98
    v_add_f32 v97, v97, v99
    v_mul_f32 v98, 0x3b124925, v96
    v_mul_f32 v99, 0x3b124925, v97
    v_fma_f32 v99, -v98, v98, v99
    v_max_f32 v99, 0, v99
    v_cvt_pk_bf16_f32 v100, 0, v99
    v_add_f32 v100, 0x3727c5ac, v100
    v_cvt_pk_bf16_f32 v100, 0, v100
    v_sqrt_f32 v100, v100
    s_nop 0
    v_cvt_pk_bf16_f32 v100, 0, v100
    v_rcp_f32 v100, v100
    s_nop 0
    v_mul_f32 v99, v99, v100
    v_mul_f32 v99, v99, v100
    v_cvt_pk_bf16_f32 v104, 0, v99
    v_add_f32 v104, 0x3727c5ac, v104
    v_cvt_pk_bf16_f32 v104, 0, v104
    v_sqrt_f32 v104, v104
    s_nop 0
    v_cvt_pk_bf16_f32 v102, 0, v104
    v_rcp_f32 v104, v102
    s_nop 0
    v_mul_f32 v104, v104, v100
    v_mul_f32 v106, v98, v104
    v_pk_fma_f32 v[56:57], v[40:41], v[104:105], v[106:107] op_sel_hi:[1,0,0] neg_lo:[0,0,1] neg_hi:[0,0,1]
    v_pk_fma_f32 v[58:59], v[42:43], v[104:105], v[106:107] op_sel_hi:[1,0,0] neg_lo:[0,0,1] neg_hi:[0,0,1]
    v_pk_fma_f32 v[60:61], v[44:45], v[104:105], v[106:107] op_sel_hi:[1,0,0] neg_lo:[0,0,1] neg_hi:[0,0,1]
    v_pk_fma_f32 v[62:63], v[46:47], v[104:105], v[106:107] op_sel_hi:[1,0,0] neg_lo:[0,0,1] neg_hi:[0,0,1]
    v_pk_fma_f32 v[64:65], v[48:49], v[104:105], v[106:107] op_sel_hi:[1,0,0] neg_lo:[0,0,1] neg_hi:[0,0,1]
    v_pk_fma_f32 v[66:67], v[50:51], v[104:105], v[106:107] op_sel_hi:[1,0,0] neg_lo:[0,0,1] neg_hi:[0,0,1]
    v_pk_fma_f32 v[68:69], v[52:53], v[104:105], v[106:107] op_sel_hi:[1,0,0] neg_lo:[0,0,1] neg_hi:[0,0,1]
    v_pk_fma_f32 v[70:71], v[54:55], v[104:105], v[106:107] op_sel_hi:[1,0,0] neg_lo:[0,0,1] neg_hi:[0,0,1]
    v_cvt_pk_bf16_f32 v80, v56, v57
    v_cvt_pk_bf16_f32 v81, v58, v59
    v_cvt_pk_bf16_f32 v82, v60, v61
    v_cvt_pk_bf16_f32 v83, v62, v63
    v_cvt_pk_bf16_f32 v84, v64, v65
    v_cvt_pk_bf16_f32 v85, v66, v67
    v_cvt_pk_bf16_f32 v86, v68, v69
    v_cvt_pk_bf16_f32 v87, v70, v71
    v_lshrrev_b32 v102, 16, v102
    v_cndmask_b32 v84, v84, v102, s[92:93]
    ds_write_b128 v109, v[80:83] offset:0
    ds_write_b128 v109, v[84:87] offset:512
    s_waitcnt lgkmcnt(0)
    s_barrier
    ds_read_b64_tr_b16 v[88:89], v110 offset:0
    ds_read_b64_tr_b16 v[90:91], v110 offset:4352
    ds_read_b64_tr_b16 v[92:93], v110 offset:512
    ds_read_b64_tr_b16 v[94:95], v110 offset:4864
    s_waitcnt lgkmcnt(2)
    buffer_store_dwordx4 v[88:91], v111, s[24:27], s63 offen sc1
    s_waitcnt lgkmcnt(0)
    buffer_store_dwordx4 v[92:95], v22, s[24:27], s64 offen sc1
    s_add_u32 s57, s57, 27648
    buffer_load_dwordx4 v10, s[16:19], s57 offen offset:2048 lds
    s_add_u32 s57, s57, 27648
    buffer_load_dwordx4 v11, s[16:19], s57 offen offset:3072 lds
    s_add_u32 m0, s52, 65536
    s_add_u32 s57, s65, 1
    s_sub_u32 s3, s57, 13
    s_min_u32 s57, s57, s3
    s_mul_i32 s57, s57, 114688
    buffer_load_dwordx4 v10, s[16:19], s57 offen offset:0 lds
    s_add_u32 s57, s57, 27648
    buffer_load_dwordx4 v11, s[16:19], s57 offen offset:1024 lds
    s_add_u32 s57, s57, 27648
    buffer_load_dwordx4 v10, s[16:19], s57 offen offset:2048 lds
    s_add_u32 s57, s57, 27648
    buffer_load_dwordx4 v11, s[16:19], s57 offen offset:3072 lds
    s_waitcnt vmcnt(6)
    v_cmp_eq_u32 vcc, 0, v29
    s_nop 0
    s_cbranch_vccz L_ok2
    s_mov_b32 s59, 100000
L_spin1:
    buffer_load_dword v29, off, s[40:43], 0 sc1
    s_waitcnt vmcnt(0)
    v_cmp_eq_u32 vcc, 0, v29
    s_nop 0
    s_cbranch_vccz L_ok2
    s_sub_u32 s59, s59, 1
    s_cbranch_scc0 L_spin1
L_ok2:
    v_readfirstlane_b32 s47, v29
    s_barrier
    s_cmp_lg_u32 s44, 0
    s_cbranch_scc1 L_nopub3
    s_lshl_b32 s60, s2, 5
    s_add_u32 s60, s60, 12582912
    v_mov_b32 v30, s47
    s_mov_b64 exec, 1
    buffer_store_dword v30, off, s[24:27], s60 sc1
    s_mov_b64 exec, -1
L_nopub3:
    s_lshl_b32 s53, s44, 11
    s_add_u32 s53, s53, 12582912
    v_lshl_add_u32 v18, v1, 5, s53
    s_lshl_b32 s53, s50, 7
    s_add_u32 m0, s52, 81920
    s_add_u32 s57, s65, 2
    s_sub_u32 s3, s57, 13
    s_min_u32 s57, s57, s3
    s_mul_i32 s57, s57, 114688
    buffer_load_dwordx4 v10, s[16:19], s57 offen offset:0 lds
    v_lshl_add_u32 v19, v208, 3, s53
    s_lshl2_add_u32 s67, s51, s44
    s_mul_i32 s67, s67, 58624
    s_lshl_b32 s53, s50, 11
    s_add_u32 s57, s57, 27648
    buffer_load_dwordx4 v11, s[16:19], s57 offen offset:1024 lds
    s_add_u32 s67, s67, s53
    s_add_u32 s67, s67, 2097152
    v_mov_b32 v236, 0xbdd2d3e8
    v_mov_b32 v237, 0xc0135761
    s_add_u32 s57, s57, 27648
    buffer_load_dwordx4 v10, s[16:19], s57 offen offset:2048 lds
    s_or_b32 s88, s88, 0
    s_add_u32 s54, s88, 24
    s_mul_i32 s84, s54, 66816
    s_lshl2_add_u32 s84, s52, s84
    s_mul_i32 s83, s54, 58624
    s_add_u32 s83, s83, s53
    s_and_b32 s54, s44, 1
    s_lshl_b32 s54, s54, 10
    s_add_u32 s57, s57, 27648
    buffer_load_dwordx4 v11, s[16:19], s57 offen offset:3072 lds
    s_add_u32 s83, s83, s54
    s_add_u32 s83, s83, 2097152
    s_lshl1_add_u32 s54, s54, 49152
    v_add_u32 v243, s54, v23
    s_add_u32 m0, s52, 98304
    s_add_u32 s57, s65, 3
    s_sub_u32 s3, s57, 13
    s_min_u32 s57, s57, s3
    s_mul_i32 s57, s57, 114688
    buffer_load_dwordx4 v10, s[16:19], s57 offen offset:0 lds
    s_cmp_lt_u32 s88, 4
    s_cselect_b32 s84, s84, 2130706432
    s_cselect_b32 s83, s83, 2130706432
    s_cmp_lt_u32 s44, 2
    s_cselect_b32 s83, s83, 2130706432
    s_cmp_eq_u32 s44, 0
    s_cselect_b32 s85, 1.0, 0
    s_mul_i32 s53, s45, 7
    s_lshr_b32 s53, s53, 1
    s_sub_u32 s53, s50, s53
    s_lshl1_add_u32 s53, s53, s88
    s_sub_u32 s53, s53, 4
    s_mul_i32 s54, s44, 28
    s_add_u32 s54, s54, s53
    s_lshl_b32 s87, s54, 16
    s_lshl_b32 s54, s45, 9
    s_add_u32 s87, s87, s54
    s_cmp_ge_u32 s88, 4
    s_cselect_b32 s87, s87, 2130706432
    v_lshrrev_b32 v254, 2, v1
    v_lshlrev_b32 v254, 12, v254
    v_lshl_add_u32 v254, v210, 7, v254
    s_add_u32 s57, s57, 27648
    buffer_load_dwordx4 v11, s[16:19], s57 offen offset:1024 lds
    s_waitcnt vmcnt(10)
    ds_read_b64_tr_b16 a[0:1], v2 offset:0
    ds_read_b64_tr_b16 a[2:3], v2 offset:512
    ds_read_b64_tr_b16 a[4:5], v3 offset:0
    ds_read_b64_tr_b16 a[6:7], v3 offset:512
    s_add_u32 s57, s57, 27648
    buffer_load_dwordx4 v10, s[16:19], s57 offen offset:2048 lds
    ds_read_b64_tr_b16 a[8:9], v2 offset:256
    ds_read_b64_tr_b16 a[10:11], v2 offset:768
    ds_read_b64_tr_b16 a[12:13], v3 offset:256
    ds_read_b64_tr_b16 a[14:15], v3 offset:768
    s_add_u32 s57, s57, 27648
    buffer_load_dwordx4 v11, s[16:19], s57 offen offset:3072 lds
    s_lshr_b32 s53, s46, 2
    s_and_b32 s89, s46, 3
    s_bfe_u32 s54, s46, 0x20001
    s_and_b32 s55, s46, 1
    s_add_u32 s55, s55, 4
    s_cmp_lt_u32 s46, 16
    s_cselect_b32 s53, s53, s54
    s_cselect_b32 s89, s89, s55
    s_mul_i32 s49, s53, 2
    s_add_u32 s49, s49, s89
    s_sub_u32 s54, s49, 6
    s_min_u32 s49, s49, s54
    s_or_b32 s89, s89, 0
    s_add_u32 m0, s52, 114688
    s_add_u32 s57, s65, 4
    s_sub_u32 s3, s57, 13
    s_min_u32 s57, s57, s3
    s_mul_i32 s57, s57, 114688
    buffer_load_dwordx4 v10, s[16:19], s57 offen offset:0 lds
    s_lshl2_add_u32 s48, s45, s53
    s_mul_i32 s53, s44, 1835008
    s_lshl_b32 s74, s48, 7
    s_add_u32 s53, s53, s74
    s_add_u32 s57, s57, 27648
    buffer_load_dwordx4 v11, s[16:19], s57 offen offset:1024 lds
    s_waitcnt vmcnt(10)
    ds_read_b64_tr_b16 a[16:17], v2 offset:16384
    ds_read_b64_tr_b16 a[18:19], v2 offset:16896
    ds_read_b64_tr_b16 a[20:21], v3 offset:16384
    ds_read_b64_tr_b16 a[22:23], v3 offset:16896
    s_add_u32 s57, s57, 27648
    buffer_load_dwordx4 v10, s[16:19], s57 offen offset:2048 lds
    ds_read_b64_tr_b16 a[24:25], v2 offset:16640
    ds_read_b64_tr_b16 a[26:27], v2 offset:17152
    ds_read_b64_tr_b16 a[28:29], v3 offset:16640
    ds_read_b64_tr_b16 a[30:31], v3 offset:17152
    s_lshl_b32 s56, s44, 5
    v_lshlrev_b32 v217, 5, v212
    v_xor_b32 v217, v217, v214
    v_xor_b32 v217, s56, v217
    s_add_u32 s57, s57, 27648
    buffer_load_dwordx4 v11, s[16:19], s57 offen offset:3072 lds
    s_add_u32 s74, s74, s56
    v_lshlrev_b32 v12, 12, v213
    v_add3_u32 v12, v12, v217, s53
    s_mul_i32 s53, s44, 28672
    s_add_u32 m0, s52, 131072
    s_add_u32 s57, s65, 5
    s_sub_u32 s3, s57, 13
    s_min_u32 s57, s57, s3
    s_mul_i32 s57, s57, 114688
    buffer_load_dwordx4 v10, s[16:19], s57 offen offset:0 lds
    s_lshl_b32 s54, s49, 7
    s_add_u32 s55, s53, s54
    v_mul_u32_u24 v13, 896, v213
    v_add3_u32 v13, v13, v214, s55
    s_add_u32 s57, s57, 27648
    buffer_load_dwordx4 v11, s[16:19], s57 offen offset:1024 lds
    s_waitcnt vmcnt(10)
    ds_read_b64_tr_b16 a[32:33], v2 offset:32768
    ds_read_b64_tr_b16 a[34:35], v2 offset:33280
    ds_read_b64_tr_b16 a[36:37], v3 offset:32768
    ds_read_b64_tr_b16 a[38:39], v3 offset:33280
    v_xor_b32 v14, 32, v13
    s_mul_i32 s55, s44, 21504
    v_subrev_u32 v239, s55, v13
    s_and_b32 s55, s56, 32
    ds_read_b64_tr_b16 a[40:41], v2 offset:33024
    ds_read_b64_tr_b16 a[42:43], v2 offset:33536
    ds_read_b64_tr_b16 a[44:45], v3 offset:33024
    ds_read_b64_tr_b16 a[46:47], v3 offset:33536
    s_add_u32 s57, s57, 27648
    buffer_load_dwordx4 v10, s[16:19], s57 offen offset:2048 lds
    v_xor_b32 v239, s55, v239
    s_mul_i32 s73, s48, 57344
    s_add_u32 s71, s73, s54
    s_mul_i32 s55, s44, 14336
    s_add_u32 s57, s57, 27648
    buffer_load_dwordx4 v11, s[16:19], s57 offen offset:3072 lds
    s_add_u32 s71, s71, s55
    s_add_u32 s72, s71, 7168
    v_bfe_u32 v217, v1, 1, 2
    v_lshl_add_u32 v217, v212, 2, v217
    s_add_u32 m0, s52, 147456
    s_add_u32 s57, s65, 6
    s_sub_u32 s3, s57, 13
    s_min_u32 s57, s57, s3
    s_mul_i32 s57, s57, 114688
    buffer_load_dwordx4 v10, s[16:19], s57 offen offset:0 lds
    v_and_b32 v218, 24, v1
    v_add_u32 v217, v217, v218
    v_mul_u32_u24 v15, 896, v217
    v_and_b32 v217, 1, v1
    v_lshl_add_u32 v15, v217, 4, v15
    v_add_u32 v15, s53, v15
    s_lshl_b32 s54, s89, 5
    s_add_u32 s54, s54, 768
    s_add_u32 s57, s57, 27648
    buffer_load_dwordx4 v11, s[16:19], s57 offen offset:1024 lds
    s_waitcnt vmcnt(10)
    ds_read_b64_tr_b16 a[48:49], v2 offset:49152
    ds_read_b64_tr_b16 a[50:51], v2 offset:49664
    ds_read_b64_tr_b16 a[52:53], v3 offset:49152
    ds_read_b64_tr_b16 a[54:55], v3 offset:49664
    s_add_u32 s57, s57, 27648
    buffer_load_dwordx4 v10, s[16:19], s57 offen offset:2048 lds
    ds_read_b64_tr_b16 a[56:57], v2 offset:49408
    ds_read_b64_tr_b16 a[58:59], v2 offset:49920
    ds_read_b64_tr_b16 a[60:61], v3 offset:49408
    ds_read_b64_tr_b16 a[62:63], v3 offset:49920
    s_add_u32 s57, s57, 27648
    buffer_load_dwordx4 v11, s[16:19], s57 offen offset:3072 lds
    s_add_u32 s68, s89, 24
    s_mul_i32 s68, s68, 58624
    s_mul_i32 s69, s44, 14336
    s_add_u32 s69, s69, 2097152
    s_add_u32 s68, s68, s69
    s_mul_i32 s55, s49, 234496
    s_add_u32 s69, s69, s55
    s_add_u32 s73, s73, s54
    s_waitcnt lgkmcnt(15)
    s_add_u32 m0, s52, 49152
    s_add_u32 s57, s65, 7
    s_sub_u32 s3, s57, 13
    s_min_u32 s57, s57, s3
    s_mul_i32 s57, s57, 114688
    buffer_load_dwordx4 v10, s[16:19], s57 offen offset:0 lds
    s_mov_b32 s76, 0
    s_add_u32 s77, s76, 2048
    s_cmp_eq_u32 s77, 14336
    s_cselect_b32 s77, 0, s77
    s_add_u32 s78, s77, 2048
    s_cmp_eq_u32 s78, 14336
    s_cselect_b32 s78, 0, s78
    s_add_u32 s79, s78, 2048
    s_cmp_eq_u32 s79, 14336
    s_cselect_b32 s79, 0, s79
    s_add_u32 s80, s79, 2048
    s_cmp_eq_u32 s80, 14336
    s_cselect_b32 s80, 0, s80
    s_add_u32 s81, s80, 2048
    s_cmp_eq_u32 s81, 14336
    s_cselect_b32 s81, 0, s81
    s_add_u32 s82, s81, 2048
    s_cmp_eq_u32 s82, 14336
    s_cselect_b32 s82, 0, s82
    s_add_u32 s57, s57, 27648
    buffer_load_dwordx4 v11, s[16:19], s57 offen offset:1024 lds
    s_waitcnt vmcnt(10)
    ds_read_b64_tr_b16 a[64:65], v4 offset:0
    ds_read_b64_tr_b16 a[66:67], v4 offset:512
    ds_read_b64_tr_b16 a[68:69], v5 offset:0
    ds_read_b64_tr_b16 a[70:71], v5 offset:512
    s_add_u32 s57, s57, 27648
    buffer_load_dwordx4 v10, s[16:19], s57 offen offset:2048 lds
    ds_read_b64_tr_b16 a[72:73], v4 offset:256
    ds_read_b64_tr_b16 a[74:75], v4 offset:768
    ds_read_b64_tr_b16 a[76:77], v5 offset:256
    ds_read_b64_tr_b16 a[78:79], v5 offset:768
    s_add_u32 s57, s57, 27648
    buffer_load_dwordx4 v11, s[16:19], s57 offen offset:3072 lds
    s_cmp_lt_u32 s89, 4
    s_cselect_b32 s75, s54, 2130706432
    s_cselect_b32 s68, s68, 2130706432
    s_cselect_b32 s73, s73, 2130706432
    v_lshlrev_b32 v16, 3, v1
    v_add_u32 v16, 81920, v16
    v_and_b32 v217, 7, v1
    v_min_u32 v218, 6, v217
    s_add_u32 m0, s52, 65536
    s_add_u32 s57, s65, 8
    s_sub_u32 s3, s57, 13
    s_min_u32 s57, s57, s3
    s_mul_i32 s57, s57, 114688
    buffer_load_dwordx4 v10, s[16:19], s57 offen offset:0 lds
    s_mul_i32 s54, s44, 7
    v_add_u32 v218, s54, v218
    v_mul_u32_u24 v219, 2, v218
    v_add_u32 v219, s89, v219
    s_add_u32 s57, s57, 27648
    buffer_load_dwordx4 v11, s[16:19], s57 offen offset:1024 lds
    s_waitcnt vmcnt(10)
    ds_read_b64_tr_b16 a[80:81], v4 offset:16384
    ds_read_b64_tr_b16 a[82:83], v4 offset:16896
    ds_read_b64_tr_b16 a[84:85], v5 offset:16384
    ds_read_b64_tr_b16 a[86:87], v5 offset:16896
    s_add_u32 s57, s57, 27648
    buffer_load_dwordx4 v10, s[16:19], s57 offen offset:2048 lds
    ds_read_b64_tr_b16 a[88:89], v4 offset:16640
    ds_read_b64_tr_b16 a[90:91], v4 offset:17152
    ds_read_b64_tr_b16 a[92:93], v5 offset:16640
    ds_read_b64_tr_b16 a[94:95], v5 offset:17152
    v_mul_u32_u24 v220, 43, v219
    v_lshrrev_b32 v220, 8, v220
    v_mul_u32_u24 v220, 6, v220
    v_sub_u32 v219, v219, v220
    s_add_u32 s57, s57, 27648
    buffer_load_dwordx4 v11, s[16:19], s57 offen offset:3072 lds
    v_subrev_u32 v219, s49, v219
    v_bfe_u32 v220, v1, 3, 1
    v_mul_i32_i24 v219, v219, v220
    v_add_u32 v219, s49, v219
    s_waitcnt lgkmcnt(15)
    s_add_u32 m0, s52, 81920
    s_add_u32 s57, s65, 9
    s_sub_u32 s3, s57, 13
    s_min_u32 s57, s57, s3
    s_mul_i32 s57, s57, 114688
    buffer_load_dwordx4 v10, s[16:19], s57 offen offset:0 lds
    v_lshl_add_u32 v218, v219, 5, v218
    v_lshlrev_b32 v20, 7, v218
    v_add_u32 v20, 12713984, v20
    s_lshr_b32 s53, s48, 1
    s_add_u32 s57, s57, 27648
    buffer_load_dwordx4 v11, s[16:19], s57 offen offset:1024 lds
    s_waitcnt vmcnt(10)
    ds_read_b64_tr_b16 a[96:97], v4 offset:32768
    ds_read_b64_tr_b16 a[98:99], v4 offset:33280
    ds_read_b64_tr_b16 a[100:101], v5 offset:32768
    ds_read_b64_tr_b16 a[102:103], v5 offset:33280
    s_lshl_b32 s53, s53, 7
    s_add_u32 s53, s53, 12779520
    v_lshl_add_u32 v21, v210, 11, s53
    s_lshl_b32 s70, s48, 16
    ds_read_b64_tr_b16 a[104:105], v4 offset:33024
    ds_read_b64_tr_b16 a[106:107], v4 offset:33536
    ds_read_b64_tr_b16 a[108:109], v5 offset:33024
    ds_read_b64_tr_b16 a[110:111], v5 offset:33536
    s_add_u32 s57, s57, 27648
    buffer_load_dwordx4 v10, s[16:19], s57 offen offset:2048 lds
    s_lshl2_add_u32 s70, s52, s70
    s_add_u32 s70, s70, 4194304
    v_lshrrev_b32 v218, 3, v1
    v_mul_u32_u24 v22, 896, v218
    s_add_u32 s57, s57, 27648
    buffer_load_dwordx4 v11, s[16:19], s57 offen offset:3072 lds
    v_lshl_add_u32 v22, v217, 4, v22
    v_lshlrev_b32 v25, 1, v211
    s_add_u32 s53, s52, 65536
    v_mul_u32_u24 v244, 176, v218
    buffer_load_dwordx2 v[224:225], v19, s[32:35], 0 offen offset:0
    v_lshl_add_u32 v244, v217, 4, v244
    v_add_u32 v244, s53, v244
    v_mul_u32_u24 v238, 176, v211
    v_lshl_add_u32 v238, v208, 3, v238
    buffer_load_dwordx2 v[226:227], v19, s[32:35], 0 offen offset:32
    s_waitcnt vmcnt(10)
    ds_read_b64_tr_b16 a[112:113], v2 offset:0
    ds_read_b64_tr_b16 a[114:115], v2 offset:512
    ds_read_b64_tr_b16 a[116:117], v3 offset:0
    ds_read_b64_tr_b16 a[118:119], v3 offset:512
    buffer_load_dwordx2 v[228:229], v19, s[32:35], 0 offen offset:64
    ds_read_b64_tr_b16 a[120:121], v2 offset:256
    ds_read_b64_tr_b16 a[122:123], v2 offset:768
    ds_read_b64_tr_b16 a[124:125], v3 offset:256
    ds_read_b64_tr_b16 a[126:127], v3 offset:768
    buffer_load_dwordx2 v[230:231], v19, s[32:35], 0 offen offset:96
    v_add_u32 v238, s53, v238
    v_lshrrev_b32 v218, 2, v0
    v_mul_u32_u24 v26, 896, v218
    v_lshl_add_u32 v26, v210, 3, v26
    s_add_u32 m0, s52, 98304
    s_add_u32 s57, s65, 10
    s_sub_u32 s3, s57, 13
    s_min_u32 s57, s57, s3
    s_mul_i32 s57, s57, 114688
    buffer_load_dwordx4 v10, s[16:19], s57 offen offset:0 lds
    v_lshrrev_b32 v218, 2, v1
    v_mul_u32_u24 v252, 176, v218
    v_lshl_add_u32 v252, v210, 3, v252
    v_add_u32 v252, s53, v252
    s_sub_u32 s53, 49152, s52
    v_add_u32 v246, s53, v2
    v_add_u32 v247, s53, v3
    v_mul_u32_u24 v218, 3072, v208
    s_add_u32 s57, s57, 27648
    buffer_load_dwordx4 v11, s[16:19], s57 offen offset:1024 lds
    s_waitcnt vmcnt(10)
    ds_read_b64_tr_b16 a[128:129], v2 offset:16384
    ds_read_b64_tr_b16 a[130:131], v2 offset:16896
    ds_read_b64_tr_b16 a[132:133], v3 offset:16384
    ds_read_b64_tr_b16 a[134:135], v3 offset:16896
    s_add_u32 s57, s57, 27648
    buffer_load_dwordx4 v10, s[16:19], s57 offen offset:2048 lds
    ds_read_b64_tr_b16 a[136:137], v2 offset:16640
    ds_read_b64_tr_b16 a[138:139], v2 offset:17152
    ds_read_b64_tr_b16 a[140:141], v3 offset:16640
    ds_read_b64_tr_b16 a[142:143], v3 offset:17152
    s_add_u32 s57, s57, 27648
    buffer_load_dwordx4 v11, s[16:19], s57 offen offset:3072 lds
    v_add_u32 v248, v218, v246
    v_add_u32 v249, v218, v247
    v_add_u32 v232, s52, v23
    v_xor_b32 v233, 4096, v232
    v_xor_b32 v234, 8192, v232
    v_xor_b32 v235, 12288, v232
    s_waitcnt lgkmcnt(15)
    s_add_u32 m0, s52, 114688
    s_add_u32 s57, s65, 11
    s_sub_u32 s3, s57, 13
    s_min_u32 s57, s57, s3
    s_mul_i32 s57, s57, 114688
    buffer_load_dwordx4 v10, s[16:19], s57 offen offset:0 lds
    s_add_u32 s57, s57, 27648
    buffer_load_dwordx4 v11, s[16:19], s57 offen offset:1024 lds
    s_waitcnt vmcnt(10)
    ds_read_b64_tr_b16 a[144:145], v2 offset:32768
    ds_read_b64_tr_b16 a[146:147], v2 offset:33280
    ds_read_b64_tr_b16 a[148:149], v3 offset:32768
    ds_read_b64_tr_b16 a[150:151], v3 offset:33280
    s_add_u32 s57, s57, 27648
    buffer_load_dwordx4 v10, s[16:19], s57 offen offset:2048 lds
    ds_read_b64_tr_b16 a[152:153], v2 offset:33024
    ds_read_b64_tr_b16 a[154:155], v2 offset:33536
    ds_read_b64_tr_b16 a[156:157], v3 offset:33024
    ds_read_b64_tr_b16 a[158:159], v3 offset:33536
    s_add_u32 s57, s57, 27648
    buffer_load_dwordx4 v11, s[16:19], s57 offen offset:3072 lds
    s_add_u32 m0, s52, 131072
    s_add_u32 s57, s65, 12
    s_sub_u32 s3, s57, 13
    s_min_u32 s57, s57, s3
    s_mul_i32 s57, s57, 114688
    buffer_load_dwordx4 v10, s[16:19], s57 offen offset:0 lds
    s_add_u32 s57, s57, 27648
    buffer_load_dwordx4 v11, s[16:19], s57 offen offset:1024 lds
    s_add_u32 s57, s57, 27648
    buffer_load_dwordx4 v10, s[16:19], s57 offen offset:2048 lds
    s_waitcnt vmcnt(11)
    v_lshlrev_b32 v32, 16, v224
    v_and_b32 v33, s61, v224
    v_lshlrev_b32 v34, 16, v225
    v_and_b32 v35, s61, v225
    v_lshlrev_b32 v36, 16, v226
    v_and_b32 v37, s61, v226
    v_lshlrev_b32 v38, 16, v227
    v_and_b32 v39, s61, v227
    s_add_u32 s57, s57, 27648
    buffer_load_dwordx4 v11, s[16:19], s57 offen offset:3072 lds
    v_lshlrev_b32 v40, 16, v228
    v_and_b32 v41, s61, v228
    v_lshlrev_b32 v42, 16, v229
    v_and_b32 v43, s61, v229
    buffer_load_dword v17, v18, s[24:27], 0 offen sc1
    v_lshlrev_b32 v44, 16, v230
    v_and_b32 v45, s61, v230
    v_lshlrev_b32 v46, 16, v231
    v_and_b32 v47, s61, v231
    v_mul_f32 v96, s85, v32
    v_mul_f32 v97, s85, v33
    v_mul_f32 v98, s85, v34
    v_mul_f32 v99, s85, v35
    s_add_u32 m0, s52, 147456
    s_mov_b32 s57, 1490944
    buffer_load_dwordx4 v10, s[16:19], s57 offen offset:0 lds
    s_waitcnt vmcnt(10)
    ds_read_b64_tr_b16 a[160:161], v2 offset:49152
    ds_read_b64_tr_b16 a[162:163], v2 offset:49664
    ds_read_b64_tr_b16 a[164:165], v3 offset:49152
    ds_read_b64_tr_b16 a[166:167], v3 offset:49664
    v_mul_f32 v100, s85, v36
    v_mul_f32 v101, s85, v37
    v_mul_f32 v102, s85, v38
    v_mul_f32 v103, s85, v39
    ds_read_b64_tr_b16 a[168:169], v2 offset:49408
    ds_read_b64_tr_b16 a[170:171], v2 offset:49920
    ds_read_b64_tr_b16 a[172:173], v3 offset:49408
    ds_read_b64_tr_b16 a[174:175], v3 offset:49920
    s_add_u32 s57, s57, 27648
    buffer_load_dwordx4 v11, s[16:19], s57 offen offset:1024 lds
    v_mul_f32 v104, s85, v40
    v_mul_f32 v105, s85, v41
    v_mul_f32 v106, s85, v42
    v_mul_f32 v107, s85, v43
    s_add_u32 s57, s57, 27648
    buffer_load_dwordx4 v10, s[16:19], s57 offen offset:2048 lds
    v_mul_f32 v108, s85, v44
    v_mul_f32 v109, s85, v45
    v_mul_f32 v110, s85, v46
    v_mul_f32 v111, s85, v47
    s_add_u32 s57, s57, 27648
    buffer_load_dwordx4 v11, s[16:19], s57 offen offset:3072 lds
    s_waitcnt lgkmcnt(15)
    s_add_u32 m0, s52, 49152
    s_mov_b32 s57, 1605632
    buffer_load_dwordx4 v10, s[16:19], s57 offen offset:0 lds
    s_waitcnt vmcnt(10)
    ds_read_b64_tr_b16 a[176:177], v4 offset:0
    ds_read_b64_tr_b16 a[178:179], v4 offset:512
    ds_read_b64_tr_b16 a[180:181], v5 offset:0
    ds_read_b64_tr_b16 a[182:183], v5 offset:512
    s_add_u32 s57, s57, 27648
    buffer_load_dwordx4 v11, s[16:19], s57 offen offset:1024 lds
    ds_read_b64_tr_b16 a[184:185], v4 offset:256
    ds_read_b64_tr_b16 a[186:187], v4 offset:768
    ds_read_b64_tr_b16 a[188:189], v5 offset:256
    ds_read_b64_tr_b16 a[190:191], v5 offset:768
    s_add_u32 s57, s57, 27648
    buffer_load_dwordx4 v10, s[16:19], s57 offen offset:2048 lds
    s_add_u32 s57, s57, 27648
    buffer_load_dwordx4 v11, s[16:19], s57 offen offset:3072 lds
    s_add_u32 m0, s52, 65536
    s_mov_b32 s57, 1720320
    buffer_load_dwordx4 v10, s[16:19], s57 offen offset:0 lds
    s_waitcnt vmcnt(10)
    ds_read_b64_tr_b16 a[192:193], v4 offset:16384
    ds_read_b64_tr_b16 a[194:195], v4 offset:16896
    ds_read_b64_tr_b16 a[196:197], v5 offset:16384
    ds_read_b64_tr_b16 a[198:199], v5 offset:16896
    s_add_u32 s57, s57, 27648
    buffer_load_dwordx4 v11, s[16:19], s57 offen offset:1024 lds
    ds_read_b64_tr_b16 a[200:201], v4 offset:16640
    ds_read_b64_tr_b16 a[202:203], v4 offset:17152
    ds_read_b64_tr_b16 a[204:205], v5 offset:16640
    ds_read_b64_tr_b16 a[206:207], v5 offset:17152
    s_add_u32 s57, s57, 27648
    buffer_load_dwordx4 v10, s[16:19], s57 offen offset:2048 lds
    s_waitcnt vmcnt(11)
    v_cmp_ne_u32 vcc, s47, v17
    s_nop 0
    s_cbranch_vccz L_ok5
    s_mov_b32 s59, 100000
L_spin4:
    buffer_load_dword v17, v18, s[24:27], 0 offen sc1
    s_waitcnt vmcnt(0)
    v_cmp_ne_u32 vcc, s47, v17
    s_nop 0
    s_cbranch_vccz L_ok5
    s_sub_u32 s59, s59, 1
    s_cbranch_scc0 L_spin4
L_ok5:
    s_cmp_ge_u32 s88, 4
    s_cbranch_scc1 L_p2_alt
    s_add_u32 s57, s57, 27648
    buffer_load_dwordx4 v11, s[16:19], s57 offen offset:3072 lds
    s_mov_b32 s66, s84
    s_lshl_b32 s86, s65, 10
    s_add_u32 s58, s86, s66
    s_add_u32 s86, s66, 13312
    buffer_load_dwordx4 v[112:115], v23, s[24:27], s58 offen offset:0 sc1
    s_add_u32 s58, s58, 1024
    s_cmp_eq_u32 s58, s86
    s_cselect_b32 s58, s66, s58
    buffer_load_dwordx4 v[116:119], v23, s[24:27], s58 offen offset:0 sc1
    s_waitcnt vmcnt(10)
    ds_read_b64_tr_b16 a[208:209], v4 offset:32768
    ds_read_b64_tr_b16 a[210:211], v4 offset:33280
    ds_read_b64_tr_b16 a[212:213], v5 offset:32768
    ds_read_b64_tr_b16 a[214:215], v5 offset:33280
    s_add_u32 s58, s58, 1024
    s_cmp_eq_u32 s58, s86
    s_cselect_b32 s58, s66, s58
    buffer_load_dwordx4 v[120:123], v23, s[24:27], s58 offen offset:0 sc1
    ds_read_b64_tr_b16 a[216:217], v4 offset:33024
    ds_read_b64_tr_b16 a[218:219], v4 offset:33536
    ds_read_b64_tr_b16 a[220:221], v5 offset:33024
    ds_read_b64_tr_b16 a[222:223], v5 offset:33536
    s_add_u32 s58, s58, 1024
    s_cmp_eq_u32 s58, s86
    s_cselect_b32 s58, s66, s58
    buffer_load_dwordx4 v[124:127], v23, s[24:27], s58 offen offset:0 sc1
    s_add_u32 s58, s58, 1024
    s_cmp_eq_u32 s58, s86
    s_cselect_b32 s58, s66, s58
    buffer_load_dwordx4 v[128:131], v23, s[24:27], s58 offen offset:0 sc1
    s_add_u32 s58, s58, 1024
    s_cmp_eq_u32 s58, s86
    s_cselect_b32 s58, s66, s58
    buffer_load_dwordx4 v[132:135], v23, s[24:27], s58 offen offset:0 sc1
    s_waitcnt vmcnt(10)
    ds_read_b64_tr_b16 a[224:225], v2 offset:0
    ds_read_b64_tr_b16 a[226:227], v2 offset:512
    ds_read_b64_tr_b16 a[228:229], v3 offset:0
    ds_read_b64_tr_b16 a[230:231], v3 offset:512
    s_add_u32 s58, s58, 1024
    s_cmp_eq_u32 s58, s86
    s_cselect_b32 s58, s66, s58
    buffer_load_dwordx4 v[136:139], v23, s[24:27], s58 offen offset:0 sc1
    ds_read_b64_tr_b16 a[232:233], v2 offset:256
    ds_read_b64_tr_b16 a[234:235], v2 offset:768
    ds_read_b64_tr_b16 a[236:237], v3 offset:256
    ds_read_b64_tr_b16 a[238:239], v3 offset:768
    s_add_u32 s58, s58, 1024
    s_cmp_eq_u32 s58, s86
    s_cselect_b32 s58, s66, s58
    buffer_load_dwordx4 v[140:143], v23, s[24:27], s58 offen offset:0 sc1
    s_add_u32 s58, s58, 1024
    s_cmp_eq_u32 s58, s86
    s_cselect_b32 s58, s66, s58
    buffer_load_dwordx4 v[144:147], v23, s[24:27], s58 offen offset:0 sc1
    s_add_u32 s58, s58, 1024
    s_cmp_eq_u32 s58, s86
    s_cselect_b32 s58, s66, s58
    buffer_load_dwordx4 v[148:151], v23, s[24:27], s58 offen offset:0 sc1
    s_waitcnt vmcnt(10)
    ds_read_b64_tr_b16 a[240:241], v2 offset:16384
    ds_read_b64_tr_b16 a[242:243], v2 offset:16896
    ds_read_b64_tr_b16 a[244:245], v3 offset:16384
    ds_read_b64_tr_b16 a[246:247], v3 offset:16896
    s_add_u32 s58, s58, 1024
    s_cmp_eq_u32 s58, s86
    s_cselect_b32 s58, s66, s58
    buffer_load_dwordx4 v[152:155], v23, s[24:27], s58 offen offset:0 sc1
    ds_read_b64_tr_b16 a[248:249], v2 offset:16640
    ds_read_b64_tr_b16 a[250:251], v2 offset:17152
    ds_read_b64_tr_b16 a[252:253], v3 offset:16640
    ds_read_b64_tr_b16 a[254:255], v3 offset:17152
    s_waitcnt vmcnt(10)
    v_mfma_f32_16x16x32_bf16 v[96:99], a[0:3], v[112:115], v[96:99]
    s_add_u32 s58, s58, 1024
    s_cmp_eq_u32 s58, s86
    s_cselect_b32 s58, s66, s58
    v_mfma_f32_16x16x32_bf16 v[100:103], a[4:7], v[112:115], v[100:103]
    buffer_load_dwordx4 v[156:159], v23, s[24:27], s58 offen offset:0 sc1
    v_mfma_f32_16x16x32_bf16 v[104:107], a[8:11], v[112:115], v[104:107]
    v_mfma_f32_16x16x32_bf16 v[108:111], a[12:15], v[112:115], v[108:111]
    s_waitcnt vmcnt(10)
    v_mfma_f32_16x16x32_bf16 v[96:99], a[16:19], v[116:119], v[96:99]
    s_add_u32 s58, s58, 1024
    s_cmp_eq_u32 s58, s86
    s_cselect_b32 s58, s66, s58
    v_mfma_f32_16x16x32_bf16 v[100:103], a[20:23], v[116:119], v[100:103]
    buffer_load_dwordx4 v[112:115], v23, s[24:27], s58 offen offset:0 sc1
    v_mfma_f32_16x16x32_bf16 v[104:107], a[24:27], v[116:119], v[104:107]
    v_mfma_f32_16x16x32_bf16 v[108:111], a[28:31], v[116:119], v[108:111]
    s_waitcnt vmcnt(10)
    v_mfma_f32_16x16x32_bf16 v[96:99], a[32:35], v[120:123], v[96:99]
    s_add_u32 s58, s66, 13312
    v_mfma_f32_16x16x32_bf16 v[100:103], a[36:39], v[120:123], v[100:103]
    buffer_load_dwordx4 v[116:119], v23, s[24:27], s58 offen offset:0 sc1
    v_mfma_f32_16x16x32_bf16 v[104:107], a[40:43], v[120:123], v[104:107]
    v_mfma_f32_16x16x32_bf16 v[108:111], a[44:47], v[120:123], v[108:111]
    s_waitcnt vmcnt(10)
    v_mfma_f32_16x16x32_bf16 v[96:99], a[48:51], v[124:127], v[96:99]
    s_add_u32 s58, s66, 14336
    v_mfma_f32_16x16x32_bf16 v[100:103], a[52:55], v[124:127], v[100:103]
    buffer_load_dwordx4 v[120:123], v23, s[24:27], s58 offen offset:0 sc1
    v_mfma_f32_16x16x32_bf16 v[104:107], a[56:59], v[124:127], v[104:107]
    v_mfma_f32_16x16x32_bf16 v[108:111], a[60:63], v[124:127], v[108:111]
    s_waitcnt vmcnt(10)
    v_mfma_f32_16x16x32_bf16 v[96:99], a[64:67], v[128:131], v[96:99]
    s_add_u32 s58, s66, 15360
    v_mfma_f32_16x16x32_bf16 v[100:103], a[68:71], v[128:131], v[100:103]
    buffer_load_dwordx4 v[124:127], v23, s[24:27], s58 offen offset:0 sc1
    v_mfma_f32_16x16x32_bf16 v[104:107], a[72:75], v[128:131], v[104:107]
    v_mfma_f32_16x16x32_bf16 v[108:111], a[76:79], v[128:131], v[108:111]
    s_waitcnt vmcnt(10)
    v_mfma_f32_16x16x32_bf16 v[96:99], a[80:83], v[132:135], v[96:99]
    s_xor_b32 s66, s44, 3
    s_lshl2_add_u32 s66, s51, s66
    s_mul_i32 s66, s66, 66816
    s_lshl2_add_u32 s66, s52, s66
    s_lshl_b32 s86, s65, 10
    s_add_u32 s58, s86, s66
    s_add_u32 s86, s66, 13312
    v_mfma_f32_16x16x32_bf16 v[100:103], a[84:87], v[132:135], v[100:103]
    buffer_load_dwordx4 v[128:131], v23, s[24:27], s58 offen offset:0 sc1
    v_mfma_f32_16x16x32_bf16 v[104:107], a[88:91], v[132:135], v[104:107]
    v_mfma_f32_16x16x32_bf16 v[108:111], a[92:95], v[132:135], v[108:111]
    s_waitcnt vmcnt(10)
    v_mfma_f32_16x16x32_bf16 v[96:99], a[96:99], v[136:139], v[96:99]
    s_add_u32 s58, s58, 1024
    s_cmp_eq_u32 s58, s86
    s_cselect_b32 s58, s66, s58
    v_mfma_f32_16x16x32_bf16 v[100:103], a[100:103], v[136:139], v[100:103]
    buffer_load_dwordx4 v[132:135], v23, s[24:27], s58 offen offset:0 sc1
    v_mfma_f32_16x16x32_bf16 v[104:107], a[104:107], v[136:139], v[104:107]
    v_mfma_f32_16x16x32_bf16 v[108:111], a[108:111], v[136:139], v[108:111]
    s_waitcnt vmcnt(10)
    v_mfma_f32_16x16x32_bf16 v[96:99], a[112:115], v[140:143], v[96:99]
    s_add_u32 s58, s58, 1024
    s_cmp_eq_u32 s58, s86
    s_cselect_b32 s58, s66, s58
    v_mfma_f32_16x16x32_bf16 v[100:103], a[116:119], v[140:143], v[100:103]
    buffer_load_dwordx4 v[136:139], v23, s[24:27], s58 offen offset:0 sc1
    v_mfma_f32_16x16x32_bf16 v[104:107], a[120:123], v[140:143], v[104:107]
    v_mfma_f32_16x16x32_bf16 v[108:111], a[124:127], v[140:143], v[108:111]
    s_waitcnt vmcnt(10)
    v_mfma_f32_16x16x32_bf16 v[96:99], a[128:131], v[144:147], v[96:99]
    s_add_u32 s58, s58, 1024
    s_cmp_eq_u32 s58, s86
    s_cselect_b32 s58, s66, s58
    v_mfma_f32_16x16x32_bf16 v[100:103], a[132:135], v[144:147], v[100:103]
    buffer_load_dwordx4 v[140:143], v23, s[24:27], s58 offen offset:0 sc1
    v_mfma_f32_16x16x32_bf16 v[104:107], a[136:139], v[144:147], v[104:107]
    v_mfma_f32_16x16x32_bf16 v[108:111], a[140:143], v[144:147], v[108:111]
    s_waitcnt vmcnt(10)
    s_waitcnt lgkmcnt(15)
    v_mfma_f32_16x16x32_bf16 v[96:99], a[144:147], v[148:151], v[96:99]
    s_add_u32 s58, s58, 1024
    s_cmp_eq_u32 s58, s86
    s_cselect_b32 s58, s66, s58
    v_mfma_f32_16x16x32_bf16 v[100:103], a[148:151], v[148:151], v[100:103]
    buffer_load_dwordx4 v[144:147], v23, s[24:27], s58 offen offset:0 sc1
    v_mfma_f32_16x16x32_bf16 v[104:107], a[152:155], v[148:151], v[104:107]
    v_mfma_f32_16x16x32_bf16 v[108:111], a[156:159], v[148:151], v[108:111]
    s_waitcnt vmcnt(10)
    v_mfma_f32_16x16x32_bf16 v[96:99], a[160:163], v[152:155], v[96:99]
    s_add_u32 s58, s58, 1024
    s_cmp_eq_u32 s58, s86
    s_cselect_b32 s58, s66, s58
    v_mfma_f32_16x16x32_bf16 v[100:103], a[164:167], v[152:155], v[100:103]
    buffer_load_dwordx4 v[148:151], v23, s[24:27], s58 offen offset:0 sc1
    v_mfma_f32_16x16x32_bf16 v[104:107], a[168:171], v[152:155], v[104:107]
    v_mfma_f32_16x16x32_bf16 v[108:111], a[172:175], v[152:155], v[108:111]
    s_waitcnt vmcnt(10)
    v_mfma_f32_16x16x32_bf16 v[96:99], a[176:179], v[156:159], v[96:99]
    s_add_u32 s58, s58, 1024
    s_cmp_eq_u32 s58, s86
    s_cselect_b32 s58, s66, s58
    v_mfma_f32_16x16x32_bf16 v[100:103], a[180:183], v[156:159], v[100:103]
    buffer_load_dwordx4 v[152:155], v23, s[24:27], s58 offen offset:0 sc1
    v_mfma_f32_16x16x32_bf16 v[104:107], a[184:187], v[156:159], v[104:107]
    v_mfma_f32_16x16x32_bf16 v[108:111], a[188:191], v[156:159], v[108:111]
    s_waitcnt vmcnt(10)
    v_mfma_f32_16x16x32_bf16 v[96:99], a[192:195], v[112:115], v[96:99]
    s_add_u32 s58, s58, 1024
    s_cmp_eq_u32 s58, s86
    s_cselect_b32 s58, s66, s58
    v_mfma_f32_16x16x32_bf16 v[100:103], a[196:199], v[112:115], v[100:103]
    buffer_load_dwordx4 v[156:159], v23, s[24:27], s58 offen offset:0 sc1
    v_mfma_f32_16x16x32_bf16 v[104:107], a[200:203], v[112:115], v[104:107]
    v_mfma_f32_16x16x32_bf16 v[108:111], a[204:207], v[112:115], v[108:111]
    s_waitcnt vmcnt(10)
    v_mfma_f32_16x16x32_bf16 v[96:99], a[208:211], v[116:119], v[96:99]
    s_add_u32 s58, s58, 1024
    s_cmp_eq_u32 s58, s86
    s_cselect_b32 s58, s66, s58
    v_mfma_f32_16x16x32_bf16 v[100:103], a[212:215], v[116:119], v[100:103]
    buffer_load_dwordx4 v[112:115], v23, s[24:27], s58 offen offset:0 sc1
    v_mfma_f32_16x16x32_bf16 v[104:107], a[216:219], v[116:119], v[104:107]
    v_mfma_f32_16x16x32_bf16 v[108:111], a[220:223], v[116:119], v[108:111]
    s_waitcnt vmcnt(10)
    s_waitcnt lgkmcnt(8)
    v_mfma_f32_16x16x32_bf16 v[96:99], a[224:227], v[120:123], v[96:99]
    s_add_u32 s58, s58, 1024
    s_cmp_eq_u32 s58, s86
    s_cselect_b32 s58, s66, s58
    v_mfma_f32_16x16x32_bf16 v[100:103], a[228:231], v[120:123], v[100:103]
    buffer_load_dwordx4 v[116:119], v23, s[24:27], s58 offen offset:0 sc1
    v_mfma_f32_16x16x32_bf16 v[104:107], a[232:235], v[120:123], v[104:107]
    v_mfma_f32_16x16x32_bf16 v[108:111], a[236:239], v[120:123], v[108:111]
    s_waitcnt vmcnt(10)
    s_waitcnt lgkmcnt(0)
    v_mfma_f32_16x16x32_bf16 v[96:99], a[240:243], v[124:127], v[96:99]
    s_add_u32 s58, s58, 1024
    s_cmp_eq_u32 s58, s86
    s_cselect_b32 s58, s66, s58
    v_mfma_f32_16x16x32_bf16 v[100:103], a[244:247], v[124:127], v[100:103]
    buffer_load_dwordx4 v[120:123], v23, s[24:27], s58 offen offset:0 sc1
    v_mfma_f32_16x16x32_bf16 v[104:107], a[248:251], v[124:127], v[104:107]
    v_mfma_f32_16x16x32_bf16 v[108:111], a[252:255], v[124:127], v[108:111]
L_p2_join:
    s_waitcnt vmcnt(10)
    v_mfma_f32_16x16x32_bf16 v[80:83], a[0:3], v[128:131], 0
    s_add_u32 s58, s58, 1024
    s_cmp_eq_u32 s58, s86
    s_cselect_b32 s58, s66, s58
    v_mfma_f32_16x16x32_bf16 v[84:87], a[4:7], v[128:131], 0
    buffer_load_dwordx4 v[124:127], v23, s[24:27], s58 offen offset:0 sc1
    v_mfma_f32_16x16x32_bf16 v[88:91], a[8:11], v[128:131], 0
    v_mfma_f32_16x16x32_bf16 v[92:95], a[12:15], v[128:131], 0
    buffer_load_dwordx4 v[216:219], v22, s[4:7], s71 offen
    s_waitcnt vmcnt(11)
    v_mfma_f32_16x16x32_bf16 v[80:83], a[16:19], v[132:135], v[80:83]
    ds_write_b128 v232, v[96:99] offset:49152
    v_mfma_f32_16x16x32_bf16 v[84:87], a[20:23], v[132:135], v[84:87]
    v_mfma_f32_16x16x32_bf16 v[88:91], a[24:27], v[132:135], v[88:91]
    v_mfma_f32_16x16x32_bf16 v[92:95], a[28:31], v[132:135], v[92:95]
    s_waitcnt vmcnt(10)
    v_mfma_f32_16x16x32_bf16 v[80:83], a[32:35], v[136:139], v[80:83]
    s_add_u32 s58, s58, 1024
    s_cmp_eq_u32 s58, s86
    s_cselect_b32 s58, s66, s58
    v_mfma_f32_16x16x32_bf16 v[84:87], a[36:39], v[136:139], v[84:87]
    buffer_load_dwordx4 v[128:131], v23, s[24:27], s58 offen offset:0 sc1
    v_mfma_f32_16x16x32_bf16 v[88:91], a[40:43], v[136:139], v[88:91]
    ds_write_b128 v232, v[100:103] offset:50176
    v_mfma_f32_16x16x32_bf16 v[92:95], a[44:47], v[136:139], v[92:95]
    buffer_load_dwordx4 v[220:223], v22, s[4:7], s72 offen
    s_waitcnt vmcnt(11)
    v_mfma_f32_16x16x32_bf16 v[80:83], a[48:51], v[140:143], v[80:83]
    ds_write_b128 v232, v[104:107] offset:51200
    v_mfma_f32_16x16x32_bf16 v[84:87], a[52:55], v[140:143], v[84:87]
    v_mfma_f32_16x16x32_bf16 v[88:91], a[56:59], v[140:143], v[88:91]
    v_mfma_f32_16x16x32_bf16 v[92:95], a[60:63], v[140:143], v[92:95]
    s_waitcnt vmcnt(10)
    v_mfma_f32_16x16x32_bf16 v[80:83], a[64:67], v[144:147], v[80:83]
    s_add_u32 s58, s66, 13312
    v_mfma_f32_16x16x32_bf16 v[84:87], a[68:71], v[144:147], v[84:87]
    buffer_load_dwordx4 v[132:135], v23, s[24:27], s58 offen offset:0 sc1
    v_mfma_f32_16x16x32_bf16 v[88:91], a[72:75], v[144:147], v[88:91]
    ds_write_b128 v232, v[108:111] offset:52224
    v_mfma_f32_16x16x32_bf16 v[92:95], a[76:79], v[144:147], v[92:95]
    buffer_load_dwordx2 v[224:225], v26, s[4:7], s73 offen
    s_waitcnt vmcnt(11)
    v_mfma_f32_16x16x32_bf16 v[80:83], a[80:83], v[148:151], v[80:83]
    v_mfma_f32_16x16x32_bf16 v[84:87], a[84:87], v[148:151], v[84:87]
    v_mfma_f32_16x16x32_bf16 v[88:91], a[88:91], v[148:151], v[88:91]
    v_mfma_f32_16x16x32_bf16 v[92:95], a[92:95], v[148:151], v[92:95]
    s_waitcnt vmcnt(10)
    v_mfma_f32_16x16x32_bf16 v[80:83], a[96:99], v[152:155], v[80:83]
    s_add_u32 s58, s66, 14336
    v_mfma_f32_16x16x32_bf16 v[84:87], a[100:103], v[152:155], v[84:87]
    buffer_load_dwordx4 v[136:139], v23, s[24:27], s58 offen offset:0 sc1
    v_mfma_f32_16x16x32_bf16 v[88:91], a[104:107], v[152:155], v[88:91]
    v_mfma_f32_16x16x32_bf16 v[92:95], a[108:111], v[152:155], v[92:95]
    buffer_load_ushort v228, v25, s[36:39], s74 offen
    s_waitcnt vmcnt(11)
    v_mfma_f32_16x16x32_bf16 v[80:83], a[112:115], v[156:159], v[80:83]
    s_waitcnt lgkmcnt(0)
    s_barrier
    v_mfma_f32_16x16x32_bf16 v[84:87], a[116:119], v[156:159], v[84:87]
    v_mfma_f32_16x16x32_bf16 v[88:91], a[120:123], v[156:159], v[88:91]
    v_mfma_f32_16x16x32_bf16 v[92:95], a[124:127], v[156:159], v[92:95]
    s_waitcnt vmcnt(10)
    v_mfma_f32_16x16x32_bf16 v[80:83], a[128:131], v[112:115], v[80:83]
    s_add_u32 s58, s66, 15360
    v_mfma_f32_16x16x32_bf16 v[84:87], a[132:135], v[112:115], v[84:87]
    buffer_load_dwordx4 v[140:143], v23, s[24:27], s58 offen offset:0 sc1
    v_mfma_f32_16x16x32_bf16 v[88:91], a[136:139], v[112:115], v[88:91]
    ds_read_b128 v[160:163], v243 offset:0
    ds_read_b128 v[164:167], v243 offset:1024
    v_mfma_f32_16x16x32_bf16 v[92:95], a[140:143], v[112:115], v[92:95]
    ds_read_b128 v[168:171], v243 offset:4096
    s_waitcnt vmcnt(10)
    v_mfma_f32_16x16x32_bf16 v[80:83], a[144:147], v[116:119], v[80:83]
    s_xor_b32 s66, s44, 2
    s_lshl2_add_u32 s66, s51, s66
    s_mul_i32 s66, s66, 66816
    s_lshl2_add_u32 s66, s52, s66
    s_lshl_b32 s86, s65, 10
    s_add_u32 s58, s86, s66
    s_add_u32 s86, s66, 13312
    v_mfma_f32_16x16x32_bf16 v[84:87], a[148:151], v[116:119], v[84:87]
    buffer_load_dwordx4 v[144:147], v23, s[24:27], s58 offen offset:0 sc1
    v_mfma_f32_16x16x32_bf16 v[88:91], a[152:155], v[116:119], v[88:91]
    ds_read_b128 v[172:175], v243 offset:5120
    ds_read_b128 v[176:179], v243 offset:8192
    v_mfma_f32_16x16x32_bf16 v[92:95], a[156:159], v[116:119], v[92:95]
    ds_read_b128 v[180:183], v243 offset:9216
    s_waitcnt vmcnt(10)
    v_mfma_f32_16x16x32_bf16 v[80:83], a[160:163], v[120:123], v[80:83]
    s_add_u32 s58, s58, 1024
    s_cmp_eq_u32 s58, s86
    s_cselect_b32 s58, s66, s58
    v_mfma_f32_16x16x32_bf16 v[84:87], a[164:167], v[120:123], v[84:87]
    buffer_load_dwordx4 v[148:151], v23, s[24:27], s58 offen offset:0 sc1
    v_mfma_f32_16x16x32_bf16 v[88:91], a[168:171], v[120:123], v[88:91]
    ds_read_b128 v[184:187], v243 offset:12288
    v_mfma_f32_16x16x32_bf16 v[92:95], a[172:175], v[120:123], v[92:95]
    ds_read_b128 v[188:191], v243 offset:13312
    s_waitcnt vmcnt(10)
    v_mfma_f32_16x16x32_bf16 v[80:83], a[176:179], v[124:127], v[80:83]
    s_add_u32 s58, s58, 1024
    s_cmp_eq_u32 s58, s86
    s_cselect_b32 s58, s66, s58
    v_mfma_f32_16x16x32_bf16 v[84:87], a[180:183], v[124:127], v[84:87]
    buffer_load_dwordx4 v[152:155], v23, s[24:27], s58 offen offset:0 sc1
    v_mfma_f32_16x16x32_bf16 v[88:91], a[184:187], v[124:127], v[88:91]
    v_mfma_f32_16x16x32_bf16 v[92:95], a[188:191], v[124:127], v[92:95]
    s_add_u32 s58, s58, 1024
    s_cmp_eq_u32 s58, s86
    s_cselect_b32 s58, s66, s58
    buffer_load_dwordx4 v[156:159], v23, s[24:27], s58 offen offset:0 sc1
    s_waitcnt vmcnt(10)
    v_mfma_f32_16x16x32_bf16 v[80:83], a[192:195], v[128:131], v[80:83]
    s_add_u32 s58, s58, 1024
    s_cmp_eq_u32 s58, s86
    s_cselect_b32 s58, s66, s58
    v_mfma_f32_16x16x32_bf16 v[84:87], a[196:199], v[128:131], v[84:87]
    buffer_load_dwordx4 v[112:115], v23, s[24:27], s58 offen offset:0 sc1
    v_mfma_f32_16x16x32_bf16 v[88:91], a[200:203], v[128:131], v[88:91]
    s_waitcnt lgkmcnt(0)
    v_add_f32 v160, v160, v168
    v_mfma_f32_16x16x32_bf16 v[92:95], a[204:207], v[128:131], v[92:95]
    v_add_f32 v161, v161, v169
    s_add_u32 s58, s58, 1024
    s_cmp_eq_u32 s58, s86
    s_cselect_b32 s58, s66, s58
    buffer_load_dwordx4 v[116:119], v23, s[24:27], s58 offen offset:0 sc1
    s_waitcnt vmcnt(10)
    v_mfma_f32_16x16x32_bf16 v[80:83], a[208:211], v[132:135], v[80:83]
    s_add_u32 s58, s58, 1024
    s_cmp_eq_u32 s58, s86
    s_cselect_b32 s58, s66, s58
    v_mfma_f32_16x16x32_bf16 v[84:87], a[212:215], v[132:135], v[84:87]
    buffer_load_dwordx4 v[120:123], v23, s[24:27], s58 offen offset:0 sc1
    v_mfma_f32_16x16x32_bf16 v[88:91], a[216:219], v[132:135], v[88:91]
    v_add_f32 v162, v162, v170
    v_add_f32 v163, v163, v171
    v_mfma_f32_16x16x32_bf16 v[92:95], a[220:223], v[132:135], v[92:95]
    v_add_f32 v164, v164, v172
    s_add_u32 s58, s58, 1024
    s_cmp_eq_u32 s58, s86
    s_cselect_b32 s58, s66, s58
    buffer_load_dwordx4 v[124:127], v23, s[24:27], s58 offen offset:0 sc1
    s_waitcnt vmcnt(10)
    v_mfma_f32_16x16x32_bf16 v[80:83], a[224:227], v[136:139], v[80:83]
    s_add_u32 s58, s58, 1024
    s_cmp_eq_u32 s58, s86
    s_cselect_b32 s58, s66, s58
    v_mfma_f32_16x16x32_bf16 v[84:87], a[228:231], v[136:139], v[84:87]
    buffer_load_dwordx4 v[128:131], v23, s[24:27], s58 offen offset:0 sc1
    v_mfma_f32_16x16x32_bf16 v[88:91], a[232:235], v[136:139], v[88:91]
    v_add_f32 v165, v165, v173
    v_add_f32 v166, v166, v174
    v_mfma_f32_16x16x32_bf16 v[92:95], a[236:239], v[136:139], v[92:95]
    v_add_f32 v167, v167, v175
    s_add_u32 s58, s58, 1024
    s_cmp_eq_u32 s58, s86
    s_cselect_b32 s58, s66, s58
    buffer_load_dwordx4 v[132:135], v23, s[24:27], s58 offen offset:0 sc1
    s_waitcnt vmcnt(10)
    v_mfma_f32_16x16x32_bf16 v[80:83], a[240:243], v[140:143], v[80:83]
    s_add_u32 s58, s58, 1024
    s_cmp_eq_u32 s58, s86
    s_cselect_b32 s58, s66, s58
    v_mfma_f32_16x16x32_bf16 v[84:87], a[244:247], v[140:143], v[84:87]
    buffer_load_dwordx4 v[136:139], v23, s[24:27], s58 offen offset:0 sc1
    v_mfma_f32_16x16x32_bf16 v[88:91], a[248:251], v[140:143], v[88:91]
    v_add_f32 v160, v160, v176
    v_add_f32 v161, v161, v177
    v_mfma_f32_16x16x32_bf16 v[92:95], a[252:255], v[140:143], v[92:95]
    v_add_f32 v162, v162, v178
    s_waitcnt vmcnt(10)
    v_mfma_f32_16x16x32_bf16 v[64:67], a[0:3], v[144:147], 0
    s_add_u32 s58, s58, 1024
    s_cmp_eq_u32 s58, s86
    s_cselect_b32 s58, s66, s58
    v_mfma_f32_16x16x32_bf16 v[68:71], a[4:7], v[144:147], 0
    buffer_load_dwordx4 v[140:143], v23, s[24:27], s58 offen offset:0 sc1
    v_mfma_f32_16x16x32_bf16 v[72:75], a[8:11], v[144:147], 0
    v_mfma_f32_16x16x32_bf16 v[76:79], a[12:15], v[144:147], 0
    s_waitcnt vmcnt(10)
    v_mfma_f32_16x16x32_bf16 v[64:67], a[16:19], v[148:151], v[64:67]
    s_add_u32 s58, s58, 1024
    s_cmp_eq_u32 s58, s86
    s_cselect_b32 s58, s66, s58
    v_mfma_f32_16x16x32_bf16 v[68:71], a[20:23], v[148:151], v[68:71]
    buffer_load_dwordx4 v[144:147], v23, s[24:27], s58 offen offset:0 sc1
    v_mfma_f32_16x16x32_bf16 v[72:75], a[24:27], v[148:151], v[72:75]
    ds_write_b128 v232, v[80:83] offset:32768
    v_mfma_f32_16x16x32_bf16 v[76:79], a[28:31], v[148:151], v[76:79]
    s_waitcnt vmcnt(10)
    v_mfma_f32_16x16x32_bf16 v[64:67], a[32:35], v[152:155], v[64:67]
    s_add_u32 s58, s66, 13312
    v_mfma_f32_16x16x32_bf16 v[68:71], a[36:39], v[152:155], v[68:71]
    buffer_load_dwordx4 v[148:151], v23, s[24:27], s58 offen offset:0 sc1
    v_mfma_f32_16x16x32_bf16 v[72:75], a[40:43], v[152:155], v[72:75]
    ds_write_b128 v232, v[84:87] offset:33792
    v_mfma_f32_16x16x32_bf16 v[76:79], a[44:47], v[152:155], v[76:79]
    s_waitcnt vmcnt(10)
    v_mfma_f32_16x16x32_bf16 v[64:67], a[48:51], v[156:159], v[64:67]
    s_add_u32 s58, s66, 14336
    ds_write_b128 v232, v[88:91] offset:34816
    v_mfma_f32_16x16x32_bf16 v[68:71], a[52:55], v[156:159], v[68:71]
    buffer_load_dwordx4 v[152:155], v23, s[24:27], s58 offen offset:0 sc1
    v_mfma_f32_16x16x32_bf16 v[72:75], a[56:59], v[156:159], v[72:75]
    v_add_f32 v163, v163, v179
    v_add_f32 v164, v164, v180
    v_mfma_f32_16x16x32_bf16 v[76:79], a[60:63], v[156:159], v[76:79]
    v_add_f32 v165, v165, v181
    s_waitcnt vmcnt(10)
    v_mfma_f32_16x16x32_bf16 v[64:67], a[64:67], v[112:115], v[64:67]
    s_add_u32 s58, s66, 15360
    ds_write_b128 v232, v[92:95] offset:35840
    v_mfma_f32_16x16x32_bf16 v[68:71], a[68:71], v[112:115], v[68:71]
    buffer_load_dwordx4 v[156:159], v23, s[24:27], s58 offen offset:0 sc1
    v_mfma_f32_16x16x32_bf16 v[72:75], a[72:75], v[112:115], v[72:75]
    v_add_f32 v166, v166, v182
    v_add_f32 v167, v167, v183
    v_mfma_f32_16x16x32_bf16 v[76:79], a[76:79], v[112:115], v[76:79]
    v_add_f32 v160, v160, v184
    s_waitcnt vmcnt(10)
    v_mfma_f32_16x16x32_bf16 v[64:67], a[80:83], v[116:119], v[64:67]
    s_xor_b32 s66, s44, 1
    s_lshl2_add_u32 s66, s51, s66
    s_mul_i32 s66, s66, 66816
    s_lshl2_add_u32 s66, s52, s66
    s_lshl_b32 s86, s65, 10
    s_add_u32 s58, s86, s66
    s_add_u32 s86, s66, 13312
    v_mfma_f32_16x16x32_bf16 v[68:71], a[84:87], v[116:119], v[68:71]
    buffer_load_dwordx4 v[112:115], v23, s[24:27], s58 offen offset:0 sc1
    v_mfma_f32_16x16x32_bf16 v[72:75], a[88:91], v[116:119], v[72:75]
    v_add_f32 v161, v161, v185
    v_add_f32 v162, v162, v186
    v_mfma_f32_16x16x32_bf16 v[76:79], a[92:95], v[116:119], v[76:79]
    v_add_f32 v163, v163, v187
    s_waitcnt vmcnt(10)
    v_mfma_f32_16x16x32_bf16 v[64:67], a[96:99], v[120:123], v[64:67]
    s_add_u32 s58, s58, 1024
    s_cmp_eq_u32 s58, s86
    s_cselect_b32 s58, s66, s58
    v_mfma_f32_16x16x32_bf16 v[68:71], a[100:103], v[120:123], v[68:71]
    buffer_load_dwordx4 v[116:119], v23, s[24:27], s58 offen offset:0 sc1
    v_mfma_f32_16x16x32_bf16 v[72:75], a[104:107], v[120:123], v[72:75]
    v_add_f32 v164, v164, v188
    v_add_f32 v165, v165, v189
    v_mfma_f32_16x16x32_bf16 v[76:79], a[108:111], v[120:123], v[76:79]
    v_add_f32 v166, v166, v190
    s_waitcnt vmcnt(10)
    v_mfma_f32_16x16x32_bf16 v[64:67], a[112:115], v[124:127], v[64:67]
    s_add_u32 s58, s58, 1024
    s_cmp_eq_u32 s58, s86
    s_cselect_b32 s58, s66, s58
    v_mfma_f32_16x16x32_bf16 v[68:71], a[116:119], v[124:127], v[68:71]
    buffer_load_dwordx4 v[120:123], v23, s[24:27], s58 offen offset:0 sc1
    v_mfma_f32_16x16x32_bf16 v[72:75], a[120:123], v[124:127], v[72:75]
    v_add_f32 v167, v167, v191
    v_mul_f32 v192, v160, v160
    v_mfma_f32_16x16x32_bf16 v[76:79], a[124:127], v[124:127], v[76:79]
    v_mul_f32 v193, v161, v161
    s_waitcnt vmcnt(10)
    v_mfma_f32_16x16x32_bf16 v[64:67], a[128:131], v[128:131], v[64:67]
    s_add_u32 s58, s58, 1024
    s_cmp_eq_u32 s58, s86
    s_cselect_b32 s58, s66, s58
    v_mfma_f32_16x16x32_bf16 v[68:71], a[132:135], v[128:131], v[68:71]
    buffer_load_dwordx4 v[124:127], v23, s[24:27], s58 offen offset:0 sc1
    v_mfma_f32_16x16x32_bf16 v[72:75], a[136:139], v[128:131], v[72:75]
    v_mul_f32 v194, v162, v162
    v_mul_f32 v195, v163, v163
    v_mfma_f32_16x16x32_bf16 v[76:79], a[140:143], v[128:131], v[76:79]
    v_mul_f32 v196, v164, v164
    s_waitcnt vmcnt(10)
    v_mfma_f32_16x16x32_bf16 v[64:67], a[144:147], v[132:135], v[64:67]
    s_add_u32 s58, s58, 1024
    s_cmp_eq_u32 s58, s86
    s_cselect_b32 s58, s66, s58
    v_mfma_f32_16x16x32_bf16 v[68:71], a[148:151], v[132:135], v[68:71]
    buffer_load_dwordx4 v[128:131], v23, s[24:27], s58 offen offset:0 sc1
    v_mfma_f32_16x16x32_bf16 v[72:75], a[152:155], v[132:135], v[72:75]
    v_mul_f32 v197, v165, v165
    v_mul_f32 v198, v166, v166
    v_mfma_f32_16x16x32_bf16 v[76:79], a[156:159], v[132:135], v[76:79]
    v_mul_f32 v199, v167, v167
    ds_write_b128 v244, v[216:219]
    s_waitcnt vmcnt(10)
    v_mfma_f32_16x16x32_bf16 v[64:67], a[160:163], v[136:139], v[64:67]
    s_add_u32 s58, s58, 1024
    s_cmp_eq_u32 s58, s86
    s_cselect_b32 s58, s66, s58
    v_mfma_f32_16x16x32_bf16 v[68:71], a[164:167], v[136:139], v[68:71]
    buffer_load_dwordx4 v[132:135], v23, s[24:27], s58 offen offset:0 sc1
    v_mfma_f32_16x16x32_bf16 v[72:75], a[168:171], v[136:139], v[72:75]
    v_fma_f32 v192, v192, v236, v237
    v_fma_f32 v193, v193, v236, v237
    v_mfma_f32_16x16x32_bf16 v[76:79], a[172:175], v[136:139], v[76:79]
    v_fma_f32 v194, v194, v236, v237
    s_waitcnt vmcnt(10)
    v_mfma_f32_16x16x32_bf16 v[64:67], a[176:179], v[140:143], v[64:67]
    s_add_u32 s58, s58, 1024
    s_cmp_eq_u32 s58, s86
    s_cselect_b32 s58, s66, s58
    v_mfma_f32_16x16x32_bf16 v[68:71], a[180:183], v[140:143], v[68:71]
    buffer_load_dwordx4 v[136:139], v23, s[24:27], s58 offen offset:0 sc1
    v_mfma_f32_16x16x32_bf16 v[72:75], a[184:187], v[140:143], v[72:75]
    v_fma_f32 v195, v195, v236, v237
    v_fma_f32 v196, v196, v236, v237
    v_mfma_f32_16x16x32_bf16 v[76:79], a[188:191], v[140:143], v[76:79]
    v_fma_f32 v197, v197, v236, v237
    ds_write_b128 v244, v[220:223] offset:1408
    s_waitcnt vmcnt(10)
    v_mfma_f32_16x16x32_bf16 v[64:67], a[192:195], v[144:147], v[64:67]
    s_add_u32 s58, s58, 1024
    s_cmp_eq_u32 s58, s86
    s_cselect_b32 s58, s66, s58
    v_mfma_f32_16x16x32_bf16 v[68:71], a[196:199], v[144:147], v[68:71]
    buffer_load_dwordx4 v[140:143], v23, s[24:27], s58 offen offset:0 sc1
    v_mfma_f32_16x16x32_bf16 v[72:75], a[200:203], v[144:147], v[72:75]
    v_fma_f32 v198, v198, v236, v237
    v_fma_f32 v199, v199, v236, v237
    v_mfma_f32_16x16x32_bf16 v[76:79], a[204:207], v[144:147], v[76:79]
    v_mul_f32 v192, v192, v160
    s_waitcnt vmcnt(10)
    v_mfma_f32_16x16x32_bf16 v[64:67], a[208:211], v[148:151], v[64:67]
    s_add_u32 s58, s58, 1024
    s_cmp_eq_u32 s58, s86
    s_cselect_b32 s58, s66, s58
    v_mfma_f32_16x16x32_bf16 v[68:71], a[212:215], v[148:151], v[68:71]
    buffer_load_dwordx4 v[144:147], v23, s[24:27], s58 offen offset:0 sc1
    v_mfma_f32_16x16x32_bf16 v[72:75], a[216:219], v[148:151], v[72:75]
    v_mul_f32 v193, v193, v161
    v_mul_f32 v194, v194, v162
    v_mfma_f32_16x16x32_bf16 v[76:79], a[220:223], v[148:151], v[76:79]
    v_mul_f32 v195, v195, v163
    ds_write_b64 v252, v[224:225] offset:128
    s_waitcnt vmcnt(10)
    v_mfma_f32_16x16x32_bf16 v[64:67], a[224:227], v[152:155], v[64:67]
    s_add_u32 s58, s58, 1024
    s_cmp_eq_u32 s58, s86
    s_cselect_b32 s58, s66, s58
    v_mfma_f32_16x16x32_bf16 v[68:71], a[228:231], v[152:155], v[68:71]
    buffer_load_dwordx4 v[148:151], v23, s[24:27], s58 offen offset:0 sc1
    v_mfma_f32_16x16x32_bf16 v[72:75], a[232:235], v[152:155], v[72:75]
    v_mul_f32 v196, v196, v164
    v_mul_f32 v197, v197, v165
    v_mfma_f32_16x16x32_bf16 v[76:79], a[236:239], v[152:155], v[76:79]
    v_mul_f32 v198, v198, v166
    s_waitcnt vmcnt(10)
    v_mfma_f32_16x16x32_bf16 v[64:67], a[240:243], v[156:159], v[64:67]
    s_add_u32 s58, s58, 1024
    s_cmp_eq_u32 s58, s86
    s_cselect_b32 s58, s66, s58
    v_mfma_f32_16x16x32_bf16 v[68:71], a[244:247], v[156:159], v[68:71]
    buffer_load_dwordx4 v[152:155], v23, s[24:27], s58 offen offset:0 sc1
    v_mfma_f32_16x16x32_bf16 v[72:75], a[248:251], v[156:159], v[72:75]
    v_mul_f32 v199, v199, v167
    v_mfma_f32_16x16x32_bf16 v[76:79], a[252:255], v[156:159], v[76:79]
    ds_read_b64 v[216:217], v238 offset:0
    ds_read_b64 v[218:219], v238 offset:32
    ds_read_b64 v[220:221], v238 offset:64
    ds_read_b64 v[222:223], v238 offset:96
    ds_read_b64 v[224:225], v238 offset:128
    s_waitcnt vmcnt(10)
    v_mfma_f32_16x16x32_bf16 v[48:51], a[0:3], v[112:115], 0
    s_add_u32 s58, s58, 1024
    s_cmp_eq_u32 s58, s86
    s_cselect_b32 s58, s66, s58
    v_mfma_f32_16x16x32_bf16 v[52:55], a[4:7], v[112:115], 0
    buffer_load_dwordx4 v[156:159], v23, s[24:27], s58 offen offset:0 sc1
    v_mfma_f32_16x16x32_bf16 v[56:59], a[8:11], v[112:115], 0
    v_mfma_f32_16x16x32_bf16 v[60:63], a[12:15], v[112:115], 0
    s_waitcnt vmcnt(10)
    v_mfma_f32_16x16x32_bf16 v[48:51], a[16:19], v[116:119], v[48:51]
    s_add_u32 s58, s58, 1024
    s_cmp_eq_u32 s58, s86
    s_cselect_b32 s58, s66, s58
    v_mfma_f32_16x16x32_bf16 v[52:55], a[20:23], v[116:119], v[52:55]
    buffer_load_dwordx4 v[112:115], v23, s[24:27], s58 offen offset:0 sc1
    v_mfma_f32_16x16x32_bf16 v[56:59], a[24:27], v[116:119], v[56:59]
    ds_write_b128 v232, v[64:67] offset:16384
    v_mfma_f32_16x16x32_bf16 v[60:63], a[28:31], v[116:119], v[60:63]
    s_waitcnt vmcnt(10)
    v_mfma_f32_16x16x32_bf16 v[48:51], a[32:35], v[120:123], v[48:51]
    s_add_u32 s58, s66, 13312
    v_mfma_f32_16x16x32_bf16 v[52:55], a[36:39], v[120:123], v[52:55]
    buffer_load_dwordx4 v[116:119], v23, s[24:27], s58 offen offset:0 sc1
    v_mfma_f32_16x16x32_bf16 v[56:59], a[40:43], v[120:123], v[56:59]
    ds_write_b128 v232, v[68:71] offset:17408
    v_mfma_f32_16x16x32_bf16 v[60:63], a[44:47], v[120:123], v[60:63]
    s_waitcnt vmcnt(10)
    v_mfma_f32_16x16x32_bf16 v[48:51], a[48:51], v[124:127], v[48:51]
    s_add_u32 s58, s66, 14336
    ds_write_b128 v232, v[72:75] offset:18432
    v_mfma_f32_16x16x32_bf16 v[52:55], a[52:55], v[124:127], v[52:55]
    buffer_load_dwordx4 v[120:123], v23, s[24:27], s58 offen offset:0 sc1
    v_mfma_f32_16x16x32_bf16 v[56:59], a[56:59], v[124:127], v[56:59]
    v_exp_f32 v192, v192
    v_exp_f32 v193, v193
    v_mfma_f32_16x16x32_bf16 v[60:63], a[60:63], v[124:127], v[60:63]
    v_exp_f32 v194, v194
    s_waitcnt vmcnt(10)
    v_mfma_f32_16x16x32_bf16 v[48:51], a[64:67], v[128:131], v[48:51]
    s_add_u32 s58, s66, 15360
    ds_write_b128 v232, v[76:79] offset:19456
    v_mfma_f32_16x16x32_bf16 v[52:55], a[68:71], v[128:131], v[52:55]
    buffer_load_dwordx4 v[124:127], v23, s[24:27], s58 offen offset:0 sc1
    v_mfma_f32_16x16x32_bf16 v[56:59], a[72:75], v[128:131], v[56:59]
    v_exp_f32 v195, v195
    v_exp_f32 v196, v196
    v_mfma_f32_16x16x32_bf16 v[60:63], a[76:79], v[128:131], v[60:63]
    v_exp_f32 v197, v197
    s_waitcnt vmcnt(10)
    v_mfma_f32_16x16x32_bf16 v[48:51], a[80:83], v[132:135], v[48:51]
    s_xor_b32 s66, s44, 0
    s_lshl2_add_u32 s66, s51, s66
    s_mul_i32 s66, s66, 66816
    s_lshl2_add_u32 s66, s52, s66
    s_lshl_b32 s86, s65, 10
    s_add_u32 s58, s86, s66
    s_add_u32 s86, s66, 13312
    v_mfma_f32_16x16x32_bf16 v[52:55], a[84:87], v[132:135], v[52:55]
    buffer_load_dwordx4 v[128:131], v23, s[24:27], s58 offen offset:0 sc1
    v_mfma_f32_16x16x32_bf16 v[56:59], a[88:91], v[132:135], v[56:59]
    v_exp_f32 v198, v198
    v_exp_f32 v199, v199
    v_mfma_f32_16x16x32_bf16 v[60:63], a[92:95], v[132:135], v[60:63]
    v_add_f32 v192, 1.0, v192
    s_waitcnt vmcnt(10)
    v_mfma_f32_16x16x32_bf16 v[48:51], a[96:99], v[136:139], v[48:51]
    s_add_u32 s58, s58, 1024
    s_cmp_eq_u32 s58, s86
    s_cselect_b32 s58, s66, s58
    v_mfma_f32_16x16x32_bf16 v[52:55], a[100:103], v[136:139], v[52:55]
    buffer_load_dwordx4 v[132:135], v23, s[24:27], s58 offen offset:0 sc1
    v_mfma_f32_16x16x32_bf16 v[56:59], a[104:107], v[136:139], v[56:59]
    v_add_f32 v193, 1.0, v193
    v_add_f32 v194, 1.0, v194
    v_mfma_f32_16x16x32_bf16 v[60:63], a[108:111], v[136:139], v[60:63]
    v_add_f32 v195, 1.0, v195
    s_waitcnt vmcnt(10)
    v_mfma_f32_16x16x32_bf16 v[48:51], a[112:115], v[140:143], v[48:51]
    s_add_u32 s58, s58, 1024
    s_cmp_eq_u32 s58, s86
    s_cselect_b32 s58, s66, s58
    v_mfma_f32_16x16x32_bf16 v[52:55], a[116:119], v[140:143], v[52:55]
    buffer_load_dwordx4 v[136:139], v23, s[24:27], s58 offen offset:0 sc1
    v_mfma_f32_16x16x32_bf16 v[56:59], a[120:123], v[140:143], v[56:59]
    v_add_f32 v196, 1.0, v196
    v_add_f32 v197, 1.0, v197
    v_mfma_f32_16x16x32_bf16 v[60:63], a[124:127], v[140:143], v[60:63]
    v_add_f32 v198, 1.0, v198
    s_waitcnt vmcnt(10)
    v_mfma_f32_16x16x32_bf16 v[48:51], a[128:131], v[144:147], v[48:51]
    s_add_u32 s58, s58, 1024
    s_cmp_eq_u32 s58, s86
    s_cselect_b32 s58, s66, s58
    v_mfma_f32_16x16x32_bf16 v[52:55], a[132:135], v[144:147], v[52:55]
    buffer_load_dwordx4 v[140:143], v23, s[24:27], s58 offen offset:0 sc1
    v_mfma_f32_16x16x32_bf16 v[56:59], a[136:139], v[144:147], v[56:59]
    v_add_f32 v199, 1.0, v199
    v_rcp_f32 v192, v192
    v_mfma_f32_16x16x32_bf16 v[60:63], a[140:143], v[144:147], v[60:63]
    v_rcp_f32 v193, v193
    s_waitcnt vmcnt(10)
    v_mfma_f32_16x16x32_bf16 v[48:51], a[144:147], v[148:151], v[48:51]
    s_add_u32 s58, s58, 1024
    s_cmp_eq_u32 s58, s86
    s_cselect_b32 s58, s66, s58
    v_mfma_f32_16x16x32_bf16 v[52:55], a[148:151], v[148:151], v[52:55]
    buffer_load_dwordx4 v[144:147], v23, s[24:27], s58 offen offset:0 sc1
    v_mfma_f32_16x16x32_bf16 v[56:59], a[152:155], v[148:151], v[56:59]
    v_rcp_f32 v194, v194
    v_rcp_f32 v195, v195
    v_mfma_f32_16x16x32_bf16 v[60:63], a[156:159], v[148:151], v[60:63]
    v_rcp_f32 v196, v196
    s_waitcnt vmcnt(10)
    v_mfma_f32_16x16x32_bf16 v[48:51], a[160:163], v[152:155], v[48:51]
    s_add_u32 s58, s58, 1024
    s_cmp_eq_u32 s58, s86
    s_cselect_b32 s58, s66, s58
    v_mfma_f32_16x16x32_bf16 v[52:55], a[164:167], v[152:155], v[52:55]
    buffer_load_dwordx4 v[148:151], v23, s[24:27], s58 offen offset:0 sc1
    v_mfma_f32_16x16x32_bf16 v[56:59], a[168:171], v[152:155], v[56:59]
    v_rcp_f32 v197, v197
    v_rcp_f32 v198, v198
    v_mfma_f32_16x16x32_bf16 v[60:63], a[172:175], v[152:155], v[60:63]
    v_rcp_f32 v199, v199
    s_waitcnt vmcnt(10)
    v_mfma_f32_16x16x32_bf16 v[48:51], a[176:179], v[156:159], v[48:51]
    s_add_u32 s58, s58, 1024
    s_cmp_eq_u32 s58, s86
    s_cselect_b32 s58, s66, s58
    v_mfma_f32_16x16x32_bf16 v[52:55], a[180:183], v[156:159], v[52:55]
    buffer_load_dwordx4 v[152:155], v23, s[24:27], s58 offen offset:0 sc1
    v_mfma_f32_16x16x32_bf16 v[56:59], a[184:187], v[156:159], v[56:59]
    v_mul_f32 v192, v192, v160
    v_mul_f32 v193, v193, v161
    v_mfma_f32_16x16x32_bf16 v[60:63], a[188:191], v[156:159], v[60:63]
    v_mul_f32 v194, v194, v162
    s_waitcnt vmcnt(10)
    v_mfma_f32_16x16x32_bf16 v[48:51], a[192:195], v[112:115], v[48:51]
    s_add_u32 s58, s58, 1024
    s_cmp_eq_u32 s58, s86
    s_cselect_b32 s58, s66, s58
    v_mfma_f32_16x16x32_bf16 v[52:55], a[196:199], v[112:115], v[52:55]
    buffer_load_dwordx4 v[156:159], v23, s[24:27], s58 offen offset:0 sc1
    v_mfma_f32_16x16x32_bf16 v[56:59], a[200:203], v[112:115], v[56:59]
    v_mul_f32 v195, v195, v163
    v_mul_f32 v196, v196, v164
    v_mfma_f32_16x16x32_bf16 v[60:63], a[204:207], v[112:115], v[60:63]
    v_mul_f32 v197, v197, v165
    s_waitcnt vmcnt(10)
    v_mfma_f32_16x16x32_bf16 v[48:51], a[208:211], v[116:119], v[48:51]
    s_add_u32 s58, s58, 1024
    s_cmp_eq_u32 s58, s86
    s_cselect_b32 s58, s66, s58
    v_mfma_f32_16x16x32_bf16 v[52:55], a[212:215], v[116:119], v[52:55]
    buffer_load_dwordx4 v[112:115], v23, s[24:27], s58 offen offset:0 sc1
    v_mfma_f32_16x16x32_bf16 v[56:59], a[216:219], v[116:119], v[56:59]
    v_mul_f32 v198, v198, v166
    v_mul_f32 v199, v199, v167
    v_mfma_f32_16x16x32_bf16 v[60:63], a[220:223], v[116:119], v[60:63]
    v_cvt_pk_bf16_f32 v96, v192, v193
    s_waitcnt vmcnt(10)
    v_mfma_f32_16x16x32_bf16 v[48:51], a[224:227], v[120:123], v[48:51]
    s_add_u32 s58, s58, 1024
    s_cmp_eq_u32 s58, s86
    s_cselect_b32 s58, s66, s58
    v_mfma_f32_16x16x32_bf16 v[52:55], a[228:231], v[120:123], v[52:55]
    buffer_load_dwordx4 v[116:119], v23, s[24:27], s58 offen offset:0 sc1
    v_mfma_f32_16x16x32_bf16 v[56:59], a[232:235], v[120:123], v[56:59]
    v_cvt_pk_bf16_f32 v97, v194, v195
    v_cvt_pk_bf16_f32 v98, v196, v197
    v_mfma_f32_16x16x32_bf16 v[60:63], a[236:239], v[120:123], v[60:63]
    v_cvt_pk_bf16_f32 v99, v198, v199
    s_waitcnt vmcnt(10)
    v_mfma_f32_16x16x32_bf16 v[48:51], a[240:243], v[124:127], v[48:51]
    s_add_u32 s58, s58, 1024
    s_cmp_eq_u32 s58, s86
    s_cselect_b32 s58, s66, s58
    v_mfma_f32_16x16x32_bf16 v[52:55], a[244:247], v[124:127], v[52:55]
    buffer_load_dwordx4 v[120:123], v23, s[24:27], s58 offen offset:0 sc1
    v_mfma_f32_16x16x32_bf16 v[56:59], a[248:251], v[124:127], v[56:59]
    v_mfma_f32_16x16x32_bf16 v[60:63], a[252:255], v[124:127], v[60:63]
    s_waitcnt vmcnt(10)
    v_mfma_f32_16x16x32_bf16 v[32:35], a[0:3], v[128:131], v[32:35]
    s_add_u32 s58, s58, 1024
    s_cmp_eq_u32 s58, s86
    s_cselect_b32 s58, s66, s58
    v_mfma_f32_16x16x32_bf16 v[36:39], a[4:7], v[128:131], v[36:39]
    buffer_load_dwordx4 v[124:127], v23, s[24:27], s58 offen offset:0 sc1
    v_mfma_f32_16x16x32_bf16 v[40:43], a[8:11], v[128:131], v[40:43]
    v_mfma_f32_16x16x32_bf16 v[44:47], a[12:15], v[128:131], v[44:47]
    s_waitcnt vmcnt(10)
    v_mfma_f32_16x16x32_bf16 v[32:35], a[16:19], v[132:135], v[32:35]
    s_add_u32 s58, s58, 1024
    s_cmp_eq_u32 s58, s86
    s_cselect_b32 s58, s66, s58
    v_mfma_f32_16x16x32_bf16 v[36:39], a[20:23], v[132:135], v[36:39]
    buffer_load_dwordx4 v[128:131], v23, s[24:27], s58 offen offset:0 sc1
    v_mfma_f32_16x16x32_bf16 v[40:43], a[24:27], v[132:135], v[40:43]
    ds_write_b128 v232, v[48:51] offset:0
    v_mfma_f32_16x16x32_bf16 v[44:47], a[28:31], v[132:135], v[44:47]
    ds_write_b128 v232, v[52:55] offset:1024
    s_waitcnt vmcnt(10)
    v_mfma_f32_16x16x32_bf16 v[32:35], a[32:35], v[136:139], v[32:35]
    s_add_u32 s58, s66, 13312
    v_mfma_f32_16x16x32_bf16 v[36:39], a[36:39], v[136:139], v[36:39]
    buffer_load_dwordx4 v[132:135], v23, s[24:27], s58 offen offset:0 sc1
    v_mfma_f32_16x16x32_bf16 v[40:43], a[40:43], v[136:139], v[40:43]
    ds_write_b128 v232, v[56:59] offset:2048
    v_mfma_f32_16x16x32_bf16 v[44:47], a[44:47], v[136:139], v[44:47]
    ds_write_b128 v232, v[60:63] offset:3072
    s_waitcnt vmcnt(10)
    v_mfma_f32_16x16x32_bf16 v[32:35], a[48:51], v[140:143], v[32:35]
    s_add_u32 s58, s66, 14336
    v_mfma_f32_16x16x32_bf16 v[36:39], a[52:55], v[140:143], v[36:39]
    buffer_load_dwordx4 v[136:139], v23, s[24:27], s58 offen offset:0 sc1
    v_mfma_f32_16x16x32_bf16 v[40:43], a[56:59], v[140:143], v[40:43]
    v_mfma_f32_16x16x32_bf16 v[44:47], a[60:63], v[140:143], v[44:47]
    s_waitcnt vmcnt(10)
    v_mfma_f32_16x16x32_bf16 v[32:35], a[64:67], v[144:147], v[32:35]
    s_add_u32 s58, s66, 15360
    v_mfma_f32_16x16x32_bf16 v[36:39], a[68:71], v[144:147], v[36:39]
    buffer_load_dwordx4 v[140:143], v23, s[24:27], s58 offen offset:0 sc1
    v_mfma_f32_16x16x32_bf16 v[40:43], a[72:75], v[144:147], v[40:43]
    v_mfma_f32_16x16x32_bf16 v[44:47], a[76:79], v[144:147], v[44:47]
    s_add_u32 m0, s52, 81920
    s_lshl_b32 s57, s76, 7
    buffer_load_dwordx4 v12, s[20:23], s57 offen offset:0 lds
    s_waitcnt vmcnt(11)
    v_mfma_f32_16x16x32_bf16 v[32:35], a[80:83], v[148:151], v[32:35]
    s_waitcnt lgkmcnt(0)
    s_barrier
    v_mfma_f32_16x16x32_bf16 v[36:39], a[84:87], v[148:151], v[36:39]
    v_mfma_f32_16x16x32_bf16 v[40:43], a[88:91], v[148:151], v[40:43]
    v_mfma_f32_16x16x32_bf16 v[44:47], a[92:95], v[148:151], v[44:47]
    s_add_u32 s57, s57, 31744
    buffer_load_dwordx4 v12, s[20:23], s57 offen offset:1024 lds
    s_waitcnt vmcnt(11)
    v_mfma_f32_16x16x32_bf16 v[32:35], a[96:99], v[152:155], v[32:35]
    ds_read_b128 v[160:163], v233 offset:0
    v_mfma_f32_16x16x32_bf16 v[36:39], a[100:103], v[152:155], v[36:39]
    ds_read_b128 v[176:179], v234 offset:16384
    v_mfma_f32_16x16x32_bf16 v[40:43], a[104:107], v[152:155], v[40:43]
    ds_read_b128 v[192:195], v235 offset:32768
    v_mfma_f32_16x16x32_bf16 v[44:47], a[108:111], v[152:155], v[44:47]
    s_add_u32 s57, s57, 31744
    buffer_load_dwordx4 v12, s[20:23], s57 offen offset:2048 lds
    s_waitcnt vmcnt(11)
    v_mfma_f32_16x16x32_bf16 v[32:35], a[112:115], v[156:159], v[32:35]
    ds_read_b128 v[164:167], v233 offset:1024
    v_mfma_f32_16x16x32_bf16 v[36:39], a[116:119], v[156:159], v[36:39]
    ds_read_b128 v[180:183], v234 offset:17408
    v_mfma_f32_16x16x32_bf16 v[40:43], a[120:123], v[156:159], v[40:43]
    ds_read_b128 v[196:199], v235 offset:33792
    v_mfma_f32_16x16x32_bf16 v[44:47], a[124:127], v[156:159], v[44:47]
    s_add_u32 s57, s57, 31744
    buffer_load_dwordx4 v12, s[20:23], s57 offen offset:3072 lds
    s_waitcnt vmcnt(11)
    v_mfma_f32_16x16x32_bf16 v[32:35], a[128:131], v[112:115], v[32:35]
    ds_read_b128 v[168:171], v233 offset:2048
    v_mfma_f32_16x16x32_bf16 v[36:39], a[132:135], v[112:115], v[36:39]
    ds_read_b128 v[184:187], v234 offset:18432
    v_mfma_f32_16x16x32_bf16 v[40:43], a[136:139], v[112:115], v[40:43]
    ds_read_b128 v[200:203], v235 offset:34816
    v_mfma_f32_16x16x32_bf16 v[44:47], a[140:143], v[112:115], v[44:47]
    s_add_u32 m0, s52, 98304
    s_lshl_b32 s57, s76, 7
    s_add_u32 s57, s57, 131072
    buffer_load_dwordx4 v12, s[20:23], s57 offen offset:0 lds
    s_waitcnt vmcnt(11)
    v_mfma_f32_16x16x32_bf16 v[32:35], a[144:147], v[116:119], v[32:35]
    ds_read_b128 v[172:175], v233 offset:3072
    v_mfma_f32_16x16x32_bf16 v[36:39], a[148:151], v[116:119], v[36:39]
    ds_read_b128 v[188:191], v234 offset:19456
    v_mfma_f32_16x16x32_bf16 v[40:43], a[152:155], v[116:119], v[40:43]
    ds_read_b128 v[204:207], v235 offset:35840
    v_mfma_f32_16x16x32_bf16 v[44:47], a[156:159], v[116:119], v[44:47]
    s_add_u32 s57, s57, 31744
    buffer_load_dwordx4 v12, s[20:23], s57 offen offset:1024 lds
    s_waitcnt vmcnt(11)
    v_mfma_f32_16x16x32_bf16 v[32:35], a[160:163], v[120:123], v[32:35]
    v_mfma_f32_16x16x32_bf16 v[36:39], a[164:167], v[120:123], v[36:39]
    v_mfma_f32_16x16x32_bf16 v[40:43], a[168:171], v[120:123], v[40:43]
    v_mfma_f32_16x16x32_bf16 v[44:47], a[172:175], v[120:123], v[44:47]
    s_add_u32 s57, s57, 31744
    buffer_load_dwordx4 v12, s[20:23], s57 offen offset:2048 lds
    s_waitcnt vmcnt(11)
    v_mfma_f32_16x16x32_bf16 v[32:35], a[176:179], v[124:127], v[32:35]
    s_waitcnt lgkmcnt(9)
    v_mfma_f32_16x16x32_bf16 v[36:39], a[180:183], v[124:127], v[36:39]
    v_add_f32 v160, v160, v176
    v_mfma_f32_16x16x32_bf16 v[40:43], a[184:187], v[124:127], v[40:43]
    v_add_f32 v161, v161, v177
    v_mfma_f32_16x16x32_bf16 v[44:47], a[188:191], v[124:127], v[44:47]
    v_add_f32 v162, v162, v178
    s_add_u32 s57, s57, 31744
    buffer_load_dwordx4 v12, s[20:23], s57 offen offset:3072 lds
    s_waitcnt vmcnt(11)
    v_mfma_f32_16x16x32_bf16 v[32:35], a[192:195], v[128:131], v[32:35]
    v_add_f32 v163, v163, v179
    v_mfma_f32_16x16x32_bf16 v[36:39], a[196:199], v[128:131], v[36:39]
    s_waitcnt lgkmcnt(6)
    v_mfma_f32_16x16x32_bf16 v[40:43], a[200:203], v[128:131], v[40:43]
    v_add_f32 v164, v164, v180
    v_mfma_f32_16x16x32_bf16 v[44:47], a[204:207], v[128:131], v[44:47]
    v_add_f32 v165, v165, v181
    s_add_u32 m0, s52, 114688
    s_lshl_b32 s57, s77, 7
    buffer_load_dwordx4 v12, s[20:23], s57 offen offset:0 lds
    s_waitcnt vmcnt(11)
    v_mfma_f32_16x16x32_bf16 v[32:35], a[208:211], v[132:135], v[32:35]
    v_add_f32 v166, v166, v182
    v_mfma_f32_16x16x32_bf16 v[36:39], a[212:215], v[132:135], v[36:39]
    v_add_f32 v167, v167, v183
    v_mfma_f32_16x16x32_bf16 v[40:43], a[216:219], v[132:135], v[40:43]
    s_waitcnt lgkmcnt(3)
    v_mfma_f32_16x16x32_bf16 v[44:47], a[220:223], v[132:135], v[44:47]
    v_add_f32 v168, v168, v184
    s_add_u32 s57, s57, 31744
    buffer_load_dwordx4 v12, s[20:23], s57 offen offset:1024 lds
    s_waitcnt vmcnt(11)
    v_mfma_f32_16x16x32_bf16 v[32:35], a[224:227], v[136:139], v[32:35]
    v_add_f32 v169, v169, v185
    v_mfma_f32_16x16x32_bf16 v[36:39], a[228:231], v[136:139], v[36:39]
    v_add_f32 v170, v170, v186
    v_mfma_f32_16x16x32_bf16 v[40:43], a[232:235], v[136:139], v[40:43]
    v_add_f32 v171, v171, v187
    v_mfma_f32_16x16x32_bf16 v[44:47], a[236:239], v[136:139], v[44:47]
    s_waitcnt lgkmcnt(0)
    s_add_u32 s57, s57, 31744
    buffer_load_dwordx4 v12, s[20:23], s57 offen offset:2048 lds
    s_waitcnt vmcnt(11)
    v_mfma_f32_16x16x32_bf16 v[32:35], a[240:243], v[140:143], v[32:35]
    v_add_f32 v172, v172, v188
    v_mfma_f32_16x16x32_bf16 v[36:39], a[244:247], v[140:143], v[36:39]
    v_add_f32 v173, v173, v189
    v_mfma_f32_16x16x32_bf16 v[40:43], a[248:251], v[140:143], v[40:43]
    v_add_f32 v174, v174, v190
    v_mfma_f32_16x16x32_bf16 v[44:47], a[252:255], v[140:143], v[44:47]
    v_add_f32 v175, v175, v191
    v_pk_add_f32 v[160:161], v[160:161], v[192:193]
    v_pk_add_f32 v[162:163], v[162:163], v[194:195]
    v_pk_add_f32 v[164:165], v[164:165], v[196:197]
    v_pk_add_f32 v[166:167], v[166:167], v[198:199]
    v_pk_add_f32 v[168:169], v[168:169], v[200:201]
    v_pk_add_f32 v[170:171], v[170:171], v[202:203]
    v_pk_add_f32 v[172:173], v[172:173], v[204:205]
    v_pk_add_f32 v[174:175], v[174:175], v[206:207]
    buffer_store_dwordx4 v[96:99], v23, s[24:27], s83 offen sc1
    s_add_u32 s57, s57, 31744
    buffer_load_dwordx4 v12, s[20:23], s57 offen offset:3072 lds
    v_pk_add_f32 v[32:33], v[32:33], v[160:161]
    v_pk_add_f32 v[34:35], v[34:35], v[162:163]
    v_pk_add_f32 v[36:37], v[36:37], v[164:165]
    v_pk_add_f32 v[38:39], v[38:39], v[166:167]
    v_pk_mul_f32 v[48:49], v[32:33], v[32:33]
    v_pk_mul_f32 v[50:51], v[34:35], v[34:35]
    v_pk_mul_f32 v[52:53], v[36:37], v[36:37]
    v_pk_mul_f32 v[54:55], v[38:39], v[38:39]
    s_add_u32 m0, s52, 131072
    s_lshl_b32 s57, s77, 7
    s_add_u32 s57, s57, 131072
    buffer_load_dwordx4 v12, s[20:23], s57 offen offset:0 lds
    v_pk_fma_f32 v[48:49], v[48:49], v[236:237], v[236:237] op_sel:[0,0,1] op_sel_hi:[1,0,1]
    v_pk_fma_f32 v[50:51], v[50:51], v[236:237], v[236:237] op_sel:[0,0,1] op_sel_hi:[1,0,1]
    v_pk_fma_f32 v[52:53], v[52:53], v[236:237], v[236:237] op_sel:[0,0,1] op_sel_hi:[1,0,1]
    v_pk_fma_f32 v[54:55], v[54:55], v[236:237], v[236:237] op_sel:[0,0,1] op_sel_hi:[1,0,1]
    v_pk_mul_f32 v[48:49], v[48:49], v[32:33]
    v_pk_mul_f32 v[50:51], v[50:51], v[34:35]
    v_pk_mul_f32 v[52:53], v[52:53], v[36:37]
    v_pk_mul_f32 v[54:55], v[54:55], v[38:39]
    s_add_u32 s57, s57, 31744
    buffer_load_dwordx4 v12, s[20:23], s57 offen offset:1024 lds
    s_waitcnt vmcnt(11)
    ds_read_b64_tr_b16 a[0:1], v6 offset:32768
    ds_read_b64_tr_b16 a[2:3], v6 offset:34816
    ds_read_b64_tr_b16 a[4:5], v7 offset:32768
    ds_read_b64_tr_b16 a[6:7], v7 offset:34816
    v_exp_f32 v48, v48
    v_exp_f32 v49, v49
    v_exp_f32 v50, v50
    v_exp_f32 v51, v51
    ds_read_b64_tr_b16 a[8:9], v6 offset:33024
    ds_read_b64_tr_b16 a[10:11], v6 offset:35072
    ds_read_b64_tr_b16 a[12:13], v7 offset:33024
    ds_read_b64_tr_b16 a[14:15], v7 offset:35072
    s_add_u32 s57, s57, 31744
    buffer_load_dwordx4 v12, s[20:23], s57 offen offset:2048 lds
    v_exp_f32 v52, v52
    v_exp_f32 v53, v53
    v_exp_f32 v54, v54
    v_exp_f32 v55, v55
    v_pk_add_f32 v[48:49], v[48:49], 1.0 op_sel_hi:[1,0]
    v_pk_add_f32 v[50:51], v[50:51], 1.0 op_sel_hi:[1,0]
    v_pk_add_f32 v[52:53], v[52:53], 1.0 op_sel_hi:[1,0]
    v_pk_add_f32 v[54:55], v[54:55], 1.0 op_sel_hi:[1,0]
    s_add_u32 s57, s57, 31744
    buffer_load_dwordx4 v12, s[20:23], s57 offen offset:3072 lds
    v_rcp_f32 v48, v48
    v_rcp_f32 v49, v49
    v_rcp_f32 v50, v50
    v_rcp_f32 v51, v51
    v_rcp_f32 v52, v52
    v_rcp_f32 v53, v53
    v_rcp_f32 v54, v54
    v_rcp_f32 v55, v55
    v_pk_mul_f32 v[48:49], v[48:49], v[32:33]
    v_pk_mul_f32 v[50:51], v[50:51], v[34:35]
    v_pk_mul_f32 v[52:53], v[52:53], v[36:37]
    v_pk_mul_f32 v[54:55], v[54:55], v[38:39]
    s_add_u32 m0, s52, 147456
    s_lshl_b32 s57, s78, 7
    buffer_load_dwordx4 v12, s[20:23], s57 offen offset:0 lds
    v_cvt_pk_bf16_f32 v56, v48, v49
    v_cvt_pk_bf16_f32 v57, v50, v51
    v_cvt_pk_bf16_f32 v58, v52, v53
    v_cvt_pk_bf16_f32 v59, v54, v55
    buffer_store_dwordx4 v[56:59], v23, s[24:27], s67 offen offset:0 sc1
    v_pk_add_f32 v[40:41], v[40:41], v[168:169]
    v_pk_add_f32 v[42:43], v[42:43], v[170:171]
    v_pk_add_f32 v[44:45], v[44:45], v[172:173]
    v_pk_add_f32 v[46:47], v[46:47], v[174:175]
    s_add_u32 s57, s57, 31744
    buffer_load_dwordx4 v12, s[20:23], s57 offen offset:1024 lds
    s_waitcnt vmcnt(12)
    ds_read_b64_tr_b16 a[16:17], v6 offset:49152
    ds_read_b64_tr_b16 a[18:19], v6 offset:51200
    ds_read_b64_tr_b16 a[20:21], v7 offset:49152
    ds_read_b64_tr_b16 a[22:23], v7 offset:51200
    v_pk_mul_f32 v[48:49], v[40:41], v[40:41]
    v_pk_mul_f32 v[50:51], v[42:43], v[42:43]
    v_pk_mul_f32 v[52:53], v[44:45], v[44:45]
    v_pk_mul_f32 v[54:55], v[46:47], v[46:47]
    ds_read_b64_tr_b16 a[24:25], v6 offset:49408
    ds_read_b64_tr_b16 a[26:27], v6 offset:51456
    ds_read_b64_tr_b16 a[28:29], v7 offset:49408
    ds_read_b64_tr_b16 a[30:31], v7 offset:51456
    s_add_u32 s57, s57, 31744
    buffer_load_dwordx4 v12, s[20:23], s57 offen offset:2048 lds
    v_pk_fma_f32 v[48:49], v[48:49], v[236:237], v[236:237] op_sel:[0,0,1] op_sel_hi:[1,0,1]
    v_pk_fma_f32 v[50:51], v[50:51], v[236:237], v[236:237] op_sel:[0,0,1] op_sel_hi:[1,0,1]
    v_pk_fma_f32 v[52:53], v[52:53], v[236:237], v[236:237] op_sel:[0,0,1] op_sel_hi:[1,0,1]
    v_pk_fma_f32 v[54:55], v[54:55], v[236:237], v[236:237] op_sel:[0,0,1] op_sel_hi:[1,0,1]
    v_pk_mul_f32 v[48:49], v[48:49], v[40:41]
    v_pk_mul_f32 v[50:51], v[50:51], v[42:43]
    v_pk_mul_f32 v[52:53], v[52:53], v[44:45]
    v_pk_mul_f32 v[54:55], v[54:55], v[46:47]
    s_add_u32 s57, s57, 31744
    buffer_load_dwordx4 v12, s[20:23], s57 offen offset:3072 lds
    v_exp_f32 v48, v48
    v_exp_f32 v49, v49
    v_exp_f32 v50, v50
    v_exp_f32 v51, v51
    v_exp_f32 v52, v52
    v_exp_f32 v53, v53
    v_exp_f32 v54, v54
    v_exp_f32 v55, v55
    v_pk_add_f32 v[48:49], v[48:49], 1.0 op_sel_hi:[1,0]
    v_pk_add_f32 v[50:51], v[50:51], 1.0 op_sel_hi:[1,0]
    v_pk_add_f32 v[52:53], v[52:53], 1.0 op_sel_hi:[1,0]
    v_pk_add_f32 v[54:55], v[54:55], 1.0 op_sel_hi:[1,0]
    s_add_u32 m0, s52, 49152
    s_lshl_b32 s57, s78, 7
    s_add_u32 s57, s57, 131072
    buffer_load_dwordx4 v12, s[20:23], s57 offen offset:0 lds
    v_rcp_f32 v48, v48
    v_rcp_f32 v49, v49
    v_rcp_f32 v50, v50
    v_rcp_f32 v51, v51
    v_rcp_f32 v52, v52
    v_rcp_f32 v53, v53
    v_rcp_f32 v54, v54
    v_rcp_f32 v55, v55
    s_add_u32 s57, s57, 31744
    buffer_load_dwordx4 v12, s[20:23], s57 offen offset:1024 lds
    s_waitcnt vmcnt(11)
    ds_read_b64_tr_b16 a[32:33], v8 offset:0
    ds_read_b64_tr_b16 a[34:35], v8 offset:2048
    ds_read_b64_tr_b16 a[36:37], v9 offset:0
    ds_read_b64_tr_b16 a[38:39], v9 offset:2048
    v_pk_mul_f32 v[48:49], v[48:49], v[40:41]
    v_pk_mul_f32 v[50:51], v[50:51], v[42:43]
    v_pk_mul_f32 v[52:53], v[52:53], v[44:45]
    v_pk_mul_f32 v[54:55], v[54:55], v[46:47]
    ds_read_b64_tr_b16 a[40:41], v8 offset:256
    ds_read_b64_tr_b16 a[42:43], v8 offset:2304
    ds_read_b64_tr_b16 a[44:45], v9 offset:256
    ds_read_b64_tr_b16 a[46:47], v9 offset:2304
    s_add_u32 s57, s57, 31744
    buffer_load_dwordx4 v12, s[20:23], s57 offen offset:2048 lds
    v_cvt_pk_bf16_f32 v60, v48, v49
    v_cvt_pk_bf16_f32 v61, v50, v51
    v_cvt_pk_bf16_f32 v62, v52, v53
    v_cvt_pk_bf16_f32 v63, v54, v55
    buffer_store_dwordx4 v[60:63], v23, s[24:27], s67 offen offset:1024 sc1
    s_add_u32 s57, s57, 31744
    buffer_load_dwordx4 v12, s[20:23], s57 offen offset:3072 lds
    s_add_u32 m0, s52, 65536
    s_lshl_b32 s57, s79, 7
    buffer_load_dwordx4 v12, s[20:23], s57 offen offset:0 lds
    s_add_u32 s57, s57, 31744
    buffer_load_dwordx4 v12, s[20:23], s57 offen offset:1024 lds
    s_waitcnt vmcnt(12)
    ds_read_b64_tr_b16 a[48:49], v8 offset:16384
    ds_read_b64_tr_b16 a[50:51], v8 offset:18432
    ds_read_b64_tr_b16 a[52:53], v9 offset:16384
    ds_read_b64_tr_b16 a[54:55], v9 offset:18432
    s_add_u32 s57, s57, 31744
    buffer_load_dwordx4 v12, s[20:23], s57 offen offset:2048 lds
    ds_read_b64_tr_b16 a[56:57], v8 offset:16640
    ds_read_b64_tr_b16 a[58:59], v8 offset:18688
    ds_read_b64_tr_b16 a[60:61], v9 offset:16640
    ds_read_b64_tr_b16 a[62:63], v9 offset:18688
    s_add_u32 s57, s57, 31744
    buffer_load_dwordx4 v12, s[20:23], s57 offen offset:3072 lds
    s_waitcnt lgkmcnt(15)
    s_add_u32 m0, s52, 81920
    s_lshl_b32 s57, s79, 7
    s_add_u32 s57, s57, 131072
    buffer_load_dwordx4 v12, s[20:23], s57 offen offset:0 lds
    s_add_u32 s57, s57, 31744
    buffer_load_dwordx4 v12, s[20:23], s57 offen offset:1024 lds
    s_waitcnt vmcnt(11)
    ds_read_b64_tr_b16 a[64:65], v8 offset:32768
    ds_read_b64_tr_b16 a[66:67], v8 offset:34816
    ds_read_b64_tr_b16 a[68:69], v9 offset:32768
    ds_read_b64_tr_b16 a[70:71], v9 offset:34816
    s_add_u32 s57, s57, 31744
    buffer_load_dwordx4 v12, s[20:23], s57 offen offset:2048 lds
    ds_read_b64_tr_b16 a[72:73], v8 offset:33024
    ds_read_b64_tr_b16 a[74:75], v8 offset:35072
    ds_read_b64_tr_b16 a[76:77], v9 offset:33024
    ds_read_b64_tr_b16 a[78:79], v9 offset:35072
    s_add_u32 s57, s57, 31744
    buffer_load_dwordx4 v12, s[20:23], s57 offen offset:3072 lds
    s_add_u32 m0, s52, 98304
    s_lshl_b32 s57, s80, 7
    buffer_load_dwordx4 v12, s[20:23], s57 offen offset:0 lds
    s_add_u32 s57, s57, 31744
    buffer_load_dwordx4 v12, s[20:23], s57 offen offset:1024 lds
    s_waitcnt vmcnt(10)
    ds_read_b64_tr_b16 a[80:81], v6 offset:0
    ds_read_b64_tr_b16 a[82:83], v6 offset:2048
    ds_read_b64_tr_b16 a[84:85], v7 offset:0
    ds_read_b64_tr_b16 a[86:87], v7 offset:2048
    s_add_u32 s57, s57, 31744
    buffer_load_dwordx4 v12, s[20:23], s57 offen offset:2048 lds
    ds_read_b64_tr_b16 a[88:89], v6 offset:256
    ds_read_b64_tr_b16 a[90:91], v6 offset:2304
    ds_read_b64_tr_b16 a[92:93], v7 offset:256
    ds_read_b64_tr_b16 a[94:95], v7 offset:2304
    s_barrier
    s_cmp_lg_u32 s44, 0
    s_cbranch_scc1 L_nopub6
    s_lshl_b32 s60, s51, 5
    s_add_u32 s60, s60, s50
    s_lshl_b32 s60, s60, 7
    s_add_u32 s60, s60, 12713984
    v_mov_b32 v30, s47
    s_mov_b64 exec, 1
    buffer_store_dword v30, off, s[24:27], s60 sc1
    s_mov_b64 exec, -1
L_nopub6:
L_p3join:
    s_add_u32 s57, s57, 31744
    buffer_load_dwordx4 v12, s[20:23], s57 offen offset:3072 lds
    v_lshlrev_b32 v228, 16, v228
    v_lshlrev_b32 v32, 16, v216
    v_and_b32 v33, s61, v216
    v_lshlrev_b32 v34, 16, v217
    s_waitcnt lgkmcnt(15)
    s_add_u32 m0, s52, 114688
    s_lshl_b32 s57, s80, 7
    s_add_u32 s57, s57, 131072
    buffer_load_dwordx4 v12, s[20:23], s57 offen offset:0 lds
    v_and_b32 v35, s61, v217
    v_add_f32 v32, v32, v228
    v_add_f32 v33, v33, v228
    v_add_f32 v34, v34, v228
    s_add_u32 s57, s57, 31744
    buffer_load_dwordx4 v12, s[20:23], s57 offen offset:1024 lds
    s_waitcnt vmcnt(10)
    ds_read_b64_tr_b16 a[96:97], v6 offset:16384
    ds_read_b64_tr_b16 a[98:99], v6 offset:18432
    ds_read_b64_tr_b16 a[100:101], v7 offset:16384
    ds_read_b64_tr_b16 a[102:103], v7 offset:18432
    v_add_f32 v35, v35, v228
    v_lshlrev_b32 v48, 16, v218
    v_and_b32 v49, s61, v218
    v_lshlrev_b32 v50, 16, v219
    ds_read_b64_tr_b16 a[104:105], v6 offset:16640
    ds_read_b64_tr_b16 a[106:107], v6 offset:18688
    ds_read_b64_tr_b16 a[108:109], v7 offset:16640
    ds_read_b64_tr_b16 a[110:111], v7 offset:18688
    s_add_u32 s57, s57, 31744
    buffer_load_dwordx4 v12, s[20:23], s57 offen offset:2048 lds
    v_and_b32 v51, s61, v219
    v_add_f32 v48, v48, v228
    v_add_f32 v49, v49, v228
    v_add_f32 v50, v50, v228
    s_add_u32 s57, s57, 31744
    buffer_load_dwordx4 v12, s[20:23], s57 offen offset:3072 lds
    v_add_f32 v51, v51, v228
    v_lshlrev_b32 v64, 16, v220
    v_and_b32 v65, s61, v220
    v_lshlrev_b32 v66, 16, v221
    s_add_u32 m0, s52, 131072
    s_lshl_b32 s57, s81, 7
    buffer_load_dwordx4 v12, s[20:23], s57 offen offset:0 lds
    v_and_b32 v67, s61, v221
    v_add_f32 v64, v64, v228
    v_add_f32 v65, v65, v228
    v_add_f32 v66, v66, v228
    v_add_f32 v67, v67, v228
    v_lshlrev_b32 v80, 16, v222
    v_and_b32 v81, s61, v222
    v_lshlrev_b32 v82, 16, v223
    s_add_u32 s57, s57, 31744
    buffer_load_dwordx4 v12, s[20:23], s57 offen offset:1024 lds
    s_waitcnt vmcnt(10)
    ds_read_b64_tr_b16 a[112:113], v6 offset:32768
    ds_read_b64_tr_b16 a[114:115], v6 offset:34816
    ds_read_b64_tr_b16 a[116:117], v7 offset:32768
    ds_read_b64_tr_b16 a[118:119], v7 offset:34816
    s_add_u32 s57, s57, 31744
    buffer_load_dwordx4 v12, s[20:23], s57 offen offset:2048 lds
    ds_read_b64_tr_b16 a[120:121], v6 offset:33024
    ds_read_b64_tr_b16 a[122:123], v6 offset:35072
    ds_read_b64_tr_b16 a[124:125], v7 offset:33024
    ds_read_b64_tr_b16 a[126:127], v7 offset:35072
    s_add_u32 s57, s57, 31744
    buffer_load_dwordx4 v12, s[20:23], s57 offen offset:3072 lds
    v_and_b32 v83, s61, v223
    v_add_f32 v80, v80, v228
    v_add_f32 v81, v81, v228
    v_add_f32 v82, v82, v228
    v_add_f32 v83, v83, v228
    v_lshlrev_b32 v96, 16, v224
    v_and_b32 v97, s61, v224
    v_lshlrev_b32 v98, 16, v225
    s_waitcnt lgkmcnt(15)
    s_add_u32 m0, s52, 147456
    s_lshl_b32 s57, s81, 7
    s_add_u32 s57, s57, 131072
    buffer_load_dwordx4 v12, s[20:23], s57 offen offset:0 lds
    v_and_b32 v99, s61, v225
    v_add_f32 v96, v96, v228
    v_add_f32 v97, v97, v228
    v_add_f32 v98, v98, v228
    s_add_u32 s57, s57, 31744
    buffer_load_dwordx4 v12, s[20:23], s57 offen offset:1024 lds
    s_waitcnt vmcnt(10)
    ds_read_b64_tr_b16 a[128:129], v6 offset:49152
    ds_read_b64_tr_b16 a[130:131], v6 offset:51200
    ds_read_b64_tr_b16 a[132:133], v7 offset:49152
    ds_read_b64_tr_b16 a[134:135], v7 offset:51200
    s_add_u32 s57, s57, 31744
    buffer_load_dwordx4 v12, s[20:23], s57 offen offset:2048 lds
    ds_read_b64_tr_b16 a[136:137], v6 offset:49408
    ds_read_b64_tr_b16 a[138:139], v6 offset:51456
    ds_read_b64_tr_b16 a[140:141], v7 offset:49408
    ds_read_b64_tr_b16 a[142:143], v7 offset:51456
    v_add_f32 v99, v99, v228
    s_add_u32 s57, s57, 31744
    buffer_load_dwordx4 v12, s[20:23], s57 offen offset:3072 lds
    s_add_u32 m0, s52, 49152
    s_lshl_b32 s57, s82, 7
    buffer_load_dwordx4 v12, s[20:23], s57 offen offset:0 lds
    s_add_u32 s57, s57, 31744
    buffer_load_dwordx4 v12, s[20:23], s57 offen offset:1024 lds
    s_waitcnt vmcnt(10)
    ds_read_b64_tr_b16 a[144:145], v8 offset:0
    ds_read_b64_tr_b16 a[146:147], v8 offset:2048
    ds_read_b64_tr_b16 a[148:149], v9 offset:0
    ds_read_b64_tr_b16 a[150:151], v9 offset:2048
    s_add_u32 s57, s57, 31744
    buffer_load_dwordx4 v12, s[20:23], s57 offen offset:2048 lds
    ds_read_b64_tr_b16 a[152:153], v8 offset:256
    ds_read_b64_tr_b16 a[154:155], v8 offset:2304
    ds_read_b64_tr_b16 a[156:157], v9 offset:256
    ds_read_b64_tr_b16 a[158:159], v9 offset:2304
    s_add_u32 s57, s57, 31744
    buffer_load_dwordx4 v12, s[20:23], s57 offen offset:3072 lds
    s_waitcnt lgkmcnt(15)
    s_add_u32 m0, s52, 65536
    s_lshl_b32 s57, s82, 7
    s_add_u32 s57, s57, 131072
    buffer_load_dwordx4 v12, s[20:23], s57 offen offset:0 lds
    s_add_u32 s57, s57, 31744
    buffer_load_dwordx4 v12, s[20:23], s57 offen offset:1024 lds
    s_waitcnt vmcnt(10)
    ds_read_b64_tr_b16 a[160:161], v8 offset:16384
    ds_read_b64_tr_b16 a[162:163], v8 offset:18432
    ds_read_b64_tr_b16 a[164:165], v9 offset:16384
    ds_read_b64_tr_b16 a[166:167], v9 offset:18432
    s_add_u32 s57, s57, 31744
    buffer_load_dwordx4 v12, s[20:23], s57 offen offset:2048 lds
    ds_read_b64_tr_b16 a[168:169], v8 offset:16640
    ds_read_b64_tr_b16 a[170:171], v8 offset:18688
    ds_read_b64_tr_b16 a[172:173], v9 offset:16640
    ds_read_b64_tr_b16 a[174:175], v9 offset:18688
    s_add_u32 s57, s57, 31744
    buffer_load_dwordx4 v12, s[20:23], s57 offen offset:3072 lds
    s_add_u32 m0, s52, 81920
    s_mov_b32 s57, s75
    buffer_load_dwordx4 v15, s[12:15], s57 offen offset:0 lds
    s_add_u32 s57, s57, 113664
    buffer_load_dwordx4 v15, s[12:15], s57 offen offset:1024 lds
    s_waitcnt vmcnt(10)
    ds_read_b64_tr_b16 a[176:177], v8 offset:32768
    ds_read_b64_tr_b16 a[178:179], v8 offset:34816
    ds_read_b64_tr_b16 a[180:181], v9 offset:32768
    ds_read_b64_tr_b16 a[182:183], v9 offset:34816
    s_add_u32 s57, s57, 113664
    buffer_load_dwordx4 v15, s[12:15], s57 offen offset:2048 lds
    ds_read_b64_tr_b16 a[184:185], v8 offset:33024
    ds_read_b64_tr_b16 a[186:187], v8 offset:35072
    ds_read_b64_tr_b16 a[188:189], v9 offset:33024
    ds_read_b64_tr_b16 a[190:191], v9 offset:35072
    s_add_u32 s57, s57, 113664
    buffer_load_dwordx4 v15, s[12:15], s57 offen offset:3072 lds
    s_waitcnt lgkmcnt(15)
    s_add_u32 m0, s52, 98304
    s_mov_b32 s57, 0
    buffer_load_dwordx4 v13, s[12:15], s57 offen offset:0 lds
    s_add_u32 s57, s57, 6144
    buffer_load_dwordx4 v14, s[12:15], s57 offen offset:1024 lds
    s_waitcnt vmcnt(10)
    ds_read_b64_tr_b16 a[192:193], v6 offset:0
    ds_read_b64_tr_b16 a[194:195], v6 offset:2048
    ds_read_b64_tr_b16 a[196:197], v7 offset:0
    ds_read_b64_tr_b16 a[198:199], v7 offset:2048
    s_add_u32 s57, s57, 6144
    buffer_load_dwordx4 v13, s[12:15], s57 offen offset:2048 lds
    ds_read_b64_tr_b16 a[200:201], v6 offset:256
    ds_read_b64_tr_b16 a[202:203], v6 offset:2304
    ds_read_b64_tr_b16 a[204:205], v7 offset:256
    ds_read_b64_tr_b16 a[206:207], v7 offset:2304
    s_add_u32 s57, s57, 6144
    buffer_load_dwordx4 v14, s[12:15], s57 offen offset:3072 lds
    buffer_load_dword v17, v20, s[24:27], 0 offen sc1
    s_add_u32 m0, s52, 114688
    s_mov_b32 s57, 114688
    buffer_load_dwordx4 v13, s[12:15], s57 offen offset:0 lds
    s_waitcnt vmcnt(10)
    ds_read_b64_tr_b16 a[208:209], v6 offset:16384
    ds_read_b64_tr_b16 a[210:211], v6 offset:18432
    ds_read_b64_tr_b16 a[212:213], v7 offset:16384
    ds_read_b64_tr_b16 a[214:215], v7 offset:18432
    s_add_u32 s57, s57, 6144
    buffer_load_dwordx4 v14, s[12:15], s57 offen offset:1024 lds
    ds_read_b64_tr_b16 a[216:217], v6 offset:16640
    ds_read_b64_tr_b16 a[218:219], v6 offset:18688
    ds_read_b64_tr_b16 a[220:221], v7 offset:16640
    ds_read_b64_tr_b16 a[222:223], v7 offset:18688
    s_add_u32 s57, s57, 6144
    buffer_load_dwordx4 v13, s[12:15], s57 offen offset:2048 lds
    s_add_u32 s57, s57, 6144
    buffer_load_dwordx4 v14, s[12:15], s57 offen offset:3072 lds
    s_waitcnt lgkmcnt(15)
    s_add_u32 m0, s52, 131072
    s_mov_b32 s57, 229376
    buffer_load_dwordx4 v13, s[12:15], s57 offen offset:0 lds
    s_add_u32 s57, s57, 6144
    buffer_load_dwordx4 v14, s[12:15], s57 offen offset:1024 lds
    s_add_u32 s57, s57, 6144
    buffer_load_dwordx4 v13, s[12:15], s57 offen offset:2048 lds
    s_add_u32 s57, s57, 6144
    buffer_load_dwordx4 v14, s[12:15], s57 offen offset:3072 lds
    s_add_u32 m0, s52, 147456
    s_mov_b32 s57, 344064
    buffer_load_dwordx4 v239, s[12:15], s57 offen offset:0 lds
    s_add_u32 s57, s57, 27648
    buffer_load_dwordx4 v239, s[12:15], s57 offen offset:1024 lds
    s_waitcnt vmcnt(10)
    v_cmp_ne_u32 vcc, s47, v17
    s_nop 0
    s_cbranch_vccz L_ok8
    s_mov_b32 s59, 100000
L_spin7:
    buffer_load_dword v17, v20, s[24:27], 0 offen sc1
    s_waitcnt vmcnt(0)
    v_cmp_ne_u32 vcc, s47, v17
    s_nop 0
    s_cbranch_vccz L_ok8
    s_sub_u32 s59, s59, 1
    s_cbranch_scc0 L_spin7
L_ok8:
    s_cmp_ge_u32 s89, 4
    s_cbranch_scc1 L_p3_alt
    s_mov_b32 s66, s68
    s_add_u32 s58, s66, s76
    buffer_load_dwordx4 v[144:147], v23, s[24:27], s58 offen offset:0 sc1
    buffer_load_dwordx4 v[148:151], v23, s[24:27], s58 offen offset:1024 sc1
    s_add_u32 s58, s66, s77
    buffer_load_dwordx4 v[152:155], v23, s[24:27], s58 offen offset:0 sc1
    buffer_load_dwordx4 v[156:159], v23, s[24:27], s58 offen offset:1024 sc1
    s_add_u32 s58, s66, s78
    buffer_load_dwordx4 v[112:115], v23, s[24:27], s58 offen offset:0 sc1
    buffer_load_dwordx4 v[116:119], v23, s[24:27], s58 offen offset:1024 sc1
    s_add_u32 s58, s66, s79
    buffer_load_dwordx4 v[120:123], v23, s[24:27], s58 offen offset:0 sc1
    buffer_load_dwordx4 v[124:127], v23, s[24:27], s58 offen offset:1024 sc1
    s_add_u32 s58, s66, s80
    buffer_load_dwordx4 v[128:131], v23, s[24:27], s58 offen offset:0 sc1
    buffer_load_dwordx4 v[132:135], v23, s[24:27], s58 offen offset:1024 sc1
    s_add_u32 s58, s66, s81
    buffer_load_dwordx4 v[136:139], v23, s[24:27], s58 offen offset:0 sc1
    s_waitcnt vmcnt(10)
    v_mfma_f32_16x16x32_bf16 v[96:99], v[144:147], a[0:3], v[96:99]
    v_mfma_f32_16x16x32_bf16 v[100:103], v[144:147], a[4:7], 0
    buffer_load_dwordx4 v[140:143], v23, s[24:27], s58 offen offset:1024 sc1
    v_mfma_f32_16x16x32_bf16 v[104:107], v[144:147], a[8:11], 0
    v_mfma_f32_16x16x32_bf16 v[108:111], v[144:147], a[12:15], 0
    s_waitcnt vmcnt(10)
    v_mfma_f32_16x16x32_bf16 v[96:99], v[148:151], a[16:19], v[96:99]
    s_add_u32 s58, s66, s82
    v_mfma_f32_16x16x32_bf16 v[100:103], v[148:151], a[20:23], v[100:103]
    buffer_load_dwordx4 v[144:147], v23, s[24:27], s58 offen offset:0 sc1
    v_mfma_f32_16x16x32_bf16 v[104:107], v[148:151], a[24:27], v[104:107]
    v_mfma_f32_16x16x32_bf16 v[108:111], v[148:151], a[28:31], v[108:111]
    s_waitcnt vmcnt(10)
    v_mfma_f32_16x16x32_bf16 v[96:99], v[152:155], a[32:35], v[96:99]
    v_mfma_f32_16x16x32_bf16 v[100:103], v[152:155], a[36:39], v[100:103]
    buffer_load_dwordx4 v[148:151], v23, s[24:27], s58 offen offset:1024 sc1
    v_mfma_f32_16x16x32_bf16 v[104:107], v[152:155], a[40:43], v[104:107]
    v_mfma_f32_16x16x32_bf16 v[108:111], v[152:155], a[44:47], v[108:111]
    s_waitcnt vmcnt(10)
    v_mfma_f32_16x16x32_bf16 v[96:99], v[156:159], a[48:51], v[96:99]
    s_add_u32 s66, s69, 175872
    s_add_u32 s58, s66, s76
    v_mfma_f32_16x16x32_bf16 v[100:103], v[156:159], a[52:55], v[100:103]
    buffer_load_dwordx4 v[152:155], v23, s[24:27], s58 offen offset:0 sc1
    v_mfma_f32_16x16x32_bf16 v[104:107], v[156:159], a[56:59], v[104:107]
    v_mfma_f32_16x16x32_bf16 v[108:111], v[156:159], a[60:63], v[108:111]
    s_waitcnt vmcnt(10)
    v_mfma_f32_16x16x32_bf16 v[96:99], v[112:115], a[64:67], v[96:99]
    v_mfma_f32_16x16x32_bf16 v[100:103], v[112:115], a[68:71], v[100:103]
    buffer_load_dwordx4 v[156:159], v23, s[24:27], s58 offen offset:1024 sc1
    v_mfma_f32_16x16x32_bf16 v[104:107], v[112:115], a[72:75], v[104:107]
    v_mfma_f32_16x16x32_bf16 v[108:111], v[112:115], a[76:79], v[108:111]
    s_waitcnt vmcnt(10)
    v_mfma_f32_16x16x32_bf16 v[96:99], v[116:119], a[80:83], v[96:99]
    s_add_u32 s58, s66, s77
    v_mfma_f32_16x16x32_bf16 v[100:103], v[116:119], a[84:87], v[100:103]
    buffer_load_dwordx4 v[112:115], v23, s[24:27], s58 offen offset:0 sc1
    v_mfma_f32_16x16x32_bf16 v[104:107], v[116:119], a[88:91], v[104:107]
    v_mfma_f32_16x16x32_bf16 v[108:111], v[116:119], a[92:95], v[108:111]
    s_waitcnt vmcnt(10)
    v_mfma_f32_16x16x32_bf16 v[96:99], v[120:123], a[96:99], v[96:99]
    v_mfma_f32_16x16x32_bf16 v[100:103], v[120:123], a[100:103], v[100:103]
    buffer_load_dwordx4 v[116:119], v23, s[24:27], s58 offen offset:1024 sc1
    v_mfma_f32_16x16x32_bf16 v[104:107], v[120:123], a[104:107], v[104:107]
    v_mfma_f32_16x16x32_bf16 v[108:111], v[120:123], a[108:111], v[108:111]
    s_waitcnt vmcnt(10)
    v_mfma_f32_16x16x32_bf16 v[96:99], v[124:127], a[112:115], v[96:99]
    s_add_u32 s58, s66, s78
    v_mfma_f32_16x16x32_bf16 v[100:103], v[124:127], a[116:119], v[100:103]
    buffer_load_dwordx4 v[120:123], v23, s[24:27], s58 offen offset:0 sc1
    v_mfma_f32_16x16x32_bf16 v[104:107], v[124:127], a[120:123], v[104:107]
    v_mfma_f32_16x16x32_bf16 v[108:111], v[124:127], a[124:127], v[108:111]
    s_waitcnt vmcnt(10)
    v_mfma_f32_16x16x32_bf16 v[96:99], v[128:131], a[128:131], v[96:99]
    v_mfma_f32_16x16x32_bf16 v[100:103], v[128:131], a[132:135], v[100:103]
    buffer_load_dwordx4 v[124:127], v23, s[24:27], s58 offen offset:1024 sc1
    v_mfma_f32_16x16x32_bf16 v[104:107], v[128:131], a[136:139], v[104:107]
    v_mfma_f32_16x16x32_bf16 v[108:111], v[128:131], a[140:143], v[108:111]
    s_waitcnt vmcnt(10)
    v_mfma_f32_16x16x32_bf16 v[96:99], v[132:135], a[144:147], v[96:99]
    s_add_u32 s58, s66, s79
    v_mfma_f32_16x16x32_bf16 v[100:103], v[132:135], a[148:151], v[100:103]
    buffer_load_dwordx4 v[128:131], v23, s[24:27], s58 offen offset:0 sc1
    v_mfma_f32_16x16x32_bf16 v[104:107], v[132:135], a[152:155], v[104:107]
    v_mfma_f32_16x16x32_bf16 v[108:111], v[132:135], a[156:159], v[108:111]
    s_waitcnt vmcnt(10)
    v_mfma_f32_16x16x32_bf16 v[96:99], v[136:139], a[160:163], v[96:99]
    v_mfma_f32_16x16x32_bf16 v[100:103], v[136:139], a[164:167], v[100:103]
    buffer_load_dwordx4 v[132:135], v23, s[24:27], s58 offen offset:1024 sc1
    v_mfma_f32_16x16x32_bf16 v[104:107], v[136:139], a[168:171], v[104:107]
    v_mfma_f32_16x16x32_bf16 v[108:111], v[136:139], a[172:175], v[108:111]
    s_waitcnt vmcnt(10)
    v_mfma_f32_16x16x32_bf16 v[96:99], v[140:143], a[176:179], v[96:99]
    s_add_u32 s58, s66, s80
    v_mfma_f32_16x16x32_bf16 v[100:103], v[140:143], a[180:183], v[100:103]
    buffer_load_dwordx4 v[136:139], v23, s[24:27], s58 offen offset:0 sc1
    v_mfma_f32_16x16x32_bf16 v[104:107], v[140:143], a[184:187], v[104:107]
    v_mfma_f32_16x16x32_bf16 v[108:111], v[140:143], a[188:191], v[108:111]
    s_waitcnt vmcnt(10)
    s_waitcnt lgkmcnt(8)
    v_mfma_f32_16x16x32_bf16 v[96:99], v[144:147], a[192:195], v[96:99]
    v_mfma_f32_16x16x32_bf16 v[100:103], v[144:147], a[196:199], v[100:103]
    buffer_load_dwordx4 v[140:143], v23, s[24:27], s58 offen offset:1024 sc1
    v_mfma_f32_16x16x32_bf16 v[104:107], v[144:147], a[200:203], v[104:107]
    v_mfma_f32_16x16x32_bf16 v[108:111], v[144:147], a[204:207], v[108:111]
    s_waitcnt vmcnt(10)
    s_waitcnt lgkmcnt(0)
    v_mfma_f32_16x16x32_bf16 v[96:99], v[148:151], a[208:211], v[96:99]
    s_add_u32 s58, s66, s81
    v_mfma_f32_16x16x32_bf16 v[100:103], v[148:151], a[212:215], v[100:103]
    buffer_load_dwordx4 v[144:147], v23, s[24:27], s58 offen offset:0 sc1
    v_mfma_f32_16x16x32_bf16 v[104:107], v[148:151], a[216:219], v[104:107]
    v_mfma_f32_16x16x32_bf16 v[108:111], v[148:151], a[220:223], v[108:111]
L_p3_join:
    s_waitcnt vmcnt(10)
    v_mfma_f32_16x16x32_bf16 v[80:83], v[152:155], a[0:3], v[80:83]
    v_mfma_f32_16x16x32_bf16 v[84:87], v[152:155], a[4:7], 0
    buffer_load_dwordx4 v[148:151], v23, s[24:27], s58 offen offset:1024 sc1
    v_mfma_f32_16x16x32_bf16 v[88:91], v[152:155], a[8:11], 0
    v_mfma_f32_16x16x32_bf16 v[92:95], v[152:155], a[12:15], 0
    s_waitcnt vmcnt(10)
    v_mfma_f32_16x16x32_bf16 v[80:83], v[156:159], a[16:19], v[80:83]
    s_add_u32 s58, s66, s82
    v_mfma_f32_16x16x32_bf16 v[84:87], v[156:159], a[20:23], v[84:87]
    buffer_load_dwordx4 v[152:155], v23, s[24:27], s58 offen offset:0 sc1
    v_mfma_f32_16x16x32_bf16 v[88:91], v[156:159], a[24:27], v[88:91]
    ds_write_b128 v232, v[100:103] offset:3072
    v_mfma_f32_16x16x32_bf16 v[92:95], v[156:159], a[28:31], v[92:95]
    s_waitcnt vmcnt(10)
    v_mfma_f32_16x16x32_bf16 v[80:83], v[112:115], a[32:35], v[80:83]
    v_mfma_f32_16x16x32_bf16 v[84:87], v[112:115], a[36:39], v[84:87]
    buffer_load_dwordx4 v[156:159], v23, s[24:27], s58 offen offset:1024 sc1
    v_mfma_f32_16x16x32_bf16 v[88:91], v[112:115], a[40:43], v[88:91]
    ds_write_b128 v232, v[104:107] offset:19456
    v_mfma_f32_16x16x32_bf16 v[92:95], v[112:115], a[44:47], v[92:95]
    s_waitcnt vmcnt(10)
    v_mfma_f32_16x16x32_bf16 v[80:83], v[116:119], a[48:51], v[80:83]
    s_add_u32 s66, s69, 117248
    s_add_u32 s58, s66, s76
    v_mfma_f32_16x16x32_bf16 v[84:87], v[116:119], a[52:55], v[84:87]
    buffer_load_dwordx4 v[112:115], v23, s[24:27], s58 offen offset:0 sc1
    v_mfma_f32_16x16x32_bf16 v[88:91], v[116:119], a[56:59], v[88:91]
    ds_write_b128 v232, v[108:111] offset:35840
    v_mfma_f32_16x16x32_bf16 v[92:95], v[116:119], a[60:63], v[92:95]
    s_waitcnt vmcnt(10)
    v_mfma_f32_16x16x32_bf16 v[80:83], v[120:123], a[64:67], v[80:83]
    v_mfma_f32_16x16x32_bf16 v[84:87], v[120:123], a[68:71], v[84:87]
    buffer_load_dwordx4 v[116:119], v23, s[24:27], s58 offen offset:1024 sc1
    v_mfma_f32_16x16x32_bf16 v[88:91], v[120:123], a[72:75], v[88:91]
    v_mfma_f32_16x16x32_bf16 v[92:95], v[120:123], a[76:79], v[92:95]
    s_waitcnt vmcnt(10)
    v_mfma_f32_16x16x32_bf16 v[80:83], v[124:127], a[80:83], v[80:83]
    s_add_u32 s58, s66, s77
    v_mfma_f32_16x16x32_bf16 v[84:87], v[124:127], a[84:87], v[84:87]
    buffer_load_dwordx4 v[120:123], v23, s[24:27], s58 offen offset:0 sc1
    v_mfma_f32_16x16x32_bf16 v[88:91], v[124:127], a[88:91], v[88:91]
    s_waitcnt lgkmcnt(0)
    s_barrier
    v_mfma_f32_16x16x32_bf16 v[92:95], v[124:127], a[92:95], v[92:95]
    s_waitcnt vmcnt(10)
    v_mfma_f32_16x16x32_bf16 v[80:83], v[128:131], a[96:99], v[80:83]
    v_mfma_f32_16x16x32_bf16 v[84:87], v[128:131], a[100:103], v[84:87]
    buffer_load_dwordx4 v[124:127], v23, s[24:27], s58 offen offset:1024 sc1
    v_mfma_f32_16x16x32_bf16 v[88:91], v[128:131], a[104:107], v[88:91]
    ds_read_b128 v[100:103], v233 offset:3072
    ds_read_b128 v[104:107], v234 offset:19456
    v_mfma_f32_16x16x32_bf16 v[92:95], v[128:131], a[108:111], v[92:95]
    ds_read_b128 v[108:111], v235 offset:35840
    s_waitcnt vmcnt(10)
    v_mfma_f32_16x16x32_bf16 v[80:83], v[132:135], a[112:115], v[80:83]
    s_add_u32 s58, s66, s78
    v_mfma_f32_16x16x32_bf16 v[84:87], v[132:135], a[116:119], v[84:87]
    buffer_load_dwordx4 v[128:131], v23, s[24:27], s58 offen offset:0 sc1
    v_mfma_f32_16x16x32_bf16 v[88:91], v[132:135], a[120:123], v[88:91]
    ds_read_b64_tr_b16 v[160:161], v16 offset:0
    v_mfma_f32_16x16x32_bf16 v[92:95], v[132:135], a[124:127], v[92:95]
    ds_read_b64_tr_b16 v[162:163], v16 offset:512
    s_waitcnt vmcnt(10)
    v_mfma_f32_16x16x32_bf16 v[80:83], v[136:139], a[128:131], v[80:83]
    s_waitcnt lgkmcnt(2)
    v_mfma_f32_16x16x32_bf16 v[84:87], v[136:139], a[132:135], v[84:87]
    buffer_load_dwordx4 v[132:135], v23, s[24:27], s58 offen offset:1024 sc1
    v_mfma_f32_16x16x32_bf16 v[88:91], v[136:139], a[136:139], v[88:91]
    v_add_f32 v96, v96, v100
    v_add_f32 v97, v97, v101
    ds_read_b64_tr_b16 v[164:165], v16 offset:4096
    v_mfma_f32_16x16x32_bf16 v[92:95], v[136:139], a[140:143], v[92:95]
    ds_read_b64_tr_b16 v[166:167], v16 offset:4608
    s_waitcnt vmcnt(10)
    v_mfma_f32_16x16x32_bf16 v[80:83], v[140:143], a[144:147], v[80:83]
    s_add_u32 s58, s66, s79
    v_add_f32 v98, v98, v102
    v_mfma_f32_16x16x32_bf16 v[84:87], v[140:143], a[148:151], v[84:87]
    buffer_load_dwordx4 v[136:139], v23, s[24:27], s58 offen offset:0 sc1
    v_mfma_f32_16x16x32_bf16 v[88:91], v[140:143], a[152:155], v[88:91]
    v_add_f32 v99, v99, v103
    v_add_f32 v96, v96, v104
    ds_read_b64_tr_b16 v[168:169], v16 offset:8192
    v_mfma_f32_16x16x32_bf16 v[92:95], v[140:143], a[156:159], v[92:95]
    ds_read_b64_tr_b16 v[170:171], v16 offset:8704
    s_waitcnt vmcnt(10)
    v_mfma_f32_16x16x32_bf16 v[80:83], v[144:147], a[160:163], v[80:83]
    v_add_f32 v97, v97, v105
    v_mfma_f32_16x16x32_bf16 v[84:87], v[144:147], a[164:167], v[84:87]
    buffer_load_dwordx4 v[140:143], v23, s[24:27], s58 offen offset:1024 sc1
    v_mfma_f32_16x16x32_bf16 v[88:91], v[144:147], a[168:171], v[88:91]
    v_add_f32 v98, v98, v106
    v_add_f32 v99, v99, v107
    ds_read_b64_tr_b16 v[172:173], v16 offset:12288
    v_mfma_f32_16x16x32_bf16 v[92:95], v[144:147], a[172:175], v[92:95]
    ds_read_b64_tr_b16 v[174:175], v16 offset:12800
    s_waitcnt vmcnt(10)
    v_mfma_f32_16x16x32_bf16 v[80:83], v[148:151], a[176:179], v[80:83]
    s_add_u32 s58, s66, s80
    v_mfma_f32_16x16x32_bf16 v[84:87], v[148:151], a[180:183], v[84:87]
    buffer_load_dwordx4 v[144:147], v23, s[24:27], s58 offen offset:0 sc1
    v_mfma_f32_16x16x32_bf16 v[88:91], v[148:151], a[184:187], v[88:91]
    v_add_f32 v96, v96, v108
    v_add_f32 v97, v97, v109
    v_mfma_f32_16x16x32_bf16 v[92:95], v[148:151], a[188:191], v[92:95]
    v_add_f32 v98, v98, v110
    s_waitcnt vmcnt(10)
    v_mfma_f32_16x16x32_bf16 v[80:83], v[152:155], a[192:195], v[80:83]
    v_mfma_f32_16x16x32_bf16 v[84:87], v[152:155], a[196:199], v[84:87]
    buffer_load_dwordx4 v[148:151], v23, s[24:27], s58 offen offset:1024 sc1
    v_mfma_f32_16x16x32_bf16 v[88:91], v[152:155], a[200:203], v[88:91]
    v_add_f32 v99, v99, v111
    v_mfma_f32_16x16x32_bf16 v[92:95], v[152:155], a[204:207], v[92:95]
    s_waitcnt vmcnt(10)
    v_mfma_f32_16x16x32_bf16 v[80:83], v[156:159], a[208:211], v[80:83]
    s_add_u32 s58, s66, s81
    v_mfma_f32_16x16x32_bf16 v[84:87], v[156:159], a[212:215], v[84:87]
    buffer_load_dwordx4 v[152:155], v23, s[24:27], s58 offen offset:0 sc1
    v_mfma_f32_16x16x32_bf16 v[88:91], v[156:159], a[216:219], v[88:91]
    v_mfma_f32_16x16x32_bf16 v[92:95], v[156:159], a[220:223], v[92:95]
    s_waitcnt vmcnt(10)
    v_mfma_f32_16x16x32_bf16 v[64:67], v[112:115], a[0:3], v[64:67]
    v_mfma_f32_16x16x32_bf16 v[68:71], v[112:115], a[4:7], 0
    buffer_load_dwordx4 v[156:159], v23, s[24:27], s58 offen offset:1024 sc1
    v_mfma_f32_16x16x32_bf16 v[72:75], v[112:115], a[8:11], 0
    ds_read_b64_tr_b16 v[192:193], v16 offset:1024
    v_mfma_f32_16x16x32_bf16 v[76:79], v[112:115], a[12:15], 0
    ds_read_b64_tr_b16 v[194:195], v16 offset:1536
    s_waitcnt vmcnt(10)
    v_mfma_f32_16x16x32_bf16 v[64:67], v[116:119], a[16:19], v[64:67]
    s_add_u32 s58, s66, s82
    v_mfma_f32_16x16x32_bf16 v[68:71], v[116:119], a[20:23], v[68:71]
    buffer_load_dwordx4 v[112:115], v23, s[24:27], s58 offen offset:0 sc1
    v_mfma_f32_16x16x32_bf16 v[72:75], v[116:119], a[24:27], v[72:75]
    ds_read_b64_tr_b16 v[196:197], v16 offset:5120
    ds_read_b64_tr_b16 v[198:199], v16 offset:5632
    v_mfma_f32_16x16x32_bf16 v[76:79], v[116:119], a[28:31], v[76:79]
    ds_write_b128 v232, v[84:87] offset:49152
    s_waitcnt vmcnt(10)
    v_mfma_f32_16x16x32_bf16 v[64:67], v[120:123], a[32:35], v[64:67]
    v_mfma_f32_16x16x32_bf16 v[68:71], v[120:123], a[36:39], v[68:71]
    buffer_load_dwordx4 v[116:119], v23, s[24:27], s58 offen offset:1024 sc1
    v_mfma_f32_16x16x32_bf16 v[72:75], v[120:123], a[40:43], v[72:75]
    ds_read_b64_tr_b16 v[200:201], v16 offset:9216
    ds_read_b64_tr_b16 v[202:203], v16 offset:9728
    v_mfma_f32_16x16x32_bf16 v[76:79], v[120:123], a[44:47], v[76:79]
    ds_write_b128 v232, v[88:91] offset:50176
    s_waitcnt vmcnt(10)
    v_mfma_f32_16x16x32_bf16 v[64:67], v[124:127], a[48:51], v[64:67]
    s_add_u32 s66, s69, 58624
    s_add_u32 s58, s66, s76
    v_mfma_f32_16x16x32_bf16 v[68:71], v[124:127], a[52:55], v[68:71]
    buffer_load_dwordx4 v[120:123], v23, s[24:27], s58 offen offset:0 sc1
    v_mfma_f32_16x16x32_bf16 v[72:75], v[124:127], a[56:59], v[72:75]
    ds_read_b64_tr_b16 v[204:205], v16 offset:13312
    ds_read_b64_tr_b16 v[206:207], v16 offset:13824
    v_mfma_f32_16x16x32_bf16 v[76:79], v[124:127], a[60:63], v[76:79]
    ds_write_b128 v232, v[92:95] offset:51200
    s_waitcnt vmcnt(10)
    v_mfma_f32_16x16x32_bf16 v[64:67], v[128:131], a[64:67], v[64:67]
    v_mfma_f32_16x16x32_bf16 v[68:71], v[128:131], a[68:71], v[68:71]
    buffer_load_dwordx4 v[124:127], v23, s[24:27], s58 offen offset:1024 sc1
    v_mfma_f32_16x16x32_bf16 v[72:75], v[128:131], a[72:75], v[72:75]
    ds_read_b64_tr_b16 v[100:101], v16 offset:2048
    v_mfma_f32_16x16x32_bf16 v[76:79], v[128:131], a[76:79], v[76:79]
    ds_read_b64_tr_b16 v[102:103], v16 offset:2560
    s_waitcnt vmcnt(10)
    v_mfma_f32_16x16x32_bf16 v[64:67], v[132:135], a[80:83], v[64:67]
    s_add_u32 s58, s66, s77
    v_mfma_f32_16x16x32_bf16 v[68:71], v[132:135], a[84:87], v[68:71]
    buffer_load_dwordx4 v[128:131], v23, s[24:27], s58 offen offset:0 sc1
    v_mfma_f32_16x16x32_bf16 v[72:75], v[132:135], a[88:91], v[72:75]
    s_waitcnt lgkmcnt(2)
    s_barrier
    v_mfma_f32_16x16x32_bf16 v[76:79], v[132:135], a[92:95], v[76:79]
    s_waitcnt vmcnt(10)
    v_mfma_f32_16x16x32_bf16 v[64:67], v[136:139], a[96:99], v[64:67]
    v_mfma_f32_16x16x32_bf16 v[68:71], v[136:139], a[100:103], v[68:71]
    buffer_load_dwordx4 v[132:135], v23, s[24:27], s58 offen offset:1024 sc1
    v_mfma_f32_16x16x32_bf16 v[72:75], v[136:139], a[104:107], v[72:75]
    ds_read_b128 v[84:87], v233 offset:49152
    ds_read_b128 v[88:91], v234 offset:50176
    v_mfma_f32_16x16x32_bf16 v[76:79], v[136:139], a[108:111], v[76:79]
    ds_read_b128 v[92:95], v235 offset:51200
    s_waitcnt vmcnt(10)
    v_mfma_f32_16x16x32_bf16 v[64:67], v[140:143], a[112:115], v[64:67]
    s_add_u32 s58, s66, s78
    v_mfma_f32_16x16x32_bf16 v[68:71], v[140:143], a[116:119], v[68:71]
    buffer_load_dwordx4 v[136:139], v23, s[24:27], s58 offen offset:0 sc1
    v_mfma_f32_16x16x32_bf16 v[72:75], v[140:143], a[120:123], v[72:75]
    ds_read_b64_tr_b16 a[224:225], v246 offset:0
    v_mfma_f32_16x16x32_bf16 v[76:79], v[140:143], a[124:127], v[76:79]
    ds_read_b64_tr_b16 a[226:227], v246 offset:512
    s_waitcnt vmcnt(10)
    v_mfma_f32_16x16x32_bf16 v[64:67], v[144:147], a[128:131], v[64:67]
    s_waitcnt lgkmcnt(2)
    v_mfma_f32_16x16x32_bf16 v[68:71], v[144:147], a[132:135], v[68:71]
    buffer_load_dwordx4 v[140:143], v23, s[24:27], s58 offen offset:1024 sc1
    v_mfma_f32_16x16x32_bf16 v[72:75], v[144:147], a[136:139], v[72:75]
    v_add_f32 v80, v80, v84
    v_add_f32 v81, v81, v85
    ds_read_b64_tr_b16 a[228:229], v247 offset:0
    v_mfma_f32_16x16x32_bf16 v[76:79], v[144:147], a[140:143], v[76:79]
    ds_read_b64_tr_b16 a[230:231], v247 offset:512
    s_waitcnt vmcnt(10)
    v_mfma_f32_16x16x32_bf16 v[64:67], v[148:151], a[144:147], v[64:67]
    s_add_u32 s58, s66, s79
    v_add_f32 v82, v82, v86
    v_mfma_f32_16x16x32_bf16 v[68:71], v[148:151], a[148:151], v[68:71]
    buffer_load_dwordx4 v[144:147], v23, s[24:27], s58 offen offset:0 sc1
    v_mfma_f32_16x16x32_bf16 v[72:75], v[148:151], a[152:155], v[72:75]
    v_add_f32 v83, v83, v87
    v_add_f32 v80, v80, v88
    ds_read_b64_tr_b16 a[232:233], v246 offset:256
    v_mfma_f32_16x16x32_bf16 v[76:79], v[148:151], a[156:159], v[76:79]
    ds_read_b64_tr_b16 a[234:235], v246 offset:768
    s_waitcnt vmcnt(10)
    v_mfma_f32_16x16x32_bf16 v[64:67], v[152:155], a[160:163], v[64:67]
    v_add_f32 v81, v81, v89
    v_mfma_f32_16x16x32_bf16 v[68:71], v[152:155], a[164:167], v[68:71]
    buffer_load_dwordx4 v[148:151], v23, s[24:27], s58 offen offset:1024 sc1
    v_mfma_f32_16x16x32_bf16 v[72:75], v[152:155], a[168:171], v[72:75]
    v_add_f32 v82, v82, v90
    v_add_f32 v83, v83, v91
    ds_read_b64_tr_b16 a[236:237], v247 offset:256
    v_mfma_f32_16x16x32_bf16 v[76:79], v[152:155], a[172:175], v[76:79]
    ds_read_b64_tr_b16 a[238:239], v247 offset:768
    s_waitcnt vmcnt(10)
    v_mfma_f32_16x16x32_bf16 v[64:67], v[156:159], a[176:179], v[64:67]
    s_add_u32 s58, s66, s80
    v_mfma_f32_16x16x32_bf16 v[68:71], v[156:159], a[180:183], v[68:71]
    buffer_load_dwordx4 v[152:155], v23, s[24:27], s58 offen offset:0 sc1
    v_mfma_f32_16x16x32_bf16 v[72:75], v[156:159], a[184:187], v[72:75]
    v_add_f32 v80, v80, v92
    v_add_f32 v81, v81, v93
    v_mfma_f32_16x16x32_bf16 v[76:79], v[156:159], a[188:191], v[76:79]
    v_add_f32 v82, v82, v94
    s_waitcnt vmcnt(10)
    v_mfma_f32_16x16x32_bf16 v[64:67], v[112:115], a[192:195], v[64:67]
    v_mfma_f32_16x16x32_bf16 v[68:71], v[112:115], a[196:199], v[68:71]
    buffer_load_dwordx4 v[156:159], v23, s[24:27], s58 offen offset:1024 sc1
    v_mfma_f32_16x16x32_bf16 v[72:75], v[112:115], a[200:203], v[72:75]
    v_add_f32 v83, v83, v95
    v_mfma_f32_16x16x32_bf16 v[76:79], v[112:115], a[204:207], v[76:79]
    s_waitcnt vmcnt(10)
    v_mfma_f32_16x16x32_bf16 v[64:67], v[116:119], a[208:211], v[64:67]
    s_add_u32 s58, s66, s81
    v_mfma_f32_16x16x32_bf16 v[68:71], v[116:119], a[212:215], v[68:71]
    buffer_load_dwordx4 v[112:115], v23, s[24:27], s58 offen offset:0 sc1
    v_mfma_f32_16x16x32_bf16 v[72:75], v[116:119], a[216:219], v[72:75]
    v_mfma_f32_16x16x32_bf16 v[76:79], v[116:119], a[220:223], v[76:79]
    s_waitcnt vmcnt(10)
    v_mfma_f32_16x16x32_bf16 v[48:51], v[120:123], a[0:3], v[48:51]
    v_mfma_f32_16x16x32_bf16 v[52:55], v[120:123], a[4:7], 0
    buffer_load_dwordx4 v[116:119], v23, s[24:27], s58 offen offset:1024 sc1
    v_mfma_f32_16x16x32_bf16 v[56:59], v[120:123], a[8:11], 0
    ds_read_b64_tr_b16 v[104:105], v16 offset:6144
    v_mfma_f32_16x16x32_bf16 v[60:63], v[120:123], a[12:15], 0
    ds_read_b64_tr_b16 v[106:107], v16 offset:6656
    s_waitcnt vmcnt(10)
    v_mfma_f32_16x16x32_bf16 v[48:51], v[124:127], a[16:19], v[48:51]
    s_add_u32 s58, s66, s82
    v_mfma_f32_16x16x32_bf16 v[52:55], v[124:127], a[20:23], v[52:55]
    buffer_load_dwordx4 v[120:123], v23, s[24:27], s58 offen offset:0 sc1
    v_mfma_f32_16x16x32_bf16 v[56:59], v[124:127], a[24:27], v[56:59]
    ds_read_b64_tr_b16 v[108:109], v16 offset:10240
    ds_read_b64_tr_b16 v[110:111], v16 offset:10752
    v_mfma_f32_16x16x32_bf16 v[60:63], v[124:127], a[28:31], v[60:63]
    ds_write_b128 v232, v[68:71] offset:32768
    s_waitcnt vmcnt(10)
    v_mfma_f32_16x16x32_bf16 v[48:51], v[128:131], a[32:35], v[48:51]
    v_mfma_f32_16x16x32_bf16 v[52:55], v[128:131], a[36:39], v[52:55]
    buffer_load_dwordx4 v[124:127], v23, s[24:27], s58 offen offset:1024 sc1
    v_mfma_f32_16x16x32_bf16 v[56:59], v[128:131], a[40:43], v[56:59]
    ds_read_b64_tr_b16 v[84:85], v16 offset:14336
    ds_read_b64_tr_b16 v[86:87], v16 offset:14848
    v_mfma_f32_16x16x32_bf16 v[60:63], v[128:131], a[44:47], v[60:63]
    ds_write_b128 v232, v[72:75] offset:33792
    s_waitcnt vmcnt(10)
    v_mfma_f32_16x16x32_bf16 v[48:51], v[132:135], a[48:51], v[48:51]
    s_add_u32 s66, s69, 0
    s_add_u32 s58, s66, s76
    v_mfma_f32_16x16x32_bf16 v[52:55], v[132:135], a[52:55], v[52:55]
    buffer_load_dwordx4 v[128:131], v23, s[24:27], s58 offen offset:0 sc1
    v_mfma_f32_16x16x32_bf16 v[56:59], v[132:135], a[56:59], v[56:59]
    ds_read_b64_tr_b16 v[88:89], v16 offset:3072
    ds_read_b64_tr_b16 v[90:91], v16 offset:3584
    v_mfma_f32_16x16x32_bf16 v[60:63], v[132:135], a[60:63], v[60:63]
    ds_write_b128 v232, v[76:79] offset:34816
    s_waitcnt vmcnt(10)
    v_mfma_f32_16x16x32_bf16 v[48:51], v[136:139], a[64:67], v[48:51]
    v_mfma_f32_16x16x32_bf16 v[52:55], v[136:139], a[68:71], v[52:55]
    buffer_load_dwordx4 v[132:135], v23, s[24:27], s58 offen offset:1024 sc1
    v_mfma_f32_16x16x32_bf16 v[56:59], v[136:139], a[72:75], v[56:59]
    ds_read_b64_tr_b16 v[92:93], v16 offset:7168
    v_mfma_f32_16x16x32_bf16 v[60:63], v[136:139], a[76:79], v[60:63]
    ds_read_b64_tr_b16 v[94:95], v16 offset:7680
    s_waitcnt vmcnt(10)
    v_mfma_f32_16x16x32_bf16 v[48:51], v[140:143], a[80:83], v[48:51]
    s_add_u32 s58, s66, s77
    v_mfma_f32_16x16x32_bf16 v[52:55], v[140:143], a[84:87], v[52:55]
    buffer_load_dwordx4 v[136:139], v23, s[24:27], s58 offen offset:0 sc1
    v_mfma_f32_16x16x32_bf16 v[56:59], v[140:143], a[88:91], v[56:59]
    s_waitcnt lgkmcnt(2)
    s_barrier
    v_mfma_f32_16x16x32_bf16 v[60:63], v[140:143], a[92:95], v[60:63]
    buffer_load_dword v19, v21, s[24:27], 0 offen sc1
    s_waitcnt vmcnt(11)
    v_mfma_f32_16x16x32_bf16 v[48:51], v[144:147], a[96:99], v[48:51]
    ds_read_b128 v[68:71], v233 offset:32768
    v_mfma_f32_16x16x32_bf16 v[52:55], v[144:147], a[100:103], v[52:55]
    ds_read_b128 v[72:75], v234 offset:33792
    v_mfma_f32_16x16x32_bf16 v[56:59], v[144:147], a[104:107], v[56:59]
    ds_read_b128 v[76:79], v235 offset:34816
    v_mfma_f32_16x16x32_bf16 v[60:63], v[144:147], a[108:111], v[60:63]
    s_waitcnt vmcnt(10)
    v_mfma_f32_16x16x32_bf16 v[48:51], v[148:151], a[112:115], v[48:51]
    v_mfma_f32_16x16x32_bf16 v[52:55], v[148:151], a[116:119], v[52:55]
    buffer_load_dwordx4 v[140:143], v23, s[24:27], s58 offen offset:1024 sc1
    v_mfma_f32_16x16x32_bf16 v[56:59], v[148:151], a[120:123], v[56:59]
    ds_read_b64_tr_b16 a[240:241], v246 offset:4096
    v_mfma_f32_16x16x32_bf16 v[60:63], v[148:151], a[124:127], v[60:63]
    ds_read_b64_tr_b16 a[242:243], v246 offset:4608
    s_waitcnt vmcnt(10)
    v_mfma_f32_16x16x32_bf16 v[48:51], v[152:155], a[128:131], v[48:51]
    s_add_u32 s58, s66, s78
    s_waitcnt lgkmcnt(2)
    v_mfma_f32_16x16x32_bf16 v[52:55], v[152:155], a[132:135], v[52:55]
    buffer_load_dwordx4 v[144:147], v23, s[24:27], s58 offen offset:0 sc1
    v_mfma_f32_16x16x32_bf16 v[56:59], v[152:155], a[136:139], v[56:59]
    v_add_f32 v64, v64, v68
    v_add_f32 v65, v65, v69
    ds_read_b64_tr_b16 a[244:245], v247 offset:4096
    v_mfma_f32_16x16x32_bf16 v[60:63], v[152:155], a[140:143], v[60:63]
    ds_read_b64_tr_b16 a[246:247], v247 offset:4608
    s_waitcnt vmcnt(10)
    v_mfma_f32_16x16x32_bf16 v[48:51], v[156:159], a[144:147], v[48:51]
    v_add_f32 v66, v66, v70
    v_mfma_f32_16x16x32_bf16 v[52:55], v[156:159], a[148:151], v[52:55]
    buffer_load_dwordx4 v[148:151], v23, s[24:27], s58 offen offset:1024 sc1
    v_mfma_f32_16x16x32_bf16 v[56:59], v[156:159], a[152:155], v[56:59]
    v_add_f32 v67, v67, v71
    v_add_f32 v64, v64, v72
    ds_read_b64_tr_b16 a[248:249], v246 offset:4352
    v_mfma_f32_16x16x32_bf16 v[60:63], v[156:159], a[156:159], v[60:63]
    ds_read_b64_tr_b16 a[250:251], v246 offset:4864
    s_waitcnt vmcnt(10)
    v_mfma_f32_16x16x32_bf16 v[48:51], v[112:115], a[160:163], v[48:51]
    s_add_u32 s58, s66, s79
    v_add_f32 v65, v65, v73
    v_mfma_f32_16x16x32_bf16 v[52:55], v[112:115], a[164:167], v[52:55]
    buffer_load_dwordx4 v[152:155], v23, s[24:27], s58 offen offset:0 sc1
    v_mfma_f32_16x16x32_bf16 v[56:59], v[112:115], a[168:171], v[56:59]
    v_add_f32 v66, v66, v74
    v_add_f32 v67, v67, v75
    ds_read_b64_tr_b16 a[252:253], v247 offset:4352
    v_mfma_f32_16x16x32_bf16 v[60:63], v[112:115], a[172:175], v[60:63]
    ds_read_b64_tr_b16 a[254:255], v247 offset:4864
    s_waitcnt vmcnt(10)
    v_mfma_f32_16x16x32_bf16 v[48:51], v[116:119], a[176:179], v[48:51]
    v_mfma_f32_16x16x32_bf16 v[52:55], v[116:119], a[180:183], v[52:55]
    buffer_load_dwordx4 v[156:159], v23, s[24:27], s58 offen offset:1024 sc1
    v_mfma_f32_16x16x32_bf16 v[56:59], v[116:119], a[184:187], v[56:59]
    v_add_f32 v64, v64, v76
    v_add_f32 v65, v65, v77
    v_mfma_f32_16x16x32_bf16 v[60:63], v[116:119], a[188:191], v[60:63]
    v_add_f32 v66, v66, v78
    s_waitcnt vmcnt(10)
    v_mfma_f32_16x16x32_bf16 v[48:51], v[120:123], a[192:195], v[48:51]
    s_add_u32 s58, s66, s80
    v_mfma_f32_16x16x32_bf16 v[52:55], v[120:123], a[196:199], v[52:55]
    buffer_load_dwordx4 v[112:115], v23, s[24:27], s58 offen offset:0 sc1
    v_mfma_f32_16x16x32_bf16 v[56:59], v[120:123], a[200:203], v[56:59]
    v_add_f32 v67, v67, v79
    v_mfma_f32_16x16x32_bf16 v[60:63], v[120:123], a[204:207], v[60:63]
    s_waitcnt vmcnt(10)
    v_mfma_f32_16x16x32_bf16 v[48:51], v[124:127], a[208:211], v[48:51]
    v_mfma_f32_16x16x32_bf16 v[52:55], v[124:127], a[212:215], v[52:55]
    buffer_load_dwordx4 v[116:119], v23, s[24:27], s58 offen offset:1024 sc1
    v_mfma_f32_16x16x32_bf16 v[56:59], v[124:127], a[216:219], v[56:59]
    v_mfma_f32_16x16x32_bf16 v[60:63], v[124:127], a[220:223], v[60:63]
    s_waitcnt vmcnt(10)
    v_mfma_f32_16x16x32_bf16 v[32:35], v[128:131], a[0:3], v[32:35]
    s_add_u32 s58, s66, s81
    v_mfma_f32_16x16x32_bf16 v[36:39], v[128:131], a[4:7], 0
    buffer_load_dwordx4 v[120:123], v23, s[24:27], s58 offen offset:0 sc1
    v_mfma_f32_16x16x32_bf16 v[40:43], v[128:131], a[8:11], 0
    v_mfma_f32_16x16x32_bf16 v[44:47], v[128:131], a[12:15], 0
    s_waitcnt vmcnt(10)
    v_mfma_f32_16x16x32_bf16 v[32:35], v[132:135], a[16:19], v[32:35]
    ds_write_b128 v232, v[52:55] offset:16384
    v_mfma_f32_16x16x32_bf16 v[36:39], v[132:135], a[20:23], v[36:39]
    buffer_load_dwordx4 v[124:127], v23, s[24:27], s58 offen offset:1024 sc1
    v_mfma_f32_16x16x32_bf16 v[40:43], v[132:135], a[24:27], v[40:43]
    ds_read_b64_tr_b16 a[0:1], v246 offset:8192
    ds_read_b64_tr_b16 a[2:3], v246 offset:8704
    ds_read_b64_tr_b16 a[4:5], v247 offset:8192
    v_mfma_f32_16x16x32_bf16 v[44:47], v[132:135], a[28:31], v[44:47]
    ds_read_b64_tr_b16 a[6:7], v247 offset:8704
    s_waitcnt vmcnt(10)
    v_mfma_f32_16x16x32_bf16 v[32:35], v[136:139], a[32:35], v[32:35]
    s_add_u32 s58, s66, s82
    ds_write_b128 v232, v[56:59] offset:17408
    v_mfma_f32_16x16x32_bf16 v[36:39], v[136:139], a[36:39], v[36:39]
    buffer_load_dwordx4 v[128:131], v23, s[24:27], s58 offen offset:0 sc1
    v_mfma_f32_16x16x32_bf16 v[40:43], v[136:139], a[40:43], v[40:43]
    ds_read_b64_tr_b16 a[8:9], v246 offset:8448
    ds_read_b64_tr_b16 a[10:11], v246 offset:8960
    ds_read_b64_tr_b16 a[12:13], v247 offset:8448
    v_mfma_f32_16x16x32_bf16 v[44:47], v[136:139], a[44:47], v[44:47]
    ds_read_b64_tr_b16 a[14:15], v247 offset:8960
    buffer_load_dwordx4 v[132:135], v23, s[24:27], s58 offen offset:1024 sc1
    s_waitcnt vmcnt(11)
    v_cmp_ne_u32 vcc, s47, v19
    s_nop 0
    s_cbranch_vccz L_ok10
    s_mov_b32 s59, 100000
L_spin9:
    buffer_load_dword v19, v21, s[24:27], 0 offen sc1
    s_waitcnt vmcnt(0)
    v_cmp_ne_u32 vcc, s47, v19
    s_nop 0
    s_cbranch_vccz L_ok10
    s_sub_u32 s59, s59, 1
    s_cbranch_scc0 L_spin9
L_ok10:
    s_waitcnt vmcnt(10)
    v_mfma_f32_16x16x32_bf16 v[32:35], v[140:143], a[48:51], v[32:35]
    s_add_u32 s58, s70, 0
    ds_write_b128 v232, v[60:63] offset:18432
    v_mfma_f32_16x16x32_bf16 v[36:39], v[140:143], a[52:55], v[36:39]
    buffer_load_dwordx4 v[136:139], v23, s[24:27], s58 offen offset:0 sc1
    v_mfma_f32_16x16x32_bf16 v[40:43], v[140:143], a[56:59], v[40:43]
    ds_read_b64_tr_b16 a[16:17], v246 offset:12288
    ds_read_b64_tr_b16 a[18:19], v246 offset:12800
    ds_read_b64_tr_b16 a[20:21], v247 offset:12288
    v_mfma_f32_16x16x32_bf16 v[44:47], v[140:143], a[60:63], v[44:47]
    ds_read_b64_tr_b16 a[22:23], v247 offset:12800
    s_waitcnt vmcnt(10)
    v_mfma_f32_16x16x32_bf16 v[32:35], v[144:147], a[64:67], v[32:35]
    ds_read_b64_tr_b16 a[24:25], v246 offset:12544
    v_mfma_f32_16x16x32_bf16 v[36:39], v[144:147], a[68:71], v[36:39]
    buffer_load_dwordx4 v[140:143], v23, s[24:27], s58 offen offset:1024 sc1
    v_mfma_f32_16x16x32_bf16 v[40:43], v[144:147], a[72:75], v[40:43]
    ds_read_b64_tr_b16 a[26:27], v246 offset:13056
    ds_read_b64_tr_b16 a[28:29], v247 offset:12544
    v_mfma_f32_16x16x32_bf16 v[44:47], v[144:147], a[76:79], v[44:47]
    ds_read_b64_tr_b16 a[30:31], v247 offset:13056
    s_waitcnt vmcnt(10)
    v_mfma_f32_16x16x32_bf16 v[32:35], v[148:151], a[80:83], v[32:35]
    ds_read_b64_tr_b16 a[32:33], v246 offset:16384
    v_mfma_f32_16x16x32_bf16 v[36:39], v[148:151], a[84:87], v[36:39]
    buffer_load_dwordx4 v[144:147], v23, s[24:27], s58 offen offset:2048 sc1
    v_mfma_f32_16x16x32_bf16 v[40:43], v[148:151], a[88:91], v[40:43]
    ds_read_b64_tr_b16 a[34:35], v246 offset:16896
    ds_read_b64_tr_b16 a[36:37], v247 offset:16384
    v_mfma_f32_16x16x32_bf16 v[44:47], v[148:151], a[92:95], v[44:47]
    ds_read_b64_tr_b16 a[38:39], v247 offset:16896
    s_waitcnt vmcnt(10)
    v_mfma_f32_16x16x32_bf16 v[32:35], v[152:155], a[96:99], v[32:35]
    ds_read_b64_tr_b16 a[40:41], v246 offset:16640
    v_mfma_f32_16x16x32_bf16 v[36:39], v[152:155], a[100:103], v[36:39]
    buffer_load_dwordx4 v[148:151], v23, s[24:27], s58 offen offset:3072 sc1
    v_mfma_f32_16x16x32_bf16 v[40:43], v[152:155], a[104:107], v[40:43]
    ds_read_b64_tr_b16 a[42:43], v246 offset:17152
    ds_read_b64_tr_b16 a[44:45], v247 offset:16640
    v_mfma_f32_16x16x32_bf16 v[44:47], v[152:155], a[108:111], v[44:47]
    ds_read_b64_tr_b16 a[46:47], v247 offset:17152
    s_waitcnt vmcnt(10)
    v_mfma_f32_16x16x32_bf16 v[32:35], v[156:159], a[112:115], v[32:35]
    s_add_u32 s58, s70, 4096
    ds_read_b64_tr_b16 a[48:49], v246 offset:20480
    v_mfma_f32_16x16x32_bf16 v[36:39], v[156:159], a[116:119], v[36:39]
    buffer_load_dwordx4 v[152:155], v23, s[24:27], s58 offen offset:0 sc1
    v_mfma_f32_16x16x32_bf16 v[40:43], v[156:159], a[120:123], v[40:43]
    ds_read_b64_tr_b16 a[50:51], v246 offset:20992
    ds_read_b64_tr_b16 a[52:53], v247 offset:20480
    v_mfma_f32_16x16x32_bf16 v[44:47], v[156:159], a[124:127], v[44:47]
    ds_read_b64_tr_b16 a[54:55], v247 offset:20992
    s_waitcnt vmcnt(10)
    v_mfma_f32_16x16x32_bf16 v[32:35], v[112:115], a[128:131], v[32:35]
    ds_read_b64_tr_b16 a[56:57], v246 offset:20736
    v_mfma_f32_16x16x32_bf16 v[36:39], v[112:115], a[132:135], v[36:39]
    buffer_load_dwordx4 v[156:159], v23, s[24:27], s58 offen offset:1024 sc1
    v_mfma_f32_16x16x32_bf16 v[40:43], v[112:115], a[136:139], v[40:43]
    ds_read_b64_tr_b16 a[58:59], v246 offset:21248
    ds_read_b64_tr_b16 a[60:61], v247 offset:20736
    v_mfma_f32_16x16x32_bf16 v[44:47], v[112:115], a[140:143], v[44:47]
    ds_read_b64_tr_b16 a[62:63], v247 offset:21248
    s_waitcnt vmcnt(10)
    v_mfma_f32_16x16x32_bf16 v[32:35], v[116:119], a[144:147], v[32:35]
    ds_read_b64_tr_b16 a[64:65], v246 offset:24576
    v_mfma_f32_16x16x32_bf16 v[36:39], v[116:119], a[148:151], v[36:39]
    buffer_load_dwordx4 v[112:115], v23, s[24:27], s58 offen offset:2048 sc1
    v_mfma_f32_16x16x32_bf16 v[40:43], v[116:119], a[152:155], v[40:43]
    ds_read_b64_tr_b16 a[66:67], v246 offset:25088
    ds_read_b64_tr_b16 a[68:69], v247 offset:24576
    v_mfma_f32_16x16x32_bf16 v[44:47], v[116:119], a[156:159], v[44:47]
    ds_read_b64_tr_b16 a[70:71], v247 offset:25088
    s_waitcnt vmcnt(10)
    v_mfma_f32_16x16x32_bf16 v[32:35], v[120:123], a[160:163], v[32:35]
    ds_read_b64_tr_b16 a[72:73], v246 offset:24832
    v_mfma_f32_16x16x32_bf16 v[36:39], v[120:123], a[164:167], v[36:39]
    buffer_load_dwordx4 v[116:119], v23, s[24:27], s58 offen offset:3072 sc1
    v_mfma_f32_16x16x32_bf16 v[40:43], v[120:123], a[168:171], v[40:43]
    ds_read_b64_tr_b16 a[74:75], v246 offset:25344
    ds_read_b64_tr_b16 a[76:77], v247 offset:24832
    v_mfma_f32_16x16x32_bf16 v[44:47], v[120:123], a[172:175], v[44:47]
    ds_read_b64_tr_b16 a[78:79], v247 offset:25344
    s_waitcnt vmcnt(10)
    v_mfma_f32_16x16x32_bf16 v[32:35], v[124:127], a[176:179], v[32:35]
    s_add_u32 s58, s70, 8192
    ds_read_b64_tr_b16 a[80:81], v246 offset:28672
    v_mfma_f32_16x16x32_bf16 v[36:39], v[124:127], a[180:183], v[36:39]
    buffer_load_dwordx4 v[120:123], v23, s[24:27], s58 offen offset:0 sc1
    v_mfma_f32_16x16x32_bf16 v[40:43], v[124:127], a[184:187], v[40:43]
    ds_read_b64_tr_b16 a[82:83], v246 offset:29184
    ds_read_b64_tr_b16 a[84:85], v247 offset:28672
    v_mfma_f32_16x16x32_bf16 v[44:47], v[124:127], a[188:191], v[44:47]
    ds_read_b64_tr_b16 a[86:87], v247 offset:29184
    s_waitcnt vmcnt(10)
    v_mfma_f32_16x16x32_bf16 v[32:35], v[128:131], a[192:195], v[32:35]
    ds_read_b64_tr_b16 a[88:89], v246 offset:28928
    v_mfma_f32_16x16x32_bf16 v[36:39], v[128:131], a[196:199], v[36:39]
    buffer_load_dwordx4 v[124:127], v23, s[24:27], s58 offen offset:1024 sc1
    v_mfma_f32_16x16x32_bf16 v[40:43], v[128:131], a[200:203], v[40:43]
    ds_read_b64_tr_b16 a[90:91], v246 offset:29440
    ds_read_b64_tr_b16 a[92:93], v247 offset:28928
    v_mfma_f32_16x16x32_bf16 v[44:47], v[128:131], a[204:207], v[44:47]
    ds_read_b64_tr_b16 a[94:95], v247 offset:29440
    s_waitcnt vmcnt(10)
    v_mfma_f32_16x16x32_bf16 v[32:35], v[132:135], a[208:211], v[32:35]
    ds_read_b64_tr_b16 a[96:97], v246 offset:32768
    v_mfma_f32_16x16x32_bf16 v[36:39], v[132:135], a[212:215], v[36:39]
    buffer_load_dwordx4 v[128:131], v23, s[24:27], s58 offen offset:2048 sc1
    v_mfma_f32_16x16x32_bf16 v[40:43], v[132:135], a[216:219], v[40:43]
    ds_read_b64_tr_b16 a[98:99], v246 offset:33280
    ds_read_b64_tr_b16 a[100:101], v247 offset:32768
    v_mfma_f32_16x16x32_bf16 v[44:47], v[132:135], a[220:223], v[44:47]
    ds_read_b64_tr_b16 a[102:103], v247 offset:33280
    s_waitcnt vmcnt(10)
    v_mfma_f32_16x16x32_bf16 v[32:35], a[224:227], v[136:139], v[32:35]
    v_mfma_f32_16x16x32_bf16 v[48:51], a[228:231], v[136:139], v[48:51]
    buffer_load_dwordx4 v[132:135], v23, s[24:27], s58 offen offset:3072 sc1
    v_mfma_f32_16x16x32_bf16 v[64:67], a[232:235], v[136:139], v[64:67]
    ds_read_b64_tr_b16 a[104:105], v246 offset:33024
    ds_read_b64_tr_b16 a[106:107], v246 offset:33536
    v_mfma_f32_16x16x32_bf16 v[80:83], a[236:239], v[136:139], v[80:83]
    ds_read_b64_tr_b16 a[108:109], v247 offset:33024
    ds_read_b64_tr_b16 a[110:111], v247 offset:33536
    v_mfma_f32_16x16x32_bf16 v[96:99], v[160:163], v[136:139], v[96:99]
    ds_read_b64_tr_b16 a[112:113], v246 offset:36864
    s_waitcnt lgkmcnt(15)
    s_waitcnt vmcnt(10)
    v_mfma_f32_16x16x32_bf16 v[32:35], a[240:243], v[140:143], v[32:35]
    s_add_u32 s58, s70, 12288
    v_mfma_f32_16x16x32_bf16 v[48:51], a[244:247], v[140:143], v[48:51]
    buffer_load_dwordx4 v[136:139], v23, s[24:27], s58 offen offset:0 sc1
    v_mfma_f32_16x16x32_bf16 v[64:67], a[248:251], v[140:143], v[64:67]
    ds_read_b64_tr_b16 a[114:115], v246 offset:37376
    ds_read_b64_tr_b16 a[116:117], v247 offset:36864
    v_mfma_f32_16x16x32_bf16 v[80:83], a[252:255], v[140:143], v[80:83]
    ds_read_b64_tr_b16 a[118:119], v247 offset:37376
    ds_read_b64_tr_b16 a[120:121], v246 offset:37120
    v_mfma_f32_16x16x32_bf16 v[96:99], v[164:167], v[140:143], v[96:99]
    ds_write_b128 v232, v[36:39] offset:0
    s_waitcnt vmcnt(10)
    v_mfma_f32_16x16x32_bf16 v[32:35], a[0:3], v[144:147], v[32:35]
    v_mfma_f32_16x16x32_bf16 v[48:51], a[4:7], v[144:147], v[48:51]
    buffer_load_dwordx4 v[140:143], v23, s[24:27], s58 offen offset:1024 sc1
    v_mfma_f32_16x16x32_bf16 v[64:67], a[8:11], v[144:147], v[64:67]
    ds_read_b64_tr_b16 a[122:123], v246 offset:37632
    ds_read_b64_tr_b16 a[124:125], v247 offset:37120
    v_mfma_f32_16x16x32_bf16 v[80:83], a[12:15], v[144:147], v[80:83]
    ds_read_b64_tr_b16 a[126:127], v247 offset:37632
    ds_read_b64_tr_b16 a[128:129], v246 offset:40960
    v_mfma_f32_16x16x32_bf16 v[96:99], v[168:171], v[144:147], v[96:99]
    ds_write_b128 v232, v[40:43] offset:1024
    s_waitcnt vmcnt(10)
    v_mfma_f32_16x16x32_bf16 v[32:35], a[16:19], v[148:151], v[32:35]
    ds_read_b64_tr_b16 a[130:131], v246 offset:41472
    v_mfma_f32_16x16x32_bf16 v[48:51], a[20:23], v[148:151], v[48:51]
    ds_read_b64_tr_b16 a[132:133], v247 offset:40960
    v_mfma_f32_16x16x32_bf16 v[64:67], a[24:27], v[148:151], v[64:67]
    ds_read_b64_tr_b16 a[134:135], v247 offset:41472
    v_mfma_f32_16x16x32_bf16 v[80:83], a[28:31], v[148:151], v[80:83]
    ds_read_b64_tr_b16 a[136:137], v246 offset:41216
    v_mfma_f32_16x16x32_bf16 v[96:99], v[172:175], v[148:151], v[96:99]
    ds_write_b128 v232, v[44:47] offset:2048
    s_waitcnt vmcnt(9)
    v_mfma_f32_16x16x32_bf16 v[32:35], a[32:35], v[152:155], v[32:35]
    ds_read_b64_tr_b16 a[138:139], v246 offset:41728
    v_mfma_f32_16x16x32_bf16 v[48:51], a[36:39], v[152:155], v[48:51]
    ds_read_b64_tr_b16 a[140:141], v247 offset:41216
    v_mfma_f32_16x16x32_bf16 v[64:67], a[40:43], v[152:155], v[64:67]
    ds_read_b64_tr_b16 a[142:143], v247 offset:41728
    v_mfma_f32_16x16x32_bf16 v[80:83], a[44:47], v[152:155], v[80:83]
    ds_read_b64_tr_b16 a[144:145], v246 offset:45056
    v_mfma_f32_16x16x32_bf16 v[96:99], v[192:195], v[152:155], v[96:99]
    ds_read_b64_tr_b16 a[146:147], v246 offset:45568
    s_waitcnt vmcnt(8)
    v_mfma_f32_16x16x32_bf16 v[32:35], a[48:51], v[156:159], v[32:35]
    ds_read_b64_tr_b16 a[148:149], v247 offset:45056
    v_mfma_f32_16x16x32_bf16 v[48:51], a[52:55], v[156:159], v[48:51]
    ds_read_b64_tr_b16 a[150:151], v247 offset:45568
    v_mfma_f32_16x16x32_bf16 v[64:67], a[56:59], v[156:159], v[64:67]
    ds_read_b64_tr_b16 a[152:153], v246 offset:45312
    v_mfma_f32_16x16x32_bf16 v[80:83], a[60:63], v[156:159], v[80:83]
    ds_read_b64_tr_b16 a[154:155], v246 offset:45824
    v_mfma_f32_16x16x32_bf16 v[96:99], v[196:199], v[156:159], v[96:99]
    s_waitcnt lgkmcnt(9)
    s_barrier
    s_waitcnt vmcnt(7)
    v_mfma_f32_16x16x32_bf16 v[32:35], a[64:67], v[112:115], v[32:35]
    ds_read_b64_tr_b16 a[156:157], v247 offset:45312
    ds_read_b64_tr_b16 a[158:159], v247 offset:45824
    v_mfma_f32_16x16x32_bf16 v[48:51], a[68:71], v[112:115], v[48:51]
    ds_read_b64_tr_b16 a[160:161], v248 offset:49152
    ds_read_b64_tr_b16 a[162:163], v248 offset:49664
    v_mfma_f32_16x16x32_bf16 v[64:67], a[72:75], v[112:115], v[64:67]
    ds_read_b128 v[52:55], v233 offset:16384
    v_mfma_f32_16x16x32_bf16 v[80:83], a[76:79], v[112:115], v[80:83]
    ds_read_b128 v[56:59], v234 offset:17408
    v_mfma_f32_16x16x32_bf16 v[96:99], v[200:203], v[112:115], v[96:99]
    ds_read_b128 v[60:63], v235 offset:18432
    s_waitcnt vmcnt(6)
    v_mfma_f32_16x16x32_bf16 v[32:35], a[80:83], v[116:119], v[32:35]
    ds_read_b64_tr_b16 a[164:165], v249 offset:49152
    ds_read_b64_tr_b16 a[166:167], v249 offset:49664
    v_mfma_f32_16x16x32_bf16 v[48:51], a[84:87], v[116:119], v[48:51]
    ds_read_b64_tr_b16 a[168:169], v248 offset:49408
    ds_read_b64_tr_b16 a[170:171], v248 offset:49920
    v_mfma_f32_16x16x32_bf16 v[64:67], a[88:91], v[116:119], v[64:67]
    ds_read_b128 v[36:39], v233 offset:0
    v_mfma_f32_16x16x32_bf16 v[80:83], a[92:95], v[116:119], v[80:83]
    ds_read_b128 v[40:43], v234 offset:1024
    v_mfma_f32_16x16x32_bf16 v[96:99], v[204:207], v[116:119], v[96:99]
    ds_read_b128 v[44:47], v235 offset:2048
    s_waitcnt vmcnt(5)
    v_mfma_f32_16x16x32_bf16 v[32:35], a[96:99], v[120:123], v[32:35]
    ds_read_b64_tr_b16 a[172:173], v249 offset:49408
    v_mfma_f32_16x16x32_bf16 v[48:51], a[100:103], v[120:123], v[48:51]
    ds_read_b64_tr_b16 a[174:175], v249 offset:49920
    v_mfma_f32_16x16x32_bf16 v[64:67], a[104:107], v[120:123], v[64:67]
    ds_read_b64_tr_b16 a[176:177], v248 offset:50176
    v_mfma_f32_16x16x32_bf16 v[80:83], a[108:111], v[120:123], v[80:83]
    ds_read_b64_tr_b16 a[178:179], v248 offset:50688
    v_mfma_f32_16x16x32_bf16 v[96:99], v[100:103], v[120:123], v[96:99]
    ds_read_b64_tr_b16 a[180:181], v249 offset:50176
    s_waitcnt vmcnt(4)
    v_mfma_f32_16x16x32_bf16 v[32:35], a[112:115], v[124:127], v[32:35]
    ds_read_b64_tr_b16 a[182:183], v249 offset:50688
    v_mfma_f32_16x16x32_bf16 v[48:51], a[116:119], v[124:127], v[48:51]
    ds_read_b64_tr_b16 a[184:185], v248 offset:50432
    v_mfma_f32_16x16x32_bf16 v[64:67], a[120:123], v[124:127], v[64:67]
    ds_read_b64_tr_b16 a[186:187], v248 offset:50944
    v_mfma_f32_16x16x32_bf16 v[80:83], a[124:127], v[124:127], v[80:83]
    ds_read_b64_tr_b16 a[188:189], v249 offset:50432
    v_mfma_f32_16x16x32_bf16 v[96:99], v[104:107], v[124:127], v[96:99]
    ds_read_b64_tr_b16 a[190:191], v249 offset:50944
    s_waitcnt lgkmcnt(15)
    s_waitcnt vmcnt(3)
    v_mfma_f32_16x16x32_bf16 v[32:35], a[128:131], v[128:131], v[32:35]
    v_mfma_f32_16x16x32_bf16 v[48:51], a[132:135], v[128:131], v[48:51]
    v_add_f32 v52, v52, v56
    v_mfma_f32_16x16x32_bf16 v[64:67], a[136:139], v[128:131], v[64:67]
    v_add_f32 v53, v53, v57
    v_mfma_f32_16x16x32_bf16 v[80:83], a[140:143], v[128:131], v[80:83]
    v_add_f32 v54, v54, v58
    v_mfma_f32_16x16x32_bf16 v[96:99], v[108:111], v[128:131], v[96:99]
    v_add_f32 v55, v55, v59
    s_waitcnt vmcnt(2)
    v_mfma_f32_16x16x32_bf16 v[32:35], a[144:147], v[132:135], v[32:35]
    v_add_f32 v52, v52, v60
    v_mfma_f32_16x16x32_bf16 v[48:51], a[148:151], v[132:135], v[48:51]
    v_add_f32 v53, v53, v61
    v_mfma_f32_16x16x32_bf16 v[64:67], a[152:155], v[132:135], v[64:67]
    v_add_f32 v54, v54, v62
    v_mfma_f32_16x16x32_bf16 v[80:83], a[156:159], v[132:135], v[80:83]
    v_add_f32 v55, v55, v63
    v_mfma_f32_16x16x32_bf16 v[96:99], v[84:87], v[132:135], v[96:99]
    s_waitcnt lgkmcnt(10)
    s_waitcnt lgkmcnt(8)
    s_waitcnt vmcnt(1)
    v_mfma_f32_16x16x32_bf16 v[32:35], a[160:163], v[136:139], v[32:35]
    v_add_f32 v36, v36, v40
    v_mfma_f32_16x16x32_bf16 v[48:51], a[164:167], v[136:139], v[48:51]
    v_add_f32 v37, v37, v41
    v_mfma_f32_16x16x32_bf16 v[64:67], a[168:171], v[136:139], v[64:67]
    v_add_f32 v38, v38, v42
    v_mfma_f32_16x16x32_bf16 v[80:83], a[172:175], v[136:139], v[80:83]
    v_add_f32 v39, v39, v43
    v_mfma_f32_16x16x32_bf16 v[96:99], v[88:91], v[136:139], v[96:99]
    v_add_f32 v36, v36, v44
    s_waitcnt lgkmcnt(0)
    s_waitcnt vmcnt(0)
    v_mfma_f32_16x16x32_bf16 v[32:35], a[176:179], v[140:143], v[32:35]
    v_add_f32 v37, v37, v45
    v_mfma_f32_16x16x32_bf16 v[48:51], a[180:183], v[140:143], v[48:51]
    v_add_f32 v38, v38, v46
    v_mfma_f32_16x16x32_bf16 v[64:67], a[184:187], v[140:143], v[64:67]
    v_add_f32 v39, v39, v47
    v_mfma_f32_16x16x32_bf16 v[80:83], a[188:191], v[140:143], v[80:83]
    v_mfma_f32_16x16x32_bf16 v[96:99], v[92:95], v[140:143], v[96:99]
    s_nop 0
    v_pk_add_f32 v[32:33], v[32:33], v[36:37]
    v_pk_add_f32 v[34:35], v[34:35], v[38:39]
    v_pk_add_f32 v[48:49], v[48:49], v[52:53]
    v_pk_add_f32 v[50:51], v[50:51], v[54:55]
    v_cvt_pk_bf16_f32 v176, v32, v33
    v_cvt_pk_bf16_f32 v177, v34, v35
    ds_write_b64 v238, v[176:177] offset:0
    v_cvt_pk_bf16_f32 v178, v48, v49
    v_cvt_pk_bf16_f32 v179, v50, v51
    ds_write_b64 v238, v[178:179] offset:32
    v_cvt_pk_bf16_f32 v180, v64, v65
    v_cvt_pk_bf16_f32 v181, v66, v67
    ds_write_b64 v238, v[180:181] offset:64
    v_cvt_pk_bf16_f32 v182, v80, v81
    v_cvt_pk_bf16_f32 v183, v82, v83
    ds_write_b64 v238, v[182:183] offset:96
    ds_read_b128 v[216:219], v244 offset:0
    ds_read_b128 v[220:223], v244 offset:1408
    v_cvt_pk_bf16_f32 v184, v96, v97
    v_cvt_pk_bf16_f32 v185, v98, v99
    ds_write_b64 v238, v[184:185] offset:128
    ds_read_b64 v[224:225], v252 offset:128
    s_waitcnt lgkmcnt(3)
    buffer_store_dwordx4 v[216:219], v22, s[28:31], s71 offen
    s_waitcnt lgkmcnt(2)
    buffer_store_dwordx4 v[220:223], v22, s[28:31], s72 offen
    s_waitcnt lgkmcnt(0)
    buffer_store_dwordx2 v[224:225], v26, s[28:31], s73 offen
L_end:
    s_endpgm
L_p2_alt:
    s_add_u32 s57, s57, 27648
    buffer_load_dwordx4 v11, s[16:19], s57 offen offset:3072 lds
    s_xor_b32 s66, s44, 3
    s_lshl2_add_u32 s66, s51, s66
    s_mul_i32 s66, s66, 66816
    s_lshl2_add_u32 s66, s52, s66
    s_lshl_b32 s86, s65, 10
    s_add_u32 s58, s86, s66
    s_add_u32 s86, s66, 13312
    buffer_load_dwordx4 v[128:131], v23, s[24:27], s58 offen offset:0 sc1
    s_add_u32 s58, s58, 1024
    s_cmp_eq_u32 s58, s86
    s_cselect_b32 s58, s66, s58
    buffer_load_dwordx4 v[132:135], v23, s[24:27], s58 offen offset:0 sc1
    s_add_u32 s58, s58, 1024
    s_cmp_eq_u32 s58, s86
    s_cselect_b32 s58, s66, s58
    buffer_load_dwordx4 v[136:139], v23, s[24:27], s58 offen offset:0 sc1
    s_add_u32 s58, s58, 1024
    s_cmp_eq_u32 s58, s86
    s_cselect_b32 s58, s66, s58
    buffer_load_dwordx4 v[140:143], v23, s[24:27], s58 offen offset:0 sc1
    s_add_u32 s58, s58, 1024
    s_cmp_eq_u32 s58, s86
    s_cselect_b32 s58, s66, s58
    buffer_load_dwordx4 v[144:147], v23, s[24:27], s58 offen offset:0 sc1
    s_add_u32 s58, s58, 1024
    s_cmp_eq_u32 s58, s86
    s_cselect_b32 s58, s66, s58
    buffer_load_dwordx4 v[148:151], v23, s[24:27], s58 offen offset:0 sc1
    s_add_u32 s58, s58, 1024
    s_cmp_eq_u32 s58, s86
    s_cselect_b32 s58, s66, s58
    buffer_load_dwordx4 v[152:155], v23, s[24:27], s58 offen offset:0 sc1
    s_add_u32 s58, s58, 1024
    s_cmp_eq_u32 s58, s86
    s_cselect_b32 s58, s66, s58
    buffer_load_dwordx4 v[156:159], v23, s[24:27], s58 offen offset:0 sc1
    s_add_u32 s58, s58, 1024
    s_cmp_eq_u32 s58, s86
    s_cselect_b32 s58, s66, s58
    buffer_load_dwordx4 v[112:115], v23, s[24:27], s58 offen offset:0 sc1
    s_add_u32 s58, s58, 1024
    s_cmp_eq_u32 s58, s86
    s_cselect_b32 s58, s66, s58
    buffer_load_dwordx4 v[116:119], v23, s[24:27], s58 offen offset:0 sc1
    s_add_u32 s58, s58, 1024
    s_cmp_eq_u32 s58, s86
    s_cselect_b32 s58, s66, s58
    buffer_load_dwordx4 v[120:123], v23, s[24:27], s58 offen offset:0 sc1
    s_waitcnt vmcnt(19)
    ds_read_b64_tr_b16 a[208:209], v4 offset:32768
    ds_read_b64_tr_b16 a[210:211], v4 offset:33280
    ds_read_b64_tr_b16 a[212:213], v5 offset:32768
    ds_read_b64_tr_b16 a[214:215], v5 offset:33280
    ds_read_b64_tr_b16 a[216:217], v4 offset:33024
    ds_read_b64_tr_b16 a[218:219], v4 offset:33536
    ds_read_b64_tr_b16 a[220:221], v5 offset:33024
    ds_read_b64_tr_b16 a[222:223], v5 offset:33536
    s_waitcnt vmcnt(15)
    ds_read_b64_tr_b16 a[224:225], v2 offset:0
    ds_read_b64_tr_b16 a[226:227], v2 offset:512
    ds_read_b64_tr_b16 a[228:229], v3 offset:0
    ds_read_b64_tr_b16 a[230:231], v3 offset:512
    ds_read_b64_tr_b16 a[232:233], v2 offset:256
    ds_read_b64_tr_b16 a[234:235], v2 offset:768
    ds_read_b64_tr_b16 a[236:237], v3 offset:256
    ds_read_b64_tr_b16 a[238:239], v3 offset:768
    s_waitcnt vmcnt(11)
    ds_read_b64_tr_b16 a[240:241], v2 offset:16384
    ds_read_b64_tr_b16 a[242:243], v2 offset:16896
    ds_read_b64_tr_b16 a[244:245], v3 offset:16384
    ds_read_b64_tr_b16 a[246:247], v3 offset:16896
    ds_read_b64_tr_b16 a[248:249], v2 offset:16640
    ds_read_b64_tr_b16 a[250:251], v2 offset:17152
    ds_read_b64_tr_b16 a[252:253], v3 offset:16640
    ds_read_b64_tr_b16 a[254:255], v3 offset:17152
    s_waitcnt lgkmcnt(0)
    s_branch L_p2_join
L_p3_alt:
    s_add_u32 s66, s69, 175872
    s_add_u32 s58, s66, s76
    buffer_load_dwordx4 v[152:155], v23, s[24:27], s58 offen offset:0 sc1
    buffer_load_dwordx4 v[156:159], v23, s[24:27], s58 offen offset:1024 sc1
    s_add_u32 s58, s66, s77
    buffer_load_dwordx4 v[112:115], v23, s[24:27], s58 offen offset:0 sc1
    buffer_load_dwordx4 v[116:119], v23, s[24:27], s58 offen offset:1024 sc1
    s_add_u32 s58, s66, s78
    buffer_load_dwordx4 v[120:123], v23, s[24:27], s58 offen offset:0 sc1
    buffer_load_dwordx4 v[124:127], v23, s[24:27], s58 offen offset:1024 sc1
    s_add_u32 s58, s66, s79
    buffer_load_dwordx4 v[128:131], v23, s[24:27], s58 offen offset:0 sc1
    buffer_load_dwordx4 v[132:135], v23, s[24:27], s58 offen offset:1024 sc1
    s_add_u32 s58, s66, s80
    buffer_load_dwordx4 v[136:139], v23, s[24:27], s58 offen offset:0 sc1
    buffer_load_dwordx4 v[140:143], v23, s[24:27], s58 offen offset:1024 sc1
    s_add_u32 s58, s66, s81
    buffer_load_dwordx4 v[144:147], v23, s[24:27], s58 offen offset:0 sc1
    s_waitcnt vmcnt(11) lgkmcnt(0)
    s_branch L_p3_join
L_help:
    s_sub_u32 s55, s46, 21
    v_lshlrev_b32 v217, 7, v1
    v_lshrrev_b32 v218, 2, v1
    v_lshlrev_b32 v218, 12, v218
    v_lshl_add_u32 v218, v210, 7, v218
    v_mul_u32_u24 v220, 3584, v1
    s_lshl4_add_u32 s54, s44, s65
    s_mul_i32 s54, s54, 114688
    s_lshl_b32 s56, s50, 7
    s_add_u32 s54, s54, s56
    buffer_load_dword v108, v220, s[16:19], s54 offen
    v_mul_u32_u24 v109, 1088, v25
    v_lshl_add_u32 v109, v26, 4, v109
    v_mul_u32_u24 v110, 1088, v209
    v_lshl_add_u32 v110, v208, 5, v110
    v_lshl_add_u32 v110, v210, 3, v110
    s_lshl_b32 s53, s44, 7
    v_add_u32 v110, s53, v110
    v_mul_u32_u24 v111, 66816, v208
    v_lshl_add_u32 v111, v211, 4, v111
    s_mul_i32 s63, s44, 267264
    s_lshl_b32 s53, s2, 8
    s_add_u32 s63, s63, s53
    s_add_u32 s64, s63, 1069056
    v_cmp_gt_u32 vcc, 208, v0
    v_mov_b32 v100, 2130706432
    v_cmp_le_u32 s[92:93], 24, v26
    v_cndmask_b32 v22, v100, v111, vcc
    s_mov_b32 s62, 0x3f803f80
    s_mov_b32 s61, 0xffff0000
    v_mov_b32 v96, 0
    v_mov_b32 v97, 0
    s_waitcnt vmcnt(3)
    v_dot2c_f32_bf16 v96, s62, v32
    v_dot2c_f32_bf16 v97, v32, v32
    v_lshlrev_b32 v40, 16, v32
    v_and_b32 v41, s61, v32
    v_dot2c_f32_bf16 v96, s62, v33
    v_dot2c_f32_bf16 v97, v33, v33
    v_lshlrev_b32 v42, 16, v33
    v_and_b32 v43, s61, v33
    v_dot2c_f32_bf16 v96, s62, v34
    v_dot2c_f32_bf16 v97, v34, v34
    v_lshlrev_b32 v44, 16, v34
    v_and_b32 v45, s61, v34
    v_dot2c_f32_bf16 v96, s62, v35
    v_dot2c_f32_bf16 v97, v35, v35
    v_lshlrev_b32 v46, 16, v35
    v_and_b32 v47, s61, v35
    s_waitcnt vmcnt(2)
    v_dot2c_f32_bf16 v96, s62, v36
    v_dot2c_f32_bf16 v97, v36, v36
    v_lshlrev_b32 v48, 16, v36
    v_and_b32 v49, s61, v36
    v_dot2c_f32_bf16 v96, s62, v37
    v_dot2c_f32_bf16 v97, v37, v37
    v_lshlrev_b32 v50, 16, v37
    v_and_b32 v51, s61, v37
    v_dot2c_f32_bf16 v96, s62, v38
    v_dot2c_f32_bf16 v97, v38, v38
    v_lshlrev_b32 v52, 16, v38
    v_and_b32 v53, s61, v38
    v_dot2c_f32_bf16 v96, s62, v39
    v_dot2c_f32_bf16 v97, v39, v39
    v_lshlrev_b32 v54, 16, v39
    v_and_b32 v55, s61, v39
    buffer_load_dword v29, off, s[40:43], 0 sc1
    v_add_f32_dpp v96, v96, v96 quad_perm:[1,0,3,2] row_mask:0xf bank_mask:0xf
    v_add_f32_dpp v97, v97, v97 quad_perm:[1,0,3,2] row_mask:0xf bank_mask:0xf
    s_nop 0
    v_add_f32_dpp v96, v96, v96 quad_perm:[2,3,0,1] row_mask:0xf bank_mask:0xf
    v_add_f32_dpp v97, v97, v97 quad_perm:[2,3,0,1] row_mask:0xf bank_mask:0xf
    s_nop 0
    v_add_f32_dpp v96, v96, v96 row_half_mirror row_mask:0xf bank_mask:0xf
    v_add_f32_dpp v97, v97, v97 row_half_mirror row_mask:0xf bank_mask:0xf
    s_nop 0
    v_add_f32_dpp v96, v96, v96 row_mirror row_mask:0xf bank_mask:0xf
    v_add_f32_dpp v97, v97, v97 row_mirror row_mask:0xf bank_mask:0xf
    v_mov_b32 v98, v96
    v_mov_b32 v99, v97
    s_nop 0
    v_permlane16_swap_b32 v96, v98
    v_permlane16_swap_b32 v97, v99
    v_add_f32 v96, v96, v98
    v_add_f32 v97, v97, v99
    v_mul_f32 v98, 0x3b124925, v96
    v_mul_f32 v99, 0x3b124925, v97
    v_fma_f32 v99, -v98, v98, v99
    v_max_f32 v99, 0, v99
    v_cvt_pk_bf16_f32 v100, 0, v99
    v_add_f32 v100, 0x3727c5ac, v100
    v_cvt_pk_bf16_f32 v100, 0, v100
    v_sqrt_f32 v100, v100
    s_nop 0
    v_cvt_pk_bf16_f32 v100, 0, v100
    v_rcp_f32 v100, v100
    s_nop 0
    v_mul_f32 v99, v99, v100
    v_mul_f32 v99, v99, v100
    v_cvt_pk_bf16_f32 v104, 0, v99
    v_add_f32 v104, 0x3727c5ac, v104
    v_cvt_pk_bf16_f32 v104, 0, v104
    v_sqrt_f32 v104, v104
    s_nop 0
    v_cvt_pk_bf16_f32 v102, 0, v104
    v_rcp_f32 v104, v102
    s_nop 0
    v_mul_f32 v104, v104, v100
    v_mul_f32 v106, v98, v104
    v_pk_fma_f32 v[56:57], v[40:41], v[104:105], v[106:107] op_sel_hi:[1,0,0] neg_lo:[0,0,1] neg_hi:[0,0,1]
    v_pk_fma_f32 v[58:59], v[42:43], v[104:105], v[106:107] op_sel_hi:[1,0,0] neg_lo:[0,0,1] neg_hi:[0,0,1]
    v_pk_fma_f32 v[60:61], v[44:45], v[104:105], v[106:107] op_sel_hi:[1,0,0] neg_lo:[0,0,1] neg_hi:[0,0,1]
    v_pk_fma_f32 v[62:63], v[46:47], v[104:105], v[106:107] op_sel_hi:[1,0,0] neg_lo:[0,0,1] neg_hi:[0,0,1]
    v_pk_fma_f32 v[64:65], v[48:49], v[104:105], v[106:107] op_sel_hi:[1,0,0] neg_lo:[0,0,1] neg_hi:[0,0,1]
    v_pk_fma_f32 v[66:67], v[50:51], v[104:105], v[106:107] op_sel_hi:[1,0,0] neg_lo:[0,0,1] neg_hi:[0,0,1]
    v_pk_fma_f32 v[68:69], v[52:53], v[104:105], v[106:107] op_sel_hi:[1,0,0] neg_lo:[0,0,1] neg_hi:[0,0,1]
    v_pk_fma_f32 v[70:71], v[54:55], v[104:105], v[106:107] op_sel_hi:[1,0,0] neg_lo:[0,0,1] neg_hi:[0,0,1]
    v_cvt_pk_bf16_f32 v80, v56, v57
    v_cvt_pk_bf16_f32 v81, v58, v59
    v_cvt_pk_bf16_f32 v82, v60, v61
    v_cvt_pk_bf16_f32 v83, v62, v63
    v_cvt_pk_bf16_f32 v84, v64, v65
    v_cvt_pk_bf16_f32 v85, v66, v67
    v_cvt_pk_bf16_f32 v86, v68, v69
    v_cvt_pk_bf16_f32 v87, v70, v71
    v_lshrrev_b32 v102, 16, v102
    v_cndmask_b32 v84, v84, v102, s[92:93]
    ds_write_b128 v109, v[80:83] offset:0
    ds_write_b128 v109, v[84:87] offset:512
    s_waitcnt lgkmcnt(0)
    s_barrier
    ds_read_b64_tr_b16 v[88:89], v110 offset:0
    ds_read_b64_tr_b16 v[90:91], v110 offset:4352
    ds_read_b64_tr_b16 v[92:93], v110 offset:512
    ds_read_b64_tr_b16 v[94:95], v110 offset:4864
    s_waitcnt lgkmcnt(2)
    buffer_store_dwordx4 v[88:91], v111, s[24:27], s63 offen sc1
    s_waitcnt lgkmcnt(0)
    buffer_store_dwordx4 v[92:95], v22, s[24:27], s64 offen sc1
    v_min_u32 v220, 111104, v220
    s_add_u32 s54, s54, 229376
    buffer_load_dword v108, v220, s[16:19], s54 offen
    s_waitcnt vmcnt(1)
    v_cmp_eq_u32 vcc, 0, v29
    s_nop 0
    s_cbranch_vccz L_ok12
    s_mov_b32 s59, 100000
L_spin11:
    buffer_load_dword v29, off, s[40:43], 0 sc1
    s_waitcnt vmcnt(0)
    v_cmp_eq_u32 vcc, 0, v29
    s_nop 0
    s_cbranch_vccz L_ok12
    s_sub_u32 s59, s59, 1
    s_cbranch_scc0 L_spin11
L_ok12:
    v_readfirstlane_b32 s47, v29
    s_barrier
    s_cmp_lg_u32 s44, 0
    s_cbranch_scc1 L_nopub13
    s_lshl_b32 s60, s2, 5
    s_add_u32 s60, s60, 12582912
    v_mov_b32 v30, s47
    s_mov_b64 exec, 1
    buffer_store_dword v30, off, s[24:27], s60 sc1
    s_mov_b64 exec, -1
L_nopub13:
    buffer_load_dword v108, v217, s[32:35], 0 offen
    v_lshrrev_b32 v219, 2, v1
    v_min_u32 v219, 15, v219
    v_mul_u32_u24 v219, 3584, v219
    v_lshl_add_u32 v219, v210, 7, v219
    s_mul_i32 s54, s55, 16
    s_lshl_b32 s56, s44, 9
    s_add_u32 s54, s54, s56
    s_add_u32 s54, s54, 416
    s_mul_i32 s54, s54, 3584
    s_mul_i32 s56, s45, 7
    s_lshr_b32 s56, s56, 1
    s_lshl_b32 s56, s56, 7
    s_add_u32 s54, s54, s56
    buffer_load_dword v108, v219, s[16:19], s54 offen
    s_add_u32 s54, s54, 172032
    buffer_load_dword v108, v219, s[16:19], s54 offen
    s_add_u32 s54, s54, 172032
    s_lshl_b32 s54, s44, 11
    s_add_u32 s54, s54, 12582912
    v_lshl_add_u32 v221, v1, 5, s54
    buffer_load_dword v222, v221, s[24:27], 0 offen sc1
    s_waitcnt vmcnt(0)
    v_cmp_ne_u32 vcc, s47, v222
    s_nop 0
    s_cbranch_vccz L_ok15
    s_mov_b32 s59, 100000
L_spin14:
    buffer_load_dword v222, v221, s[24:27], 0 offen sc1
    s_waitcnt vmcnt(0)
    v_cmp_ne_u32 vcc, s47, v222
    s_nop 0
    s_cbranch_vccz L_ok15
    s_sub_u32 s59, s59, 1
    s_cbranch_scc0 L_spin14
L_ok15:
    s_add_u32 s54, s55, 0
    s_lshr_b32 s56, s54, 1
    s_add_u32 s56, s56, 24
    s_mul_i32 s56, s56, 66816
    s_lshl2_add_u32 s56, s52, s56
    s_and_b32 s54, s54, 1
    s_lshl_b32 s54, s54, 13
    s_add_u32 s56, s56, s54
    buffer_load_dword v108, v217, s[24:27], s56 offen sc1
    s_add_u32 s54, s55, 3
    s_lshr_b32 s56, s54, 1
    s_add_u32 s56, s56, 24
    s_mul_i32 s56, s56, 66816
    s_lshl2_add_u32 s56, s52, s56
    s_and_b32 s54, s54, 1
    s_lshl_b32 s54, s54, 13
    s_add_u32 s56, s56, s54
    buffer_load_dword v108, v217, s[24:27], s56 offen sc1
    s_add_u32 s54, s55, 6
    s_lshr_b32 s56, s54, 1
    s_add_u32 s56, s56, 24
    s_mul_i32 s56, s56, 66816
    s_lshl2_add_u32 s56, s52, s56
    s_and_b32 s54, s54, 1
    s_lshl_b32 s54, s54, 13
    s_add_u32 s56, s56, s54
    s_cmp_lt_u32 s55, 2
    s_cselect_b32 s56, s56, 2130706432
    buffer_load_dword v108, v217, s[24:27], s56 offen sc1
    s_mul_i32 s54, s44, 28
    s_add_u32 s54, s54, s55
    s_add_u32 s54, s54, 0
    s_lshl_b32 s54, s54, 16
    s_lshl_b32 s56, s45, 9
    s_add_u32 s54, s54, s56
    buffer_load_dword v108, v218, s[20:23], s54 offen
    s_add_u32 s54, s54, 196608
    buffer_load_dword v108, v218, s[20:23], s54 offen
    s_add_u32 s54, s54, 196608
    buffer_load_dword v108, v218, s[20:23], s54 offen
    s_add_u32 s54, s54, 196608
    buffer_load_dword v108, v218, s[20:23], s54 offen
    s_add_u32 s54, s54, 196608
    buffer_load_dword v108, v217, s[36:39], 0 offen
    s_waitcnt vmcnt(0) lgkmcnt(0)
    v_lshlrev_b32 v216, 6, v209
    v_lshl_add_u32 v216, v210, 3, v216
    v_lshl_add_u32 v216, v215, 5, v216
    s_add_u32 s53, s52, 49152
    v_lshl_add_u32 v2, v208, 10, v216
    v_add_u32 v2, s53, v2
    v_xor_b32 v3, 32, v2
    v_add_u32 v4, 65536, v2
    v_add_u32 v5, 65536, v3
    v_lshl_add_u32 v6, v208, 9, v216
    v_add_u32 v6, s53, v6
    v_xor_b32 v7, 32, v6
    v_add_u32 v8, 65536, v6
    v_add_u32 v9, 65536, v7
    s_lshr_b32 s53, s46, 2
    s_and_b32 s89, s46, 3
    s_bfe_u32 s54, s46, 0x20001
    s_and_b32 s55, s46, 1
    s_add_u32 s55, s55, 4
    s_cmp_lt_u32 s46, 16
    s_cselect_b32 s53, s53, s54
    s_cselect_b32 s89, s89, s55
    s_mul_i32 s49, s53, 2
    s_add_u32 s49, s49, s89
    s_sub_u32 s54, s49, 6
    s_min_u32 s49, s49, s54
    s_or_b32 s89, s89, 0
    s_lshl2_add_u32 s48, s45, s53
    s_mul_i32 s53, s44, 1835008
    s_lshl_b32 s74, s48, 7
    s_add_u32 s53, s53, s74
    s_lshl_b32 s56, s44, 5
    v_lshlrev_b32 v217, 5, v212
    v_xor_b32 v217, v217, v214
    v_xor_b32 v217, s56, v217
    s_add_u32 s74, s74, s56
    v_lshlrev_b32 v12, 12, v213
    v_add3_u32 v12, v12, v217, s53
    s_mul_i32 s53, s44, 28672
    s_lshl_b32 s54, s49, 7
    s_add_u32 s55, s53, s54
    v_mul_u32_u24 v13, 896, v213
    v_add3_u32 v13, v13, v214, s55
    v_xor_b32 v14, 32, v13
    s_mul_i32 s55, s44, 21504
    v_subrev_u32 v239, s55, v13
    s_and_b32 s55, s56, 32
    v_xor_b32 v239, s55, v239
    s_mul_i32 s73, s48, 57344
    s_add_u32 s71, s73, s54
    s_mul_i32 s55, s44, 14336
    s_add_u32 s71, s71, s55
    s_add_u32 s72, s71, 7168
    v_bfe_u32 v217, v1, 1, 2
    v_lshl_add_u32 v217, v212, 2, v217
    v_and_b32 v218, 24, v1
    v_add_u32 v217, v217, v218
    v_mul_u32_u24 v15, 896, v217
    v_and_b32 v217, 1, v1
    v_lshl_add_u32 v15, v217, 4, v15
    v_add_u32 v15, s53, v15
    s_lshl_b32 s54, s89, 5
    s_add_u32 s54, s54, 768
    s_add_u32 s68, s89, 24
    s_mul_i32 s68, s68, 58624
    s_mul_i32 s69, s44, 14336
    s_add_u32 s69, s69, 2097152
    s_add_u32 s68, s68, s69
    s_mul_i32 s55, s49, 234496
    s_add_u32 s69, s69, s55
    s_add_u32 s73, s73, s54
    s_mov_b32 s76, 0
    s_add_u32 s77, s76, 2048
    s_cmp_eq_u32 s77, 14336
    s_cselect_b32 s77, 0, s77
    s_add_u32 s78, s77, 2048
    s_cmp_eq_u32 s78, 14336
    s_cselect_b32 s78, 0, s78
    s_add_u32 s79, s78, 2048
    s_cmp_eq_u32 s79, 14336
    s_cselect_b32 s79, 0, s79
    s_add_u32 s80, s79, 2048
    s_cmp_eq_u32 s80, 14336
    s_cselect_b32 s80, 0, s80
    s_add_u32 s81, s80, 2048
    s_cmp_eq_u32 s81, 14336
    s_cselect_b32 s81, 0, s81
    s_add_u32 s82, s81, 2048
    s_cmp_eq_u32 s82, 14336
    s_cselect_b32 s82, 0, s82
    s_cmp_lt_u32 s89, 4
    s_cselect_b32 s75, s54, 2130706432
    s_cselect_b32 s68, s68, 2130706432
    s_cselect_b32 s73, s73, 2130706432
    v_lshlrev_b32 v16, 3, v1
    v_add_u32 v16, 81920, v16
    v_and_b32 v217, 7, v1
    v_min_u32 v218, 6, v217
    s_mul_i32 s54, s44, 7
    v_add_u32 v218, s54, v218
    v_mul_u32_u24 v219, 2, v218
    v_add_u32 v219, s89, v219
    v_mul_u32_u24 v220, 43, v219
    v_lshrrev_b32 v220, 8, v220
    v_mul_u32_u24 v220, 6, v220
    v_sub_u32 v219, v219, v220
    v_subrev_u32 v219, s49, v219
    v_bfe_u32 v220, v1, 3, 1
    v_mul_i32_i24 v219, v219, v220
    v_add_u32 v219, s49, v219
    v_lshl_add_u32 v218, v219, 5, v218
    v_lshlrev_b32 v20, 7, v218
    v_add_u32 v20, 12713984, v20
    s_lshr_b32 s53, s48, 1
    s_lshl_b32 s53, s53, 7
    s_add_u32 s53, s53, 12779520
    v_lshl_add_u32 v21, v210, 11, s53
    s_lshl_b32 s70, s48, 16
    s_lshl2_add_u32 s70, s52, s70
    s_add_u32 s70, s70, 4194304
    v_lshrrev_b32 v218, 3, v1
    v_mul_u32_u24 v22, 896, v218
    v_lshl_add_u32 v22, v217, 4, v22
    v_lshlrev_b32 v25, 1, v211
    s_add_u32 s53, s52, 65536
    v_mul_u32_u24 v244, 176, v218
    v_lshl_add_u32 v244, v217, 4, v244
    v_add_u32 v244, s53, v244
    v_mul_u32_u24 v238, 176, v211
    v_lshl_add_u32 v238, v208, 3, v238
    v_add_u32 v238, s53, v238
    v_lshrrev_b32 v218, 2, v0
    v_mul_u32_u24 v26, 896, v218
    v_lshl_add_u32 v26, v210, 3, v26
    v_lshrrev_b32 v218, 2, v1
    v_mul_u32_u24 v252, 176, v218
    v_lshl_add_u32 v252, v210, 3, v252
    v_add_u32 v252, s53, v252
    s_sub_u32 s53, 49152, s52
    v_add_u32 v246, s53, v2
    v_add_u32 v247, s53, v3
    v_mul_u32_u24 v218, 3072, v208
    v_add_u32 v248, v218, v246
    v_add_u32 v249, v218, v247
    v_add_u32 v232, s52, v23
    v_xor_b32 v233, 4096, v232
    v_xor_b32 v234, 8192, v232
    v_xor_b32 v235, 12288, v232
    buffer_load_dwordx4 v[216:219], v22, s[4:7], s71 offen
    buffer_load_dwordx4 v[220:223], v22, s[4:7], s72 offen
    buffer_load_dwordx2 v[224:225], v26, s[4:7], s73 offen
    buffer_load_ushort v228, v25, s[36:39], s74 offen
    s_waitcnt vmcnt(0)
    ds_write_b128 v244, v[216:219]
    ds_write_b128 v244, v[220:223] offset:1408
    ds_write_b64 v252, v[224:225] offset:128
    ds_read_b64 v[216:217], v238 offset:0
    ds_read_b64 v[218:219], v238 offset:32
    ds_read_b64 v[220:221], v238 offset:64
    ds_read_b64 v[222:223], v238 offset:96
    ds_read_b64 v[224:225], v238 offset:128
    s_add_u32 m0, s52, 81920
    s_lshl_b32 s57, s76, 7
    buffer_load_dwordx4 v12, s[20:23], s57 offen offset:0 lds
    s_add_u32 s57, s57, 31744
    buffer_load_dwordx4 v12, s[20:23], s57 offen offset:1024 lds
    s_add_u32 s57, s57, 31744
    buffer_load_dwordx4 v12, s[20:23], s57 offen offset:2048 lds
    s_add_u32 s57, s57, 31744
    buffer_load_dwordx4 v12, s[20:23], s57 offen offset:3072 lds
    s_add_u32 m0, s52, 98304
    s_lshl_b32 s57, s76, 7
    s_add_u32 s57, s57, 131072
    buffer_load_dwordx4 v12, s[20:23], s57 offen offset:0 lds
    s_add_u32 s57, s57, 31744
    buffer_load_dwordx4 v12, s[20:23], s57 offen offset:1024 lds
    s_add_u32 s57, s57, 31744
    buffer_load_dwordx4 v12, s[20:23], s57 offen offset:2048 lds
    s_add_u32 s57, s57, 31744
    buffer_load_dwordx4 v12, s[20:23], s57 offen offset:3072 lds
    s_add_u32 m0, s52, 114688
    s_lshl_b32 s57, s77, 7
    buffer_load_dwordx4 v12, s[20:23], s57 offen offset:0 lds
    s_add_u32 s57, s57, 31744
    buffer_load_dwordx4 v12, s[20:23], s57 offen offset:1024 lds
    s_add_u32 s57, s57, 31744
    buffer_load_dwordx4 v12, s[20:23], s57 offen offset:2048 lds
    s_add_u32 s57, s57, 31744
    buffer_load_dwordx4 v12, s[20:23], s57 offen offset:3072 lds
    s_add_u32 m0, s52, 131072
    s_lshl_b32 s57, s77, 7
    s_add_u32 s57, s57, 131072
    buffer_load_dwordx4 v12, s[20:23], s57 offen offset:0 lds
    s_add_u32 s57, s57, 31744
    buffer_load_dwordx4 v12, s[20:23], s57 offen offset:1024 lds
    s_waitcnt vmcnt(10)
    ds_read_b64_tr_b16 a[0:1], v6 offset:32768
    ds_read_b64_tr_b16 a[2:3], v6 offset:34816
    ds_read_b64_tr_b16 a[4:5], v7 offset:32768
    ds_read_b64_tr_b16 a[6:7], v7 offset:34816
    ds_read_b64_tr_b16 a[8:9], v6 offset:33024
    ds_read_b64_tr_b16 a[10:11], v6 offset:35072
    ds_read_b64_tr_b16 a[12:13], v7 offset:33024
    ds_read_b64_tr_b16 a[14:15], v7 offset:35072
    s_add_u32 s57, s57, 31744
    buffer_load_dwordx4 v12, s[20:23], s57 offen offset:2048 lds
    s_add_u32 s57, s57, 31744
    buffer_load_dwordx4 v12, s[20:23], s57 offen offset:3072 lds
    s_add_u32 m0, s52, 147456
    s_lshl_b32 s57, s78, 7
    buffer_load_dwordx4 v12, s[20:23], s57 offen offset:0 lds
    s_add_u32 s57, s57, 31744
    buffer_load_dwordx4 v12, s[20:23], s57 offen offset:1024 lds
    s_waitcnt vmcnt(10)
    ds_read_b64_tr_b16 a[16:17], v6 offset:49152
    ds_read_b64_tr_b16 a[18:19], v6 offset:51200
    ds_read_b64_tr_b16 a[20:21], v7 offset:49152
    ds_read_b64_tr_b16 a[22:23], v7 offset:51200
    ds_read_b64_tr_b16 a[24:25], v6 offset:49408
    ds_read_b64_tr_b16 a[26:27], v6 offset:51456
    ds_read_b64_tr_b16 a[28:29], v7 offset:49408
    ds_read_b64_tr_b16 a[30:31], v7 offset:51456
    s_add_u32 s57, s57, 31744
    buffer_load_dwordx4 v12, s[20:23], s57 offen offset:2048 lds
    s_add_u32 s57, s57, 31744
    buffer_load_dwordx4 v12, s[20:23], s57 offen offset:3072 lds
    s_add_u32 m0, s52, 49152
    s_lshl_b32 s57, s78, 7
    s_add_u32 s57, s57, 131072
    buffer_load_dwordx4 v12, s[20:23], s57 offen offset:0 lds
    s_add_u32 s57, s57, 31744
    buffer_load_dwordx4 v12, s[20:23], s57 offen offset:1024 lds
    s_waitcnt vmcnt(10)
    ds_read_b64_tr_b16 a[32:33], v8 offset:0
    ds_read_b64_tr_b16 a[34:35], v8 offset:2048
    ds_read_b64_tr_b16 a[36:37], v9 offset:0
    ds_read_b64_tr_b16 a[38:39], v9 offset:2048
    ds_read_b64_tr_b16 a[40:41], v8 offset:256
    ds_read_b64_tr_b16 a[42:43], v8 offset:2304
    ds_read_b64_tr_b16 a[44:45], v9 offset:256
    ds_read_b64_tr_b16 a[46:47], v9 offset:2304
    s_add_u32 s57, s57, 31744
    buffer_load_dwordx4 v12, s[20:23], s57 offen offset:2048 lds
    s_add_u32 s57, s57, 31744
    buffer_load_dwordx4 v12, s[20:23], s57 offen offset:3072 lds
    s_waitcnt lgkmcnt(15)
    s_add_u32 m0, s52, 65536
    s_lshl_b32 s57, s79, 7
    buffer_load_dwordx4 v12, s[20:23], s57 offen offset:0 lds
    s_add_u32 s57, s57, 31744
    buffer_load_dwordx4 v12, s[20:23], s57 offen offset:1024 lds
    s_waitcnt vmcnt(10)
    ds_read_b64_tr_b16 a[48:49], v8 offset:16384
    ds_read_b64_tr_b16 a[50:51], v8 offset:18432
    ds_read_b64_tr_b16 a[52:53], v9 offset:16384
    ds_read_b64_tr_b16 a[54:55], v9 offset:18432
    s_add_u32 s57, s57, 31744
    buffer_load_dwordx4 v12, s[20:23], s57 offen offset:2048 lds
    ds_read_b64_tr_b16 a[56:57], v8 offset:16640
    ds_read_b64_tr_b16 a[58:59], v8 offset:18688
    ds_read_b64_tr_b16 a[60:61], v9 offset:16640
    ds_read_b64_tr_b16 a[62:63], v9 offset:18688
    s_add_u32 s57, s57, 31744
    buffer_load_dwordx4 v12, s[20:23], s57 offen offset:3072 lds
    s_add_u32 m0, s52, 81920
    s_lshl_b32 s57, s79, 7
    s_add_u32 s57, s57, 131072
    buffer_load_dwordx4 v12, s[20:23], s57 offen offset:0 lds
    s_add_u32 s57, s57, 31744
    buffer_load_dwordx4 v12, s[20:23], s57 offen offset:1024 lds
    s_waitcnt vmcnt(10)
    ds_read_b64_tr_b16 a[64:65], v8 offset:32768
    ds_read_b64_tr_b16 a[66:67], v8 offset:34816
    ds_read_b64_tr_b16 a[68:69], v9 offset:32768
    ds_read_b64_tr_b16 a[70:71], v9 offset:34816
    s_add_u32 s57, s57, 31744
    buffer_load_dwordx4 v12, s[20:23], s57 offen offset:2048 lds
    ds_read_b64_tr_b16 a[72:73], v8 offset:33024
    ds_read_b64_tr_b16 a[74:75], v8 offset:35072
    ds_read_b64_tr_b16 a[76:77], v9 offset:33024
    ds_read_b64_tr_b16 a[78:79], v9 offset:35072
    s_add_u32 s57, s57, 31744
    buffer_load_dwordx4 v12, s[20:23], s57 offen offset:3072 lds
    s_waitcnt lgkmcnt(15)
    s_add_u32 m0, s52, 98304
    s_lshl_b32 s57, s80, 7
    buffer_load_dwordx4 v12, s[20:23], s57 offen offset:0 lds
    s_add_u32 s57, s57, 31744
    buffer_load_dwordx4 v12, s[20:23], s57 offen offset:1024 lds
    s_waitcnt vmcnt(10)
    ds_read_b64_tr_b16 a[80:81], v6 offset:0
    ds_read_b64_tr_b16 a[82:83], v6 offset:2048
    ds_read_b64_tr_b16 a[84:85], v7 offset:0
    ds_read_b64_tr_b16 a[86:87], v7 offset:2048
    s_add_u32 s57, s57, 31744
    buffer_load_dwordx4 v12, s[20:23], s57 offen offset:2048 lds
    ds_read_b64_tr_b16 a[88:89], v6 offset:256
    ds_read_b64_tr_b16 a[90:91], v6 offset:2304
    ds_read_b64_tr_b16 a[92:93], v7 offset:256
    ds_read_b64_tr_b16 a[94:95], v7 offset:2304
    s_waitcnt vmcnt(0) lgkmcnt(0)
    s_branch L_p3join
L_role_a:
    v_lshrrev_b32 v112, 4, v1
    v_bfe_u32 v113, v1, 2, 2
    v_and_b32 v114, 3, v1
    v_and_b32 v115, 15, v1
    v_lshrrev_b32 v116, 5, v1
    s_lshr_b32 s48, s45, 1
    s_and_b32 s53, s45, 1
    s_lshl3_add_u32 s49, s53, s46
    s_sub_u32 s49, s49, 24
    s_lshl_b32 s90, s44, 11
    s_and_b32 s53, s44, 1
    s_lshl_b32 s53, s53, 1
    v_lshlrev_b32 v117, 2, v112
    v_sub_u32 v117, v115, v117
    v_and_b32 v117, 15, v117
    v_xor_b32 v117, s53, v117
    v_mul_u32_u24 v2, 2688, v112
    v_lshl_add_u32 v2, v117, 4, v2
    s_mul_i32 s53, s44, 21504
    s_mul_i32 s54, s48, 224
    s_andn2_b32 s54, s54, 63
    s_add_u32 s53, s53, s54
    v_add_u32 v2, s53, v2
    s_add_u32 m0, s90, 65536
    s_mov_b32 s57, 896
    buffer_load_dwordx4 v2, s[8:11], s57 offen offset:0 lds
    s_mov_b32 s57, 10624
    buffer_load_dwordx4 v2, s[8:11], s57 offen offset:1024 lds
    v_mul_u32_u24 v109, 1088, v25
    v_lshl_add_u32 v109, v26, 4, v109
    v_mul_u32_u24 v110, 1088, v113
    v_lshl_add_u32 v110, v112, 5, v110
    v_lshl_add_u32 v110, v114, 3, v110
    s_lshl_b32 s53, s44, 7
    v_add_u32 v110, s53, v110
    v_mul_u32_u24 v111, 66816, v112
    v_lshl_add_u32 v111, v115, 4, v111
    s_mul_i32 s63, s44, 267264
    s_lshl_b32 s53, s2, 8
    s_add_u32 s63, s63, s53
    s_add_u32 s64, s63, 1069056
    v_cmp_gt_u32 vcc, 208, v0
    v_mov_b32 v100, 2130706432
    v_cmp_le_u32 s[92:93], 24, v26
    v_cndmask_b32 v22, v100, v111, vcc
    s_mov_b32 s62, 0x3f803f80
    s_mov_b32 s61, 0xffff0000
    v_mov_b32 v96, 0
    v_mov_b32 v97, 0
    v_and_b32 v117, 1, v112
    v_lshlrev_b32 v117, 5, v117
    s_mul_i32 s53, s44, 56
    s_and_b32 s54, s48, 1
    s_lshl_b32 s54, s54, 5
    s_add_u32 s53, s53, s54
    v_lshlrev_b32 v118, 11, v112
    v_lshl_add_u32 v118, v113, 8, v118
    v_add_u32 v118, 65536, v118
    v_lshl_add_u32 v119, v114, 3, s53
    v_add_u32 v119, 0, v119
    v_xor_b32 v119, v119, v117
    v_lshl_add_u32 v119, v113, 6, v119
    v_and_b32 v119, 255, v119
    v_add_u32 v6, v118, v119
    v_add_u32 v10, 49152, v6
    v_subrev_u32 v120, 65536, v6
    v_lshl_add_u32 v119, v114, 3, s53
    v_add_u32 v119, 32, v119
    v_xor_b32 v119, v119, v117
    v_lshl_add_u32 v119, v113, 6, v119
    v_and_b32 v119, 255, v119
    v_add_u32 v7, v118, v119
    v_add_u32 v11, 49152, v7
    v_subrev_u32 v121, 65536, v7
    s_and_b32 s54, s44, 1
    s_lshl_b32 s54, s54, 3
    s_sub_u32 s53, s53, s54
    v_lshl_add_u32 v119, v114, 4, s53
    v_add_u32 v119, 0, v119
    v_xor_b32 v119, v119, v117
    v_lshl_add_u32 v119, v113, 6, v119
    v_and_b32 v119, 255, v119
    v_add_u32 v8, v118, v119
    v_add_u32 v12, 49152, v8
    v_subrev_u32 v122, 65536, v8
    v_lshl_add_u32 v119, v114, 4, s53
    v_add_u32 v119, 8, v119
    v_xor_b32 v119, v119, v117
    v_lshl_add_u32 v119, v113, 6, v119
    v_and_b32 v119, 255, v119
    v_add_u32 v9, v118, v119
    v_add_u32 v13, 49152, v9
    v_subrev_u32 v123, 65536, v9
    s_waitcnt vmcnt(4)
    v_dot2c_f32_bf16 v96, s62, v32
    v_dot2c_f32_bf16 v97, v32, v32
    v_lshlrev_b32 v40, 16, v32
    v_and_b32 v41, s61, v32
    v_dot2c_f32_bf16 v96, s62, v33
    v_dot2c_f32_bf16 v97, v33, v33
    v_lshlrev_b32 v42, 16, v33
    v_and_b32 v43, s61, v33
    v_dot2c_f32_bf16 v96, s62, v34
    v_dot2c_f32_bf16 v97, v34, v34
    v_lshlrev_b32 v44, 16, v34
    v_and_b32 v45, s61, v34
    v_dot2c_f32_bf16 v96, s62, v35
    v_dot2c_f32_bf16 v97, v35, v35
    v_lshlrev_b32 v46, 16, v35
    v_and_b32 v47, s61, v35
    s_waitcnt vmcnt(3)
    v_dot2c_f32_bf16 v96, s62, v36
    v_dot2c_f32_bf16 v97, v36, v36
    v_lshlrev_b32 v48, 16, v36
    v_and_b32 v49, s61, v36
    v_dot2c_f32_bf16 v96, s62, v37
    v_dot2c_f32_bf16 v97, v37, v37
    v_lshlrev_b32 v50, 16, v37
    v_and_b32 v51, s61, v37
    v_dot2c_f32_bf16 v96, s62, v38
    v_dot2c_f32_bf16 v97, v38, v38
    v_lshlrev_b32 v52, 16, v38
    v_and_b32 v53, s61, v38
    v_dot2c_f32_bf16 v96, s62, v39
    v_dot2c_f32_bf16 v97, v39, v39
    v_lshlrev_b32 v54, 16, v39
    v_and_b32 v55, s61, v39
    buffer_load_dword v29, off, s[40:43], 0 sc1
    v_add_f32_dpp v96, v96, v96 quad_perm:[1,0,3,2] row_mask:0xf bank_mask:0xf
    v_add_f32_dpp v97, v97, v97 quad_perm:[1,0,3,2] row_mask:0xf bank_mask:0xf
    s_nop 0
    v_add_f32_dpp v96, v96, v96 quad_perm:[2,3,0,1] row_mask:0xf bank_mask:0xf
    v_add_f32_dpp v97, v97, v97 quad_perm:[2,3,0,1] row_mask:0xf bank_mask:0xf
    s_nop 0
    v_add_f32_dpp v96, v96, v96 row_half_mirror row_mask:0xf bank_mask:0xf
    v_add_f32_dpp v97, v97, v97 row_half_mirror row_mask:0xf bank_mask:0xf
    s_nop 0
    v_add_f32_dpp v96, v96, v96 row_mirror row_mask:0xf bank_mask:0xf
    v_add_f32_dpp v97, v97, v97 row_mirror row_mask:0xf bank_mask:0xf
    v_mov_b32 v98, v96
    v_mov_b32 v99, v97
    s_nop 0
    v_permlane16_swap_b32 v96, v98
    v_permlane16_swap_b32 v97, v99
    v_add_f32 v96, v96, v98
    v_add_f32 v97, v97, v99
    v_mul_f32 v98, 0x3b124925, v96
    v_mul_f32 v99, 0x3b124925, v97
    v_fma_f32 v99, -v98, v98, v99
    v_max_f32 v99, 0, v99
    v_cvt_pk_bf16_f32 v100, 0, v99
    v_add_f32 v100, 0x3727c5ac, v100
    v_cvt_pk_bf16_f32 v100, 0, v100
    v_sqrt_f32 v100, v100
    s_nop 0
    v_cvt_pk_bf16_f32 v100, 0, v100
    v_rcp_f32 v100, v100
    s_nop 0
    v_mul_f32 v99, v99, v100
    v_mul_f32 v99, v99, v100
    v_cvt_pk_bf16_f32 v104, 0, v99
    v_add_f32 v104, 0x3727c5ac, v104
    v_cvt_pk_bf16_f32 v104, 0, v104
    v_sqrt_f32 v104, v104
    s_nop 0
    v_cvt_pk_bf16_f32 v102, 0, v104
    v_rcp_f32 v104, v102
    s_nop 0
    v_mul_f32 v104, v104, v100
    v_mul_f32 v106, v98, v104
    v_pk_fma_f32 v[56:57], v[40:41], v[104:105], v[106:107] op_sel_hi:[1,0,0] neg_lo:[0,0,1] neg_hi:[0,0,1]
    v_pk_fma_f32 v[58:59], v[42:43], v[104:105], v[106:107] op_sel_hi:[1,0,0] neg_lo:[0,0,1] neg_hi:[0,0,1]
    v_pk_fma_f32 v[60:61], v[44:45], v[104:105], v[106:107] op_sel_hi:[1,0,0] neg_lo:[0,0,1] neg_hi:[0,0,1]
    v_pk_fma_f32 v[62:63], v[46:47], v[104:105], v[106:107] op_sel_hi:[1,0,0] neg_lo:[0,0,1] neg_hi:[0,0,1]
    v_pk_fma_f32 v[64:65], v[48:49], v[104:105], v[106:107] op_sel_hi:[1,0,0] neg_lo:[0,0,1] neg_hi:[0,0,1]
    v_pk_fma_f32 v[66:67], v[50:51], v[104:105], v[106:107] op_sel_hi:[1,0,0] neg_lo:[0,0,1] neg_hi:[0,0,1]
    v_pk_fma_f32 v[68:69], v[52:53], v[104:105], v[106:107] op_sel_hi:[1,0,0] neg_lo:[0,0,1] neg_hi:[0,0,1]
    v_pk_fma_f32 v[70:71], v[54:55], v[104:105], v[106:107] op_sel_hi:[1,0,0] neg_lo:[0,0,1] neg_hi:[0,0,1]
    v_cvt_pk_bf16_f32 v80, v56, v57
    v_cvt_pk_bf16_f32 v81, v58, v59
    v_cvt_pk_bf16_f32 v82, v60, v61
    v_cvt_pk_bf16_f32 v83, v62, v63
    v_cvt_pk_bf16_f32 v84, v64, v65
    v_cvt_pk_bf16_f32 v85, v66, v67
    v_cvt_pk_bf16_f32 v86, v68, v69
    v_cvt_pk_bf16_f32 v87, v70, v71
    v_lshrrev_b32 v102, 16, v102
    v_cndmask_b32 v84, v84, v102, s[92:93]
    ds_write_b128 v109, v[80:83] offset:49152
    ds_write_b128 v109, v[84:87] offset:49664
    s_waitcnt lgkmcnt(0)
    s_barrier
    ds_read_b64_tr_b16 v[88:89], v110 offset:49152
    ds_read_b64_tr_b16 v[90:91], v110 offset:53504
    ds_read_b64_tr_b16 v[92:93], v110 offset:49664
    ds_read_b64_tr_b16 v[94:95], v110 offset:54016
    s_waitcnt lgkmcnt(2)
    buffer_store_dwordx4 v[88:91], v111, s[24:27], s63 offen sc1
    s_waitcnt lgkmcnt(0)
    buffer_store_dwordx4 v[92:95], v22, s[24:27], s64 offen sc1
    s_add_u32 m0, s90, 73728
    s_mov_b32 s57, 86912
    buffer_load_dwordx4 v2, s[8:11], s57 offen offset:0 lds
    s_movk_i32 s94, 224
    v_mul_u32_u24 v3, 66816, v116
    v_and_b32 v118, 1, v112
    v_lshlrev_b32 v119, 2, v118
    v_xor_b32 v119, v119, v115
    v_lshl_add_u32 v3, v118, 8, v3
    v_lshl_add_u32 v3, v119, 4, v3
    v_cmp_gt_u32 s[92:93], s94, v0
    v_mov_b32 v119, 2130706432
    s_mov_b32 s57, 96640
    buffer_load_dwordx4 v2, s[8:11], s57 offen offset:1024 lds
    v_lshlrev_b32 v4, 9, v116
    v_cndmask_b32 v24, v119, v3, s[92:93]
    v_lshl_add_u32 v4, v118, 7, v4
    v_lshl_add_u32 v4, v113, 4, v4
    v_lshrrev_b32 v118, 1, v114
    v_mul_u32_u24 v118, 320, v118
    v_add_u32 v4, v118, v4
    v_and_b32 v118, 1, v114
    v_lshl_add_u32 v4, v118, 3, v4
    v_xor_b32 v25, 64, v4
    s_lshl_b32 s53, s49, 4
    s_sub_u32 s53, s53, 2
    v_min_u32 v117, 17, v1
    v_add_u32 v117, s53, v117
    v_max_i32 v117, 0, v117
    v_lshlrev_b32 v19, 5, v117
    s_add_u32 m0, s90, 81920
    s_mov_b32 s57, 172928
    buffer_load_dwordx4 v2, s[8:11], s57 offen offset:0 lds
    v_add_u32 v19, 12582912, v19
    v_and_b32 v117, 1, v115
    v_cmp_eq_u32 s[76:77], 1, v117
    v_lshl_add_u32 v117, v112, 2, v117
    v_cmp_le_u32 s[78:79], v117, v115
    v_mul_u32_u24 v118, 304, v116
    v_lshl_add_u32 v93, v117, 1, v118
    v_add_u32 v117, 2, v117
    v_cmp_le_u32 s[80:81], v117, v115
    v_add_u32 v94, 4, v93
    v_mov_b32 v118, 14336
    v_mov_b32 v119, 30720
    v_cndmask_b32 v117, v118, v119, s[78:79]
    v_add_u32 v93, v117, v93
    v_cndmask_b32 v117, v118, v119, s[80:81]
    v_add_u32 v94, v117, v94
    s_mov_b32 s57, 182656
    buffer_load_dwordx4 v2, s[8:11], s57 offen offset:1024 lds
    v_lshrrev_b32 v117, 3, v115
    v_mul_u32_u24 v117, 304, v117
    v_lshl_add_u32 v92, v115, 1, v117
    v_add_u32 v92, v119, v92
    v_cmp_eq_u32 s[82:83], 3, v112
    v_mov_b32 v117, 0xffff
    v_mov_b32 v118, 0xffff0000
    v_cndmask_b32 v117, v117, v118, s[76:77]
    v_cndmask_b32 v14, v117, 0, s[78:79]
    v_cndmask_b32 v15, v117, 0, s[80:81]
    v_cndmask_b32 v16, 0, v117, s[78:79]
    v_cndmask_b32 v17, 0, v117, s[80:81]
    s_mov_b32 s91, 0x3e8b97f6
    v_mov_b32 v18, 0xf149f2ca
    s_lshl_b32 s53, s49, 3
    s_lshl_b32 s72, s53, 9
    s_add_u32 m0, s90, 90112
    s_mov_b32 s57, 258944
    buffer_load_dwordx4 v2, s[8:11], s57 offen offset:0 lds
    s_lshl_b32 s74, s53, 14
    s_lshl2_add_u32 s54, s48, s44
    s_mul_i32 s54, s54, 7
    s_lshr_b32 s54, s54, 1
    s_lshl_b32 s54, s54, 8
    s_add_u32 s74, s74, s54
    s_add_u32 s74, s74, 4194304
    s_mul_i32 s68, s44, 534528
    s_add_u32 s68, s68, 0
    s_mul_i32 s69, s44, 534528
    s_add_u32 s69, s69, 132608
    s_mul_i32 s70, s44, 534528
    s_add_u32 s70, s70, 265216
    s_mul_i32 s71, s44, 534528
    s_add_u32 s71, s71, 397824
    s_cmp_eq_u32 s44, 3
    s_cselect_b32 s71, 2130706432, s71
    s_cmp_eq_u32 s49, 0
    s_cselect_b64 s[84:85], -1, 0
    s_andn2_b64 s[86:87], s[84:85], s[80:81]
    s_andn2_b64 s[84:85], s[84:85], s[78:79]
    s_bitcmp1_b32 s44, 0
    s_cselect_b64 s[88:89], -1, 0
    s_cselect_b32 s53, 0, 3
    s_cselect_b32 s54, 8, 0
    v_cmp_eq_u32 vcc, s53, v112
    s_lshr_b32 s53, s44, 1
    s_lshl_b32 s55, s53, 11
    s_add_u32 s54, s54, s55
    s_add_u32 s54, s54, 147456
    v_lshl_add_u32 v118, v115, 4, s54
    v_add_u32 v117, 151552, v23
    v_cndmask_b32 v95, v117, v118, vcc
    v_mov_b32 v117, 2130706432
    v_cndmask_b32 v23, v23, v117, vcc
    s_lshl1_add_u32 s53, s48, s53
    s_mul_i32 s53, s53, 1792
    s_and_b32 s54, s44, 1
    s_lshl1_add_u32 s54, s49, s54
    s_lshl_b32 s54, s54, 16
    s_add_u32 s53, s53, s54
    s_add_u32 s95, s53, 4195072
    s_and_b32 s53, s46, 7
    s_mul_i32 s54, s44, 28
    s_add_u32 s54, s54, s53
    s_add_u32 s54, s54, 12
    s_lshl_b32 s73, s54, 16
    s_lshl_b32 s54, s45, 9
    s_add_u32 s73, s73, s54
    s_lshl3_add_u32 s75, s44, s53
    s_lshl_b32 s75, s75, 13
    v_lshrrev_b32 v5, 2, v1
    v_lshlrev_b32 v5, 12, v5
    v_lshl_add_u32 v5, v114, 7, v5
    v_lshlrev_b32 v20, 7, v1
    s_mov_b32 s57, 268672
    buffer_load_dwordx4 v2, s[8:11], s57 offen offset:1024 lds
    s_add_u32 m0, s90, 98304
    s_mov_b32 s57, 344960
    buffer_load_dwordx4 v2, s[8:11], s57 offen offset:0 lds
    s_mov_b32 s57, 354688
    buffer_load_dwordx4 v2, s[8:11], s57 offen offset:1024 lds
    s_add_u32 m0, s90, 106496
    s_mov_b32 s57, 430976
    buffer_load_dwordx4 v2, s[8:11], s57 offen offset:0 lds
    s_mov_b32 s57, 440704
    buffer_load_dwordx4 v2, s[8:11], s57 offen offset:1024 lds
    s_add_u32 m0, s90, 114688
    s_mov_b32 s57, 516992
    buffer_load_dwordx4 v2, s[8:11], s57 offen offset:0 lds
    s_mov_b32 s57, 526720
    buffer_load_dwordx4 v2, s[8:11], s57 offen offset:1024 lds
    s_add_u32 m0, s90, 122880
    s_mov_b32 s57, 603008
    buffer_load_dwordx4 v2, s[8:11], s57 offen offset:0 lds
    s_mov_b32 s57, 612736
    buffer_load_dwordx4 v2, s[8:11], s57 offen offset:1024 lds
    s_add_u32 m0, s90, 131072
    s_mov_b32 s57, 689024
    buffer_load_dwordx4 v2, s[8:11], s57 offen offset:0 lds
    s_mov_b32 s57, 698752
    buffer_load_dwordx4 v2, s[8:11], s57 offen offset:1024 lds
    s_add_u32 m0, s90, 139264
    s_mov_b32 s57, 775040
    buffer_load_dwordx4 v2, s[8:11], s57 offen offset:0 lds
    s_mov_b32 s57, 784768
    buffer_load_dwordx4 v2, s[8:11], s57 offen offset:1024 lds
    s_add_u32 m0, s90, 147456
    s_mov_b32 s57, 861056
    buffer_load_dwordx4 v2, s[8:11], s57 offen offset:0 lds
    s_mov_b32 s57, 870784
    buffer_load_dwordx4 v2, s[8:11], s57 offen offset:1024 lds
    s_waitcnt vmcnt(20)
    v_cmp_eq_u32 vcc, 0, v29
    s_nop 0
    s_cbranch_vccz L_ok17
    s_mov_b32 s59, 100000
L_spin16:
    buffer_load_dword v29, off, s[40:43], 0 sc1
    s_waitcnt vmcnt(0)
    v_cmp_eq_u32 vcc, 0, v29
    s_nop 0
    s_cbranch_vccz L_ok17
    s_sub_u32 s59, s59, 1
    s_cbranch_scc0 L_spin16
L_ok17:
    v_readfirstlane_b32 s47, v29
    s_barrier
    s_cmp_lg_u32 s44, 0
    s_cbranch_scc1 L_nopub18
    s_lshl_b32 s60, s2, 5
    s_add_u32 s60, s60, 12582912
    v_mov_b32 v30, s47
    s_mov_b64 exec, 1
    buffer_store_dword v30, off, s[24:27], s60 sc1
    s_mov_b64 exec, -1
L_nopub18:
    s_waitcnt vmcnt(16)
    s_barrier
    s_add_u32 m0, s90, 155648
    s_mov_b32 s57, 947072
    buffer_load_dwordx4 v2, s[8:11], s57 offen offset:0 lds
    s_mov_b32 s57, 956800
    buffer_load_dwordx4 v2, s[8:11], s57 offen offset:1024 lds
    ds_read_b64_tr_b16 a[8:9], v6 offset:0
    ds_read_b64_tr_b16 a[10:11], v6 offset:1024
    ds_read_b64_tr_b16 a[12:13], v7 offset:0
    ds_read_b64_tr_b16 a[14:15], v7 offset:1024
    s_add_u32 m0, s90, 0
    s_mov_b32 s57, 1033088
    buffer_load_dwordx4 v2, s[8:11], s57 offen offset:0 lds
    s_mov_b32 s57, 1042816
    buffer_load_dwordx4 v2, s[8:11], s57 offen offset:1024 lds
    ds_read_b64_tr_b16 a[32:33], v6 offset:8192
    ds_read_b64_tr_b16 a[34:35], v6 offset:9216
    ds_read_b64_tr_b16 a[36:37], v7 offset:8192
    ds_read_b64_tr_b16 a[38:39], v7 offset:9216
    s_add_u32 m0, s90, 8192
    s_mov_b32 s57, 1119104
    buffer_load_dwordx4 v2, s[8:11], s57 offen offset:0 lds
    s_mov_b32 s57, 1128832
    buffer_load_dwordx4 v2, s[8:11], s57 offen offset:1024 lds
    ds_read_b64_tr_b16 a[56:57], v6 offset:16384
    ds_read_b64_tr_b16 a[58:59], v6 offset:17408
    ds_read_b64_tr_b16 a[60:61], v7 offset:16384
    ds_read_b64_tr_b16 a[62:63], v7 offset:17408
    s_waitcnt vmcnt(16)
    s_waitcnt lgkmcnt(0)
    s_barrier
    s_add_u32 m0, s90, 16384
    s_mov_b32 s57, 1792
    buffer_load_dwordx4 v2, s[8:11], s57 offen offset:0 lds
    s_mov_b32 s57, 11520
    buffer_load_dwordx4 v2, s[8:11], s57 offen offset:1024 lds
    ds_read_b64_tr_b16 a[80:81], v6 offset:24576
    ds_read_b64_tr_b16 a[82:83], v6 offset:25600
    ds_read_b64_tr_b16 a[84:85], v7 offset:24576
    ds_read_b64_tr_b16 a[86:87], v7 offset:25600
    s_add_u32 m0, s90, 24576
    s_mov_b32 s57, 87808
    buffer_load_dwordx4 v2, s[8:11], s57 offen offset:0 lds
    s_mov_b32 s57, 97536
    buffer_load_dwordx4 v2, s[8:11], s57 offen offset:1024 lds
    ds_read_b64_tr_b16 a[104:105], v6 offset:32768
    ds_read_b64_tr_b16 a[106:107], v6 offset:33792
    ds_read_b64_tr_b16 a[108:109], v7 offset:32768
    ds_read_b64_tr_b16 a[110:111], v7 offset:33792
    s_add_u32 m0, s90, 32768
    s_mov_b32 s57, 173824
    buffer_load_dwordx4 v2, s[8:11], s57 offen offset:0 lds
    s_mov_b32 s57, 183552
    buffer_load_dwordx4 v2, s[8:11], s57 offen offset:1024 lds
    ds_read_b64_tr_b16 a[128:129], v6 offset:40960
    ds_read_b64_tr_b16 a[130:131], v6 offset:41984
    ds_read_b64_tr_b16 a[132:133], v7 offset:40960
    ds_read_b64_tr_b16 a[134:135], v7 offset:41984
    s_waitcnt vmcnt(16)
    s_waitcnt lgkmcnt(0)
    s_barrier
    s_add_u32 m0, s90, 40960
    s_mov_b32 s57, 259840
    buffer_load_dwordx4 v2, s[8:11], s57 offen offset:0 lds
    s_mov_b32 s57, 269568
    buffer_load_dwordx4 v2, s[8:11], s57 offen offset:1024 lds
    ds_read_b64_tr_b16 a[152:153], v10 offset:0
    ds_read_b64_tr_b16 a[154:155], v10 offset:1024
    ds_read_b64_tr_b16 a[156:157], v11 offset:0
    ds_read_b64_tr_b16 a[158:159], v11 offset:1024
    s_add_u32 m0, s90, 65536
    s_mov_b32 s57, 345856
    buffer_load_dwordx4 v2, s[8:11], s57 offen offset:0 lds
    s_mov_b32 s57, 355584
    buffer_load_dwordx4 v2, s[8:11], s57 offen offset:1024 lds
    ds_read_b64_tr_b16 a[176:177], v10 offset:8192
    ds_read_b64_tr_b16 a[178:179], v10 offset:9216
    ds_read_b64_tr_b16 a[180:181], v11 offset:8192
    ds_read_b64_tr_b16 a[182:183], v11 offset:9216
    s_add_u32 m0, s90, 73728
    s_mov_b32 s57, 431872
    buffer_load_dwordx4 v2, s[8:11], s57 offen offset:0 lds
    s_mov_b32 s57, 441600
    buffer_load_dwordx4 v2, s[8:11], s57 offen offset:1024 lds
    ds_read_b64_tr_b16 a[200:201], v10 offset:16384
    ds_read_b64_tr_b16 a[202:203], v10 offset:17408
    ds_read_b64_tr_b16 a[204:205], v11 offset:16384
    ds_read_b64_tr_b16 a[206:207], v11 offset:17408
    s_waitcnt vmcnt(16)
    s_waitcnt lgkmcnt(0)
    s_barrier
    s_add_u32 m0, s90, 81920
    s_mov_b32 s57, 517888
    buffer_load_dwordx4 v2, s[8:11], s57 offen offset:0 lds
    s_mov_b32 s57, 527616
    buffer_load_dwordx4 v2, s[8:11], s57 offen offset:1024 lds
    ds_read_b64_tr_b16 a[224:225], v10 offset:24576
    ds_read_b64_tr_b16 a[226:227], v10 offset:25600
    ds_read_b64_tr_b16 a[228:229], v11 offset:24576
    ds_read_b64_tr_b16 a[230:231], v11 offset:25600
    s_add_u32 m0, s90, 90112
    s_mov_b32 s57, 603904
    buffer_load_dwordx4 v2, s[8:11], s57 offen offset:0 lds
    s_mov_b32 s57, 613632
    buffer_load_dwordx4 v2, s[8:11], s57 offen offset:1024 lds
    ds_read_b64_tr_b16 a[248:249], v10 offset:32768
    ds_read_b64_tr_b16 a[250:251], v10 offset:33792
    ds_read_b64_tr_b16 a[252:253], v11 offset:32768
    ds_read_b64_tr_b16 a[254:255], v11 offset:33792
    s_add_u32 m0, s90, 98304
    s_mov_b32 s57, 689920
    buffer_load_dwordx4 v2, s[8:11], s57 offen offset:0 lds
    s_mov_b32 s57, 699648
    buffer_load_dwordx4 v2, s[8:11], s57 offen offset:1024 lds
    ds_read_b64_tr_b16 v[192:193], v10 offset:40960
    ds_read_b64_tr_b16 v[194:195], v10 offset:41984
    ds_read_b64_tr_b16 v[196:197], v11 offset:40960
    ds_read_b64_tr_b16 v[198:199], v11 offset:41984
    s_waitcnt vmcnt(16)
    s_waitcnt lgkmcnt(0)
    s_barrier
    ds_read_b64_tr_b16 v[216:217], v120 offset:0
    ds_read_b64_tr_b16 v[218:219], v120 offset:1024
    ds_read_b64_tr_b16 v[220:221], v121 offset:0
    ds_read_b64_tr_b16 v[222:223], v121 offset:1024
    ds_read_b64_tr_b16 v[240:241], v120 offset:8192
    ds_read_b64_tr_b16 v[242:243], v120 offset:9216
    ds_read_b64_tr_b16 v[244:245], v121 offset:8192
    ds_read_b64_tr_b16 v[246:247], v121 offset:9216
    s_add_u32 m0, s90, 106496
    s_mov_b32 s57, 775936
    buffer_load_dwordx4 v2, s[8:11], s57 offen offset:0 lds
    ds_read_b64_tr_b16 a[16:17], v122 offset:16384
    ds_read_b64_tr_b16 a[18:19], v122 offset:17408
    ds_read_b64_tr_b16 a[20:21], v123 offset:16384
    ds_read_b64_tr_b16 a[22:23], v123 offset:17408
    s_mov_b32 s57, 785664
    buffer_load_dwordx4 v2, s[8:11], s57 offen offset:1024 lds
    s_waitcnt vmcnt(12)
    s_waitcnt lgkmcnt(0)
    s_barrier
    ds_read_b64_tr_b16 a[40:41], v122 offset:24576
    ds_read_b64_tr_b16 a[42:43], v122 offset:25600
    ds_read_b64_tr_b16 a[44:45], v123 offset:24576
    ds_read_b64_tr_b16 a[46:47], v123 offset:25600
    ds_read_b64_tr_b16 a[64:65], v122 offset:32768
    ds_read_b64_tr_b16 a[66:67], v122 offset:33792
    ds_read_b64_tr_b16 a[68:69], v123 offset:32768
    ds_read_b64_tr_b16 a[70:71], v123 offset:33792
    ds_read_b64_tr_b16 a[88:89], v122 offset:40960
    ds_read_b64_tr_b16 a[90:91], v122 offset:41984
    ds_read_b64_tr_b16 a[92:93], v123 offset:40960
    ds_read_b64_tr_b16 a[94:95], v123 offset:41984
    buffer_load_dword v21, v19, s[24:27], 0 offen sc1
    s_add_u32 m0, s90, 114688
    s_mov_b32 s57, 861952
    buffer_load_dwordx4 v2, s[8:11], s57 offen offset:0 lds
    s_mov_b32 s57, 871680
    buffer_load_dwordx4 v2, s[8:11], s57 offen offset:1024 lds
    s_add_u32 m0, s90, 122880
    s_mov_b32 s57, 947968
    buffer_load_dwordx4 v2, s[8:11], s57 offen offset:0 lds
    s_mov_b32 s57, 957696
    buffer_load_dwordx4 v2, s[8:11], s57 offen offset:1024 lds
    s_add_u32 m0, s90, 131072
    s_mov_b32 s57, 1033984
    buffer_load_dwordx4 v2, s[8:11], s57 offen offset:0 lds
    s_waitcnt vmcnt(12)
    s_waitcnt lgkmcnt(0)
    s_barrier
    ds_read_b64_tr_b16 a[112:113], v8 offset:0
    ds_read_b64_tr_b16 a[114:115], v8 offset:1024
    ds_read_b64_tr_b16 a[116:117], v9 offset:0
    ds_read_b64_tr_b16 a[118:119], v9 offset:1024
    ds_read_b64_tr_b16 a[136:137], v8 offset:8192
    ds_read_b64_tr_b16 a[138:139], v8 offset:9216
    ds_read_b64_tr_b16 a[140:141], v9 offset:8192
    ds_read_b64_tr_b16 a[142:143], v9 offset:9216
    ds_read_b64_tr_b16 a[160:161], v8 offset:16384
    ds_read_b64_tr_b16 a[162:163], v8 offset:17408
    ds_read_b64_tr_b16 a[164:165], v9 offset:16384
    ds_read_b64_tr_b16 a[166:167], v9 offset:17408
    s_mov_b32 s57, 1043712
    buffer_load_dwordx4 v2, s[8:11], s57 offen offset:1024 lds
    s_waitcnt vmcnt(6)
    v_cmp_ne_u32 vcc, s47, v21
    s_nop 0
    s_cbranch_vccz L_ok20
    s_mov_b32 s59, 100000
L_spin19:
    buffer_load_dword v21, v19, s[24:27], 0 offen sc1
    s_waitcnt vmcnt(0)
    v_cmp_ne_u32 vcc, s47, v21
    s_nop 0
    s_cbranch_vccz L_ok20
    s_sub_u32 s59, s59, 1
    s_cbranch_scc0 L_spin19
L_ok20:
    s_add_u32 m0, s52, 0
    s_sub_u32 s58, s72, 512
    s_max_i32 s58, s58, 0
    s_add_u32 s57, s58, s68
    buffer_load_dwordx4 v3, s[24:27], s57 offen offset:0 sc1 lds
    s_add_u32 s57, s58, s69
    buffer_load_dwordx4 v3, s[24:27], s57 offen offset:1024 sc1 lds
    s_add_u32 s57, s58, s70
    buffer_load_dwordx4 v24, s[24:27], s57 offen offset:2048 sc1 lds
    s_add_u32 s57, s58, s71
    buffer_load_dwordx4 v3, s[24:27], s57 offen offset:3072 sc1 lds
    s_add_u32 m0, s52, 16384
    s_add_u32 s58, s72, 0
    s_add_u32 s57, s58, s68
    buffer_load_dwordx4 v3, s[24:27], s57 offen offset:0 sc1 lds
    s_waitcnt lgkmcnt(0)
    s_barrier
    ds_read_b64_tr_b16 a[184:185], v8 offset:24576
    ds_read_b64_tr_b16 a[186:187], v8 offset:25600
    ds_read_b64_tr_b16 a[188:189], v9 offset:24576
    ds_read_b64_tr_b16 a[190:191], v9 offset:25600
    ds_read_b64_tr_b16 a[208:209], v8 offset:32768
    ds_read_b64_tr_b16 a[210:211], v8 offset:33792
    ds_read_b64_tr_b16 a[212:213], v9 offset:32768
    ds_read_b64_tr_b16 a[214:215], v9 offset:33792
    ds_read_b64_tr_b16 a[232:233], v8 offset:40960
    ds_read_b64_tr_b16 a[234:235], v8 offset:41984
    ds_read_b64_tr_b16 a[236:237], v9 offset:40960
    ds_read_b64_tr_b16 a[238:239], v9 offset:41984
    s_add_u32 s57, s58, s69
    buffer_load_dwordx4 v3, s[24:27], s57 offen offset:1024 sc1 lds
    s_add_u32 s57, s58, s70
    buffer_load_dwordx4 v24, s[24:27], s57 offen offset:2048 sc1 lds
    s_add_u32 s57, s58, s71
    buffer_load_dwordx4 v3, s[24:27], s57 offen offset:3072 sc1 lds
    s_add_u32 m0, s90, 139264
    s_mov_b32 s57, 1120000
    buffer_load_dwordx4 v2, s[8:11], s57 offen offset:0 lds
    s_mov_b32 s57, 1129728
    buffer_load_dwordx4 v2, s[8:11], s57 offen offset:1024 lds
    s_add_u32 m0, s90, 147456
    s_mov_b32 s57, 0
    buffer_load_dwordx4 v2, s[8:11], s57 offen offset:0 lds
    s_mov_b32 s57, 9728
    buffer_load_dwordx4 v2, s[8:11], s57 offen offset:1024 lds
    s_add_u32 m0, s90, 155648
    s_mov_b32 s57, 86016
    buffer_load_dwordx4 v2, s[8:11], s57 offen offset:0 lds
    s_mov_b32 s57, 95744
    buffer_load_dwordx4 v2, s[8:11], s57 offen offset:1024 lds
    s_add_u32 m0, s52, 32768
    s_add_u32 s58, s72, 512
    s_add_u32 s57, s58, s68
    buffer_load_dwordx4 v3, s[24:27], s57 offen offset:0 sc1 lds
    s_add_u32 s57, s58, s69
    buffer_load_dwordx4 v3, s[24:27], s57 offen offset:1024 sc1 lds
    s_waitcnt vmcnt(12)
    s_waitcnt lgkmcnt(0)
    s_barrier
    ds_read_b64_tr_b16 v[120:121], v4 offset:0
    ds_read_b64_tr_b16 v[122:123], v25 offset:0
    ds_read_b64_tr_b16 v[124:125], v4 offset:1024
    ds_read_b64_tr_b16 v[126:127], v25 offset:1024
    ds_read_b64_tr_b16 v[128:129], v4 offset:2048
    ds_read_b64_tr_b16 v[130:131], v25 offset:2048
    ds_read_b64_tr_b16 v[132:133], v4 offset:3072
    ds_read_b64_tr_b16 v[134:135], v25 offset:3072
    ds_read_b64_tr_b16 v[136:137], v4 offset:4096
    ds_read_b64_tr_b16 v[138:139], v25 offset:4096
    ds_read_b64_tr_b16 v[140:141], v4 offset:5120
    ds_read_b64_tr_b16 v[142:143], v25 offset:5120
    ds_read_b64_tr_b16 v[144:145], v4 offset:6144
    ds_read_b64_tr_b16 v[146:147], v25 offset:6144
    ds_read_b64_tr_b16 v[148:149], v4 offset:7168
    ds_read_b64_tr_b16 v[150:151], v25 offset:7168
    ds_read_b64_tr_b16 v[152:153], v4 offset:8192
    ds_read_b64_tr_b16 v[154:155], v25 offset:8192
    ds_read_b64_tr_b16 v[156:157], v4 offset:9216
    ds_read_b64_tr_b16 v[158:159], v25 offset:9216
    ds_read_b64_tr_b16 v[160:161], v4 offset:10240
    ds_read_b64_tr_b16 v[162:163], v25 offset:10240
    ds_read_b64_tr_b16 v[164:165], v4 offset:11264
    ds_read_b64_tr_b16 v[166:167], v25 offset:11264
    ds_read_b64_tr_b16 v[168:169], v4 offset:12288
    ds_read_b64_tr_b16 v[170:171], v25 offset:12288
    ds_read_b64_tr_b16 v[172:173], v4 offset:13312
    ds_read_b64_tr_b16 v[174:175], v25 offset:13312
    s_waitcnt lgkmcnt(15)
    v_mfma_f32_16x16x32_bf16 v[96:99], a[8:11], v[120:123], 0
    s_add_u32 s57, s58, s70
    ds_read_b64_tr_b16 v[176:177], v12 offset:0
    v_mfma_f32_16x16x32_bf16 v[96:99], a[32:35], v[124:127], v[96:99]
    buffer_load_dwordx4 v24, s[24:27], s57 offen offset:2048 sc1 lds
    v_mfma_f32_16x16x32_bf16 v[96:99], a[56:59], v[128:131], v[96:99]
    ds_read_b64_tr_b16 v[178:179], v12 offset:1024
    ds_read_b64_tr_b16 v[180:181], v13 offset:0
    v_mfma_f32_16x16x32_bf16 v[96:99], a[80:83], v[132:135], v[96:99]
    ds_read_b64_tr_b16 v[182:183], v13 offset:1024
    ds_read_b64_tr_b16 v[200:201], v12 offset:8192
    v_mfma_f32_16x16x32_bf16 v[96:99], a[104:107], v[136:139], v[96:99]
    s_add_u32 s57, s58, s71
    ds_read_b64_tr_b16 v[202:203], v12 offset:9216
    v_mfma_f32_16x16x32_bf16 v[96:99], a[128:131], v[140:143], v[96:99]
    buffer_load_dwordx4 v3, s[24:27], s57 offen offset:3072 sc1 lds
    s_waitcnt lgkmcnt(15)
    v_mfma_f32_16x16x32_bf16 v[96:99], a[152:155], v[144:147], v[96:99]
    ds_read_b64_tr_b16 v[204:205], v13 offset:8192
    ds_read_b64_tr_b16 v[206:207], v13 offset:9216
    v_mfma_f32_16x16x32_bf16 v[96:99], a[176:179], v[148:151], v[96:99]
    ds_read_b64_tr_b16 v[224:225], v12 offset:16384
    ds_read_b64_tr_b16 v[226:227], v12 offset:17408
    s_waitcnt lgkmcnt(15)
    v_mfma_f32_16x16x32_bf16 v[96:99], a[200:203], v[152:155], v[96:99]
    s_add_u32 m0, s90, 65536
    s_mov_b32 s57, 172032
    ds_read_b64_tr_b16 v[228:229], v13 offset:16384
    v_mfma_f32_16x16x32_bf16 v[96:99], a[224:227], v[156:159], v[96:99]
    buffer_load_dwordx4 v2, s[8:11], s57 offen offset:0 lds
    s_waitcnt lgkmcnt(15)
    v_mfma_f32_16x16x32_bf16 v[96:99], a[248:251], v[160:163], v[96:99]
    ds_read_b64_tr_b16 v[230:231], v13 offset:17408
    v_mfma_f32_16x16x32_bf16 v[96:99], v[192:195], v[164:167], v[96:99]
    s_waitcnt lgkmcnt(12)
    v_mfma_f32_16x16x32_bf16 v[96:99], v[216:219], v[168:171], v[96:99]
    s_mov_b32 s57, 181760
    v_mfma_f32_16x16x32_bf16 v[96:99], v[240:243], v[172:175], v[96:99]
    buffer_load_dwordx4 v2, s[8:11], s57 offen offset:1024 lds
    v_mfma_f32_16x16x32_bf16 v[100:103], a[12:15], v[120:123], 0
    v_mfma_f32_16x16x32_bf16 v[100:103], a[36:39], v[124:127], v[100:103]
    v_mfma_f32_16x16x32_bf16 v[100:103], a[60:63], v[128:131], v[100:103]
    s_add_u32 m0, s90, 73728
    s_mov_b32 s57, 258048
    v_mfma_f32_16x16x32_bf16 v[100:103], a[84:87], v[132:135], v[100:103]
    buffer_load_dwordx4 v2, s[8:11], s57 offen offset:0 lds
    v_mfma_f32_16x16x32_bf16 v[100:103], a[108:111], v[136:139], v[100:103]
    v_mfma_f32_16x16x32_bf16 v[100:103], a[132:135], v[140:143], v[100:103]
    v_mfma_f32_16x16x32_bf16 v[100:103], a[156:159], v[144:147], v[100:103]
    s_mov_b32 s57, 267776
    v_cvt_pk_bf16_f32 v52, v96, v97
    v_mfma_f32_16x16x32_bf16 v[100:103], a[180:183], v[148:151], v[100:103]
    buffer_load_dwordx4 v2, s[8:11], s57 offen offset:1024 lds
    v_mfma_f32_16x16x32_bf16 v[100:103], a[204:207], v[152:155], v[100:103]
    v_cvt_pk_bf16_f32 v53, v98, v99
    v_mfma_f32_16x16x32_bf16 v[100:103], a[228:231], v[156:159], v[100:103]
    v_mfma_f32_16x16x32_bf16 v[100:103], a[252:255], v[160:163], v[100:103]
    s_add_u32 m0, s90, 81920
    s_mov_b32 s57, 344064
    v_mfma_f32_16x16x32_bf16 v[100:103], v[196:199], v[164:167], v[100:103]
    buffer_load_dwordx4 v2, s[8:11], s57 offen offset:0 lds
    v_mfma_f32_16x16x32_bf16 v[100:103], v[220:223], v[168:171], v[100:103]
    v_mfma_f32_16x16x32_bf16 v[100:103], v[244:247], v[172:175], v[100:103]
    v_mfma_f32_16x16x32_bf16 v[104:107], v[120:123], a[16:19], 0
    s_mov_b32 s57, 353792
    v_mfma_f32_16x16x32_bf16 v[104:107], v[124:127], a[40:43], v[104:107]
    buffer_load_dwordx4 v2, s[8:11], s57 offen offset:1024 lds
    v_mfma_f32_16x16x32_bf16 v[104:107], v[128:131], a[64:67], v[104:107]
    v_mfma_f32_16x16x32_bf16 v[104:107], v[132:135], a[88:91], v[104:107]
    s_waitcnt vmcnt(10)
    s_waitcnt lgkmcnt(0)
    s_barrier
    v_mfma_f32_16x16x32_bf16 v[104:107], v[136:139], a[112:115], v[104:107]
    s_add_u32 m0, s90, 90112
    s_mov_b32 s57, 430080
    ds_read_b64_tr_b16 v[248:249], v12 offset:24576
    v_mfma_f32_16x16x32_bf16 v[104:107], v[140:143], a[136:139], v[104:107]
    buffer_load_dwordx4 v2, s[8:11], s57 offen offset:0 lds
    v_mfma_f32_16x16x32_bf16 v[104:107], v[144:147], a[160:163], v[104:107]
    v_cvt_pk_bf16_f32 v54, v100, v101
    v_cvt_pk_bf16_f32 v55, v102, v103
    v_mfma_f32_16x16x32_bf16 v[104:107], v[148:151], a[184:187], v[104:107]
    v_cndmask_b32 v54, v54, 0, s[82:83]
    v_cndmask_b32 v55, v55, 0, s[82:83]
    v_mfma_f32_16x16x32_bf16 v[104:107], v[152:155], a[208:211], v[104:107]
    s_mov_b32 s57, 439808
    ds_read_b64_tr_b16 v[250:251], v12 offset:25600
    buffer_load_dwordx4 v2, s[8:11], s57 offen offset:1024 lds
    ds_read_b64_tr_b16 v[252:253], v13 offset:24576
    ds_read_b64_tr_b16 v[254:255], v13 offset:25600
    v_mfma_f32_16x16x32_bf16 v[104:107], v[156:159], a[232:235], v[104:107]
    ds_read_b64_tr_b16 a[0:1], v10 offset:32768
    ds_read_b64_tr_b16 a[2:3], v10 offset:33792
    v_mfma_f32_16x16x32_bf16 v[104:107], v[160:163], v[176:179], v[104:107]
    ds_read_b64_tr_b16 a[4:5], v11 offset:32768
    ds_read_b64_tr_b16 a[6:7], v11 offset:33792
    v_mfma_f32_16x16x32_bf16 v[104:107], v[164:167], v[200:203], v[104:107]
    ds_read_b64_tr_b16 a[24:25], v10 offset:40960
    ds_read_b64_tr_b16 a[26:27], v10 offset:41984
    s_waitcnt lgkmcnt(6)
    v_mfma_f32_16x16x32_bf16 v[104:107], v[168:171], v[224:227], v[104:107]
    s_add_u32 m0, s90, 98304
    s_mov_b32 s57, 516096
    ds_read_b64_tr_b16 a[28:29], v11 offset:40960
    v_mfma_f32_16x16x32_bf16 v[104:107], v[172:175], v[248:251], v[104:107]
    buffer_load_dwordx4 v2, s[8:11], s57 offen offset:0 lds
    v_mfma_f32_16x16x32_bf16 v[108:111], v[120:123], a[20:23], 0
    ds_read_b64_tr_b16 v[120:121], v4 offset:16384
    ds_read_b64_tr_b16 v[122:123], v25 offset:16384
    v_mfma_f32_16x16x32_bf16 v[108:111], v[124:127], a[44:47], v[108:111]
    ds_read_b64_tr_b16 v[124:125], v4 offset:17408
    ds_read_b64_tr_b16 a[30:31], v11 offset:41984
    v_mfma_f32_16x16x32_bf16 v[108:111], v[128:131], a[68:71], v[108:111]
    ds_read_b64_tr_b16 v[126:127], v25 offset:17408
    ds_read_b64_tr_b16 v[128:129], v4 offset:18432
    s_mov_b32 s57, 525824
    v_mfma_f32_16x16x32_bf16 v[108:111], v[132:135], a[92:95], v[108:111]
    buffer_load_dwordx4 v2, s[8:11], s57 offen offset:1024 lds
    v_mfma_f32_16x16x32_bf16 v[108:111], v[136:139], a[116:119], v[108:111]
    ds_read_b64_tr_b16 v[130:131], v25 offset:18432
    ds_read_b64_tr_b16 v[132:133], v4 offset:19456
    v_mfma_f32_16x16x32_bf16 v[108:111], v[140:143], a[140:143], v[108:111]
    ds_read_b64_tr_b16 v[134:135], v25 offset:19456
    ds_read_b64_tr_b16 v[136:137], v4 offset:20480
    v_mfma_f32_16x16x32_bf16 v[108:111], v[144:147], a[164:167], v[108:111]
    ds_read_b64_tr_b16 v[138:139], v25 offset:20480
    s_add_u32 m0, s90, 106496
    s_mov_b32 s57, 602112
    v_mfma_f32_16x16x32_bf16 v[108:111], v[148:151], a[188:191], v[108:111]
    buffer_load_dwordx4 v2, s[8:11], s57 offen offset:0 lds
    v_mfma_f32_16x16x32_bf16 v[108:111], v[152:155], a[212:215], v[108:111]
    ds_read_b64_tr_b16 v[140:141], v4 offset:21504
    ds_read_b64_tr_b16 v[142:143], v25 offset:21504
    v_mfma_f32_16x16x32_bf16 v[108:111], v[156:159], a[236:239], v[108:111]
    ds_read_b64_tr_b16 v[144:145], v4 offset:22528
    ds_read_b64_tr_b16 v[146:147], v25 offset:22528
    v_mfma_f32_16x16x32_bf16 v[108:111], v[160:163], v[180:183], v[108:111]
    ds_read_b64_tr_b16 v[148:149], v4 offset:23552
    ds_read_b64_tr_b16 v[150:151], v25 offset:23552
    s_mov_b32 s57, 611840
    v_mfma_f32_16x16x32_bf16 v[108:111], v[164:167], v[204:207], v[108:111]
    buffer_load_dwordx4 v2, s[8:11], s57 offen offset:1024 lds
    v_mfma_f32_16x16x32_bf16 v[108:111], v[168:171], v[228:231], v[108:111]
    ds_read_b64_tr_b16 v[152:153], v4 offset:24576
    ds_read_b64_tr_b16 v[154:155], v25 offset:24576
    v_mfma_f32_16x16x32_bf16 v[108:111], v[172:175], v[252:255], v[108:111]
    ds_read_b64_tr_b16 v[156:157], v4 offset:25600
    ds_read_b64_tr_b16 v[158:159], v25 offset:25600
    s_waitcnt lgkmcnt(15)
    v_mfma_f32_16x16x32_bf16 v[112:115], a[8:11], v[120:123], 0
    ds_read_b64_tr_b16 v[160:161], v4 offset:26624
    s_add_u32 m0, s90, 114688
    s_mov_b32 s57, 688128
    v_mfma_f32_16x16x32_bf16 v[112:115], a[32:35], v[124:127], v[112:115]
    buffer_load_dwordx4 v2, s[8:11], s57 offen offset:0 lds
    s_waitcnt lgkmcnt(13)
    v_mfma_f32_16x16x32_bf16 v[112:115], a[56:59], v[128:131], v[112:115]
    ds_read_b64_tr_b16 v[162:163], v25 offset:26624
    ds_read_b64_tr_b16 v[164:165], v4 offset:27648
    v_mfma_f32_16x16x32_bf16 v[112:115], a[80:83], v[132:135], v[112:115]
    ds_read_b64_tr_b16 v[166:167], v25 offset:27648
    ds_read_b64_tr_b16 v[168:169], v4 offset:28672
    s_waitcnt lgkmcnt(13)
    v_mfma_f32_16x16x32_bf16 v[112:115], a[104:107], v[136:139], v[112:115]
    ds_read_b64_tr_b16 v[170:171], v25 offset:28672
    ds_read_b64_tr_b16 v[172:173], v4 offset:29696
    s_mov_b32 s57, 697856
    v_mfma_f32_16x16x32_bf16 v[112:115], a[128:131], v[140:143], v[112:115]
    buffer_load_dwordx4 v2, s[8:11], s57 offen offset:1024 lds
    s_waitcnt lgkmcnt(11)
    v_mfma_f32_16x16x32_bf16 v[112:115], a[152:155], v[144:147], v[112:115]
    ds_read_b64_tr_b16 v[174:175], v25 offset:29696
    v_cvt_pk_bf16_f32 v32, v104, v105
    v_mfma_f32_16x16x32_bf16 v[112:115], a[176:179], v[148:151], v[112:115]
    v_cvt_pk_bf16_f32 v33, v106, v107
    v_cvt_pk_bf16_f32 v42, v108, v109
    s_waitcnt lgkmcnt(8)
    v_mfma_f32_16x16x32_bf16 v[112:115], a[200:203], v[152:155], v[112:115]
    s_add_u32 m0, s90, 122880
    s_mov_b32 s57, 774144
    v_cvt_pk_bf16_f32 v43, v110, v111
    v_mfma_f32_16x16x32_bf16 v[112:115], a[224:227], v[156:159], v[112:115]
    buffer_load_dwordx4 v2, s[8:11], s57 offen offset:0 lds
    s_waitcnt lgkmcnt(4)
    v_mfma_f32_16x16x32_bf16 v[112:115], a[248:251], v[160:163], v[112:115]
    v_mfma_f32_16x16x32_bf16 v[112:115], v[192:195], v[164:167], v[112:115]
    s_waitcnt lgkmcnt(0)
    v_mfma_f32_16x16x32_bf16 v[112:115], v[216:219], v[168:171], v[112:115]
    s_mov_b32 s57, 783872
    v_mfma_f32_16x16x32_bf16 v[112:115], v[240:243], v[172:175], v[112:115]
    buffer_load_dwordx4 v2, s[8:11], s57 offen offset:1024 lds
    v_mfma_f32_16x16x32_bf16 v[116:119], a[12:15], v[120:123], 0
    v_mfma_f32_16x16x32_bf16 v[116:119], a[36:39], v[124:127], v[116:119]
    s_waitcnt vmcnt(10)
    s_barrier
    v_mfma_f32_16x16x32_bf16 v[116:119], a[60:63], v[128:131], v[116:119]
    s_add_u32 m0, s90, 131072
    s_mov_b32 s57, 860160
    ds_read_b64_tr_b16 a[48:49], v6 offset:0
    v_mfma_f32_16x16x32_bf16 v[116:119], a[84:87], v[132:135], v[116:119]
    buffer_load_dwordx4 v2, s[8:11], s57 offen offset:0 lds
    v_mfma_f32_16x16x32_bf16 v[116:119], a[108:111], v[136:139], v[116:119]
    ds_read_b64_tr_b16 a[50:51], v6 offset:1024
    ds_read_b64_tr_b16 a[52:53], v7 offset:0
    v_mfma_f32_16x16x32_bf16 v[116:119], a[132:135], v[140:143], v[116:119]
    ds_read_b64_tr_b16 a[54:55], v7 offset:1024
    ds_read_b64_tr_b16 a[72:73], v6 offset:8192
    v_mfma_f32_16x16x32_bf16 v[116:119], a[156:159], v[144:147], v[116:119]
    s_mov_b32 s57, 869888
    v_cvt_pk_bf16_f32 v56, v112, v113
    v_mfma_f32_16x16x32_bf16 v[116:119], a[180:183], v[148:151], v[116:119]
    buffer_load_dwordx4 v2, s[8:11], s57 offen offset:1024 lds
    v_mfma_f32_16x16x32_bf16 v[116:119], a[204:207], v[152:155], v[116:119]
    v_cvt_pk_bf16_f32 v57, v114, v115
    ds_read_b64_tr_b16 a[74:75], v6 offset:9216
    v_mfma_f32_16x16x32_bf16 v[116:119], a[228:231], v[156:159], v[116:119]
    ds_read_b64_tr_b16 a[76:77], v7 offset:8192
    ds_read_b64_tr_b16 a[78:79], v7 offset:9216
    v_mfma_f32_16x16x32_bf16 v[116:119], a[252:255], v[160:163], v[116:119]
    s_add_u32 m0, s90, 139264
    s_mov_b32 s57, 946176
    ds_read_b64_tr_b16 a[96:97], v6 offset:16384
    v_mfma_f32_16x16x32_bf16 v[116:119], v[196:199], v[164:167], v[116:119]
    buffer_load_dwordx4 v2, s[8:11], s57 offen offset:0 lds
    v_mfma_f32_16x16x32_bf16 v[116:119], v[220:223], v[168:171], v[116:119]
    ds_read_b64_tr_b16 a[98:99], v6 offset:17408
    ds_read_b64_tr_b16 a[100:101], v7 offset:16384
    v_mfma_f32_16x16x32_bf16 v[116:119], v[244:247], v[172:175], v[116:119]
    ds_read_b64_tr_b16 a[102:103], v7 offset:17408
    v_mfma_f32_16x16x32_bf16 v[96:99], v[120:123], a[16:19], 0
    s_mov_b32 s57, 955904
    v_mfma_f32_16x16x32_bf16 v[96:99], v[124:127], a[40:43], v[96:99]
    buffer_load_dwordx4 v2, s[8:11], s57 offen offset:1024 lds
    v_mfma_f32_16x16x32_bf16 v[96:99], v[128:131], a[64:67], v[96:99]
    v_mfma_f32_16x16x32_bf16 v[96:99], v[132:135], a[88:91], v[96:99]
    v_mfma_f32_16x16x32_bf16 v[96:99], v[136:139], a[112:115], v[96:99]
    s_add_u32 m0, s90, 147456
    s_mov_b32 s57, 1032192
    v_mfma_f32_16x16x32_bf16 v[96:99], v[140:143], a[136:139], v[96:99]
    buffer_load_dwordx4 v2, s[8:11], s57 offen offset:0 lds
    v_mfma_f32_16x16x32_bf16 v[96:99], v[144:147], a[160:163], v[96:99]
    v_cvt_pk_bf16_f32 v58, v116, v117
    v_cvt_pk_bf16_f32 v59, v118, v119
    v_mfma_f32_16x16x32_bf16 v[96:99], v[148:151], a[184:187], v[96:99]
    v_cndmask_b32 v58, v58, 0, s[82:83]
    v_cndmask_b32 v59, v59, 0, s[82:83]
    v_mfma_f32_16x16x32_bf16 v[96:99], v[152:155], a[208:211], v[96:99]
    s_mov_b32 s57, 1041920
    v_mfma_f32_16x16x32_bf16 v[96:99], v[156:159], a[232:235], v[96:99]
    buffer_load_dwordx4 v2, s[8:11], s57 offen offset:1024 lds
    v_mfma_f32_16x16x32_bf16 v[96:99], v[160:163], v[176:179], v[96:99]
    v_mfma_f32_16x16x32_bf16 v[96:99], v[164:167], v[200:203], v[96:99]
    s_waitcnt vmcnt(10)
    s_waitcnt lgkmcnt(0)
    s_barrier
    v_mfma_f32_16x16x32_bf16 v[96:99], v[168:171], v[224:227], v[96:99]
    s_add_u32 m0, s90, 155648
    s_mov_b32 s57, 1118208
    ds_read_b64_tr_b16 a[120:121], v6 offset:24576
    v_mfma_f32_16x16x32_bf16 v[96:99], v[172:175], v[248:251], v[96:99]
    buffer_load_dwordx4 v2, s[8:11], s57 offen offset:0 lds
    v_mfma_f32_16x16x32_bf16 v[100:103], v[120:123], a[20:23], 0
    ds_read_b64_tr_b16 v[120:121], v4 offset:32768
    ds_read_b64_tr_b16 v[122:123], v25 offset:32768
    v_mfma_f32_16x16x32_bf16 v[100:103], v[124:127], a[44:47], v[100:103]
    ds_read_b64_tr_b16 v[124:125], v4 offset:33792
    ds_read_b64_tr_b16 a[122:123], v6 offset:25600
    v_mfma_f32_16x16x32_bf16 v[100:103], v[128:131], a[68:71], v[100:103]
    ds_read_b64_tr_b16 v[126:127], v25 offset:33792
    ds_read_b64_tr_b16 v[128:129], v4 offset:34816
    s_mov_b32 s57, 1127936
    v_mfma_f32_16x16x32_bf16 v[100:103], v[132:135], a[92:95], v[100:103]
    buffer_load_dwordx4 v2, s[8:11], s57 offen offset:1024 lds
    v_mfma_f32_16x16x32_bf16 v[100:103], v[136:139], a[116:119], v[100:103]
    ds_read_b64_tr_b16 v[130:131], v25 offset:34816
    ds_read_b64_tr_b16 v[132:133], v4 offset:35840
    v_mfma_f32_16x16x32_bf16 v[100:103], v[140:143], a[140:143], v[100:103]
    ds_read_b64_tr_b16 v[134:135], v25 offset:35840
    ds_read_b64_tr_b16 v[136:137], v4 offset:36864
    v_mfma_f32_16x16x32_bf16 v[100:103], v[144:147], a[164:167], v[100:103]
    ds_read_b64_tr_b16 v[138:139], v25 offset:36864
    s_add_u32 m0, s52, 49152
    s_add_u32 s58, s72, 1024
    s_add_u32 s57, s58, s68
    v_mfma_f32_16x16x32_bf16 v[100:103], v[148:151], a[188:191], v[100:103]
    buffer_load_dwordx4 v3, s[24:27], s57 offen offset:0 sc1 lds
    v_mfma_f32_16x16x32_bf16 v[100:103], v[152:155], a[212:215], v[100:103]
    ds_read_b64_tr_b16 v[140:141], v4 offset:37888
    ds_read_b64_tr_b16 v[142:143], v25 offset:37888
    v_mfma_f32_16x16x32_bf16 v[100:103], v[156:159], a[236:239], v[100:103]
    ds_read_b64_tr_b16 v[144:145], v4 offset:38912
    ds_read_b64_tr_b16 v[146:147], v25 offset:38912
    v_mfma_f32_16x16x32_bf16 v[100:103], v[160:163], v[180:183], v[100:103]
    ds_read_b64_tr_b16 v[148:149], v4 offset:39936
    ds_read_b64_tr_b16 v[150:151], v25 offset:39936
    s_add_u32 s57, s58, s69
    v_mfma_f32_16x16x32_bf16 v[100:103], v[164:167], v[204:207], v[100:103]
    buffer_load_dwordx4 v3, s[24:27], s57 offen offset:1024 sc1 lds
    v_mfma_f32_16x16x32_bf16 v[100:103], v[168:171], v[228:231], v[100:103]
    ds_read_b64_tr_b16 v[152:153], v4 offset:40960
    ds_read_b64_tr_b16 v[154:155], v25 offset:40960
    v_mfma_f32_16x16x32_bf16 v[100:103], v[172:175], v[252:255], v[100:103]
    ds_read_b64_tr_b16 v[156:157], v4 offset:41984
    ds_read_b64_tr_b16 v[158:159], v25 offset:41984
    s_waitcnt lgkmcnt(15)
    v_mfma_f32_16x16x32_bf16 v[104:107], a[8:11], v[120:123], 0
    ds_read_b64_tr_b16 v[160:161], v4 offset:43008
    s_add_u32 s57, s58, s70
    v_mfma_f32_16x16x32_bf16 v[104:107], a[32:35], v[124:127], v[104:107]
    buffer_load_dwordx4 v24, s[24:27], s57 offen offset:2048 sc1 lds
    s_waitcnt lgkmcnt(13)
    v_mfma_f32_16x16x32_bf16 v[104:107], a[56:59], v[128:131], v[104:107]
    ds_read_b64_tr_b16 v[162:163], v25 offset:43008
    ds_read_b64_tr_b16 v[164:165], v4 offset:44032
    v_mfma_f32_16x16x32_bf16 v[104:107], a[80:83], v[132:135], v[104:107]
    ds_read_b64_tr_b16 v[166:167], v25 offset:44032
    ds_read_b64_tr_b16 v[168:169], v4 offset:45056
    s_waitcnt lgkmcnt(13)
    v_mfma_f32_16x16x32_bf16 v[104:107], a[104:107], v[136:139], v[104:107]
    ds_read_b64_tr_b16 v[170:171], v25 offset:45056
    ds_read_b64_tr_b16 v[172:173], v4 offset:46080
    s_add_u32 s57, s58, s71
    v_mfma_f32_16x16x32_bf16 v[104:107], a[128:131], v[140:143], v[104:107]
    buffer_load_dwordx4 v3, s[24:27], s57 offen offset:3072 sc1 lds
    s_waitcnt lgkmcnt(11)
    v_mfma_f32_16x16x32_bf16 v[104:107], a[152:155], v[144:147], v[104:107]
    ds_read_b64_tr_b16 v[174:175], v25 offset:46080
    v_cvt_pk_bf16_f32 v34, v96, v97
    v_mfma_f32_16x16x32_bf16 v[104:107], a[176:179], v[148:151], v[104:107]
    v_cvt_pk_bf16_f32 v35, v98, v99
    v_cvt_pk_bf16_f32 v44, v100, v101
    s_waitcnt lgkmcnt(8)
    v_mfma_f32_16x16x32_bf16 v[104:107], a[200:203], v[152:155], v[104:107]
    v_cvt_pk_bf16_f32 v45, v102, v103
    ds_read_b64_tr_b16 a[124:125], v7 offset:24576
    v_mfma_f32_16x16x32_bf16 v[104:107], a[224:227], v[156:159], v[104:107]
    ds_read_b64_tr_b16 a[126:127], v7 offset:25600
    ds_read_b64_tr_b16 a[144:145], v6 offset:32768
    s_waitcnt lgkmcnt(7)
    v_mfma_f32_16x16x32_bf16 v[104:107], a[248:251], v[160:163], v[104:107]
    ds_read_b64_tr_b16 a[146:147], v6 offset:33792
    ds_read_b64_tr_b16 a[148:149], v7 offset:32768
    v_mfma_f32_16x16x32_bf16 v[104:107], v[192:195], v[164:167], v[104:107]
    ds_read_b64_tr_b16 a[150:151], v7 offset:33792
    ds_read_b64_tr_b16 a[168:169], v6 offset:40960
    s_waitcnt lgkmcnt(7)
    v_mfma_f32_16x16x32_bf16 v[104:107], v[216:219], v[168:171], v[104:107]
    ds_read_b64_tr_b16 a[170:171], v6 offset:41984
    ds_read_b64_tr_b16 a[172:173], v7 offset:40960
    v_mfma_f32_16x16x32_bf16 v[104:107], v[240:243], v[172:175], v[104:107]
    ds_read_b64_tr_b16 a[174:175], v7 offset:41984
    s_waitcnt vmcnt(10)
    s_waitcnt lgkmcnt(0)
    s_barrier
    v_mfma_f32_16x16x32_bf16 v[108:111], a[12:15], v[120:123], 0
    ds_read_b64_tr_b16 a[192:193], v10 offset:0
    ds_read_b64_tr_b16 a[194:195], v10 offset:1024
    v_mfma_f32_16x16x32_bf16 v[108:111], a[36:39], v[124:127], v[108:111]
    ds_read_b64_tr_b16 a[196:197], v11 offset:0
    ds_read_b64_tr_b16 a[198:199], v11 offset:1024
    v_mfma_f32_16x16x32_bf16 v[108:111], a[60:63], v[128:131], v[108:111]
    ds_read_b64_tr_b16 a[216:217], v10 offset:8192
    ds_read_b64_tr_b16 a[218:219], v10 offset:9216
    v_mfma_f32_16x16x32_bf16 v[108:111], a[84:87], v[132:135], v[108:111]
    ds_read_b64_tr_b16 a[220:221], v11 offset:8192
    ds_read_b64_tr_b16 a[222:223], v11 offset:9216
    v_mfma_f32_16x16x32_bf16 v[108:111], a[108:111], v[136:139], v[108:111]
    ds_read_b64_tr_b16 a[240:241], v10 offset:16384
    ds_read_b64_tr_b16 a[242:243], v10 offset:17408
    v_mfma_f32_16x16x32_bf16 v[108:111], a[132:135], v[140:143], v[108:111]
    ds_read_b64_tr_b16 a[244:245], v11 offset:16384
    ds_read_b64_tr_b16 a[246:247], v11 offset:17408
    v_mfma_f32_16x16x32_bf16 v[108:111], a[156:159], v[144:147], v[108:111]
    v_cvt_pk_bf16_f32 v60, v104, v105
    v_cvt_pk_bf16_f32 v61, v106, v107
    v_mfma_f32_16x16x32_bf16 v[108:111], a[180:183], v[148:151], v[108:111]
    v_mfma_f32_16x16x32_bf16 v[108:111], a[204:207], v[152:155], v[108:111]
    v_mfma_f32_16x16x32_bf16 v[108:111], a[228:231], v[156:159], v[108:111]
    v_mfma_f32_16x16x32_bf16 v[108:111], a[252:255], v[160:163], v[108:111]
    v_mfma_f32_16x16x32_bf16 v[108:111], v[196:199], v[164:167], v[108:111]
    v_mfma_f32_16x16x32_bf16 v[108:111], v[220:223], v[168:171], v[108:111]
    v_mfma_f32_16x16x32_bf16 v[108:111], v[244:247], v[172:175], v[108:111]
    v_mfma_f32_16x16x32_bf16 v[112:115], v[120:123], a[16:19], 0
    v_mfma_f32_16x16x32_bf16 v[112:115], v[124:127], a[40:43], v[112:115]
    v_mfma_f32_16x16x32_bf16 v[112:115], v[128:131], a[64:67], v[112:115]
    v_mfma_f32_16x16x32_bf16 v[112:115], v[132:135], a[88:91], v[112:115]
    s_waitcnt vmcnt(4)
    s_waitcnt lgkmcnt(0)
    s_barrier
    v_mfma_f32_16x16x32_bf16 v[112:115], v[136:139], a[112:115], v[112:115]
    ds_read_b64_tr_b16 v[184:185], v10 offset:24576
    ds_read_b64_tr_b16 v[186:187], v10 offset:25600
    v_mfma_f32_16x16x32_bf16 v[112:115], v[140:143], a[136:139], v[112:115]
    ds_read_b64_tr_b16 v[188:189], v11 offset:24576
    ds_read_b64_tr_b16 v[190:191], v11 offset:25600
    v_mfma_f32_16x16x32_bf16 v[112:115], v[144:147], a[160:163], v[112:115]
    v_cvt_pk_bf16_f32 v62, v108, v109
    v_cvt_pk_bf16_f32 v63, v110, v111
    v_mfma_f32_16x16x32_bf16 v[112:115], v[148:151], a[184:187], v[112:115]
    v_cndmask_b32 v62, v62, 0, s[82:83]
    v_cndmask_b32 v63, v63, 0, s[82:83]
    v_mfma_f32_16x16x32_bf16 v[112:115], v[152:155], a[208:211], v[112:115]
    ds_read_b64_tr_b16 v[208:209], v10 offset:32768
    ds_read_b64_tr_b16 v[210:211], v10 offset:33792
    v_mfma_f32_16x16x32_bf16 v[112:115], v[156:159], a[232:235], v[112:115]
    ds_read_b64_tr_b16 v[212:213], v11 offset:32768
    ds_read_b64_tr_b16 v[214:215], v11 offset:33792
    v_mfma_f32_16x16x32_bf16 v[112:115], v[160:163], v[176:179], v[112:115]
    ds_read_b64_tr_b16 v[232:233], v10 offset:40960
    ds_read_b64_tr_b16 v[234:235], v10 offset:41984
    v_mfma_f32_16x16x32_bf16 v[112:115], v[164:167], v[200:203], v[112:115]
    ds_read_b64_tr_b16 v[236:237], v11 offset:40960
    ds_read_b64_tr_b16 v[238:239], v11 offset:41984
    v_mfma_f32_16x16x32_bf16 v[112:115], v[168:171], v[224:227], v[112:115]
    v_mfma_f32_16x16x32_bf16 v[112:115], v[172:175], v[248:251], v[112:115]
    v_mfma_f32_16x16x32_bf16 v[116:119], v[120:123], a[20:23], 0
    v_mfma_f32_16x16x32_bf16 v[116:119], v[124:127], a[44:47], v[116:119]
    s_waitcnt lgkmcnt(0)
    s_barrier
    v_mfma_f32_16x16x32_bf16 v[116:119], v[128:131], a[68:71], v[116:119]
    s_add_u32 m0, s52, 65536
    s_add_u32 s58, s72, 1536
    s_add_u32 s57, s58, s68
    v_mfma_f32_16x16x32_bf16 v[116:119], v[132:135], a[92:95], v[116:119]
    buffer_load_dwordx4 v3, s[24:27], s57 offen offset:0 sc1 lds
    v_mfma_f32_16x16x32_bf16 v[116:119], v[136:139], a[116:119], v[116:119]
    v_mfma_f32_16x16x32_bf16 v[116:119], v[140:143], a[140:143], v[116:119]
    v_mfma_f32_16x16x32_bf16 v[116:119], v[144:147], a[164:167], v[116:119]
    v_cvt_pk_bf16_f32 v36, v112, v113
    v_cvt_pk_bf16_f32 v37, v114, v115
    v_mfma_f32_16x16x32_bf16 v[116:119], v[148:151], a[188:191], v[116:119]
    v_mfma_f32_16x16x32_bf16 v[116:119], v[152:155], a[212:215], v[116:119]
    s_add_u32 s57, s58, s69
    v_mfma_f32_16x16x32_bf16 v[116:119], v[156:159], a[236:239], v[116:119]
    buffer_load_dwordx4 v3, s[24:27], s57 offen offset:1024 sc1 lds
    v_mfma_f32_16x16x32_bf16 v[116:119], v[160:163], v[180:183], v[116:119]
    v_mfma_f32_16x16x32_bf16 v[116:119], v[164:167], v[204:207], v[116:119]
    v_mfma_f32_16x16x32_bf16 v[116:119], v[168:171], v[228:231], v[116:119]
    v_mfma_f32_16x16x32_bf16 v[116:119], v[172:175], v[252:255], v[116:119]
    v_mfma_f32_16x16x32_bf16 v[96:99], a[0:3], v[120:123], 0
    s_add_u32 s57, s58, s70
    v_mfma_f32_16x16x32_bf16 v[96:99], a[24:27], v[124:127], v[96:99]
    buffer_load_dwordx4 v24, s[24:27], s57 offen offset:2048 sc1 lds
    v_mfma_f32_16x16x32_bf16 v[96:99], a[48:51], v[128:131], v[96:99]
    v_mfma_f32_16x16x32_bf16 v[96:99], a[72:75], v[132:135], v[96:99]
    v_mfma_f32_16x16x32_bf16 v[96:99], a[96:99], v[136:139], v[96:99]
    v_mfma_f32_16x16x32_bf16 v[96:99], a[120:123], v[140:143], v[96:99]
    v_mfma_f32_16x16x32_bf16 v[96:99], a[144:147], v[144:147], v[96:99]
    s_add_u32 s57, s58, s71
    v_cvt_pk_bf16_f32 v46, v116, v117
    v_mfma_f32_16x16x32_bf16 v[96:99], a[168:171], v[148:151], v[96:99]
    buffer_load_dwordx4 v3, s[24:27], s57 offen offset:3072 sc1 lds
    v_mfma_f32_16x16x32_bf16 v[96:99], a[192:195], v[152:155], v[96:99]
    v_cvt_pk_bf16_f32 v47, v118, v119
    v_mfma_f32_16x16x32_bf16 v[96:99], a[216:219], v[156:159], v[96:99]
    v_mfma_f32_16x16x32_bf16 v[96:99], a[240:243], v[160:163], v[96:99]
    v_mfma_f32_16x16x32_bf16 v[96:99], v[184:187], v[164:167], v[96:99]
    v_mfma_f32_16x16x32_bf16 v[96:99], v[208:211], v[168:171], v[96:99]
    s_add_u32 m0, s52, 81920
    s_add_u32 s58, s72, 2048
    s_add_u32 s57, s58, s68
    v_mfma_f32_16x16x32_bf16 v[96:99], v[232:235], v[172:175], v[96:99]
    buffer_load_dwordx4 v3, s[24:27], s57 offen offset:0 sc1 lds
    v_mfma_f32_16x16x32_bf16 v[100:103], a[4:7], v[120:123], 0
    ds_read_b64_tr_b16 v[120:121], v4 offset:16384
    ds_read_b64_tr_b16 v[122:123], v25 offset:16384
    v_mfma_f32_16x16x32_bf16 v[100:103], a[28:31], v[124:127], v[100:103]
    ds_read_b64_tr_b16 v[124:125], v4 offset:17408
    v_mfma_f32_16x16x32_bf16 v[100:103], a[52:55], v[128:131], v[100:103]
    ds_read_b64_tr_b16 v[126:127], v25 offset:17408
    ds_read_b64_tr_b16 v[128:129], v4 offset:18432
    v_mfma_f32_16x16x32_bf16 v[100:103], a[76:79], v[132:135], v[100:103]
    ds_read_b64_tr_b16 v[130:131], v25 offset:18432
    v_mfma_f32_16x16x32_bf16 v[100:103], a[100:103], v[136:139], v[100:103]
    ds_read_b64_tr_b16 v[132:133], v4 offset:19456
    s_add_u32 s57, s58, s69
    v_mfma_f32_16x16x32_bf16 v[100:103], a[124:127], v[140:143], v[100:103]
    buffer_load_dwordx4 v3, s[24:27], s57 offen offset:1024 sc1 lds
    v_mfma_f32_16x16x32_bf16 v[100:103], a[148:151], v[144:147], v[100:103]
    ds_read_b64_tr_b16 v[134:135], v25 offset:19456
    ds_read_b64_tr_b16 v[136:137], v4 offset:20480
    v_mfma_f32_16x16x32_bf16 v[100:103], a[172:175], v[148:151], v[100:103]
    ds_read_b64_tr_b16 v[138:139], v25 offset:20480
    ds_read_b64_tr_b16 v[140:141], v4 offset:21504
    v_mfma_f32_16x16x32_bf16 v[100:103], a[196:199], v[152:155], v[100:103]
    ds_read_b64_tr_b16 v[142:143], v25 offset:21504
    ds_read_b64_tr_b16 v[144:145], v4 offset:22528
    v_mfma_f32_16x16x32_bf16 v[100:103], a[220:223], v[156:159], v[100:103]
    ds_read_b64_tr_b16 v[146:147], v25 offset:22528
    v_cvt_pk_bf16_f32 v64, v96, v97
    v_mfma_f32_16x16x32_bf16 v[100:103], a[244:247], v[160:163], v[100:103]
    ds_read_b64_tr_b16 v[148:149], v4 offset:23552
    ds_read_b64_tr_b16 v[150:151], v25 offset:23552
    s_add_u32 s57, s58, s70
    v_mfma_f32_16x16x32_bf16 v[100:103], v[188:191], v[164:167], v[100:103]
    buffer_load_dwordx4 v24, s[24:27], s57 offen offset:2048 sc1 lds
    v_mfma_f32_16x16x32_bf16 v[100:103], v[212:215], v[168:171], v[100:103]
    ds_read_b64_tr_b16 v[152:153], v4 offset:24576
    ds_read_b64_tr_b16 v[154:155], v25 offset:24576
    v_mfma_f32_16x16x32_bf16 v[100:103], v[236:239], v[172:175], v[100:103]
    ds_read_b64_tr_b16 v[156:157], v4 offset:25600
    ds_read_b64_tr_b16 v[158:159], v25 offset:25600
    s_waitcnt lgkmcnt(15)
    v_mfma_f32_16x16x32_bf16 v[104:107], a[0:3], v[120:123], 0
    ds_read_b64_tr_b16 v[160:161], v4 offset:26624
    v_cvt_pk_bf16_f32 v65, v98, v99
    v_mfma_f32_16x16x32_bf16 v[104:107], a[24:27], v[124:127], v[104:107]
    ds_read_b64_tr_b16 v[162:163], v25 offset:26624
    ds_read_b64_tr_b16 v[164:165], v4 offset:27648
    s_waitcnt lgkmcnt(15)
    v_mfma_f32_16x16x32_bf16 v[104:107], a[48:51], v[128:131], v[104:107]
    ds_read_b64_tr_b16 v[166:167], v25 offset:27648
    s_add_u32 s57, s58, s71
    v_mfma_f32_16x16x32_bf16 v[104:107], a[72:75], v[132:135], v[104:107]
    buffer_load_dwordx4 v3, s[24:27], s57 offen offset:3072 sc1 lds
    s_waitcnt lgkmcnt(12)
    v_mfma_f32_16x16x32_bf16 v[104:107], a[96:99], v[136:139], v[104:107]
    ds_read_b64_tr_b16 v[168:169], v4 offset:28672
    ds_read_b64_tr_b16 v[170:171], v25 offset:28672
    v_mfma_f32_16x16x32_bf16 v[104:107], a[120:123], v[140:143], v[104:107]
    ds_read_b64_tr_b16 v[172:173], v4 offset:29696
    ds_read_b64_tr_b16 v[174:175], v25 offset:29696
    s_waitcnt lgkmcnt(12)
    v_mfma_f32_16x16x32_bf16 v[104:107], a[144:147], v[144:147], v[104:107]
    v_cvt_pk_bf16_f32 v66, v100, v101
    v_cvt_pk_bf16_f32 v67, v102, v103
    v_mfma_f32_16x16x32_bf16 v[104:107], a[168:171], v[148:151], v[104:107]
    v_cndmask_b32 v66, v66, 0, s[82:83]
    v_cndmask_b32 v67, v67, 0, s[82:83]
    s_waitcnt lgkmcnt(8)
    v_mfma_f32_16x16x32_bf16 v[104:107], a[192:195], v[152:155], v[104:107]
    s_add_u32 m0, s52, 98304
    s_add_u32 s58, s72, 2560
    s_add_u32 s57, s58, s68
    v_mfma_f32_16x16x32_bf16 v[104:107], a[216:219], v[156:159], v[104:107]
    buffer_load_dwordx4 v3, s[24:27], s57 offen offset:0 sc1 lds
    s_waitcnt lgkmcnt(4)
    v_mfma_f32_16x16x32_bf16 v[104:107], a[240:243], v[160:163], v[104:107]
    v_mfma_f32_16x16x32_bf16 v[104:107], v[184:187], v[164:167], v[104:107]
    s_waitcnt lgkmcnt(0)
    v_mfma_f32_16x16x32_bf16 v[104:107], v[208:211], v[168:171], v[104:107]
    v_mfma_f32_16x16x32_bf16 v[104:107], v[232:235], v[172:175], v[104:107]
    s_waitcnt vmcnt(9)
    s_barrier
    v_mfma_f32_16x16x32_bf16 v[108:111], a[4:7], v[120:123], 0
    ds_read_b64_tr_b16 v[120:121], v4 offset:49152
    ds_read_b64_tr_b16 v[122:123], v25 offset:49152
    s_add_u32 s57, s58, s69
    v_mfma_f32_16x16x32_bf16 v[108:111], a[28:31], v[124:127], v[108:111]
    buffer_load_dwordx4 v3, s[24:27], s57 offen offset:1024 sc1 lds
    v_mfma_f32_16x16x32_bf16 v[108:111], a[52:55], v[128:131], v[108:111]
    ds_read_b64_tr_b16 v[124:125], v4 offset:50176
    ds_read_b64_tr_b16 v[126:127], v25 offset:50176
    v_mfma_f32_16x16x32_bf16 v[108:111], a[76:79], v[132:135], v[108:111]
    ds_read_b64_tr_b16 v[128:129], v4 offset:51200
    ds_read_b64_tr_b16 v[130:131], v25 offset:51200
    v_mfma_f32_16x16x32_bf16 v[108:111], a[100:103], v[136:139], v[108:111]
    ds_read_b64_tr_b16 v[132:133], v4 offset:52224
    v_mfma_f32_16x16x32_bf16 v[108:111], a[124:127], v[140:143], v[108:111]
    ds_read_b64_tr_b16 v[134:135], v25 offset:52224
    ds_read_b64_tr_b16 v[136:137], v4 offset:53248
    v_mfma_f32_16x16x32_bf16 v[108:111], a[148:151], v[144:147], v[108:111]
    ds_read_b64_tr_b16 v[138:139], v25 offset:53248
    s_add_u32 s57, s58, s70
    v_mfma_f32_16x16x32_bf16 v[108:111], a[172:175], v[148:151], v[108:111]
    buffer_load_dwordx4 v24, s[24:27], s57 offen offset:2048 sc1 lds
    v_mfma_f32_16x16x32_bf16 v[108:111], a[196:199], v[152:155], v[108:111]
    ds_read_b64_tr_b16 v[140:141], v4 offset:54272
    ds_read_b64_tr_b16 v[142:143], v25 offset:54272
    v_mfma_f32_16x16x32_bf16 v[108:111], a[220:223], v[156:159], v[108:111]
    ds_read_b64_tr_b16 v[144:145], v4 offset:55296
    ds_read_b64_tr_b16 v[146:147], v25 offset:55296
    v_mfma_f32_16x16x32_bf16 v[108:111], a[244:247], v[160:163], v[108:111]
    ds_read_b64_tr_b16 v[148:149], v4 offset:56320
    ds_read_b64_tr_b16 v[150:151], v25 offset:56320
    v_mfma_f32_16x16x32_bf16 v[108:111], v[188:191], v[164:167], v[108:111]
    ds_read_b64_tr_b16 v[152:153], v4 offset:57344
    v_cvt_pk_bf16_f32 v68, v104, v105
    v_mfma_f32_16x16x32_bf16 v[108:111], v[212:215], v[168:171], v[108:111]
    ds_read_b64_tr_b16 v[154:155], v25 offset:57344
    ds_read_b64_tr_b16 v[156:157], v4 offset:58368
    s_add_u32 s57, s58, s71
    v_mfma_f32_16x16x32_bf16 v[108:111], v[236:239], v[172:175], v[108:111]
    buffer_load_dwordx4 v3, s[24:27], s57 offen offset:3072 sc1 lds
    s_waitcnt lgkmcnt(15)
    v_mfma_f32_16x16x32_bf16 v[112:115], a[8:11], v[120:123], 0
    ds_read_b64_tr_b16 v[158:159], v25 offset:58368
    ds_read_b64_tr_b16 v[160:161], v4 offset:59392
    v_mfma_f32_16x16x32_bf16 v[112:115], a[32:35], v[124:127], v[112:115]
    ds_read_b64_tr_b16 v[162:163], v25 offset:59392
    ds_read_b64_tr_b16 v[164:165], v4 offset:60416
    s_waitcnt lgkmcnt(15)
    v_mfma_f32_16x16x32_bf16 v[112:115], a[56:59], v[128:131], v[112:115]
    ds_read_b64_tr_b16 v[166:167], v25 offset:60416
    v_cvt_pk_bf16_f32 v69, v106, v107
    v_mfma_f32_16x16x32_bf16 v[112:115], a[80:83], v[132:135], v[112:115]
    ds_read_b64_tr_b16 v[168:169], v4 offset:61440
    s_waitcnt lgkmcnt(13)
    v_mfma_f32_16x16x32_bf16 v[112:115], a[104:107], v[136:139], v[112:115]
    ds_read_b64_tr_b16 v[170:171], v25 offset:61440
    ds_read_b64_tr_b16 v[172:173], v4 offset:62464
    s_and_b32 s54, s46, 7
    s_lshl_b32 s54, s54, 11
    s_getpc_b64 s[98:99]
L_pc21:
    v_lshrrev_b32 v6, 4, v0
    v_lshl_add_u32 v6, v6, 7, s54
    v_min_u32 v6, L_codeend-L_pc21-4, v6
    v_mov_b32 v7, s99
    v_add_co_u32 v6, vcc, s98, v6
    s_nop 1
    v_addc_co_u32 v7, vcc, 0, v7, vcc
    v_mfma_f32_16x16x32_bf16 v[112:115], a[128:131], v[140:143], v[112:115]
    global_load_dword v22, v[6:7], off
    s_waitcnt lgkmcnt(11)
    v_mfma_f32_16x16x32_bf16 v[112:115], a[152:155], v[144:147], v[112:115]
    ds_read_b64_tr_b16 v[174:175], v25 offset:62464
    v_cvt_pk_bf16_f32 v70, v108, v109
    v_mfma_f32_16x16x32_bf16 v[112:115], a[176:179], v[148:151], v[112:115]
    v_cvt_pk_bf16_f32 v71, v110, v111
    v_cndmask_b32 v70, v70, 0, s[82:83]
    s_waitcnt lgkmcnt(8)
    v_mfma_f32_16x16x32_bf16 v[112:115], a[200:203], v[152:155], v[112:115]
    v_cndmask_b32 v71, v71, 0, s[82:83]
    v_mov_b32 v8, 0
    v_mfma_f32_16x16x32_bf16 v[112:115], a[224:227], v[156:159], v[112:115]
    v_mov_b32 v9, 0
    v_mov_b32 v10, 0
    s_waitcnt lgkmcnt(4)
    v_mfma_f32_16x16x32_bf16 v[112:115], a[248:251], v[160:163], v[112:115]
    s_add_u32 m0, s52, 114688
    s_add_u32 s58, s72, 3072
    s_add_u32 s57, s58, s68
    v_mfma_f32_16x16x32_bf16 v[72:75], v[52:55], v[68:71], 0
    v_mfma_f32_16x16x32_bf16 v[112:115], v[192:195], v[164:167], v[112:115]
    buffer_load_dwordx4 v3, s[24:27], s57 offen offset:0 sc1 lds
    s_waitcnt lgkmcnt(0)
    v_mfma_f32_16x16x32_bf16 v[112:115], v[216:219], v[168:171], v[112:115]
    v_mfma_f32_16x16x32_bf16 v[76:79], v[56:59], v[68:71], 0
    v_mfma_f32_16x16x32_bf16 v[112:115], v[240:243], v[172:175], v[112:115]
    ds_read_u16_d16_hi v8, v93 offset:0
    ds_read_u16_d16_hi v9, v94 offset:0
    v_mfma_f32_16x16x32_bf16 v[116:119], a[12:15], v[120:123], 0
    ds_read_u16_d16_hi v10, v92 offset:0
    v_mfma_f32_16x16x32_bf16 v[116:119], a[36:39], v[124:127], v[116:119]
    v_mfma_f32_16x16x32_bf16 v[116:119], a[60:63], v[128:131], v[116:119]
    s_add_u32 s57, s58, s69
    v_mfma_f32_16x16x32_bf16 v[116:119], a[84:87], v[132:135], v[116:119]
    buffer_load_dwordx4 v3, s[24:27], s57 offen offset:1024 sc1 lds
    v_mfma_f32_16x16x32_bf16 v[116:119], a[108:111], v[136:139], v[116:119]
    v_cndmask_b32 v26, v72, v73, s[76:77]
    v_cndmask_b32 v27, v74, v75, s[76:77]
    v_mfma_f32_16x16x32_bf16 v[116:119], a[132:135], v[140:143], v[116:119]
    v_cndmask_b32 v28, v76, v77, s[76:77]
    v_cndmask_b32 v29, v78, v79, s[76:77]
    v_mfma_f32_16x16x32_bf16 v[116:119], a[156:159], v[144:147], v[116:119]
    v_cvt_pk_bf16_f32 v52, v112, v113
    v_cvt_pk_bf16_f32 v53, v114, v115
    v_mfma_f32_16x16x32_bf16 v[116:119], a[180:183], v[148:151], v[116:119]
    v_cndmask_b32 v26, v26, v28, s[78:79]
    v_cndmask_b32 v27, v27, v29, s[80:81]
    v_mfma_f32_16x16x32_bf16 v[116:119], a[204:207], v[152:155], v[116:119]
    s_add_u32 s57, s58, s70
    s_waitcnt lgkmcnt(0)
    v_mfma_f32_16x16x32_bf16 v[116:119], a[228:231], v[156:159], v[116:119]
    buffer_load_dwordx4 v24, s[24:27], s57 offen offset:2048 sc1 lds
    v_mfma_f32_16x16x32_bf16 v[116:119], a[252:255], v[160:163], v[116:119]
    v_mul_f32 v26, v26, v8
    v_mul_f32 v27, v27, v9
    v_mfma_f32_16x16x32_bf16 v[116:119], v[196:199], v[164:167], v[116:119]
    v_mul_f32 v11, s91, v10
    v_cndmask_b32 v26, v26, v18, s[84:85]
    v_mfma_f32_16x16x32_bf16 v[116:119], v[220:223], v[168:171], v[116:119]
    v_cndmask_b32 v27, v27, v18, s[86:87]
    v_max_f32 v28, v26, v27
    v_mfma_f32_16x16x32_bf16 v[116:119], v[244:247], v[172:175], v[116:119]
    v_mov_b32 v29, v28
    v_mfma_f32_16x16x32_bf16 v[96:99], v[120:123], a[16:19], 0
    s_add_u32 s57, s58, s71
    v_mfma_f32_16x16x32_bf16 v[96:99], v[124:127], a[40:43], v[96:99]
    buffer_load_dwordx4 v3, s[24:27], s57 offen offset:3072 sc1 lds
    v_mfma_f32_16x16x32_bf16 v[96:99], v[128:131], a[64:67], v[96:99]
    v_permlane16_swap_b32 v28, v29
    v_max_f32 v28, v28, v29
    v_mfma_f32_16x16x32_bf16 v[96:99], v[132:135], a[88:91], v[96:99]
    v_mov_b32 v29, v28
    v_mfma_f32_16x16x32_bf16 v[96:99], v[136:139], a[112:115], v[96:99]
    v_mfma_f32_16x16x32_bf16 v[96:99], v[140:143], a[136:139], v[96:99]
    v_permlane32_swap_b32 v28, v29
    v_max_f32 v28, v28, v29
    v_mfma_f32_16x16x32_bf16 v[96:99], v[144:147], a[160:163], v[96:99]
    s_add_u32 m0, s52, 131072
    s_add_u32 s58, s72, 3584
    s_add_u32 s57, s58, s68
    v_cvt_pk_bf16_f32 v54, v116, v117
    v_mfma_f32_16x16x32_bf16 v[96:99], v[148:151], a[184:187], v[96:99]
    buffer_load_dwordx4 v3, s[24:27], s57 offen offset:0 sc1 lds
    v_mfma_f32_16x16x32_bf16 v[96:99], v[152:155], a[208:211], v[96:99]
    v_cvt_pk_bf16_f32 v55, v118, v119
    v_cndmask_b32 v54, v54, 0, s[82:83]
    v_mfma_f32_16x16x32_bf16 v[96:99], v[156:159], a[232:235], v[96:99]
    v_cndmask_b32 v55, v55, 0, s[82:83]
    v_sub_f32 v26, v26, v28
    v_mfma_f32_16x16x32_bf16 v[96:99], v[160:163], v[176:179], v[96:99]
    v_sub_f32 v27, v27, v28
    v_mul_f32 v26, v11, v26
    v_mfma_f32_16x16x32_bf16 v[96:99], v[164:167], v[200:203], v[96:99]
    v_mul_f32 v27, v11, v27
    v_exp_f32 v26, v26
    v_mfma_f32_16x16x32_bf16 v[96:99], v[168:171], v[224:227], v[96:99]
    s_add_u32 s57, s58, s69
    v_exp_f32 v27, v27
    v_mfma_f32_16x16x32_bf16 v[96:99], v[172:175], v[248:251], v[96:99]
    buffer_load_dwordx4 v3, s[24:27], s57 offen offset:1024 sc1 lds
    v_mfma_f32_16x16x32_bf16 v[100:103], v[120:123], a[20:23], 0
    v_add_f32 v28, v26, v27
    v_mov_b32 v29, v28
    v_mfma_f32_16x16x32_bf16 v[100:103], v[124:127], a[44:47], v[100:103]
    v_mfma_f32_16x16x32_bf16 v[100:103], v[128:131], a[68:71], v[100:103]
    v_permlane16_swap_b32 v28, v29
    v_add_f32 v28, v28, v29
    v_mfma_f32_16x16x32_bf16 v[100:103], v[132:135], a[92:95], v[100:103]
    v_mov_b32 v29, v28
    v_mfma_f32_16x16x32_bf16 v[100:103], v[136:139], a[116:119], v[100:103]
    s_add_u32 s57, s58, s70
    v_mfma_f32_16x16x32_bf16 v[100:103], v[140:143], a[140:143], v[100:103]
    buffer_load_dwordx4 v24, s[24:27], s57 offen offset:2048 sc1 lds
    v_mfma_f32_16x16x32_bf16 v[100:103], v[144:147], a[164:167], v[100:103]
    v_cvt_pk_bf16_f32 v38, v96, v97
    v_cvt_pk_bf16_f32 v39, v98, v99
    v_mfma_f32_16x16x32_bf16 v[100:103], v[148:151], a[188:191], v[100:103]
    v_permlane32_swap_b32 v28, v29
    v_add_f32 v28, v28, v29
    v_mfma_f32_16x16x32_bf16 v[100:103], v[152:155], a[212:215], v[100:103]
    v_rcp_f32 v28, v28
    v_mfma_f32_16x16x32_bf16 v[100:103], v[156:159], a[236:239], v[100:103]
    v_mul_f32 v26, v26, v8
    v_mul_f32 v27, v27, v9
    v_mfma_f32_16x16x32_bf16 v[100:103], v[160:163], v[180:183], v[100:103]
    s_add_u32 s57, s58, s71
    v_mul_f32 v26, v26, v28
    v_mfma_f32_16x16x32_bf16 v[100:103], v[164:167], v[204:207], v[100:103]
    buffer_load_dwordx4 v3, s[24:27], s57 offen offset:3072 sc1 lds
    v_mfma_f32_16x16x32_bf16 v[100:103], v[168:171], v[228:231], v[100:103]
    v_mul_f32 v27, v27, v28
    v_cvt_pk_bf16_f32 v26, v26, v26
    v_mfma_f32_16x16x32_bf16 v[100:103], v[172:175], v[252:255], v[100:103]
    v_cvt_pk_bf16_f32 v27, v27, v27
    v_and_b32 v80, v26, v14
    v_mfma_f32_16x16x32_bf16 v[104:107], a[0:3], v[120:123], 0
    v_and_b32 v81, v27, v15
    v_and_b32 v82, v26, v16
    v_mfma_f32_16x16x32_bf16 v[104:107], a[24:27], v[124:127], v[104:107]
    v_and_b32 v83, v27, v17
    v_mfma_f32_16x16x32_bf16 v[104:107], a[48:51], v[128:131], v[104:107]
    s_add_u32 s57, s73, 0
    v_mfma_f32_16x16x32_bf16 v[104:107], a[72:75], v[132:135], v[104:107]
    buffer_load_dword v22, v5, s[20:23], s57 offen
    v_mfma_f32_16x16x32_bf16 v[104:107], a[96:99], v[136:139], v[104:107]
    v_mfma_f32_16x16x32_bf16 v[72:75], v[32:35], v[80:83], 0
    v_mfma_f32_16x16x32_bf16 v[104:107], a[120:123], v[140:143], v[104:107]
    v_mfma_f32_16x16x32_bf16 v[76:79], v[42:45], v[80:83], 0
    v_mfma_f32_16x16x32_bf16 v[104:107], a[144:147], v[144:147], v[104:107]
    v_cvt_pk_bf16_f32 v48, v100, v101
    v_cvt_pk_bf16_f32 v49, v102, v103
    v_mfma_f32_16x16x32_bf16 v[104:107], a[168:171], v[148:151], v[104:107]
    s_add_u32 s53, s74, 0
    v_mfma_f32_16x16x32_bf16 v[104:107], a[192:195], v[152:155], v[104:107]
    v_mfma_f32_16x16x32_bf16 v[104:107], a[216:219], v[156:159], v[104:107]
    v_mfma_f32_16x16x32_bf16 v[104:107], a[240:243], v[160:163], v[104:107]
    v_mfma_f32_16x16x32_bf16 v[104:107], v[184:187], v[164:167], v[104:107]
    v_mfma_f32_16x16x32_bf16 v[104:107], v[208:211], v[168:171], v[104:107]
    v_cvt_pk_bf16_f32 v84, v72, v73
    v_cvt_pk_bf16_f32 v85, v74, v75
    v_mfma_f32_16x16x32_bf16 v[104:107], v[232:235], v[172:175], v[104:107]
    v_cvt_pk_bf16_f32 v86, v76, v77
    v_cvt_pk_bf16_f32 v87, v78, v79
    s_waitcnt vmcnt(5)
    s_barrier
    v_mfma_f32_16x16x32_bf16 v[108:111], a[4:7], v[120:123], 0
    v_add_u32 v4, 65536, v4
    v_add_u32 v25, 65536, v25
    ds_read_b64_tr_b16 v[120:121], v4 offset:0
    ds_read_b64_tr_b16 v[122:123], v25 offset:0
    v_mfma_f32_16x16x32_bf16 v[108:111], a[28:31], v[124:127], v[108:111]
    ds_read_b64_tr_b16 v[124:125], v4 offset:1024
    buffer_store_dwordx4 v[84:87], v23, s[24:27], s53 offen sc1
    v_mfma_f32_16x16x32_bf16 v[108:111], a[52:55], v[128:131], v[108:111]
    ds_read_b64_tr_b16 v[126:127], v25 offset:1024
    ds_read_b64_tr_b16 v[128:129], v4 offset:2048
    v_mfma_f32_16x16x32_bf16 v[108:111], a[76:79], v[132:135], v[108:111]
    ds_read_b64_tr_b16 v[130:131], v25 offset:2048
    v_cndmask_b32 v80, v84, v86, s[88:89]
    v_mfma_f32_16x16x32_bf16 v[108:111], a[100:103], v[136:139], v[108:111]
    ds_read_b64_tr_b16 v[132:133], v4 offset:3072
    v_cndmask_b32 v81, v85, v87, s[88:89]
    v_mfma_f32_16x16x32_bf16 v[108:111], a[124:127], v[140:143], v[108:111]
    ds_read_b64_tr_b16 v[134:135], v25 offset:3072
    ds_read_b64_tr_b16 v[136:137], v4 offset:4096
    v_mfma_f32_16x16x32_bf16 v[108:111], a[148:151], v[144:147], v[108:111]
    ds_read_b64_tr_b16 v[138:139], v25 offset:4096
    v_cvt_pk_bf16_f32 v68, v104, v105
    v_mfma_f32_16x16x32_bf16 v[108:111], a[172:175], v[148:151], v[108:111]
    ds_read_b64_tr_b16 v[140:141], v4 offset:5120
    ds_read_b64_tr_b16 v[142:143], v25 offset:5120
    v_mfma_f32_16x16x32_bf16 v[108:111], a[196:199], v[152:155], v[108:111]
    ds_read_b64_tr_b16 v[144:145], v4 offset:6144
    v_cvt_pk_bf16_f32 v69, v106, v107
    v_mfma_f32_16x16x32_bf16 v[108:111], a[220:223], v[156:159], v[108:111]
    ds_read_b64_tr_b16 v[146:147], v25 offset:6144
    ds_write_b64 v95, v[80:81] offset:0
    v_mfma_f32_16x16x32_bf16 v[108:111], a[244:247], v[160:163], v[108:111]
    ds_read_b64_tr_b16 v[148:149], v4 offset:7168
    ds_read_b64_tr_b16 v[150:151], v25 offset:7168
    v_mfma_f32_16x16x32_bf16 v[108:111], v[188:191], v[164:167], v[108:111]
    ds_read_b64_tr_b16 v[152:153], v4 offset:8192
    v_mfma_f32_16x16x32_bf16 v[108:111], v[212:215], v[168:171], v[108:111]
    ds_read_b64_tr_b16 v[154:155], v25 offset:8192
    ds_read_b64_tr_b16 v[156:157], v4 offset:9216
    v_mfma_f32_16x16x32_bf16 v[108:111], v[236:239], v[172:175], v[108:111]
    ds_read_b64_tr_b16 v[158:159], v25 offset:9216
    v_mfma_f32_16x16x32_bf16 v[72:75], v[56:59], v[64:67], 0
    s_waitcnt lgkmcnt(15)
    v_mfma_f32_16x16x32_bf16 v[112:115], a[8:11], v[120:123], 0
    ds_read_b64_tr_b16 v[160:161], v4 offset:10240
    v_mfma_f32_16x16x32_bf16 v[76:79], v[60:63], v[64:67], 0
    v_mfma_f32_16x16x32_bf16 v[112:115], a[32:35], v[124:127], v[112:115]
    ds_read_b64_tr_b16 v[162:163], v25 offset:10240
    ds_read_b64_tr_b16 v[164:165], v4 offset:11264
    s_waitcnt lgkmcnt(15)
    v_mfma_f32_16x16x32_bf16 v[112:115], a[56:59], v[128:131], v[112:115]
    ds_read_b64_tr_b16 v[166:167], v25 offset:11264
    ds_read_u16_d16_hi v8, v93 offset:16384
    v_mfma_f32_16x16x32_bf16 v[112:115], a[80:83], v[132:135], v[112:115]
    ds_read_b64_tr_b16 v[168:169], v4 offset:12288
    ds_read_u16_d16_hi v9, v94 offset:16384
    s_waitcnt lgkmcnt(15)
    v_mfma_f32_16x16x32_bf16 v[112:115], a[104:107], v[136:139], v[112:115]
    ds_read_b64_tr_b16 v[170:171], v25 offset:12288
    ds_read_b64_tr_b16 v[172:173], v4 offset:13312
    v_mfma_f32_16x16x32_bf16 v[112:115], a[128:131], v[140:143], v[112:115]
    ds_read_b64_tr_b16 v[174:175], v25 offset:13312
    ds_read_u16_d16_hi v10, v92 offset:16384
    s_waitcnt lgkmcnt(15)
    v_mfma_f32_16x16x32_bf16 v[112:115], a[152:155], v[144:147], v[112:115]
    v_cvt_pk_bf16_f32 v70, v108, v109
    v_cvt_pk_bf16_f32 v71, v110, v111
    v_mfma_f32_16x16x32_bf16 v[112:115], a[176:179], v[148:151], v[112:115]
    v_cndmask_b32 v70, v70, 0, s[82:83]
    v_cndmask_b32 v71, v71, 0, s[82:83]
    s_waitcnt lgkmcnt(11)
    v_mfma_f32_16x16x32_bf16 v[112:115], a[200:203], v[152:155], v[112:115]
    v_mfma_f32_16x16x32_bf16 v[112:115], a[224:227], v[156:159], v[112:115]
    v_cndmask_b32 v26, v72, v73, s[76:77]
    v_cndmask_b32 v27, v74, v75, s[76:77]
    s_waitcnt lgkmcnt(7)
    v_mfma_f32_16x16x32_bf16 v[112:115], a[248:251], v[160:163], v[112:115]
    v_cndmask_b32 v28, v76, v77, s[76:77]
    v_cndmask_b32 v29, v78, v79, s[76:77]
    v_mfma_f32_16x16x32_bf16 v[112:115], v[192:195], v[164:167], v[112:115]
    v_cndmask_b32 v26, v26, v28, s[78:79]
    v_cndmask_b32 v27, v27, v29, s[80:81]
    s_waitcnt lgkmcnt(1)
    v_mfma_f32_16x16x32_bf16 v[112:115], v[216:219], v[168:171], v[112:115]
    s_waitcnt lgkmcnt(0)
    v_mul_f32 v26, v26, v8
    v_mfma_f32_16x16x32_bf16 v[112:115], v[240:243], v[172:175], v[112:115]
    v_mul_f32 v27, v27, v9
    v_mul_f32 v11, s91, v10
    v_mfma_f32_16x16x32_bf16 v[116:119], a[12:15], v[120:123], 0
    s_add_u32 s57, s73, 524288
    v_max_f32 v28, v26, v27
    v_mfma_f32_16x16x32_bf16 v[116:119], a[36:39], v[124:127], v[116:119]
    buffer_load_dword v22, v5, s[20:23], s57 offen
    v_mfma_f32_16x16x32_bf16 v[116:119], a[60:63], v[128:131], v[116:119]
    v_mov_b32 v29, v28
    v_mfma_f32_16x16x32_bf16 v[116:119], a[84:87], v[132:135], v[116:119]
    v_mfma_f32_16x16x32_bf16 v[116:119], a[108:111], v[136:139], v[116:119]
    v_permlane16_swap_b32 v28, v29
    v_max_f32 v28, v28, v29
    v_mfma_f32_16x16x32_bf16 v[116:119], a[132:135], v[140:143], v[116:119]
    v_mov_b32 v29, v28
    v_mfma_f32_16x16x32_bf16 v[116:119], a[156:159], v[144:147], v[116:119]
    v_cvt_pk_bf16_f32 v56, v112, v113
    v_cvt_pk_bf16_f32 v57, v114, v115
    v_mfma_f32_16x16x32_bf16 v[116:119], a[180:183], v[148:151], v[116:119]
    v_permlane32_swap_b32 v28, v29
    v_max_f32 v28, v28, v29
    v_mfma_f32_16x16x32_bf16 v[116:119], a[204:207], v[152:155], v[116:119]
    v_sub_f32 v26, v26, v28
    v_sub_f32 v27, v27, v28
    v_mfma_f32_16x16x32_bf16 v[116:119], a[228:231], v[156:159], v[116:119]
    v_mul_f32 v26, v11, v26
    v_mul_f32 v27, v11, v27
    v_mfma_f32_16x16x32_bf16 v[116:119], a[252:255], v[160:163], v[116:119]
    v_exp_f32 v26, v26
    v_mfma_f32_16x16x32_bf16 v[116:119], v[196:199], v[164:167], v[116:119]
    v_exp_f32 v27, v27
    v_mfma_f32_16x16x32_bf16 v[116:119], v[220:223], v[168:171], v[116:119]
    v_add_f32 v28, v26, v27
    v_mov_b32 v29, v28
    v_mfma_f32_16x16x32_bf16 v[116:119], v[244:247], v[172:175], v[116:119]
    v_mfma_f32_16x16x32_bf16 v[96:99], v[120:123], a[16:19], 0
    v_permlane16_swap_b32 v28, v29
    v_add_f32 v28, v28, v29
    v_mfma_f32_16x16x32_bf16 v[96:99], v[124:127], a[40:43], v[96:99]
    v_mov_b32 v29, v28
    v_mfma_f32_16x16x32_bf16 v[96:99], v[128:131], a[64:67], v[96:99]
    v_mfma_f32_16x16x32_bf16 v[96:99], v[132:135], a[88:91], v[96:99]
    v_permlane32_swap_b32 v28, v29
    v_add_f32 v28, v28, v29
    v_mfma_f32_16x16x32_bf16 v[96:99], v[136:139], a[112:115], v[96:99]
    v_rcp_f32 v28, v28
    v_mfma_f32_16x16x32_bf16 v[96:99], v[140:143], a[136:139], v[96:99]
    v_mul_f32 v26, v26, v8
    v_mul_f32 v27, v27, v9
    v_mfma_f32_16x16x32_bf16 v[96:99], v[144:147], a[160:163], v[96:99]
    v_cvt_pk_bf16_f32 v58, v116, v117
    v_cvt_pk_bf16_f32 v59, v118, v119
    v_mfma_f32_16x16x32_bf16 v[96:99], v[148:151], a[184:187], v[96:99]
    v_cndmask_b32 v58, v58, 0, s[82:83]
    v_cndmask_b32 v59, v59, 0, s[82:83]
    v_mfma_f32_16x16x32_bf16 v[96:99], v[152:155], a[208:211], v[96:99]
    v_mul_f32 v26, v26, v28
    v_mul_f32 v27, v27, v28
    v_mfma_f32_16x16x32_bf16 v[96:99], v[156:159], a[232:235], v[96:99]
    v_cvt_pk_bf16_f32 v26, v26, v26
    v_cvt_pk_bf16_f32 v27, v27, v27
    v_mfma_f32_16x16x32_bf16 v[96:99], v[160:163], v[176:179], v[96:99]
    v_and_b32 v80, v26, v14
    v_and_b32 v81, v27, v15
    v_mfma_f32_16x16x32_bf16 v[96:99], v[164:167], v[200:203], v[96:99]
    v_and_b32 v82, v26, v16
    v_and_b32 v83, v27, v17
    v_mfma_f32_16x16x32_bf16 v[96:99], v[168:171], v[224:227], v[96:99]
    v_mfma_f32_16x16x32_bf16 v[96:99], v[172:175], v[248:251], v[96:99]
    v_mfma_f32_16x16x32_bf16 v[72:75], v[34:37], v[80:83], 0
    v_mfma_f32_16x16x32_bf16 v[100:103], v[120:123], a[20:23], 0
    v_mfma_f32_16x16x32_bf16 v[76:79], v[44:47], v[80:83], 0
    v_mfma_f32_16x16x32_bf16 v[100:103], v[124:127], a[44:47], v[100:103]
    s_add_u32 s53, s74, 16384
    v_mfma_f32_16x16x32_bf16 v[100:103], v[128:131], a[68:71], v[100:103]
    v_mfma_f32_16x16x32_bf16 v[100:103], v[132:135], a[92:95], v[100:103]
    v_mfma_f32_16x16x32_bf16 v[100:103], v[136:139], a[116:119], v[100:103]
    v_mfma_f32_16x16x32_bf16 v[100:103], v[140:143], a[140:143], v[100:103]
    v_mfma_f32_16x16x32_bf16 v[100:103], v[144:147], a[164:167], v[100:103]
    v_cvt_pk_bf16_f32 v40, v96, v97
    v_cvt_pk_bf16_f32 v41, v98, v99
    v_mfma_f32_16x16x32_bf16 v[100:103], v[148:151], a[188:191], v[100:103]
    v_cvt_pk_bf16_f32 v32, v96, v97
    v_cvt_pk_bf16_f32 v33, v98, v99
    v_mfma_f32_16x16x32_bf16 v[100:103], v[152:155], a[212:215], v[100:103]
    v_cvt_pk_bf16_f32 v84, v72, v73
    v_cvt_pk_bf16_f32 v85, v74, v75
    v_mfma_f32_16x16x32_bf16 v[100:103], v[156:159], a[236:239], v[100:103]
    v_cvt_pk_bf16_f32 v86, v76, v77
    v_cvt_pk_bf16_f32 v87, v78, v79
    v_mfma_f32_16x16x32_bf16 v[100:103], v[160:163], v[180:183], v[100:103]
    buffer_store_dwordx4 v[84:87], v23, s[24:27], s53 offen sc1
    v_mfma_f32_16x16x32_bf16 v[100:103], v[164:167], v[204:207], v[100:103]
    v_cndmask_b32 v80, v84, v86, s[88:89]
    v_cndmask_b32 v81, v85, v87, s[88:89]
    v_mfma_f32_16x16x32_bf16 v[100:103], v[168:171], v[228:231], v[100:103]
    s_add_u32 s57, s75, 0
    ds_write_b64 v95, v[80:81] offset:256
    v_mfma_f32_16x16x32_bf16 v[100:103], v[172:175], v[252:255], v[100:103]
    buffer_load_dword v22, v20, s[12:15], s57 offen
    v_mfma_f32_16x16x32_bf16 v[104:107], a[0:3], v[120:123], 0
    v_mfma_f32_16x16x32_bf16 v[104:107], a[24:27], v[124:127], v[104:107]
    v_mfma_f32_16x16x32_bf16 v[72:75], v[60:63], v[68:71], 0
    v_mfma_f32_16x16x32_bf16 v[104:107], a[48:51], v[128:131], v[104:107]
    v_mfma_f32_16x16x32_bf16 v[76:79], v[52:55], v[68:71], 0
    v_mfma_f32_16x16x32_bf16 v[104:107], a[72:75], v[132:135], v[104:107]
    ds_read_u16_d16_hi v8, v93 offset:32768
    ds_read_u16_d16_hi v9, v94 offset:32768
    v_mfma_f32_16x16x32_bf16 v[104:107], a[96:99], v[136:139], v[104:107]
    ds_read_u16_d16_hi v10, v92 offset:32768
    v_mfma_f32_16x16x32_bf16 v[104:107], a[120:123], v[140:143], v[104:107]
    v_mfma_f32_16x16x32_bf16 v[104:107], a[144:147], v[144:147], v[104:107]
    v_cvt_pk_bf16_f32 v50, v100, v101
    v_cvt_pk_bf16_f32 v51, v102, v103
    v_mfma_f32_16x16x32_bf16 v[104:107], a[168:171], v[148:151], v[104:107]
    v_cvt_pk_bf16_f32 v42, v100, v101
    v_cvt_pk_bf16_f32 v43, v102, v103
    v_mfma_f32_16x16x32_bf16 v[104:107], a[192:195], v[152:155], v[104:107]
    v_cndmask_b32 v26, v72, v73, s[76:77]
    v_cndmask_b32 v27, v74, v75, s[76:77]
    v_mfma_f32_16x16x32_bf16 v[104:107], a[216:219], v[156:159], v[104:107]
    v_cndmask_b32 v28, v76, v77, s[76:77]
    v_cndmask_b32 v29, v78, v79, s[76:77]
    v_mfma_f32_16x16x32_bf16 v[104:107], a[240:243], v[160:163], v[104:107]
    v_cndmask_b32 v26, v26, v28, s[78:79]
    v_cndmask_b32 v27, v27, v29, s[80:81]
    v_mfma_f32_16x16x32_bf16 v[104:107], v[184:187], v[164:167], v[104:107]
    s_waitcnt lgkmcnt(0)
    v_mul_f32 v26, v26, v8
    v_mfma_f32_16x16x32_bf16 v[104:107], v[208:211], v[168:171], v[104:107]
    v_mul_f32 v27, v27, v9
    v_mul_f32 v11, s91, v10
    v_mfma_f32_16x16x32_bf16 v[104:107], v[232:235], v[172:175], v[104:107]
    v_max_f32 v28, v26, v27
    v_mov_b32 v29, v28
    v_mfma_f32_16x16x32_bf16 v[108:111], a[4:7], v[120:123], 0
    ds_read_b64_tr_b16 v[120:121], v4 offset:16384
    ds_read_b64_tr_b16 v[122:123], v25 offset:16384
    v_mfma_f32_16x16x32_bf16 v[108:111], a[28:31], v[124:127], v[108:111]
    ds_read_b64_tr_b16 v[124:125], v4 offset:17408
    v_permlane16_swap_b32 v28, v29
    v_mfma_f32_16x16x32_bf16 v[108:111], a[52:55], v[128:131], v[108:111]
    ds_read_b64_tr_b16 v[126:127], v25 offset:17408
    ds_read_b64_tr_b16 v[128:129], v4 offset:18432
    v_mfma_f32_16x16x32_bf16 v[108:111], a[76:79], v[132:135], v[108:111]
    ds_read_b64_tr_b16 v[130:131], v25 offset:18432
    v_max_f32 v28, v28, v29
    v_mfma_f32_16x16x32_bf16 v[108:111], a[100:103], v[136:139], v[108:111]
    ds_read_b64_tr_b16 v[132:133], v4 offset:19456
    v_mov_b32 v29, v28
    v_mfma_f32_16x16x32_bf16 v[108:111], a[124:127], v[140:143], v[108:111]
    ds_read_b64_tr_b16 v[134:135], v25 offset:19456
    ds_read_b64_tr_b16 v[136:137], v4 offset:20480
    v_mfma_f32_16x16x32_bf16 v[108:111], a[148:151], v[144:147], v[108:111]
    ds_read_b64_tr_b16 v[138:139], v25 offset:20480
    v_cvt_pk_bf16_f32 v64, v104, v105
    v_mfma_f32_16x16x32_bf16 v[108:111], a[172:175], v[148:151], v[108:111]
    ds_read_b64_tr_b16 v[140:141], v4 offset:21504
    ds_read_b64_tr_b16 v[142:143], v25 offset:21504
    v_mfma_f32_16x16x32_bf16 v[108:111], a[196:199], v[152:155], v[108:111]
    ds_read_b64_tr_b16 v[144:145], v4 offset:22528
    v_cvt_pk_bf16_f32 v65, v106, v107
    v_mfma_f32_16x16x32_bf16 v[108:111], a[220:223], v[156:159], v[108:111]
    ds_read_b64_tr_b16 v[146:147], v25 offset:22528
    v_permlane32_swap_b32 v28, v29
    v_mfma_f32_16x16x32_bf16 v[108:111], a[244:247], v[160:163], v[108:111]
    ds_read_b64_tr_b16 v[148:149], v4 offset:23552
    ds_read_b64_tr_b16 v[150:151], v25 offset:23552
    v_mfma_f32_16x16x32_bf16 v[108:111], v[188:191], v[164:167], v[108:111]
    ds_read_b64_tr_b16 v[152:153], v4 offset:24576
    v_max_f32 v28, v28, v29
    v_mfma_f32_16x16x32_bf16 v[108:111], v[212:215], v[168:171], v[108:111]
    ds_read_b64_tr_b16 v[154:155], v25 offset:24576
    ds_read_b64_tr_b16 v[156:157], v4 offset:25600
    v_mfma_f32_16x16x32_bf16 v[108:111], v[236:239], v[172:175], v[108:111]
    ds_read_b64_tr_b16 v[158:159], v25 offset:25600
    v_sub_f32 v26, v26, v28
    s_waitcnt lgkmcnt(15)
    v_mfma_f32_16x16x32_bf16 v[112:115], a[8:11], v[120:123], 0
    ds_read_b64_tr_b16 v[160:161], v4 offset:26624
    v_sub_f32 v27, v27, v28
    v_mfma_f32_16x16x32_bf16 v[112:115], a[32:35], v[124:127], v[112:115]
    ds_read_b64_tr_b16 v[162:163], v25 offset:26624
    ds_read_b64_tr_b16 v[164:165], v4 offset:27648
    s_waitcnt lgkmcnt(15)
    v_mfma_f32_16x16x32_bf16 v[112:115], a[56:59], v[128:131], v[112:115]
    ds_read_b64_tr_b16 v[166:167], v25 offset:27648
    v_mul_f32 v26, v11, v26
    v_mfma_f32_16x16x32_bf16 v[112:115], a[80:83], v[132:135], v[112:115]
    ds_read_b64_tr_b16 v[168:169], v4 offset:28672
    v_mul_f32 v27, v11, v27
    s_waitcnt lgkmcnt(13)
    v_mfma_f32_16x16x32_bf16 v[112:115], a[104:107], v[136:139], v[112:115]
    ds_read_b64_tr_b16 v[170:171], v25 offset:28672
    ds_read_b64_tr_b16 v[172:173], v4 offset:29696
    v_mfma_f32_16x16x32_bf16 v[112:115], a[128:131], v[140:143], v[112:115]
    ds_read_b64_tr_b16 v[174:175], v25 offset:29696
    v_exp_f32 v26, v26
    s_waitcnt lgkmcnt(12)
    v_mfma_f32_16x16x32_bf16 v[112:115], a[152:155], v[144:147], v[112:115]
    v_cvt_pk_bf16_f32 v66, v108, v109
    v_cvt_pk_bf16_f32 v67, v110, v111
    v_mfma_f32_16x16x32_bf16 v[112:115], a[176:179], v[148:151], v[112:115]
    v_cndmask_b32 v66, v66, 0, s[82:83]
    v_cndmask_b32 v67, v67, 0, s[82:83]
    s_waitcnt lgkmcnt(8)
    v_mfma_f32_16x16x32_bf16 v[112:115], a[200:203], v[152:155], v[112:115]
    v_exp_f32 v27, v27
    v_mfma_f32_16x16x32_bf16 v[112:115], a[224:227], v[156:159], v[112:115]
    v_add_f32 v28, v26, v27
    v_mov_b32 v29, v28
    s_waitcnt lgkmcnt(4)
    v_mfma_f32_16x16x32_bf16 v[112:115], a[248:251], v[160:163], v[112:115]
    s_add_u32 s57, s75, 262144
    v_mfma_f32_16x16x32_bf16 v[112:115], v[192:195], v[164:167], v[112:115]
    buffer_load_dword v22, v20, s[12:15], s57 offen
    s_waitcnt lgkmcnt(0)
    v_mfma_f32_16x16x32_bf16 v[112:115], v[216:219], v[168:171], v[112:115]
    v_permlane16_swap_b32 v28, v29
    v_add_f32 v28, v28, v29
    v_mfma_f32_16x16x32_bf16 v[112:115], v[240:243], v[172:175], v[112:115]
    v_mov_b32 v29, v28
    v_mfma_f32_16x16x32_bf16 v[116:119], a[12:15], v[120:123], 0
    v_mfma_f32_16x16x32_bf16 v[116:119], a[36:39], v[124:127], v[116:119]
    v_permlane32_swap_b32 v28, v29
    v_add_f32 v28, v28, v29
    v_mfma_f32_16x16x32_bf16 v[116:119], a[60:63], v[128:131], v[116:119]
    v_rcp_f32 v28, v28
    v_mfma_f32_16x16x32_bf16 v[116:119], a[84:87], v[132:135], v[116:119]
    v_mul_f32 v26, v26, v8
    v_mul_f32 v27, v27, v9
    v_mfma_f32_16x16x32_bf16 v[116:119], a[108:111], v[136:139], v[116:119]
    v_mul_f32 v26, v26, v28
    v_mul_f32 v27, v27, v28
    v_mfma_f32_16x16x32_bf16 v[116:119], a[132:135], v[140:143], v[116:119]
    v_cvt_pk_bf16_f32 v26, v26, v26
    v_cvt_pk_bf16_f32 v27, v27, v27
    v_mfma_f32_16x16x32_bf16 v[116:119], a[156:159], v[144:147], v[116:119]
    v_cvt_pk_bf16_f32 v60, v112, v113
    v_cvt_pk_bf16_f32 v61, v114, v115
    v_mfma_f32_16x16x32_bf16 v[116:119], a[180:183], v[148:151], v[116:119]
    v_and_b32 v80, v26, v14
    v_and_b32 v81, v27, v15
    v_mfma_f32_16x16x32_bf16 v[116:119], a[204:207], v[152:155], v[116:119]
    v_and_b32 v82, v26, v16
    v_and_b32 v83, v27, v17
    v_mfma_f32_16x16x32_bf16 v[116:119], a[228:231], v[156:159], v[116:119]
    v_mfma_f32_16x16x32_bf16 v[116:119], a[252:255], v[160:163], v[116:119]
    v_mfma_f32_16x16x32_bf16 v[72:75], v[36:39], v[80:83], 0
    v_mfma_f32_16x16x32_bf16 v[116:119], v[196:199], v[164:167], v[116:119]
    v_mfma_f32_16x16x32_bf16 v[76:79], v[46:49], v[80:83], 0
    v_mfma_f32_16x16x32_bf16 v[116:119], v[220:223], v[168:171], v[116:119]
    s_add_u32 s53, s74, 32768
    v_mfma_f32_16x16x32_bf16 v[116:119], v[244:247], v[172:175], v[116:119]
    v_mfma_f32_16x16x32_bf16 v[96:99], v[120:123], a[16:19], 0
    v_mfma_f32_16x16x32_bf16 v[96:99], v[124:127], a[40:43], v[96:99]
    v_mfma_f32_16x16x32_bf16 v[96:99], v[128:131], a[64:67], v[96:99]
    v_mfma_f32_16x16x32_bf16 v[96:99], v[132:135], a[88:91], v[96:99]
    v_cvt_pk_bf16_f32 v84, v72, v73
    v_cvt_pk_bf16_f32 v85, v74, v75
    v_mfma_f32_16x16x32_bf16 v[96:99], v[136:139], a[112:115], v[96:99]
    v_cvt_pk_bf16_f32 v86, v76, v77
    v_cvt_pk_bf16_f32 v87, v78, v79
    v_mfma_f32_16x16x32_bf16 v[96:99], v[140:143], a[136:139], v[96:99]
    buffer_store_dwordx4 v[84:87], v23, s[24:27], s53 offen sc1
    v_mfma_f32_16x16x32_bf16 v[96:99], v[144:147], a[160:163], v[96:99]
    v_cvt_pk_bf16_f32 v62, v116, v117
    v_cvt_pk_bf16_f32 v63, v118, v119
    v_mfma_f32_16x16x32_bf16 v[96:99], v[148:151], a[184:187], v[96:99]
    v_cndmask_b32 v62, v62, 0, s[82:83]
    v_cndmask_b32 v63, v63, 0, s[82:83]
    v_mfma_f32_16x16x32_bf16 v[96:99], v[152:155], a[208:211], v[96:99]
    v_cndmask_b32 v80, v84, v86, s[88:89]
    v_cndmask_b32 v81, v85, v87, s[88:89]
    v_mfma_f32_16x16x32_bf16 v[96:99], v[156:159], a[232:235], v[96:99]
    ds_write_b64 v95, v[80:81] offset:512
    v_mfma_f32_16x16x32_bf16 v[96:99], v[160:163], v[176:179], v[96:99]
    v_mfma_f32_16x16x32_bf16 v[72:75], v[52:55], v[64:67], 0
    v_mfma_f32_16x16x32_bf16 v[96:99], v[164:167], v[200:203], v[96:99]
    v_mfma_f32_16x16x32_bf16 v[76:79], v[56:59], v[64:67], 0
    v_mfma_f32_16x16x32_bf16 v[96:99], v[168:171], v[224:227], v[96:99]
    ds_read_u16_d16_hi v8, v93 offset:49152
    ds_read_u16_d16_hi v9, v94 offset:49152
    v_mfma_f32_16x16x32_bf16 v[96:99], v[172:175], v[248:251], v[96:99]
    ds_read_u16_d16_hi v10, v92 offset:49152
    v_mfma_f32_16x16x32_bf16 v[100:103], v[120:123], a[20:23], 0
    v_mfma_f32_16x16x32_bf16 v[100:103], v[124:127], a[44:47], v[100:103]
    v_mfma_f32_16x16x32_bf16 v[100:103], v[128:131], a[68:71], v[100:103]
    v_mfma_f32_16x16x32_bf16 v[100:103], v[132:135], a[92:95], v[100:103]
    v_cndmask_b32 v26, v72, v73, s[76:77]
    v_cndmask_b32 v27, v74, v75, s[76:77]
    v_mfma_f32_16x16x32_bf16 v[100:103], v[136:139], a[116:119], v[100:103]
    v_cndmask_b32 v28, v76, v77, s[76:77]
    v_cndmask_b32 v29, v78, v79, s[76:77]
    v_mfma_f32_16x16x32_bf16 v[100:103], v[140:143], a[140:143], v[100:103]
    v_cndmask_b32 v26, v26, v28, s[78:79]
    v_cndmask_b32 v27, v27, v29, s[80:81]
    v_mfma_f32_16x16x32_bf16 v[100:103], v[144:147], a[164:167], v[100:103]
    v_cvt_pk_bf16_f32 v34, v96, v97
    v_cvt_pk_bf16_f32 v35, v98, v99
    v_mfma_f32_16x16x32_bf16 v[100:103], v[148:151], a[188:191], v[100:103]
    s_waitcnt lgkmcnt(0)
    v_mul_f32 v26, v26, v8
    v_mfma_f32_16x16x32_bf16 v[100:103], v[152:155], a[212:215], v[100:103]
    v_mul_f32 v27, v27, v9
    v_mul_f32 v11, s91, v10
    v_mfma_f32_16x16x32_bf16 v[100:103], v[156:159], a[236:239], v[100:103]
    v_max_f32 v28, v26, v27
    v_mov_b32 v29, v28
    v_mfma_f32_16x16x32_bf16 v[100:103], v[160:163], v[180:183], v[100:103]
    v_mfma_f32_16x16x32_bf16 v[100:103], v[164:167], v[204:207], v[100:103]
    v_permlane16_swap_b32 v28, v29
    v_max_f32 v28, v28, v29
    v_mfma_f32_16x16x32_bf16 v[100:103], v[168:171], v[228:231], v[100:103]
    v_mov_b32 v29, v28
    v_mfma_f32_16x16x32_bf16 v[100:103], v[172:175], v[252:255], v[100:103]
    v_mfma_f32_16x16x32_bf16 v[104:107], a[0:3], v[120:123], 0
    v_permlane32_swap_b32 v28, v29
    v_max_f32 v28, v28, v29
    v_mfma_f32_16x16x32_bf16 v[104:107], a[24:27], v[124:127], v[104:107]
    v_sub_f32 v26, v26, v28
    v_sub_f32 v27, v27, v28
    v_mfma_f32_16x16x32_bf16 v[104:107], a[48:51], v[128:131], v[104:107]
    v_mul_f32 v26, v11, v26
    v_mul_f32 v27, v11, v27
    v_mfma_f32_16x16x32_bf16 v[104:107], a[72:75], v[132:135], v[104:107]
    v_exp_f32 v26, v26
    v_mfma_f32_16x16x32_bf16 v[104:107], a[96:99], v[136:139], v[104:107]
    v_exp_f32 v27, v27
    v_mfma_f32_16x16x32_bf16 v[104:107], a[120:123], v[140:143], v[104:107]
    v_add_f32 v28, v26, v27
    v_mov_b32 v29, v28
    v_mfma_f32_16x16x32_bf16 v[104:107], a[144:147], v[144:147], v[104:107]
    v_cvt_pk_bf16_f32 v44, v100, v101
    v_cvt_pk_bf16_f32 v45, v102, v103
    v_mfma_f32_16x16x32_bf16 v[104:107], a[168:171], v[148:151], v[104:107]
    v_permlane16_swap_b32 v28, v29
    v_add_f32 v28, v28, v29
    v_mfma_f32_16x16x32_bf16 v[104:107], a[192:195], v[152:155], v[104:107]
    v_mov_b32 v29, v28
    v_mfma_f32_16x16x32_bf16 v[104:107], a[216:219], v[156:159], v[104:107]
    v_mfma_f32_16x16x32_bf16 v[104:107], a[240:243], v[160:163], v[104:107]
    v_permlane32_swap_b32 v28, v29
    v_add_f32 v28, v28, v29
    v_mfma_f32_16x16x32_bf16 v[104:107], v[184:187], v[164:167], v[104:107]
    v_rcp_f32 v28, v28
    v_mfma_f32_16x16x32_bf16 v[104:107], v[208:211], v[168:171], v[104:107]
    v_mul_f32 v26, v26, v8
    v_mul_f32 v27, v27, v9
    v_mfma_f32_16x16x32_bf16 v[104:107], v[232:235], v[172:175], v[104:107]
    v_mul_f32 v26, v26, v28
    v_mul_f32 v27, v27, v28
    v_mfma_f32_16x16x32_bf16 v[108:111], a[4:7], v[120:123], 0
    ds_read_b64_tr_b16 v[120:121], v4 offset:32768
    ds_read_b64_tr_b16 v[122:123], v25 offset:32768
    v_mfma_f32_16x16x32_bf16 v[108:111], a[28:31], v[124:127], v[108:111]
    ds_read_b64_tr_b16 v[124:125], v4 offset:33792
    v_cvt_pk_bf16_f32 v26, v26, v26
    v_mfma_f32_16x16x32_bf16 v[108:111], a[52:55], v[128:131], v[108:111]
    ds_read_b64_tr_b16 v[126:127], v25 offset:33792
    ds_read_b64_tr_b16 v[128:129], v4 offset:34816
    v_mfma_f32_16x16x32_bf16 v[108:111], a[76:79], v[132:135], v[108:111]
    ds_read_b64_tr_b16 v[130:131], v25 offset:34816
    v_cvt_pk_bf16_f32 v27, v27, v27
    v_mfma_f32_16x16x32_bf16 v[108:111], a[100:103], v[136:139], v[108:111]
    ds_read_b64_tr_b16 v[132:133], v4 offset:35840
    v_and_b32 v80, v26, v14
    v_mfma_f32_16x16x32_bf16 v[108:111], a[124:127], v[140:143], v[108:111]
    ds_read_b64_tr_b16 v[134:135], v25 offset:35840
    ds_read_b64_tr_b16 v[136:137], v4 offset:36864
    v_mfma_f32_16x16x32_bf16 v[108:111], a[148:151], v[144:147], v[108:111]
    ds_read_b64_tr_b16 v[138:139], v25 offset:36864
    v_cvt_pk_bf16_f32 v68, v104, v105
    v_mfma_f32_16x16x32_bf16 v[108:111], a[172:175], v[148:151], v[108:111]
    ds_read_b64_tr_b16 v[140:141], v4 offset:37888
    ds_read_b64_tr_b16 v[142:143], v25 offset:37888
    v_mfma_f32_16x16x32_bf16 v[108:111], a[196:199], v[152:155], v[108:111]
    ds_read_b64_tr_b16 v[144:145], v4 offset:38912
    v_cvt_pk_bf16_f32 v69, v106, v107
    v_mfma_f32_16x16x32_bf16 v[108:111], a[220:223], v[156:159], v[108:111]
    ds_read_b64_tr_b16 v[146:147], v25 offset:38912
    v_and_b32 v81, v27, v15
    v_mfma_f32_16x16x32_bf16 v[108:111], a[244:247], v[160:163], v[108:111]
    ds_read_b64_tr_b16 v[148:149], v4 offset:39936
    ds_read_b64_tr_b16 v[150:151], v25 offset:39936
    v_mfma_f32_16x16x32_bf16 v[108:111], v[188:191], v[164:167], v[108:111]
    ds_read_b64_tr_b16 v[152:153], v4 offset:40960
    v_and_b32 v82, v26, v16
    v_mfma_f32_16x16x32_bf16 v[108:111], v[212:215], v[168:171], v[108:111]
    ds_read_b64_tr_b16 v[154:155], v25 offset:40960
    ds_read_b64_tr_b16 v[156:157], v4 offset:41984
    v_mfma_f32_16x16x32_bf16 v[108:111], v[236:239], v[172:175], v[108:111]
    ds_read_b64_tr_b16 v[158:159], v25 offset:41984
    v_and_b32 v83, v27, v17
    s_waitcnt lgkmcnt(15)
    v_mfma_f32_16x16x32_bf16 v[112:115], a[8:11], v[120:123], 0
    ds_read_b64_tr_b16 v[160:161], v4 offset:43008
    v_mfma_f32_16x16x32_bf16 v[112:115], a[32:35], v[124:127], v[112:115]
    ds_read_b64_tr_b16 v[162:163], v25 offset:43008
    ds_read_b64_tr_b16 v[164:165], v4 offset:44032
    s_waitcnt lgkmcnt(15)
    v_mfma_f32_16x16x32_bf16 v[112:115], a[56:59], v[128:131], v[112:115]
    ds_read_b64_tr_b16 v[166:167], v25 offset:44032
    v_mfma_f32_16x16x32_bf16 v[72:75], v[38:41], v[80:83], 0
    v_mfma_f32_16x16x32_bf16 v[112:115], a[80:83], v[132:135], v[112:115]
    ds_read_b64_tr_b16 v[168:169], v4 offset:45056
    v_mfma_f32_16x16x32_bf16 v[76:79], v[48:51], v[80:83], 0
    s_waitcnt lgkmcnt(13)
    v_mfma_f32_16x16x32_bf16 v[112:115], a[104:107], v[136:139], v[112:115]
    ds_read_b64_tr_b16 v[170:171], v25 offset:45056
    ds_read_b64_tr_b16 v[172:173], v4 offset:46080
    v_mfma_f32_16x16x32_bf16 v[112:115], a[128:131], v[140:143], v[112:115]
    ds_read_b64_tr_b16 v[174:175], v25 offset:46080
    s_add_u32 s53, s74, 49152
    s_waitcnt lgkmcnt(12)
    v_mfma_f32_16x16x32_bf16 v[112:115], a[152:155], v[144:147], v[112:115]
    v_cvt_pk_bf16_f32 v70, v108, v109
    v_cvt_pk_bf16_f32 v71, v110, v111
    v_mfma_f32_16x16x32_bf16 v[112:115], a[176:179], v[148:151], v[112:115]
    v_cndmask_b32 v70, v70, 0, s[82:83]
    v_cndmask_b32 v71, v71, 0, s[82:83]
    s_waitcnt lgkmcnt(8)
    v_mfma_f32_16x16x32_bf16 v[112:115], a[200:203], v[152:155], v[112:115]
    v_mfma_f32_16x16x32_bf16 v[112:115], a[224:227], v[156:159], v[112:115]
    s_waitcnt lgkmcnt(4)
    v_mfma_f32_16x16x32_bf16 v[112:115], a[248:251], v[160:163], v[112:115]
    v_cvt_pk_bf16_f32 v84, v72, v73
    v_cvt_pk_bf16_f32 v85, v74, v75
    v_mfma_f32_16x16x32_bf16 v[112:115], v[192:195], v[164:167], v[112:115]
    v_cvt_pk_bf16_f32 v86, v76, v77
    v_cvt_pk_bf16_f32 v87, v78, v79
    s_waitcnt lgkmcnt(0)
    v_mfma_f32_16x16x32_bf16 v[112:115], v[216:219], v[168:171], v[112:115]
    buffer_store_dwordx4 v[84:87], v23, s[24:27], s53 offen sc1
    v_mfma_f32_16x16x32_bf16 v[112:115], v[240:243], v[172:175], v[112:115]
    v_cndmask_b32 v80, v84, v86, s[88:89]
    v_cndmask_b32 v81, v85, v87, s[88:89]
    v_mfma_f32_16x16x32_bf16 v[116:119], a[12:15], v[120:123], 0
    ds_write_b64 v95, v[80:81] offset:768
    v_add_u32 v92, 65536, v92
    v_mfma_f32_16x16x32_bf16 v[116:119], a[36:39], v[124:127], v[116:119]
    v_add_u32 v93, 65536, v93
    v_add_u32 v94, 65536, v94
    v_mfma_f32_16x16x32_bf16 v[116:119], a[60:63], v[128:131], v[116:119]
    v_mfma_f32_16x16x32_bf16 v[72:75], v[56:59], v[68:71], 0
    v_mfma_f32_16x16x32_bf16 v[116:119], a[84:87], v[132:135], v[116:119]
    v_mfma_f32_16x16x32_bf16 v[76:79], v[60:63], v[68:71], 0
    v_mfma_f32_16x16x32_bf16 v[116:119], a[108:111], v[136:139], v[116:119]
    ds_read_u16_d16_hi v8, v93 offset:0
    ds_read_u16_d16_hi v9, v94 offset:0
    v_mfma_f32_16x16x32_bf16 v[116:119], a[132:135], v[140:143], v[116:119]
    ds_read_u16_d16_hi v10, v92 offset:0
    v_mfma_f32_16x16x32_bf16 v[116:119], a[156:159], v[144:147], v[116:119]
    v_cvt_pk_bf16_f32 v52, v112, v113
    v_cvt_pk_bf16_f32 v53, v114, v115
    v_mfma_f32_16x16x32_bf16 v[116:119], a[180:183], v[148:151], v[116:119]
    v_mfma_f32_16x16x32_bf16 v[116:119], a[204:207], v[152:155], v[116:119]
    v_mfma_f32_16x16x32_bf16 v[116:119], a[228:231], v[156:159], v[116:119]
    v_cndmask_b32 v26, v72, v73, s[76:77]
    v_cndmask_b32 v27, v74, v75, s[76:77]
    v_mfma_f32_16x16x32_bf16 v[116:119], a[252:255], v[160:163], v[116:119]
    v_cndmask_b32 v28, v76, v77, s[76:77]
    v_cndmask_b32 v29, v78, v79, s[76:77]
    v_mfma_f32_16x16x32_bf16 v[116:119], v[196:199], v[164:167], v[116:119]
    v_cndmask_b32 v26, v26, v28, s[78:79]
    v_cndmask_b32 v27, v27, v29, s[80:81]
    v_mfma_f32_16x16x32_bf16 v[116:119], v[220:223], v[168:171], v[116:119]
    s_waitcnt lgkmcnt(0)
    v_mul_f32 v26, v26, v8
    v_mfma_f32_16x16x32_bf16 v[116:119], v[244:247], v[172:175], v[116:119]
    v_mul_f32 v27, v27, v9
    v_mul_f32 v11, s91, v10
    v_mfma_f32_16x16x32_bf16 v[96:99], v[120:123], a[16:19], 0
    v_max_f32 v28, v26, v27
    v_mov_b32 v29, v28
    v_mfma_f32_16x16x32_bf16 v[96:99], v[124:127], a[40:43], v[96:99]
    v_mfma_f32_16x16x32_bf16 v[96:99], v[128:131], a[64:67], v[96:99]
    v_permlane16_swap_b32 v28, v29
    v_max_f32 v28, v28, v29
    v_mfma_f32_16x16x32_bf16 v[96:99], v[132:135], a[88:91], v[96:99]
    v_mov_b32 v29, v28
    v_mfma_f32_16x16x32_bf16 v[96:99], v[136:139], a[112:115], v[96:99]
    v_mfma_f32_16x16x32_bf16 v[96:99], v[140:143], a[136:139], v[96:99]
    v_permlane32_swap_b32 v28, v29
    v_max_f32 v28, v28, v29
    v_mfma_f32_16x16x32_bf16 v[96:99], v[144:147], a[160:163], v[96:99]
    v_cvt_pk_bf16_f32 v54, v116, v117
    v_cvt_pk_bf16_f32 v55, v118, v119
    v_mfma_f32_16x16x32_bf16 v[96:99], v[148:151], a[184:187], v[96:99]
    v_cndmask_b32 v54, v54, 0, s[82:83]
    v_cndmask_b32 v55, v55, 0, s[82:83]
    v_mfma_f32_16x16x32_bf16 v[96:99], v[152:155], a[208:211], v[96:99]
    v_sub_f32 v26, v26, v28
    v_sub_f32 v27, v27, v28
    v_mfma_f32_16x16x32_bf16 v[96:99], v[156:159], a[232:235], v[96:99]
    v_mul_f32 v26, v11, v26
    v_mul_f32 v27, v11, v27
    v_mfma_f32_16x16x32_bf16 v[96:99], v[160:163], v[176:179], v[96:99]
    v_exp_f32 v26, v26
    v_mfma_f32_16x16x32_bf16 v[96:99], v[164:167], v[200:203], v[96:99]
    v_exp_f32 v27, v27
    v_mfma_f32_16x16x32_bf16 v[96:99], v[168:171], v[224:227], v[96:99]
    v_add_f32 v28, v26, v27
    v_mov_b32 v29, v28
    v_mfma_f32_16x16x32_bf16 v[96:99], v[172:175], v[248:251], v[96:99]
    v_mfma_f32_16x16x32_bf16 v[100:103], v[120:123], a[20:23], 0
    v_permlane16_swap_b32 v28, v29
    v_add_f32 v28, v28, v29
    v_mfma_f32_16x16x32_bf16 v[100:103], v[124:127], a[44:47], v[100:103]
    v_mov_b32 v29, v28
    v_mfma_f32_16x16x32_bf16 v[100:103], v[128:131], a[68:71], v[100:103]
    v_mfma_f32_16x16x32_bf16 v[100:103], v[132:135], a[92:95], v[100:103]
    v_permlane32_swap_b32 v28, v29
    v_add_f32 v28, v28, v29
    v_mfma_f32_16x16x32_bf16 v[100:103], v[136:139], a[116:119], v[100:103]
    v_rcp_f32 v28, v28
    v_mfma_f32_16x16x32_bf16 v[100:103], v[140:143], a[140:143], v[100:103]
    v_mul_f32 v26, v26, v8
    v_mul_f32 v27, v27, v9
    v_mfma_f32_16x16x32_bf16 v[100:103], v[144:147], a[164:167], v[100:103]
    v_cvt_pk_bf16_f32 v36, v96, v97
    v_cvt_pk_bf16_f32 v37, v98, v99
    v_mfma_f32_16x16x32_bf16 v[100:103], v[148:151], a[188:191], v[100:103]
    v_mul_f32 v26, v26, v28
    v_mul_f32 v27, v27, v28
    v_mfma_f32_16x16x32_bf16 v[100:103], v[152:155], a[212:215], v[100:103]
    v_cvt_pk_bf16_f32 v26, v26, v26
    v_cvt_pk_bf16_f32 v27, v27, v27
    v_mfma_f32_16x16x32_bf16 v[100:103], v[156:159], a[236:239], v[100:103]
    v_and_b32 v80, v26, v14
    v_and_b32 v81, v27, v15
    v_mfma_f32_16x16x32_bf16 v[100:103], v[160:163], v[180:183], v[100:103]
    v_and_b32 v82, v26, v16
    v_and_b32 v83, v27, v17
    v_mfma_f32_16x16x32_bf16 v[100:103], v[164:167], v[204:207], v[100:103]
    v_mfma_f32_16x16x32_bf16 v[100:103], v[168:171], v[228:231], v[100:103]
    v_mfma_f32_16x16x32_bf16 v[72:75], v[32:35], v[80:83], 0
    v_mfma_f32_16x16x32_bf16 v[100:103], v[172:175], v[252:255], v[100:103]
    v_mfma_f32_16x16x32_bf16 v[76:79], v[42:45], v[80:83], 0
    v_mfma_f32_16x16x32_bf16 v[104:107], a[0:3], v[120:123], 0
    s_add_u32 s53, s74, 65536
    v_mfma_f32_16x16x32_bf16 v[104:107], a[24:27], v[124:127], v[104:107]
    v_mfma_f32_16x16x32_bf16 v[104:107], a[48:51], v[128:131], v[104:107]
    v_mfma_f32_16x16x32_bf16 v[104:107], a[72:75], v[132:135], v[104:107]
    v_mfma_f32_16x16x32_bf16 v[104:107], a[96:99], v[136:139], v[104:107]
    v_mfma_f32_16x16x32_bf16 v[104:107], a[120:123], v[140:143], v[104:107]
    v_cvt_pk_bf16_f32 v84, v72, v73
    v_cvt_pk_bf16_f32 v85, v74, v75
    v_mfma_f32_16x16x32_bf16 v[104:107], a[144:147], v[144:147], v[104:107]
    v_cvt_pk_bf16_f32 v46, v100, v101
    v_cvt_pk_bf16_f32 v47, v102, v103
    v_mfma_f32_16x16x32_bf16 v[104:107], a[168:171], v[148:151], v[104:107]
    v_cvt_pk_bf16_f32 v86, v76, v77
    v_cvt_pk_bf16_f32 v87, v78, v79
    v_mfma_f32_16x16x32_bf16 v[104:107], a[192:195], v[152:155], v[104:107]
    buffer_store_dwordx4 v[84:87], v23, s[24:27], s53 offen sc1
    v_mfma_f32_16x16x32_bf16 v[104:107], a[216:219], v[156:159], v[104:107]
    v_cndmask_b32 v80, v84, v86, s[88:89]
    v_cndmask_b32 v81, v85, v87, s[88:89]
    v_mfma_f32_16x16x32_bf16 v[104:107], a[240:243], v[160:163], v[104:107]
    ds_write_b64 v95, v[80:81] offset:1024
    v_mfma_f32_16x16x32_bf16 v[104:107], v[184:187], v[164:167], v[104:107]
    v_mfma_f32_16x16x32_bf16 v[104:107], v[208:211], v[168:171], v[104:107]
    v_mfma_f32_16x16x32_bf16 v[104:107], v[232:235], v[172:175], v[104:107]
    v_mfma_f32_16x16x32_bf16 v[108:111], a[4:7], v[120:123], 0
    ds_read_b64_tr_b16 v[120:121], v4 offset:49152
    ds_read_b64_tr_b16 v[122:123], v25 offset:49152
    v_mfma_f32_16x16x32_bf16 v[108:111], a[28:31], v[124:127], v[108:111]
    ds_read_b64_tr_b16 v[124:125], v4 offset:50176
    v_mfma_f32_16x16x32_bf16 v[108:111], a[52:55], v[128:131], v[108:111]
    ds_read_b64_tr_b16 v[126:127], v25 offset:50176
    ds_read_b64_tr_b16 v[128:129], v4 offset:51200
    v_mfma_f32_16x16x32_bf16 v[108:111], a[76:79], v[132:135], v[108:111]
    ds_read_b64_tr_b16 v[130:131], v25 offset:51200
    v_mfma_f32_16x16x32_bf16 v[108:111], a[100:103], v[136:139], v[108:111]
    ds_read_b64_tr_b16 v[132:133], v4 offset:52224
    v_mfma_f32_16x16x32_bf16 v[108:111], a[124:127], v[140:143], v[108:111]
    ds_read_b64_tr_b16 v[134:135], v25 offset:52224
    ds_read_b64_tr_b16 v[136:137], v4 offset:53248
    v_mfma_f32_16x16x32_bf16 v[108:111], a[148:151], v[144:147], v[108:111]
    ds_read_b64_tr_b16 v[138:139], v25 offset:53248
    v_cvt_pk_bf16_f32 v64, v104, v105
    v_mfma_f32_16x16x32_bf16 v[108:111], a[172:175], v[148:151], v[108:111]
    ds_read_b64_tr_b16 v[140:141], v4 offset:54272
    ds_read_b64_tr_b16 v[142:143], v25 offset:54272
    v_mfma_f32_16x16x32_bf16 v[108:111], a[196:199], v[152:155], v[108:111]
    ds_read_b64_tr_b16 v[144:145], v4 offset:55296
    v_cvt_pk_bf16_f32 v65, v106, v107
    v_mfma_f32_16x16x32_bf16 v[108:111], a[220:223], v[156:159], v[108:111]
    ds_read_b64_tr_b16 v[146:147], v25 offset:55296
    v_mfma_f32_16x16x32_bf16 v[108:111], a[244:247], v[160:163], v[108:111]
    ds_read_b64_tr_b16 v[148:149], v4 offset:56320
    ds_read_b64_tr_b16 v[150:151], v25 offset:56320
    v_mfma_f32_16x16x32_bf16 v[108:111], v[188:191], v[164:167], v[108:111]
    ds_read_b64_tr_b16 v[152:153], v4 offset:57344
    v_mfma_f32_16x16x32_bf16 v[108:111], v[212:215], v[168:171], v[108:111]
    ds_read_b64_tr_b16 v[154:155], v25 offset:57344
    ds_read_b64_tr_b16 v[156:157], v4 offset:58368
    v_mfma_f32_16x16x32_bf16 v[108:111], v[236:239], v[172:175], v[108:111]
    ds_read_b64_tr_b16 v[158:159], v25 offset:58368
    s_waitcnt lgkmcnt(15)
    v_mfma_f32_16x16x32_bf16 v[112:115], a[8:11], v[120:123], 0
    ds_read_b64_tr_b16 v[160:161], v4 offset:59392
    v_mfma_f32_16x16x32_bf16 v[112:115], a[32:35], v[124:127], v[112:115]
    ds_read_b64_tr_b16 v[162:163], v25 offset:59392
    ds_read_b64_tr_b16 v[164:165], v4 offset:60416
    s_waitcnt lgkmcnt(15)
    v_mfma_f32_16x16x32_bf16 v[112:115], a[56:59], v[128:131], v[112:115]
    ds_read_b64_tr_b16 v[166:167], v25 offset:60416
    v_mfma_f32_16x16x32_bf16 v[112:115], a[80:83], v[132:135], v[112:115]
    ds_read_b64_tr_b16 v[168:169], v4 offset:61440
    s_waitcnt lgkmcnt(13)
    v_mfma_f32_16x16x32_bf16 v[112:115], a[104:107], v[136:139], v[112:115]
    ds_read_b64_tr_b16 v[170:171], v25 offset:61440
    ds_read_b64_tr_b16 v[172:173], v4 offset:62464
    v_mfma_f32_16x16x32_bf16 v[112:115], a[128:131], v[140:143], v[112:115]
    ds_read_b64_tr_b16 v[174:175], v25 offset:62464
    s_waitcnt lgkmcnt(12)
    v_mfma_f32_16x16x32_bf16 v[112:115], a[152:155], v[144:147], v[112:115]
    v_cvt_pk_bf16_f32 v66, v108, v109
    v_cvt_pk_bf16_f32 v67, v110, v111
    v_mfma_f32_16x16x32_bf16 v[112:115], a[176:179], v[148:151], v[112:115]
    v_cndmask_b32 v66, v66, 0, s[82:83]
    v_cndmask_b32 v67, v67, 0, s[82:83]
    s_waitcnt lgkmcnt(8)
    v_mfma_f32_16x16x32_bf16 v[112:115], a[200:203], v[152:155], v[112:115]
    v_mfma_f32_16x16x32_bf16 v[112:115], a[224:227], v[156:159], v[112:115]
    v_mfma_f32_16x16x32_bf16 v[72:75], v[60:63], v[64:67], 0
    s_waitcnt lgkmcnt(4)
    v_mfma_f32_16x16x32_bf16 v[112:115], a[248:251], v[160:163], v[112:115]
    v_mfma_f32_16x16x32_bf16 v[76:79], v[52:55], v[64:67], 0
    v_mfma_f32_16x16x32_bf16 v[112:115], v[192:195], v[164:167], v[112:115]
    ds_read_u16_d16_hi v8, v93 offset:16384
    ds_read_u16_d16_hi v9, v94 offset:16384
    s_waitcnt lgkmcnt(2)
    v_mfma_f32_16x16x32_bf16 v[112:115], v[216:219], v[168:171], v[112:115]
    ds_read_u16_d16_hi v10, v92 offset:16384
    v_mfma_f32_16x16x32_bf16 v[112:115], v[240:243], v[172:175], v[112:115]
    v_mfma_f32_16x16x32_bf16 v[116:119], a[12:15], v[120:123], 0
    v_mfma_f32_16x16x32_bf16 v[116:119], a[36:39], v[124:127], v[116:119]
    v_mfma_f32_16x16x32_bf16 v[116:119], a[60:63], v[128:131], v[116:119]
    v_cndmask_b32 v26, v72, v73, s[76:77]
    v_cndmask_b32 v27, v74, v75, s[76:77]
    v_mfma_f32_16x16x32_bf16 v[116:119], a[84:87], v[132:135], v[116:119]
    v_cndmask_b32 v28, v76, v77, s[76:77]
    v_cndmask_b32 v29, v78, v79, s[76:77]
    v_mfma_f32_16x16x32_bf16 v[116:119], a[108:111], v[136:139], v[116:119]
    v_cndmask_b32 v26, v26, v28, s[78:79]
    v_cndmask_b32 v27, v27, v29, s[80:81]
    v_mfma_f32_16x16x32_bf16 v[116:119], a[132:135], v[140:143], v[116:119]
    s_waitcnt lgkmcnt(0)
    v_mul_f32 v26, v26, v8
    v_mfma_f32_16x16x32_bf16 v[116:119], a[156:159], v[144:147], v[116:119]
    v_cvt_pk_bf16_f32 v56, v112, v113
    v_cvt_pk_bf16_f32 v57, v114, v115
    v_mfma_f32_16x16x32_bf16 v[116:119], a[180:183], v[148:151], v[116:119]
    v_mul_f32 v27, v27, v9
    v_mul_f32 v11, s91, v10
    v_mfma_f32_16x16x32_bf16 v[116:119], a[204:207], v[152:155], v[116:119]
    v_max_f32 v28, v26, v27
    v_mov_b32 v29, v28
    v_mfma_f32_16x16x32_bf16 v[116:119], a[228:231], v[156:159], v[116:119]
    v_mfma_f32_16x16x32_bf16 v[116:119], a[252:255], v[160:163], v[116:119]
    v_permlane16_swap_b32 v28, v29
    v_max_f32 v28, v28, v29
    v_mfma_f32_16x16x32_bf16 v[116:119], v[196:199], v[164:167], v[116:119]
    v_mov_b32 v29, v28
    v_mfma_f32_16x16x32_bf16 v[116:119], v[220:223], v[168:171], v[116:119]
    v_mfma_f32_16x16x32_bf16 v[116:119], v[244:247], v[172:175], v[116:119]
    v_permlane32_swap_b32 v28, v29
    v_max_f32 v28, v28, v29
    v_mfma_f32_16x16x32_bf16 v[96:99], v[120:123], a[16:19], 0
    v_sub_f32 v26, v26, v28
    v_sub_f32 v27, v27, v28
    v_mfma_f32_16x16x32_bf16 v[96:99], v[124:127], a[40:43], v[96:99]
    v_mul_f32 v26, v11, v26
    v_mul_f32 v27, v11, v27
    v_mfma_f32_16x16x32_bf16 v[96:99], v[128:131], a[64:67], v[96:99]
    v_exp_f32 v26, v26
    v_mfma_f32_16x16x32_bf16 v[96:99], v[132:135], a[88:91], v[96:99]
    v_exp_f32 v27, v27
    v_mfma_f32_16x16x32_bf16 v[96:99], v[136:139], a[112:115], v[96:99]
    v_add_f32 v28, v26, v27
    v_mov_b32 v29, v28
    v_mfma_f32_16x16x32_bf16 v[96:99], v[140:143], a[136:139], v[96:99]
    v_mfma_f32_16x16x32_bf16 v[96:99], v[144:147], a[160:163], v[96:99]
    v_cvt_pk_bf16_f32 v58, v116, v117
    v_cvt_pk_bf16_f32 v59, v118, v119
    v_mfma_f32_16x16x32_bf16 v[96:99], v[148:151], a[184:187], v[96:99]
    v_cndmask_b32 v58, v58, 0, s[82:83]
    v_cndmask_b32 v59, v59, 0, s[82:83]
    v_mfma_f32_16x16x32_bf16 v[96:99], v[152:155], a[208:211], v[96:99]
    v_permlane16_swap_b32 v28, v29
    v_add_f32 v28, v28, v29
    v_mfma_f32_16x16x32_bf16 v[96:99], v[156:159], a[232:235], v[96:99]
    v_mov_b32 v29, v28
    v_mfma_f32_16x16x32_bf16 v[96:99], v[160:163], v[176:179], v[96:99]
    v_mfma_f32_16x16x32_bf16 v[96:99], v[164:167], v[200:203], v[96:99]
    v_permlane32_swap_b32 v28, v29
    v_add_f32 v28, v28, v29
    v_mfma_f32_16x16x32_bf16 v[96:99], v[168:171], v[224:227], v[96:99]
    v_rcp_f32 v28, v28
    v_mfma_f32_16x16x32_bf16 v[96:99], v[172:175], v[248:251], v[96:99]
    v_mul_f32 v26, v26, v8
    v_mul_f32 v27, v27, v9
    v_mfma_f32_16x16x32_bf16 v[100:103], v[120:123], a[20:23], 0
    v_mul_f32 v26, v26, v28
    v_mul_f32 v27, v27, v28
    v_mfma_f32_16x16x32_bf16 v[100:103], v[124:127], a[44:47], v[100:103]
    v_cvt_pk_bf16_f32 v26, v26, v26
    v_cvt_pk_bf16_f32 v27, v27, v27
    v_mfma_f32_16x16x32_bf16 v[100:103], v[128:131], a[68:71], v[100:103]
    v_and_b32 v80, v26, v14
    v_and_b32 v81, v27, v15
    v_mfma_f32_16x16x32_bf16 v[100:103], v[132:135], a[92:95], v[100:103]
    v_and_b32 v82, v26, v16
    v_and_b32 v83, v27, v17
    v_mfma_f32_16x16x32_bf16 v[100:103], v[136:139], a[116:119], v[100:103]
    v_mfma_f32_16x16x32_bf16 v[100:103], v[140:143], a[140:143], v[100:103]
    v_mfma_f32_16x16x32_bf16 v[72:75], v[34:37], v[80:83], 0
    v_mfma_f32_16x16x32_bf16 v[100:103], v[144:147], a[164:167], v[100:103]
    v_cvt_pk_bf16_f32 v38, v96, v97
    v_cvt_pk_bf16_f32 v39, v98, v99
    v_mfma_f32_16x16x32_bf16 v[100:103], v[148:151], a[188:191], v[100:103]
    v_mfma_f32_16x16x32_bf16 v[76:79], v[44:47], v[80:83], 0
    v_mfma_f32_16x16x32_bf16 v[100:103], v[152:155], a[212:215], v[100:103]
    s_add_u32 s53, s74, 81920
    v_mfma_f32_16x16x32_bf16 v[100:103], v[156:159], a[236:239], v[100:103]
    v_mfma_f32_16x16x32_bf16 v[100:103], v[160:163], v[180:183], v[100:103]
    v_mfma_f32_16x16x32_bf16 v[100:103], v[164:167], v[204:207], v[100:103]
    v_mfma_f32_16x16x32_bf16 v[100:103], v[168:171], v[228:231], v[100:103]
    v_mfma_f32_16x16x32_bf16 v[100:103], v[172:175], v[252:255], v[100:103]
    v_cvt_pk_bf16_f32 v84, v72, v73
    v_cvt_pk_bf16_f32 v85, v74, v75
    v_mfma_f32_16x16x32_bf16 v[104:107], a[0:3], v[120:123], 0
    v_cvt_pk_bf16_f32 v86, v76, v77
    v_cvt_pk_bf16_f32 v87, v78, v79
    v_mfma_f32_16x16x32_bf16 v[104:107], a[24:27], v[124:127], v[104:107]
    buffer_store_dwordx4 v[84:87], v23, s[24:27], s53 offen sc1
    v_mfma_f32_16x16x32_bf16 v[104:107], a[48:51], v[128:131], v[104:107]
    v_cndmask_b32 v80, v84, v86, s[88:89]
    v_cndmask_b32 v81, v85, v87, s[88:89]
    v_mfma_f32_16x16x32_bf16 v[104:107], a[72:75], v[132:135], v[104:107]
    ds_write_b64 v95, v[80:81] offset:1280
    v_mfma_f32_16x16x32_bf16 v[104:107], a[96:99], v[136:139], v[104:107]
    v_mfma_f32_16x16x32_bf16 v[104:107], a[120:123], v[140:143], v[104:107]
    v_mfma_f32_16x16x32_bf16 v[104:107], a[144:147], v[144:147], v[104:107]
    v_cvt_pk_bf16_f32 v48, v100, v101
    v_cvt_pk_bf16_f32 v49, v102, v103
    v_mfma_f32_16x16x32_bf16 v[104:107], a[168:171], v[148:151], v[104:107]
    v_mfma_f32_16x16x32_bf16 v[104:107], a[192:195], v[152:155], v[104:107]
    v_mfma_f32_16x16x32_bf16 v[104:107], a[216:219], v[156:159], v[104:107]
    v_mfma_f32_16x16x32_bf16 v[104:107], a[240:243], v[160:163], v[104:107]
    v_mfma_f32_16x16x32_bf16 v[104:107], v[184:187], v[164:167], v[104:107]
    v_mfma_f32_16x16x32_bf16 v[104:107], v[208:211], v[168:171], v[104:107]
    v_mfma_f32_16x16x32_bf16 v[104:107], v[232:235], v[172:175], v[104:107]
    s_waitcnt vmcnt(10)
    s_barrier
    v_mfma_f32_16x16x32_bf16 v[108:111], a[4:7], v[120:123], 0
    v_add_u32 v4, 65536, v4
    v_add_u32 v25, 65536, v25
    ds_read_b64_tr_b16 v[120:121], v4 offset:0
    ds_read_b64_tr_b16 v[122:123], v25 offset:0
    v_mfma_f32_16x16x32_bf16 v[108:111], a[28:31], v[124:127], v[108:111]
    ds_read_b64_tr_b16 v[124:125], v4 offset:1024
    v_mfma_f32_16x16x32_bf16 v[108:111], a[52:55], v[128:131], v[108:111]
    ds_read_b64_tr_b16 v[126:127], v25 offset:1024
    ds_read_b64_tr_b16 v[128:129], v4 offset:2048
    v_mfma_f32_16x16x32_bf16 v[108:111], a[76:79], v[132:135], v[108:111]
    ds_read_b64_tr_b16 v[130:131], v25 offset:2048
    v_mfma_f32_16x16x32_bf16 v[108:111], a[100:103], v[136:139], v[108:111]
    ds_read_b64_tr_b16 v[132:133], v4 offset:3072
    v_mfma_f32_16x16x32_bf16 v[108:111], a[124:127], v[140:143], v[108:111]
    ds_read_b64_tr_b16 v[134:135], v25 offset:3072
    ds_read_b64_tr_b16 v[136:137], v4 offset:4096
    v_mfma_f32_16x16x32_bf16 v[108:111], a[148:151], v[144:147], v[108:111]
    ds_read_b64_tr_b16 v[138:139], v25 offset:4096
    v_cvt_pk_bf16_f32 v68, v104, v105
    v_mfma_f32_16x16x32_bf16 v[108:111], a[172:175], v[148:151], v[108:111]
    ds_read_b64_tr_b16 v[140:141], v4 offset:5120
    ds_read_b64_tr_b16 v[142:143], v25 offset:5120
    v_mfma_f32_16x16x32_bf16 v[108:111], a[196:199], v[152:155], v[108:111]
    ds_read_b64_tr_b16 v[144:145], v4 offset:6144
    v_cvt_pk_bf16_f32 v69, v106, v107
    v_mfma_f32_16x16x32_bf16 v[108:111], a[220:223], v[156:159], v[108:111]
    ds_read_b64_tr_b16 v[146:147], v25 offset:6144
    v_mfma_f32_16x16x32_bf16 v[108:111], a[244:247], v[160:163], v[108:111]
    ds_read_b64_tr_b16 v[148:149], v4 offset:7168
    ds_read_b64_tr_b16 v[150:151], v25 offset:7168
    v_mfma_f32_16x16x32_bf16 v[108:111], v[188:191], v[164:167], v[108:111]
    ds_read_b64_tr_b16 v[152:153], v4 offset:8192
    v_mfma_f32_16x16x32_bf16 v[108:111], v[212:215], v[168:171], v[108:111]
    ds_read_b64_tr_b16 v[154:155], v25 offset:8192
    ds_read_b64_tr_b16 v[156:157], v4 offset:9216
    v_mfma_f32_16x16x32_bf16 v[108:111], v[236:239], v[172:175], v[108:111]
    ds_read_b64_tr_b16 v[158:159], v25 offset:9216
    s_waitcnt lgkmcnt(15)
    v_mfma_f32_16x16x32_bf16 v[112:115], a[0:3], v[120:123], 0
    ds_read_b64_tr_b16 v[160:161], v4 offset:10240
    v_mfma_f32_16x16x32_bf16 v[112:115], a[24:27], v[124:127], v[112:115]
    ds_read_b64_tr_b16 v[162:163], v25 offset:10240
    ds_read_b64_tr_b16 v[164:165], v4 offset:11264
    s_waitcnt lgkmcnt(15)
    v_mfma_f32_16x16x32_bf16 v[112:115], a[48:51], v[128:131], v[112:115]
    ds_read_b64_tr_b16 v[166:167], v25 offset:11264
    v_mfma_f32_16x16x32_bf16 v[112:115], a[72:75], v[132:135], v[112:115]
    ds_read_b64_tr_b16 v[168:169], v4 offset:12288
    s_waitcnt lgkmcnt(13)
    v_mfma_f32_16x16x32_bf16 v[112:115], a[96:99], v[136:139], v[112:115]
    ds_read_b64_tr_b16 v[170:171], v25 offset:12288
    ds_read_b64_tr_b16 v[172:173], v4 offset:13312
    v_mfma_f32_16x16x32_bf16 v[112:115], a[120:123], v[140:143], v[112:115]
    ds_read_b64_tr_b16 v[174:175], v25 offset:13312
    s_waitcnt lgkmcnt(12)
    v_mfma_f32_16x16x32_bf16 v[112:115], a[144:147], v[144:147], v[112:115]
    v_cvt_pk_bf16_f32 v70, v108, v109
    v_cvt_pk_bf16_f32 v71, v110, v111
    v_mfma_f32_16x16x32_bf16 v[112:115], a[168:171], v[148:151], v[112:115]
    v_cndmask_b32 v70, v70, 0, s[82:83]
    v_cndmask_b32 v71, v71, 0, s[82:83]
    s_waitcnt lgkmcnt(8)
    v_mfma_f32_16x16x32_bf16 v[112:115], a[192:195], v[152:155], v[112:115]
    v_mfma_f32_16x16x32_bf16 v[112:115], a[216:219], v[156:159], v[112:115]
    v_mfma_f32_16x16x32_bf16 v[72:75], v[52:55], v[68:71], 0
    s_waitcnt lgkmcnt(4)
    v_mfma_f32_16x16x32_bf16 v[112:115], a[240:243], v[160:163], v[112:115]
    v_mfma_f32_16x16x32_bf16 v[76:79], v[56:59], v[68:71], 0
    v_mfma_f32_16x16x32_bf16 v[112:115], v[184:187], v[164:167], v[112:115]
    ds_read_u16_d16_hi v8, v93 offset:32768
    ds_read_u16_d16_hi v9, v94 offset:32768
    s_waitcnt lgkmcnt(2)
    v_mfma_f32_16x16x32_bf16 v[112:115], v[208:211], v[168:171], v[112:115]
    ds_read_u16_d16_hi v10, v92 offset:32768
    v_mfma_f32_16x16x32_bf16 v[112:115], v[232:235], v[172:175], v[112:115]
    v_mfma_f32_16x16x32_bf16 v[116:119], a[4:7], v[120:123], 0
    v_mfma_f32_16x16x32_bf16 v[116:119], a[28:31], v[124:127], v[116:119]
    v_mfma_f32_16x16x32_bf16 v[116:119], a[52:55], v[128:131], v[116:119]
    v_cndmask_b32 v26, v72, v73, s[76:77]
    v_cndmask_b32 v27, v74, v75, s[76:77]
    v_mfma_f32_16x16x32_bf16 v[116:119], a[76:79], v[132:135], v[116:119]
    v_cndmask_b32 v28, v76, v77, s[76:77]
    v_cndmask_b32 v29, v78, v79, s[76:77]
    v_mfma_f32_16x16x32_bf16 v[116:119], a[100:103], v[136:139], v[116:119]
    v_cndmask_b32 v26, v26, v28, s[78:79]
    v_cndmask_b32 v27, v27, v29, s[80:81]
    v_mfma_f32_16x16x32_bf16 v[116:119], a[124:127], v[140:143], v[116:119]
    s_waitcnt lgkmcnt(0)
    v_mul_f32 v26, v26, v8
    v_mfma_f32_16x16x32_bf16 v[116:119], a[148:151], v[144:147], v[116:119]
    v_cvt_pk_bf16_f32 v64, v112, v113
    v_cvt_pk_bf16_f32 v65, v114, v115
    v_mfma_f32_16x16x32_bf16 v[116:119], a[172:175], v[148:151], v[116:119]
    v_mul_f32 v27, v27, v9
    v_mul_f32 v11, s91, v10
    v_mfma_f32_16x16x32_bf16 v[116:119], a[196:199], v[152:155], v[116:119]
    v_max_f32 v28, v26, v27
    v_mov_b32 v29, v28
    v_mfma_f32_16x16x32_bf16 v[116:119], a[220:223], v[156:159], v[116:119]
    v_mfma_f32_16x16x32_bf16 v[116:119], a[244:247], v[160:163], v[116:119]
    v_permlane16_swap_b32 v28, v29
    v_max_f32 v28, v28, v29
    v_mfma_f32_16x16x32_bf16 v[116:119], v[188:191], v[164:167], v[116:119]
    v_mov_b32 v29, v28
    v_mfma_f32_16x16x32_bf16 v[116:119], v[212:215], v[168:171], v[116:119]
    v_mfma_f32_16x16x32_bf16 v[116:119], v[236:239], v[172:175], v[116:119]
    v_permlane32_swap_b32 v28, v29
    v_max_f32 v28, v28, v29
    v_mfma_f32_16x16x32_bf16 v[96:99], a[8:11], v[120:123], 0
    v_sub_f32 v26, v26, v28
    v_sub_f32 v27, v27, v28
    v_mfma_f32_16x16x32_bf16 v[96:99], a[32:35], v[124:127], v[96:99]
    v_mul_f32 v26, v11, v26
    v_mul_f32 v27, v11, v27
    v_mfma_f32_16x16x32_bf16 v[96:99], a[56:59], v[128:131], v[96:99]
    v_exp_f32 v26, v26
    v_mfma_f32_16x16x32_bf16 v[96:99], a[80:83], v[132:135], v[96:99]
    v_exp_f32 v27, v27
    v_mfma_f32_16x16x32_bf16 v[96:99], a[104:107], v[136:139], v[96:99]
    v_add_f32 v28, v26, v27
    v_mov_b32 v29, v28
    v_mfma_f32_16x16x32_bf16 v[96:99], a[128:131], v[140:143], v[96:99]
    v_mfma_f32_16x16x32_bf16 v[96:99], a[152:155], v[144:147], v[96:99]
    v_cvt_pk_bf16_f32 v66, v116, v117
    v_cvt_pk_bf16_f32 v67, v118, v119
    v_mfma_f32_16x16x32_bf16 v[96:99], a[176:179], v[148:151], v[96:99]
    v_cndmask_b32 v66, v66, 0, s[82:83]
    v_cndmask_b32 v67, v67, 0, s[82:83]
    v_mfma_f32_16x16x32_bf16 v[96:99], a[200:203], v[152:155], v[96:99]
    v_permlane16_swap_b32 v28, v29
    v_add_f32 v28, v28, v29
    v_mfma_f32_16x16x32_bf16 v[96:99], a[224:227], v[156:159], v[96:99]
    v_mov_b32 v29, v28
    v_mfma_f32_16x16x32_bf16 v[96:99], a[248:251], v[160:163], v[96:99]
    v_mfma_f32_16x16x32_bf16 v[96:99], v[192:195], v[164:167], v[96:99]
    v_permlane32_swap_b32 v28, v29
    v_add_f32 v28, v28, v29
    v_mfma_f32_16x16x32_bf16 v[96:99], v[216:219], v[168:171], v[96:99]
    v_rcp_f32 v28, v28
    v_mfma_f32_16x16x32_bf16 v[96:99], v[240:243], v[172:175], v[96:99]
    v_mul_f32 v26, v26, v8
    v_mul_f32 v27, v27, v9
    v_mfma_f32_16x16x32_bf16 v[100:103], a[12:15], v[120:123], 0
    v_mul_f32 v26, v26, v28
    v_mul_f32 v27, v27, v28
    v_mfma_f32_16x16x32_bf16 v[100:103], a[36:39], v[124:127], v[100:103]
    v_cvt_pk_bf16_f32 v26, v26, v26
    v_cvt_pk_bf16_f32 v27, v27, v27
    v_mfma_f32_16x16x32_bf16 v[100:103], a[60:63], v[128:131], v[100:103]
    v_and_b32 v80, v26, v14
    v_and_b32 v81, v27, v15
    v_mfma_f32_16x16x32_bf16 v[100:103], a[84:87], v[132:135], v[100:103]
    v_and_b32 v82, v26, v16
    v_and_b32 v83, v27, v17
    v_mfma_f32_16x16x32_bf16 v[100:103], a[108:111], v[136:139], v[100:103]
    v_mfma_f32_16x16x32_bf16 v[100:103], a[132:135], v[140:143], v[100:103]
    v_mfma_f32_16x16x32_bf16 v[72:75], v[36:39], v[80:83], 0
    v_mfma_f32_16x16x32_bf16 v[100:103], a[156:159], v[144:147], v[100:103]
    v_cvt_pk_bf16_f32 v60, v96, v97
    v_cvt_pk_bf16_f32 v61, v98, v99
    v_mfma_f32_16x16x32_bf16 v[100:103], a[180:183], v[148:151], v[100:103]
    v_mfma_f32_16x16x32_bf16 v[76:79], v[46:49], v[80:83], 0
    v_mfma_f32_16x16x32_bf16 v[100:103], a[204:207], v[152:155], v[100:103]
    s_add_u32 s53, s74, 98304
    v_mfma_f32_16x16x32_bf16 v[100:103], a[228:231], v[156:159], v[100:103]
    v_mfma_f32_16x16x32_bf16 v[100:103], a[252:255], v[160:163], v[100:103]
    v_mfma_f32_16x16x32_bf16 v[100:103], v[196:199], v[164:167], v[100:103]
    v_mfma_f32_16x16x32_bf16 v[100:103], v[220:223], v[168:171], v[100:103]
    v_mfma_f32_16x16x32_bf16 v[100:103], v[244:247], v[172:175], v[100:103]
    v_cvt_pk_bf16_f32 v84, v72, v73
    v_cvt_pk_bf16_f32 v85, v74, v75
    v_mfma_f32_16x16x32_bf16 v[104:107], v[120:123], a[16:19], 0
    v_cvt_pk_bf16_f32 v86, v76, v77
    v_cvt_pk_bf16_f32 v87, v78, v79
    v_mfma_f32_16x16x32_bf16 v[104:107], v[124:127], a[40:43], v[104:107]
    buffer_store_dwordx4 v[84:87], v23, s[24:27], s53 offen sc1
    v_mfma_f32_16x16x32_bf16 v[104:107], v[128:131], a[64:67], v[104:107]
    v_cndmask_b32 v80, v84, v86, s[88:89]
    v_cndmask_b32 v81, v85, v87, s[88:89]
    v_mfma_f32_16x16x32_bf16 v[104:107], v[132:135], a[88:91], v[104:107]
    ds_write_b64 v95, v[80:81] offset:1536
    v_mfma_f32_16x16x32_bf16 v[104:107], v[136:139], a[112:115], v[104:107]
    v_mfma_f32_16x16x32_bf16 v[104:107], v[140:143], a[136:139], v[104:107]
    v_mfma_f32_16x16x32_bf16 v[104:107], v[144:147], a[160:163], v[104:107]
    v_cvt_pk_bf16_f32 v62, v100, v101
    v_cvt_pk_bf16_f32 v63, v102, v103
    v_mfma_f32_16x16x32_bf16 v[104:107], v[148:151], a[184:187], v[104:107]
    v_cndmask_b32 v62, v62, 0, s[82:83]
    v_cndmask_b32 v63, v63, 0, s[82:83]
    v_mfma_f32_16x16x32_bf16 v[104:107], v[152:155], a[208:211], v[104:107]
    v_mfma_f32_16x16x32_bf16 v[104:107], v[156:159], a[232:235], v[104:107]
    v_mfma_f32_16x16x32_bf16 v[72:75], v[56:59], v[64:67], 0
    v_mfma_f32_16x16x32_bf16 v[104:107], v[160:163], v[176:179], v[104:107]
    v_mfma_f32_16x16x32_bf16 v[76:79], v[60:63], v[64:67], 0
    v_mfma_f32_16x16x32_bf16 v[104:107], v[164:167], v[200:203], v[104:107]
    ds_read_u16_d16_hi v8, v93 offset:49152
    ds_read_u16_d16_hi v9, v94 offset:49152
    v_mfma_f32_16x16x32_bf16 v[104:107], v[168:171], v[224:227], v[104:107]
    ds_read_u16_d16_hi v10, v92 offset:49152
    v_mfma_f32_16x16x32_bf16 v[104:107], v[172:175], v[248:251], v[104:107]
    v_mfma_f32_16x16x32_bf16 v[108:111], v[120:123], a[20:23], 0
    v_mfma_f32_16x16x32_bf16 v[108:111], v[124:127], a[44:47], v[108:111]
    v_mfma_f32_16x16x32_bf16 v[108:111], v[128:131], a[68:71], v[108:111]
    v_cndmask_b32 v26, v72, v73, s[76:77]
    v_cndmask_b32 v27, v74, v75, s[76:77]
    v_mfma_f32_16x16x32_bf16 v[108:111], v[132:135], a[92:95], v[108:111]
    v_cndmask_b32 v28, v76, v77, s[76:77]
    v_cndmask_b32 v29, v78, v79, s[76:77]
    v_mfma_f32_16x16x32_bf16 v[108:111], v[136:139], a[116:119], v[108:111]
    v_cndmask_b32 v26, v26, v28, s[78:79]
    v_cndmask_b32 v27, v27, v29, s[80:81]
    v_mfma_f32_16x16x32_bf16 v[108:111], v[140:143], a[140:143], v[108:111]
    s_waitcnt lgkmcnt(0)
    v_mul_f32 v26, v26, v8
    v_mfma_f32_16x16x32_bf16 v[108:111], v[144:147], a[164:167], v[108:111]
    v_cvt_pk_bf16_f32 v40, v104, v105
    v_cvt_pk_bf16_f32 v41, v106, v107
    v_mfma_f32_16x16x32_bf16 v[108:111], v[148:151], a[188:191], v[108:111]
    v_mul_f32 v27, v27, v9
    v_mul_f32 v11, s91, v10
    v_mfma_f32_16x16x32_bf16 v[108:111], v[152:155], a[212:215], v[108:111]
    v_max_f32 v28, v26, v27
    v_mov_b32 v29, v28
    v_mfma_f32_16x16x32_bf16 v[108:111], v[156:159], a[236:239], v[108:111]
    v_mfma_f32_16x16x32_bf16 v[108:111], v[160:163], v[180:183], v[108:111]
    v_permlane16_swap_b32 v28, v29
    v_max_f32 v28, v28, v29
    v_mfma_f32_16x16x32_bf16 v[108:111], v[164:167], v[204:207], v[108:111]
    v_mov_b32 v29, v28
    v_mfma_f32_16x16x32_bf16 v[108:111], v[168:171], v[228:231], v[108:111]
    v_mfma_f32_16x16x32_bf16 v[108:111], v[172:175], v[252:255], v[108:111]
    v_permlane32_swap_b32 v28, v29
    v_max_f32 v28, v28, v29
    s_nop 5
    v_cvt_pk_bf16_f32 v50, v108, v109
    v_cvt_pk_bf16_f32 v51, v110, v111
    v_sub_f32 v26, v26, v28
    v_sub_f32 v27, v27, v28
    v_mul_f32 v26, v11, v26
    v_mul_f32 v27, v11, v27
    v_exp_f32 v26, v26
    v_exp_f32 v27, v27
    s_nop 0
    v_add_f32 v28, v26, v27
    v_mov_b32 v29, v28
    s_nop 1
    v_permlane16_swap_b32 v28, v29
    v_add_f32 v28, v28, v29
    v_mov_b32 v29, v28
    s_nop 1
    v_permlane32_swap_b32 v28, v29
    v_add_f32 v28, v28, v29
    v_rcp_f32 v28, v28
    v_mul_f32 v26, v26, v8
    v_mul_f32 v27, v27, v9
    v_mul_f32 v26, v26, v28
    v_mul_f32 v27, v27, v28
    v_cvt_pk_bf16_f32 v26, v26, v26
    v_cvt_pk_bf16_f32 v27, v27, v27
    v_and_b32 v80, v26, v14
    v_and_b32 v81, v27, v15
    v_and_b32 v82, v26, v16
    v_and_b32 v83, v27, v17
    s_nop 1
    v_mfma_f32_16x16x32_bf16 v[72:75], v[38:41], v[80:83], 0
    v_mfma_f32_16x16x32_bf16 v[76:79], v[48:51], v[80:83], 0
    s_add_u32 s53, s74, 114688
    s_nop 5
    v_cvt_pk_bf16_f32 v84, v72, v73
    v_cvt_pk_bf16_f32 v85, v74, v75
    v_cvt_pk_bf16_f32 v86, v76, v77
    v_cvt_pk_bf16_f32 v87, v78, v79
    buffer_store_dwordx4 v[84:87], v23, s[24:27], s53 offen sc1
    v_cndmask_b32 v80, v84, v86, s[88:89]
    v_cndmask_b32 v81, v85, v87, s[88:89]
    ds_write_b64 v95, v[80:81] offset:1792
    v_lshlrev_b32 v6, 4, v0
    v_add_u32 v6, 147456, v6
    v_lshrrev_b32 v7, 4, v1
    v_and_b32 v12, 15, v1
    v_lshlrev_b32 v7, 14, v7
    v_lshl_add_u32 v7, v12, 4, v7
    s_waitcnt lgkmcnt(0)
    s_barrier
    ds_read_b128 v[72:75], v6
    s_waitcnt lgkmcnt(0)
    buffer_store_dwordx4 v[72:75], v7, s[24:27], s95 offen sc1
    s_waitcnt vmcnt(0) lgkmcnt(0)
    s_barrier
    s_cmp_lg_u32 s44, 0
    s_cbranch_scc1 L_nopub22
    s_lshl_b32 s60, s48, 4
    s_add_u32 s60, s60, s49
    s_lshl_b32 s60, s60, 7
    s_add_u32 s60, s60, 12779520
    v_mov_b32 v30, s47
    s_mov_b64 exec, 1
    buffer_store_dword v30, off, s[24:27], s60 sc1
    s_mov_b64 exec, -1
L_nopub22:
    s_endpgm
L_codeend:
.section .rodata,"a"
.p2align 6
.amdhsa_kernel parallel_sum__sliding_local_dilated__mixer_token_mlp__prompt_kernel
  .amdhsa_next_free_vgpr 512
  .amdhsa_next_free_sgpr 102
  .amdhsa_accum_offset 256
  .amdhsa_group_segment_fixed_size 0
  .amdhsa_kernarg_size 88
  .amdhsa_user_sgpr_count 2
  .amdhsa_user_sgpr_kernarg_segment_ptr 1
  .amdhsa_system_sgpr_workgroup_id_x 1
  .amdhsa_float_denorm_mode_32 3
.end_amdhsa_kernel
```

```asm
; @launch grid=(256,1,1) block=(256,1,1) lds=163840
.amdgcn_target "amdgcn-amd-amdhsa--gfx950"
.text
.globl parallel_sum__sliding_local_dilated__mixer_token_mlp__prompt_kernel
.p2align 8
.type parallel_sum__sliding_local_dilated__mixer_token_mlp__prompt_kernel,@function
parallel_sum__sliding_local_dilated__mixer_token_mlp__prompt_kernel:
    s_cmp_ge_u32 s2, 256
    s_cbranch_scc1 L_end
    s_load_dwordx2 s[4:5], s[0:1], 0
    s_load_dwordx16 s[76:91], s[0:1], 0
    s_load_dwordx4 s[92:95], s[0:1], 64
    s_load_dwordx2 s[24:25], s[0:1], 80
    s_lshr_b32 s46, s2, 3
    s_getpc_b64 s[98:99]
L_pc:
    s_mul_i32 s53, s46, 1536
    v_lshrrev_b32 v26, 4, v0
    v_min_u32 v26, 11, v26
    v_lshl_add_u32 v26, v26, 7, s53
    v_lshrrev_b32 v25, 5, v0
    v_min_u32 v26, L_codeend-L_pc-4, v26
    v_mov_b32 v29, s99
    v_add_co_u32 v28, vcc, s98, v26
    s_nop 1
    v_addc_co_u32 v29, vcc, 0, v29, vcc
    global_load_dword v108, v[28:29], off
    v_and_b32 v26, 31, v0
    v_mul_u32_u24 v24, 896, v25
    v_lshl_add_u32 v24, v26, 4, v24
    s_mul_i32 s53, s2, 7168
    v_add_u32 v24, s53, v24
    v_cmp_gt_u32 vcc, 24, v26
    v_mov_b32 v27, 2130706432
    s_mov_b32 s6, 1835008
    s_mov_b32 s7, 0x20000
    v_cndmask_b32 v22, v27, v24, vcc
    v_lshrrev_b32 v27, 6, v0
    v_and_b32 v1, 63, v0
    s_waitcnt lgkmcnt(0)
    buffer_load_dwordx4 v[32:35], v24, s[4:7], 0 offen
    buffer_load_dwordx4 v[36:39], v22, s[4:7], 0 offen offset:512
    v_readfirstlane_b32 s44, v27
    s_and_b32 s45, s2, 7
    s_mov_b64 s[8:9], s[78:79]
    s_mov_b32 s10, 1204224
    s_mov_b32 s11, s7
    s_and_b32 s53, s45, 6
    s_lshr_b32 s53, 0xc9, s53
    s_and_b32 s53, s53, 3
    s_add_u32 s54, s53, 1
    s_bfe_u32 s54, s54, 0x10001
    s_add_u32 s54, s54, 1
    s_mul_i32 s53, s53, 224
    s_andn2_b32 s53, s53, 127
    s_sub_u32 s55, s46, 3
    s_cmp_lt_u32 s46, 24
    s_cselect_b32 s55, 63, s55
    s_cmp_lt_u32 s46, 21
    s_cselect_b32 s55, s46, s55
    s_mul_i32 s55, s55, 43008
    s_add_u32 s53, s53, s55
    v_and_b32 v27, 3, v0
    v_min_u32 v27, s54, v27
    v_bfe_u32 v28, v0, 2, 2
    v_min_u32 v28, 2, v28
    v_mul_u32_u24 v28, 7, v28
    v_add_u32 v27, v27, v28
    v_lshrrev_b32 v28, 4, v0
    v_min_u32 v28, 15, v28
    v_mul_u32_u24 v28, 21, v28
    v_add_lshl_u32 v27, v27, v28, 7
    buffer_load_dword v108, v27, s[8:11], s53 offen
    s_mov_b64 s[40:41], s[94:95]
    s_mov_b32 s42, 256
    s_mov_b32 s43, s7
    s_or_b32 s53, s2, s44
    s_cbranch_scc1 L_nononce
    s_memrealtime s[98:99]
    s_waitcnt lgkmcnt(0)
    s_or_b32 s98, s98, 1
    v_mov_b32 v28, s98
    s_mov_b64 exec, 1
    buffer_store_dword v28, off, s[40:43], 0 sc1
    s_mov_b64 exec, -1
L_nononce:
    s_mov_b64 s[16:17], s[84:85]
    s_mov_b32 s18, 7340032
    s_mov_b32 s19, s7
    s_mov_b32 s26, 16777216
    s_mov_b32 s27, s7
    s_mov_b64 s[20:21], s[88:89]
    s_mov_b32 s22, 7340032
    s_mov_b32 s23, s7
    s_mov_b64 s[12:13], s[80:81]
    s_mov_b32 s14, 401408
    s_mov_b32 s15, s7
    s_mov_b64 s[28:29], s[92:93]
    s_mov_b32 s30, 1835008
    s_mov_b32 s31, s7
    s_mov_b64 s[32:33], s[86:87]
    s_mov_b32 s34, 3584
    s_mov_b32 s35, s7
    s_mov_b64 s[36:37], s[90:91]
    s_mov_b32 s38, 4096
    s_mov_b32 s39, s7
    s_lshl_b32 s52, s44, 12
    v_lshlrev_b32 v23, 4, v1
    s_cmp_ge_u32 s46, 24
    s_cbranch_scc1 L_role_a
    v_lshrrev_b32 v208, 4, v1
    v_bfe_u32 v209, v1, 2, 2
    v_and_b32 v210, 3, v1
    v_and_b32 v211, 15, v1
    v_lshrrev_b32 v212, 5, v1
    s_mul_i32 s55, s45, 3
    s_max_u32 s55, s55, 1
    s_add_u32 s55, s55, s46
    s_sub_u32 s55, s55, 1
    s_sub_u32 s56, s55, 21
    s_min_u32 s55, s55, s56
    s_and_b32 s54, s45, 1
    s_mul_i32 s54, s54, 24
    s_sub_u32 s54, s46, s54
    s_cmp_ge_u32 s46, 21
    s_cselect_b32 s54, s54, s55
    s_mul_i32 s53, s45, 21
    s_add_u32 s53, s53, s54
    s_mul_i32 s50, s53, 171
    s_lshr_b32 s50, s50, 10
    s_mul_i32 s54, s50, 6
    s_sub_u32 s88, s53, s54
    s_mul_i32 s51, s50, 2
    s_add_u32 s51, s51, s88
    s_mul_i32 s54, s51, 43
    s_lshr_b32 s54, s54, 8
    s_mul_i32 s54, s54, 6
    s_sub_u32 s51, s51, s54
    s_mul_i32 s65, s51, 13
    s_add_u32 s65, s65, 2
    s_mul_i32 s65, s65, 171
    s_lshr_b32 s65, s65, 10
    v_lshl_add_u32 v213, v212, 2, v209
    v_and_b32 v215, 1, v208
    v_lshlrev_b32 v214, 4, v210
    v_lshl_add_u32 v214, v215, 6, v214
    s_mul_i32 s53, s44, 1835008
    s_lshl_b32 s54, s50, 7
    s_add_u32 s53, s53, s54
    v_mul_u32_u24 v10, 3584, v213
    v_add3_u32 v10, v10, v214, s53
    v_xor_b32 v11, 32, v10
    s_cmp_ge_u32 s46, 21
    s_cbranch_scc1 L_help
    s_add_u32 m0, s52, 49152
    s_add_u32 s57, s65, 0
    s_sub_u32 s3, s57, 13
    s_min_u32 s57, s57, s3
    s_mul_i32 s57, s57, 114688
    buffer_load_dwordx4 v10, s[16:19], s57 offen offset:0 lds
    s_add_u32 s57, s57, 27648
    buffer_load_dwordx4 v11, s[16:19], s57 offen offset:1024 lds
    v_mul_u32_u24 v109, 1088, v25
    v_lshl_add_u32 v109, v26, 4, v109
    v_mul_u32_u24 v110, 1088, v209
    v_lshl_add_u32 v110, v208, 5, v110
    v_lshl_add_u32 v110, v210, 3, v110
    s_lshl_b32 s53, s44, 7
    v_add_u32 v110, s53, v110
    v_mul_u32_u24 v111, 66816, v208
    v_lshl_add_u32 v111, v211, 4, v111
    s_mul_i32 s63, s44, 267264
    s_lshl_b32 s53, s2, 8
    s_add_u32 s63, s63, s53
    s_add_u32 s64, s63, 1069056
    v_cmp_gt_u32 vcc, 208, v0
    v_mov_b32 v100, 2130706432
    v_cmp_le_u32 s[92:93], 24, v26
    v_cndmask_b32 v22, v100, v111, vcc
    s_mov_b32 s62, 0x3f803f80
    s_mov_b32 s61, 0xffff0000
    v_mov_b32 v96, 0
    v_mov_b32 v97, 0
    v_lshlrev_b32 v216, 6, v209
    v_lshl_add_u32 v216, v210, 3, v216
    v_lshl_add_u32 v216, v215, 5, v216
    s_add_u32 s53, s52, 49152
    v_lshl_add_u32 v2, v208, 10, v216
    v_add_u32 v2, s53, v2
    v_xor_b32 v3, 32, v2
    v_add_u32 v4, 65536, v2
    v_add_u32 v5, 65536, v3
    v_lshl_add_u32 v6, v208, 9, v216
    v_add_u32 v6, s53, v6
    v_xor_b32 v7, 32, v6
    v_add_u32 v8, 65536, v6
    v_add_u32 v9, 65536, v7
    s_waitcnt vmcnt(4)
    v_dot2c_f32_bf16 v96, s62, v32
    v_dot2c_f32_bf16 v97, v32, v32
    v_lshlrev_b32 v40, 16, v32
    v_and_b32 v41, s61, v32
    v_dot2c_f32_bf16 v96, s62, v33
    v_dot2c_f32_bf16 v97, v33, v33
    v_lshlrev_b32 v42, 16, v33
    v_and_b32 v43, s61, v33
    v_dot2c_f32_bf16 v96, s62, v34
    v_dot2c_f32_bf16 v97, v34, v34
    v_lshlrev_b32 v44, 16, v34
    v_and_b32 v45, s61, v34
    v_dot2c_f32_bf16 v96, s62, v35
    v_dot2c_f32_bf16 v97, v35, v35
    v_lshlrev_b32 v46, 16, v35
    v_and_b32 v47, s61, v35
    s_waitcnt vmcnt(3)
    v_dot2c_f32_bf16 v96, s62, v36
    v_dot2c_f32_bf16 v97, v36, v36
    v_lshlrev_b32 v48, 16, v36
    v_and_b32 v49, s61, v36
    v_dot2c_f32_bf16 v96, s62, v37
    v_dot2c_f32_bf16 v97, v37, v37
    v_lshlrev_b32 v50, 16, v37
    v_and_b32 v51, s61, v37
    v_dot2c_f32_bf16 v96, s62, v38
    v_dot2c_f32_bf16 v97, v38, v38
    v_lshlrev_b32 v52, 16, v38
    v_and_b32 v53, s61, v38
    v_dot2c_f32_bf16 v96, s62, v39
    v_dot2c_f32_bf16 v97, v39, v39
    v_lshlrev_b32 v54, 16, v39
    v_and_b32 v55, s61, v39
    buffer_load_dword v29, off, s[40:43], 0 sc1
    v_add_f32_dpp v96, v96, v96 quad_perm:[1,0,3,2] row_mask:0xf bank_mask:0xf
    v_add_f32_dpp v97, v97, v97 quad_perm:[1,0,3,2] row_mask:0xf bank_mask:0xf
    s_nop 0
    v_add_f32_dpp v96, v96, v96 quad_perm:[2,3,0,1] row_mask:0xf bank_mask:0xf
    v_add_f32_dpp v97, v97, v97 quad_perm:[2,3,0,1] row_mask:0xf bank_mask:0xf
    s_nop 0
    v_add_f32_dpp v96, v96, v96 row_half_mirror row_mask:0xf bank_mask:0xf
    v_add_f32_dpp v97, v97, v97 row_half_mirror row_mask:0xf bank_mask:0xf
    s_nop 0
    v_add_f32_dpp v96, v96, v96 row_mirror row_mask:0xf bank_mask:0xf
    v_add_f32_dpp v97, v97, v97 row_mirror row_mask:0xf bank_mask:0xf
    v_mov_b32 v98, v96
    v_mov_b32 v99, v97
    s_nop 0
    v_permlane16_swap_b32 v96, v98
    v_permlane16_swap_b32 v97, v99
    v_add_f32 v96, v96, v98
    v_add_f32 v97, v97, v99
    v_mul_f32 v98, 0x3b124925, v96
    v_mul_f32 v99, 0x3b124925, v97
    v_fma_f32 v99, -v98, v98, v99
    v_max_f32 v99, 0, v99
    v_cvt_pk_bf16_f32 v100, 0, v99
    v_add_f32 v100, 0x3727c5ac, v100
    v_cvt_pk_bf16_f32 v100, 0, v100
    v_sqrt_f32 v100, v100
    s_nop 0
    v_cvt_pk_bf16_f32 v100, 0, v100
    v_rcp_f32 v100, v100
    s_nop 0
    v_mul_f32 v99, v99, v100
    v_mul_f32 v99, v99, v100
    v_cvt_pk_bf16_f32 v104, 0, v99
    v_add_f32 v104, 0x3727c5ac, v104
    v_cvt_pk_bf16_f32 v104, 0, v104
    v_sqrt_f32 v104, v104
    s_nop 0
    v_cvt_pk_bf16_f32 v102, 0, v104
    v_rcp_f32 v104, v102
    s_nop 0
    v_mul_f32 v104, v104, v100
    v_mul_f32 v106, v98, v104
    v_pk_fma_f32 v[56:57], v[40:41], v[104:105], v[106:107] op_sel_hi:[1,0,0] neg_lo:[0,0,1] neg_hi:[0,0,1]
    v_pk_fma_f32 v[58:59], v[42:43], v[104:105], v[106:107] op_sel_hi:[1,0,0] neg_lo:[0,0,1] neg_hi:[0,0,1]
    v_pk_fma_f32 v[60:61], v[44:45], v[104:105], v[106:107] op_sel_hi:[1,0,0] neg_lo:[0,0,1] neg_hi:[0,0,1]
    v_pk_fma_f32 v[62:63], v[46:47], v[104:105], v[106:107] op_sel_hi:[1,0,0] neg_lo:[0,0,1] neg_hi:[0,0,1]
    v_pk_fma_f32 v[64:65], v[48:49], v[104:105], v[106:107] op_sel_hi:[1,0,0] neg_lo:[0,0,1] neg_hi:[0,0,1]
    v_pk_fma_f32 v[66:67], v[50:51], v[104:105], v[106:107] op_sel_hi:[1,0,0] neg_lo:[0,0,1] neg_hi:[0,0,1]
    v_pk_fma_f32 v[68:69], v[52:53], v[104:105], v[106:107] op_sel_hi:[1,0,0] neg_lo:[0,0,1] neg_hi:[0,0,1]
    v_pk_fma_f32 v[70:71], v[54:55], v[104:105], v[106:107] op_sel_hi:[1,0,0] neg_lo:[0,0,1] neg_hi:[0,0,1]
    v_cvt_pk_bf16_f32 v80, v56, v57
    v_cvt_pk_bf16_f32 v81, v58, v59
    v_cvt_pk_bf16_f32 v82, v60, v61
    v_cvt_pk_bf16_f32 v83, v62, v63
    v_cvt_pk_bf16_f32 v84, v64, v65
    v_cvt_pk_bf16_f32 v85, v66, v67
    v_cvt_pk_bf16_f32 v86, v68, v69
    v_cvt_pk_bf16_f32 v87, v70, v71
    v_lshrrev_b32 v102, 16, v102
    v_cndmask_b32 v84, v84, v102, s[92:93]
    ds_write_b128 v109, v[80:83] offset:0
    ds_write_b128 v109, v[84:87] offset:512
    s_waitcnt lgkmcnt(0)
    s_barrier
    ds_read_b64_tr_b16 v[88:89], v110 offset:0
    ds_read_b64_tr_b16 v[90:91], v110 offset:4352
    ds_read_b64_tr_b16 v[92:93], v110 offset:512
    ds_read_b64_tr_b16 v[94:95], v110 offset:4864
    s_waitcnt lgkmcnt(2)
    buffer_store_dwordx4 v[88:91], v111, s[24:27], s63 offen sc1
    s_waitcnt lgkmcnt(0)
    buffer_store_dwordx4 v[92:95], v22, s[24:27], s64 offen sc1
    s_add_u32 s57, s57, 27648
    buffer_load_dwordx4 v10, s[16:19], s57 offen offset:2048 lds
    s_add_u32 s57, s57, 27648
    buffer_load_dwordx4 v11, s[16:19], s57 offen offset:3072 lds
    s_add_u32 m0, s52, 65536
    s_add_u32 s57, s65, 1
    s_sub_u32 s3, s57, 13
    s_min_u32 s57, s57, s3
    s_mul_i32 s57, s57, 114688
    buffer_load_dwordx4 v10, s[16:19], s57 offen offset:0 lds
    s_add_u32 s57, s57, 27648
    buffer_load_dwordx4 v11, s[16:19], s57 offen offset:1024 lds
    s_add_u32 s57, s57, 27648
    buffer_load_dwordx4 v10, s[16:19], s57 offen offset:2048 lds
    s_add_u32 s57, s57, 27648
    buffer_load_dwordx4 v11, s[16:19], s57 offen offset:3072 lds
    s_branch L_body
.p2align 12
L_body:
    s_mov_b32 s59, s44
    s_mov_b64 exec, 0
    s_branch L_wb_go
L_wb_ret:
    s_add_u32 s59, s59, 4
L_wb_go:
    s_cmp_eq_u32 s59, 0
    s_cbranch_scc1 L_wb_0
    s_cmp_eq_u32 s59, 1
    s_cbranch_scc1 L_wb_1
    s_cmp_eq_u32 s59, 2
    s_cbranch_scc1 L_wb_2
    s_cmp_eq_u32 s59, 3
    s_cbranch_scc1 L_wb_3
    s_cmp_eq_u32 s59, 4
    s_cbranch_scc1 L_wb_3
    s_cmp_eq_u32 s59, 5
    s_cbranch_scc1 L_wb_3
    s_mov_b64 exec, -1
    s_waitcnt vmcnt(6)
    v_cmp_eq_u32 vcc, 0, v29
    s_nop 0
    s_cbranch_vccz L_ok2
    s_mov_b32 s59, 100000
L_spin1:
    buffer_load_dword v29, off, s[40:43], 0 sc1
    s_waitcnt vmcnt(0)
    v_cmp_eq_u32 vcc, 0, v29
    s_nop 0
    s_cbranch_vccz L_ok2
    s_sub_u32 s59, s59, 1
    s_cbranch_scc0 L_spin1
L_ok2:
    v_readfirstlane_b32 s47, v29
    s_barrier
    s_cmp_lg_u32 s44, 0
    s_cbranch_scc1 L_nopub3
    s_lshl_b32 s60, s2, 5
    s_add_u32 s60, s60, 12582912
    v_mov_b32 v30, s47
    s_mov_b64 exec, 1
    buffer_store_dword v30, off, s[24:27], s60 sc1
    s_mov_b64 exec, -1
L_nopub3:
    s_lshl_b32 s53, s44, 11
    s_add_u32 s53, s53, 12582912
    v_lshl_add_u32 v18, v1, 5, s53
    s_lshl_b32 s53, s50, 7
    s_add_u32 m0, s52, 81920
    s_add_u32 s57, s65, 2
    s_sub_u32 s3, s57, 13
    s_min_u32 s57, s57, s3
    s_mul_i32 s57, s57, 114688
    buffer_load_dwordx4 v10, s[16:19], s57 offen offset:0 lds
    v_lshl_add_u32 v19, v208, 3, s53
    s_lshl2_add_u32 s67, s51, s44
    s_mul_i32 s67, s67, 58624
    s_lshl_b32 s53, s50, 11
    s_add_u32 s57, s57, 27648
    buffer_load_dwordx4 v11, s[16:19], s57 offen offset:1024 lds
    s_add_u32 s67, s67, s53
    s_add_u32 s67, s67, 2097152
    v_mov_b32 v236, 0xbdd2d3e8
    v_mov_b32 v237, 0xc0135761
    s_add_u32 s57, s57, 27648
    buffer_load_dwordx4 v10, s[16:19], s57 offen offset:2048 lds
    s_or_b32 s88, s88, 0
    s_add_u32 s54, s88, 24
    s_mul_i32 s84, s54, 66816
    s_lshl2_add_u32 s84, s52, s84
    s_mul_i32 s83, s54, 58624
    s_add_u32 s83, s83, s53
    s_and_b32 s54, s44, 1
    s_lshl_b32 s54, s54, 10
    s_add_u32 s57, s57, 27648
    buffer_load_dwordx4 v11, s[16:19], s57 offen offset:3072 lds
    s_add_u32 s83, s83, s54
    s_add_u32 s83, s83, 2097152
    s_lshl1_add_u32 s54, s54, 49152
    v_add_u32 v243, s54, v23
    s_add_u32 m0, s52, 98304
    s_add_u32 s57, s65, 3
    s_sub_u32 s3, s57, 13
    s_min_u32 s57, s57, s3
    s_mul_i32 s57, s57, 114688
    buffer_load_dwordx4 v10, s[16:19], s57 offen offset:0 lds
    s_cmp_lt_u32 s88, 4
    s_cselect_b32 s84, s84, 2130706432
    s_cselect_b32 s83, s83, 2130706432
    s_cmp_lt_u32 s44, 2
    s_cselect_b32 s83, s83, 2130706432
    s_cmp_eq_u32 s44, 0
    s_cselect_b32 s85, 1.0, 0
    s_mul_i32 s53, s45, 7
    s_lshr_b32 s53, s53, 1
    s_sub_u32 s53, s50, s53
    s_lshl1_add_u32 s53, s53, s88
    s_sub_u32 s53, s53, 4
    s_mul_i32 s54, s44, 28
    s_add_u32 s54, s54, s53
    s_lshl_b32 s87, s54, 16
    s_lshl_b32 s54, s45, 9
    s_add_u32 s87, s87, s54
    s_cmp_ge_u32 s88, 4
    s_cselect_b32 s87, s87, 2130706432
    v_lshrrev_b32 v254, 2, v1
    v_lshlrev_b32 v254, 12, v254
    v_lshl_add_u32 v254, v210, 7, v254
    s_add_u32 s57, s57, 27648
    buffer_load_dwordx4 v11, s[16:19], s57 offen offset:1024 lds
    s_waitcnt vmcnt(10)
    ds_read_b64_tr_b16 a[0:1], v2 offset:0
    ds_read_b64_tr_b16 a[2:3], v2 offset:512
    ds_read_b64_tr_b16 a[4:5], v3 offset:0
    ds_read_b64_tr_b16 a[6:7], v3 offset:512
    s_add_u32 s57, s57, 27648
    buffer_load_dwordx4 v10, s[16:19], s57 offen offset:2048 lds
    ds_read_b64_tr_b16 a[8:9], v2 offset:256
    ds_read_b64_tr_b16 a[10:11], v2 offset:768
    ds_read_b64_tr_b16 a[12:13], v3 offset:256
    ds_read_b64_tr_b16 a[14:15], v3 offset:768
    s_add_u32 s57, s57, 27648
    buffer_load_dwordx4 v11, s[16:19], s57 offen offset:3072 lds
    s_lshr_b32 s53, s46, 2
    s_and_b32 s89, s46, 3
    s_bfe_u32 s54, s46, 0x20001
    s_and_b32 s55, s46, 1
    s_add_u32 s55, s55, 4
    s_cmp_lt_u32 s46, 16
    s_cselect_b32 s53, s53, s54
    s_cselect_b32 s89, s89, s55
    s_mul_i32 s49, s53, 2
    s_add_u32 s49, s49, s89
    s_sub_u32 s54, s49, 6
    s_min_u32 s49, s49, s54
    s_or_b32 s89, s89, 0
    s_add_u32 m0, s52, 114688
    s_add_u32 s57, s65, 4
    s_sub_u32 s3, s57, 13
    s_min_u32 s57, s57, s3
    s_mul_i32 s57, s57, 114688
    buffer_load_dwordx4 v10, s[16:19], s57 offen offset:0 lds
    s_lshl2_add_u32 s48, s45, s53
    s_mul_i32 s53, s44, 1835008
    s_lshl_b32 s74, s48, 7
    s_add_u32 s53, s53, s74
    s_add_u32 s57, s57, 27648
    buffer_load_dwordx4 v11, s[16:19], s57 offen offset:1024 lds
    s_waitcnt vmcnt(10)
    ds_read_b64_tr_b16 a[16:17], v2 offset:16384
    ds_read_b64_tr_b16 a[18:19], v2 offset:16896
    ds_read_b64_tr_b16 a[20:21], v3 offset:16384
    ds_read_b64_tr_b16 a[22:23], v3 offset:16896
    s_add_u32 s57, s57, 27648
    buffer_load_dwordx4 v10, s[16:19], s57 offen offset:2048 lds
    ds_read_b64_tr_b16 a[24:25], v2 offset:16640
    ds_read_b64_tr_b16 a[26:27], v2 offset:17152
    ds_read_b64_tr_b16 a[28:29], v3 offset:16640
    ds_read_b64_tr_b16 a[30:31], v3 offset:17152
    s_lshl_b32 s56, s44, 5
    v_lshlrev_b32 v217, 5, v212
    v_xor_b32 v217, v217, v214
    v_xor_b32 v217, s56, v217
    s_add_u32 s57, s57, 27648
    buffer_load_dwordx4 v11, s[16:19], s57 offen offset:3072 lds
    s_add_u32 s74, s74, s56
    v_lshlrev_b32 v12, 12, v213
    v_add3_u32 v12, v12, v217, s53
    s_mul_i32 s53, s44, 28672
    s_add_u32 m0, s52, 131072
    s_add_u32 s57, s65, 5
    s_sub_u32 s3, s57, 13
    s_min_u32 s57, s57, s3
    s_mul_i32 s57, s57, 114688
    buffer_load_dwordx4 v10, s[16:19], s57 offen offset:0 lds
    s_lshl_b32 s54, s49, 7
    s_add_u32 s55, s53, s54
    v_mul_u32_u24 v13, 896, v213
    v_add3_u32 v13, v13, v214, s55
    s_add_u32 s57, s57, 27648
    buffer_load_dwordx4 v11, s[16:19], s57 offen offset:1024 lds
    s_waitcnt vmcnt(10)
    ds_read_b64_tr_b16 a[32:33], v2 offset:32768
    ds_read_b64_tr_b16 a[34:35], v2 offset:33280
    ds_read_b64_tr_b16 a[36:37], v3 offset:32768
    ds_read_b64_tr_b16 a[38:39], v3 offset:33280
    v_xor_b32 v14, 32, v13
    s_mul_i32 s55, s44, 21504
    v_subrev_u32 v239, s55, v13
    s_and_b32 s55, s56, 32
    ds_read_b64_tr_b16 a[40:41], v2 offset:33024
    ds_read_b64_tr_b16 a[42:43], v2 offset:33536
    ds_read_b64_tr_b16 a[44:45], v3 offset:33024
    ds_read_b64_tr_b16 a[46:47], v3 offset:33536
    s_add_u32 s57, s57, 27648
    buffer_load_dwordx4 v10, s[16:19], s57 offen offset:2048 lds
    v_xor_b32 v239, s55, v239
    s_mul_i32 s73, s48, 57344
    s_add_u32 s71, s73, s54
    s_mul_i32 s55, s44, 14336
    s_add_u32 s57, s57, 27648
    buffer_load_dwordx4 v11, s[16:19], s57 offen offset:3072 lds
    s_add_u32 s71, s71, s55
    s_add_u32 s72, s71, 7168
    v_bfe_u32 v217, v1, 1, 2
    v_lshl_add_u32 v217, v212, 2, v217
    s_add_u32 m0, s52, 147456
    s_add_u32 s57, s65, 6
    s_sub_u32 s3, s57, 13
    s_min_u32 s57, s57, s3
    s_mul_i32 s57, s57, 114688
    buffer_load_dwordx4 v10, s[16:19], s57 offen offset:0 lds
    v_and_b32 v218, 24, v1
    v_add_u32 v217, v217, v218
    v_mul_u32_u24 v15, 896, v217
    v_and_b32 v217, 1, v1
    v_lshl_add_u32 v15, v217, 4, v15
    v_add_u32 v15, s53, v15
    s_lshl_b32 s54, s89, 5
    s_add_u32 s54, s54, 768
    s_add_u32 s57, s57, 27648
    buffer_load_dwordx4 v11, s[16:19], s57 offen offset:1024 lds
    s_waitcnt vmcnt(10)
    ds_read_b64_tr_b16 a[48:49], v2 offset:49152
    ds_read_b64_tr_b16 a[50:51], v2 offset:49664
    ds_read_b64_tr_b16 a[52:53], v3 offset:49152
    ds_read_b64_tr_b16 a[54:55], v3 offset:49664
    s_add_u32 s57, s57, 27648
    buffer_load_dwordx4 v10, s[16:19], s57 offen offset:2048 lds
    ds_read_b64_tr_b16 a[56:57], v2 offset:49408
    ds_read_b64_tr_b16 a[58:59], v2 offset:49920
    ds_read_b64_tr_b16 a[60:61], v3 offset:49408
    ds_read_b64_tr_b16 a[62:63], v3 offset:49920
    s_add_u32 s57, s57, 27648
    buffer_load_dwordx4 v11, s[16:19], s57 offen offset:3072 lds
    s_add_u32 s68, s89, 24
    s_mul_i32 s68, s68, 58624
    s_mul_i32 s69, s44, 14336
    s_add_u32 s69, s69, 2097152
    s_add_u32 s68, s68, s69
    s_mul_i32 s55, s49, 234496
    s_add_u32 s69, s69, s55
    s_add_u32 s73, s73, s54
    s_waitcnt lgkmcnt(15)
    s_add_u32 m0, s52, 49152
    s_add_u32 s57, s65, 7
    s_sub_u32 s3, s57, 13
    s_min_u32 s57, s57, s3
    s_mul_i32 s57, s57, 114688
    buffer_load_dwordx4 v10, s[16:19], s57 offen offset:0 lds
    s_mov_b32 s76, 0
    s_add_u32 s77, s76, 2048
    s_cmp_eq_u32 s77, 14336
    s_cselect_b32 s77, 0, s77
    s_add_u32 s78, s77, 2048
    s_cmp_eq_u32 s78, 14336
    s_cselect_b32 s78, 0, s78
    s_add_u32 s79, s78, 2048
    s_cmp_eq_u32 s79, 14336
    s_cselect_b32 s79, 0, s79
    s_add_u32 s80, s79, 2048
    s_cmp_eq_u32 s80, 14336
    s_cselect_b32 s80, 0, s80
    s_add_u32 s81, s80, 2048
    s_cmp_eq_u32 s81, 14336
    s_cselect_b32 s81, 0, s81
    s_add_u32 s82, s81, 2048
    s_cmp_eq_u32 s82, 14336
    s_cselect_b32 s82, 0, s82
    s_add_u32 s57, s57, 27648
    buffer_load_dwordx4 v11, s[16:19], s57 offen offset:1024 lds
    s_waitcnt vmcnt(10)
    ds_read_b64_tr_b16 a[64:65], v4 offset:0
    ds_read_b64_tr_b16 a[66:67], v4 offset:512
    ds_read_b64_tr_b16 a[68:69], v5 offset:0
    ds_read_b64_tr_b16 a[70:71], v5 offset:512
    s_add_u32 s57, s57, 27648
    buffer_load_dwordx4 v10, s[16:19], s57 offen offset:2048 lds
    ds_read_b64_tr_b16 a[72:73], v4 offset:256
    ds_read_b64_tr_b16 a[74:75], v4 offset:768
    ds_read_b64_tr_b16 a[76:77], v5 offset:256
    ds_read_b64_tr_b16 a[78:79], v5 offset:768
    s_add_u32 s57, s57, 27648
    buffer_load_dwordx4 v11, s[16:19], s57 offen offset:3072 lds
    s_cmp_lt_u32 s89, 4
    s_cselect_b32 s75, s54, 2130706432
    s_cselect_b32 s68, s68, 2130706432
    s_cselect_b32 s73, s73, 2130706432
    v_lshlrev_b32 v16, 3, v1
    v_add_u32 v16, 81920, v16
    v_and_b32 v217, 7, v1
    v_min_u32 v218, 6, v217
    s_add_u32 m0, s52, 65536
    s_add_u32 s57, s65, 8
    s_sub_u32 s3, s57, 13
    s_min_u32 s57, s57, s3
    s_mul_i32 s57, s57, 114688
    buffer_load_dwordx4 v10, s[16:19], s57 offen offset:0 lds
    s_mul_i32 s54, s44, 7
    v_add_u32 v218, s54, v218
    v_mul_u32_u24 v219, 2, v218
    v_add_u32 v219, s89, v219
    s_add_u32 s57, s57, 27648
    buffer_load_dwordx4 v11, s[16:19], s57 offen offset:1024 lds
    s_waitcnt vmcnt(10)
    ds_read_b64_tr_b16 a[80:81], v4 offset:16384
    ds_read_b64_tr_b16 a[82:83], v4 offset:16896
    ds_read_b64_tr_b16 a[84:85], v5 offset:16384
    ds_read_b64_tr_b16 a[86:87], v5 offset:16896
    s_add_u32 s57, s57, 27648
    buffer_load_dwordx4 v10, s[16:19], s57 offen offset:2048 lds
    ds_read_b64_tr_b16 a[88:89], v4 offset:16640
    ds_read_b64_tr_b16 a[90:91], v4 offset:17152
    ds_read_b64_tr_b16 a[92:93], v5 offset:16640
    ds_read_b64_tr_b16 a[94:95], v5 offset:17152
    v_mul_u32_u24 v220, 43, v219
    v_lshrrev_b32 v220, 8, v220
    v_mul_u32_u24 v220, 6, v220
    v_sub_u32 v219, v219, v220
    s_add_u32 s57, s57, 27648
    buffer_load_dwordx4 v11, s[16:19], s57 offen offset:3072 lds
    v_subrev_u32 v219, s49, v219
    v_bfe_u32 v220, v1, 3, 1
    v_mul_i32_i24 v219, v219, v220
    v_add_u32 v219, s49, v219
    s_waitcnt lgkmcnt(15)
    s_add_u32 m0, s52, 81920
    s_add_u32 s57, s65, 9
    s_sub_u32 s3, s57, 13
    s_min_u32 s57, s57, s3
    s_mul_i32 s57, s57, 114688
    buffer_load_dwordx4 v10, s[16:19], s57 offen offset:0 lds
    v_lshl_add_u32 v218, v219, 5, v218
    v_lshlrev_b32 v20, 7, v218
    v_add_u32 v20, 12713984, v20
    s_lshr_b32 s53, s48, 1
    s_add_u32 s57, s57, 27648
    buffer_load_dwordx4 v11, s[16:19], s57 offen offset:1024 lds
    s_waitcnt vmcnt(10)
    ds_read_b64_tr_b16 a[96:97], v4 offset:32768
    ds_read_b64_tr_b16 a[98:99], v4 offset:33280
    ds_read_b64_tr_b16 a[100:101], v5 offset:32768
    ds_read_b64_tr_b16 a[102:103], v5 offset:33280
    s_lshl_b32 s53, s53, 7
    s_add_u32 s53, s53, 12779520
    v_lshl_add_u32 v21, v210, 11, s53
    s_lshl_b32 s70, s48, 16
    ds_read_b64_tr_b16 a[104:105], v4 offset:33024
    ds_read_b64_tr_b16 a[106:107], v4 offset:33536
    ds_read_b64_tr_b16 a[108:109], v5 offset:33024
    ds_read_b64_tr_b16 a[110:111], v5 offset:33536
    s_add_u32 s57, s57, 27648
    buffer_load_dwordx4 v10, s[16:19], s57 offen offset:2048 lds
    s_lshl2_add_u32 s70, s52, s70
    s_add_u32 s70, s70, 4194304
    v_lshrrev_b32 v218, 3, v1
    v_mul_u32_u24 v22, 896, v218
    s_add_u32 s57, s57, 27648
    buffer_load_dwordx4 v11, s[16:19], s57 offen offset:3072 lds
    v_lshl_add_u32 v22, v217, 4, v22
    v_lshlrev_b32 v25, 1, v211
    s_add_u32 s53, s52, 65536
    v_mul_u32_u24 v244, 176, v218
    buffer_load_dwordx2 v[224:225], v19, s[32:35], 0 offen offset:0
    v_lshl_add_u32 v244, v217, 4, v244
    v_add_u32 v244, s53, v244
    v_mul_u32_u24 v238, 176, v211
    v_lshl_add_u32 v238, v208, 3, v238
    buffer_load_dwordx2 v[226:227], v19, s[32:35], 0 offen offset:32
    s_waitcnt vmcnt(10)
    ds_read_b64_tr_b16 a[112:113], v2 offset:0
    ds_read_b64_tr_b16 a[114:115], v2 offset:512
    ds_read_b64_tr_b16 a[116:117], v3 offset:0
    ds_read_b64_tr_b16 a[118:119], v3 offset:512
    buffer_load_dwordx2 v[228:229], v19, s[32:35], 0 offen offset:64
    ds_read_b64_tr_b16 a[120:121], v2 offset:256
    ds_read_b64_tr_b16 a[122:123], v2 offset:768
    ds_read_b64_tr_b16 a[124:125], v3 offset:256
    ds_read_b64_tr_b16 a[126:127], v3 offset:768
    buffer_load_dwordx2 v[230:231], v19, s[32:35], 0 offen offset:96
    v_add_u32 v238, s53, v238
    v_lshrrev_b32 v218, 2, v0
    v_mul_u32_u24 v26, 896, v218
    v_lshl_add_u32 v26, v210, 3, v26
    s_add_u32 m0, s52, 98304
    s_add_u32 s57, s65, 10
    s_sub_u32 s3, s57, 13
    s_min_u32 s57, s57, s3
    s_mul_i32 s57, s57, 114688
    buffer_load_dwordx4 v10, s[16:19], s57 offen offset:0 lds
    v_lshrrev_b32 v218, 2, v1
    v_mul_u32_u24 v252, 176, v218
    v_lshl_add_u32 v252, v210, 3, v252
    v_add_u32 v252, s53, v252
    s_sub_u32 s53, 49152, s52
    v_add_u32 v246, s53, v2
    v_add_u32 v247, s53, v3
    v_mul_u32_u24 v218, 3072, v208
    s_add_u32 s57, s57, 27648
    buffer_load_dwordx4 v11, s[16:19], s57 offen offset:1024 lds
    s_waitcnt vmcnt(10)
    ds_read_b64_tr_b16 a[128:129], v2 offset:16384
    ds_read_b64_tr_b16 a[130:131], v2 offset:16896
    ds_read_b64_tr_b16 a[132:133], v3 offset:16384
    ds_read_b64_tr_b16 a[134:135], v3 offset:16896
    s_add_u32 s57, s57, 27648
    buffer_load_dwordx4 v10, s[16:19], s57 offen offset:2048 lds
    ds_read_b64_tr_b16 a[136:137], v2 offset:16640
    ds_read_b64_tr_b16 a[138:139], v2 offset:17152
    ds_read_b64_tr_b16 a[140:141], v3 offset:16640
    ds_read_b64_tr_b16 a[142:143], v3 offset:17152
    s_add_u32 s57, s57, 27648
    buffer_load_dwordx4 v11, s[16:19], s57 offen offset:3072 lds
    v_add_u32 v248, v218, v246
    v_add_u32 v249, v218, v247
    v_add_u32 v232, s52, v23
    v_xor_b32 v233, 4096, v232
    v_xor_b32 v234, 8192, v232
    v_xor_b32 v235, 12288, v232
    s_waitcnt lgkmcnt(15)
    s_add_u32 m0, s52, 114688
    s_add_u32 s57, s65, 11
    s_sub_u32 s3, s57, 13
    s_min_u32 s57, s57, s3
    s_mul_i32 s57, s57, 114688
    buffer_load_dwordx4 v10, s[16:19], s57 offen offset:0 lds
    s_add_u32 s57, s57, 27648
    buffer_load_dwordx4 v11, s[16:19], s57 offen offset:1024 lds
    s_waitcnt vmcnt(10)
    ds_read_b64_tr_b16 a[144:145], v2 offset:32768
    ds_read_b64_tr_b16 a[146:147], v2 offset:33280
    ds_read_b64_tr_b16 a[148:149], v3 offset:32768
    ds_read_b64_tr_b16 a[150:151], v3 offset:33280
    s_add_u32 s57, s57, 27648
    buffer_load_dwordx4 v10, s[16:19], s57 offen offset:2048 lds
    ds_read_b64_tr_b16 a[152:153], v2 offset:33024
    ds_read_b64_tr_b16 a[154:155], v2 offset:33536
    ds_read_b64_tr_b16 a[156:157], v3 offset:33024
    ds_read_b64_tr_b16 a[158:159], v3 offset:33536
    s_add_u32 s57, s57, 27648
    buffer_load_dwordx4 v11, s[16:19], s57 offen offset:3072 lds
    s_add_u32 m0, s52, 131072
    s_add_u32 s57, s65, 12
    s_sub_u32 s3, s57, 13
    s_min_u32 s57, s57, s3
    s_mul_i32 s57, s57, 114688
    buffer_load_dwordx4 v10, s[16:19], s57 offen offset:0 lds
    s_add_u32 s57, s57, 27648
    buffer_load_dwordx4 v11, s[16:19], s57 offen offset:1024 lds
    s_add_u32 s57, s57, 27648
    buffer_load_dwordx4 v10, s[16:19], s57 offen offset:2048 lds
    s_waitcnt vmcnt(11)
    v_lshlrev_b32 v32, 16, v224
    v_and_b32 v33, s61, v224
    v_lshlrev_b32 v34, 16, v225
    v_and_b32 v35, s61, v225
    v_lshlrev_b32 v36, 16, v226
    v_and_b32 v37, s61, v226
    v_lshlrev_b32 v38, 16, v227
    v_and_b32 v39, s61, v227
    s_add_u32 s57, s57, 27648
    buffer_load_dwordx4 v11, s[16:19], s57 offen offset:3072 lds
    v_lshlrev_b32 v40, 16, v228
    v_and_b32 v41, s61, v228
    v_lshlrev_b32 v42, 16, v229
    v_and_b32 v43, s61, v229
    buffer_load_dword v17, v18, s[24:27], 0 offen sc1
    v_lshlrev_b32 v44, 16, v230
    v_and_b32 v45, s61, v230
    v_lshlrev_b32 v46, 16, v231
    v_and_b32 v47, s61, v231
    v_mul_f32 v96, s85, v32
    v_mul_f32 v97, s85, v33
    v_mul_f32 v98, s85, v34
    v_mul_f32 v99, s85, v35
    s_add_u32 m0, s52, 147456
    s_mov_b32 s57, 1490944
    buffer_load_dwordx4 v10, s[16:19], s57 offen offset:0 lds
    s_waitcnt vmcnt(10)
    ds_read_b64_tr_b16 a[160:161], v2 offset:49152
    ds_read_b64_tr_b16 a[162:163], v2 offset:49664
    ds_read_b64_tr_b16 a[164:165], v3 offset:49152
    ds_read_b64_tr_b16 a[166:167], v3 offset:49664
    v_mul_f32 v100, s85, v36
    v_mul_f32 v101, s85, v37
    v_mul_f32 v102, s85, v38
    v_mul_f32 v103, s85, v39
    ds_read_b64_tr_b16 a[168:169], v2 offset:49408
    ds_read_b64_tr_b16 a[170:171], v2 offset:49920
    ds_read_b64_tr_b16 a[172:173], v3 offset:49408
    ds_read_b64_tr_b16 a[174:175], v3 offset:49920
    s_add_u32 s57, s57, 27648
    buffer_load_dwordx4 v11, s[16:19], s57 offen offset:1024 lds
    v_mul_f32 v104, s85, v40
    v_mul_f32 v105, s85, v41
    v_mul_f32 v106, s85, v42
    v_mul_f32 v107, s85, v43
    s_add_u32 s57, s57, 27648
    buffer_load_dwordx4 v10, s[16:19], s57 offen offset:2048 lds
    v_mul_f32 v108, s85, v44
    v_mul_f32 v109, s85, v45
    v_mul_f32 v110, s85, v46
    v_mul_f32 v111, s85, v47
    s_add_u32 s57, s57, 27648
    buffer_load_dwordx4 v11, s[16:19], s57 offen offset:3072 lds
    s_waitcnt lgkmcnt(15)
    s_add_u32 m0, s52, 49152
    s_mov_b32 s57, 1605632
    buffer_load_dwordx4 v10, s[16:19], s57 offen offset:0 lds
    s_waitcnt vmcnt(10)
    ds_read_b64_tr_b16 a[176:177], v4 offset:0
    ds_read_b64_tr_b16 a[178:179], v4 offset:512
    ds_read_b64_tr_b16 a[180:181], v5 offset:0
    ds_read_b64_tr_b16 a[182:183], v5 offset:512
    s_add_u32 s57, s57, 27648
    buffer_load_dwordx4 v11, s[16:19], s57 offen offset:1024 lds
    ds_read_b64_tr_b16 a[184:185], v4 offset:256
    ds_read_b64_tr_b16 a[186:187], v4 offset:768
    ds_read_b64_tr_b16 a[188:189], v5 offset:256
    ds_read_b64_tr_b16 a[190:191], v5 offset:768
    s_add_u32 s57, s57, 27648
    buffer_load_dwordx4 v10, s[16:19], s57 offen offset:2048 lds
    s_add_u32 s57, s57, 27648
    buffer_load_dwordx4 v11, s[16:19], s57 offen offset:3072 lds
    s_add_u32 m0, s52, 65536
    s_mov_b32 s57, 1720320
    buffer_load_dwordx4 v10, s[16:19], s57 offen offset:0 lds
    s_waitcnt vmcnt(10)
    ds_read_b64_tr_b16 a[192:193], v4 offset:16384
    ds_read_b64_tr_b16 a[194:195], v4 offset:16896
    ds_read_b64_tr_b16 a[196:197], v5 offset:16384
    ds_read_b64_tr_b16 a[198:199], v5 offset:16896
    s_add_u32 s57, s57, 27648
    buffer_load_dwordx4 v11, s[16:19], s57 offen offset:1024 lds
    ds_read_b64_tr_b16 a[200:201], v4 offset:16640
    ds_read_b64_tr_b16 a[202:203], v4 offset:17152
    ds_read_b64_tr_b16 a[204:205], v5 offset:16640
    ds_read_b64_tr_b16 a[206:207], v5 offset:17152
    s_add_u32 s57, s57, 27648
    buffer_load_dwordx4 v10, s[16:19], s57 offen offset:2048 lds
    s_waitcnt vmcnt(11)
    v_cmp_ne_u32 vcc, s47, v17
    s_nop 0
    s_cbranch_vccz L_ok5
    s_mov_b32 s59, 100000
L_spin4:
    buffer_load_dword v17, v18, s[24:27], 0 offen sc1
    s_waitcnt vmcnt(0)
    v_cmp_ne_u32 vcc, s47, v17
    s_nop 0
    s_cbranch_vccz L_ok5
    s_sub_u32 s59, s59, 1
    s_cbranch_scc0 L_spin4
L_ok5:
    s_cmp_ge_u32 s88, 4
    s_cbranch_scc1 L_p2_alt
    s_add_u32 s57, s57, 27648
    buffer_load_dwordx4 v11, s[16:19], s57 offen offset:3072 lds
    s_mov_b32 s66, s84
    s_lshl_b32 s86, s65, 10
    s_add_u32 s58, s86, s66
    s_add_u32 s86, s66, 13312
    buffer_load_dwordx4 v[112:115], v23, s[24:27], s58 offen offset:0 sc1
    s_add_u32 s58, s58, 1024
    s_cmp_eq_u32 s58, s86
    s_cselect_b32 s58, s66, s58
    buffer_load_dwordx4 v[116:119], v23, s[24:27], s58 offen offset:0 sc1
    s_waitcnt vmcnt(10)
    ds_read_b64_tr_b16 a[208:209], v4 offset:32768
    ds_read_b64_tr_b16 a[210:211], v4 offset:33280
    ds_read_b64_tr_b16 a[212:213], v5 offset:32768
    ds_read_b64_tr_b16 a[214:215], v5 offset:33280
    s_add_u32 s58, s58, 1024
    s_cmp_eq_u32 s58, s86
    s_cselect_b32 s58, s66, s58
    buffer_load_dwordx4 v[120:123], v23, s[24:27], s58 offen offset:0 sc1
    ds_read_b64_tr_b16 a[216:217], v4 offset:33024
    ds_read_b64_tr_b16 a[218:219], v4 offset:33536
    ds_read_b64_tr_b16 a[220:221], v5 offset:33024
    ds_read_b64_tr_b16 a[222:223], v5 offset:33536
    s_add_u32 s58, s58, 1024
    s_cmp_eq_u32 s58, s86
    s_cselect_b32 s58, s66, s58
    buffer_load_dwordx4 v[124:127], v23, s[24:27], s58 offen offset:0 sc1
    s_add_u32 s58, s58, 1024
    s_cmp_eq_u32 s58, s86
    s_cselect_b32 s58, s66, s58
    buffer_load_dwordx4 v[128:131], v23, s[24:27], s58 offen offset:0 sc1
    s_add_u32 s58, s58, 1024
    s_cmp_eq_u32 s58, s86
    s_cselect_b32 s58, s66, s58
    buffer_load_dwordx4 v[132:135], v23, s[24:27], s58 offen offset:0 sc1
    s_waitcnt vmcnt(10)
    ds_read_b64_tr_b16 a[224:225], v2 offset:0
    ds_read_b64_tr_b16 a[226:227], v2 offset:512
    ds_read_b64_tr_b16 a[228:229], v3 offset:0
    ds_read_b64_tr_b16 a[230:231], v3 offset:512
    s_add_u32 s58, s58, 1024
    s_cmp_eq_u32 s58, s86
    s_cselect_b32 s58, s66, s58
    buffer_load_dwordx4 v[136:139], v23, s[24:27], s58 offen offset:0 sc1
    ds_read_b64_tr_b16 a[232:233], v2 offset:256
    ds_read_b64_tr_b16 a[234:235], v2 offset:768
    ds_read_b64_tr_b16 a[236:237], v3 offset:256
    ds_read_b64_tr_b16 a[238:239], v3 offset:768
    s_add_u32 s58, s58, 1024
    s_cmp_eq_u32 s58, s86
    s_cselect_b32 s58, s66, s58
    buffer_load_dwordx4 v[140:143], v23, s[24:27], s58 offen offset:0 sc1
    s_add_u32 s58, s58, 1024
    s_cmp_eq_u32 s58, s86
    s_cselect_b32 s58, s66, s58
    buffer_load_dwordx4 v[144:147], v23, s[24:27], s58 offen offset:0 sc1
    s_add_u32 s58, s58, 1024
    s_cmp_eq_u32 s58, s86
    s_cselect_b32 s58, s66, s58
    buffer_load_dwordx4 v[148:151], v23, s[24:27], s58 offen offset:0 sc1
    s_waitcnt vmcnt(10)
    ds_read_b64_tr_b16 a[240:241], v2 offset:16384
    ds_read_b64_tr_b16 a[242:243], v2 offset:16896
    ds_read_b64_tr_b16 a[244:245], v3 offset:16384
    ds_read_b64_tr_b16 a[246:247], v3 offset:16896
    s_add_u32 s58, s58, 1024
    s_cmp_eq_u32 s58, s86
    s_cselect_b32 s58, s66, s58
    buffer_load_dwordx4 v[152:155], v23, s[24:27], s58 offen offset:0 sc1
    ds_read_b64_tr_b16 a[248:249], v2 offset:16640
    ds_read_b64_tr_b16 a[250:251], v2 offset:17152
    ds_read_b64_tr_b16 a[252:253], v3 offset:16640
    ds_read_b64_tr_b16 a[254:255], v3 offset:17152
    s_waitcnt vmcnt(10)
    v_mfma_f32_16x16x32_bf16 v[96:99], a[0:3], v[112:115], v[96:99]
    s_add_u32 s58, s58, 1024
    s_cmp_eq_u32 s58, s86
    s_cselect_b32 s58, s66, s58
    v_mfma_f32_16x16x32_bf16 v[100:103], a[4:7], v[112:115], v[100:103]
    buffer_load_dwordx4 v[156:159], v23, s[24:27], s58 offen offset:0 sc1
    v_mfma_f32_16x16x32_bf16 v[104:107], a[8:11], v[112:115], v[104:107]
    v_mfma_f32_16x16x32_bf16 v[108:111], a[12:15], v[112:115], v[108:111]
    s_waitcnt vmcnt(10)
    v_mfma_f32_16x16x32_bf16 v[96:99], a[16:19], v[116:119], v[96:99]
    s_add_u32 s58, s58, 1024
    s_cmp_eq_u32 s58, s86
    s_cselect_b32 s58, s66, s58
    v_mfma_f32_16x16x32_bf16 v[100:103], a[20:23], v[116:119], v[100:103]
    buffer_load_dwordx4 v[112:115], v23, s[24:27], s58 offen offset:0 sc1
    v_mfma_f32_16x16x32_bf16 v[104:107], a[24:27], v[116:119], v[104:107]
    v_mfma_f32_16x16x32_bf16 v[108:111], a[28:31], v[116:119], v[108:111]
    s_waitcnt vmcnt(10)
    v_mfma_f32_16x16x32_bf16 v[96:99], a[32:35], v[120:123], v[96:99]
    s_add_u32 s58, s66, 13312
    v_mfma_f32_16x16x32_bf16 v[100:103], a[36:39], v[120:123], v[100:103]
    buffer_load_dwordx4 v[116:119], v23, s[24:27], s58 offen offset:0 sc1
    v_mfma_f32_16x16x32_bf16 v[104:107], a[40:43], v[120:123], v[104:107]
L_wb_0:
    s_cbranch_execz L_wb_ret
    v_mfma_f32_16x16x32_bf16 v[108:111], a[44:47], v[120:123], v[108:111]
    s_waitcnt vmcnt(10)
    v_mfma_f32_16x16x32_bf16 v[96:99], a[48:51], v[124:127], v[96:99]
    s_add_u32 s58, s66, 14336
    v_mfma_f32_16x16x32_bf16 v[100:103], a[52:55], v[124:127], v[100:103]
    buffer_load_dwordx4 v[120:123], v23, s[24:27], s58 offen offset:0 sc1
    v_mfma_f32_16x16x32_bf16 v[104:107], a[56:59], v[124:127], v[104:107]
    v_mfma_f32_16x16x32_bf16 v[108:111], a[60:63], v[124:127], v[108:111]
    s_waitcnt vmcnt(10)
    v_mfma_f32_16x16x32_bf16 v[96:99], a[64:67], v[128:131], v[96:99]
    s_add_u32 s58, s66, 15360
    v_mfma_f32_16x16x32_bf16 v[100:103], a[68:71], v[128:131], v[100:103]
    buffer_load_dwordx4 v[124:127], v23, s[24:27], s58 offen offset:0 sc1
    v_mfma_f32_16x16x32_bf16 v[104:107], a[72:75], v[128:131], v[104:107]
    v_mfma_f32_16x16x32_bf16 v[108:111], a[76:79], v[128:131], v[108:111]
    s_waitcnt vmcnt(10)
    v_mfma_f32_16x16x32_bf16 v[96:99], a[80:83], v[132:135], v[96:99]
    s_xor_b32 s66, s44, 3
    s_lshl2_add_u32 s66, s51, s66
    s_mul_i32 s66, s66, 66816
    s_lshl2_add_u32 s66, s52, s66
    s_lshl_b32 s86, s65, 10
    s_add_u32 s58, s86, s66
    s_add_u32 s86, s66, 13312
    v_mfma_f32_16x16x32_bf16 v[100:103], a[84:87], v[132:135], v[100:103]
    buffer_load_dwordx4 v[128:131], v23, s[24:27], s58 offen offset:0 sc1
    v_mfma_f32_16x16x32_bf16 v[104:107], a[88:91], v[132:135], v[104:107]
    v_mfma_f32_16x16x32_bf16 v[108:111], a[92:95], v[132:135], v[108:111]
    s_waitcnt vmcnt(10)
    v_mfma_f32_16x16x32_bf16 v[96:99], a[96:99], v[136:139], v[96:99]
    s_add_u32 s58, s58, 1024
    s_cmp_eq_u32 s58, s86
    s_cselect_b32 s58, s66, s58
    v_mfma_f32_16x16x32_bf16 v[100:103], a[100:103], v[136:139], v[100:103]
    buffer_load_dwordx4 v[132:135], v23, s[24:27], s58 offen offset:0 sc1
    v_mfma_f32_16x16x32_bf16 v[104:107], a[104:107], v[136:139], v[104:107]
    v_mfma_f32_16x16x32_bf16 v[108:111], a[108:111], v[136:139], v[108:111]
    s_waitcnt vmcnt(10)
    v_mfma_f32_16x16x32_bf16 v[96:99], a[112:115], v[140:143], v[96:99]
    s_add_u32 s58, s58, 1024
    s_cmp_eq_u32 s58, s86
    s_cselect_b32 s58, s66, s58
    v_mfma_f32_16x16x32_bf16 v[100:103], a[116:119], v[140:143], v[100:103]
    buffer_load_dwordx4 v[136:139], v23, s[24:27], s58 offen offset:0 sc1
    v_mfma_f32_16x16x32_bf16 v[104:107], a[120:123], v[140:143], v[104:107]
    v_mfma_f32_16x16x32_bf16 v[108:111], a[124:127], v[140:143], v[108:111]
    s_waitcnt vmcnt(10)
    v_mfma_f32_16x16x32_bf16 v[96:99], a[128:131], v[144:147], v[96:99]
    s_add_u32 s58, s58, 1024
    s_cmp_eq_u32 s58, s86
    s_cselect_b32 s58, s66, s58
    v_mfma_f32_16x16x32_bf16 v[100:103], a[132:135], v[144:147], v[100:103]
    buffer_load_dwordx4 v[140:143], v23, s[24:27], s58 offen offset:0 sc1
    v_mfma_f32_16x16x32_bf16 v[104:107], a[136:139], v[144:147], v[104:107]
    v_mfma_f32_16x16x32_bf16 v[108:111], a[140:143], v[144:147], v[108:111]
    s_waitcnt vmcnt(10)
    s_waitcnt lgkmcnt(15)
    v_mfma_f32_16x16x32_bf16 v[96:99], a[144:147], v[148:151], v[96:99]
    s_add_u32 s58, s58, 1024
    s_cmp_eq_u32 s58, s86
    s_cselect_b32 s58, s66, s58
    v_mfma_f32_16x16x32_bf16 v[100:103], a[148:151], v[148:151], v[100:103]
    buffer_load_dwordx4 v[144:147], v23, s[24:27], s58 offen offset:0 sc1
    v_mfma_f32_16x16x32_bf16 v[104:107], a[152:155], v[148:151], v[104:107]
    v_mfma_f32_16x16x32_bf16 v[108:111], a[156:159], v[148:151], v[108:111]
    s_waitcnt vmcnt(10)
    v_mfma_f32_16x16x32_bf16 v[96:99], a[160:163], v[152:155], v[96:99]
    s_add_u32 s58, s58, 1024
    s_cmp_eq_u32 s58, s86
    s_cselect_b32 s58, s66, s58
    v_mfma_f32_16x16x32_bf16 v[100:103], a[164:167], v[152:155], v[100:103]
    buffer_load_dwordx4 v[148:151], v23, s[24:27], s58 offen offset:0 sc1
    v_mfma_f32_16x16x32_bf16 v[104:107], a[168:171], v[152:155], v[104:107]
    v_mfma_f32_16x16x32_bf16 v[108:111], a[172:175], v[152:155], v[108:111]
    s_waitcnt vmcnt(10)
    v_mfma_f32_16x16x32_bf16 v[96:99], a[176:179], v[156:159], v[96:99]
    s_add_u32 s58, s58, 1024
    s_cmp_eq_u32 s58, s86
    s_cselect_b32 s58, s66, s58
    v_mfma_f32_16x16x32_bf16 v[100:103], a[180:183], v[156:159], v[100:103]
    buffer_load_dwordx4 v[152:155], v23, s[24:27], s58 offen offset:0 sc1
    v_mfma_f32_16x16x32_bf16 v[104:107], a[184:187], v[156:159], v[104:107]
    v_mfma_f32_16x16x32_bf16 v[108:111], a[188:191], v[156:159], v[108:111]
    s_waitcnt vmcnt(10)
    v_mfma_f32_16x16x32_bf16 v[96:99], a[192:195], v[112:115], v[96:99]
    s_add_u32 s58, s58, 1024
    s_cmp_eq_u32 s58, s86
    s_cselect_b32 s58, s66, s58
    v_mfma_f32_16x16x32_bf16 v[100:103], a[196:199], v[112:115], v[100:103]
    buffer_load_dwordx4 v[156:159], v23, s[24:27], s58 offen offset:0 sc1
    v_mfma_f32_16x16x32_bf16 v[104:107], a[200:203], v[112:115], v[104:107]
    v_mfma_f32_16x16x32_bf16 v[108:111], a[204:207], v[112:115], v[108:111]
    s_waitcnt vmcnt(10)
    v_mfma_f32_16x16x32_bf16 v[96:99], a[208:211], v[116:119], v[96:99]
    s_add_u32 s58, s58, 1024
    s_cmp_eq_u32 s58, s86
    s_cselect_b32 s58, s66, s58
    v_mfma_f32_16x16x32_bf16 v[100:103], a[212:215], v[116:119], v[100:103]
    buffer_load_dwordx4 v[112:115], v23, s[24:27], s58 offen offset:0 sc1
    v_mfma_f32_16x16x32_bf16 v[104:107], a[216:219], v[116:119], v[104:107]
    v_mfma_f32_16x16x32_bf16 v[108:111], a[220:223], v[116:119], v[108:111]
    s_waitcnt vmcnt(10)
    s_waitcnt lgkmcnt(8)
    v_mfma_f32_16x16x32_bf16 v[96:99], a[224:227], v[120:123], v[96:99]
    s_add_u32 s58, s58, 1024
    s_cmp_eq_u32 s58, s86
    s_cselect_b32 s58, s66, s58
    v_mfma_f32_16x16x32_bf16 v[100:103], a[228:231], v[120:123], v[100:103]
    buffer_load_dwordx4 v[116:119], v23, s[24:27], s58 offen offset:0 sc1
    v_mfma_f32_16x16x32_bf16 v[104:107], a[232:235], v[120:123], v[104:107]
    v_mfma_f32_16x16x32_bf16 v[108:111], a[236:239], v[120:123], v[108:111]
    s_waitcnt vmcnt(10)
    s_waitcnt lgkmcnt(0)
    v_mfma_f32_16x16x32_bf16 v[96:99], a[240:243], v[124:127], v[96:99]
    s_add_u32 s58, s58, 1024
    s_cmp_eq_u32 s58, s86
    s_cselect_b32 s58, s66, s58
    v_mfma_f32_16x16x32_bf16 v[100:103], a[244:247], v[124:127], v[100:103]
    buffer_load_dwordx4 v[120:123], v23, s[24:27], s58 offen offset:0 sc1
    v_mfma_f32_16x16x32_bf16 v[104:107], a[248:251], v[124:127], v[104:107]
    v_mfma_f32_16x16x32_bf16 v[108:111], a[252:255], v[124:127], v[108:111]
L_p2_join:
    s_waitcnt vmcnt(10)
    v_mfma_f32_16x16x32_bf16 v[80:83], a[0:3], v[128:131], 0
    s_add_u32 s58, s58, 1024
    s_cmp_eq_u32 s58, s86
    s_cselect_b32 s58, s66, s58
    v_mfma_f32_16x16x32_bf16 v[84:87], a[4:7], v[128:131], 0
    buffer_load_dwordx4 v[124:127], v23, s[24:27], s58 offen offset:0 sc1
    v_mfma_f32_16x16x32_bf16 v[88:91], a[8:11], v[128:131], 0
    v_mfma_f32_16x16x32_bf16 v[92:95], a[12:15], v[128:131], 0
    buffer_load_dwordx4 v[216:219], v22, s[4:7], s71 offen
    s_waitcnt vmcnt(11)
    v_mfma_f32_16x16x32_bf16 v[80:83], a[16:19], v[132:135], v[80:83]
    ds_write_b128 v232, v[96:99] offset:49152
    v_mfma_f32_16x16x32_bf16 v[84:87], a[20:23], v[132:135], v[84:87]
    v_mfma_f32_16x16x32_bf16 v[88:91], a[24:27], v[132:135], v[88:91]
    v_mfma_f32_16x16x32_bf16 v[92:95], a[28:31], v[132:135], v[92:95]
    s_waitcnt vmcnt(10)
    v_mfma_f32_16x16x32_bf16 v[80:83], a[32:35], v[136:139], v[80:83]
    s_add_u32 s58, s58, 1024
    s_cmp_eq_u32 s58, s86
    s_cselect_b32 s58, s66, s58
    v_mfma_f32_16x16x32_bf16 v[84:87], a[36:39], v[136:139], v[84:87]
    buffer_load_dwordx4 v[128:131], v23, s[24:27], s58 offen offset:0 sc1
    v_mfma_f32_16x16x32_bf16 v[88:91], a[40:43], v[136:139], v[88:91]
    ds_write_b128 v232, v[100:103] offset:50176
    v_mfma_f32_16x16x32_bf16 v[92:95], a[44:47], v[136:139], v[92:95]
    buffer_load_dwordx4 v[220:223], v22, s[4:7], s72 offen
    s_waitcnt vmcnt(11)
    v_mfma_f32_16x16x32_bf16 v[80:83], a[48:51], v[140:143], v[80:83]
    ds_write_b128 v232, v[104:107] offset:51200
    v_mfma_f32_16x16x32_bf16 v[84:87], a[52:55], v[140:143], v[84:87]
    v_mfma_f32_16x16x32_bf16 v[88:91], a[56:59], v[140:143], v[88:91]
    v_mfma_f32_16x16x32_bf16 v[92:95], a[60:63], v[140:143], v[92:95]
    s_waitcnt vmcnt(10)
    v_mfma_f32_16x16x32_bf16 v[80:83], a[64:67], v[144:147], v[80:83]
    s_add_u32 s58, s66, 13312
    v_mfma_f32_16x16x32_bf16 v[84:87], a[68:71], v[144:147], v[84:87]
    buffer_load_dwordx4 v[132:135], v23, s[24:27], s58 offen offset:0 sc1
    v_mfma_f32_16x16x32_bf16 v[88:91], a[72:75], v[144:147], v[88:91]
    ds_write_b128 v232, v[108:111] offset:52224
    v_mfma_f32_16x16x32_bf16 v[92:95], a[76:79], v[144:147], v[92:95]
    buffer_load_dwordx2 v[224:225], v26, s[4:7], s73 offen
    s_waitcnt vmcnt(11)
    v_mfma_f32_16x16x32_bf16 v[80:83], a[80:83], v[148:151], v[80:83]
    v_mfma_f32_16x16x32_bf16 v[84:87], a[84:87], v[148:151], v[84:87]
    v_mfma_f32_16x16x32_bf16 v[88:91], a[88:91], v[148:151], v[88:91]
    v_mfma_f32_16x16x32_bf16 v[92:95], a[92:95], v[148:151], v[92:95]
    s_waitcnt vmcnt(10)
    v_mfma_f32_16x16x32_bf16 v[80:83], a[96:99], v[152:155], v[80:83]
    s_add_u32 s58, s66, 14336
    v_mfma_f32_16x16x32_bf16 v[84:87], a[100:103], v[152:155], v[84:87]
    buffer_load_dwordx4 v[136:139], v23, s[24:27], s58 offen offset:0 sc1
    v_mfma_f32_16x16x32_bf16 v[88:91], a[104:107], v[152:155], v[88:91]
    v_mfma_f32_16x16x32_bf16 v[92:95], a[108:111], v[152:155], v[92:95]
    buffer_load_ushort v228, v25, s[36:39], s74 offen
    s_waitcnt vmcnt(11)
    v_mfma_f32_16x16x32_bf16 v[80:83], a[112:115], v[156:159], v[80:83]
    s_waitcnt lgkmcnt(0)
    s_barrier
    v_mfma_f32_16x16x32_bf16 v[84:87], a[116:119], v[156:159], v[84:87]
    v_mfma_f32_16x16x32_bf16 v[88:91], a[120:123], v[156:159], v[88:91]
    v_mfma_f32_16x16x32_bf16 v[92:95], a[124:127], v[156:159], v[92:95]
    s_waitcnt vmcnt(10)
    v_mfma_f32_16x16x32_bf16 v[80:83], a[128:131], v[112:115], v[80:83]
    s_add_u32 s58, s66, 15360
    v_mfma_f32_16x16x32_bf16 v[84:87], a[132:135], v[112:115], v[84:87]
    buffer_load_dwordx4 v[140:143], v23, s[24:27], s58 offen offset:0 sc1
    v_mfma_f32_16x16x32_bf16 v[88:91], a[136:139], v[112:115], v[88:91]
    ds_read_b128 v[160:163], v243 offset:0
    ds_read_b128 v[164:167], v243 offset:1024
    v_mfma_f32_16x16x32_bf16 v[92:95], a[140:143], v[112:115], v[92:95]
    ds_read_b128 v[168:171], v243 offset:4096
    s_waitcnt vmcnt(10)
    v_mfma_f32_16x16x32_bf16 v[80:83], a[144:147], v[116:119], v[80:83]
    s_xor_b32 s66, s44, 2
    s_lshl2_add_u32 s66, s51, s66
    s_mul_i32 s66, s66, 66816
    s_lshl2_add_u32 s66, s52, s66
    s_lshl_b32 s86, s65, 10
    s_add_u32 s58, s86, s66
    s_add_u32 s86, s66, 13312
    v_mfma_f32_16x16x32_bf16 v[84:87], a[148:151], v[116:119], v[84:87]
    buffer_load_dwordx4 v[144:147], v23, s[24:27], s58 offen offset:0 sc1
    v_mfma_f32_16x16x32_bf16 v[88:91], a[152:155], v[116:119], v[88:91]
    ds_read_b128 v[172:175], v243 offset:5120
    ds_read_b128 v[176:179], v243 offset:8192
    v_mfma_f32_16x16x32_bf16 v[92:95], a[156:159], v[116:119], v[92:95]
    ds_read_b128 v[180:183], v243 offset:9216
    s_waitcnt vmcnt(10)
    v_mfma_f32_16x16x32_bf16 v[80:83], a[160:163], v[120:123], v[80:83]
    s_add_u32 s58, s58, 1024
    s_cmp_eq_u32 s58, s86
    s_cselect_b32 s58, s66, s58
    v_mfma_f32_16x16x32_bf16 v[84:87], a[164:167], v[120:123], v[84:87]
    buffer_load_dwordx4 v[148:151], v23, s[24:27], s58 offen offset:0 sc1
    v_mfma_f32_16x16x32_bf16 v[88:91], a[168:171], v[120:123], v[88:91]
    ds_read_b128 v[184:187], v243 offset:12288
    v_mfma_f32_16x16x32_bf16 v[92:95], a[172:175], v[120:123], v[92:95]
    ds_read_b128 v[188:191], v243 offset:13312
    s_waitcnt vmcnt(10)
    v_mfma_f32_16x16x32_bf16 v[80:83], a[176:179], v[124:127], v[80:83]
    s_add_u32 s58, s58, 1024
    s_cmp_eq_u32 s58, s86
    s_cselect_b32 s58, s66, s58
    v_mfma_f32_16x16x32_bf16 v[84:87], a[180:183], v[124:127], v[84:87]
    buffer_load_dwordx4 v[152:155], v23, s[24:27], s58 offen offset:0 sc1
    v_mfma_f32_16x16x32_bf16 v[88:91], a[184:187], v[124:127], v[88:91]
    v_mfma_f32_16x16x32_bf16 v[92:95], a[188:191], v[124:127], v[92:95]
    s_add_u32 s58, s58, 1024
    s_cmp_eq_u32 s58, s86
    s_cselect_b32 s58, s66, s58
    buffer_load_dwordx4 v[156:159], v23, s[24:27], s58 offen offset:0 sc1
    s_waitcnt vmcnt(10)
    v_mfma_f32_16x16x32_bf16 v[80:83], a[192:195], v[128:131], v[80:83]
    s_add_u32 s58, s58, 1024
    s_cmp_eq_u32 s58, s86
    s_cselect_b32 s58, s66, s58
    v_mfma_f32_16x16x32_bf16 v[84:87], a[196:199], v[128:131], v[84:87]
    buffer_load_dwordx4 v[112:115], v23, s[24:27], s58 offen offset:0 sc1
    v_mfma_f32_16x16x32_bf16 v[88:91], a[200:203], v[128:131], v[88:91]
    s_waitcnt lgkmcnt(0)
    v_add_f32 v160, v160, v168
    v_mfma_f32_16x16x32_bf16 v[92:95], a[204:207], v[128:131], v[92:95]
    v_add_f32 v161, v161, v169
    s_add_u32 s58, s58, 1024
    s_cmp_eq_u32 s58, s86
    s_cselect_b32 s58, s66, s58
    buffer_load_dwordx4 v[116:119], v23, s[24:27], s58 offen offset:0 sc1
    s_waitcnt vmcnt(10)
    v_mfma_f32_16x16x32_bf16 v[80:83], a[208:211], v[132:135], v[80:83]
    s_add_u32 s58, s58, 1024
    s_cmp_eq_u32 s58, s86
    s_cselect_b32 s58, s66, s58
    v_mfma_f32_16x16x32_bf16 v[84:87], a[212:215], v[132:135], v[84:87]
    buffer_load_dwordx4 v[120:123], v23, s[24:27], s58 offen offset:0 sc1
    v_mfma_f32_16x16x32_bf16 v[88:91], a[216:219], v[132:135], v[88:91]
    v_add_f32 v162, v162, v170
    v_add_f32 v163, v163, v171
    v_mfma_f32_16x16x32_bf16 v[92:95], a[220:223], v[132:135], v[92:95]
    v_add_f32 v164, v164, v172
    s_add_u32 s58, s58, 1024
    s_cmp_eq_u32 s58, s86
    s_cselect_b32 s58, s66, s58
    buffer_load_dwordx4 v[124:127], v23, s[24:27], s58 offen offset:0 sc1
    s_waitcnt vmcnt(10)
    v_mfma_f32_16x16x32_bf16 v[80:83], a[224:227], v[136:139], v[80:83]
    s_add_u32 s58, s58, 1024
    s_cmp_eq_u32 s58, s86
    s_cselect_b32 s58, s66, s58
    v_mfma_f32_16x16x32_bf16 v[84:87], a[228:231], v[136:139], v[84:87]
    buffer_load_dwordx4 v[128:131], v23, s[24:27], s58 offen offset:0 sc1
    v_mfma_f32_16x16x32_bf16 v[88:91], a[232:235], v[136:139], v[88:91]
    v_add_f32 v165, v165, v173
    v_add_f32 v166, v166, v174
    v_mfma_f32_16x16x32_bf16 v[92:95], a[236:239], v[136:139], v[92:95]
    v_add_f32 v167, v167, v175
    s_add_u32 s58, s58, 1024
    s_cmp_eq_u32 s58, s86
    s_cselect_b32 s58, s66, s58
    buffer_load_dwordx4 v[132:135], v23, s[24:27], s58 offen offset:0 sc1
    s_waitcnt vmcnt(10)
    v_mfma_f32_16x16x32_bf16 v[80:83], a[240:243], v[140:143], v[80:83]
    s_add_u32 s58, s58, 1024
    s_cmp_eq_u32 s58, s86
    s_cselect_b32 s58, s66, s58
    v_mfma_f32_16x16x32_bf16 v[84:87], a[244:247], v[140:143], v[84:87]
    buffer_load_dwordx4 v[136:139], v23, s[24:27], s58 offen offset:0 sc1
    v_mfma_f32_16x16x32_bf16 v[88:91], a[248:251], v[140:143], v[88:91]
    v_add_f32 v160, v160, v176
    v_add_f32 v161, v161, v177
    v_mfma_f32_16x16x32_bf16 v[92:95], a[252:255], v[140:143], v[92:95]
    v_add_f32 v162, v162, v178
    s_waitcnt vmcnt(10)
    v_mfma_f32_16x16x32_bf16 v[64:67], a[0:3], v[144:147], 0
    s_add_u32 s58, s58, 1024
    s_cmp_eq_u32 s58, s86
    s_cselect_b32 s58, s66, s58
    v_mfma_f32_16x16x32_bf16 v[68:71], a[4:7], v[144:147], 0
    buffer_load_dwordx4 v[140:143], v23, s[24:27], s58 offen offset:0 sc1
    v_mfma_f32_16x16x32_bf16 v[72:75], a[8:11], v[144:147], 0
    v_mfma_f32_16x16x32_bf16 v[76:79], a[12:15], v[144:147], 0
    s_waitcnt vmcnt(10)
    v_mfma_f32_16x16x32_bf16 v[64:67], a[16:19], v[148:151], v[64:67]
    s_add_u32 s58, s58, 1024
    s_cmp_eq_u32 s58, s86
    s_cselect_b32 s58, s66, s58
    v_mfma_f32_16x16x32_bf16 v[68:71], a[20:23], v[148:151], v[68:71]
    buffer_load_dwordx4 v[144:147], v23, s[24:27], s58 offen offset:0 sc1
    v_mfma_f32_16x16x32_bf16 v[72:75], a[24:27], v[148:151], v[72:75]
    ds_write_b128 v232, v[80:83] offset:32768
    v_mfma_f32_16x16x32_bf16 v[76:79], a[28:31], v[148:151], v[76:79]
    s_waitcnt vmcnt(10)
    v_mfma_f32_16x16x32_bf16 v[64:67], a[32:35], v[152:155], v[64:67]
    s_add_u32 s58, s66, 13312
    v_mfma_f32_16x16x32_bf16 v[68:71], a[36:39], v[152:155], v[68:71]
    buffer_load_dwordx4 v[148:151], v23, s[24:27], s58 offen offset:0 sc1
    v_mfma_f32_16x16x32_bf16 v[72:75], a[40:43], v[152:155], v[72:75]
    ds_write_b128 v232, v[84:87] offset:33792
    v_mfma_f32_16x16x32_bf16 v[76:79], a[44:47], v[152:155], v[76:79]
    s_waitcnt vmcnt(10)
    v_mfma_f32_16x16x32_bf16 v[64:67], a[48:51], v[156:159], v[64:67]
    s_add_u32 s58, s66, 14336
    ds_write_b128 v232, v[88:91] offset:34816
    v_mfma_f32_16x16x32_bf16 v[68:71], a[52:55], v[156:159], v[68:71]
    buffer_load_dwordx4 v[152:155], v23, s[24:27], s58 offen offset:0 sc1
    v_mfma_f32_16x16x32_bf16 v[72:75], a[56:59], v[156:159], v[72:75]
    v_add_f32 v163, v163, v179
    v_add_f32 v164, v164, v180
    v_mfma_f32_16x16x32_bf16 v[76:79], a[60:63], v[156:159], v[76:79]
    v_add_f32 v165, v165, v181
    s_waitcnt vmcnt(10)
    v_mfma_f32_16x16x32_bf16 v[64:67], a[64:67], v[112:115], v[64:67]
    s_add_u32 s58, s66, 15360
    ds_write_b128 v232, v[92:95] offset:35840
    v_mfma_f32_16x16x32_bf16 v[68:71], a[68:71], v[112:115], v[68:71]
    buffer_load_dwordx4 v[156:159], v23, s[24:27], s58 offen offset:0 sc1
    v_mfma_f32_16x16x32_bf16 v[72:75], a[72:75], v[112:115], v[72:75]
    v_add_f32 v166, v166, v182
    v_add_f32 v167, v167, v183
    v_mfma_f32_16x16x32_bf16 v[76:79], a[76:79], v[112:115], v[76:79]
    v_add_f32 v160, v160, v184
    s_waitcnt vmcnt(10)
    v_mfma_f32_16x16x32_bf16 v[64:67], a[80:83], v[116:119], v[64:67]
    s_xor_b32 s66, s44, 1
    s_lshl2_add_u32 s66, s51, s66
    s_mul_i32 s66, s66, 66816
    s_lshl2_add_u32 s66, s52, s66
    s_lshl_b32 s86, s65, 10
    s_add_u32 s58, s86, s66
    s_add_u32 s86, s66, 13312
    v_mfma_f32_16x16x32_bf16 v[68:71], a[84:87], v[116:119], v[68:71]
    buffer_load_dwordx4 v[112:115], v23, s[24:27], s58 offen offset:0 sc1
    v_mfma_f32_16x16x32_bf16 v[72:75], a[88:91], v[116:119], v[72:75]
    v_add_f32 v161, v161, v185
    v_add_f32 v162, v162, v186
    v_mfma_f32_16x16x32_bf16 v[76:79], a[92:95], v[116:119], v[76:79]
    v_add_f32 v163, v163, v187
    s_waitcnt vmcnt(10)
    v_mfma_f32_16x16x32_bf16 v[64:67], a[96:99], v[120:123], v[64:67]
    s_add_u32 s58, s58, 1024
    s_cmp_eq_u32 s58, s86
    s_cselect_b32 s58, s66, s58
    v_mfma_f32_16x16x32_bf16 v[68:71], a[100:103], v[120:123], v[68:71]
    buffer_load_dwordx4 v[116:119], v23, s[24:27], s58 offen offset:0 sc1
    v_mfma_f32_16x16x32_bf16 v[72:75], a[104:107], v[120:123], v[72:75]
    v_add_f32 v164, v164, v188
    v_add_f32 v165, v165, v189
    v_mfma_f32_16x16x32_bf16 v[76:79], a[108:111], v[120:123], v[76:79]
    v_add_f32 v166, v166, v190
    s_waitcnt vmcnt(10)
    v_mfma_f32_16x16x32_bf16 v[64:67], a[112:115], v[124:127], v[64:67]
    s_add_u32 s58, s58, 1024
    s_cmp_eq_u32 s58, s86
    s_cselect_b32 s58, s66, s58
    v_mfma_f32_16x16x32_bf16 v[68:71], a[116:119], v[124:127], v[68:71]
    buffer_load_dwordx4 v[120:123], v23, s[24:27], s58 offen offset:0 sc1
    v_mfma_f32_16x16x32_bf16 v[72:75], a[120:123], v[124:127], v[72:75]
    v_add_f32 v167, v167, v191
    v_mul_f32 v192, v160, v160
    v_mfma_f32_16x16x32_bf16 v[76:79], a[124:127], v[124:127], v[76:79]
    v_mul_f32 v193, v161, v161
    s_waitcnt vmcnt(10)
    v_mfma_f32_16x16x32_bf16 v[64:67], a[128:131], v[128:131], v[64:67]
    s_add_u32 s58, s58, 1024
    s_cmp_eq_u32 s58, s86
    s_cselect_b32 s58, s66, s58
    v_mfma_f32_16x16x32_bf16 v[68:71], a[132:135], v[128:131], v[68:71]
    buffer_load_dwordx4 v[124:127], v23, s[24:27], s58 offen offset:0 sc1
    v_mfma_f32_16x16x32_bf16 v[72:75], a[136:139], v[128:131], v[72:75]
    v_mul_f32 v194, v162, v162
    v_mul_f32 v195, v163, v163
    v_mfma_f32_16x16x32_bf16 v[76:79], a[140:143], v[128:131], v[76:79]
    v_mul_f32 v196, v164, v164
    s_waitcnt vmcnt(10)
    v_mfma_f32_16x16x32_bf16 v[64:67], a[144:147], v[132:135], v[64:67]
    s_add_u32 s58, s58, 1024
    s_cmp_eq_u32 s58, s86
    s_cselect_b32 s58, s66, s58
    v_mfma_f32_16x16x32_bf16 v[68:71], a[148:151], v[132:135], v[68:71]
    buffer_load_dwordx4 v[128:131], v23, s[24:27], s58 offen offset:0 sc1
    v_mfma_f32_16x16x32_bf16 v[72:75], a[152:155], v[132:135], v[72:75]
    v_mul_f32 v197, v165, v165
    v_mul_f32 v198, v166, v166
    v_mfma_f32_16x16x32_bf16 v[76:79], a[156:159], v[132:135], v[76:79]
    v_mul_f32 v199, v167, v167
    ds_write_b128 v244, v[216:219]
    s_waitcnt vmcnt(10)
    v_mfma_f32_16x16x32_bf16 v[64:67], a[160:163], v[136:139], v[64:67]
    s_add_u32 s58, s58, 1024
    s_cmp_eq_u32 s58, s86
    s_cselect_b32 s58, s66, s58
    v_mfma_f32_16x16x32_bf16 v[68:71], a[164:167], v[136:139], v[68:71]
    buffer_load_dwordx4 v[132:135], v23, s[24:27], s58 offen offset:0 sc1
    v_mfma_f32_16x16x32_bf16 v[72:75], a[168:171], v[136:139], v[72:75]
    v_fma_f32 v192, v192, v236, v237
    v_fma_f32 v193, v193, v236, v237
    v_mfma_f32_16x16x32_bf16 v[76:79], a[172:175], v[136:139], v[76:79]
    v_fma_f32 v194, v194, v236, v237
    s_waitcnt vmcnt(10)
    v_mfma_f32_16x16x32_bf16 v[64:67], a[176:179], v[140:143], v[64:67]
    s_add_u32 s58, s58, 1024
    s_cmp_eq_u32 s58, s86
    s_cselect_b32 s58, s66, s58
    v_mfma_f32_16x16x32_bf16 v[68:71], a[180:183], v[140:143], v[68:71]
    buffer_load_dwordx4 v[136:139], v23, s[24:27], s58 offen offset:0 sc1
    v_mfma_f32_16x16x32_bf16 v[72:75], a[184:187], v[140:143], v[72:75]
    v_fma_f32 v195, v195, v236, v237
    v_fma_f32 v196, v196, v236, v237
    v_mfma_f32_16x16x32_bf16 v[76:79], a[188:191], v[140:143], v[76:79]
    v_fma_f32 v197, v197, v236, v237
    ds_write_b128 v244, v[220:223] offset:1408
    s_waitcnt vmcnt(10)
    v_mfma_f32_16x16x32_bf16 v[64:67], a[192:195], v[144:147], v[64:67]
    s_add_u32 s58, s58, 1024
    s_cmp_eq_u32 s58, s86
    s_cselect_b32 s58, s66, s58
    v_mfma_f32_16x16x32_bf16 v[68:71], a[196:199], v[144:147], v[68:71]
    buffer_load_dwordx4 v[140:143], v23, s[24:27], s58 offen offset:0 sc1
    v_mfma_f32_16x16x32_bf16 v[72:75], a[200:203], v[144:147], v[72:75]
    v_fma_f32 v198, v198, v236, v237
    v_fma_f32 v199, v199, v236, v237
    v_mfma_f32_16x16x32_bf16 v[76:79], a[204:207], v[144:147], v[76:79]
    v_mul_f32 v192, v192, v160
    s_waitcnt vmcnt(10)
    v_mfma_f32_16x16x32_bf16 v[64:67], a[208:211], v[148:151], v[64:67]
    s_add_u32 s58, s58, 1024
    s_cmp_eq_u32 s58, s86
    s_cselect_b32 s58, s66, s58
    v_mfma_f32_16x16x32_bf16 v[68:71], a[212:215], v[148:151], v[68:71]
    buffer_load_dwordx4 v[144:147], v23, s[24:27], s58 offen offset:0 sc1
    v_mfma_f32_16x16x32_bf16 v[72:75], a[216:219], v[148:151], v[72:75]
    v_mul_f32 v193, v193, v161
    v_mul_f32 v194, v194, v162
    v_mfma_f32_16x16x32_bf16 v[76:79], a[220:223], v[148:151], v[76:79]
    v_mul_f32 v195, v195, v163
    ds_write_b64 v252, v[224:225] offset:128
    s_waitcnt vmcnt(10)
    v_mfma_f32_16x16x32_bf16 v[64:67], a[224:227], v[152:155], v[64:67]
    s_add_u32 s58, s58, 1024
    s_cmp_eq_u32 s58, s86
    s_cselect_b32 s58, s66, s58
    v_mfma_f32_16x16x32_bf16 v[68:71], a[228:231], v[152:155], v[68:71]
    buffer_load_dwordx4 v[148:151], v23, s[24:27], s58 offen offset:0 sc1
    v_mfma_f32_16x16x32_bf16 v[72:75], a[232:235], v[152:155], v[72:75]
    v_mul_f32 v196, v196, v164
    v_mul_f32 v197, v197, v165
    v_mfma_f32_16x16x32_bf16 v[76:79], a[236:239], v[152:155], v[76:79]
    v_mul_f32 v198, v198, v166
    s_waitcnt vmcnt(10)
    v_mfma_f32_16x16x32_bf16 v[64:67], a[240:243], v[156:159], v[64:67]
    s_add_u32 s58, s58, 1024
    s_cmp_eq_u32 s58, s86
    s_cselect_b32 s58, s66, s58
    v_mfma_f32_16x16x32_bf16 v[68:71], a[244:247], v[156:159], v[68:71]
    buffer_load_dwordx4 v[152:155], v23, s[24:27], s58 offen offset:0 sc1
    v_mfma_f32_16x16x32_bf16 v[72:75], a[248:251], v[156:159], v[72:75]
    v_mul_f32 v199, v199, v167
    v_mfma_f32_16x16x32_bf16 v[76:79], a[252:255], v[156:159], v[76:79]
    ds_read_b64 v[216:217], v238 offset:0
    ds_read_b64 v[218:219], v238 offset:32
    ds_read_b64 v[220:221], v238 offset:64
    ds_read_b64 v[222:223], v238 offset:96
    ds_read_b64 v[224:225], v238 offset:128
    s_waitcnt vmcnt(10)
    v_mfma_f32_16x16x32_bf16 v[48:51], a[0:3], v[112:115], 0
    s_add_u32 s58, s58, 1024
    s_cmp_eq_u32 s58, s86
    s_cselect_b32 s58, s66, s58
    v_mfma_f32_16x16x32_bf16 v[52:55], a[4:7], v[112:115], 0
    buffer_load_dwordx4 v[156:159], v23, s[24:27], s58 offen offset:0 sc1
    v_mfma_f32_16x16x32_bf16 v[56:59], a[8:11], v[112:115], 0
    v_mfma_f32_16x16x32_bf16 v[60:63], a[12:15], v[112:115], 0
    s_waitcnt vmcnt(10)
    v_mfma_f32_16x16x32_bf16 v[48:51], a[16:19], v[116:119], v[48:51]
    s_add_u32 s58, s58, 1024
    s_cmp_eq_u32 s58, s86
    s_cselect_b32 s58, s66, s58
    v_mfma_f32_16x16x32_bf16 v[52:55], a[20:23], v[116:119], v[52:55]
    buffer_load_dwordx4 v[112:115], v23, s[24:27], s58 offen offset:0 sc1
    v_mfma_f32_16x16x32_bf16 v[56:59], a[24:27], v[116:119], v[56:59]
    ds_write_b128 v232, v[64:67] offset:16384
    v_mfma_f32_16x16x32_bf16 v[60:63], a[28:31], v[116:119], v[60:63]
    s_waitcnt vmcnt(10)
    v_mfma_f32_16x16x32_bf16 v[48:51], a[32:35], v[120:123], v[48:51]
    s_add_u32 s58, s66, 13312
    v_mfma_f32_16x16x32_bf16 v[52:55], a[36:39], v[120:123], v[52:55]
    buffer_load_dwordx4 v[116:119], v23, s[24:27], s58 offen offset:0 sc1
    v_mfma_f32_16x16x32_bf16 v[56:59], a[40:43], v[120:123], v[56:59]
    ds_write_b128 v232, v[68:71] offset:17408
    v_mfma_f32_16x16x32_bf16 v[60:63], a[44:47], v[120:123], v[60:63]
    s_waitcnt vmcnt(10)
    v_mfma_f32_16x16x32_bf16 v[48:51], a[48:51], v[124:127], v[48:51]
    s_add_u32 s58, s66, 14336
    ds_write_b128 v232, v[72:75] offset:18432
    v_mfma_f32_16x16x32_bf16 v[52:55], a[52:55], v[124:127], v[52:55]
    buffer_load_dwordx4 v[120:123], v23, s[24:27], s58 offen offset:0 sc1
    v_mfma_f32_16x16x32_bf16 v[56:59], a[56:59], v[124:127], v[56:59]
    v_exp_f32 v192, v192
    v_exp_f32 v193, v193
    v_mfma_f32_16x16x32_bf16 v[60:63], a[60:63], v[124:127], v[60:63]
    v_exp_f32 v194, v194
    s_waitcnt vmcnt(10)
    v_mfma_f32_16x16x32_bf16 v[48:51], a[64:67], v[128:131], v[48:51]
    s_add_u32 s58, s66, 15360
    ds_write_b128 v232, v[76:79] offset:19456
    v_mfma_f32_16x16x32_bf16 v[52:55], a[68:71], v[128:131], v[52:55]
    buffer_load_dwordx4 v[124:127], v23, s[24:27], s58 offen offset:0 sc1
    v_mfma_f32_16x16x32_bf16 v[56:59], a[72:75], v[128:131], v[56:59]
    v_exp_f32 v195, v195
    v_exp_f32 v196, v196
    v_mfma_f32_16x16x32_bf16 v[60:63], a[76:79], v[128:131], v[60:63]
    v_exp_f32 v197, v197
    s_waitcnt vmcnt(10)
    v_mfma_f32_16x16x32_bf16 v[48:51], a[80:83], v[132:135], v[48:51]
    s_xor_b32 s66, s44, 0
    s_lshl2_add_u32 s66, s51, s66
    s_mul_i32 s66, s66, 66816
    s_lshl2_add_u32 s66, s52, s66
    s_lshl_b32 s86, s65, 10
    s_add_u32 s58, s86, s66
    s_add_u32 s86, s66, 13312
    v_mfma_f32_16x16x32_bf16 v[52:55], a[84:87], v[132:135], v[52:55]
    buffer_load_dwordx4 v[128:131], v23, s[24:27], s58 offen offset:0 sc1
    v_mfma_f32_16x16x32_bf16 v[56:59], a[88:91], v[132:135], v[56:59]
    v_exp_f32 v198, v198
    v_exp_f32 v199, v199
    v_mfma_f32_16x16x32_bf16 v[60:63], a[92:95], v[132:135], v[60:63]
    v_add_f32 v192, 1.0, v192
    s_waitcnt vmcnt(10)
    v_mfma_f32_16x16x32_bf16 v[48:51], a[96:99], v[136:139], v[48:51]
    s_add_u32 s58, s58, 1024
    s_cmp_eq_u32 s58, s86
    s_cselect_b32 s58, s66, s58
    v_mfma_f32_16x16x32_bf16 v[52:55], a[100:103], v[136:139], v[52:55]
    buffer_load_dwordx4 v[132:135], v23, s[24:27], s58 offen offset:0 sc1
    v_mfma_f32_16x16x32_bf16 v[56:59], a[104:107], v[136:139], v[56:59]
    v_add_f32 v193, 1.0, v193
    v_add_f32 v194, 1.0, v194
    v_mfma_f32_16x16x32_bf16 v[60:63], a[108:111], v[136:139], v[60:63]
    v_add_f32 v195, 1.0, v195
    s_waitcnt vmcnt(10)
    v_mfma_f32_16x16x32_bf16 v[48:51], a[112:115], v[140:143], v[48:51]
    s_add_u32 s58, s58, 1024
    s_cmp_eq_u32 s58, s86
    s_cselect_b32 s58, s66, s58
    v_mfma_f32_16x16x32_bf16 v[52:55], a[116:119], v[140:143], v[52:55]
    buffer_load_dwordx4 v[136:139], v23, s[24:27], s58 offen offset:0 sc1
    v_mfma_f32_16x16x32_bf16 v[56:59], a[120:123], v[140:143], v[56:59]
    v_add_f32 v196, 1.0, v196
    v_add_f32 v197, 1.0, v197
    v_mfma_f32_16x16x32_bf16 v[60:63], a[124:127], v[140:143], v[60:63]
    v_add_f32 v198, 1.0, v198
    s_waitcnt vmcnt(10)
    v_mfma_f32_16x16x32_bf16 v[48:51], a[128:131], v[144:147], v[48:51]
    s_add_u32 s58, s58, 1024
    s_cmp_eq_u32 s58, s86
    s_cselect_b32 s58, s66, s58
    v_mfma_f32_16x16x32_bf16 v[52:55], a[132:135], v[144:147], v[52:55]
    buffer_load_dwordx4 v[140:143], v23, s[24:27], s58 offen offset:0 sc1
    v_mfma_f32_16x16x32_bf16 v[56:59], a[136:139], v[144:147], v[56:59]
    v_add_f32 v199, 1.0, v199
    v_rcp_f32 v192, v192
    v_mfma_f32_16x16x32_bf16 v[60:63], a[140:143], v[144:147], v[60:63]
    v_rcp_f32 v193, v193
    s_waitcnt vmcnt(10)
    v_mfma_f32_16x16x32_bf16 v[48:51], a[144:147], v[148:151], v[48:51]
    s_add_u32 s58, s58, 1024
    s_cmp_eq_u32 s58, s86
    s_cselect_b32 s58, s66, s58
    v_mfma_f32_16x16x32_bf16 v[52:55], a[148:151], v[148:151], v[52:55]
    buffer_load_dwordx4 v[144:147], v23, s[24:27], s58 offen offset:0 sc1
    v_mfma_f32_16x16x32_bf16 v[56:59], a[152:155], v[148:151], v[56:59]
    v_rcp_f32 v194, v194
    v_rcp_f32 v195, v195
    v_mfma_f32_16x16x32_bf16 v[60:63], a[156:159], v[148:151], v[60:63]
    v_rcp_f32 v196, v196
    s_waitcnt vmcnt(10)
    v_mfma_f32_16x16x32_bf16 v[48:51], a[160:163], v[152:155], v[48:51]
    s_add_u32 s58, s58, 1024
    s_cmp_eq_u32 s58, s86
    s_cselect_b32 s58, s66, s58
    v_mfma_f32_16x16x32_bf16 v[52:55], a[164:167], v[152:155], v[52:55]
    buffer_load_dwordx4 v[148:151], v23, s[24:27], s58 offen offset:0 sc1
    v_mfma_f32_16x16x32_bf16 v[56:59], a[168:171], v[152:155], v[56:59]
    v_rcp_f32 v197, v197
    v_rcp_f32 v198, v198
    v_mfma_f32_16x16x32_bf16 v[60:63], a[172:175], v[152:155], v[60:63]
    v_rcp_f32 v199, v199
    s_waitcnt vmcnt(10)
    v_mfma_f32_16x16x32_bf16 v[48:51], a[176:179], v[156:159], v[48:51]
    s_add_u32 s58, s58, 1024
    s_cmp_eq_u32 s58, s86
    s_cselect_b32 s58, s66, s58
    v_mfma_f32_16x16x32_bf16 v[52:55], a[180:183], v[156:159], v[52:55]
    buffer_load_dwordx4 v[152:155], v23, s[24:27], s58 offen offset:0 sc1
    v_mfma_f32_16x16x32_bf16 v[56:59], a[184:187], v[156:159], v[56:59]
    v_mul_f32 v192, v192, v160
    v_mul_f32 v193, v193, v161
    v_mfma_f32_16x16x32_bf16 v[60:63], a[188:191], v[156:159], v[60:63]
    v_mul_f32 v194, v194, v162
    s_waitcnt vmcnt(10)
    v_mfma_f32_16x16x32_bf16 v[48:51], a[192:195], v[112:115], v[48:51]
    s_add_u32 s58, s58, 1024
    s_cmp_eq_u32 s58, s86
    s_cselect_b32 s58, s66, s58
    v_mfma_f32_16x16x32_bf16 v[52:55], a[196:199], v[112:115], v[52:55]
    buffer_load_dwordx4 v[156:159], v23, s[24:27], s58 offen offset:0 sc1
    v_mfma_f32_16x16x32_bf16 v[56:59], a[200:203], v[112:115], v[56:59]
    v_mul_f32 v195, v195, v163
    v_mul_f32 v196, v196, v164
L_wb_1:
    s_cbranch_execz L_wb_ret
    v_mfma_f32_16x16x32_bf16 v[60:63], a[204:207], v[112:115], v[60:63]
    v_mul_f32 v197, v197, v165
    s_waitcnt vmcnt(10)
    v_mfma_f32_16x16x32_bf16 v[48:51], a[208:211], v[116:119], v[48:51]
    s_add_u32 s58, s58, 1024
    s_cmp_eq_u32 s58, s86
    s_cselect_b32 s58, s66, s58
    v_mfma_f32_16x16x32_bf16 v[52:55], a[212:215], v[116:119], v[52:55]
    buffer_load_dwordx4 v[112:115], v23, s[24:27], s58 offen offset:0 sc1
    v_mfma_f32_16x16x32_bf16 v[56:59], a[216:219], v[116:119], v[56:59]
    v_mul_f32 v198, v198, v166
    v_mul_f32 v199, v199, v167
    v_mfma_f32_16x16x32_bf16 v[60:63], a[220:223], v[116:119], v[60:63]
    v_cvt_pk_bf16_f32 v96, v192, v193
    s_waitcnt vmcnt(10)
    v_mfma_f32_16x16x32_bf16 v[48:51], a[224:227], v[120:123], v[48:51]
    s_add_u32 s58, s58, 1024
    s_cmp_eq_u32 s58, s86
    s_cselect_b32 s58, s66, s58
    v_mfma_f32_16x16x32_bf16 v[52:55], a[228:231], v[120:123], v[52:55]
    buffer_load_dwordx4 v[116:119], v23, s[24:27], s58 offen offset:0 sc1
    v_mfma_f32_16x16x32_bf16 v[56:59], a[232:235], v[120:123], v[56:59]
    v_cvt_pk_bf16_f32 v97, v194, v195
    v_cvt_pk_bf16_f32 v98, v196, v197
    v_mfma_f32_16x16x32_bf16 v[60:63], a[236:239], v[120:123], v[60:63]
    v_cvt_pk_bf16_f32 v99, v198, v199
    s_waitcnt vmcnt(10)
    v_mfma_f32_16x16x32_bf16 v[48:51], a[240:243], v[124:127], v[48:51]
    s_add_u32 s58, s58, 1024
    s_cmp_eq_u32 s58, s86
    s_cselect_b32 s58, s66, s58
    v_mfma_f32_16x16x32_bf16 v[52:55], a[244:247], v[124:127], v[52:55]
    buffer_load_dwordx4 v[120:123], v23, s[24:27], s58 offen offset:0 sc1
    v_mfma_f32_16x16x32_bf16 v[56:59], a[248:251], v[124:127], v[56:59]
    v_mfma_f32_16x16x32_bf16 v[60:63], a[252:255], v[124:127], v[60:63]
    s_waitcnt vmcnt(10)
    v_mfma_f32_16x16x32_bf16 v[32:35], a[0:3], v[128:131], v[32:35]
    s_add_u32 s58, s58, 1024
    s_cmp_eq_u32 s58, s86
    s_cselect_b32 s58, s66, s58
    v_mfma_f32_16x16x32_bf16 v[36:39], a[4:7], v[128:131], v[36:39]
    buffer_load_dwordx4 v[124:127], v23, s[24:27], s58 offen offset:0 sc1
    v_mfma_f32_16x16x32_bf16 v[40:43], a[8:11], v[128:131], v[40:43]
    v_mfma_f32_16x16x32_bf16 v[44:47], a[12:15], v[128:131], v[44:47]
    s_waitcnt vmcnt(10)
    v_mfma_f32_16x16x32_bf16 v[32:35], a[16:19], v[132:135], v[32:35]
    s_add_u32 s58, s58, 1024
    s_cmp_eq_u32 s58, s86
    s_cselect_b32 s58, s66, s58
    v_mfma_f32_16x16x32_bf16 v[36:39], a[20:23], v[132:135], v[36:39]
    buffer_load_dwordx4 v[128:131], v23, s[24:27], s58 offen offset:0 sc1
    v_mfma_f32_16x16x32_bf16 v[40:43], a[24:27], v[132:135], v[40:43]
    ds_write_b128 v232, v[48:51] offset:0
    v_mfma_f32_16x16x32_bf16 v[44:47], a[28:31], v[132:135], v[44:47]
    ds_write_b128 v232, v[52:55] offset:1024
    s_waitcnt vmcnt(10)
    v_mfma_f32_16x16x32_bf16 v[32:35], a[32:35], v[136:139], v[32:35]
    s_add_u32 s58, s66, 13312
    v_mfma_f32_16x16x32_bf16 v[36:39], a[36:39], v[136:139], v[36:39]
    buffer_load_dwordx4 v[132:135], v23, s[24:27], s58 offen offset:0 sc1
    v_mfma_f32_16x16x32_bf16 v[40:43], a[40:43], v[136:139], v[40:43]
    ds_write_b128 v232, v[56:59] offset:2048
    v_mfma_f32_16x16x32_bf16 v[44:47], a[44:47], v[136:139], v[44:47]
    ds_write_b128 v232, v[60:63] offset:3072
    s_waitcnt vmcnt(10)
    v_mfma_f32_16x16x32_bf16 v[32:35], a[48:51], v[140:143], v[32:35]
    s_add_u32 s58, s66, 14336
    v_mfma_f32_16x16x32_bf16 v[36:39], a[52:55], v[140:143], v[36:39]
    buffer_load_dwordx4 v[136:139], v23, s[24:27], s58 offen offset:0 sc1
    v_mfma_f32_16x16x32_bf16 v[40:43], a[56:59], v[140:143], v[40:43]
    v_mfma_f32_16x16x32_bf16 v[44:47], a[60:63], v[140:143], v[44:47]
    s_waitcnt vmcnt(10)
    v_mfma_f32_16x16x32_bf16 v[32:35], a[64:67], v[144:147], v[32:35]
    s_add_u32 s58, s66, 15360
    v_mfma_f32_16x16x32_bf16 v[36:39], a[68:71], v[144:147], v[36:39]
    buffer_load_dwordx4 v[140:143], v23, s[24:27], s58 offen offset:0 sc1
    v_mfma_f32_16x16x32_bf16 v[40:43], a[72:75], v[144:147], v[40:43]
    v_mfma_f32_16x16x32_bf16 v[44:47], a[76:79], v[144:147], v[44:47]
    s_add_u32 m0, s52, 81920
    s_lshl_b32 s57, s76, 7
    buffer_load_dwordx4 v12, s[20:23], s57 offen offset:0 lds
    s_waitcnt vmcnt(11)
    v_mfma_f32_16x16x32_bf16 v[32:35], a[80:83], v[148:151], v[32:35]
    s_waitcnt lgkmcnt(0)
    s_barrier
    v_mfma_f32_16x16x32_bf16 v[36:39], a[84:87], v[148:151], v[36:39]
    v_mfma_f32_16x16x32_bf16 v[40:43], a[88:91], v[148:151], v[40:43]
    v_mfma_f32_16x16x32_bf16 v[44:47], a[92:95], v[148:151], v[44:47]
    s_add_u32 s57, s57, 31744
    buffer_load_dwordx4 v12, s[20:23], s57 offen offset:1024 lds
    s_waitcnt vmcnt(11)
    v_mfma_f32_16x16x32_bf16 v[32:35], a[96:99], v[152:155], v[32:35]
    ds_read_b128 v[160:163], v233 offset:0
    v_mfma_f32_16x16x32_bf16 v[36:39], a[100:103], v[152:155], v[36:39]
    ds_read_b128 v[176:179], v234 offset:16384
    v_mfma_f32_16x16x32_bf16 v[40:43], a[104:107], v[152:155], v[40:43]
    ds_read_b128 v[192:195], v235 offset:32768
    v_mfma_f32_16x16x32_bf16 v[44:47], a[108:111], v[152:155], v[44:47]
    s_add_u32 s57, s57, 31744
    buffer_load_dwordx4 v12, s[20:23], s57 offen offset:2048 lds
    s_waitcnt vmcnt(11)
    v_mfma_f32_16x16x32_bf16 v[32:35], a[112:115], v[156:159], v[32:35]
    ds_read_b128 v[164:167], v233 offset:1024
    v_mfma_f32_16x16x32_bf16 v[36:39], a[116:119], v[156:159], v[36:39]
    ds_read_b128 v[180:183], v234 offset:17408
    v_mfma_f32_16x16x32_bf16 v[40:43], a[120:123], v[156:159], v[40:43]
    ds_read_b128 v[196:199], v235 offset:33792
    v_mfma_f32_16x16x32_bf16 v[44:47], a[124:127], v[156:159], v[44:47]
    s_add_u32 s57, s57, 31744
    buffer_load_dwordx4 v12, s[20:23], s57 offen offset:3072 lds
    s_waitcnt vmcnt(11)
    v_mfma_f32_16x16x32_bf16 v[32:35], a[128:131], v[112:115], v[32:35]
    ds_read_b128 v[168:171], v233 offset:2048
    v_mfma_f32_16x16x32_bf16 v[36:39], a[132:135], v[112:115], v[36:39]
    ds_read_b128 v[184:187], v234 offset:18432
    v_mfma_f32_16x16x32_bf16 v[40:43], a[136:139], v[112:115], v[40:43]
    ds_read_b128 v[200:203], v235 offset:34816
    v_mfma_f32_16x16x32_bf16 v[44:47], a[140:143], v[112:115], v[44:47]
    s_add_u32 m0, s52, 98304
    s_lshl_b32 s57, s76, 7
    s_add_u32 s57, s57, 131072
    buffer_load_dwordx4 v12, s[20:23], s57 offen offset:0 lds
    s_waitcnt vmcnt(11)
    v_mfma_f32_16x16x32_bf16 v[32:35], a[144:147], v[116:119], v[32:35]
    ds_read_b128 v[172:175], v233 offset:3072
    v_mfma_f32_16x16x32_bf16 v[36:39], a[148:151], v[116:119], v[36:39]
    ds_read_b128 v[188:191], v234 offset:19456
    v_mfma_f32_16x16x32_bf16 v[40:43], a[152:155], v[116:119], v[40:43]
    ds_read_b128 v[204:207], v235 offset:35840
    v_mfma_f32_16x16x32_bf16 v[44:47], a[156:159], v[116:119], v[44:47]
    s_add_u32 s57, s57, 31744
    buffer_load_dwordx4 v12, s[20:23], s57 offen offset:1024 lds
    s_waitcnt vmcnt(11)
    v_mfma_f32_16x16x32_bf16 v[32:35], a[160:163], v[120:123], v[32:35]
    v_mfma_f32_16x16x32_bf16 v[36:39], a[164:167], v[120:123], v[36:39]
    v_mfma_f32_16x16x32_bf16 v[40:43], a[168:171], v[120:123], v[40:43]
    v_mfma_f32_16x16x32_bf16 v[44:47], a[172:175], v[120:123], v[44:47]
    s_add_u32 s57, s57, 31744
    buffer_load_dwordx4 v12, s[20:23], s57 offen offset:2048 lds
    s_waitcnt vmcnt(11)
    v_mfma_f32_16x16x32_bf16 v[32:35], a[176:179], v[124:127], v[32:35]
    s_waitcnt lgkmcnt(9)
    v_mfma_f32_16x16x32_bf16 v[36:39], a[180:183], v[124:127], v[36:39]
    v_add_f32 v160, v160, v176
    v_mfma_f32_16x16x32_bf16 v[40:43], a[184:187], v[124:127], v[40:43]
    v_add_f32 v161, v161, v177
    v_mfma_f32_16x16x32_bf16 v[44:47], a[188:191], v[124:127], v[44:47]
    v_add_f32 v162, v162, v178
    s_add_u32 s57, s57, 31744
    buffer_load_dwordx4 v12, s[20:23], s57 offen offset:3072 lds
    s_waitcnt vmcnt(11)
    v_mfma_f32_16x16x32_bf16 v[32:35], a[192:195], v[128:131], v[32:35]
    v_add_f32 v163, v163, v179
    v_mfma_f32_16x16x32_bf16 v[36:39], a[196:199], v[128:131], v[36:39]
    s_waitcnt lgkmcnt(6)
    v_mfma_f32_16x16x32_bf16 v[40:43], a[200:203], v[128:131], v[40:43]
    v_add_f32 v164, v164, v180
    v_mfma_f32_16x16x32_bf16 v[44:47], a[204:207], v[128:131], v[44:47]
    v_add_f32 v165, v165, v181
    s_add_u32 m0, s52, 114688
    s_lshl_b32 s57, s77, 7
    buffer_load_dwordx4 v12, s[20:23], s57 offen offset:0 lds
    s_waitcnt vmcnt(11)
    v_mfma_f32_16x16x32_bf16 v[32:35], a[208:211], v[132:135], v[32:35]
    v_add_f32 v166, v166, v182
    v_mfma_f32_16x16x32_bf16 v[36:39], a[212:215], v[132:135], v[36:39]
    v_add_f32 v167, v167, v183
    v_mfma_f32_16x16x32_bf16 v[40:43], a[216:219], v[132:135], v[40:43]
    s_waitcnt lgkmcnt(3)
    v_mfma_f32_16x16x32_bf16 v[44:47], a[220:223], v[132:135], v[44:47]
    v_add_f32 v168, v168, v184
    s_add_u32 s57, s57, 31744
    buffer_load_dwordx4 v12, s[20:23], s57 offen offset:1024 lds
    s_waitcnt vmcnt(11)
    v_mfma_f32_16x16x32_bf16 v[32:35], a[224:227], v[136:139], v[32:35]
    v_add_f32 v169, v169, v185
    v_mfma_f32_16x16x32_bf16 v[36:39], a[228:231], v[136:139], v[36:39]
    v_add_f32 v170, v170, v186
    v_mfma_f32_16x16x32_bf16 v[40:43], a[232:235], v[136:139], v[40:43]
    v_add_f32 v171, v171, v187
    v_mfma_f32_16x16x32_bf16 v[44:47], a[236:239], v[136:139], v[44:47]
    s_waitcnt lgkmcnt(0)
    s_add_u32 s57, s57, 31744
    buffer_load_dwordx4 v12, s[20:23], s57 offen offset:2048 lds
    s_waitcnt vmcnt(11)
    v_mfma_f32_16x16x32_bf16 v[32:35], a[240:243], v[140:143], v[32:35]
    v_add_f32 v172, v172, v188
    v_mfma_f32_16x16x32_bf16 v[36:39], a[244:247], v[140:143], v[36:39]
    v_add_f32 v173, v173, v189
    v_mfma_f32_16x16x32_bf16 v[40:43], a[248:251], v[140:143], v[40:43]
    v_add_f32 v174, v174, v190
    v_mfma_f32_16x16x32_bf16 v[44:47], a[252:255], v[140:143], v[44:47]
    v_add_f32 v175, v175, v191
    v_pk_add_f32 v[160:161], v[160:161], v[192:193]
    v_pk_add_f32 v[162:163], v[162:163], v[194:195]
    v_pk_add_f32 v[164:165], v[164:165], v[196:197]
    v_pk_add_f32 v[166:167], v[166:167], v[198:199]
    v_pk_add_f32 v[168:169], v[168:169], v[200:201]
    v_pk_add_f32 v[170:171], v[170:171], v[202:203]
    v_pk_add_f32 v[172:173], v[172:173], v[204:205]
    v_pk_add_f32 v[174:175], v[174:175], v[206:207]
    buffer_store_dwordx4 v[96:99], v23, s[24:27], s83 offen sc1
    s_add_u32 s57, s57, 31744
    buffer_load_dwordx4 v12, s[20:23], s57 offen offset:3072 lds
    v_pk_add_f32 v[32:33], v[32:33], v[160:161]
    v_pk_add_f32 v[34:35], v[34:35], v[162:163]
    v_pk_add_f32 v[36:37], v[36:37], v[164:165]
    v_pk_add_f32 v[38:39], v[38:39], v[166:167]
    v_pk_mul_f32 v[48:49], v[32:33], v[32:33]
    v_pk_mul_f32 v[50:51], v[34:35], v[34:35]
    v_pk_mul_f32 v[52:53], v[36:37], v[36:37]
    v_pk_mul_f32 v[54:55], v[38:39], v[38:39]
    s_add_u32 m0, s52, 131072
    s_lshl_b32 s57, s77, 7
    s_add_u32 s57, s57, 131072
    buffer_load_dwordx4 v12, s[20:23], s57 offen offset:0 lds
    v_pk_fma_f32 v[48:49], v[48:49], v[236:237], v[236:237] op_sel:[0,0,1] op_sel_hi:[1,0,1]
    v_pk_fma_f32 v[50:51], v[50:51], v[236:237], v[236:237] op_sel:[0,0,1] op_sel_hi:[1,0,1]
    v_pk_fma_f32 v[52:53], v[52:53], v[236:237], v[236:237] op_sel:[0,0,1] op_sel_hi:[1,0,1]
    v_pk_fma_f32 v[54:55], v[54:55], v[236:237], v[236:237] op_sel:[0,0,1] op_sel_hi:[1,0,1]
    v_pk_mul_f32 v[48:49], v[48:49], v[32:33]
    v_pk_mul_f32 v[50:51], v[50:51], v[34:35]
    v_pk_mul_f32 v[52:53], v[52:53], v[36:37]
    v_pk_mul_f32 v[54:55], v[54:55], v[38:39]
    s_add_u32 s57, s57, 31744
    buffer_load_dwordx4 v12, s[20:23], s57 offen offset:1024 lds
    s_waitcnt vmcnt(11)
    ds_read_b64_tr_b16 a[0:1], v6 offset:32768
    ds_read_b64_tr_b16 a[2:3], v6 offset:34816
    ds_read_b64_tr_b16 a[4:5], v7 offset:32768
    ds_read_b64_tr_b16 a[6:7], v7 offset:34816
    v_exp_f32 v48, v48
    v_exp_f32 v49, v49
    v_exp_f32 v50, v50
    v_exp_f32 v51, v51
    ds_read_b64_tr_b16 a[8:9], v6 offset:33024
    ds_read_b64_tr_b16 a[10:11], v6 offset:35072
    ds_read_b64_tr_b16 a[12:13], v7 offset:33024
    ds_read_b64_tr_b16 a[14:15], v7 offset:35072
    s_add_u32 s57, s57, 31744
    buffer_load_dwordx4 v12, s[20:23], s57 offen offset:2048 lds
    v_exp_f32 v52, v52
    v_exp_f32 v53, v53
    v_exp_f32 v54, v54
    v_exp_f32 v55, v55
    v_pk_add_f32 v[48:49], v[48:49], 1.0 op_sel_hi:[1,0]
    v_pk_add_f32 v[50:51], v[50:51], 1.0 op_sel_hi:[1,0]
    v_pk_add_f32 v[52:53], v[52:53], 1.0 op_sel_hi:[1,0]
    v_pk_add_f32 v[54:55], v[54:55], 1.0 op_sel_hi:[1,0]
    s_add_u32 s57, s57, 31744
    buffer_load_dwordx4 v12, s[20:23], s57 offen offset:3072 lds
    v_rcp_f32 v48, v48
    v_rcp_f32 v49, v49
    v_rcp_f32 v50, v50
    v_rcp_f32 v51, v51
    v_rcp_f32 v52, v52
    v_rcp_f32 v53, v53
    v_rcp_f32 v54, v54
    v_rcp_f32 v55, v55
    v_pk_mul_f32 v[48:49], v[48:49], v[32:33]
    v_pk_mul_f32 v[50:51], v[50:51], v[34:35]
    v_pk_mul_f32 v[52:53], v[52:53], v[36:37]
    v_pk_mul_f32 v[54:55], v[54:55], v[38:39]
    s_add_u32 m0, s52, 147456
    s_lshl_b32 s57, s78, 7
    buffer_load_dwordx4 v12, s[20:23], s57 offen offset:0 lds
    v_cvt_pk_bf16_f32 v56, v48, v49
    v_cvt_pk_bf16_f32 v57, v50, v51
    v_cvt_pk_bf16_f32 v58, v52, v53
    v_cvt_pk_bf16_f32 v59, v54, v55
    buffer_store_dwordx4 v[56:59], v23, s[24:27], s67 offen offset:0 sc1
    v_pk_add_f32 v[40:41], v[40:41], v[168:169]
    v_pk_add_f32 v[42:43], v[42:43], v[170:171]
    v_pk_add_f32 v[44:45], v[44:45], v[172:173]
    v_pk_add_f32 v[46:47], v[46:47], v[174:175]
    s_add_u32 s57, s57, 31744
    buffer_load_dwordx4 v12, s[20:23], s57 offen offset:1024 lds
    s_waitcnt vmcnt(12)
    ds_read_b64_tr_b16 a[16:17], v6 offset:49152
    ds_read_b64_tr_b16 a[18:19], v6 offset:51200
    ds_read_b64_tr_b16 a[20:21], v7 offset:49152
    ds_read_b64_tr_b16 a[22:23], v7 offset:51200
    v_pk_mul_f32 v[48:49], v[40:41], v[40:41]
    v_pk_mul_f32 v[50:51], v[42:43], v[42:43]
    v_pk_mul_f32 v[52:53], v[44:45], v[44:45]
    v_pk_mul_f32 v[54:55], v[46:47], v[46:47]
    ds_read_b64_tr_b16 a[24:25], v6 offset:49408
    ds_read_b64_tr_b16 a[26:27], v6 offset:51456
    ds_read_b64_tr_b16 a[28:29], v7 offset:49408
    ds_read_b64_tr_b16 a[30:31], v7 offset:51456
    s_add_u32 s57, s57, 31744
    buffer_load_dwordx4 v12, s[20:23], s57 offen offset:2048 lds
    v_pk_fma_f32 v[48:49], v[48:49], v[236:237], v[236:237] op_sel:[0,0,1] op_sel_hi:[1,0,1]
    v_pk_fma_f32 v[50:51], v[50:51], v[236:237], v[236:237] op_sel:[0,0,1] op_sel_hi:[1,0,1]
    v_pk_fma_f32 v[52:53], v[52:53], v[236:237], v[236:237] op_sel:[0,0,1] op_sel_hi:[1,0,1]
    v_pk_fma_f32 v[54:55], v[54:55], v[236:237], v[236:237] op_sel:[0,0,1] op_sel_hi:[1,0,1]
    v_pk_mul_f32 v[48:49], v[48:49], v[40:41]
    v_pk_mul_f32 v[50:51], v[50:51], v[42:43]
    v_pk_mul_f32 v[52:53], v[52:53], v[44:45]
    v_pk_mul_f32 v[54:55], v[54:55], v[46:47]
    s_add_u32 s57, s57, 31744
    buffer_load_dwordx4 v12, s[20:23], s57 offen offset:3072 lds
    v_exp_f32 v48, v48
    v_exp_f32 v49, v49
    v_exp_f32 v50, v50
    v_exp_f32 v51, v51
    v_exp_f32 v52, v52
    v_exp_f32 v53, v53
    v_exp_f32 v54, v54
    v_exp_f32 v55, v55
    v_pk_add_f32 v[48:49], v[48:49], 1.0 op_sel_hi:[1,0]
    v_pk_add_f32 v[50:51], v[50:51], 1.0 op_sel_hi:[1,0]
    v_pk_add_f32 v[52:53], v[52:53], 1.0 op_sel_hi:[1,0]
    v_pk_add_f32 v[54:55], v[54:55], 1.0 op_sel_hi:[1,0]
    s_add_u32 m0, s52, 49152
    s_lshl_b32 s57, s78, 7
    s_add_u32 s57, s57, 131072
    buffer_load_dwordx4 v12, s[20:23], s57 offen offset:0 lds
    v_rcp_f32 v48, v48
    v_rcp_f32 v49, v49
    v_rcp_f32 v50, v50
    v_rcp_f32 v51, v51
    v_rcp_f32 v52, v52
    v_rcp_f32 v53, v53
    v_rcp_f32 v54, v54
    v_rcp_f32 v55, v55
    s_add_u32 s57, s57, 31744
    buffer_load_dwordx4 v12, s[20:23], s57 offen offset:1024 lds
    s_waitcnt vmcnt(11)
    ds_read_b64_tr_b16 a[32:33], v8 offset:0
    ds_read_b64_tr_b16 a[34:35], v8 offset:2048
    ds_read_b64_tr_b16 a[36:37], v9 offset:0
    ds_read_b64_tr_b16 a[38:39], v9 offset:2048
    v_pk_mul_f32 v[48:49], v[48:49], v[40:41]
    v_pk_mul_f32 v[50:51], v[50:51], v[42:43]
    v_pk_mul_f32 v[52:53], v[52:53], v[44:45]
    v_pk_mul_f32 v[54:55], v[54:55], v[46:47]
    ds_read_b64_tr_b16 a[40:41], v8 offset:256
    ds_read_b64_tr_b16 a[42:43], v8 offset:2304
    ds_read_b64_tr_b16 a[44:45], v9 offset:256
    ds_read_b64_tr_b16 a[46:47], v9 offset:2304
    s_add_u32 s57, s57, 31744
    buffer_load_dwordx4 v12, s[20:23], s57 offen offset:2048 lds
    v_cvt_pk_bf16_f32 v60, v48, v49
    v_cvt_pk_bf16_f32 v61, v50, v51
    v_cvt_pk_bf16_f32 v62, v52, v53
    v_cvt_pk_bf16_f32 v63, v54, v55
    buffer_store_dwordx4 v[60:63], v23, s[24:27], s67 offen offset:1024 sc1
    s_add_u32 s57, s57, 31744
    buffer_load_dwordx4 v12, s[20:23], s57 offen offset:3072 lds
    s_add_u32 m0, s52, 65536
    s_lshl_b32 s57, s79, 7
    buffer_load_dwordx4 v12, s[20:23], s57 offen offset:0 lds
    s_add_u32 s57, s57, 31744
    buffer_load_dwordx4 v12, s[20:23], s57 offen offset:1024 lds
    s_waitcnt vmcnt(12)
    ds_read_b64_tr_b16 a[48:49], v8 offset:16384
    ds_read_b64_tr_b16 a[50:51], v8 offset:18432
    ds_read_b64_tr_b16 a[52:53], v9 offset:16384
    ds_read_b64_tr_b16 a[54:55], v9 offset:18432
    s_add_u32 s57, s57, 31744
    buffer_load_dwordx4 v12, s[20:23], s57 offen offset:2048 lds
    ds_read_b64_tr_b16 a[56:57], v8 offset:16640
    ds_read_b64_tr_b16 a[58:59], v8 offset:18688
    ds_read_b64_tr_b16 a[60:61], v9 offset:16640
    ds_read_b64_tr_b16 a[62:63], v9 offset:18688
    s_add_u32 s57, s57, 31744
    buffer_load_dwordx4 v12, s[20:23], s57 offen offset:3072 lds
    s_waitcnt lgkmcnt(15)
    s_add_u32 m0, s52, 81920
    s_lshl_b32 s57, s79, 7
    s_add_u32 s57, s57, 131072
    buffer_load_dwordx4 v12, s[20:23], s57 offen offset:0 lds
    s_add_u32 s57, s57, 31744
    buffer_load_dwordx4 v12, s[20:23], s57 offen offset:1024 lds
    s_waitcnt vmcnt(11)
    ds_read_b64_tr_b16 a[64:65], v8 offset:32768
    ds_read_b64_tr_b16 a[66:67], v8 offset:34816
    ds_read_b64_tr_b16 a[68:69], v9 offset:32768
    ds_read_b64_tr_b16 a[70:71], v9 offset:34816
    s_add_u32 s57, s57, 31744
    buffer_load_dwordx4 v12, s[20:23], s57 offen offset:2048 lds
    ds_read_b64_tr_b16 a[72:73], v8 offset:33024
    ds_read_b64_tr_b16 a[74:75], v8 offset:35072
    ds_read_b64_tr_b16 a[76:77], v9 offset:33024
    ds_read_b64_tr_b16 a[78:79], v9 offset:35072
    s_add_u32 s57, s57, 31744
    buffer_load_dwordx4 v12, s[20:23], s57 offen offset:3072 lds
    s_add_u32 m0, s52, 98304
    s_lshl_b32 s57, s80, 7
    buffer_load_dwordx4 v12, s[20:23], s57 offen offset:0 lds
    s_add_u32 s57, s57, 31744
    buffer_load_dwordx4 v12, s[20:23], s57 offen offset:1024 lds
    s_waitcnt vmcnt(10)
    ds_read_b64_tr_b16 a[80:81], v6 offset:0
    ds_read_b64_tr_b16 a[82:83], v6 offset:2048
    ds_read_b64_tr_b16 a[84:85], v7 offset:0
    ds_read_b64_tr_b16 a[86:87], v7 offset:2048
    s_add_u32 s57, s57, 31744
    buffer_load_dwordx4 v12, s[20:23], s57 offen offset:2048 lds
    ds_read_b64_tr_b16 a[88:89], v6 offset:256
    ds_read_b64_tr_b16 a[90:91], v6 offset:2304
    ds_read_b64_tr_b16 a[92:93], v7 offset:256
    ds_read_b64_tr_b16 a[94:95], v7 offset:2304
    s_barrier
    s_cmp_lg_u32 s44, 0
    s_cbranch_scc1 L_nopub6
    s_lshl_b32 s60, s51, 5
    s_add_u32 s60, s60, s50
    s_lshl_b32 s60, s60, 7
    s_add_u32 s60, s60, 12713984
    v_mov_b32 v30, s47
    s_mov_b64 exec, 1
    buffer_store_dword v30, off, s[24:27], s60 sc1
    s_mov_b64 exec, -1
L_nopub6:
L_p3join:
    s_add_u32 s57, s57, 31744
    buffer_load_dwordx4 v12, s[20:23], s57 offen offset:3072 lds
    v_lshlrev_b32 v228, 16, v228
    v_lshlrev_b32 v32, 16, v216
    v_and_b32 v33, s61, v216
    v_lshlrev_b32 v34, 16, v217
    s_waitcnt lgkmcnt(15)
    s_add_u32 m0, s52, 114688
    s_lshl_b32 s57, s80, 7
    s_add_u32 s57, s57, 131072
    buffer_load_dwordx4 v12, s[20:23], s57 offen offset:0 lds
    v_and_b32 v35, s61, v217
    v_add_f32 v32, v32, v228
    v_add_f32 v33, v33, v228
    v_add_f32 v34, v34, v228
    s_add_u32 s57, s57, 31744
    buffer_load_dwordx4 v12, s[20:23], s57 offen offset:1024 lds
    s_waitcnt vmcnt(10)
    ds_read_b64_tr_b16 a[96:97], v6 offset:16384
    ds_read_b64_tr_b16 a[98:99], v6 offset:18432
    ds_read_b64_tr_b16 a[100:101], v7 offset:16384
    ds_read_b64_tr_b16 a[102:103], v7 offset:18432
    v_add_f32 v35, v35, v228
    v_lshlrev_b32 v48, 16, v218
    v_and_b32 v49, s61, v218
    v_lshlrev_b32 v50, 16, v219
    ds_read_b64_tr_b16 a[104:105], v6 offset:16640
    ds_read_b64_tr_b16 a[106:107], v6 offset:18688
    ds_read_b64_tr_b16 a[108:109], v7 offset:16640
    ds_read_b64_tr_b16 a[110:111], v7 offset:18688
    s_add_u32 s57, s57, 31744
    buffer_load_dwordx4 v12, s[20:23], s57 offen offset:2048 lds
    v_and_b32 v51, s61, v219
    v_add_f32 v48, v48, v228
    v_add_f32 v49, v49, v228
    v_add_f32 v50, v50, v228
    s_add_u32 s57, s57, 31744
    buffer_load_dwordx4 v12, s[20:23], s57 offen offset:3072 lds
    v_add_f32 v51, v51, v228
    v_lshlrev_b32 v64, 16, v220
    v_and_b32 v65, s61, v220
    v_lshlrev_b32 v66, 16, v221
    s_add_u32 m0, s52, 131072
    s_lshl_b32 s57, s81, 7
    buffer_load_dwordx4 v12, s[20:23], s57 offen offset:0 lds
    v_and_b32 v67, s61, v221
    v_add_f32 v64, v64, v228
    v_add_f32 v65, v65, v228
    v_add_f32 v66, v66, v228
    v_add_f32 v67, v67, v228
    v_lshlrev_b32 v80, 16, v222
    v_and_b32 v81, s61, v222
    v_lshlrev_b32 v82, 16, v223
    s_add_u32 s57, s57, 31744
    buffer_load_dwordx4 v12, s[20:23], s57 offen offset:1024 lds
    s_waitcnt vmcnt(10)
    ds_read_b64_tr_b16 a[112:113], v6 offset:32768
    ds_read_b64_tr_b16 a[114:115], v6 offset:34816
    ds_read_b64_tr_b16 a[116:117], v7 offset:32768
    ds_read_b64_tr_b16 a[118:119], v7 offset:34816
    s_add_u32 s57, s57, 31744
    buffer_load_dwordx4 v12, s[20:23], s57 offen offset:2048 lds
    ds_read_b64_tr_b16 a[120:121], v6 offset:33024
    ds_read_b64_tr_b16 a[122:123], v6 offset:35072
    ds_read_b64_tr_b16 a[124:125], v7 offset:33024
    ds_read_b64_tr_b16 a[126:127], v7 offset:35072
    s_add_u32 s57, s57, 31744
    buffer_load_dwordx4 v12, s[20:23], s57 offen offset:3072 lds
    v_and_b32 v83, s61, v223
    v_add_f32 v80, v80, v228
    v_add_f32 v81, v81, v228
    v_add_f32 v82, v82, v228
    v_add_f32 v83, v83, v228
    v_lshlrev_b32 v96, 16, v224
    v_and_b32 v97, s61, v224
    v_lshlrev_b32 v98, 16, v225
    s_waitcnt lgkmcnt(15)
    s_add_u32 m0, s52, 147456
    s_lshl_b32 s57, s81, 7
    s_add_u32 s57, s57, 131072
    buffer_load_dwordx4 v12, s[20:23], s57 offen offset:0 lds
    v_and_b32 v99, s61, v225
    v_add_f32 v96, v96, v228
    v_add_f32 v97, v97, v228
    v_add_f32 v98, v98, v228
    s_add_u32 s57, s57, 31744
    buffer_load_dwordx4 v12, s[20:23], s57 offen offset:1024 lds
    s_waitcnt vmcnt(10)
    ds_read_b64_tr_b16 a[128:129], v6 offset:49152
    ds_read_b64_tr_b16 a[130:131], v6 offset:51200
    ds_read_b64_tr_b16 a[132:133], v7 offset:49152
    ds_read_b64_tr_b16 a[134:135], v7 offset:51200
    s_add_u32 s57, s57, 31744
    buffer_load_dwordx4 v12, s[20:23], s57 offen offset:2048 lds
    ds_read_b64_tr_b16 a[136:137], v6 offset:49408
    ds_read_b64_tr_b16 a[138:139], v6 offset:51456
    ds_read_b64_tr_b16 a[140:141], v7 offset:49408
    ds_read_b64_tr_b16 a[142:143], v7 offset:51456
    v_add_f32 v99, v99, v228
    s_add_u32 s57, s57, 31744
    buffer_load_dwordx4 v12, s[20:23], s57 offen offset:3072 lds
    s_add_u32 m0, s52, 49152
    s_lshl_b32 s57, s82, 7
    buffer_load_dwordx4 v12, s[20:23], s57 offen offset:0 lds
    s_add_u32 s57, s57, 31744
    buffer_load_dwordx4 v12, s[20:23], s57 offen offset:1024 lds
    s_waitcnt vmcnt(10)
    ds_read_b64_tr_b16 a[144:145], v8 offset:0
    ds_read_b64_tr_b16 a[146:147], v8 offset:2048
    ds_read_b64_tr_b16 a[148:149], v9 offset:0
    ds_read_b64_tr_b16 a[150:151], v9 offset:2048
    s_add_u32 s57, s57, 31744
    buffer_load_dwordx4 v12, s[20:23], s57 offen offset:2048 lds
    ds_read_b64_tr_b16 a[152:153], v8 offset:256
    ds_read_b64_tr_b16 a[154:155], v8 offset:2304
    ds_read_b64_tr_b16 a[156:157], v9 offset:256
    ds_read_b64_tr_b16 a[158:159], v9 offset:2304
    s_add_u32 s57, s57, 31744
    buffer_load_dwordx4 v12, s[20:23], s57 offen offset:3072 lds
    s_waitcnt lgkmcnt(15)
    s_add_u32 m0, s52, 65536
    s_lshl_b32 s57, s82, 7
    s_add_u32 s57, s57, 131072
    buffer_load_dwordx4 v12, s[20:23], s57 offen offset:0 lds
    s_add_u32 s57, s57, 31744
    buffer_load_dwordx4 v12, s[20:23], s57 offen offset:1024 lds
    s_waitcnt vmcnt(10)
    ds_read_b64_tr_b16 a[160:161], v8 offset:16384
    ds_read_b64_tr_b16 a[162:163], v8 offset:18432
    ds_read_b64_tr_b16 a[164:165], v9 offset:16384
    ds_read_b64_tr_b16 a[166:167], v9 offset:18432
    s_add_u32 s57, s57, 31744
    buffer_load_dwordx4 v12, s[20:23], s57 offen offset:2048 lds
    ds_read_b64_tr_b16 a[168:169], v8 offset:16640
    ds_read_b64_tr_b16 a[170:171], v8 offset:18688
    ds_read_b64_tr_b16 a[172:173], v9 offset:16640
    ds_read_b64_tr_b16 a[174:175], v9 offset:18688
    s_add_u32 s57, s57, 31744
    buffer_load_dwordx4 v12, s[20:23], s57 offen offset:3072 lds
    s_add_u32 m0, s52, 81920
    s_mov_b32 s57, s75
    buffer_load_dwordx4 v15, s[12:15], s57 offen offset:0 lds
    s_add_u32 s57, s57, 113664
    buffer_load_dwordx4 v15, s[12:15], s57 offen offset:1024 lds
    s_waitcnt vmcnt(10)
    ds_read_b64_tr_b16 a[176:177], v8 offset:32768
    ds_read_b64_tr_b16 a[178:179], v8 offset:34816
    ds_read_b64_tr_b16 a[180:181], v9 offset:32768
    ds_read_b64_tr_b16 a[182:183], v9 offset:34816
    s_add_u32 s57, s57, 113664
    buffer_load_dwordx4 v15, s[12:15], s57 offen offset:2048 lds
    ds_read_b64_tr_b16 a[184:185], v8 offset:33024
    ds_read_b64_tr_b16 a[186:187], v8 offset:35072
    ds_read_b64_tr_b16 a[188:189], v9 offset:33024
    ds_read_b64_tr_b16 a[190:191], v9 offset:35072
    s_add_u32 s57, s57, 113664
    buffer_load_dwordx4 v15, s[12:15], s57 offen offset:3072 lds
    s_waitcnt lgkmcnt(15)
    s_add_u32 m0, s52, 98304
    s_mov_b32 s57, 0
    buffer_load_dwordx4 v13, s[12:15], s57 offen offset:0 lds
    s_add_u32 s57, s57, 6144
    buffer_load_dwordx4 v14, s[12:15], s57 offen offset:1024 lds
    s_waitcnt vmcnt(10)
    ds_read_b64_tr_b16 a[192:193], v6 offset:0
    ds_read_b64_tr_b16 a[194:195], v6 offset:2048
    ds_read_b64_tr_b16 a[196:197], v7 offset:0
    ds_read_b64_tr_b16 a[198:199], v7 offset:2048
    s_add_u32 s57, s57, 6144
    buffer_load_dwordx4 v13, s[12:15], s57 offen offset:2048 lds
    ds_read_b64_tr_b16 a[200:201], v6 offset:256
    ds_read_b64_tr_b16 a[202:203], v6 offset:2304
    ds_read_b64_tr_b16 a[204:205], v7 offset:256
    ds_read_b64_tr_b16 a[206:207], v7 offset:2304
    s_add_u32 s57, s57, 6144
    buffer_load_dwordx4 v14, s[12:15], s57 offen offset:3072 lds
    buffer_load_dword v17, v20, s[24:27], 0 offen sc1
    s_add_u32 m0, s52, 114688
    s_mov_b32 s57, 114688
    buffer_load_dwordx4 v13, s[12:15], s57 offen offset:0 lds
    s_waitcnt vmcnt(10)
    ds_read_b64_tr_b16 a[208:209], v6 offset:16384
L_wb_2:
    s_cbranch_execz L_wb_ret
    ds_read_b64_tr_b16 a[210:211], v6 offset:18432
    ds_read_b64_tr_b16 a[212:213], v7 offset:16384
    ds_read_b64_tr_b16 a[214:215], v7 offset:18432
    s_add_u32 s57, s57, 6144
    buffer_load_dwordx4 v14, s[12:15], s57 offen offset:1024 lds
    ds_read_b64_tr_b16 a[216:217], v6 offset:16640
    ds_read_b64_tr_b16 a[218:219], v6 offset:18688
    ds_read_b64_tr_b16 a[220:221], v7 offset:16640
    ds_read_b64_tr_b16 a[222:223], v7 offset:18688
    s_add_u32 s57, s57, 6144
    buffer_load_dwordx4 v13, s[12:15], s57 offen offset:2048 lds
    s_add_u32 s57, s57, 6144
    buffer_load_dwordx4 v14, s[12:15], s57 offen offset:3072 lds
    s_waitcnt lgkmcnt(15)
    s_add_u32 m0, s52, 131072
    s_mov_b32 s57, 229376
    buffer_load_dwordx4 v13, s[12:15], s57 offen offset:0 lds
    s_add_u32 s57, s57, 6144
    buffer_load_dwordx4 v14, s[12:15], s57 offen offset:1024 lds
    s_add_u32 s57, s57, 6144
    buffer_load_dwordx4 v13, s[12:15], s57 offen offset:2048 lds
    s_add_u32 s57, s57, 6144
    buffer_load_dwordx4 v14, s[12:15], s57 offen offset:3072 lds
    s_add_u32 m0, s52, 147456
    s_mov_b32 s57, 344064
    buffer_load_dwordx4 v239, s[12:15], s57 offen offset:0 lds
    s_add_u32 s57, s57, 27648
    buffer_load_dwordx4 v239, s[12:15], s57 offen offset:1024 lds
    s_waitcnt vmcnt(10)
    v_cmp_ne_u32 vcc, s47, v17
    s_nop 0
    s_cbranch_vccz L_ok8
    s_mov_b32 s59, 100000
L_spin7:
    buffer_load_dword v17, v20, s[24:27], 0 offen sc1
    s_waitcnt vmcnt(0)
    v_cmp_ne_u32 vcc, s47, v17
    s_nop 0
    s_cbranch_vccz L_ok8
    s_sub_u32 s59, s59, 1
    s_cbranch_scc0 L_spin7
L_ok8:
    s_cmp_ge_u32 s89, 4
    s_cbranch_scc1 L_p3_alt
    s_mov_b32 s66, s68
    s_add_u32 s58, s66, s76
    buffer_load_dwordx4 v[144:147], v23, s[24:27], s58 offen offset:0 sc1
    buffer_load_dwordx4 v[148:151], v23, s[24:27], s58 offen offset:1024 sc1
    s_add_u32 s58, s66, s77
    buffer_load_dwordx4 v[152:155], v23, s[24:27], s58 offen offset:0 sc1
    buffer_load_dwordx4 v[156:159], v23, s[24:27], s58 offen offset:1024 sc1
    s_add_u32 s58, s66, s78
    buffer_load_dwordx4 v[112:115], v23, s[24:27], s58 offen offset:0 sc1
    buffer_load_dwordx4 v[116:119], v23, s[24:27], s58 offen offset:1024 sc1
    s_add_u32 s58, s66, s79
    buffer_load_dwordx4 v[120:123], v23, s[24:27], s58 offen offset:0 sc1
    buffer_load_dwordx4 v[124:127], v23, s[24:27], s58 offen offset:1024 sc1
    s_add_u32 s58, s66, s80
    buffer_load_dwordx4 v[128:131], v23, s[24:27], s58 offen offset:0 sc1
    buffer_load_dwordx4 v[132:135], v23, s[24:27], s58 offen offset:1024 sc1
    s_add_u32 s58, s66, s81
    buffer_load_dwordx4 v[136:139], v23, s[24:27], s58 offen offset:0 sc1
    s_waitcnt vmcnt(10)
    v_mfma_f32_16x16x32_bf16 v[96:99], v[144:147], a[0:3], v[96:99]
    v_mfma_f32_16x16x32_bf16 v[100:103], v[144:147], a[4:7], 0
    buffer_load_dwordx4 v[140:143], v23, s[24:27], s58 offen offset:1024 sc1
    v_mfma_f32_16x16x32_bf16 v[104:107], v[144:147], a[8:11], 0
    v_mfma_f32_16x16x32_bf16 v[108:111], v[144:147], a[12:15], 0
    s_waitcnt vmcnt(10)
    v_mfma_f32_16x16x32_bf16 v[96:99], v[148:151], a[16:19], v[96:99]
    s_add_u32 s58, s66, s82
    v_mfma_f32_16x16x32_bf16 v[100:103], v[148:151], a[20:23], v[100:103]
    buffer_load_dwordx4 v[144:147], v23, s[24:27], s58 offen offset:0 sc1
    v_mfma_f32_16x16x32_bf16 v[104:107], v[148:151], a[24:27], v[104:107]
    v_mfma_f32_16x16x32_bf16 v[108:111], v[148:151], a[28:31], v[108:111]
    s_waitcnt vmcnt(10)
    v_mfma_f32_16x16x32_bf16 v[96:99], v[152:155], a[32:35], v[96:99]
    v_mfma_f32_16x16x32_bf16 v[100:103], v[152:155], a[36:39], v[100:103]
    buffer_load_dwordx4 v[148:151], v23, s[24:27], s58 offen offset:1024 sc1
    v_mfma_f32_16x16x32_bf16 v[104:107], v[152:155], a[40:43], v[104:107]
    v_mfma_f32_16x16x32_bf16 v[108:111], v[152:155], a[44:47], v[108:111]
    s_waitcnt vmcnt(10)
    v_mfma_f32_16x16x32_bf16 v[96:99], v[156:159], a[48:51], v[96:99]
    s_add_u32 s66, s69, 175872
    s_add_u32 s58, s66, s76
    v_mfma_f32_16x16x32_bf16 v[100:103], v[156:159], a[52:55], v[100:103]
    buffer_load_dwordx4 v[152:155], v23, s[24:27], s58 offen offset:0 sc1
    v_mfma_f32_16x16x32_bf16 v[104:107], v[156:159], a[56:59], v[104:107]
    v_mfma_f32_16x16x32_bf16 v[108:111], v[156:159], a[60:63], v[108:111]
    s_waitcnt vmcnt(10)
    v_mfma_f32_16x16x32_bf16 v[96:99], v[112:115], a[64:67], v[96:99]
    v_mfma_f32_16x16x32_bf16 v[100:103], v[112:115], a[68:71], v[100:103]
    buffer_load_dwordx4 v[156:159], v23, s[24:27], s58 offen offset:1024 sc1
    v_mfma_f32_16x16x32_bf16 v[104:107], v[112:115], a[72:75], v[104:107]
    v_mfma_f32_16x16x32_bf16 v[108:111], v[112:115], a[76:79], v[108:111]
    s_waitcnt vmcnt(10)
    v_mfma_f32_16x16x32_bf16 v[96:99], v[116:119], a[80:83], v[96:99]
    s_add_u32 s58, s66, s77
    v_mfma_f32_16x16x32_bf16 v[100:103], v[116:119], a[84:87], v[100:103]
    buffer_load_dwordx4 v[112:115], v23, s[24:27], s58 offen offset:0 sc1
    v_mfma_f32_16x16x32_bf16 v[104:107], v[116:119], a[88:91], v[104:107]
    v_mfma_f32_16x16x32_bf16 v[108:111], v[116:119], a[92:95], v[108:111]
    s_waitcnt vmcnt(10)
    v_mfma_f32_16x16x32_bf16 v[96:99], v[120:123], a[96:99], v[96:99]
    v_mfma_f32_16x16x32_bf16 v[100:103], v[120:123], a[100:103], v[100:103]
    buffer_load_dwordx4 v[116:119], v23, s[24:27], s58 offen offset:1024 sc1
    v_mfma_f32_16x16x32_bf16 v[104:107], v[120:123], a[104:107], v[104:107]
    v_mfma_f32_16x16x32_bf16 v[108:111], v[120:123], a[108:111], v[108:111]
    s_waitcnt vmcnt(10)
    v_mfma_f32_16x16x32_bf16 v[96:99], v[124:127], a[112:115], v[96:99]
    s_add_u32 s58, s66, s78
    v_mfma_f32_16x16x32_bf16 v[100:103], v[124:127], a[116:119], v[100:103]
    buffer_load_dwordx4 v[120:123], v23, s[24:27], s58 offen offset:0 sc1
    v_mfma_f32_16x16x32_bf16 v[104:107], v[124:127], a[120:123], v[104:107]
    v_mfma_f32_16x16x32_bf16 v[108:111], v[124:127], a[124:127], v[108:111]
    s_waitcnt vmcnt(10)
    v_mfma_f32_16x16x32_bf16 v[96:99], v[128:131], a[128:131], v[96:99]
    v_mfma_f32_16x16x32_bf16 v[100:103], v[128:131], a[132:135], v[100:103]
    buffer_load_dwordx4 v[124:127], v23, s[24:27], s58 offen offset:1024 sc1
    v_mfma_f32_16x16x32_bf16 v[104:107], v[128:131], a[136:139], v[104:107]
    v_mfma_f32_16x16x32_bf16 v[108:111], v[128:131], a[140:143], v[108:111]
    s_waitcnt vmcnt(10)
    v_mfma_f32_16x16x32_bf16 v[96:99], v[132:135], a[144:147], v[96:99]
    s_add_u32 s58, s66, s79
    v_mfma_f32_16x16x32_bf16 v[100:103], v[132:135], a[148:151], v[100:103]
    buffer_load_dwordx4 v[128:131], v23, s[24:27], s58 offen offset:0 sc1
    v_mfma_f32_16x16x32_bf16 v[104:107], v[132:135], a[152:155], v[104:107]
    v_mfma_f32_16x16x32_bf16 v[108:111], v[132:135], a[156:159], v[108:111]
    s_waitcnt vmcnt(10)
    v_mfma_f32_16x16x32_bf16 v[96:99], v[136:139], a[160:163], v[96:99]
    v_mfma_f32_16x16x32_bf16 v[100:103], v[136:139], a[164:167], v[100:103]
    buffer_load_dwordx4 v[132:135], v23, s[24:27], s58 offen offset:1024 sc1
    v_mfma_f32_16x16x32_bf16 v[104:107], v[136:139], a[168:171], v[104:107]
    v_mfma_f32_16x16x32_bf16 v[108:111], v[136:139], a[172:175], v[108:111]
    s_waitcnt vmcnt(10)
    v_mfma_f32_16x16x32_bf16 v[96:99], v[140:143], a[176:179], v[96:99]
    s_add_u32 s58, s66, s80
    v_mfma_f32_16x16x32_bf16 v[100:103], v[140:143], a[180:183], v[100:103]
    buffer_load_dwordx4 v[136:139], v23, s[24:27], s58 offen offset:0 sc1
    v_mfma_f32_16x16x32_bf16 v[104:107], v[140:143], a[184:187], v[104:107]
    v_mfma_f32_16x16x32_bf16 v[108:111], v[140:143], a[188:191], v[108:111]
    s_waitcnt vmcnt(10)
    s_waitcnt lgkmcnt(8)
    v_mfma_f32_16x16x32_bf16 v[96:99], v[144:147], a[192:195], v[96:99]
    v_mfma_f32_16x16x32_bf16 v[100:103], v[144:147], a[196:199], v[100:103]
    buffer_load_dwordx4 v[140:143], v23, s[24:27], s58 offen offset:1024 sc1
    v_mfma_f32_16x16x32_bf16 v[104:107], v[144:147], a[200:203], v[104:107]
    v_mfma_f32_16x16x32_bf16 v[108:111], v[144:147], a[204:207], v[108:111]
    s_waitcnt vmcnt(10)
    s_waitcnt lgkmcnt(0)
    v_mfma_f32_16x16x32_bf16 v[96:99], v[148:151], a[208:211], v[96:99]
    s_add_u32 s58, s66, s81
    v_mfma_f32_16x16x32_bf16 v[100:103], v[148:151], a[212:215], v[100:103]
    buffer_load_dwordx4 v[144:147], v23, s[24:27], s58 offen offset:0 sc1
    v_mfma_f32_16x16x32_bf16 v[104:107], v[148:151], a[216:219], v[104:107]
    v_mfma_f32_16x16x32_bf16 v[108:111], v[148:151], a[220:223], v[108:111]
L_p3_join:
    s_waitcnt vmcnt(10)
    v_mfma_f32_16x16x32_bf16 v[80:83], v[152:155], a[0:3], v[80:83]
    v_mfma_f32_16x16x32_bf16 v[84:87], v[152:155], a[4:7], 0
    buffer_load_dwordx4 v[148:151], v23, s[24:27], s58 offen offset:1024 sc1
    v_mfma_f32_16x16x32_bf16 v[88:91], v[152:155], a[8:11], 0
    v_mfma_f32_16x16x32_bf16 v[92:95], v[152:155], a[12:15], 0
    s_waitcnt vmcnt(10)
    v_mfma_f32_16x16x32_bf16 v[80:83], v[156:159], a[16:19], v[80:83]
    s_add_u32 s58, s66, s82
    v_mfma_f32_16x16x32_bf16 v[84:87], v[156:159], a[20:23], v[84:87]
    buffer_load_dwordx4 v[152:155], v23, s[24:27], s58 offen offset:0 sc1
    v_mfma_f32_16x16x32_bf16 v[88:91], v[156:159], a[24:27], v[88:91]
    ds_write_b128 v232, v[100:103] offset:3072
    v_mfma_f32_16x16x32_bf16 v[92:95], v[156:159], a[28:31], v[92:95]
    s_waitcnt vmcnt(10)
    v_mfma_f32_16x16x32_bf16 v[80:83], v[112:115], a[32:35], v[80:83]
    v_mfma_f32_16x16x32_bf16 v[84:87], v[112:115], a[36:39], v[84:87]
    buffer_load_dwordx4 v[156:159], v23, s[24:27], s58 offen offset:1024 sc1
    v_mfma_f32_16x16x32_bf16 v[88:91], v[112:115], a[40:43], v[88:91]
    ds_write_b128 v232, v[104:107] offset:19456
    v_mfma_f32_16x16x32_bf16 v[92:95], v[112:115], a[44:47], v[92:95]
    s_waitcnt vmcnt(10)
    v_mfma_f32_16x16x32_bf16 v[80:83], v[116:119], a[48:51], v[80:83]
    s_add_u32 s66, s69, 117248
    s_add_u32 s58, s66, s76
    v_mfma_f32_16x16x32_bf16 v[84:87], v[116:119], a[52:55], v[84:87]
    buffer_load_dwordx4 v[112:115], v23, s[24:27], s58 offen offset:0 sc1
    v_mfma_f32_16x16x32_bf16 v[88:91], v[116:119], a[56:59], v[88:91]
    ds_write_b128 v232, v[108:111] offset:35840
    v_mfma_f32_16x16x32_bf16 v[92:95], v[116:119], a[60:63], v[92:95]
    s_waitcnt vmcnt(10)
    v_mfma_f32_16x16x32_bf16 v[80:83], v[120:123], a[64:67], v[80:83]
    v_mfma_f32_16x16x32_bf16 v[84:87], v[120:123], a[68:71], v[84:87]
    buffer_load_dwordx4 v[116:119], v23, s[24:27], s58 offen offset:1024 sc1
    v_mfma_f32_16x16x32_bf16 v[88:91], v[120:123], a[72:75], v[88:91]
    v_mfma_f32_16x16x32_bf16 v[92:95], v[120:123], a[76:79], v[92:95]
    s_waitcnt vmcnt(10)
    v_mfma_f32_16x16x32_bf16 v[80:83], v[124:127], a[80:83], v[80:83]
    s_add_u32 s58, s66, s77
    v_mfma_f32_16x16x32_bf16 v[84:87], v[124:127], a[84:87], v[84:87]
    buffer_load_dwordx4 v[120:123], v23, s[24:27], s58 offen offset:0 sc1
    v_mfma_f32_16x16x32_bf16 v[88:91], v[124:127], a[88:91], v[88:91]
    s_waitcnt lgkmcnt(0)
    s_barrier
    v_mfma_f32_16x16x32_bf16 v[92:95], v[124:127], a[92:95], v[92:95]
    s_waitcnt vmcnt(10)
    v_mfma_f32_16x16x32_bf16 v[80:83], v[128:131], a[96:99], v[80:83]
    v_mfma_f32_16x16x32_bf16 v[84:87], v[128:131], a[100:103], v[84:87]
    buffer_load_dwordx4 v[124:127], v23, s[24:27], s58 offen offset:1024 sc1
    v_mfma_f32_16x16x32_bf16 v[88:91], v[128:131], a[104:107], v[88:91]
    ds_read_b128 v[100:103], v233 offset:3072
    ds_read_b128 v[104:107], v234 offset:19456
    v_mfma_f32_16x16x32_bf16 v[92:95], v[128:131], a[108:111], v[92:95]
    ds_read_b128 v[108:111], v235 offset:35840
    s_waitcnt vmcnt(10)
    v_mfma_f32_16x16x32_bf16 v[80:83], v[132:135], a[112:115], v[80:83]
    s_add_u32 s58, s66, s78
    v_mfma_f32_16x16x32_bf16 v[84:87], v[132:135], a[116:119], v[84:87]
    buffer_load_dwordx4 v[128:131], v23, s[24:27], s58 offen offset:0 sc1
    v_mfma_f32_16x16x32_bf16 v[88:91], v[132:135], a[120:123], v[88:91]
    ds_read_b64_tr_b16 v[160:161], v16 offset:0
    v_mfma_f32_16x16x32_bf16 v[92:95], v[132:135], a[124:127], v[92:95]
    ds_read_b64_tr_b16 v[162:163], v16 offset:512
    s_waitcnt vmcnt(10)
    v_mfma_f32_16x16x32_bf16 v[80:83], v[136:139], a[128:131], v[80:83]
    s_waitcnt lgkmcnt(2)
    v_mfma_f32_16x16x32_bf16 v[84:87], v[136:139], a[132:135], v[84:87]
    buffer_load_dwordx4 v[132:135], v23, s[24:27], s58 offen offset:1024 sc1
    v_mfma_f32_16x16x32_bf16 v[88:91], v[136:139], a[136:139], v[88:91]
    v_add_f32 v96, v96, v100
    v_add_f32 v97, v97, v101
    ds_read_b64_tr_b16 v[164:165], v16 offset:4096
    v_mfma_f32_16x16x32_bf16 v[92:95], v[136:139], a[140:143], v[92:95]
    ds_read_b64_tr_b16 v[166:167], v16 offset:4608
    s_waitcnt vmcnt(10)
    v_mfma_f32_16x16x32_bf16 v[80:83], v[140:143], a[144:147], v[80:83]
    s_add_u32 s58, s66, s79
    v_add_f32 v98, v98, v102
    v_mfma_f32_16x16x32_bf16 v[84:87], v[140:143], a[148:151], v[84:87]
    buffer_load_dwordx4 v[136:139], v23, s[24:27], s58 offen offset:0 sc1
    v_mfma_f32_16x16x32_bf16 v[88:91], v[140:143], a[152:155], v[88:91]
    v_add_f32 v99, v99, v103
    v_add_f32 v96, v96, v104
    ds_read_b64_tr_b16 v[168:169], v16 offset:8192
    v_mfma_f32_16x16x32_bf16 v[92:95], v[140:143], a[156:159], v[92:95]
    ds_read_b64_tr_b16 v[170:171], v16 offset:8704
    s_waitcnt vmcnt(10)
    v_mfma_f32_16x16x32_bf16 v[80:83], v[144:147], a[160:163], v[80:83]
    v_add_f32 v97, v97, v105
    v_mfma_f32_16x16x32_bf16 v[84:87], v[144:147], a[164:167], v[84:87]
    buffer_load_dwordx4 v[140:143], v23, s[24:27], s58 offen offset:1024 sc1
    v_mfma_f32_16x16x32_bf16 v[88:91], v[144:147], a[168:171], v[88:91]
    v_add_f32 v98, v98, v106
    v_add_f32 v99, v99, v107
    ds_read_b64_tr_b16 v[172:173], v16 offset:12288
    v_mfma_f32_16x16x32_bf16 v[92:95], v[144:147], a[172:175], v[92:95]
    ds_read_b64_tr_b16 v[174:175], v16 offset:12800
    s_waitcnt vmcnt(10)
    v_mfma_f32_16x16x32_bf16 v[80:83], v[148:151], a[176:179], v[80:83]
    s_add_u32 s58, s66, s80
    v_mfma_f32_16x16x32_bf16 v[84:87], v[148:151], a[180:183], v[84:87]
    buffer_load_dwordx4 v[144:147], v23, s[24:27], s58 offen offset:0 sc1
    v_mfma_f32_16x16x32_bf16 v[88:91], v[148:151], a[184:187], v[88:91]
    v_add_f32 v96, v96, v108
    v_add_f32 v97, v97, v109
    v_mfma_f32_16x16x32_bf16 v[92:95], v[148:151], a[188:191], v[92:95]
    v_add_f32 v98, v98, v110
    s_waitcnt vmcnt(10)
    v_mfma_f32_16x16x32_bf16 v[80:83], v[152:155], a[192:195], v[80:83]
    v_mfma_f32_16x16x32_bf16 v[84:87], v[152:155], a[196:199], v[84:87]
    buffer_load_dwordx4 v[148:151], v23, s[24:27], s58 offen offset:1024 sc1
    v_mfma_f32_16x16x32_bf16 v[88:91], v[152:155], a[200:203], v[88:91]
    v_add_f32 v99, v99, v111
    v_mfma_f32_16x16x32_bf16 v[92:95], v[152:155], a[204:207], v[92:95]
    s_waitcnt vmcnt(10)
    v_mfma_f32_16x16x32_bf16 v[80:83], v[156:159], a[208:211], v[80:83]
    s_add_u32 s58, s66, s81
    v_mfma_f32_16x16x32_bf16 v[84:87], v[156:159], a[212:215], v[84:87]
    buffer_load_dwordx4 v[152:155], v23, s[24:27], s58 offen offset:0 sc1
    v_mfma_f32_16x16x32_bf16 v[88:91], v[156:159], a[216:219], v[88:91]
    v_mfma_f32_16x16x32_bf16 v[92:95], v[156:159], a[220:223], v[92:95]
    s_waitcnt vmcnt(10)
    v_mfma_f32_16x16x32_bf16 v[64:67], v[112:115], a[0:3], v[64:67]
    v_mfma_f32_16x16x32_bf16 v[68:71], v[112:115], a[4:7], 0
    buffer_load_dwordx4 v[156:159], v23, s[24:27], s58 offen offset:1024 sc1
    v_mfma_f32_16x16x32_bf16 v[72:75], v[112:115], a[8:11], 0
    ds_read_b64_tr_b16 v[192:193], v16 offset:1024
    v_mfma_f32_16x16x32_bf16 v[76:79], v[112:115], a[12:15], 0
    ds_read_b64_tr_b16 v[194:195], v16 offset:1536
    s_waitcnt vmcnt(10)
    v_mfma_f32_16x16x32_bf16 v[64:67], v[116:119], a[16:19], v[64:67]
    s_add_u32 s58, s66, s82
    v_mfma_f32_16x16x32_bf16 v[68:71], v[116:119], a[20:23], v[68:71]
    buffer_load_dwordx4 v[112:115], v23, s[24:27], s58 offen offset:0 sc1
    v_mfma_f32_16x16x32_bf16 v[72:75], v[116:119], a[24:27], v[72:75]
    ds_read_b64_tr_b16 v[196:197], v16 offset:5120
    ds_read_b64_tr_b16 v[198:199], v16 offset:5632
    v_mfma_f32_16x16x32_bf16 v[76:79], v[116:119], a[28:31], v[76:79]
    ds_write_b128 v232, v[84:87] offset:49152
    s_waitcnt vmcnt(10)
    v_mfma_f32_16x16x32_bf16 v[64:67], v[120:123], a[32:35], v[64:67]
    v_mfma_f32_16x16x32_bf16 v[68:71], v[120:123], a[36:39], v[68:71]
    buffer_load_dwordx4 v[116:119], v23, s[24:27], s58 offen offset:1024 sc1
    v_mfma_f32_16x16x32_bf16 v[72:75], v[120:123], a[40:43], v[72:75]
    ds_read_b64_tr_b16 v[200:201], v16 offset:9216
    ds_read_b64_tr_b16 v[202:203], v16 offset:9728
    v_mfma_f32_16x16x32_bf16 v[76:79], v[120:123], a[44:47], v[76:79]
    ds_write_b128 v232, v[88:91] offset:50176
    s_waitcnt vmcnt(10)
    v_mfma_f32_16x16x32_bf16 v[64:67], v[124:127], a[48:51], v[64:67]
    s_add_u32 s66, s69, 58624
    s_add_u32 s58, s66, s76
    v_mfma_f32_16x16x32_bf16 v[68:71], v[124:127], a[52:55], v[68:71]
    buffer_load_dwordx4 v[120:123], v23, s[24:27], s58 offen offset:0 sc1
    v_mfma_f32_16x16x32_bf16 v[72:75], v[124:127], a[56:59], v[72:75]
    ds_read_b64_tr_b16 v[204:205], v16 offset:13312
    ds_read_b64_tr_b16 v[206:207], v16 offset:13824
    v_mfma_f32_16x16x32_bf16 v[76:79], v[124:127], a[60:63], v[76:79]
    ds_write_b128 v232, v[92:95] offset:51200
    s_waitcnt vmcnt(10)
    v_mfma_f32_16x16x32_bf16 v[64:67], v[128:131], a[64:67], v[64:67]
    v_mfma_f32_16x16x32_bf16 v[68:71], v[128:131], a[68:71], v[68:71]
    buffer_load_dwordx4 v[124:127], v23, s[24:27], s58 offen offset:1024 sc1
    v_mfma_f32_16x16x32_bf16 v[72:75], v[128:131], a[72:75], v[72:75]
    ds_read_b64_tr_b16 v[100:101], v16 offset:2048
    v_mfma_f32_16x16x32_bf16 v[76:79], v[128:131], a[76:79], v[76:79]
    ds_read_b64_tr_b16 v[102:103], v16 offset:2560
    s_waitcnt vmcnt(10)
    v_mfma_f32_16x16x32_bf16 v[64:67], v[132:135], a[80:83], v[64:67]
    s_add_u32 s58, s66, s77
    v_mfma_f32_16x16x32_bf16 v[68:71], v[132:135], a[84:87], v[68:71]
    buffer_load_dwordx4 v[128:131], v23, s[24:27], s58 offen offset:0 sc1
    v_mfma_f32_16x16x32_bf16 v[72:75], v[132:135], a[88:91], v[72:75]
    s_waitcnt lgkmcnt(2)
    s_barrier
    v_mfma_f32_16x16x32_bf16 v[76:79], v[132:135], a[92:95], v[76:79]
    s_waitcnt vmcnt(10)
    v_mfma_f32_16x16x32_bf16 v[64:67], v[136:139], a[96:99], v[64:67]
    v_mfma_f32_16x16x32_bf16 v[68:71], v[136:139], a[100:103], v[68:71]
    buffer_load_dwordx4 v[132:135], v23, s[24:27], s58 offen offset:1024 sc1
    v_mfma_f32_16x16x32_bf16 v[72:75], v[136:139], a[104:107], v[72:75]
    ds_read_b128 v[84:87], v233 offset:49152
    ds_read_b128 v[88:91], v234 offset:50176
    v_mfma_f32_16x16x32_bf16 v[76:79], v[136:139], a[108:111], v[76:79]
    ds_read_b128 v[92:95], v235 offset:51200
    s_waitcnt vmcnt(10)
    v_mfma_f32_16x16x32_bf16 v[64:67], v[140:143], a[112:115], v[64:67]
    s_add_u32 s58, s66, s78
    v_mfma_f32_16x16x32_bf16 v[68:71], v[140:143], a[116:119], v[68:71]
    buffer_load_dwordx4 v[136:139], v23, s[24:27], s58 offen offset:0 sc1
    v_mfma_f32_16x16x32_bf16 v[72:75], v[140:143], a[120:123], v[72:75]
    ds_read_b64_tr_b16 a[224:225], v246 offset:0
    v_mfma_f32_16x16x32_bf16 v[76:79], v[140:143], a[124:127], v[76:79]
    ds_read_b64_tr_b16 a[226:227], v246 offset:512
    s_waitcnt vmcnt(10)
    v_mfma_f32_16x16x32_bf16 v[64:67], v[144:147], a[128:131], v[64:67]
    s_waitcnt lgkmcnt(2)
    v_mfma_f32_16x16x32_bf16 v[68:71], v[144:147], a[132:135], v[68:71]
    buffer_load_dwordx4 v[140:143], v23, s[24:27], s58 offen offset:1024 sc1
    v_mfma_f32_16x16x32_bf16 v[72:75], v[144:147], a[136:139], v[72:75]
    v_add_f32 v80, v80, v84
    v_add_f32 v81, v81, v85
    ds_read_b64_tr_b16 a[228:229], v247 offset:0
    v_mfma_f32_16x16x32_bf16 v[76:79], v[144:147], a[140:143], v[76:79]
    ds_read_b64_tr_b16 a[230:231], v247 offset:512
    s_waitcnt vmcnt(10)
    v_mfma_f32_16x16x32_bf16 v[64:67], v[148:151], a[144:147], v[64:67]
    s_add_u32 s58, s66, s79
    v_add_f32 v82, v82, v86
    v_mfma_f32_16x16x32_bf16 v[68:71], v[148:151], a[148:151], v[68:71]
    buffer_load_dwordx4 v[144:147], v23, s[24:27], s58 offen offset:0 sc1
    v_mfma_f32_16x16x32_bf16 v[72:75], v[148:151], a[152:155], v[72:75]
    v_add_f32 v83, v83, v87
    v_add_f32 v80, v80, v88
    ds_read_b64_tr_b16 a[232:233], v246 offset:256
    v_mfma_f32_16x16x32_bf16 v[76:79], v[148:151], a[156:159], v[76:79]
    ds_read_b64_tr_b16 a[234:235], v246 offset:768
    s_waitcnt vmcnt(10)
    v_mfma_f32_16x16x32_bf16 v[64:67], v[152:155], a[160:163], v[64:67]
    v_add_f32 v81, v81, v89
    v_mfma_f32_16x16x32_bf16 v[68:71], v[152:155], a[164:167], v[68:71]
    buffer_load_dwordx4 v[148:151], v23, s[24:27], s58 offen offset:1024 sc1
    v_mfma_f32_16x16x32_bf16 v[72:75], v[152:155], a[168:171], v[72:75]
    v_add_f32 v82, v82, v90
    v_add_f32 v83, v83, v91
    ds_read_b64_tr_b16 a[236:237], v247 offset:256
    v_mfma_f32_16x16x32_bf16 v[76:79], v[152:155], a[172:175], v[76:79]
    ds_read_b64_tr_b16 a[238:239], v247 offset:768
    s_waitcnt vmcnt(10)
    v_mfma_f32_16x16x32_bf16 v[64:67], v[156:159], a[176:179], v[64:67]
    s_add_u32 s58, s66, s80
    v_mfma_f32_16x16x32_bf16 v[68:71], v[156:159], a[180:183], v[68:71]
    buffer_load_dwordx4 v[152:155], v23, s[24:27], s58 offen offset:0 sc1
    v_mfma_f32_16x16x32_bf16 v[72:75], v[156:159], a[184:187], v[72:75]
    v_add_f32 v80, v80, v92
    v_add_f32 v81, v81, v93
    v_mfma_f32_16x16x32_bf16 v[76:79], v[156:159], a[188:191], v[76:79]
    v_add_f32 v82, v82, v94
    s_waitcnt vmcnt(10)
    v_mfma_f32_16x16x32_bf16 v[64:67], v[112:115], a[192:195], v[64:67]
    v_mfma_f32_16x16x32_bf16 v[68:71], v[112:115], a[196:199], v[68:71]
    buffer_load_dwordx4 v[156:159], v23, s[24:27], s58 offen offset:1024 sc1
    v_mfma_f32_16x16x32_bf16 v[72:75], v[112:115], a[200:203], v[72:75]
    v_add_f32 v83, v83, v95
    v_mfma_f32_16x16x32_bf16 v[76:79], v[112:115], a[204:207], v[76:79]
    s_waitcnt vmcnt(10)
    v_mfma_f32_16x16x32_bf16 v[64:67], v[116:119], a[208:211], v[64:67]
    s_add_u32 s58, s66, s81
    v_mfma_f32_16x16x32_bf16 v[68:71], v[116:119], a[212:215], v[68:71]
    buffer_load_dwordx4 v[112:115], v23, s[24:27], s58 offen offset:0 sc1
    v_mfma_f32_16x16x32_bf16 v[72:75], v[116:119], a[216:219], v[72:75]
    v_mfma_f32_16x16x32_bf16 v[76:79], v[116:119], a[220:223], v[76:79]
    s_waitcnt vmcnt(10)
    v_mfma_f32_16x16x32_bf16 v[48:51], v[120:123], a[0:3], v[48:51]
    v_mfma_f32_16x16x32_bf16 v[52:55], v[120:123], a[4:7], 0
    buffer_load_dwordx4 v[116:119], v23, s[24:27], s58 offen offset:1024 sc1
    v_mfma_f32_16x16x32_bf16 v[56:59], v[120:123], a[8:11], 0
    ds_read_b64_tr_b16 v[104:105], v16 offset:6144
    v_mfma_f32_16x16x32_bf16 v[60:63], v[120:123], a[12:15], 0
    ds_read_b64_tr_b16 v[106:107], v16 offset:6656
    s_waitcnt vmcnt(10)
    v_mfma_f32_16x16x32_bf16 v[48:51], v[124:127], a[16:19], v[48:51]
    s_add_u32 s58, s66, s82
    v_mfma_f32_16x16x32_bf16 v[52:55], v[124:127], a[20:23], v[52:55]
    buffer_load_dwordx4 v[120:123], v23, s[24:27], s58 offen offset:0 sc1
    v_mfma_f32_16x16x32_bf16 v[56:59], v[124:127], a[24:27], v[56:59]
    ds_read_b64_tr_b16 v[108:109], v16 offset:10240
    ds_read_b64_tr_b16 v[110:111], v16 offset:10752
    v_mfma_f32_16x16x32_bf16 v[60:63], v[124:127], a[28:31], v[60:63]
    ds_write_b128 v232, v[68:71] offset:32768
    s_waitcnt vmcnt(10)
    v_mfma_f32_16x16x32_bf16 v[48:51], v[128:131], a[32:35], v[48:51]
    v_mfma_f32_16x16x32_bf16 v[52:55], v[128:131], a[36:39], v[52:55]
    buffer_load_dwordx4 v[124:127], v23, s[24:27], s58 offen offset:1024 sc1
    v_mfma_f32_16x16x32_bf16 v[56:59], v[128:131], a[40:43], v[56:59]
    ds_read_b64_tr_b16 v[84:85], v16 offset:14336
    ds_read_b64_tr_b16 v[86:87], v16 offset:14848
    v_mfma_f32_16x16x32_bf16 v[60:63], v[128:131], a[44:47], v[60:63]
    ds_write_b128 v232, v[72:75] offset:33792
    s_waitcnt vmcnt(10)
    v_mfma_f32_16x16x32_bf16 v[48:51], v[132:135], a[48:51], v[48:51]
    s_add_u32 s66, s69, 0
    s_add_u32 s58, s66, s76
    v_mfma_f32_16x16x32_bf16 v[52:55], v[132:135], a[52:55], v[52:55]
    buffer_load_dwordx4 v[128:131], v23, s[24:27], s58 offen offset:0 sc1
    v_mfma_f32_16x16x32_bf16 v[56:59], v[132:135], a[56:59], v[56:59]
    ds_read_b64_tr_b16 v[88:89], v16 offset:3072
    ds_read_b64_tr_b16 v[90:91], v16 offset:3584
    v_mfma_f32_16x16x32_bf16 v[60:63], v[132:135], a[60:63], v[60:63]
    ds_write_b128 v232, v[76:79] offset:34816
    s_waitcnt vmcnt(10)
    v_mfma_f32_16x16x32_bf16 v[48:51], v[136:139], a[64:67], v[48:51]
    v_mfma_f32_16x16x32_bf16 v[52:55], v[136:139], a[68:71], v[52:55]
    buffer_load_dwordx4 v[132:135], v23, s[24:27], s58 offen offset:1024 sc1
    v_mfma_f32_16x16x32_bf16 v[56:59], v[136:139], a[72:75], v[56:59]
    ds_read_b64_tr_b16 v[92:93], v16 offset:7168
    v_mfma_f32_16x16x32_bf16 v[60:63], v[136:139], a[76:79], v[60:63]
    ds_read_b64_tr_b16 v[94:95], v16 offset:7680
    s_waitcnt vmcnt(10)
    v_mfma_f32_16x16x32_bf16 v[48:51], v[140:143], a[80:83], v[48:51]
    s_add_u32 s58, s66, s77
    v_mfma_f32_16x16x32_bf16 v[52:55], v[140:143], a[84:87], v[52:55]
    buffer_load_dwordx4 v[136:139], v23, s[24:27], s58 offen offset:0 sc1
    v_mfma_f32_16x16x32_bf16 v[56:59], v[140:143], a[88:91], v[56:59]
    s_waitcnt lgkmcnt(2)
    s_barrier
    v_mfma_f32_16x16x32_bf16 v[60:63], v[140:143], a[92:95], v[60:63]
    buffer_load_dword v19, v21, s[24:27], 0 offen sc1
    s_waitcnt vmcnt(11)
    v_mfma_f32_16x16x32_bf16 v[48:51], v[144:147], a[96:99], v[48:51]
    ds_read_b128 v[68:71], v233 offset:32768
    v_mfma_f32_16x16x32_bf16 v[52:55], v[144:147], a[100:103], v[52:55]
    ds_read_b128 v[72:75], v234 offset:33792
    v_mfma_f32_16x16x32_bf16 v[56:59], v[144:147], a[104:107], v[56:59]
    ds_read_b128 v[76:79], v235 offset:34816
    v_mfma_f32_16x16x32_bf16 v[60:63], v[144:147], a[108:111], v[60:63]
    s_waitcnt vmcnt(10)
    v_mfma_f32_16x16x32_bf16 v[48:51], v[148:151], a[112:115], v[48:51]
    v_mfma_f32_16x16x32_bf16 v[52:55], v[148:151], a[116:119], v[52:55]
    buffer_load_dwordx4 v[140:143], v23, s[24:27], s58 offen offset:1024 sc1
    v_mfma_f32_16x16x32_bf16 v[56:59], v[148:151], a[120:123], v[56:59]
    ds_read_b64_tr_b16 a[240:241], v246 offset:4096
    v_mfma_f32_16x16x32_bf16 v[60:63], v[148:151], a[124:127], v[60:63]
    ds_read_b64_tr_b16 a[242:243], v246 offset:4608
    s_waitcnt vmcnt(10)
    v_mfma_f32_16x16x32_bf16 v[48:51], v[152:155], a[128:131], v[48:51]
    s_add_u32 s58, s66, s78
    s_waitcnt lgkmcnt(2)
    v_mfma_f32_16x16x32_bf16 v[52:55], v[152:155], a[132:135], v[52:55]
    buffer_load_dwordx4 v[144:147], v23, s[24:27], s58 offen offset:0 sc1
    v_mfma_f32_16x16x32_bf16 v[56:59], v[152:155], a[136:139], v[56:59]
    v_add_f32 v64, v64, v68
    v_add_f32 v65, v65, v69
    ds_read_b64_tr_b16 a[244:245], v247 offset:4096
    v_mfma_f32_16x16x32_bf16 v[60:63], v[152:155], a[140:143], v[60:63]
    ds_read_b64_tr_b16 a[246:247], v247 offset:4608
    s_waitcnt vmcnt(10)
    v_mfma_f32_16x16x32_bf16 v[48:51], v[156:159], a[144:147], v[48:51]
    v_add_f32 v66, v66, v70
    v_mfma_f32_16x16x32_bf16 v[52:55], v[156:159], a[148:151], v[52:55]
    buffer_load_dwordx4 v[148:151], v23, s[24:27], s58 offen offset:1024 sc1
    v_mfma_f32_16x16x32_bf16 v[56:59], v[156:159], a[152:155], v[56:59]
    v_add_f32 v67, v67, v71
    v_add_f32 v64, v64, v72
    ds_read_b64_tr_b16 a[248:249], v246 offset:4352
    v_mfma_f32_16x16x32_bf16 v[60:63], v[156:159], a[156:159], v[60:63]
    ds_read_b64_tr_b16 a[250:251], v246 offset:4864
    s_waitcnt vmcnt(10)
    v_mfma_f32_16x16x32_bf16 v[48:51], v[112:115], a[160:163], v[48:51]
    s_add_u32 s58, s66, s79
    v_add_f32 v65, v65, v73
    v_mfma_f32_16x16x32_bf16 v[52:55], v[112:115], a[164:167], v[52:55]
    buffer_load_dwordx4 v[152:155], v23, s[24:27], s58 offen offset:0 sc1
    v_mfma_f32_16x16x32_bf16 v[56:59], v[112:115], a[168:171], v[56:59]
    v_add_f32 v66, v66, v74
    v_add_f32 v67, v67, v75
    ds_read_b64_tr_b16 a[252:253], v247 offset:4352
    v_mfma_f32_16x16x32_bf16 v[60:63], v[112:115], a[172:175], v[60:63]
    ds_read_b64_tr_b16 a[254:255], v247 offset:4864
    s_waitcnt vmcnt(10)
    v_mfma_f32_16x16x32_bf16 v[48:51], v[116:119], a[176:179], v[48:51]
    v_mfma_f32_16x16x32_bf16 v[52:55], v[116:119], a[180:183], v[52:55]
    buffer_load_dwordx4 v[156:159], v23, s[24:27], s58 offen offset:1024 sc1
    v_mfma_f32_16x16x32_bf16 v[56:59], v[116:119], a[184:187], v[56:59]
    v_add_f32 v64, v64, v76
    v_add_f32 v65, v65, v77
    v_mfma_f32_16x16x32_bf16 v[60:63], v[116:119], a[188:191], v[60:63]
    v_add_f32 v66, v66, v78
    s_waitcnt vmcnt(10)
    v_mfma_f32_16x16x32_bf16 v[48:51], v[120:123], a[192:195], v[48:51]
    s_add_u32 s58, s66, s80
    v_mfma_f32_16x16x32_bf16 v[52:55], v[120:123], a[196:199], v[52:55]
    buffer_load_dwordx4 v[112:115], v23, s[24:27], s58 offen offset:0 sc1
    v_mfma_f32_16x16x32_bf16 v[56:59], v[120:123], a[200:203], v[56:59]
    v_add_f32 v67, v67, v79
    v_mfma_f32_16x16x32_bf16 v[60:63], v[120:123], a[204:207], v[60:63]
    s_waitcnt vmcnt(10)
    v_mfma_f32_16x16x32_bf16 v[48:51], v[124:127], a[208:211], v[48:51]
    v_mfma_f32_16x16x32_bf16 v[52:55], v[124:127], a[212:215], v[52:55]
    buffer_load_dwordx4 v[116:119], v23, s[24:27], s58 offen offset:1024 sc1
    v_mfma_f32_16x16x32_bf16 v[56:59], v[124:127], a[216:219], v[56:59]
    v_mfma_f32_16x16x32_bf16 v[60:63], v[124:127], a[220:223], v[60:63]
    s_waitcnt vmcnt(10)
    v_mfma_f32_16x16x32_bf16 v[32:35], v[128:131], a[0:3], v[32:35]
    s_add_u32 s58, s66, s81
    v_mfma_f32_16x16x32_bf16 v[36:39], v[128:131], a[4:7], 0
    buffer_load_dwordx4 v[120:123], v23, s[24:27], s58 offen offset:0 sc1
    v_mfma_f32_16x16x32_bf16 v[40:43], v[128:131], a[8:11], 0
    v_mfma_f32_16x16x32_bf16 v[44:47], v[128:131], a[12:15], 0
    s_waitcnt vmcnt(10)
    v_mfma_f32_16x16x32_bf16 v[32:35], v[132:135], a[16:19], v[32:35]
    ds_write_b128 v232, v[52:55] offset:16384
    v_mfma_f32_16x16x32_bf16 v[36:39], v[132:135], a[20:23], v[36:39]
    buffer_load_dwordx4 v[124:127], v23, s[24:27], s58 offen offset:1024 sc1
    v_mfma_f32_16x16x32_bf16 v[40:43], v[132:135], a[24:27], v[40:43]
    ds_read_b64_tr_b16 a[0:1], v246 offset:8192
    ds_read_b64_tr_b16 a[2:3], v246 offset:8704
    ds_read_b64_tr_b16 a[4:5], v247 offset:8192
    v_mfma_f32_16x16x32_bf16 v[44:47], v[132:135], a[28:31], v[44:47]
    ds_read_b64_tr_b16 a[6:7], v247 offset:8704
    s_waitcnt vmcnt(10)
    v_mfma_f32_16x16x32_bf16 v[32:35], v[136:139], a[32:35], v[32:35]
    s_add_u32 s58, s66, s82
    ds_write_b128 v232, v[56:59] offset:17408
    v_mfma_f32_16x16x32_bf16 v[36:39], v[136:139], a[36:39], v[36:39]
    buffer_load_dwordx4 v[128:131], v23, s[24:27], s58 offen offset:0 sc1
    v_mfma_f32_16x16x32_bf16 v[40:43], v[136:139], a[40:43], v[40:43]
    ds_read_b64_tr_b16 a[8:9], v246 offset:8448
    ds_read_b64_tr_b16 a[10:11], v246 offset:8960
    ds_read_b64_tr_b16 a[12:13], v247 offset:8448
    v_mfma_f32_16x16x32_bf16 v[44:47], v[136:139], a[44:47], v[44:47]
    ds_read_b64_tr_b16 a[14:15], v247 offset:8960
    buffer_load_dwordx4 v[132:135], v23, s[24:27], s58 offen offset:1024 sc1
    s_waitcnt vmcnt(11)
    v_cmp_ne_u32 vcc, s47, v19
    s_nop 0
    s_cbranch_vccz L_ok10
    s_mov_b32 s59, 100000
L_spin9:
    buffer_load_dword v19, v21, s[24:27], 0 offen sc1
    s_waitcnt vmcnt(0)
    v_cmp_ne_u32 vcc, s47, v19
    s_nop 0
    s_cbranch_vccz L_ok10
    s_sub_u32 s59, s59, 1
    s_cbranch_scc0 L_spin9
L_ok10:
    s_waitcnt vmcnt(10)
    v_mfma_f32_16x16x32_bf16 v[32:35], v[140:143], a[48:51], v[32:35]
    s_add_u32 s58, s70, 0
    ds_write_b128 v232, v[60:63] offset:18432
    v_mfma_f32_16x16x32_bf16 v[36:39], v[140:143], a[52:55], v[36:39]
    buffer_load_dwordx4 v[136:139], v23, s[24:27], s58 offen offset:0 sc1
    v_mfma_f32_16x16x32_bf16 v[40:43], v[140:143], a[56:59], v[40:43]
    ds_read_b64_tr_b16 a[16:17], v246 offset:12288
    ds_read_b64_tr_b16 a[18:19], v246 offset:12800
    ds_read_b64_tr_b16 a[20:21], v247 offset:12288
    v_mfma_f32_16x16x32_bf16 v[44:47], v[140:143], a[60:63], v[44:47]
    ds_read_b64_tr_b16 a[22:23], v247 offset:12800
    s_waitcnt vmcnt(10)
    v_mfma_f32_16x16x32_bf16 v[32:35], v[144:147], a[64:67], v[32:35]
    ds_read_b64_tr_b16 a[24:25], v246 offset:12544
    v_mfma_f32_16x16x32_bf16 v[36:39], v[144:147], a[68:71], v[36:39]
    buffer_load_dwordx4 v[140:143], v23, s[24:27], s58 offen offset:1024 sc1
L_wb_3:
    s_cbranch_execz L_wb_ret
    v_mfma_f32_16x16x32_bf16 v[40:43], v[144:147], a[72:75], v[40:43]
    ds_read_b64_tr_b16 a[26:27], v246 offset:13056
    ds_read_b64_tr_b16 a[28:29], v247 offset:12544
    v_mfma_f32_16x16x32_bf16 v[44:47], v[144:147], a[76:79], v[44:47]
    ds_read_b64_tr_b16 a[30:31], v247 offset:13056
    s_waitcnt vmcnt(10)
    v_mfma_f32_16x16x32_bf16 v[32:35], v[148:151], a[80:83], v[32:35]
    ds_read_b64_tr_b16 a[32:33], v246 offset:16384
    v_mfma_f32_16x16x32_bf16 v[36:39], v[148:151], a[84:87], v[36:39]
    buffer_load_dwordx4 v[144:147], v23, s[24:27], s58 offen offset:2048 sc1
    v_mfma_f32_16x16x32_bf16 v[40:43], v[148:151], a[88:91], v[40:43]
    ds_read_b64_tr_b16 a[34:35], v246 offset:16896
    ds_read_b64_tr_b16 a[36:37], v247 offset:16384
    v_mfma_f32_16x16x32_bf16 v[44:47], v[148:151], a[92:95], v[44:47]
    ds_read_b64_tr_b16 a[38:39], v247 offset:16896
    s_waitcnt vmcnt(10)
    v_mfma_f32_16x16x32_bf16 v[32:35], v[152:155], a[96:99], v[32:35]
    ds_read_b64_tr_b16 a[40:41], v246 offset:16640
    v_mfma_f32_16x16x32_bf16 v[36:39], v[152:155], a[100:103], v[36:39]
    buffer_load_dwordx4 v[148:151], v23, s[24:27], s58 offen offset:3072 sc1
    v_mfma_f32_16x16x32_bf16 v[40:43], v[152:155], a[104:107], v[40:43]
    ds_read_b64_tr_b16 a[42:43], v246 offset:17152
    ds_read_b64_tr_b16 a[44:45], v247 offset:16640
    v_mfma_f32_16x16x32_bf16 v[44:47], v[152:155], a[108:111], v[44:47]
    ds_read_b64_tr_b16 a[46:47], v247 offset:17152
    s_waitcnt vmcnt(10)
    v_mfma_f32_16x16x32_bf16 v[32:35], v[156:159], a[112:115], v[32:35]
    s_add_u32 s58, s70, 4096
    ds_read_b64_tr_b16 a[48:49], v246 offset:20480
    v_mfma_f32_16x16x32_bf16 v[36:39], v[156:159], a[116:119], v[36:39]
    buffer_load_dwordx4 v[152:155], v23, s[24:27], s58 offen offset:0 sc1
    v_mfma_f32_16x16x32_bf16 v[40:43], v[156:159], a[120:123], v[40:43]
    ds_read_b64_tr_b16 a[50:51], v246 offset:20992
    ds_read_b64_tr_b16 a[52:53], v247 offset:20480
    v_mfma_f32_16x16x32_bf16 v[44:47], v[156:159], a[124:127], v[44:47]
    ds_read_b64_tr_b16 a[54:55], v247 offset:20992
    s_waitcnt vmcnt(10)
    v_mfma_f32_16x16x32_bf16 v[32:35], v[112:115], a[128:131], v[32:35]
    ds_read_b64_tr_b16 a[56:57], v246 offset:20736
    v_mfma_f32_16x16x32_bf16 v[36:39], v[112:115], a[132:135], v[36:39]
    buffer_load_dwordx4 v[156:159], v23, s[24:27], s58 offen offset:1024 sc1
    v_mfma_f32_16x16x32_bf16 v[40:43], v[112:115], a[136:139], v[40:43]
    ds_read_b64_tr_b16 a[58:59], v246 offset:21248
    ds_read_b64_tr_b16 a[60:61], v247 offset:20736
    v_mfma_f32_16x16x32_bf16 v[44:47], v[112:115], a[140:143], v[44:47]
    ds_read_b64_tr_b16 a[62:63], v247 offset:21248
    s_waitcnt vmcnt(10)
    v_mfma_f32_16x16x32_bf16 v[32:35], v[116:119], a[144:147], v[32:35]
    ds_read_b64_tr_b16 a[64:65], v246 offset:24576
    v_mfma_f32_16x16x32_bf16 v[36:39], v[116:119], a[148:151], v[36:39]
    buffer_load_dwordx4 v[112:115], v23, s[24:27], s58 offen offset:2048 sc1
    v_mfma_f32_16x16x32_bf16 v[40:43], v[116:119], a[152:155], v[40:43]
    ds_read_b64_tr_b16 a[66:67], v246 offset:25088
    ds_read_b64_tr_b16 a[68:69], v247 offset:24576
    v_mfma_f32_16x16x32_bf16 v[44:47], v[116:119], a[156:159], v[44:47]
    ds_read_b64_tr_b16 a[70:71], v247 offset:25088
    s_waitcnt vmcnt(10)
    v_mfma_f32_16x16x32_bf16 v[32:35], v[120:123], a[160:163], v[32:35]
    ds_read_b64_tr_b16 a[72:73], v246 offset:24832
    v_mfma_f32_16x16x32_bf16 v[36:39], v[120:123], a[164:167], v[36:39]
    buffer_load_dwordx4 v[116:119], v23, s[24:27], s58 offen offset:3072 sc1
    v_mfma_f32_16x16x32_bf16 v[40:43], v[120:123], a[168:171], v[40:43]
    ds_read_b64_tr_b16 a[74:75], v246 offset:25344
    ds_read_b64_tr_b16 a[76:77], v247 offset:24832
    v_mfma_f32_16x16x32_bf16 v[44:47], v[120:123], a[172:175], v[44:47]
    ds_read_b64_tr_b16 a[78:79], v247 offset:25344
    s_waitcnt vmcnt(10)
    v_mfma_f32_16x16x32_bf16 v[32:35], v[124:127], a[176:179], v[32:35]
    s_add_u32 s58, s70, 8192
    ds_read_b64_tr_b16 a[80:81], v246 offset:28672
    v_mfma_f32_16x16x32_bf16 v[36:39], v[124:127], a[180:183], v[36:39]
    buffer_load_dwordx4 v[120:123], v23, s[24:27], s58 offen offset:0 sc1
    v_mfma_f32_16x16x32_bf16 v[40:43], v[124:127], a[184:187], v[40:43]
    ds_read_b64_tr_b16 a[82:83], v246 offset:29184
    ds_read_b64_tr_b16 a[84:85], v247 offset:28672
    v_mfma_f32_16x16x32_bf16 v[44:47], v[124:127], a[188:191], v[44:47]
    ds_read_b64_tr_b16 a[86:87], v247 offset:29184
    s_waitcnt vmcnt(10)
    v_mfma_f32_16x16x32_bf16 v[32:35], v[128:131], a[192:195], v[32:35]
    ds_read_b64_tr_b16 a[88:89], v246 offset:28928
    v_mfma_f32_16x16x32_bf16 v[36:39], v[128:131], a[196:199], v[36:39]
    buffer_load_dwordx4 v[124:127], v23, s[24:27], s58 offen offset:1024 sc1
    v_mfma_f32_16x16x32_bf16 v[40:43], v[128:131], a[200:203], v[40:43]
    ds_read_b64_tr_b16 a[90:91], v246 offset:29440
    ds_read_b64_tr_b16 a[92:93], v247 offset:28928
    v_mfma_f32_16x16x32_bf16 v[44:47], v[128:131], a[204:207], v[44:47]
    ds_read_b64_tr_b16 a[94:95], v247 offset:29440
    s_waitcnt vmcnt(10)
    v_mfma_f32_16x16x32_bf16 v[32:35], v[132:135], a[208:211], v[32:35]
    ds_read_b64_tr_b16 a[96:97], v246 offset:32768
    v_mfma_f32_16x16x32_bf16 v[36:39], v[132:135], a[212:215], v[36:39]
    buffer_load_dwordx4 v[128:131], v23, s[24:27], s58 offen offset:2048 sc1
    v_mfma_f32_16x16x32_bf16 v[40:43], v[132:135], a[216:219], v[40:43]
    ds_read_b64_tr_b16 a[98:99], v246 offset:33280
    ds_read_b64_tr_b16 a[100:101], v247 offset:32768
    v_mfma_f32_16x16x32_bf16 v[44:47], v[132:135], a[220:223], v[44:47]
    ds_read_b64_tr_b16 a[102:103], v247 offset:33280
    s_waitcnt vmcnt(10)
    v_mfma_f32_16x16x32_bf16 v[32:35], a[224:227], v[136:139], v[32:35]
    v_mfma_f32_16x16x32_bf16 v[48:51], a[228:231], v[136:139], v[48:51]
    buffer_load_dwordx4 v[132:135], v23, s[24:27], s58 offen offset:3072 sc1
    v_mfma_f32_16x16x32_bf16 v[64:67], a[232:235], v[136:139], v[64:67]
    ds_read_b64_tr_b16 a[104:105], v246 offset:33024
    ds_read_b64_tr_b16 a[106:107], v246 offset:33536
    v_mfma_f32_16x16x32_bf16 v[80:83], a[236:239], v[136:139], v[80:83]
    ds_read_b64_tr_b16 a[108:109], v247 offset:33024
    ds_read_b64_tr_b16 a[110:111], v247 offset:33536
    v_mfma_f32_16x16x32_bf16 v[96:99], v[160:163], v[136:139], v[96:99]
    ds_read_b64_tr_b16 a[112:113], v246 offset:36864
    s_waitcnt lgkmcnt(15)
    s_waitcnt vmcnt(10)
    v_mfma_f32_16x16x32_bf16 v[32:35], a[240:243], v[140:143], v[32:35]
    s_add_u32 s58, s70, 12288
    v_mfma_f32_16x16x32_bf16 v[48:51], a[244:247], v[140:143], v[48:51]
    buffer_load_dwordx4 v[136:139], v23, s[24:27], s58 offen offset:0 sc1
    v_mfma_f32_16x16x32_bf16 v[64:67], a[248:251], v[140:143], v[64:67]
    ds_read_b64_tr_b16 a[114:115], v246 offset:37376
    ds_read_b64_tr_b16 a[116:117], v247 offset:36864
    v_mfma_f32_16x16x32_bf16 v[80:83], a[252:255], v[140:143], v[80:83]
    ds_read_b64_tr_b16 a[118:119], v247 offset:37376
    ds_read_b64_tr_b16 a[120:121], v246 offset:37120
    v_mfma_f32_16x16x32_bf16 v[96:99], v[164:167], v[140:143], v[96:99]
    ds_write_b128 v232, v[36:39] offset:0
    s_waitcnt vmcnt(10)
    v_mfma_f32_16x16x32_bf16 v[32:35], a[0:3], v[144:147], v[32:35]
    v_mfma_f32_16x16x32_bf16 v[48:51], a[4:7], v[144:147], v[48:51]
    buffer_load_dwordx4 v[140:143], v23, s[24:27], s58 offen offset:1024 sc1
    v_mfma_f32_16x16x32_bf16 v[64:67], a[8:11], v[144:147], v[64:67]
    ds_read_b64_tr_b16 a[122:123], v246 offset:37632
    ds_read_b64_tr_b16 a[124:125], v247 offset:37120
    v_mfma_f32_16x16x32_bf16 v[80:83], a[12:15], v[144:147], v[80:83]
    ds_read_b64_tr_b16 a[126:127], v247 offset:37632
    ds_read_b64_tr_b16 a[128:129], v246 offset:40960
    v_mfma_f32_16x16x32_bf16 v[96:99], v[168:171], v[144:147], v[96:99]
    ds_write_b128 v232, v[40:43] offset:1024
    s_waitcnt vmcnt(10)
    v_mfma_f32_16x16x32_bf16 v[32:35], a[16:19], v[148:151], v[32:35]
    ds_read_b64_tr_b16 a[130:131], v246 offset:41472
    v_mfma_f32_16x16x32_bf16 v[48:51], a[20:23], v[148:151], v[48:51]
    ds_read_b64_tr_b16 a[132:133], v247 offset:40960
    v_mfma_f32_16x16x32_bf16 v[64:67], a[24:27], v[148:151], v[64:67]
    ds_read_b64_tr_b16 a[134:135], v247 offset:41472
    v_mfma_f32_16x16x32_bf16 v[80:83], a[28:31], v[148:151], v[80:83]
    ds_read_b64_tr_b16 a[136:137], v246 offset:41216
    v_mfma_f32_16x16x32_bf16 v[96:99], v[172:175], v[148:151], v[96:99]
    ds_write_b128 v232, v[44:47] offset:2048
    s_waitcnt vmcnt(9)
    v_mfma_f32_16x16x32_bf16 v[32:35], a[32:35], v[152:155], v[32:35]
    ds_read_b64_tr_b16 a[138:139], v246 offset:41728
    v_mfma_f32_16x16x32_bf16 v[48:51], a[36:39], v[152:155], v[48:51]
    ds_read_b64_tr_b16 a[140:141], v247 offset:41216
    v_mfma_f32_16x16x32_bf16 v[64:67], a[40:43], v[152:155], v[64:67]
    ds_read_b64_tr_b16 a[142:143], v247 offset:41728
    v_mfma_f32_16x16x32_bf16 v[80:83], a[44:47], v[152:155], v[80:83]
    ds_read_b64_tr_b16 a[144:145], v246 offset:45056
    v_mfma_f32_16x16x32_bf16 v[96:99], v[192:195], v[152:155], v[96:99]
    ds_read_b64_tr_b16 a[146:147], v246 offset:45568
    s_waitcnt vmcnt(8)
    v_mfma_f32_16x16x32_bf16 v[32:35], a[48:51], v[156:159], v[32:35]
    ds_read_b64_tr_b16 a[148:149], v247 offset:45056
    v_mfma_f32_16x16x32_bf16 v[48:51], a[52:55], v[156:159], v[48:51]
    ds_read_b64_tr_b16 a[150:151], v247 offset:45568
    v_mfma_f32_16x16x32_bf16 v[64:67], a[56:59], v[156:159], v[64:67]
    ds_read_b64_tr_b16 a[152:153], v246 offset:45312
    v_mfma_f32_16x16x32_bf16 v[80:83], a[60:63], v[156:159], v[80:83]
    ds_read_b64_tr_b16 a[154:155], v246 offset:45824
    v_mfma_f32_16x16x32_bf16 v[96:99], v[196:199], v[156:159], v[96:99]
    s_waitcnt lgkmcnt(9)
    s_barrier
    s_waitcnt vmcnt(7)
    v_mfma_f32_16x16x32_bf16 v[32:35], a[64:67], v[112:115], v[32:35]
    ds_read_b64_tr_b16 a[156:157], v247 offset:45312
    ds_read_b64_tr_b16 a[158:159], v247 offset:45824
    v_mfma_f32_16x16x32_bf16 v[48:51], a[68:71], v[112:115], v[48:51]
    ds_read_b64_tr_b16 a[160:161], v248 offset:49152
    ds_read_b64_tr_b16 a[162:163], v248 offset:49664
    v_mfma_f32_16x16x32_bf16 v[64:67], a[72:75], v[112:115], v[64:67]
    ds_read_b128 v[52:55], v233 offset:16384
    v_mfma_f32_16x16x32_bf16 v[80:83], a[76:79], v[112:115], v[80:83]
    ds_read_b128 v[56:59], v234 offset:17408
    v_mfma_f32_16x16x32_bf16 v[96:99], v[200:203], v[112:115], v[96:99]
    ds_read_b128 v[60:63], v235 offset:18432
    s_waitcnt vmcnt(6)
    v_mfma_f32_16x16x32_bf16 v[32:35], a[80:83], v[116:119], v[32:35]
    ds_read_b64_tr_b16 a[164:165], v249 offset:49152
    ds_read_b64_tr_b16 a[166:167], v249 offset:49664
    v_mfma_f32_16x16x32_bf16 v[48:51], a[84:87], v[116:119], v[48:51]
    ds_read_b64_tr_b16 a[168:169], v248 offset:49408
    ds_read_b64_tr_b16 a[170:171], v248 offset:49920
    v_mfma_f32_16x16x32_bf16 v[64:67], a[88:91], v[116:119], v[64:67]
    ds_read_b128 v[36:39], v233 offset:0
    v_mfma_f32_16x16x32_bf16 v[80:83], a[92:95], v[116:119], v[80:83]
    ds_read_b128 v[40:43], v234 offset:1024
    v_mfma_f32_16x16x32_bf16 v[96:99], v[204:207], v[116:119], v[96:99]
    ds_read_b128 v[44:47], v235 offset:2048
    s_waitcnt vmcnt(5)
    v_mfma_f32_16x16x32_bf16 v[32:35], a[96:99], v[120:123], v[32:35]
    ds_read_b64_tr_b16 a[172:173], v249 offset:49408
    v_mfma_f32_16x16x32_bf16 v[48:51], a[100:103], v[120:123], v[48:51]
    ds_read_b64_tr_b16 a[174:175], v249 offset:49920
    v_mfma_f32_16x16x32_bf16 v[64:67], a[104:107], v[120:123], v[64:67]
    ds_read_b64_tr_b16 a[176:177], v248 offset:50176
    v_mfma_f32_16x16x32_bf16 v[80:83], a[108:111], v[120:123], v[80:83]
    ds_read_b64_tr_b16 a[178:179], v248 offset:50688
    v_mfma_f32_16x16x32_bf16 v[96:99], v[100:103], v[120:123], v[96:99]
    ds_read_b64_tr_b16 a[180:181], v249 offset:50176
    s_waitcnt vmcnt(4)
    v_mfma_f32_16x16x32_bf16 v[32:35], a[112:115], v[124:127], v[32:35]
    ds_read_b64_tr_b16 a[182:183], v249 offset:50688
    v_mfma_f32_16x16x32_bf16 v[48:51], a[116:119], v[124:127], v[48:51]
    ds_read_b64_tr_b16 a[184:185], v248 offset:50432
    v_mfma_f32_16x16x32_bf16 v[64:67], a[120:123], v[124:127], v[64:67]
    ds_read_b64_tr_b16 a[186:187], v248 offset:50944
    v_mfma_f32_16x16x32_bf16 v[80:83], a[124:127], v[124:127], v[80:83]
    ds_read_b64_tr_b16 a[188:189], v249 offset:50432
    v_mfma_f32_16x16x32_bf16 v[96:99], v[104:107], v[124:127], v[96:99]
    ds_read_b64_tr_b16 a[190:191], v249 offset:50944
    s_waitcnt lgkmcnt(15)
    s_waitcnt vmcnt(3)
    v_mfma_f32_16x16x32_bf16 v[32:35], a[128:131], v[128:131], v[32:35]
    v_mfma_f32_16x16x32_bf16 v[48:51], a[132:135], v[128:131], v[48:51]
    v_add_f32 v52, v52, v56
    v_mfma_f32_16x16x32_bf16 v[64:67], a[136:139], v[128:131], v[64:67]
    v_add_f32 v53, v53, v57
    v_mfma_f32_16x16x32_bf16 v[80:83], a[140:143], v[128:131], v[80:83]
    v_add_f32 v54, v54, v58
    v_mfma_f32_16x16x32_bf16 v[96:99], v[108:111], v[128:131], v[96:99]
    v_add_f32 v55, v55, v59
    s_waitcnt vmcnt(2)
    v_mfma_f32_16x16x32_bf16 v[32:35], a[144:147], v[132:135], v[32:35]
    v_add_f32 v52, v52, v60
    v_mfma_f32_16x16x32_bf16 v[48:51], a[148:151], v[132:135], v[48:51]
    v_add_f32 v53, v53, v61
    v_mfma_f32_16x16x32_bf16 v[64:67], a[152:155], v[132:135], v[64:67]
    v_add_f32 v54, v54, v62
    v_mfma_f32_16x16x32_bf16 v[80:83], a[156:159], v[132:135], v[80:83]
    v_add_f32 v55, v55, v63
    v_mfma_f32_16x16x32_bf16 v[96:99], v[84:87], v[132:135], v[96:99]
    s_waitcnt lgkmcnt(10)
    s_waitcnt lgkmcnt(8)
    s_waitcnt vmcnt(1)
    v_mfma_f32_16x16x32_bf16 v[32:35], a[160:163], v[136:139], v[32:35]
    v_add_f32 v36, v36, v40
    v_mfma_f32_16x16x32_bf16 v[48:51], a[164:167], v[136:139], v[48:51]
    v_add_f32 v37, v37, v41
    v_mfma_f32_16x16x32_bf16 v[64:67], a[168:171], v[136:139], v[64:67]
    v_add_f32 v38, v38, v42
    v_mfma_f32_16x16x32_bf16 v[80:83], a[172:175], v[136:139], v[80:83]
    v_add_f32 v39, v39, v43
    v_mfma_f32_16x16x32_bf16 v[96:99], v[88:91], v[136:139], v[96:99]
    v_add_f32 v36, v36, v44
    s_waitcnt lgkmcnt(0)
    s_waitcnt vmcnt(0)
    v_mfma_f32_16x16x32_bf16 v[32:35], a[176:179], v[140:143], v[32:35]
    v_add_f32 v37, v37, v45
    v_mfma_f32_16x16x32_bf16 v[48:51], a[180:183], v[140:143], v[48:51]
    v_add_f32 v38, v38, v46
    v_mfma_f32_16x16x32_bf16 v[64:67], a[184:187], v[140:143], v[64:67]
    v_add_f32 v39, v39, v47
    v_mfma_f32_16x16x32_bf16 v[80:83], a[188:191], v[140:143], v[80:83]
    v_mfma_f32_16x16x32_bf16 v[96:99], v[92:95], v[140:143], v[96:99]
    s_nop 0
    v_pk_add_f32 v[32:33], v[32:33], v[36:37]
    v_pk_add_f32 v[34:35], v[34:35], v[38:39]
    v_pk_add_f32 v[48:49], v[48:49], v[52:53]
    v_pk_add_f32 v[50:51], v[50:51], v[54:55]
    v_cvt_pk_bf16_f32 v176, v32, v33
    v_cvt_pk_bf16_f32 v177, v34, v35
    ds_write_b64 v238, v[176:177] offset:0
    v_cvt_pk_bf16_f32 v178, v48, v49
    v_cvt_pk_bf16_f32 v179, v50, v51
    ds_write_b64 v238, v[178:179] offset:32
    v_cvt_pk_bf16_f32 v180, v64, v65
    v_cvt_pk_bf16_f32 v181, v66, v67
    ds_write_b64 v238, v[180:181] offset:64
    v_cvt_pk_bf16_f32 v182, v80, v81
    v_cvt_pk_bf16_f32 v183, v82, v83
    ds_write_b64 v238, v[182:183] offset:96
    ds_read_b128 v[216:219], v244 offset:0
    ds_read_b128 v[220:223], v244 offset:1408
    v_cvt_pk_bf16_f32 v184, v96, v97
    v_cvt_pk_bf16_f32 v185, v98, v99
    ds_write_b64 v238, v[184:185] offset:128
    ds_read_b64 v[224:225], v252 offset:128
    s_waitcnt lgkmcnt(3)
    buffer_store_dwordx4 v[216:219], v22, s[28:31], s71 offen
    s_waitcnt lgkmcnt(2)
    buffer_store_dwordx4 v[220:223], v22, s[28:31], s72 offen
    s_waitcnt lgkmcnt(0)
    buffer_store_dwordx2 v[224:225], v26, s[28:31], s73 offen
L_end:
    s_endpgm
L_p2_alt:
    s_add_u32 s57, s57, 27648
    buffer_load_dwordx4 v11, s[16:19], s57 offen offset:3072 lds
    s_xor_b32 s66, s44, 3
    s_lshl2_add_u32 s66, s51, s66
    s_mul_i32 s66, s66, 66816
    s_lshl2_add_u32 s66, s52, s66
    s_lshl_b32 s86, s65, 10
    s_add_u32 s58, s86, s66
    s_add_u32 s86, s66, 13312
    buffer_load_dwordx4 v[128:131], v23, s[24:27], s58 offen offset:0 sc1
    s_add_u32 s58, s58, 1024
    s_cmp_eq_u32 s58, s86
    s_cselect_b32 s58, s66, s58
    buffer_load_dwordx4 v[132:135], v23, s[24:27], s58 offen offset:0 sc1
    s_add_u32 s58, s58, 1024
    s_cmp_eq_u32 s58, s86
    s_cselect_b32 s58, s66, s58
    buffer_load_dwordx4 v[136:139], v23, s[24:27], s58 offen offset:0 sc1
    s_add_u32 s58, s58, 1024
    s_cmp_eq_u32 s58, s86
    s_cselect_b32 s58, s66, s58
    buffer_load_dwordx4 v[140:143], v23, s[24:27], s58 offen offset:0 sc1
    s_add_u32 s58, s58, 1024
    s_cmp_eq_u32 s58, s86
    s_cselect_b32 s58, s66, s58
    buffer_load_dwordx4 v[144:147], v23, s[24:27], s58 offen offset:0 sc1
    s_add_u32 s58, s58, 1024
    s_cmp_eq_u32 s58, s86
    s_cselect_b32 s58, s66, s58
    buffer_load_dwordx4 v[148:151], v23, s[24:27], s58 offen offset:0 sc1
    s_add_u32 s58, s58, 1024
    s_cmp_eq_u32 s58, s86
    s_cselect_b32 s58, s66, s58
    buffer_load_dwordx4 v[152:155], v23, s[24:27], s58 offen offset:0 sc1
    s_add_u32 s58, s58, 1024
    s_cmp_eq_u32 s58, s86
    s_cselect_b32 s58, s66, s58
    buffer_load_dwordx4 v[156:159], v23, s[24:27], s58 offen offset:0 sc1
    s_add_u32 s58, s58, 1024
    s_cmp_eq_u32 s58, s86
    s_cselect_b32 s58, s66, s58
    buffer_load_dwordx4 v[112:115], v23, s[24:27], s58 offen offset:0 sc1
    s_add_u32 s58, s58, 1024
    s_cmp_eq_u32 s58, s86
    s_cselect_b32 s58, s66, s58
    buffer_load_dwordx4 v[116:119], v23, s[24:27], s58 offen offset:0 sc1
    s_add_u32 s58, s58, 1024
    s_cmp_eq_u32 s58, s86
    s_cselect_b32 s58, s66, s58
    buffer_load_dwordx4 v[120:123], v23, s[24:27], s58 offen offset:0 sc1
    s_waitcnt vmcnt(19)
    ds_read_b64_tr_b16 a[208:209], v4 offset:32768
    ds_read_b64_tr_b16 a[210:211], v4 offset:33280
    ds_read_b64_tr_b16 a[212:213], v5 offset:32768
    ds_read_b64_tr_b16 a[214:215], v5 offset:33280
    ds_read_b64_tr_b16 a[216:217], v4 offset:33024
    ds_read_b64_tr_b16 a[218:219], v4 offset:33536
    ds_read_b64_tr_b16 a[220:221], v5 offset:33024
    ds_read_b64_tr_b16 a[222:223], v5 offset:33536
    s_waitcnt vmcnt(15)
    ds_read_b64_tr_b16 a[224:225], v2 offset:0
    ds_read_b64_tr_b16 a[226:227], v2 offset:512
    ds_read_b64_tr_b16 a[228:229], v3 offset:0
    ds_read_b64_tr_b16 a[230:231], v3 offset:512
    ds_read_b64_tr_b16 a[232:233], v2 offset:256
    ds_read_b64_tr_b16 a[234:235], v2 offset:768
    ds_read_b64_tr_b16 a[236:237], v3 offset:256
    ds_read_b64_tr_b16 a[238:239], v3 offset:768
    s_waitcnt vmcnt(11)
    ds_read_b64_tr_b16 a[240:241], v2 offset:16384
    ds_read_b64_tr_b16 a[242:243], v2 offset:16896
    ds_read_b64_tr_b16 a[244:245], v3 offset:16384
    ds_read_b64_tr_b16 a[246:247], v3 offset:16896
    ds_read_b64_tr_b16 a[248:249], v2 offset:16640
    ds_read_b64_tr_b16 a[250:251], v2 offset:17152
    ds_read_b64_tr_b16 a[252:253], v3 offset:16640
    ds_read_b64_tr_b16 a[254:255], v3 offset:17152
    s_waitcnt lgkmcnt(0)
    s_branch L_p2_join
L_p3_alt:
    s_add_u32 s66, s69, 175872
    s_add_u32 s58, s66, s76
    buffer_load_dwordx4 v[152:155], v23, s[24:27], s58 offen offset:0 sc1
    buffer_load_dwordx4 v[156:159], v23, s[24:27], s58 offen offset:1024 sc1
    s_add_u32 s58, s66, s77
    buffer_load_dwordx4 v[112:115], v23, s[24:27], s58 offen offset:0 sc1
    buffer_load_dwordx4 v[116:119], v23, s[24:27], s58 offen offset:1024 sc1
    s_add_u32 s58, s66, s78
    buffer_load_dwordx4 v[120:123], v23, s[24:27], s58 offen offset:0 sc1
    buffer_load_dwordx4 v[124:127], v23, s[24:27], s58 offen offset:1024 sc1
    s_add_u32 s58, s66, s79
    buffer_load_dwordx4 v[128:131], v23, s[24:27], s58 offen offset:0 sc1
    buffer_load_dwordx4 v[132:135], v23, s[24:27], s58 offen offset:1024 sc1
    s_add_u32 s58, s66, s80
    buffer_load_dwordx4 v[136:139], v23, s[24:27], s58 offen offset:0 sc1
    buffer_load_dwordx4 v[140:143], v23, s[24:27], s58 offen offset:1024 sc1
    s_add_u32 s58, s66, s81
    buffer_load_dwordx4 v[144:147], v23, s[24:27], s58 offen offset:0 sc1
    s_waitcnt vmcnt(11) lgkmcnt(0)
    s_branch L_p3_join
L_help:
    s_sub_u32 s55, s46, 21
    v_lshlrev_b32 v217, 7, v1
    v_lshrrev_b32 v218, 2, v1
    v_lshlrev_b32 v218, 12, v218
    v_lshl_add_u32 v218, v210, 7, v218
    v_mul_u32_u24 v220, 3584, v1
    s_lshl4_add_u32 s54, s44, s65
    s_mul_i32 s54, s54, 114688
    s_lshl_b32 s56, s50, 7
    s_add_u32 s54, s54, s56
    buffer_load_dword v108, v220, s[16:19], s54 offen
    v_mul_u32_u24 v109, 1088, v25
    v_lshl_add_u32 v109, v26, 4, v109
    v_mul_u32_u24 v110, 1088, v209
    v_lshl_add_u32 v110, v208, 5, v110
    v_lshl_add_u32 v110, v210, 3, v110
    s_lshl_b32 s53, s44, 7
    v_add_u32 v110, s53, v110
    v_mul_u32_u24 v111, 66816, v208
    v_lshl_add_u32 v111, v211, 4, v111
    s_mul_i32 s63, s44, 267264
    s_lshl_b32 s53, s2, 8
    s_add_u32 s63, s63, s53
    s_add_u32 s64, s63, 1069056
    v_cmp_gt_u32 vcc, 208, v0
    v_mov_b32 v100, 2130706432
    v_cmp_le_u32 s[92:93], 24, v26
    v_cndmask_b32 v22, v100, v111, vcc
    s_mov_b32 s62, 0x3f803f80
    s_mov_b32 s61, 0xffff0000
    v_mov_b32 v96, 0
    v_mov_b32 v97, 0
    s_waitcnt vmcnt(3)
    v_dot2c_f32_bf16 v96, s62, v32
    v_dot2c_f32_bf16 v97, v32, v32
    v_lshlrev_b32 v40, 16, v32
    v_and_b32 v41, s61, v32
    v_dot2c_f32_bf16 v96, s62, v33
    v_dot2c_f32_bf16 v97, v33, v33
    v_lshlrev_b32 v42, 16, v33
    v_and_b32 v43, s61, v33
    v_dot2c_f32_bf16 v96, s62, v34
    v_dot2c_f32_bf16 v97, v34, v34
    v_lshlrev_b32 v44, 16, v34
    v_and_b32 v45, s61, v34
    v_dot2c_f32_bf16 v96, s62, v35
    v_dot2c_f32_bf16 v97, v35, v35
    v_lshlrev_b32 v46, 16, v35
    v_and_b32 v47, s61, v35
    s_waitcnt vmcnt(2)
    v_dot2c_f32_bf16 v96, s62, v36
    v_dot2c_f32_bf16 v97, v36, v36
    v_lshlrev_b32 v48, 16, v36
    v_and_b32 v49, s61, v36
    v_dot2c_f32_bf16 v96, s62, v37
    v_dot2c_f32_bf16 v97, v37, v37
    v_lshlrev_b32 v50, 16, v37
    v_and_b32 v51, s61, v37
    v_dot2c_f32_bf16 v96, s62, v38
    v_dot2c_f32_bf16 v97, v38, v38
    v_lshlrev_b32 v52, 16, v38
    v_and_b32 v53, s61, v38
    v_dot2c_f32_bf16 v96, s62, v39
    v_dot2c_f32_bf16 v97, v39, v39
    v_lshlrev_b32 v54, 16, v39
    v_and_b32 v55, s61, v39
    buffer_load_dword v29, off, s[40:43], 0 sc1
    v_add_f32_dpp v96, v96, v96 quad_perm:[1,0,3,2] row_mask:0xf bank_mask:0xf
    v_add_f32_dpp v97, v97, v97 quad_perm:[1,0,3,2] row_mask:0xf bank_mask:0xf
    s_nop 0
    v_add_f32_dpp v96, v96, v96 quad_perm:[2,3,0,1] row_mask:0xf bank_mask:0xf
    v_add_f32_dpp v97, v97, v97 quad_perm:[2,3,0,1] row_mask:0xf bank_mask:0xf
    s_nop 0
    v_add_f32_dpp v96, v96, v96 row_half_mirror row_mask:0xf bank_mask:0xf
    v_add_f32_dpp v97, v97, v97 row_half_mirror row_mask:0xf bank_mask:0xf
    s_nop 0
    v_add_f32_dpp v96, v96, v96 row_mirror row_mask:0xf bank_mask:0xf
    v_add_f32_dpp v97, v97, v97 row_mirror row_mask:0xf bank_mask:0xf
    v_mov_b32 v98, v96
    v_mov_b32 v99, v97
    s_nop 0
    v_permlane16_swap_b32 v96, v98
    v_permlane16_swap_b32 v97, v99
    v_add_f32 v96, v96, v98
    v_add_f32 v97, v97, v99
    v_mul_f32 v98, 0x3b124925, v96
    v_mul_f32 v99, 0x3b124925, v97
    v_fma_f32 v99, -v98, v98, v99
    v_max_f32 v99, 0, v99
    v_cvt_pk_bf16_f32 v100, 0, v99
    v_add_f32 v100, 0x3727c5ac, v100
    v_cvt_pk_bf16_f32 v100, 0, v100
    v_sqrt_f32 v100, v100
    s_nop 0
    v_cvt_pk_bf16_f32 v100, 0, v100
    v_rcp_f32 v100, v100
    s_nop 0
    v_mul_f32 v99, v99, v100
    v_mul_f32 v99, v99, v100
    v_cvt_pk_bf16_f32 v104, 0, v99
    v_add_f32 v104, 0x3727c5ac, v104
    v_cvt_pk_bf16_f32 v104, 0, v104
    v_sqrt_f32 v104, v104
    s_nop 0
    v_cvt_pk_bf16_f32 v102, 0, v104
    v_rcp_f32 v104, v102
    s_nop 0
    v_mul_f32 v104, v104, v100
    v_mul_f32 v106, v98, v104
    v_pk_fma_f32 v[56:57], v[40:41], v[104:105], v[106:107] op_sel_hi:[1,0,0] neg_lo:[0,0,1] neg_hi:[0,0,1]
    v_pk_fma_f32 v[58:59], v[42:43], v[104:105], v[106:107] op_sel_hi:[1,0,0] neg_lo:[0,0,1] neg_hi:[0,0,1]
    v_pk_fma_f32 v[60:61], v[44:45], v[104:105], v[106:107] op_sel_hi:[1,0,0] neg_lo:[0,0,1] neg_hi:[0,0,1]
    v_pk_fma_f32 v[62:63], v[46:47], v[104:105], v[106:107] op_sel_hi:[1,0,0] neg_lo:[0,0,1] neg_hi:[0,0,1]
    v_pk_fma_f32 v[64:65], v[48:49], v[104:105], v[106:107] op_sel_hi:[1,0,0] neg_lo:[0,0,1] neg_hi:[0,0,1]
    v_pk_fma_f32 v[66:67], v[50:51], v[104:105], v[106:107] op_sel_hi:[1,0,0] neg_lo:[0,0,1] neg_hi:[0,0,1]
    v_pk_fma_f32 v[68:69], v[52:53], v[104:105], v[106:107] op_sel_hi:[1,0,0] neg_lo:[0,0,1] neg_hi:[0,0,1]
    v_pk_fma_f32 v[70:71], v[54:55], v[104:105], v[106:107] op_sel_hi:[1,0,0] neg_lo:[0,0,1] neg_hi:[0,0,1]
    v_cvt_pk_bf16_f32 v80, v56, v57
    v_cvt_pk_bf16_f32 v81, v58, v59
    v_cvt_pk_bf16_f32 v82, v60, v61
    v_cvt_pk_bf16_f32 v83, v62, v63
    v_cvt_pk_bf16_f32 v84, v64, v65
    v_cvt_pk_bf16_f32 v85, v66, v67
    v_cvt_pk_bf16_f32 v86, v68, v69
    v_cvt_pk_bf16_f32 v87, v70, v71
    v_lshrrev_b32 v102, 16, v102
    v_cndmask_b32 v84, v84, v102, s[92:93]
    ds_write_b128 v109, v[80:83] offset:0
    ds_write_b128 v109, v[84:87] offset:512
    s_waitcnt lgkmcnt(0)
    s_barrier
    ds_read_b64_tr_b16 v[88:89], v110 offset:0
    ds_read_b64_tr_b16 v[90:91], v110 offset:4352
    ds_read_b64_tr_b16 v[92:93], v110 offset:512
    ds_read_b64_tr_b16 v[94:95], v110 offset:4864
    s_waitcnt lgkmcnt(2)
    buffer_store_dwordx4 v[88:91], v111, s[24:27], s63 offen sc1
    s_waitcnt lgkmcnt(0)
    buffer_store_dwordx4 v[92:95], v22, s[24:27], s64 offen sc1
    v_min_u32 v220, 111104, v220
    s_add_u32 s54, s54, 229376
    buffer_load_dword v108, v220, s[16:19], s54 offen
    s_waitcnt vmcnt(1)
    v_cmp_eq_u32 vcc, 0, v29
    s_nop 0
    s_cbranch_vccz L_ok12
    s_mov_b32 s59, 100000
L_spin11:
    buffer_load_dword v29, off, s[40:43], 0 sc1
    s_waitcnt vmcnt(0)
    v_cmp_eq_u32 vcc, 0, v29
    s_nop 0
    s_cbranch_vccz L_ok12
    s_sub_u32 s59, s59, 1
    s_cbranch_scc0 L_spin11
L_ok12:
    v_readfirstlane_b32 s47, v29
    s_barrier
    s_cmp_lg_u32 s44, 0
    s_cbranch_scc1 L_nopub13
    s_lshl_b32 s60, s2, 5
    s_add_u32 s60, s60, 12582912
    v_mov_b32 v30, s47
    s_mov_b64 exec, 1
    buffer_store_dword v30, off, s[24:27], s60 sc1
    s_mov_b64 exec, -1
L_nopub13:
    buffer_load_dword v108, v217, s[32:35], 0 offen
    v_lshrrev_b32 v219, 2, v1
    v_min_u32 v219, 15, v219
    v_mul_u32_u24 v219, 3584, v219
    v_lshl_add_u32 v219, v210, 7, v219
    s_mul_i32 s54, s55, 16
    s_lshl_b32 s56, s44, 9
    s_add_u32 s54, s54, s56
    s_add_u32 s54, s54, 416
    s_mul_i32 s54, s54, 3584
    s_mul_i32 s56, s45, 7
    s_lshr_b32 s56, s56, 1
    s_lshl_b32 s56, s56, 7
    s_add_u32 s54, s54, s56
    buffer_load_dword v108, v219, s[16:19], s54 offen
    s_add_u32 s54, s54, 172032
    buffer_load_dword v108, v219, s[16:19], s54 offen
    s_add_u32 s54, s54, 172032
    s_lshl_b32 s54, s44, 11
    s_add_u32 s54, s54, 12582912
    v_lshl_add_u32 v221, v1, 5, s54
    buffer_load_dword v222, v221, s[24:27], 0 offen sc1
    s_waitcnt vmcnt(0)
    v_cmp_ne_u32 vcc, s47, v222
    s_nop 0
    s_cbranch_vccz L_ok15
    s_mov_b32 s59, 100000
L_spin14:
    buffer_load_dword v222, v221, s[24:27], 0 offen sc1
    s_waitcnt vmcnt(0)
    v_cmp_ne_u32 vcc, s47, v222
    s_nop 0
    s_cbranch_vccz L_ok15
    s_sub_u32 s59, s59, 1
    s_cbranch_scc0 L_spin14
L_ok15:
    s_add_u32 s54, s55, 0
    s_lshr_b32 s56, s54, 1
    s_add_u32 s56, s56, 24
    s_mul_i32 s56, s56, 66816
    s_lshl2_add_u32 s56, s52, s56
    s_and_b32 s54, s54, 1
    s_lshl_b32 s54, s54, 13
    s_add_u32 s56, s56, s54
    buffer_load_dword v108, v217, s[24:27], s56 offen sc1
    s_add_u32 s54, s55, 3
    s_lshr_b32 s56, s54, 1
    s_add_u32 s56, s56, 24
    s_mul_i32 s56, s56, 66816
    s_lshl2_add_u32 s56, s52, s56
    s_and_b32 s54, s54, 1
    s_lshl_b32 s54, s54, 13
    s_add_u32 s56, s56, s54
    buffer_load_dword v108, v217, s[24:27], s56 offen sc1
    s_add_u32 s54, s55, 6
    s_lshr_b32 s56, s54, 1
    s_add_u32 s56, s56, 24
    s_mul_i32 s56, s56, 66816
    s_lshl2_add_u32 s56, s52, s56
    s_and_b32 s54, s54, 1
    s_lshl_b32 s54, s54, 13
    s_add_u32 s56, s56, s54
    s_cmp_lt_u32 s55, 2
    s_cselect_b32 s56, s56, 2130706432
    buffer_load_dword v108, v217, s[24:27], s56 offen sc1
    s_mul_i32 s54, s44, 28
    s_add_u32 s54, s54, s55
    s_add_u32 s54, s54, 0
    s_lshl_b32 s54, s54, 16
    s_lshl_b32 s56, s45, 9
    s_add_u32 s54, s54, s56
    buffer_load_dword v108, v218, s[20:23], s54 offen
    s_add_u32 s54, s54, 196608
    buffer_load_dword v108, v218, s[20:23], s54 offen
    s_add_u32 s54, s54, 196608
    buffer_load_dword v108, v218, s[20:23], s54 offen
    s_add_u32 s54, s54, 196608
    buffer_load_dword v108, v218, s[20:23], s54 offen
    s_add_u32 s54, s54, 196608
    buffer_load_dword v108, v217, s[36:39], 0 offen
    s_waitcnt vmcnt(0) lgkmcnt(0)
    v_lshlrev_b32 v216, 6, v209
    v_lshl_add_u32 v216, v210, 3, v216
    v_lshl_add_u32 v216, v215, 5, v216
    s_add_u32 s53, s52, 49152
    v_lshl_add_u32 v2, v208, 10, v216
    v_add_u32 v2, s53, v2
    v_xor_b32 v3, 32, v2
    v_add_u32 v4, 65536, v2
    v_add_u32 v5, 65536, v3
    v_lshl_add_u32 v6, v208, 9, v216
    v_add_u32 v6, s53, v6
    v_xor_b32 v7, 32, v6
    v_add_u32 v8, 65536, v6
    v_add_u32 v9, 65536, v7
    s_lshr_b32 s53, s46, 2
    s_and_b32 s89, s46, 3
    s_bfe_u32 s54, s46, 0x20001
    s_and_b32 s55, s46, 1
    s_add_u32 s55, s55, 4
    s_cmp_lt_u32 s46, 16
    s_cselect_b32 s53, s53, s54
    s_cselect_b32 s89, s89, s55
    s_mul_i32 s49, s53, 2
    s_add_u32 s49, s49, s89
    s_sub_u32 s54, s49, 6
    s_min_u32 s49, s49, s54
    s_or_b32 s89, s89, 0
    s_lshl2_add_u32 s48, s45, s53
    s_mul_i32 s53, s44, 1835008
    s_lshl_b32 s74, s48, 7
    s_add_u32 s53, s53, s74
    s_lshl_b32 s56, s44, 5
    v_lshlrev_b32 v217, 5, v212
    v_xor_b32 v217, v217, v214
    v_xor_b32 v217, s56, v217
    s_add_u32 s74, s74, s56
    v_lshlrev_b32 v12, 12, v213
    v_add3_u32 v12, v12, v217, s53
    s_mul_i32 s53, s44, 28672
    s_lshl_b32 s54, s49, 7
    s_add_u32 s55, s53, s54
    v_mul_u32_u24 v13, 896, v213
    v_add3_u32 v13, v13, v214, s55
    v_xor_b32 v14, 32, v13
    s_mul_i32 s55, s44, 21504
    v_subrev_u32 v239, s55, v13
    s_and_b32 s55, s56, 32
    v_xor_b32 v239, s55, v239
    s_mul_i32 s73, s48, 57344
    s_add_u32 s71, s73, s54
    s_mul_i32 s55, s44, 14336
    s_add_u32 s71, s71, s55
    s_add_u32 s72, s71, 7168
    v_bfe_u32 v217, v1, 1, 2
    v_lshl_add_u32 v217, v212, 2, v217
    v_and_b32 v218, 24, v1
    v_add_u32 v217, v217, v218
    v_mul_u32_u24 v15, 896, v217
    v_and_b32 v217, 1, v1
    v_lshl_add_u32 v15, v217, 4, v15
    v_add_u32 v15, s53, v15
    s_lshl_b32 s54, s89, 5
    s_add_u32 s54, s54, 768
    s_add_u32 s68, s89, 24
    s_mul_i32 s68, s68, 58624
    s_mul_i32 s69, s44, 14336
    s_add_u32 s69, s69, 2097152
    s_add_u32 s68, s68, s69
    s_mul_i32 s55, s49, 234496
    s_add_u32 s69, s69, s55
    s_add_u32 s73, s73, s54
    s_mov_b32 s76, 0
    s_add_u32 s77, s76, 2048
    s_cmp_eq_u32 s77, 14336
    s_cselect_b32 s77, 0, s77
    s_add_u32 s78, s77, 2048
    s_cmp_eq_u32 s78, 14336
    s_cselect_b32 s78, 0, s78
    s_add_u32 s79, s78, 2048
    s_cmp_eq_u32 s79, 14336
    s_cselect_b32 s79, 0, s79
    s_add_u32 s80, s79, 2048
    s_cmp_eq_u32 s80, 14336
    s_cselect_b32 s80, 0, s80
    s_add_u32 s81, s80, 2048
    s_cmp_eq_u32 s81, 14336
    s_cselect_b32 s81, 0, s81
    s_add_u32 s82, s81, 2048
    s_cmp_eq_u32 s82, 14336
    s_cselect_b32 s82, 0, s82
    s_cmp_lt_u32 s89, 4
    s_cselect_b32 s75, s54, 2130706432
    s_cselect_b32 s68, s68, 2130706432
    s_cselect_b32 s73, s73, 2130706432
    v_lshlrev_b32 v16, 3, v1
    v_add_u32 v16, 81920, v16
    v_and_b32 v217, 7, v1
    v_min_u32 v218, 6, v217
    s_mul_i32 s54, s44, 7
    v_add_u32 v218, s54, v218
    v_mul_u32_u24 v219, 2, v218
    v_add_u32 v219, s89, v219
    v_mul_u32_u24 v220, 43, v219
    v_lshrrev_b32 v220, 8, v220
    v_mul_u32_u24 v220, 6, v220
    v_sub_u32 v219, v219, v220
    v_subrev_u32 v219, s49, v219
    v_bfe_u32 v220, v1, 3, 1
    v_mul_i32_i24 v219, v219, v220
    v_add_u32 v219, s49, v219
    v_lshl_add_u32 v218, v219, 5, v218
    v_lshlrev_b32 v20, 7, v218
    v_add_u32 v20, 12713984, v20
    s_lshr_b32 s53, s48, 1
    s_lshl_b32 s53, s53, 7
    s_add_u32 s53, s53, 12779520
    v_lshl_add_u32 v21, v210, 11, s53
    s_lshl_b32 s70, s48, 16
    s_lshl2_add_u32 s70, s52, s70
    s_add_u32 s70, s70, 4194304
    v_lshrrev_b32 v218, 3, v1
    v_mul_u32_u24 v22, 896, v218
    v_lshl_add_u32 v22, v217, 4, v22
    v_lshlrev_b32 v25, 1, v211
    s_add_u32 s53, s52, 65536
    v_mul_u32_u24 v244, 176, v218
    v_lshl_add_u32 v244, v217, 4, v244
    v_add_u32 v244, s53, v244
    v_mul_u32_u24 v238, 176, v211
    v_lshl_add_u32 v238, v208, 3, v238
    v_add_u32 v238, s53, v238
    v_lshrrev_b32 v218, 2, v0
    v_mul_u32_u24 v26, 896, v218
    v_lshl_add_u32 v26, v210, 3, v26
    v_lshrrev_b32 v218, 2, v1
    v_mul_u32_u24 v252, 176, v218
    v_lshl_add_u32 v252, v210, 3, v252
    v_add_u32 v252, s53, v252
    s_sub_u32 s53, 49152, s52
    v_add_u32 v246, s53, v2
    v_add_u32 v247, s53, v3
    v_mul_u32_u24 v218, 3072, v208
    v_add_u32 v248, v218, v246
    v_add_u32 v249, v218, v247
    v_add_u32 v232, s52, v23
    v_xor_b32 v233, 4096, v232
    v_xor_b32 v234, 8192, v232
    v_xor_b32 v235, 12288, v232
    buffer_load_dwordx4 v[216:219], v22, s[4:7], s71 offen
    buffer_load_dwordx4 v[220:223], v22, s[4:7], s72 offen
    buffer_load_dwordx2 v[224:225], v26, s[4:7], s73 offen
    buffer_load_ushort v228, v25, s[36:39], s74 offen
    s_waitcnt vmcnt(0)
    ds_write_b128 v244, v[216:219]
    ds_write_b128 v244, v[220:223] offset:1408
    ds_write_b64 v252, v[224:225] offset:128
    ds_read_b64 v[216:217], v238 offset:0
    ds_read_b64 v[218:219], v238 offset:32
    ds_read_b64 v[220:221], v238 offset:64
    ds_read_b64 v[222:223], v238 offset:96
    ds_read_b64 v[224:225], v238 offset:128
    s_add_u32 m0, s52, 81920
    s_lshl_b32 s57, s76, 7
    buffer_load_dwordx4 v12, s[20:23], s57 offen offset:0 lds
    s_add_u32 s57, s57, 31744
    buffer_load_dwordx4 v12, s[20:23], s57 offen offset:1024 lds
    s_add_u32 s57, s57, 31744
    buffer_load_dwordx4 v12, s[20:23], s57 offen offset:2048 lds
    s_add_u32 s57, s57, 31744
    buffer_load_dwordx4 v12, s[20:23], s57 offen offset:3072 lds
    s_add_u32 m0, s52, 98304
    s_lshl_b32 s57, s76, 7
    s_add_u32 s57, s57, 131072
    buffer_load_dwordx4 v12, s[20:23], s57 offen offset:0 lds
    s_add_u32 s57, s57, 31744
    buffer_load_dwordx4 v12, s[20:23], s57 offen offset:1024 lds
    s_add_u32 s57, s57, 31744
    buffer_load_dwordx4 v12, s[20:23], s57 offen offset:2048 lds
    s_add_u32 s57, s57, 31744
    buffer_load_dwordx4 v12, s[20:23], s57 offen offset:3072 lds
    s_add_u32 m0, s52, 114688
    s_lshl_b32 s57, s77, 7
    buffer_load_dwordx4 v12, s[20:23], s57 offen offset:0 lds
    s_add_u32 s57, s57, 31744
    buffer_load_dwordx4 v12, s[20:23], s57 offen offset:1024 lds
    s_add_u32 s57, s57, 31744
    buffer_load_dwordx4 v12, s[20:23], s57 offen offset:2048 lds
    s_add_u32 s57, s57, 31744
    buffer_load_dwordx4 v12, s[20:23], s57 offen offset:3072 lds
    s_add_u32 m0, s52, 131072
    s_lshl_b32 s57, s77, 7
    s_add_u32 s57, s57, 131072
    buffer_load_dwordx4 v12, s[20:23], s57 offen offset:0 lds
    s_add_u32 s57, s57, 31744
    buffer_load_dwordx4 v12, s[20:23], s57 offen offset:1024 lds
    s_waitcnt vmcnt(10)
    ds_read_b64_tr_b16 a[0:1], v6 offset:32768
    ds_read_b64_tr_b16 a[2:3], v6 offset:34816
    ds_read_b64_tr_b16 a[4:5], v7 offset:32768
    ds_read_b64_tr_b16 a[6:7], v7 offset:34816
    ds_read_b64_tr_b16 a[8:9], v6 offset:33024
    ds_read_b64_tr_b16 a[10:11], v6 offset:35072
    ds_read_b64_tr_b16 a[12:13], v7 offset:33024
    ds_read_b64_tr_b16 a[14:15], v7 offset:35072
    s_add_u32 s57, s57, 31744
    buffer_load_dwordx4 v12, s[20:23], s57 offen offset:2048 lds
    s_add_u32 s57, s57, 31744
    buffer_load_dwordx4 v12, s[20:23], s57 offen offset:3072 lds
    s_add_u32 m0, s52, 147456
    s_lshl_b32 s57, s78, 7
    buffer_load_dwordx4 v12, s[20:23], s57 offen offset:0 lds
    s_add_u32 s57, s57, 31744
    buffer_load_dwordx4 v12, s[20:23], s57 offen offset:1024 lds
    s_waitcnt vmcnt(10)
    ds_read_b64_tr_b16 a[16:17], v6 offset:49152
    ds_read_b64_tr_b16 a[18:19], v6 offset:51200
    ds_read_b64_tr_b16 a[20:21], v7 offset:49152
    ds_read_b64_tr_b16 a[22:23], v7 offset:51200
    ds_read_b64_tr_b16 a[24:25], v6 offset:49408
    ds_read_b64_tr_b16 a[26:27], v6 offset:51456
    ds_read_b64_tr_b16 a[28:29], v7 offset:49408
    ds_read_b64_tr_b16 a[30:31], v7 offset:51456
    s_add_u32 s57, s57, 31744
    buffer_load_dwordx4 v12, s[20:23], s57 offen offset:2048 lds
    s_add_u32 s57, s57, 31744
    buffer_load_dwordx4 v12, s[20:23], s57 offen offset:3072 lds
    s_add_u32 m0, s52, 49152
    s_lshl_b32 s57, s78, 7
    s_add_u32 s57, s57, 131072
    buffer_load_dwordx4 v12, s[20:23], s57 offen offset:0 lds
    s_add_u32 s57, s57, 31744
    buffer_load_dwordx4 v12, s[20:23], s57 offen offset:1024 lds
    s_waitcnt vmcnt(10)
    ds_read_b64_tr_b16 a[32:33], v8 offset:0
    ds_read_b64_tr_b16 a[34:35], v8 offset:2048
    ds_read_b64_tr_b16 a[36:37], v9 offset:0
    ds_read_b64_tr_b16 a[38:39], v9 offset:2048
    ds_read_b64_tr_b16 a[40:41], v8 offset:256
    ds_read_b64_tr_b16 a[42:43], v8 offset:2304
    ds_read_b64_tr_b16 a[44:45], v9 offset:256
    ds_read_b64_tr_b16 a[46:47], v9 offset:2304
    s_add_u32 s57, s57, 31744
    buffer_load_dwordx4 v12, s[20:23], s57 offen offset:2048 lds
    s_add_u32 s57, s57, 31744
    buffer_load_dwordx4 v12, s[20:23], s57 offen offset:3072 lds
    s_waitcnt lgkmcnt(15)
    s_add_u32 m0, s52, 65536
    s_lshl_b32 s57, s79, 7
    buffer_load_dwordx4 v12, s[20:23], s57 offen offset:0 lds
    s_add_u32 s57, s57, 31744
    buffer_load_dwordx4 v12, s[20:23], s57 offen offset:1024 lds
    s_waitcnt vmcnt(10)
    ds_read_b64_tr_b16 a[48:49], v8 offset:16384
    ds_read_b64_tr_b16 a[50:51], v8 offset:18432
    ds_read_b64_tr_b16 a[52:53], v9 offset:16384
    ds_read_b64_tr_b16 a[54:55], v9 offset:18432
    s_add_u32 s57, s57, 31744
    buffer_load_dwordx4 v12, s[20:23], s57 offen offset:2048 lds
    ds_read_b64_tr_b16 a[56:57], v8 offset:16640
    ds_read_b64_tr_b16 a[58:59], v8 offset:18688
    ds_read_b64_tr_b16 a[60:61], v9 offset:16640
    ds_read_b64_tr_b16 a[62:63], v9 offset:18688
    s_add_u32 s57, s57, 31744
    buffer_load_dwordx4 v12, s[20:23], s57 offen offset:3072 lds
    s_add_u32 m0, s52, 81920
    s_lshl_b32 s57, s79, 7
    s_add_u32 s57, s57, 131072
    buffer_load_dwordx4 v12, s[20:23], s57 offen offset:0 lds
    s_add_u32 s57, s57, 31744
    buffer_load_dwordx4 v12, s[20:23], s57 offen offset:1024 lds
    s_waitcnt vmcnt(10)
    ds_read_b64_tr_b16 a[64:65], v8 offset:32768
    ds_read_b64_tr_b16 a[66:67], v8 offset:34816
    ds_read_b64_tr_b16 a[68:69], v9 offset:32768
    ds_read_b64_tr_b16 a[70:71], v9 offset:34816
    s_add_u32 s57, s57, 31744
    buffer_load_dwordx4 v12, s[20:23], s57 offen offset:2048 lds
    ds_read_b64_tr_b16 a[72:73], v8 offset:33024
    ds_read_b64_tr_b16 a[74:75], v8 offset:35072
    ds_read_b64_tr_b16 a[76:77], v9 offset:33024
    ds_read_b64_tr_b16 a[78:79], v9 offset:35072
    s_add_u32 s57, s57, 31744
    buffer_load_dwordx4 v12, s[20:23], s57 offen offset:3072 lds
    s_waitcnt lgkmcnt(15)
    s_add_u32 m0, s52, 98304
    s_lshl_b32 s57, s80, 7
    buffer_load_dwordx4 v12, s[20:23], s57 offen offset:0 lds
    s_add_u32 s57, s57, 31744
    buffer_load_dwordx4 v12, s[20:23], s57 offen offset:1024 lds
    s_waitcnt vmcnt(10)
    ds_read_b64_tr_b16 a[80:81], v6 offset:0
    ds_read_b64_tr_b16 a[82:83], v6 offset:2048
    ds_read_b64_tr_b16 a[84:85], v7 offset:0
    ds_read_b64_tr_b16 a[86:87], v7 offset:2048
    s_add_u32 s57, s57, 31744
    buffer_load_dwordx4 v12, s[20:23], s57 offen offset:2048 lds
    ds_read_b64_tr_b16 a[88:89], v6 offset:256
    ds_read_b64_tr_b16 a[90:91], v6 offset:2304
    ds_read_b64_tr_b16 a[92:93], v7 offset:256
    ds_read_b64_tr_b16 a[94:95], v7 offset:2304
    s_waitcnt vmcnt(0) lgkmcnt(0)
    s_branch L_p3join
L_role_a:
    v_lshrrev_b32 v112, 4, v1
    v_bfe_u32 v113, v1, 2, 2
    v_and_b32 v114, 3, v1
    v_and_b32 v115, 15, v1
    v_lshrrev_b32 v116, 5, v1
    s_and_b32 s48, s45, 6
    s_lshr_b32 s48, 0xc9, s48
    s_and_b32 s48, s48, 3
    s_and_b32 s53, s45, 1
    s_lshl3_add_u32 s49, s53, s46
    s_sub_u32 s49, s49, 24
    s_lshl_b32 s90, s44, 11
    s_and_b32 s53, s44, 1
    s_lshl_b32 s53, s53, 1
    v_lshlrev_b32 v117, 2, v112
    v_sub_u32 v117, v115, v117
    v_and_b32 v117, 15, v117
    v_xor_b32 v117, s53, v117
    v_mul_u32_u24 v2, 2688, v112
    v_lshl_add_u32 v2, v117, 4, v2
    s_mul_i32 s53, s44, 21504
    s_mul_i32 s54, s48, 224
    s_andn2_b32 s54, s54, 63
    s_add_u32 s53, s53, s54
    v_add_u32 v2, s53, v2
    s_add_u32 m0, s90, 65536
    s_mov_b32 s57, 896
    buffer_load_dwordx4 v2, s[8:11], s57 offen offset:0 lds
    s_mov_b32 s57, 10624
    buffer_load_dwordx4 v2, s[8:11], s57 offen offset:1024 lds
    v_mul_u32_u24 v109, 1088, v25
    v_lshl_add_u32 v109, v26, 4, v109
    v_mul_u32_u24 v110, 1088, v113
    v_lshl_add_u32 v110, v112, 5, v110
    v_lshl_add_u32 v110, v114, 3, v110
    s_lshl_b32 s53, s44, 7
    v_add_u32 v110, s53, v110
    v_mul_u32_u24 v111, 66816, v112
    v_lshl_add_u32 v111, v115, 4, v111
    s_mul_i32 s63, s44, 267264
    s_lshl_b32 s53, s2, 8
    s_add_u32 s63, s63, s53
    s_add_u32 s64, s63, 1069056
    v_cmp_gt_u32 vcc, 208, v0
    v_mov_b32 v100, 2130706432
    v_cmp_le_u32 s[92:93], 24, v26
    v_cndmask_b32 v22, v100, v111, vcc
    s_mov_b32 s62, 0x3f803f80
    s_mov_b32 s61, 0xffff0000
    v_mov_b32 v96, 0
    v_mov_b32 v97, 0
    v_and_b32 v117, 1, v112
    v_lshlrev_b32 v117, 5, v117
    s_mul_i32 s53, s44, 56
    s_and_b32 s54, s48, 1
    s_lshl_b32 s54, s54, 5
    s_add_u32 s53, s53, s54
    v_lshlrev_b32 v118, 11, v112
    v_lshl_add_u32 v118, v113, 8, v118
    v_add_u32 v118, 65536, v118
    v_lshl_add_u32 v119, v114, 3, s53
    v_add_u32 v119, 0, v119
    v_xor_b32 v119, v119, v117
    v_lshl_add_u32 v119, v113, 6, v119
    v_and_b32 v119, 255, v119
    v_add_u32 v6, v118, v119
    v_add_u32 v10, 49152, v6
    v_subrev_u32 v120, 65536, v6
    v_lshl_add_u32 v119, v114, 3, s53
    v_add_u32 v119, 32, v119
    v_xor_b32 v119, v119, v117
    v_lshl_add_u32 v119, v113, 6, v119
    v_and_b32 v119, 255, v119
    v_add_u32 v7, v118, v119
    v_add_u32 v11, 49152, v7
    v_subrev_u32 v121, 65536, v7
    s_and_b32 s54, s44, 1
    s_lshl_b32 s54, s54, 3
    s_sub_u32 s53, s53, s54
    v_lshl_add_u32 v119, v114, 4, s53
    v_add_u32 v119, 0, v119
    v_xor_b32 v119, v119, v117
    v_lshl_add_u32 v119, v113, 6, v119
    v_and_b32 v119, 255, v119
    v_add_u32 v8, v118, v119
    v_add_u32 v12, 49152, v8
    v_subrev_u32 v122, 65536, v8
    v_lshl_add_u32 v119, v114, 4, s53
    v_add_u32 v119, 8, v119
    v_xor_b32 v119, v119, v117
    v_lshl_add_u32 v119, v113, 6, v119
    v_and_b32 v119, 255, v119
    v_add_u32 v9, v118, v119
    v_add_u32 v13, 49152, v9
    v_subrev_u32 v123, 65536, v9
    s_waitcnt vmcnt(4)
    v_dot2c_f32_bf16 v96, s62, v32
    v_dot2c_f32_bf16 v97, v32, v32
    v_lshlrev_b32 v40, 16, v32
    v_and_b32 v41, s61, v32
    v_dot2c_f32_bf16 v96, s62, v33
    v_dot2c_f32_bf16 v97, v33, v33
    v_lshlrev_b32 v42, 16, v33
    v_and_b32 v43, s61, v33
    v_dot2c_f32_bf16 v96, s62, v34
    v_dot2c_f32_bf16 v97, v34, v34
    v_lshlrev_b32 v44, 16, v34
    v_and_b32 v45, s61, v34
    v_dot2c_f32_bf16 v96, s62, v35
    v_dot2c_f32_bf16 v97, v35, v35
    v_lshlrev_b32 v46, 16, v35
    v_and_b32 v47, s61, v35
    s_waitcnt vmcnt(3)
    v_dot2c_f32_bf16 v96, s62, v36
    v_dot2c_f32_bf16 v97, v36, v36
    v_lshlrev_b32 v48, 16, v36
    v_and_b32 v49, s61, v36
    v_dot2c_f32_bf16 v96, s62, v37
    v_dot2c_f32_bf16 v97, v37, v37
    v_lshlrev_b32 v50, 16, v37
    v_and_b32 v51, s61, v37
    v_dot2c_f32_bf16 v96, s62, v38
    v_dot2c_f32_bf16 v97, v38, v38
    v_lshlrev_b32 v52, 16, v38
    v_and_b32 v53, s61, v38
    v_dot2c_f32_bf16 v96, s62, v39
    v_dot2c_f32_bf16 v97, v39, v39
    v_lshlrev_b32 v54, 16, v39
    v_and_b32 v55, s61, v39
    buffer_load_dword v29, off, s[40:43], 0 sc1
    v_add_f32_dpp v96, v96, v96 quad_perm:[1,0,3,2] row_mask:0xf bank_mask:0xf
    v_add_f32_dpp v97, v97, v97 quad_perm:[1,0,3,2] row_mask:0xf bank_mask:0xf
    s_nop 0
    v_add_f32_dpp v96, v96, v96 quad_perm:[2,3,0,1] row_mask:0xf bank_mask:0xf
    v_add_f32_dpp v97, v97, v97 quad_perm:[2,3,0,1] row_mask:0xf bank_mask:0xf
    s_nop 0
    v_add_f32_dpp v96, v96, v96 row_half_mirror row_mask:0xf bank_mask:0xf
    v_add_f32_dpp v97, v97, v97 row_half_mirror row_mask:0xf bank_mask:0xf
    s_nop 0
    v_add_f32_dpp v96, v96, v96 row_mirror row_mask:0xf bank_mask:0xf
    v_add_f32_dpp v97, v97, v97 row_mirror row_mask:0xf bank_mask:0xf
    v_mov_b32 v98, v96
    v_mov_b32 v99, v97
    s_nop 0
    v_permlane16_swap_b32 v96, v98
    v_permlane16_swap_b32 v97, v99
    v_add_f32 v96, v96, v98
    v_add_f32 v97, v97, v99
    v_mul_f32 v98, 0x3b124925, v96
    v_mul_f32 v99, 0x3b124925, v97
    v_fma_f32 v99, -v98, v98, v99
    v_max_f32 v99, 0, v99
    v_cvt_pk_bf16_f32 v100, 0, v99
    v_add_f32 v100, 0x3727c5ac, v100
    v_cvt_pk_bf16_f32 v100, 0, v100
    v_sqrt_f32 v100, v100
    s_nop 0
    v_cvt_pk_bf16_f32 v100, 0, v100
    v_rcp_f32 v100, v100
    s_nop 0
    v_mul_f32 v99, v99, v100
    v_mul_f32 v99, v99, v100
    v_cvt_pk_bf16_f32 v104, 0, v99
    v_add_f32 v104, 0x3727c5ac, v104
    v_cvt_pk_bf16_f32 v104, 0, v104
    v_sqrt_f32 v104, v104
    s_nop 0
    v_cvt_pk_bf16_f32 v102, 0, v104
    v_rcp_f32 v104, v102
    s_nop 0
    v_mul_f32 v104, v104, v100
    v_mul_f32 v106, v98, v104
    v_pk_fma_f32 v[56:57], v[40:41], v[104:105], v[106:107] op_sel_hi:[1,0,0] neg_lo:[0,0,1] neg_hi:[0,0,1]
    v_pk_fma_f32 v[58:59], v[42:43], v[104:105], v[106:107] op_sel_hi:[1,0,0] neg_lo:[0,0,1] neg_hi:[0,0,1]
    v_pk_fma_f32 v[60:61], v[44:45], v[104:105], v[106:107] op_sel_hi:[1,0,0] neg_lo:[0,0,1] neg_hi:[0,0,1]
    v_pk_fma_f32 v[62:63], v[46:47], v[104:105], v[106:107] op_sel_hi:[1,0,0] neg_lo:[0,0,1] neg_hi:[0,0,1]
    v_pk_fma_f32 v[64:65], v[48:49], v[104:105], v[106:107] op_sel_hi:[1,0,0] neg_lo:[0,0,1] neg_hi:[0,0,1]
    v_pk_fma_f32 v[66:67], v[50:51], v[104:105], v[106:107] op_sel_hi:[1,0,0] neg_lo:[0,0,1] neg_hi:[0,0,1]
    v_pk_fma_f32 v[68:69], v[52:53], v[104:105], v[106:107] op_sel_hi:[1,0,0] neg_lo:[0,0,1] neg_hi:[0,0,1]
    v_pk_fma_f32 v[70:71], v[54:55], v[104:105], v[106:107] op_sel_hi:[1,0,0] neg_lo:[0,0,1] neg_hi:[0,0,1]
    v_cvt_pk_bf16_f32 v80, v56, v57
    v_cvt_pk_bf16_f32 v81, v58, v59
    v_cvt_pk_bf16_f32 v82, v60, v61
    v_cvt_pk_bf16_f32 v83, v62, v63
    v_cvt_pk_bf16_f32 v84, v64, v65
    v_cvt_pk_bf16_f32 v85, v66, v67
    v_cvt_pk_bf16_f32 v86, v68, v69
    v_cvt_pk_bf16_f32 v87, v70, v71
    v_lshrrev_b32 v102, 16, v102
    v_cndmask_b32 v84, v84, v102, s[92:93]
    ds_write_b128 v109, v[80:83] offset:49152
    ds_write_b128 v109, v[84:87] offset:49664
    s_waitcnt lgkmcnt(0)
    s_barrier
    ds_read_b64_tr_b16 v[88:89], v110 offset:49152
    ds_read_b64_tr_b16 v[90:91], v110 offset:53504
    ds_read_b64_tr_b16 v[92:93], v110 offset:49664
    ds_read_b64_tr_b16 v[94:95], v110 offset:54016
    s_waitcnt lgkmcnt(2)
    buffer_store_dwordx4 v[88:91], v111, s[24:27], s63 offen sc1
    s_waitcnt lgkmcnt(0)
    buffer_store_dwordx4 v[92:95], v22, s[24:27], s64 offen sc1
    s_add_u32 m0, s90, 73728
    s_mov_b32 s57, 86912
    buffer_load_dwordx4 v2, s[8:11], s57 offen offset:0 lds
    s_movk_i32 s94, 224
    v_mul_u32_u24 v3, 66816, v116
    v_and_b32 v118, 1, v112
    v_lshlrev_b32 v119, 2, v118
    v_xor_b32 v119, v119, v115
    v_lshl_add_u32 v3, v118, 8, v3
    v_lshl_add_u32 v3, v119, 4, v3
    v_cmp_gt_u32 s[92:93], s94, v0
    v_mov_b32 v119, 2130706432
    s_mov_b32 s57, 96640
    buffer_load_dwordx4 v2, s[8:11], s57 offen offset:1024 lds
    v_lshlrev_b32 v4, 9, v116
    v_cndmask_b32 v24, v119, v3, s[92:93]
    v_lshl_add_u32 v4, v118, 7, v4
    v_lshl_add_u32 v4, v113, 4, v4
    v_lshrrev_b32 v118, 1, v114
    v_mul_u32_u24 v118, 320, v118
    v_add_u32 v4, v118, v4
    v_and_b32 v118, 1, v114
    v_lshl_add_u32 v4, v118, 3, v4
    v_xor_b32 v25, 64, v4
    s_lshl_b32 s53, s49, 4
    s_sub_u32 s53, s53, 2
    v_min_u32 v117, 17, v1
    v_add_u32 v117, s53, v117
    v_max_i32 v117, 0, v117
    v_lshlrev_b32 v19, 5, v117
    s_add_u32 m0, s90, 81920
    s_mov_b32 s57, 172928
    buffer_load_dwordx4 v2, s[8:11], s57 offen offset:0 lds
    v_add_u32 v19, 12582912, v19
    v_and_b32 v117, 1, v115
    v_cmp_eq_u32 s[76:77], 1, v117
    v_lshl_add_u32 v117, v112, 2, v117
    v_cmp_le_u32 s[78:79], v117, v115
    v_mul_u32_u24 v118, 304, v116
    v_lshl_add_u32 v93, v117, 1, v118
    v_add_u32 v117, 2, v117
    v_cmp_le_u32 s[80:81], v117, v115
    v_add_u32 v94, 4, v93
    v_mov_b32 v118, 14336
    v_mov_b32 v119, 30720
    v_cndmask_b32 v117, v118, v119, s[78:79]
    v_add_u32 v93, v117, v93
    v_cndmask_b32 v117, v118, v119, s[80:81]
    v_add_u32 v94, v117, v94
    s_mov_b32 s57, 182656
    buffer_load_dwordx4 v2, s[8:11], s57 offen offset:1024 lds
    v_lshrrev_b32 v117, 3, v115
    v_mul_u32_u24 v117, 304, v117
    v_lshl_add_u32 v92, v115, 1, v117
    v_add_u32 v92, v119, v92
    v_cmp_eq_u32 s[82:83], 3, v112
    v_mov_b32 v117, 0xffff
    v_mov_b32 v118, 0xffff0000
    v_cndmask_b32 v117, v117, v118, s[76:77]
    v_cndmask_b32 v14, v117, 0, s[78:79]
    v_cndmask_b32 v15, v117, 0, s[80:81]
    v_cndmask_b32 v16, 0, v117, s[78:79]
    v_cndmask_b32 v17, 0, v117, s[80:81]
    s_mov_b32 s91, 0x3e8b97f6
    v_mov_b32 v18, 0xf149f2ca
    s_lshl_b32 s53, s49, 3
    s_lshl_b32 s72, s53, 9
    s_add_u32 m0, s90, 90112
    s_mov_b32 s57, 258944
    buffer_load_dwordx4 v2, s[8:11], s57 offen offset:0 lds
    s_lshl_b32 s74, s53, 14
    s_lshl2_add_u32 s54, s48, s44
    s_mul_i32 s54, s54, 7
    s_lshr_b32 s54, s54, 1
    s_lshl_b32 s54, s54, 8
    s_add_u32 s74, s74, s54
    s_add_u32 s74, s74, 4194304
    s_mul_i32 s68, s44, 534528
    s_add_u32 s68, s68, 0
    s_mul_i32 s69, s44, 534528
    s_add_u32 s69, s69, 132608
    s_mul_i32 s70, s44, 534528
    s_add_u32 s70, s70, 265216
    s_mul_i32 s71, s44, 534528
    s_add_u32 s71, s71, 397824
    s_cmp_eq_u32 s44, 3
    s_cselect_b32 s71, 2130706432, s71
    s_cmp_eq_u32 s49, 0
    s_cselect_b64 s[84:85], -1, 0
    s_andn2_b64 s[86:87], s[84:85], s[80:81]
    s_andn2_b64 s[84:85], s[84:85], s[78:79]
    s_bitcmp1_b32 s44, 0
    s_cselect_b64 s[88:89], -1, 0
    s_cselect_b32 s53, 0, 3
    s_cselect_b32 s54, 8, 0
    v_cmp_eq_u32 vcc, s53, v112
    s_lshr_b32 s53, s44, 1
    s_lshl_b32 s55, s53, 11
    s_add_u32 s54, s54, s55
    s_add_u32 s54, s54, 147456
    v_lshl_add_u32 v118, v115, 4, s54
    v_add_u32 v117, 151552, v23
    v_cndmask_b32 v95, v117, v118, vcc
    v_mov_b32 v117, 2130706432
    v_cndmask_b32 v23, v23, v117, vcc
    s_lshl1_add_u32 s53, s48, s53
    s_mul_i32 s53, s53, 1792
    s_and_b32 s54, s44, 1
    s_lshl1_add_u32 s54, s49, s54
    s_lshl_b32 s54, s54, 16
    s_add_u32 s53, s53, s54
    s_add_u32 s95, s53, 4195072
    s_and_b32 s53, s46, 7
    s_mul_i32 s54, s44, 28
    s_add_u32 s54, s54, s53
    s_add_u32 s54, s54, 12
    s_lshl_b32 s73, s54, 16
    s_lshl_b32 s54, s45, 9
    s_add_u32 s73, s73, s54
    s_lshl3_add_u32 s75, s44, s53
    s_lshl_b32 s75, s75, 13
    v_lshrrev_b32 v5, 2, v1
    v_lshlrev_b32 v5, 12, v5
    v_lshl_add_u32 v5, v114, 7, v5
    v_lshlrev_b32 v20, 7, v1
    s_mov_b32 s57, 268672
    buffer_load_dwordx4 v2, s[8:11], s57 offen offset:1024 lds
    s_add_u32 m0, s90, 98304
    s_mov_b32 s57, 344960
    buffer_load_dwordx4 v2, s[8:11], s57 offen offset:0 lds
    s_mov_b32 s57, 354688
    buffer_load_dwordx4 v2, s[8:11], s57 offen offset:1024 lds
    s_mov_b32 s59, s44
    s_mov_b64 exec, 0
    s_branch L_wa_go
L_wa_ret:
    s_add_u32 s59, s59, 4
L_wa_go:
    s_cmp_eq_u32 s59, 0
    s_cbranch_scc1 L_wa_0
    s_cmp_eq_u32 s59, 1
    s_cbranch_scc1 L_wa_1
    s_cmp_eq_u32 s59, 2
    s_cbranch_scc1 L_wa_2
    s_cmp_eq_u32 s59, 3
    s_cbranch_scc1 L_wa_3
    s_cmp_eq_u32 s59, 4
    s_cbranch_scc1 L_wa_3
    s_mov_b64 exec, -1
    s_add_u32 m0, s90, 106496
L_wa_0:
    s_cbranch_execz L_wa_ret
    s_mov_b32 s57, 430976
    buffer_load_dwordx4 v2, s[8:11], s57 offen offset:0 lds
    s_mov_b32 s57, 440704
    buffer_load_dwordx4 v2, s[8:11], s57 offen offset:1024 lds
    s_add_u32 m0, s90, 114688
    s_mov_b32 s57, 516992
    buffer_load_dwordx4 v2, s[8:11], s57 offen offset:0 lds
    s_mov_b32 s57, 526720
    buffer_load_dwordx4 v2, s[8:11], s57 offen offset:1024 lds
    s_add_u32 m0, s90, 122880
    s_mov_b32 s57, 603008
    buffer_load_dwordx4 v2, s[8:11], s57 offen offset:0 lds
    s_mov_b32 s57, 612736
    buffer_load_dwordx4 v2, s[8:11], s57 offen offset:1024 lds
    s_add_u32 m0, s90, 131072
    s_mov_b32 s57, 689024
    buffer_load_dwordx4 v2, s[8:11], s57 offen offset:0 lds
    s_mov_b32 s57, 698752
    buffer_load_dwordx4 v2, s[8:11], s57 offen offset:1024 lds
    s_add_u32 m0, s90, 139264
    s_mov_b32 s57, 775040
    buffer_load_dwordx4 v2, s[8:11], s57 offen offset:0 lds
    s_mov_b32 s57, 784768
    buffer_load_dwordx4 v2, s[8:11], s57 offen offset:1024 lds
    s_add_u32 m0, s90, 147456
    s_mov_b32 s57, 861056
    buffer_load_dwordx4 v2, s[8:11], s57 offen offset:0 lds
    s_mov_b32 s57, 870784
    buffer_load_dwordx4 v2, s[8:11], s57 offen offset:1024 lds
    s_waitcnt vmcnt(20)
    v_cmp_eq_u32 vcc, 0, v29
    s_nop 0
    s_cbranch_vccz L_ok17
    s_mov_b32 s59, 100000
L_spin16:
    buffer_load_dword v29, off, s[40:43], 0 sc1
    s_waitcnt vmcnt(0)
    v_cmp_eq_u32 vcc, 0, v29
    s_nop 0
    s_cbranch_vccz L_ok17
    s_sub_u32 s59, s59, 1
    s_cbranch_scc0 L_spin16
L_ok17:
    v_readfirstlane_b32 s47, v29
    s_barrier
    s_cmp_lg_u32 s44, 0
    s_cbranch_scc1 L_nopub18
    s_lshl_b32 s60, s2, 5
    s_add_u32 s60, s60, 12582912
    v_mov_b32 v30, s47
    s_mov_b64 exec, 1
    buffer_store_dword v30, off, s[24:27], s60 sc1
    s_mov_b64 exec, -1
L_nopub18:
    s_waitcnt vmcnt(16)
    s_barrier
    s_add_u32 m0, s90, 155648
    s_mov_b32 s57, 947072
    buffer_load_dwordx4 v2, s[8:11], s57 offen offset:0 lds
    s_mov_b32 s57, 956800
    buffer_load_dwordx4 v2, s[8:11], s57 offen offset:1024 lds
    ds_read_b64_tr_b16 a[8:9], v6 offset:0
    ds_read_b64_tr_b16 a[10:11], v6 offset:1024
    ds_read_b64_tr_b16 a[12:13], v7 offset:0
    ds_read_b64_tr_b16 a[14:15], v7 offset:1024
    s_add_u32 m0, s90, 0
    s_mov_b32 s57, 1033088
    buffer_load_dwordx4 v2, s[8:11], s57 offen offset:0 lds
    s_mov_b32 s57, 1042816
    buffer_load_dwordx4 v2, s[8:11], s57 offen offset:1024 lds
    ds_read_b64_tr_b16 a[32:33], v6 offset:8192
    ds_read_b64_tr_b16 a[34:35], v6 offset:9216
    ds_read_b64_tr_b16 a[36:37], v7 offset:8192
    ds_read_b64_tr_b16 a[38:39], v7 offset:9216
    s_add_u32 m0, s90, 8192
    s_mov_b32 s57, 1119104
    buffer_load_dwordx4 v2, s[8:11], s57 offen offset:0 lds
    s_mov_b32 s57, 1128832
    buffer_load_dwordx4 v2, s[8:11], s57 offen offset:1024 lds
    ds_read_b64_tr_b16 a[56:57], v6 offset:16384
    ds_read_b64_tr_b16 a[58:59], v6 offset:17408
    ds_read_b64_tr_b16 a[60:61], v7 offset:16384
    ds_read_b64_tr_b16 a[62:63], v7 offset:17408
    s_waitcnt vmcnt(16)
    s_waitcnt lgkmcnt(0)
    s_barrier
    s_add_u32 m0, s90, 16384
    s_mov_b32 s57, 1792
    buffer_load_dwordx4 v2, s[8:11], s57 offen offset:0 lds
    s_mov_b32 s57, 11520
    buffer_load_dwordx4 v2, s[8:11], s57 offen offset:1024 lds
    ds_read_b64_tr_b16 a[80:81], v6 offset:24576
    ds_read_b64_tr_b16 a[82:83], v6 offset:25600
    ds_read_b64_tr_b16 a[84:85], v7 offset:24576
    ds_read_b64_tr_b16 a[86:87], v7 offset:25600
    s_add_u32 m0, s90, 24576
    s_mov_b32 s57, 87808
    buffer_load_dwordx4 v2, s[8:11], s57 offen offset:0 lds
    s_mov_b32 s57, 97536
    buffer_load_dwordx4 v2, s[8:11], s57 offen offset:1024 lds
    ds_read_b64_tr_b16 a[104:105], v6 offset:32768
    ds_read_b64_tr_b16 a[106:107], v6 offset:33792
    ds_read_b64_tr_b16 a[108:109], v7 offset:32768
    ds_read_b64_tr_b16 a[110:111], v7 offset:33792
    s_add_u32 m0, s90, 32768
    s_mov_b32 s57, 173824
    buffer_load_dwordx4 v2, s[8:11], s57 offen offset:0 lds
    s_mov_b32 s57, 183552
    buffer_load_dwordx4 v2, s[8:11], s57 offen offset:1024 lds
    ds_read_b64_tr_b16 a[128:129], v6 offset:40960
    ds_read_b64_tr_b16 a[130:131], v6 offset:41984
    ds_read_b64_tr_b16 a[132:133], v7 offset:40960
    ds_read_b64_tr_b16 a[134:135], v7 offset:41984
    s_waitcnt vmcnt(16)
    s_waitcnt lgkmcnt(0)
    s_barrier
    s_add_u32 m0, s90, 40960
    s_mov_b32 s57, 259840
    buffer_load_dwordx4 v2, s[8:11], s57 offen offset:0 lds
    s_mov_b32 s57, 269568
    buffer_load_dwordx4 v2, s[8:11], s57 offen offset:1024 lds
    ds_read_b64_tr_b16 a[152:153], v10 offset:0
    ds_read_b64_tr_b16 a[154:155], v10 offset:1024
    ds_read_b64_tr_b16 a[156:157], v11 offset:0
    ds_read_b64_tr_b16 a[158:159], v11 offset:1024
    s_add_u32 m0, s90, 65536
    s_mov_b32 s57, 345856
    buffer_load_dwordx4 v2, s[8:11], s57 offen offset:0 lds
    s_mov_b32 s57, 355584
    buffer_load_dwordx4 v2, s[8:11], s57 offen offset:1024 lds
    ds_read_b64_tr_b16 a[176:177], v10 offset:8192
    ds_read_b64_tr_b16 a[178:179], v10 offset:9216
    ds_read_b64_tr_b16 a[180:181], v11 offset:8192
    ds_read_b64_tr_b16 a[182:183], v11 offset:9216
    s_add_u32 m0, s90, 73728
    s_mov_b32 s57, 431872
    buffer_load_dwordx4 v2, s[8:11], s57 offen offset:0 lds
    s_mov_b32 s57, 441600
    buffer_load_dwordx4 v2, s[8:11], s57 offen offset:1024 lds
    ds_read_b64_tr_b16 a[200:201], v10 offset:16384
    ds_read_b64_tr_b16 a[202:203], v10 offset:17408
    ds_read_b64_tr_b16 a[204:205], v11 offset:16384
    ds_read_b64_tr_b16 a[206:207], v11 offset:17408
    s_waitcnt vmcnt(16)
    s_waitcnt lgkmcnt(0)
    s_barrier
    ds_read_b64_tr_b16 a[224:225], v10 offset:24576
    ds_read_b64_tr_b16 a[226:227], v10 offset:25600
    ds_read_b64_tr_b16 a[228:229], v11 offset:24576
    ds_read_b64_tr_b16 a[230:231], v11 offset:25600
    ds_read_b64_tr_b16 a[248:249], v10 offset:32768
    ds_read_b64_tr_b16 a[250:251], v10 offset:33792
    ds_read_b64_tr_b16 a[252:253], v11 offset:32768
    ds_read_b64_tr_b16 a[254:255], v11 offset:33792
    s_add_u32 m0, s90, 81920
    s_mov_b32 s57, 517888
    buffer_load_dwordx4 v2, s[8:11], s57 offen offset:0 lds
    ds_read_b64_tr_b16 v[192:193], v10 offset:40960
    ds_read_b64_tr_b16 v[194:195], v10 offset:41984
    ds_read_b64_tr_b16 v[196:197], v11 offset:40960
    ds_read_b64_tr_b16 v[198:199], v11 offset:41984
    s_mov_b32 s57, 527616
    buffer_load_dwordx4 v2, s[8:11], s57 offen offset:1024 lds
    s_waitcnt vmcnt(12)
    s_waitcnt lgkmcnt(0)
    s_barrier
    ds_read_b64_tr_b16 v[216:217], v120 offset:0
    ds_read_b64_tr_b16 v[218:219], v120 offset:1024
    ds_read_b64_tr_b16 v[220:221], v121 offset:0
    ds_read_b64_tr_b16 v[222:223], v121 offset:1024
    ds_read_b64_tr_b16 v[240:241], v120 offset:8192
    ds_read_b64_tr_b16 v[242:243], v120 offset:9216
    ds_read_b64_tr_b16 v[244:245], v121 offset:8192
    ds_read_b64_tr_b16 v[246:247], v121 offset:9216
    ds_read_b64_tr_b16 a[16:17], v122 offset:16384
    ds_read_b64_tr_b16 a[18:19], v122 offset:17408
    ds_read_b64_tr_b16 a[20:21], v123 offset:16384
    ds_read_b64_tr_b16 a[22:23], v123 offset:17408
    buffer_load_dword v21, v19, s[24:27], 0 offen sc1
    s_add_u32 m0, s90, 90112
    s_mov_b32 s57, 603904
    buffer_load_dwordx4 v2, s[8:11], s57 offen offset:0 lds
    s_mov_b32 s57, 613632
    buffer_load_dwordx4 v2, s[8:11], s57 offen offset:1024 lds
    s_add_u32 m0, s90, 98304
    s_mov_b32 s57, 689920
    buffer_load_dwordx4 v2, s[8:11], s57 offen offset:0 lds
    s_mov_b32 s57, 699648
    buffer_load_dwordx4 v2, s[8:11], s57 offen offset:1024 lds
    s_add_u32 m0, s90, 106496
    s_mov_b32 s57, 775936
    buffer_load_dwordx4 v2, s[8:11], s57 offen offset:0 lds
    s_waitcnt vmcnt(12)
    s_waitcnt lgkmcnt(0)
    s_barrier
    ds_read_b64_tr_b16 a[40:41], v122 offset:24576
    ds_read_b64_tr_b16 a[42:43], v122 offset:25600
    ds_read_b64_tr_b16 a[44:45], v123 offset:24576
    ds_read_b64_tr_b16 a[46:47], v123 offset:25600
    ds_read_b64_tr_b16 a[64:65], v122 offset:32768
    ds_read_b64_tr_b16 a[66:67], v122 offset:33792
    ds_read_b64_tr_b16 a[68:69], v123 offset:32768
    ds_read_b64_tr_b16 a[70:71], v123 offset:33792
    ds_read_b64_tr_b16 a[88:89], v122 offset:40960
    ds_read_b64_tr_b16 a[90:91], v122 offset:41984
    ds_read_b64_tr_b16 a[92:93], v123 offset:40960
    ds_read_b64_tr_b16 a[94:95], v123 offset:41984
    s_mov_b32 s57, 785664
    buffer_load_dwordx4 v2, s[8:11], s57 offen offset:1024 lds
    s_waitcnt vmcnt(7)
    s_waitcnt lgkmcnt(0)
    s_barrier
    ds_read_b64_tr_b16 a[112:113], v8 offset:0
    ds_read_b64_tr_b16 a[114:115], v8 offset:1024
    ds_read_b64_tr_b16 a[116:117], v9 offset:0
    ds_read_b64_tr_b16 a[118:119], v9 offset:1024
    ds_read_b64_tr_b16 a[136:137], v8 offset:8192
    ds_read_b64_tr_b16 a[138:139], v8 offset:9216
    ds_read_b64_tr_b16 a[140:141], v9 offset:8192
    ds_read_b64_tr_b16 a[142:143], v9 offset:9216
    ds_read_b64_tr_b16 a[160:161], v8 offset:16384
    ds_read_b64_tr_b16 a[162:163], v8 offset:17408
    ds_read_b64_tr_b16 a[164:165], v9 offset:16384
    ds_read_b64_tr_b16 a[166:167], v9 offset:17408
    s_waitcnt vmcnt(6)
    v_cmp_ne_u32 vcc, s47, v21
    s_nop 0
    s_cbranch_vccz L_ok20
    s_mov_b32 s59, 100000
L_spin19:
    buffer_load_dword v21, v19, s[24:27], 0 offen sc1
    s_waitcnt vmcnt(0)
    v_cmp_ne_u32 vcc, s47, v21
    s_nop 0
    s_cbranch_vccz L_ok20
    s_sub_u32 s59, s59, 1
    s_cbranch_scc0 L_spin19
L_ok20:
    s_add_u32 m0, s52, 0
    s_sub_u32 s58, s72, 512
    s_max_i32 s58, s58, 0
    s_add_u32 s57, s58, s68
    buffer_load_dwordx4 v3, s[24:27], s57 offen offset:0 sc1 lds
    s_add_u32 s57, s58, s69
    buffer_load_dwordx4 v3, s[24:27], s57 offen offset:1024 sc1 lds
    s_add_u32 s57, s58, s70
    buffer_load_dwordx4 v24, s[24:27], s57 offen offset:2048 sc1 lds
    s_add_u32 s57, s58, s71
    buffer_load_dwordx4 v3, s[24:27], s57 offen offset:3072 sc1 lds
    s_add_u32 m0, s52, 16384
    s_add_u32 s58, s72, 0
    s_add_u32 s57, s58, s68
    buffer_load_dwordx4 v3, s[24:27], s57 offen offset:0 sc1 lds
    s_add_u32 s57, s58, s69
    buffer_load_dwordx4 v3, s[24:27], s57 offen offset:1024 sc1 lds
    s_add_u32 s57, s58, s70
    buffer_load_dwordx4 v24, s[24:27], s57 offen offset:2048 sc1 lds
    s_add_u32 s57, s58, s71
    buffer_load_dwordx4 v3, s[24:27], s57 offen offset:3072 sc1 lds
    s_add_u32 m0, s90, 114688
    s_mov_b32 s57, 861952
    buffer_load_dwordx4 v2, s[8:11], s57 offen offset:0 lds
    s_mov_b32 s57, 871680
    buffer_load_dwordx4 v2, s[8:11], s57 offen offset:1024 lds
    s_add_u32 m0, s90, 122880
    s_mov_b32 s57, 947968
    buffer_load_dwordx4 v2, s[8:11], s57 offen offset:0 lds
    s_mov_b32 s57, 957696
    buffer_load_dwordx4 v2, s[8:11], s57 offen offset:1024 lds
    s_add_u32 m0, s90, 131072
    s_mov_b32 s57, 1033984
    buffer_load_dwordx4 v2, s[8:11], s57 offen offset:0 lds
    s_mov_b32 s57, 1043712
    buffer_load_dwordx4 v2, s[8:11], s57 offen offset:1024 lds
    s_add_u32 m0, s52, 32768
    s_add_u32 s58, s72, 512
    s_add_u32 s57, s58, s68
    buffer_load_dwordx4 v3, s[24:27], s57 offen offset:0 sc1 lds
    s_add_u32 s57, s58, s69
    buffer_load_dwordx4 v3, s[24:27], s57 offen offset:1024 sc1 lds
    s_waitcnt vmcnt(12)
    s_waitcnt lgkmcnt(0)
    s_barrier
    ds_read_b64_tr_b16 v[120:121], v4 offset:0
    ds_read_b64_tr_b16 v[122:123], v25 offset:0
    ds_read_b64_tr_b16 v[124:125], v4 offset:1024
    ds_read_b64_tr_b16 v[126:127], v25 offset:1024
    ds_read_b64_tr_b16 v[128:129], v4 offset:2048
    ds_read_b64_tr_b16 v[130:131], v25 offset:2048
    ds_read_b64_tr_b16 v[132:133], v4 offset:3072
    ds_read_b64_tr_b16 v[134:135], v25 offset:3072
    ds_read_b64_tr_b16 v[136:137], v4 offset:4096
    ds_read_b64_tr_b16 v[138:139], v25 offset:4096
    ds_read_b64_tr_b16 v[140:141], v4 offset:5120
    ds_read_b64_tr_b16 v[142:143], v25 offset:5120
    ds_read_b64_tr_b16 v[144:145], v4 offset:6144
    ds_read_b64_tr_b16 v[146:147], v25 offset:6144
    ds_read_b64_tr_b16 v[148:149], v4 offset:7168
    ds_read_b64_tr_b16 v[150:151], v25 offset:7168
    ds_read_b64_tr_b16 v[152:153], v4 offset:8192
    ds_read_b64_tr_b16 v[154:155], v25 offset:8192
    ds_read_b64_tr_b16 v[156:157], v4 offset:9216
    ds_read_b64_tr_b16 v[158:159], v25 offset:9216
    ds_read_b64_tr_b16 v[160:161], v4 offset:10240
    ds_read_b64_tr_b16 v[162:163], v25 offset:10240
    ds_read_b64_tr_b16 v[164:165], v4 offset:11264
    ds_read_b64_tr_b16 v[166:167], v25 offset:11264
    ds_read_b64_tr_b16 v[168:169], v4 offset:12288
    ds_read_b64_tr_b16 v[170:171], v25 offset:12288
    ds_read_b64_tr_b16 v[172:173], v4 offset:13312
    ds_read_b64_tr_b16 v[174:175], v25 offset:13312
    s_waitcnt lgkmcnt(15)
    v_mfma_f32_16x16x32_bf16 v[96:99], a[8:11], v[120:123], 0
    s_add_u32 s57, s58, s70
    ds_read_b64_tr_b16 a[184:185], v8 offset:24576
    v_mfma_f32_16x16x32_bf16 v[96:99], a[32:35], v[124:127], v[96:99]
    buffer_load_dwordx4 v24, s[24:27], s57 offen offset:2048 sc1 lds
    v_mfma_f32_16x16x32_bf16 v[96:99], a[56:59], v[128:131], v[96:99]
    ds_read_b64_tr_b16 a[186:187], v8 offset:25600
    ds_read_b64_tr_b16 a[188:189], v9 offset:24576
    v_mfma_f32_16x16x32_bf16 v[96:99], a[80:83], v[132:135], v[96:99]
    ds_read_b64_tr_b16 a[190:191], v9 offset:25600
    ds_read_b64_tr_b16 a[208:209], v8 offset:32768
    v_mfma_f32_16x16x32_bf16 v[96:99], a[104:107], v[136:139], v[96:99]
    s_add_u32 s57, s58, s71
    ds_read_b64_tr_b16 a[210:211], v8 offset:33792
    v_mfma_f32_16x16x32_bf16 v[96:99], a[128:131], v[140:143], v[96:99]
    buffer_load_dwordx4 v3, s[24:27], s57 offen offset:3072 sc1 lds
    s_waitcnt lgkmcnt(15)
    v_mfma_f32_16x16x32_bf16 v[96:99], a[152:155], v[144:147], v[96:99]
    ds_read_b64_tr_b16 a[212:213], v9 offset:32768
    ds_read_b64_tr_b16 a[214:215], v9 offset:33792
    v_mfma_f32_16x16x32_bf16 v[96:99], a[176:179], v[148:151], v[96:99]
    ds_read_b64_tr_b16 a[232:233], v8 offset:40960
    ds_read_b64_tr_b16 a[234:235], v8 offset:41984
    s_waitcnt lgkmcnt(15)
    v_mfma_f32_16x16x32_bf16 v[96:99], a[200:203], v[152:155], v[96:99]
    s_add_u32 m0, s90, 139264
    s_mov_b32 s57, 1120000
    ds_read_b64_tr_b16 a[236:237], v9 offset:40960
    v_mfma_f32_16x16x32_bf16 v[96:99], a[224:227], v[156:159], v[96:99]
    buffer_load_dwordx4 v2, s[8:11], s57 offen offset:0 lds
    s_waitcnt lgkmcnt(15)
    v_mfma_f32_16x16x32_bf16 v[96:99], a[248:251], v[160:163], v[96:99]
    ds_read_b64_tr_b16 a[238:239], v9 offset:41984
    v_mfma_f32_16x16x32_bf16 v[96:99], v[192:195], v[164:167], v[96:99]
    s_waitcnt lgkmcnt(12)
    v_mfma_f32_16x16x32_bf16 v[96:99], v[216:219], v[168:171], v[96:99]
    s_mov_b32 s57, 1129728
    v_mfma_f32_16x16x32_bf16 v[96:99], v[240:243], v[172:175], v[96:99]
    buffer_load_dwordx4 v2, s[8:11], s57 offen offset:1024 lds
    s_waitcnt vmcnt(12)
    s_barrier
    v_mfma_f32_16x16x32_bf16 v[100:103], a[12:15], v[120:123], 0
    ds_read_b64_tr_b16 v[120:121], v4 offset:16384
    ds_read_b64_tr_b16 v[122:123], v25 offset:16384
    v_mfma_f32_16x16x32_bf16 v[100:103], a[36:39], v[124:127], v[100:103]
    ds_read_b64_tr_b16 v[124:125], v4 offset:17408
    v_mfma_f32_16x16x32_bf16 v[100:103], a[60:63], v[128:131], v[100:103]
    ds_read_b64_tr_b16 v[126:127], v25 offset:17408
    ds_read_b64_tr_b16 v[128:129], v4 offset:18432
    s_add_u32 m0, s90, 147456
    s_mov_b32 s57, 0
    v_mfma_f32_16x16x32_bf16 v[100:103], a[84:87], v[132:135], v[100:103]
    buffer_load_dwordx4 v2, s[8:11], s57 offen offset:0 lds
    v_mfma_f32_16x16x32_bf16 v[100:103], a[108:111], v[136:139], v[100:103]
    ds_read_b64_tr_b16 v[130:131], v25 offset:18432
    ds_read_b64_tr_b16 v[132:133], v4 offset:19456
    v_mfma_f32_16x16x32_bf16 v[100:103], a[132:135], v[140:143], v[100:103]
    ds_read_b64_tr_b16 v[134:135], v25 offset:19456
    ds_read_b64_tr_b16 v[136:137], v4 offset:20480
    v_mfma_f32_16x16x32_bf16 v[100:103], a[156:159], v[144:147], v[100:103]
    ds_read_b64_tr_b16 v[138:139], v25 offset:20480
    s_mov_b32 s57, 9728
    v_mfma_f32_16x16x32_bf16 v[100:103], a[180:183], v[148:151], v[100:103]
    buffer_load_dwordx4 v2, s[8:11], s57 offen offset:1024 lds
    v_mfma_f32_16x16x32_bf16 v[100:103], a[204:207], v[152:155], v[100:103]
    ds_read_b64_tr_b16 v[140:141], v4 offset:21504
    ds_read_b64_tr_b16 v[142:143], v25 offset:21504
    v_mfma_f32_16x16x32_bf16 v[100:103], a[228:231], v[156:159], v[100:103]
    ds_read_b64_tr_b16 v[144:145], v4 offset:22528
    ds_read_b64_tr_b16 v[146:147], v25 offset:22528
    v_mfma_f32_16x16x32_bf16 v[100:103], a[252:255], v[160:163], v[100:103]
    ds_read_b64_tr_b16 v[148:149], v4 offset:23552
    ds_read_b64_tr_b16 v[150:151], v25 offset:23552
    s_add_u32 m0, s90, 155648
    s_mov_b32 s57, 86016
    v_mfma_f32_16x16x32_bf16 v[100:103], v[196:199], v[164:167], v[100:103]
    buffer_load_dwordx4 v2, s[8:11], s57 offen offset:0 lds
    v_mfma_f32_16x16x32_bf16 v[100:103], v[220:223], v[168:171], v[100:103]
    ds_read_b64_tr_b16 v[152:153], v4 offset:24576
    ds_read_b64_tr_b16 v[154:155], v25 offset:24576
    v_mfma_f32_16x16x32_bf16 v[100:103], v[244:247], v[172:175], v[100:103]
    ds_read_b64_tr_b16 v[156:157], v4 offset:25600
    ds_read_b64_tr_b16 v[158:159], v25 offset:25600
    s_waitcnt lgkmcnt(15)
    v_mfma_f32_16x16x32_bf16 v[104:107], a[8:11], v[120:123], 0
    ds_read_b64_tr_b16 v[160:161], v4 offset:26624
    s_mov_b32 s57, 95744
    v_mfma_f32_16x16x32_bf16 v[104:107], a[32:35], v[124:127], v[104:107]
    buffer_load_dwordx4 v2, s[8:11], s57 offen offset:1024 lds
    s_waitcnt lgkmcnt(13)
    v_mfma_f32_16x16x32_bf16 v[104:107], a[56:59], v[128:131], v[104:107]
    ds_read_b64_tr_b16 v[162:163], v25 offset:26624
    ds_read_b64_tr_b16 v[164:165], v4 offset:27648
    v_mfma_f32_16x16x32_bf16 v[104:107], a[80:83], v[132:135], v[104:107]
    ds_read_b64_tr_b16 v[166:167], v25 offset:27648
    ds_read_b64_tr_b16 v[168:169], v4 offset:28672
    s_waitcnt vmcnt(10)
    s_barrier
    s_waitcnt lgkmcnt(13)
    v_mfma_f32_16x16x32_bf16 v[104:107], a[104:107], v[136:139], v[104:107]
    ds_read_b64_tr_b16 v[170:171], v25 offset:28672
    ds_read_b64_tr_b16 v[172:173], v4 offset:29696
    s_add_u32 m0, s90, 65536
    s_mov_b32 s57, 172032
    v_mfma_f32_16x16x32_bf16 v[104:107], a[128:131], v[140:143], v[104:107]
    buffer_load_dwordx4 v2, s[8:11], s57 offen offset:0 lds
    s_waitcnt lgkmcnt(11)
    v_mfma_f32_16x16x32_bf16 v[104:107], a[152:155], v[144:147], v[104:107]
    ds_read_b64_tr_b16 v[174:175], v25 offset:29696
    v_cvt_pk_bf16_f32 v52, v96, v97
    v_mfma_f32_16x16x32_bf16 v[104:107], a[176:179], v[148:151], v[104:107]
    v_cvt_pk_bf16_f32 v53, v98, v99
    v_cvt_pk_bf16_f32 v54, v100, v101
    s_waitcnt lgkmcnt(8)
    v_mfma_f32_16x16x32_bf16 v[104:107], a[200:203], v[152:155], v[104:107]
    s_mov_b32 s57, 181760
    v_cvt_pk_bf16_f32 v55, v102, v103
    v_mfma_f32_16x16x32_bf16 v[104:107], a[224:227], v[156:159], v[104:107]
    buffer_load_dwordx4 v2, s[8:11], s57 offen offset:1024 lds
    s_waitcnt lgkmcnt(4)
    v_mfma_f32_16x16x32_bf16 v[104:107], a[248:251], v[160:163], v[104:107]
    v_cndmask_b32 v54, v54, 0, s[82:83]
    v_cndmask_b32 v55, v55, 0, s[82:83]
    v_mfma_f32_16x16x32_bf16 v[104:107], v[192:195], v[164:167], v[104:107]
    ds_read_b64_tr_b16 v[176:177], v12 offset:0
    ds_read_b64_tr_b16 v[178:179], v12 offset:1024
    s_waitcnt lgkmcnt(2)
    v_mfma_f32_16x16x32_bf16 v[104:107], v[216:219], v[168:171], v[104:107]
    s_add_u32 m0, s90, 73728
    s_mov_b32 s57, 258048
    ds_read_b64_tr_b16 v[180:181], v13 offset:0
    v_mfma_f32_16x16x32_bf16 v[104:107], v[240:243], v[172:175], v[104:107]
    buffer_load_dwordx4 v2, s[8:11], s57 offen offset:0 lds
    v_mfma_f32_16x16x32_bf16 v[108:111], a[12:15], v[120:123], 0
    ds_read_b64_tr_b16 v[182:183], v13 offset:1024
    ds_read_b64_tr_b16 v[200:201], v12 offset:8192
    v_mfma_f32_16x16x32_bf16 v[108:111], a[36:39], v[124:127], v[108:111]
    ds_read_b64_tr_b16 v[202:203], v12 offset:9216
    ds_read_b64_tr_b16 v[204:205], v13 offset:8192
    v_mfma_f32_16x16x32_bf16 v[108:111], a[60:63], v[128:131], v[108:111]
    s_mov_b32 s57, 267776
    ds_read_b64_tr_b16 v[206:207], v13 offset:9216
    v_mfma_f32_16x16x32_bf16 v[108:111], a[84:87], v[132:135], v[108:111]
    buffer_load_dwordx4 v2, s[8:11], s57 offen offset:1024 lds
    v_mfma_f32_16x16x32_bf16 v[108:111], a[108:111], v[136:139], v[108:111]
    ds_read_b64_tr_b16 v[224:225], v12 offset:16384
    ds_read_b64_tr_b16 v[226:227], v12 offset:17408
    v_mfma_f32_16x16x32_bf16 v[108:111], a[132:135], v[140:143], v[108:111]
    ds_read_b64_tr_b16 v[228:229], v13 offset:16384
    ds_read_b64_tr_b16 v[230:231], v13 offset:17408
    v_mfma_f32_16x16x32_bf16 v[108:111], a[156:159], v[144:147], v[108:111]
    s_add_u32 m0, s90, 81920
    s_mov_b32 s57, 344064
    v_cvt_pk_bf16_f32 v56, v104, v105
    v_mfma_f32_16x16x32_bf16 v[108:111], a[180:183], v[148:151], v[108:111]
    buffer_load_dwordx4 v2, s[8:11], s57 offen offset:0 lds
    v_mfma_f32_16x16x32_bf16 v[108:111], a[204:207], v[152:155], v[108:111]
    v_cvt_pk_bf16_f32 v57, v106, v107
    v_mfma_f32_16x16x32_bf16 v[108:111], a[228:231], v[156:159], v[108:111]
    v_mfma_f32_16x16x32_bf16 v[108:111], a[252:255], v[160:163], v[108:111]
    s_mov_b32 s57, 353792
    v_mfma_f32_16x16x32_bf16 v[108:111], v[196:199], v[164:167], v[108:111]
    buffer_load_dwordx4 v2, s[8:11], s57 offen offset:1024 lds
    v_mfma_f32_16x16x32_bf16 v[108:111], v[220:223], v[168:171], v[108:111]
    v_mfma_f32_16x16x32_bf16 v[108:111], v[244:247], v[172:175], v[108:111]
    v_mfma_f32_16x16x32_bf16 v[112:115], v[120:123], a[16:19], 0
    s_add_u32 m0, s90, 90112
    s_mov_b32 s57, 430080
    v_mfma_f32_16x16x32_bf16 v[112:115], v[124:127], a[40:43], v[112:115]
    buffer_load_dwordx4 v2, s[8:11], s57 offen offset:0 lds
    v_mfma_f32_16x16x32_bf16 v[112:115], v[128:131], a[64:67], v[112:115]
    v_mfma_f32_16x16x32_bf16 v[112:115], v[132:135], a[88:91], v[112:115]
    v_mfma_f32_16x16x32_bf16 v[112:115], v[136:139], a[112:115], v[112:115]
    s_mov_b32 s57, 439808
    v_mfma_f32_16x16x32_bf16 v[112:115], v[140:143], a[136:139], v[112:115]
    buffer_load_dwordx4 v2, s[8:11], s57 offen offset:1024 lds
    v_mfma_f32_16x16x32_bf16 v[112:115], v[144:147], a[160:163], v[112:115]
    v_cvt_pk_bf16_f32 v58, v108, v109
    v_cvt_pk_bf16_f32 v59, v110, v111
    v_mfma_f32_16x16x32_bf16 v[112:115], v[148:151], a[184:187], v[112:115]
    v_cndmask_b32 v58, v58, 0, s[82:83]
    v_cndmask_b32 v59, v59, 0, s[82:83]
    v_mfma_f32_16x16x32_bf16 v[112:115], v[152:155], a[208:211], v[112:115]
    s_add_u32 m0, s90, 98304
    s_mov_b32 s57, 516096
    buffer_load_dwordx4 v2, s[8:11], s57 offen offset:0 lds
    s_waitcnt vmcnt(9)
    s_waitcnt lgkmcnt(0)
    s_barrier
    ds_read_b64_tr_b16 v[248:249], v12 offset:24576
    ds_read_b64_tr_b16 v[250:251], v12 offset:25600
    ds_read_b64_tr_b16 v[252:253], v13 offset:24576
    ds_read_b64_tr_b16 v[254:255], v13 offset:25600
    v_mfma_f32_16x16x32_bf16 v[112:115], v[156:159], a[232:235], v[112:115]
    ds_read_b64_tr_b16 a[0:1], v10 offset:32768
    ds_read_b64_tr_b16 a[2:3], v10 offset:33792
    v_mfma_f32_16x16x32_bf16 v[112:115], v[160:163], v[176:179], v[112:115]
    ds_read_b64_tr_b16 a[4:5], v11 offset:32768
    ds_read_b64_tr_b16 a[6:7], v11 offset:33792
    v_mfma_f32_16x16x32_bf16 v[112:115], v[164:167], v[200:203], v[112:115]
    ds_read_b64_tr_b16 a[24:25], v10 offset:40960
    ds_read_b64_tr_b16 a[26:27], v10 offset:41984
    s_waitcnt lgkmcnt(6)
    v_mfma_f32_16x16x32_bf16 v[112:115], v[168:171], v[224:227], v[112:115]
    s_mov_b32 s57, 525824
    ds_read_b64_tr_b16 a[28:29], v11 offset:40960
    v_mfma_f32_16x16x32_bf16 v[112:115], v[172:175], v[248:251], v[112:115]
    buffer_load_dwordx4 v2, s[8:11], s57 offen offset:1024 lds
    v_mfma_f32_16x16x32_bf16 v[116:119], v[120:123], a[20:23], 0
    ds_read_b64_tr_b16 v[120:121], v4 offset:0
    ds_read_b64_tr_b16 v[122:123], v25 offset:0
    v_mfma_f32_16x16x32_bf16 v[116:119], v[124:127], a[44:47], v[116:119]
    ds_read_b64_tr_b16 v[124:125], v4 offset:1024
    ds_read_b64_tr_b16 a[30:31], v11 offset:41984
    v_mfma_f32_16x16x32_bf16 v[116:119], v[128:131], a[68:71], v[116:119]
    ds_read_b64_tr_b16 v[126:127], v25 offset:1024
    ds_read_b64_tr_b16 v[128:129], v4 offset:2048
    s_add_u32 m0, s90, 106496
    s_mov_b32 s57, 602112
    v_mfma_f32_16x16x32_bf16 v[116:119], v[132:135], a[92:95], v[116:119]
    buffer_load_dwordx4 v2, s[8:11], s57 offen offset:0 lds
    v_mfma_f32_16x16x32_bf16 v[116:119], v[136:139], a[116:119], v[116:119]
    ds_read_b64_tr_b16 v[130:131], v25 offset:2048
    ds_read_b64_tr_b16 v[132:133], v4 offset:3072
    v_mfma_f32_16x16x32_bf16 v[116:119], v[140:143], a[140:143], v[116:119]
    ds_read_b64_tr_b16 v[134:135], v25 offset:3072
    ds_read_b64_tr_b16 v[136:137], v4 offset:4096
    v_mfma_f32_16x16x32_bf16 v[116:119], v[144:147], a[164:167], v[116:119]
    ds_read_b64_tr_b16 v[138:139], v25 offset:4096
    s_mov_b32 s57, 611840
    v_mfma_f32_16x16x32_bf16 v[116:119], v[148:151], a[188:191], v[116:119]
    buffer_load_dwordx4 v2, s[8:11], s57 offen offset:1024 lds
    v_mfma_f32_16x16x32_bf16 v[116:119], v[152:155], a[212:215], v[116:119]
    ds_read_b64_tr_b16 v[140:141], v4 offset:5120
    ds_read_b64_tr_b16 v[142:143], v25 offset:5120
    v_mfma_f32_16x16x32_bf16 v[116:119], v[156:159], a[236:239], v[116:119]
    ds_read_b64_tr_b16 v[144:145], v4 offset:6144
    ds_read_b64_tr_b16 v[146:147], v25 offset:6144
    v_mfma_f32_16x16x32_bf16 v[116:119], v[160:163], v[180:183], v[116:119]
    ds_read_b64_tr_b16 v[148:149], v4 offset:7168
    ds_read_b64_tr_b16 v[150:151], v25 offset:7168
    s_add_u32 m0, s90, 114688
    s_mov_b32 s57, 688128
    v_mfma_f32_16x16x32_bf16 v[116:119], v[164:167], v[204:207], v[116:119]
    buffer_load_dwordx4 v2, s[8:11], s57 offen offset:0 lds
    v_mfma_f32_16x16x32_bf16 v[116:119], v[168:171], v[228:231], v[116:119]
    ds_read_b64_tr_b16 v[152:153], v4 offset:8192
    ds_read_b64_tr_b16 v[154:155], v25 offset:8192
L_wa_1:
    s_cbranch_execz L_wa_ret
    v_mfma_f32_16x16x32_bf16 v[116:119], v[172:175], v[252:255], v[116:119]
    ds_read_b64_tr_b16 v[156:157], v4 offset:9216
    ds_read_b64_tr_b16 v[158:159], v25 offset:9216
    s_waitcnt lgkmcnt(15)
    v_mfma_f32_16x16x32_bf16 v[96:99], v[120:123], a[16:19], 0
    ds_read_b64_tr_b16 v[160:161], v4 offset:10240
    s_mov_b32 s57, 697856
    v_mfma_f32_16x16x32_bf16 v[96:99], v[124:127], a[40:43], v[96:99]
    buffer_load_dwordx4 v2, s[8:11], s57 offen offset:1024 lds
    s_waitcnt lgkmcnt(13)
    v_mfma_f32_16x16x32_bf16 v[96:99], v[128:131], a[64:67], v[96:99]
    ds_read_b64_tr_b16 v[162:163], v25 offset:10240
    ds_read_b64_tr_b16 v[164:165], v4 offset:11264
    v_mfma_f32_16x16x32_bf16 v[96:99], v[132:135], a[88:91], v[96:99]
    ds_read_b64_tr_b16 v[166:167], v25 offset:11264
    ds_read_b64_tr_b16 v[168:169], v4 offset:12288
    s_waitcnt lgkmcnt(13)
    v_mfma_f32_16x16x32_bf16 v[96:99], v[136:139], a[112:115], v[96:99]
    ds_read_b64_tr_b16 v[170:171], v25 offset:12288
    ds_read_b64_tr_b16 v[172:173], v4 offset:13312
    s_add_u32 m0, s90, 122880
    s_mov_b32 s57, 774144
    v_mfma_f32_16x16x32_bf16 v[96:99], v[140:143], a[136:139], v[96:99]
    buffer_load_dwordx4 v2, s[8:11], s57 offen offset:0 lds
    s_waitcnt lgkmcnt(11)
    v_mfma_f32_16x16x32_bf16 v[96:99], v[144:147], a[160:163], v[96:99]
    ds_read_b64_tr_b16 v[174:175], v25 offset:13312
    v_cvt_pk_bf16_f32 v34, v112, v113
    v_mfma_f32_16x16x32_bf16 v[96:99], v[148:151], a[184:187], v[96:99]
    v_cvt_pk_bf16_f32 v35, v114, v115
    v_cvt_pk_bf16_f32 v44, v116, v117
    s_waitcnt lgkmcnt(8)
    v_mfma_f32_16x16x32_bf16 v[96:99], v[152:155], a[208:211], v[96:99]
    s_mov_b32 s57, 783872
    v_cvt_pk_bf16_f32 v45, v118, v119
    v_mfma_f32_16x16x32_bf16 v[96:99], v[156:159], a[232:235], v[96:99]
    buffer_load_dwordx4 v2, s[8:11], s57 offen offset:1024 lds
    s_waitcnt lgkmcnt(4)
    v_mfma_f32_16x16x32_bf16 v[96:99], v[160:163], v[176:179], v[96:99]
    v_mfma_f32_16x16x32_bf16 v[96:99], v[164:167], v[200:203], v[96:99]
    s_waitcnt vmcnt(10)
    s_barrier
    s_waitcnt lgkmcnt(0)
    v_mfma_f32_16x16x32_bf16 v[96:99], v[168:171], v[224:227], v[96:99]
    s_add_u32 m0, s90, 131072
    s_mov_b32 s57, 860160
    ds_read_b64_tr_b16 a[48:49], v6 offset:0
    v_mfma_f32_16x16x32_bf16 v[96:99], v[172:175], v[248:251], v[96:99]
    buffer_load_dwordx4 v2, s[8:11], s57 offen offset:0 lds
    v_mfma_f32_16x16x32_bf16 v[100:103], v[120:123], a[20:23], 0
    ds_read_b64_tr_b16 v[120:121], v4 offset:32768
    ds_read_b64_tr_b16 v[122:123], v25 offset:32768
    v_mfma_f32_16x16x32_bf16 v[100:103], v[124:127], a[44:47], v[100:103]
    ds_read_b64_tr_b16 v[124:125], v4 offset:33792
    ds_read_b64_tr_b16 a[50:51], v6 offset:1024
    v_mfma_f32_16x16x32_bf16 v[100:103], v[128:131], a[68:71], v[100:103]
    ds_read_b64_tr_b16 v[126:127], v25 offset:33792
    ds_read_b64_tr_b16 v[128:129], v4 offset:34816
    s_mov_b32 s57, 869888
    v_mfma_f32_16x16x32_bf16 v[100:103], v[132:135], a[92:95], v[100:103]
    buffer_load_dwordx4 v2, s[8:11], s57 offen offset:1024 lds
    v_mfma_f32_16x16x32_bf16 v[100:103], v[136:139], a[116:119], v[100:103]
    ds_read_b64_tr_b16 v[130:131], v25 offset:34816
    ds_read_b64_tr_b16 v[132:133], v4 offset:35840
    v_mfma_f32_16x16x32_bf16 v[100:103], v[140:143], a[140:143], v[100:103]
    ds_read_b64_tr_b16 v[134:135], v25 offset:35840
    ds_read_b64_tr_b16 v[136:137], v4 offset:36864
    v_mfma_f32_16x16x32_bf16 v[100:103], v[144:147], a[164:167], v[100:103]
    ds_read_b64_tr_b16 v[138:139], v25 offset:36864
    s_add_u32 m0, s90, 139264
    s_mov_b32 s57, 946176
    v_mfma_f32_16x16x32_bf16 v[100:103], v[148:151], a[188:191], v[100:103]
    buffer_load_dwordx4 v2, s[8:11], s57 offen offset:0 lds
    v_mfma_f32_16x16x32_bf16 v[100:103], v[152:155], a[212:215], v[100:103]
    ds_read_b64_tr_b16 v[140:141], v4 offset:37888
    ds_read_b64_tr_b16 v[142:143], v25 offset:37888
    v_mfma_f32_16x16x32_bf16 v[100:103], v[156:159], a[236:239], v[100:103]
    ds_read_b64_tr_b16 v[144:145], v4 offset:38912
    ds_read_b64_tr_b16 v[146:147], v25 offset:38912
    v_mfma_f32_16x16x32_bf16 v[100:103], v[160:163], v[180:183], v[100:103]
    ds_read_b64_tr_b16 v[148:149], v4 offset:39936
    ds_read_b64_tr_b16 v[150:151], v25 offset:39936
    s_mov_b32 s57, 955904
    v_mfma_f32_16x16x32_bf16 v[100:103], v[164:167], v[204:207], v[100:103]
    buffer_load_dwordx4 v2, s[8:11], s57 offen offset:1024 lds
    v_mfma_f32_16x16x32_bf16 v[100:103], v[168:171], v[228:231], v[100:103]
    ds_read_b64_tr_b16 v[152:153], v4 offset:40960
    ds_read_b64_tr_b16 v[154:155], v25 offset:40960
    v_mfma_f32_16x16x32_bf16 v[100:103], v[172:175], v[252:255], v[100:103]
    ds_read_b64_tr_b16 v[156:157], v4 offset:41984
    ds_read_b64_tr_b16 v[158:159], v25 offset:41984
    s_waitcnt lgkmcnt(15)
    v_mfma_f32_16x16x32_bf16 v[104:107], a[8:11], v[120:123], 0
    ds_read_b64_tr_b16 v[160:161], v4 offset:43008
    s_add_u32 m0, s90, 147456
    s_mov_b32 s57, 1032192
    v_mfma_f32_16x16x32_bf16 v[104:107], a[32:35], v[124:127], v[104:107]
    buffer_load_dwordx4 v2, s[8:11], s57 offen offset:0 lds
    s_waitcnt lgkmcnt(13)
    v_mfma_f32_16x16x32_bf16 v[104:107], a[56:59], v[128:131], v[104:107]
    ds_read_b64_tr_b16 v[162:163], v25 offset:43008
    ds_read_b64_tr_b16 v[164:165], v4 offset:44032
    v_mfma_f32_16x16x32_bf16 v[104:107], a[80:83], v[132:135], v[104:107]
    ds_read_b64_tr_b16 v[166:167], v25 offset:44032
    ds_read_b64_tr_b16 v[168:169], v4 offset:45056
    s_waitcnt lgkmcnt(13)
    v_mfma_f32_16x16x32_bf16 v[104:107], a[104:107], v[136:139], v[104:107]
    ds_read_b64_tr_b16 v[170:171], v25 offset:45056
    ds_read_b64_tr_b16 v[172:173], v4 offset:46080
    s_mov_b32 s57, 1041920
    v_mfma_f32_16x16x32_bf16 v[104:107], a[128:131], v[140:143], v[104:107]
    buffer_load_dwordx4 v2, s[8:11], s57 offen offset:1024 lds
    s_waitcnt lgkmcnt(11)
    v_mfma_f32_16x16x32_bf16 v[104:107], a[152:155], v[144:147], v[104:107]
    ds_read_b64_tr_b16 v[174:175], v25 offset:46080
    v_cvt_pk_bf16_f32 v32, v96, v97
    v_mfma_f32_16x16x32_bf16 v[104:107], a[176:179], v[148:151], v[104:107]
    v_cvt_pk_bf16_f32 v33, v98, v99
    v_cvt_pk_bf16_f32 v42, v100, v101
    s_waitcnt lgkmcnt(8)
    v_mfma_f32_16x16x32_bf16 v[104:107], a[200:203], v[152:155], v[104:107]
    s_add_u32 m0, s90, 155648
    s_mov_b32 s57, 1118208
    v_cvt_pk_bf16_f32 v43, v102, v103
    v_mfma_f32_16x16x32_bf16 v[104:107], a[224:227], v[156:159], v[104:107]
    buffer_load_dwordx4 v2, s[8:11], s57 offen offset:0 lds
    s_waitcnt lgkmcnt(4)
    v_mfma_f32_16x16x32_bf16 v[104:107], a[248:251], v[160:163], v[104:107]
    ds_read_b64_tr_b16 a[52:53], v7 offset:0
    ds_read_b64_tr_b16 a[54:55], v7 offset:1024
    v_mfma_f32_16x16x32_bf16 v[104:107], v[192:195], v[164:167], v[104:107]
    ds_read_b64_tr_b16 a[72:73], v6 offset:8192
    ds_read_b64_tr_b16 a[74:75], v6 offset:9216
    s_waitcnt lgkmcnt(4)
    v_mfma_f32_16x16x32_bf16 v[104:107], v[216:219], v[168:171], v[104:107]
    s_mov_b32 s57, 1127936
    ds_read_b64_tr_b16 a[76:77], v7 offset:8192
    v_mfma_f32_16x16x32_bf16 v[104:107], v[240:243], v[172:175], v[104:107]
    buffer_load_dwordx4 v2, s[8:11], s57 offen offset:1024 lds
    v_mfma_f32_16x16x32_bf16 v[108:111], a[12:15], v[120:123], 0
    ds_read_b64_tr_b16 a[78:79], v7 offset:9216
    ds_read_b64_tr_b16 a[96:97], v6 offset:16384
    v_mfma_f32_16x16x32_bf16 v[108:111], a[36:39], v[124:127], v[108:111]
    ds_read_b64_tr_b16 a[98:99], v6 offset:17408
    ds_read_b64_tr_b16 a[100:101], v7 offset:16384
    v_mfma_f32_16x16x32_bf16 v[108:111], a[60:63], v[128:131], v[108:111]
    s_add_u32 m0, s52, 49152
    s_add_u32 s58, s72, 1024
    s_add_u32 s57, s58, s68
    ds_read_b64_tr_b16 a[102:103], v7 offset:17408
    v_mfma_f32_16x16x32_bf16 v[108:111], a[84:87], v[132:135], v[108:111]
    buffer_load_dwordx4 v3, s[24:27], s57 offen offset:0 sc1 lds
    s_waitcnt vmcnt(13)
    s_waitcnt lgkmcnt(0)
    s_barrier
    v_mfma_f32_16x16x32_bf16 v[108:111], a[108:111], v[136:139], v[108:111]
    ds_read_b64_tr_b16 a[120:121], v6 offset:24576
    ds_read_b64_tr_b16 a[122:123], v6 offset:25600
    v_mfma_f32_16x16x32_bf16 v[108:111], a[132:135], v[140:143], v[108:111]
    ds_read_b64_tr_b16 a[124:125], v7 offset:24576
    ds_read_b64_tr_b16 a[126:127], v7 offset:25600
    v_mfma_f32_16x16x32_bf16 v[108:111], a[156:159], v[144:147], v[108:111]
    s_add_u32 s57, s58, s69
    v_cvt_pk_bf16_f32 v60, v104, v105
    v_mfma_f32_16x16x32_bf16 v[108:111], a[180:183], v[148:151], v[108:111]
    buffer_load_dwordx4 v3, s[24:27], s57 offen offset:1024 sc1 lds
    v_mfma_f32_16x16x32_bf16 v[108:111], a[204:207], v[152:155], v[108:111]
    v_cvt_pk_bf16_f32 v61, v106, v107
    ds_read_b64_tr_b16 a[144:145], v6 offset:32768
    v_mfma_f32_16x16x32_bf16 v[108:111], a[228:231], v[156:159], v[108:111]
    ds_read_b64_tr_b16 a[146:147], v6 offset:33792
    ds_read_b64_tr_b16 a[148:149], v7 offset:32768
    v_mfma_f32_16x16x32_bf16 v[108:111], a[252:255], v[160:163], v[108:111]
    s_add_u32 s57, s58, s70
    ds_read_b64_tr_b16 a[150:151], v7 offset:33792
    v_mfma_f32_16x16x32_bf16 v[108:111], v[196:199], v[164:167], v[108:111]
    buffer_load_dwordx4 v24, s[24:27], s57 offen offset:2048 sc1 lds
    v_mfma_f32_16x16x32_bf16 v[108:111], v[220:223], v[168:171], v[108:111]
    ds_read_b64_tr_b16 a[168:169], v6 offset:40960
    ds_read_b64_tr_b16 a[170:171], v6 offset:41984
    v_mfma_f32_16x16x32_bf16 v[108:111], v[244:247], v[172:175], v[108:111]
    ds_read_b64_tr_b16 a[172:173], v7 offset:40960
    ds_read_b64_tr_b16 a[174:175], v7 offset:41984
    v_mfma_f32_16x16x32_bf16 v[112:115], v[120:123], a[16:19], 0
    s_add_u32 s57, s58, s71
    v_mfma_f32_16x16x32_bf16 v[112:115], v[124:127], a[40:43], v[112:115]
    buffer_load_dwordx4 v3, s[24:27], s57 offen offset:3072 sc1 lds
    v_mfma_f32_16x16x32_bf16 v[112:115], v[128:131], a[64:67], v[112:115]
    v_mfma_f32_16x16x32_bf16 v[112:115], v[132:135], a[88:91], v[112:115]
    s_waitcnt vmcnt(10)
    s_waitcnt lgkmcnt(0)
    s_barrier
    v_mfma_f32_16x16x32_bf16 v[112:115], v[136:139], a[112:115], v[112:115]
    ds_read_b64_tr_b16 a[192:193], v10 offset:0
    ds_read_b64_tr_b16 a[194:195], v10 offset:1024
    v_mfma_f32_16x16x32_bf16 v[112:115], v[140:143], a[136:139], v[112:115]
    ds_read_b64_tr_b16 a[196:197], v11 offset:0
    ds_read_b64_tr_b16 a[198:199], v11 offset:1024
    v_mfma_f32_16x16x32_bf16 v[112:115], v[144:147], a[160:163], v[112:115]
    v_cvt_pk_bf16_f32 v62, v108, v109
    v_cvt_pk_bf16_f32 v63, v110, v111
    v_mfma_f32_16x16x32_bf16 v[112:115], v[148:151], a[184:187], v[112:115]
    v_cndmask_b32 v62, v62, 0, s[82:83]
    v_cndmask_b32 v63, v63, 0, s[82:83]
    v_mfma_f32_16x16x32_bf16 v[112:115], v[152:155], a[208:211], v[112:115]
    ds_read_b64_tr_b16 a[216:217], v10 offset:8192
    ds_read_b64_tr_b16 a[218:219], v10 offset:9216
    v_mfma_f32_16x16x32_bf16 v[112:115], v[156:159], a[232:235], v[112:115]
    ds_read_b64_tr_b16 a[220:221], v11 offset:8192
    ds_read_b64_tr_b16 a[222:223], v11 offset:9216
    v_mfma_f32_16x16x32_bf16 v[112:115], v[160:163], v[176:179], v[112:115]
    ds_read_b64_tr_b16 a[240:241], v10 offset:16384
    ds_read_b64_tr_b16 a[242:243], v10 offset:17408
    v_mfma_f32_16x16x32_bf16 v[112:115], v[164:167], v[200:203], v[112:115]
    ds_read_b64_tr_b16 a[244:245], v11 offset:16384
    ds_read_b64_tr_b16 a[246:247], v11 offset:17408
    v_mfma_f32_16x16x32_bf16 v[112:115], v[168:171], v[224:227], v[112:115]
    v_mfma_f32_16x16x32_bf16 v[112:115], v[172:175], v[248:251], v[112:115]
    v_mfma_f32_16x16x32_bf16 v[116:119], v[120:123], a[20:23], 0
    v_mfma_f32_16x16x32_bf16 v[116:119], v[124:127], a[44:47], v[116:119]
    v_mfma_f32_16x16x32_bf16 v[116:119], v[128:131], a[68:71], v[116:119]
    v_mfma_f32_16x16x32_bf16 v[116:119], v[132:135], a[92:95], v[116:119]
    v_mfma_f32_16x16x32_bf16 v[116:119], v[136:139], a[116:119], v[116:119]
    v_mfma_f32_16x16x32_bf16 v[116:119], v[140:143], a[140:143], v[116:119]
    v_mfma_f32_16x16x32_bf16 v[116:119], v[144:147], a[164:167], v[116:119]
    s_nop 0
    v_cvt_pk_bf16_f32 v36, v112, v113
    v_cvt_pk_bf16_f32 v37, v114, v115
    v_mfma_f32_16x16x32_bf16 v[116:119], v[148:151], a[188:191], v[116:119]
    v_mfma_f32_16x16x32_bf16 v[116:119], v[152:155], a[212:215], v[116:119]
    v_mfma_f32_16x16x32_bf16 v[116:119], v[156:159], a[236:239], v[116:119]
    v_mfma_f32_16x16x32_bf16 v[116:119], v[160:163], v[180:183], v[116:119]
    v_mfma_f32_16x16x32_bf16 v[116:119], v[164:167], v[204:207], v[116:119]
    v_mfma_f32_16x16x32_bf16 v[116:119], v[168:171], v[228:231], v[116:119]
    v_mfma_f32_16x16x32_bf16 v[116:119], v[172:175], v[252:255], v[116:119]
    s_waitcnt vmcnt(4)
    s_waitcnt lgkmcnt(0)
    s_barrier
    v_mfma_f32_16x16x32_bf16 v[96:99], a[0:3], v[120:123], 0
    ds_read_b64_tr_b16 v[184:185], v10 offset:24576
    ds_read_b64_tr_b16 v[186:187], v10 offset:25600
    v_mfma_f32_16x16x32_bf16 v[96:99], a[24:27], v[124:127], v[96:99]
    ds_read_b64_tr_b16 v[188:189], v11 offset:24576
    ds_read_b64_tr_b16 v[190:191], v11 offset:25600
    v_mfma_f32_16x16x32_bf16 v[96:99], a[48:51], v[128:131], v[96:99]
    ds_read_b64_tr_b16 v[208:209], v10 offset:32768
    ds_read_b64_tr_b16 v[210:211], v10 offset:33792
    v_mfma_f32_16x16x32_bf16 v[96:99], a[72:75], v[132:135], v[96:99]
    ds_read_b64_tr_b16 v[212:213], v11 offset:32768
    ds_read_b64_tr_b16 v[214:215], v11 offset:33792
    v_mfma_f32_16x16x32_bf16 v[96:99], a[96:99], v[136:139], v[96:99]
    ds_read_b64_tr_b16 v[232:233], v10 offset:40960
    ds_read_b64_tr_b16 v[234:235], v10 offset:41984
    v_mfma_f32_16x16x32_bf16 v[96:99], a[120:123], v[140:143], v[96:99]
    ds_read_b64_tr_b16 v[236:237], v11 offset:40960
    ds_read_b64_tr_b16 v[238:239], v11 offset:41984
    v_mfma_f32_16x16x32_bf16 v[96:99], a[144:147], v[144:147], v[96:99]
    v_cvt_pk_bf16_f32 v46, v116, v117
    v_cvt_pk_bf16_f32 v47, v118, v119
    v_mfma_f32_16x16x32_bf16 v[96:99], a[168:171], v[148:151], v[96:99]
    v_mfma_f32_16x16x32_bf16 v[96:99], a[192:195], v[152:155], v[96:99]
    v_mfma_f32_16x16x32_bf16 v[96:99], a[216:219], v[156:159], v[96:99]
    s_waitcnt lgkmcnt(8)
    v_mfma_f32_16x16x32_bf16 v[96:99], a[240:243], v[160:163], v[96:99]
    v_mfma_f32_16x16x32_bf16 v[96:99], v[184:187], v[164:167], v[96:99]
    s_waitcnt lgkmcnt(0)
    s_barrier
    v_mfma_f32_16x16x32_bf16 v[96:99], v[208:211], v[168:171], v[96:99]
    s_add_u32 m0, s52, 65536
    s_add_u32 s58, s72, 1536
    s_add_u32 s57, s58, s68
    v_mfma_f32_16x16x32_bf16 v[96:99], v[232:235], v[172:175], v[96:99]
    buffer_load_dwordx4 v3, s[24:27], s57 offen offset:0 sc1 lds
    v_mfma_f32_16x16x32_bf16 v[100:103], a[4:7], v[120:123], 0
    ds_read_b64_tr_b16 v[120:121], v4 offset:16384
    ds_read_b64_tr_b16 v[122:123], v25 offset:16384
    v_mfma_f32_16x16x32_bf16 v[100:103], a[28:31], v[124:127], v[100:103]
    ds_read_b64_tr_b16 v[124:125], v4 offset:17408
    v_mfma_f32_16x16x32_bf16 v[100:103], a[52:55], v[128:131], v[100:103]
    ds_read_b64_tr_b16 v[126:127], v25 offset:17408
    ds_read_b64_tr_b16 v[128:129], v4 offset:18432
    v_mfma_f32_16x16x32_bf16 v[100:103], a[76:79], v[132:135], v[100:103]
    ds_read_b64_tr_b16 v[130:131], v25 offset:18432
    v_mfma_f32_16x16x32_bf16 v[100:103], a[100:103], v[136:139], v[100:103]
    ds_read_b64_tr_b16 v[132:133], v4 offset:19456
    s_add_u32 s57, s58, s69
    v_mfma_f32_16x16x32_bf16 v[100:103], a[124:127], v[140:143], v[100:103]
    buffer_load_dwordx4 v3, s[24:27], s57 offen offset:1024 sc1 lds
    v_mfma_f32_16x16x32_bf16 v[100:103], a[148:151], v[144:147], v[100:103]
    ds_read_b64_tr_b16 v[134:135], v25 offset:19456
    ds_read_b64_tr_b16 v[136:137], v4 offset:20480
    v_mfma_f32_16x16x32_bf16 v[100:103], a[172:175], v[148:151], v[100:103]
    ds_read_b64_tr_b16 v[138:139], v25 offset:20480
    ds_read_b64_tr_b16 v[140:141], v4 offset:21504
    v_mfma_f32_16x16x32_bf16 v[100:103], a[196:199], v[152:155], v[100:103]
    ds_read_b64_tr_b16 v[142:143], v25 offset:21504
    ds_read_b64_tr_b16 v[144:145], v4 offset:22528
    v_mfma_f32_16x16x32_bf16 v[100:103], a[220:223], v[156:159], v[100:103]
    ds_read_b64_tr_b16 v[146:147], v25 offset:22528
    v_cvt_pk_bf16_f32 v64, v96, v97
    v_mfma_f32_16x16x32_bf16 v[100:103], a[244:247], v[160:163], v[100:103]
    ds_read_b64_tr_b16 v[148:149], v4 offset:23552
    ds_read_b64_tr_b16 v[150:151], v25 offset:23552
    s_add_u32 s57, s58, s70
    v_mfma_f32_16x16x32_bf16 v[100:103], v[188:191], v[164:167], v[100:103]
    buffer_load_dwordx4 v24, s[24:27], s57 offen offset:2048 sc1 lds
    v_mfma_f32_16x16x32_bf16 v[100:103], v[212:215], v[168:171], v[100:103]
    ds_read_b64_tr_b16 v[152:153], v4 offset:24576
    ds_read_b64_tr_b16 v[154:155], v25 offset:24576
    v_mfma_f32_16x16x32_bf16 v[100:103], v[236:239], v[172:175], v[100:103]
    ds_read_b64_tr_b16 v[156:157], v4 offset:25600
    ds_read_b64_tr_b16 v[158:159], v25 offset:25600
    s_waitcnt lgkmcnt(15)
    v_mfma_f32_16x16x32_bf16 v[104:107], a[0:3], v[120:123], 0
    ds_read_b64_tr_b16 v[160:161], v4 offset:26624
    v_cvt_pk_bf16_f32 v65, v98, v99
    v_mfma_f32_16x16x32_bf16 v[104:107], a[24:27], v[124:127], v[104:107]
    ds_read_b64_tr_b16 v[162:163], v25 offset:26624
    ds_read_b64_tr_b16 v[164:165], v4 offset:27648
    s_waitcnt lgkmcnt(15)
    v_mfma_f32_16x16x32_bf16 v[104:107], a[48:51], v[128:131], v[104:107]
    ds_read_b64_tr_b16 v[166:167], v25 offset:27648
    s_add_u32 s57, s58, s71
    v_mfma_f32_16x16x32_bf16 v[104:107], a[72:75], v[132:135], v[104:107]
    buffer_load_dwordx4 v3, s[24:27], s57 offen offset:3072 sc1 lds
    s_waitcnt lgkmcnt(12)
    v_mfma_f32_16x16x32_bf16 v[104:107], a[96:99], v[136:139], v[104:107]
    ds_read_b64_tr_b16 v[168:169], v4 offset:28672
    ds_read_b64_tr_b16 v[170:171], v25 offset:28672
    v_mfma_f32_16x16x32_bf16 v[104:107], a[120:123], v[140:143], v[104:107]
    ds_read_b64_tr_b16 v[172:173], v4 offset:29696
    ds_read_b64_tr_b16 v[174:175], v25 offset:29696
    s_waitcnt lgkmcnt(12)
    v_mfma_f32_16x16x32_bf16 v[104:107], a[144:147], v[144:147], v[104:107]
    v_cvt_pk_bf16_f32 v66, v100, v101
    v_cvt_pk_bf16_f32 v67, v102, v103
    v_mfma_f32_16x16x32_bf16 v[104:107], a[168:171], v[148:151], v[104:107]
    v_cndmask_b32 v66, v66, 0, s[82:83]
    v_cndmask_b32 v67, v67, 0, s[82:83]
    s_waitcnt lgkmcnt(8)
    v_mfma_f32_16x16x32_bf16 v[104:107], a[192:195], v[152:155], v[104:107]
    s_add_u32 m0, s52, 81920
    s_add_u32 s58, s72, 2048
    s_add_u32 s57, s58, s68
    v_mfma_f32_16x16x32_bf16 v[104:107], a[216:219], v[156:159], v[104:107]
    buffer_load_dwordx4 v3, s[24:27], s57 offen offset:0 sc1 lds
    s_waitcnt lgkmcnt(4)
    v_mfma_f32_16x16x32_bf16 v[104:107], a[240:243], v[160:163], v[104:107]
    v_mfma_f32_16x16x32_bf16 v[104:107], v[184:187], v[164:167], v[104:107]
    s_waitcnt lgkmcnt(0)
    v_mfma_f32_16x16x32_bf16 v[104:107], v[208:211], v[168:171], v[104:107]
    v_mfma_f32_16x16x32_bf16 v[104:107], v[232:235], v[172:175], v[104:107]
    s_waitcnt vmcnt(5)
    s_barrier
    v_mfma_f32_16x16x32_bf16 v[108:111], a[4:7], v[120:123], 0
    ds_read_b64_tr_b16 v[120:121], v4 offset:49152
    ds_read_b64_tr_b16 v[122:123], v25 offset:49152
    s_add_u32 s57, s58, s69
    v_mfma_f32_16x16x32_bf16 v[108:111], a[28:31], v[124:127], v[108:111]
    buffer_load_dwordx4 v3, s[24:27], s57 offen offset:1024 sc1 lds
    v_mfma_f32_16x16x32_bf16 v[108:111], a[52:55], v[128:131], v[108:111]
    ds_read_b64_tr_b16 v[124:125], v4 offset:50176
    ds_read_b64_tr_b16 v[126:127], v25 offset:50176
    v_mfma_f32_16x16x32_bf16 v[108:111], a[76:79], v[132:135], v[108:111]
    ds_read_b64_tr_b16 v[128:129], v4 offset:51200
    ds_read_b64_tr_b16 v[130:131], v25 offset:51200
    v_mfma_f32_16x16x32_bf16 v[108:111], a[100:103], v[136:139], v[108:111]
    ds_read_b64_tr_b16 v[132:133], v4 offset:52224
    v_mfma_f32_16x16x32_bf16 v[108:111], a[124:127], v[140:143], v[108:111]
    ds_read_b64_tr_b16 v[134:135], v25 offset:52224
    ds_read_b64_tr_b16 v[136:137], v4 offset:53248
    v_mfma_f32_16x16x32_bf16 v[108:111], a[148:151], v[144:147], v[108:111]
    ds_read_b64_tr_b16 v[138:139], v25 offset:53248
    s_add_u32 s57, s58, s70
    v_mfma_f32_16x16x32_bf16 v[108:111], a[172:175], v[148:151], v[108:111]
    buffer_load_dwordx4 v24, s[24:27], s57 offen offset:2048 sc1 lds
    v_mfma_f32_16x16x32_bf16 v[108:111], a[196:199], v[152:155], v[108:111]
    ds_read_b64_tr_b16 v[140:141], v4 offset:54272
    ds_read_b64_tr_b16 v[142:143], v25 offset:54272
    v_mfma_f32_16x16x32_bf16 v[108:111], a[220:223], v[156:159], v[108:111]
    ds_read_b64_tr_b16 v[144:145], v4 offset:55296
    ds_read_b64_tr_b16 v[146:147], v25 offset:55296
    v_mfma_f32_16x16x32_bf16 v[108:111], a[244:247], v[160:163], v[108:111]
    ds_read_b64_tr_b16 v[148:149], v4 offset:56320
    ds_read_b64_tr_b16 v[150:151], v25 offset:56320
    v_mfma_f32_16x16x32_bf16 v[108:111], v[188:191], v[164:167], v[108:111]
    ds_read_b64_tr_b16 v[152:153], v4 offset:57344
    v_cvt_pk_bf16_f32 v68, v104, v105
    v_mfma_f32_16x16x32_bf16 v[108:111], v[212:215], v[168:171], v[108:111]
    ds_read_b64_tr_b16 v[154:155], v25 offset:57344
    ds_read_b64_tr_b16 v[156:157], v4 offset:58368
    s_add_u32 s57, s58, s71
    v_mfma_f32_16x16x32_bf16 v[108:111], v[236:239], v[172:175], v[108:111]
    buffer_load_dwordx4 v3, s[24:27], s57 offen offset:3072 sc1 lds
    s_waitcnt lgkmcnt(15)
    v_mfma_f32_16x16x32_bf16 v[112:115], a[8:11], v[120:123], 0
    ds_read_b64_tr_b16 v[158:159], v25 offset:58368
    ds_read_b64_tr_b16 v[160:161], v4 offset:59392
    v_mfma_f32_16x16x32_bf16 v[112:115], a[32:35], v[124:127], v[112:115]
    ds_read_b64_tr_b16 v[162:163], v25 offset:59392
    ds_read_b64_tr_b16 v[164:165], v4 offset:60416
    s_waitcnt lgkmcnt(15)
    v_mfma_f32_16x16x32_bf16 v[112:115], a[56:59], v[128:131], v[112:115]
    ds_read_b64_tr_b16 v[166:167], v25 offset:60416
    v_cvt_pk_bf16_f32 v69, v106, v107
    v_mfma_f32_16x16x32_bf16 v[112:115], a[80:83], v[132:135], v[112:115]
    ds_read_b64_tr_b16 v[168:169], v4 offset:61440
    s_waitcnt lgkmcnt(13)
    v_mfma_f32_16x16x32_bf16 v[112:115], a[104:107], v[136:139], v[112:115]
    ds_read_b64_tr_b16 v[170:171], v25 offset:61440
    ds_read_b64_tr_b16 v[172:173], v4 offset:62464
    s_add_u32 m0, s52, 98304
    s_add_u32 s58, s72, 2560
    s_add_u32 s57, s58, s68
    v_mfma_f32_16x16x32_bf16 v[112:115], a[128:131], v[140:143], v[112:115]
    buffer_load_dwordx4 v3, s[24:27], s57 offen offset:0 sc1 lds
    s_waitcnt lgkmcnt(11)
    v_mfma_f32_16x16x32_bf16 v[112:115], a[152:155], v[144:147], v[112:115]
    ds_read_b64_tr_b16 v[174:175], v25 offset:62464
    v_cvt_pk_bf16_f32 v70, v108, v109
    v_mfma_f32_16x16x32_bf16 v[112:115], a[176:179], v[148:151], v[112:115]
    v_cvt_pk_bf16_f32 v71, v110, v111
    v_cndmask_b32 v70, v70, 0, s[82:83]
    s_waitcnt lgkmcnt(8)
    v_mfma_f32_16x16x32_bf16 v[112:115], a[200:203], v[152:155], v[112:115]
    v_cndmask_b32 v71, v71, 0, s[82:83]
    v_mov_b32 v8, 0
    v_mfma_f32_16x16x32_bf16 v[112:115], a[224:227], v[156:159], v[112:115]
    v_mov_b32 v9, 0
    v_mov_b32 v10, 0
    s_waitcnt lgkmcnt(4)
    v_mfma_f32_16x16x32_bf16 v[112:115], a[248:251], v[160:163], v[112:115]
    s_add_u32 s57, s58, s69
    v_mfma_f32_16x16x32_bf16 v[72:75], v[52:55], v[68:71], 0
    v_mfma_f32_16x16x32_bf16 v[112:115], v[192:195], v[164:167], v[112:115]
    buffer_load_dwordx4 v3, s[24:27], s57 offen offset:1024 sc1 lds
    s_waitcnt lgkmcnt(0)
    v_mfma_f32_16x16x32_bf16 v[112:115], v[216:219], v[168:171], v[112:115]
    v_mfma_f32_16x16x32_bf16 v[76:79], v[56:59], v[68:71], 0
    v_mfma_f32_16x16x32_bf16 v[112:115], v[240:243], v[172:175], v[112:115]
    ds_read_u16_d16_hi v8, v93 offset:0
    ds_read_u16_d16_hi v9, v94 offset:0
    v_mfma_f32_16x16x32_bf16 v[116:119], a[12:15], v[120:123], 0
    ds_read_u16_d16_hi v10, v92 offset:0
    v_mfma_f32_16x16x32_bf16 v[116:119], a[36:39], v[124:127], v[116:119]
    v_mfma_f32_16x16x32_bf16 v[116:119], a[60:63], v[128:131], v[116:119]
    s_add_u32 s57, s58, s70
    v_mfma_f32_16x16x32_bf16 v[116:119], a[84:87], v[132:135], v[116:119]
    buffer_load_dwordx4 v24, s[24:27], s57 offen offset:2048 sc1 lds
    v_mfma_f32_16x16x32_bf16 v[116:119], a[108:111], v[136:139], v[116:119]
    v_cndmask_b32 v26, v72, v73, s[76:77]
    v_cndmask_b32 v27, v74, v75, s[76:77]
    v_mfma_f32_16x16x32_bf16 v[116:119], a[132:135], v[140:143], v[116:119]
    v_cndmask_b32 v28, v76, v77, s[76:77]
    v_cndmask_b32 v29, v78, v79, s[76:77]
    v_mfma_f32_16x16x32_bf16 v[116:119], a[156:159], v[144:147], v[116:119]
    v_cvt_pk_bf16_f32 v52, v112, v113
    v_cvt_pk_bf16_f32 v53, v114, v115
    v_mfma_f32_16x16x32_bf16 v[116:119], a[180:183], v[148:151], v[116:119]
    v_cndmask_b32 v26, v26, v28, s[78:79]
    v_cndmask_b32 v27, v27, v29, s[80:81]
    v_mfma_f32_16x16x32_bf16 v[116:119], a[204:207], v[152:155], v[116:119]
    s_add_u32 s57, s58, s71
    s_waitcnt lgkmcnt(0)
    v_mfma_f32_16x16x32_bf16 v[116:119], a[228:231], v[156:159], v[116:119]
    buffer_load_dwordx4 v3, s[24:27], s57 offen offset:3072 sc1 lds
    v_mfma_f32_16x16x32_bf16 v[116:119], a[252:255], v[160:163], v[116:119]
    v_mul_f32 v26, v26, v8
    v_mul_f32 v27, v27, v9
    v_mfma_f32_16x16x32_bf16 v[116:119], v[196:199], v[164:167], v[116:119]
    v_mul_f32 v11, s91, v10
    v_cndmask_b32 v26, v26, v18, s[84:85]
    v_mfma_f32_16x16x32_bf16 v[116:119], v[220:223], v[168:171], v[116:119]
    v_cndmask_b32 v27, v27, v18, s[86:87]
    v_max_f32 v28, v26, v27
    v_mfma_f32_16x16x32_bf16 v[116:119], v[244:247], v[172:175], v[116:119]
    v_mov_b32 v29, v28
    v_mfma_f32_16x16x32_bf16 v[96:99], v[120:123], a[16:19], 0
    s_add_u32 m0, s52, 114688
    s_add_u32 s58, s72, 3072
    s_add_u32 s57, s58, s68
    v_mfma_f32_16x16x32_bf16 v[96:99], v[124:127], a[40:43], v[96:99]
    buffer_load_dwordx4 v3, s[24:27], s57 offen offset:0 sc1 lds
    v_mfma_f32_16x16x32_bf16 v[96:99], v[128:131], a[64:67], v[96:99]
    v_permlane16_swap_b32 v28, v29
    v_max_f32 v28, v28, v29
    v_mfma_f32_16x16x32_bf16 v[96:99], v[132:135], a[88:91], v[96:99]
    v_mov_b32 v29, v28
    v_mfma_f32_16x16x32_bf16 v[96:99], v[136:139], a[112:115], v[96:99]
    v_mfma_f32_16x16x32_bf16 v[96:99], v[140:143], a[136:139], v[96:99]
    v_permlane32_swap_b32 v28, v29
    v_max_f32 v28, v28, v29
    v_mfma_f32_16x16x32_bf16 v[96:99], v[144:147], a[160:163], v[96:99]
    s_add_u32 s57, s58, s69
    v_cvt_pk_bf16_f32 v54, v116, v117
    v_mfma_f32_16x16x32_bf16 v[96:99], v[148:151], a[184:187], v[96:99]
    buffer_load_dwordx4 v3, s[24:27], s57 offen offset:1024 sc1 lds
    v_mfma_f32_16x16x32_bf16 v[96:99], v[152:155], a[208:211], v[96:99]
    v_cvt_pk_bf16_f32 v55, v118, v119
    v_cndmask_b32 v54, v54, 0, s[82:83]
    v_mfma_f32_16x16x32_bf16 v[96:99], v[156:159], a[232:235], v[96:99]
    v_cndmask_b32 v55, v55, 0, s[82:83]
    v_sub_f32 v26, v26, v28
    v_mfma_f32_16x16x32_bf16 v[96:99], v[160:163], v[176:179], v[96:99]
    v_sub_f32 v27, v27, v28
    v_mul_f32 v26, v11, v26
    v_mfma_f32_16x16x32_bf16 v[96:99], v[164:167], v[200:203], v[96:99]
    v_mul_f32 v27, v11, v27
    v_exp_f32 v26, v26
    v_mfma_f32_16x16x32_bf16 v[96:99], v[168:171], v[224:227], v[96:99]
    s_add_u32 s57, s58, s70
    v_exp_f32 v27, v27
    v_mfma_f32_16x16x32_bf16 v[96:99], v[172:175], v[248:251], v[96:99]
    buffer_load_dwordx4 v24, s[24:27], s57 offen offset:2048 sc1 lds
    v_mfma_f32_16x16x32_bf16 v[100:103], v[120:123], a[20:23], 0
    v_add_f32 v28, v26, v27
    v_mov_b32 v29, v28
    v_mfma_f32_16x16x32_bf16 v[100:103], v[124:127], a[44:47], v[100:103]
    v_mfma_f32_16x16x32_bf16 v[100:103], v[128:131], a[68:71], v[100:103]
    v_permlane16_swap_b32 v28, v29
    v_add_f32 v28, v28, v29
    v_mfma_f32_16x16x32_bf16 v[100:103], v[132:135], a[92:95], v[100:103]
    v_mov_b32 v29, v28
    v_mfma_f32_16x16x32_bf16 v[100:103], v[136:139], a[116:119], v[100:103]
    s_add_u32 s57, s58, s71
    v_mfma_f32_16x16x32_bf16 v[100:103], v[140:143], a[140:143], v[100:103]
    buffer_load_dwordx4 v3, s[24:27], s57 offen offset:3072 sc1 lds
    v_mfma_f32_16x16x32_bf16 v[100:103], v[144:147], a[164:167], v[100:103]
    v_cvt_pk_bf16_f32 v38, v96, v97
    v_cvt_pk_bf16_f32 v39, v98, v99
    v_mfma_f32_16x16x32_bf16 v[100:103], v[148:151], a[188:191], v[100:103]
    v_permlane32_swap_b32 v28, v29
    v_add_f32 v28, v28, v29
    v_mfma_f32_16x16x32_bf16 v[100:103], v[152:155], a[212:215], v[100:103]
    v_rcp_f32 v28, v28
    v_mfma_f32_16x16x32_bf16 v[100:103], v[156:159], a[236:239], v[100:103]
    v_mul_f32 v26, v26, v8
    v_mul_f32 v27, v27, v9
    v_mfma_f32_16x16x32_bf16 v[100:103], v[160:163], v[180:183], v[100:103]
    s_add_u32 m0, s52, 131072
    s_add_u32 s58, s72, 3584
    s_add_u32 s57, s58, s68
    v_mul_f32 v26, v26, v28
    v_mfma_f32_16x16x32_bf16 v[100:103], v[164:167], v[204:207], v[100:103]
    buffer_load_dwordx4 v3, s[24:27], s57 offen offset:0 sc1 lds
    v_mfma_f32_16x16x32_bf16 v[100:103], v[168:171], v[228:231], v[100:103]
    v_mul_f32 v27, v27, v28
    v_cvt_pk_bf16_f32 v26, v26, v26
    v_mfma_f32_16x16x32_bf16 v[100:103], v[172:175], v[252:255], v[100:103]
    v_cvt_pk_bf16_f32 v27, v27, v27
    v_and_b32 v80, v26, v14
    v_mfma_f32_16x16x32_bf16 v[104:107], a[0:3], v[120:123], 0
    v_and_b32 v81, v27, v15
    v_and_b32 v82, v26, v16
    v_mfma_f32_16x16x32_bf16 v[104:107], a[24:27], v[124:127], v[104:107]
    v_and_b32 v83, v27, v17
    v_mfma_f32_16x16x32_bf16 v[104:107], a[48:51], v[128:131], v[104:107]
    s_add_u32 s57, s58, s69
    v_mfma_f32_16x16x32_bf16 v[104:107], a[72:75], v[132:135], v[104:107]
    buffer_load_dwordx4 v3, s[24:27], s57 offen offset:1024 sc1 lds
    v_mfma_f32_16x16x32_bf16 v[104:107], a[96:99], v[136:139], v[104:107]
    v_mfma_f32_16x16x32_bf16 v[72:75], v[32:35], v[80:83], 0
    v_mfma_f32_16x16x32_bf16 v[104:107], a[120:123], v[140:143], v[104:107]
L_wa_2:
    s_cbranch_execz L_wa_ret
    v_mfma_f32_16x16x32_bf16 v[76:79], v[42:45], v[80:83], 0
    v_mfma_f32_16x16x32_bf16 v[104:107], a[144:147], v[144:147], v[104:107]
    v_cvt_pk_bf16_f32 v48, v100, v101
    v_cvt_pk_bf16_f32 v49, v102, v103
    v_mfma_f32_16x16x32_bf16 v[104:107], a[168:171], v[148:151], v[104:107]
    s_add_u32 s53, s74, 0
    v_mfma_f32_16x16x32_bf16 v[104:107], a[192:195], v[152:155], v[104:107]
    s_add_u32 s57, s58, s70
    v_mfma_f32_16x16x32_bf16 v[104:107], a[216:219], v[156:159], v[104:107]
    buffer_load_dwordx4 v24, s[24:27], s57 offen offset:2048 sc1 lds
    v_mfma_f32_16x16x32_bf16 v[104:107], a[240:243], v[160:163], v[104:107]
    v_mfma_f32_16x16x32_bf16 v[104:107], v[184:187], v[164:167], v[104:107]
    v_mfma_f32_16x16x32_bf16 v[104:107], v[208:211], v[168:171], v[104:107]
    v_cvt_pk_bf16_f32 v84, v72, v73
    v_cvt_pk_bf16_f32 v85, v74, v75
    v_mfma_f32_16x16x32_bf16 v[104:107], v[232:235], v[172:175], v[104:107]
    v_cvt_pk_bf16_f32 v86, v76, v77
    v_cvt_pk_bf16_f32 v87, v78, v79
    s_waitcnt vmcnt(7)
    s_barrier
    v_mfma_f32_16x16x32_bf16 v[108:111], a[4:7], v[120:123], 0
    v_add_u32 v4, 65536, v4
    v_add_u32 v25, 65536, v25
    ds_read_b64_tr_b16 v[120:121], v4 offset:0
    ds_read_b64_tr_b16 v[122:123], v25 offset:0
    s_add_u32 s57, s58, s71
    v_mfma_f32_16x16x32_bf16 v[108:111], a[28:31], v[124:127], v[108:111]
    buffer_load_dwordx4 v3, s[24:27], s57 offen offset:3072 sc1 lds
    v_mfma_f32_16x16x32_bf16 v[108:111], a[52:55], v[128:131], v[108:111]
    ds_read_b64_tr_b16 v[124:125], v4 offset:1024
    ds_read_b64_tr_b16 v[126:127], v25 offset:1024
    v_mfma_f32_16x16x32_bf16 v[108:111], a[76:79], v[132:135], v[108:111]
    ds_read_b64_tr_b16 v[128:129], v4 offset:2048
    ds_read_b64_tr_b16 v[130:131], v25 offset:2048
    v_mfma_f32_16x16x32_bf16 v[108:111], a[100:103], v[136:139], v[108:111]
    ds_read_b64_tr_b16 v[132:133], v4 offset:3072
    buffer_store_dwordx4 v[84:87], v23, s[24:27], s53 offen sc1
    v_mfma_f32_16x16x32_bf16 v[108:111], a[124:127], v[140:143], v[108:111]
    ds_read_b64_tr_b16 v[134:135], v25 offset:3072
    ds_read_b64_tr_b16 v[136:137], v4 offset:4096
    v_mfma_f32_16x16x32_bf16 v[108:111], a[148:151], v[144:147], v[108:111]
    ds_read_b64_tr_b16 v[138:139], v25 offset:4096
    s_add_u32 s57, s73, 0
    v_mfma_f32_16x16x32_bf16 v[108:111], a[172:175], v[148:151], v[108:111]
    buffer_load_dword v22, v5, s[20:23], s57 offen
    v_mfma_f32_16x16x32_bf16 v[108:111], a[196:199], v[152:155], v[108:111]
    ds_read_b64_tr_b16 v[140:141], v4 offset:5120
    ds_read_b64_tr_b16 v[142:143], v25 offset:5120
    v_mfma_f32_16x16x32_bf16 v[108:111], a[220:223], v[156:159], v[108:111]
    ds_read_b64_tr_b16 v[144:145], v4 offset:6144
    ds_read_b64_tr_b16 v[146:147], v25 offset:6144
    v_mfma_f32_16x16x32_bf16 v[108:111], a[244:247], v[160:163], v[108:111]
    ds_read_b64_tr_b16 v[148:149], v4 offset:7168
    ds_read_b64_tr_b16 v[150:151], v25 offset:7168
    v_mfma_f32_16x16x32_bf16 v[108:111], v[188:191], v[164:167], v[108:111]
    ds_read_b64_tr_b16 v[152:153], v4 offset:8192
    v_cvt_pk_bf16_f32 v68, v104, v105
    v_mfma_f32_16x16x32_bf16 v[108:111], v[212:215], v[168:171], v[108:111]
    ds_read_b64_tr_b16 v[154:155], v25 offset:8192
    ds_read_b64_tr_b16 v[156:157], v4 offset:9216
    v_mfma_f32_16x16x32_bf16 v[108:111], v[236:239], v[172:175], v[108:111]
    ds_read_b64_tr_b16 v[158:159], v25 offset:9216
    v_cvt_pk_bf16_f32 v69, v106, v107
    s_waitcnt lgkmcnt(15)
    v_mfma_f32_16x16x32_bf16 v[112:115], a[8:11], v[120:123], 0
    ds_read_b64_tr_b16 v[160:161], v4 offset:10240
    v_cndmask_b32 v80, v84, v86, s[88:89]
    v_mfma_f32_16x16x32_bf16 v[112:115], a[32:35], v[124:127], v[112:115]
    ds_read_b64_tr_b16 v[162:163], v25 offset:10240
    ds_read_b64_tr_b16 v[164:165], v4 offset:11264
    s_waitcnt lgkmcnt(15)
    v_mfma_f32_16x16x32_bf16 v[112:115], a[56:59], v[128:131], v[112:115]
    ds_read_b64_tr_b16 v[166:167], v25 offset:11264
    v_cndmask_b32 v81, v85, v87, s[88:89]
    v_mfma_f32_16x16x32_bf16 v[112:115], a[80:83], v[132:135], v[112:115]
    ds_read_b64_tr_b16 v[168:169], v4 offset:12288
    ds_write_b64 v95, v[80:81] offset:0
    s_waitcnt lgkmcnt(14)
    v_mfma_f32_16x16x32_bf16 v[112:115], a[104:107], v[136:139], v[112:115]
    ds_read_b64_tr_b16 v[170:171], v25 offset:12288
    ds_read_b64_tr_b16 v[172:173], v4 offset:13312
    v_mfma_f32_16x16x32_bf16 v[112:115], a[128:131], v[140:143], v[112:115]
    ds_read_b64_tr_b16 v[174:175], v25 offset:13312
    s_waitcnt lgkmcnt(13)
    v_mfma_f32_16x16x32_bf16 v[112:115], a[152:155], v[144:147], v[112:115]
    v_cvt_pk_bf16_f32 v70, v108, v109
    v_cvt_pk_bf16_f32 v71, v110, v111
    v_mfma_f32_16x16x32_bf16 v[112:115], a[176:179], v[148:151], v[112:115]
    v_cndmask_b32 v70, v70, 0, s[82:83]
    v_cndmask_b32 v71, v71, 0, s[82:83]
    s_waitcnt lgkmcnt(9)
    v_mfma_f32_16x16x32_bf16 v[112:115], a[200:203], v[152:155], v[112:115]
    v_mfma_f32_16x16x32_bf16 v[72:75], v[56:59], v[64:67], 0
    v_mfma_f32_16x16x32_bf16 v[112:115], a[224:227], v[156:159], v[112:115]
    v_mfma_f32_16x16x32_bf16 v[76:79], v[60:63], v[64:67], 0
    s_waitcnt lgkmcnt(5)
    v_mfma_f32_16x16x32_bf16 v[112:115], a[248:251], v[160:163], v[112:115]
    ds_read_u16_d16_hi v8, v93 offset:16384
    ds_read_u16_d16_hi v9, v94 offset:16384
    v_mfma_f32_16x16x32_bf16 v[112:115], v[192:195], v[164:167], v[112:115]
    ds_read_u16_d16_hi v10, v92 offset:16384
    s_waitcnt lgkmcnt(3)
    v_mfma_f32_16x16x32_bf16 v[112:115], v[216:219], v[168:171], v[112:115]
    v_mfma_f32_16x16x32_bf16 v[112:115], v[240:243], v[172:175], v[112:115]
    v_mfma_f32_16x16x32_bf16 v[116:119], a[12:15], v[120:123], 0
    v_mfma_f32_16x16x32_bf16 v[116:119], a[36:39], v[124:127], v[116:119]
    v_cndmask_b32 v26, v72, v73, s[76:77]
    v_cndmask_b32 v27, v74, v75, s[76:77]
    v_mfma_f32_16x16x32_bf16 v[116:119], a[60:63], v[128:131], v[116:119]
    v_cndmask_b32 v28, v76, v77, s[76:77]
    v_cndmask_b32 v29, v78, v79, s[76:77]
    v_mfma_f32_16x16x32_bf16 v[116:119], a[84:87], v[132:135], v[116:119]
    v_cndmask_b32 v26, v26, v28, s[78:79]
    v_cndmask_b32 v27, v27, v29, s[80:81]
    v_mfma_f32_16x16x32_bf16 v[116:119], a[108:111], v[136:139], v[116:119]
    s_waitcnt lgkmcnt(0)
    v_mul_f32 v26, v26, v8
    v_mfma_f32_16x16x32_bf16 v[116:119], a[132:135], v[140:143], v[116:119]
    v_mul_f32 v27, v27, v9
    v_mul_f32 v11, s91, v10
    v_mfma_f32_16x16x32_bf16 v[116:119], a[156:159], v[144:147], v[116:119]
    v_cvt_pk_bf16_f32 v56, v112, v113
    v_cvt_pk_bf16_f32 v57, v114, v115
    v_mfma_f32_16x16x32_bf16 v[116:119], a[180:183], v[148:151], v[116:119]
    v_max_f32 v28, v26, v27
    v_mov_b32 v29, v28
    v_mfma_f32_16x16x32_bf16 v[116:119], a[204:207], v[152:155], v[116:119]
    v_mfma_f32_16x16x32_bf16 v[116:119], a[228:231], v[156:159], v[116:119]
    v_permlane16_swap_b32 v28, v29
    v_max_f32 v28, v28, v29
    v_mfma_f32_16x16x32_bf16 v[116:119], a[252:255], v[160:163], v[116:119]
    v_mov_b32 v29, v28
    v_mfma_f32_16x16x32_bf16 v[116:119], v[196:199], v[164:167], v[116:119]
    v_mfma_f32_16x16x32_bf16 v[116:119], v[220:223], v[168:171], v[116:119]
    v_permlane32_swap_b32 v28, v29
    v_max_f32 v28, v28, v29
    v_mfma_f32_16x16x32_bf16 v[116:119], v[244:247], v[172:175], v[116:119]
    v_sub_f32 v26, v26, v28
    v_sub_f32 v27, v27, v28
    v_mfma_f32_16x16x32_bf16 v[96:99], v[120:123], a[16:19], 0
    v_mul_f32 v26, v11, v26
    v_mul_f32 v27, v11, v27
    v_mfma_f32_16x16x32_bf16 v[96:99], v[124:127], a[40:43], v[96:99]
    v_exp_f32 v26, v26
    v_mfma_f32_16x16x32_bf16 v[96:99], v[128:131], a[64:67], v[96:99]
    v_exp_f32 v27, v27
    v_mfma_f32_16x16x32_bf16 v[96:99], v[132:135], a[88:91], v[96:99]
    v_add_f32 v28, v26, v27
    v_mov_b32 v29, v28
    v_mfma_f32_16x16x32_bf16 v[96:99], v[136:139], a[112:115], v[96:99]
    s_add_u32 s57, s73, 524288
    v_mfma_f32_16x16x32_bf16 v[96:99], v[140:143], a[136:139], v[96:99]
    buffer_load_dword v22, v5, s[20:23], s57 offen
    v_mfma_f32_16x16x32_bf16 v[96:99], v[144:147], a[160:163], v[96:99]
    v_cvt_pk_bf16_f32 v58, v116, v117
    v_cvt_pk_bf16_f32 v59, v118, v119
    v_mfma_f32_16x16x32_bf16 v[96:99], v[148:151], a[184:187], v[96:99]
    v_cndmask_b32 v58, v58, 0, s[82:83]
    v_cndmask_b32 v59, v59, 0, s[82:83]
    v_mfma_f32_16x16x32_bf16 v[96:99], v[152:155], a[208:211], v[96:99]
    v_permlane16_swap_b32 v28, v29
    v_add_f32 v28, v28, v29
    v_mfma_f32_16x16x32_bf16 v[96:99], v[156:159], a[232:235], v[96:99]
    v_mov_b32 v29, v28
    v_mfma_f32_16x16x32_bf16 v[96:99], v[160:163], v[176:179], v[96:99]
    v_mfma_f32_16x16x32_bf16 v[96:99], v[164:167], v[200:203], v[96:99]
    v_permlane32_swap_b32 v28, v29
    v_add_f32 v28, v28, v29
    v_mfma_f32_16x16x32_bf16 v[96:99], v[168:171], v[224:227], v[96:99]
    v_rcp_f32 v28, v28
    v_mfma_f32_16x16x32_bf16 v[96:99], v[172:175], v[248:251], v[96:99]
    v_mul_f32 v26, v26, v8
    v_mul_f32 v27, v27, v9
    v_mfma_f32_16x16x32_bf16 v[100:103], v[120:123], a[20:23], 0
    v_mul_f32 v26, v26, v28
    v_mul_f32 v27, v27, v28
    v_mfma_f32_16x16x32_bf16 v[100:103], v[124:127], a[44:47], v[100:103]
    v_cvt_pk_bf16_f32 v26, v26, v26
    v_cvt_pk_bf16_f32 v27, v27, v27
    v_mfma_f32_16x16x32_bf16 v[100:103], v[128:131], a[68:71], v[100:103]
    v_and_b32 v80, v26, v14
    v_and_b32 v81, v27, v15
    v_mfma_f32_16x16x32_bf16 v[100:103], v[132:135], a[92:95], v[100:103]
    v_and_b32 v82, v26, v16
    v_and_b32 v83, v27, v17
    v_mfma_f32_16x16x32_bf16 v[100:103], v[136:139], a[116:119], v[100:103]
    v_mfma_f32_16x16x32_bf16 v[100:103], v[140:143], a[140:143], v[100:103]
    v_mfma_f32_16x16x32_bf16 v[72:75], v[34:37], v[80:83], 0
    v_mfma_f32_16x16x32_bf16 v[100:103], v[144:147], a[164:167], v[100:103]
    v_cvt_pk_bf16_f32 v40, v96, v97
    v_cvt_pk_bf16_f32 v41, v98, v99
    v_mfma_f32_16x16x32_bf16 v[100:103], v[148:151], a[188:191], v[100:103]
    v_cvt_pk_bf16_f32 v32, v96, v97
    v_cvt_pk_bf16_f32 v33, v98, v99
    v_mfma_f32_16x16x32_bf16 v[100:103], v[152:155], a[212:215], v[100:103]
    v_mfma_f32_16x16x32_bf16 v[76:79], v[44:47], v[80:83], 0
    v_mfma_f32_16x16x32_bf16 v[100:103], v[156:159], a[236:239], v[100:103]
    s_add_u32 s53, s74, 16384
    v_mfma_f32_16x16x32_bf16 v[100:103], v[160:163], v[180:183], v[100:103]
    v_mfma_f32_16x16x32_bf16 v[100:103], v[164:167], v[204:207], v[100:103]
    v_mfma_f32_16x16x32_bf16 v[100:103], v[168:171], v[228:231], v[100:103]
    v_mfma_f32_16x16x32_bf16 v[100:103], v[172:175], v[252:255], v[100:103]
    v_mfma_f32_16x16x32_bf16 v[104:107], a[0:3], v[120:123], 0
    v_cvt_pk_bf16_f32 v84, v72, v73
    v_cvt_pk_bf16_f32 v85, v74, v75
    v_mfma_f32_16x16x32_bf16 v[104:107], a[24:27], v[124:127], v[104:107]
    v_cvt_pk_bf16_f32 v86, v76, v77
    v_cvt_pk_bf16_f32 v87, v78, v79
    v_mfma_f32_16x16x32_bf16 v[104:107], a[48:51], v[128:131], v[104:107]
    buffer_store_dwordx4 v[84:87], v23, s[24:27], s53 offen sc1
    v_mfma_f32_16x16x32_bf16 v[104:107], a[72:75], v[132:135], v[104:107]
    v_cndmask_b32 v80, v84, v86, s[88:89]
    v_cndmask_b32 v81, v85, v87, s[88:89]
    v_mfma_f32_16x16x32_bf16 v[104:107], a[96:99], v[136:139], v[104:107]
    ds_write_b64 v95, v[80:81] offset:256
    v_mfma_f32_16x16x32_bf16 v[104:107], a[120:123], v[140:143], v[104:107]
    v_mfma_f32_16x16x32_bf16 v[72:75], v[60:63], v[68:71], 0
    v_mfma_f32_16x16x32_bf16 v[104:107], a[144:147], v[144:147], v[104:107]
    v_cvt_pk_bf16_f32 v50, v100, v101
    v_cvt_pk_bf16_f32 v51, v102, v103
    v_mfma_f32_16x16x32_bf16 v[104:107], a[168:171], v[148:151], v[104:107]
    v_cvt_pk_bf16_f32 v42, v100, v101
    v_cvt_pk_bf16_f32 v43, v102, v103
    v_mfma_f32_16x16x32_bf16 v[104:107], a[192:195], v[152:155], v[104:107]
    v_mfma_f32_16x16x32_bf16 v[76:79], v[52:55], v[68:71], 0
    v_mfma_f32_16x16x32_bf16 v[104:107], a[216:219], v[156:159], v[104:107]
    ds_read_u16_d16_hi v8, v93 offset:32768
    ds_read_u16_d16_hi v9, v94 offset:32768
    v_mfma_f32_16x16x32_bf16 v[104:107], a[240:243], v[160:163], v[104:107]
    ds_read_u16_d16_hi v10, v92 offset:32768
    v_mfma_f32_16x16x32_bf16 v[104:107], v[184:187], v[164:167], v[104:107]
    v_mfma_f32_16x16x32_bf16 v[104:107], v[208:211], v[168:171], v[104:107]
    v_mfma_f32_16x16x32_bf16 v[104:107], v[232:235], v[172:175], v[104:107]
    v_mfma_f32_16x16x32_bf16 v[108:111], a[4:7], v[120:123], 0
    ds_read_b64_tr_b16 v[120:121], v4 offset:16384
    ds_read_b64_tr_b16 v[122:123], v25 offset:16384
    v_mfma_f32_16x16x32_bf16 v[108:111], a[28:31], v[124:127], v[108:111]
    ds_read_b64_tr_b16 v[124:125], v4 offset:17408
    v_cndmask_b32 v26, v72, v73, s[76:77]
    v_mfma_f32_16x16x32_bf16 v[108:111], a[52:55], v[128:131], v[108:111]
    ds_read_b64_tr_b16 v[126:127], v25 offset:17408
    ds_read_b64_tr_b16 v[128:129], v4 offset:18432
    s_add_u32 s57, s75, 0
    v_mfma_f32_16x16x32_bf16 v[108:111], a[76:79], v[132:135], v[108:111]
    buffer_load_dword v22, v20, s[12:15], s57 offen
    v_mfma_f32_16x16x32_bf16 v[108:111], a[100:103], v[136:139], v[108:111]
    ds_read_b64_tr_b16 v[130:131], v25 offset:18432
    ds_read_b64_tr_b16 v[132:133], v4 offset:19456
    v_mfma_f32_16x16x32_bf16 v[108:111], a[124:127], v[140:143], v[108:111]
    ds_read_b64_tr_b16 v[134:135], v25 offset:19456
    ds_read_b64_tr_b16 v[136:137], v4 offset:20480
    v_mfma_f32_16x16x32_bf16 v[108:111], a[148:151], v[144:147], v[108:111]
    ds_read_b64_tr_b16 v[138:139], v25 offset:20480
    v_cvt_pk_bf16_f32 v64, v104, v105
    v_mfma_f32_16x16x32_bf16 v[108:111], a[172:175], v[148:151], v[108:111]
    ds_read_b64_tr_b16 v[140:141], v4 offset:21504
    ds_read_b64_tr_b16 v[142:143], v25 offset:21504
    v_mfma_f32_16x16x32_bf16 v[108:111], a[196:199], v[152:155], v[108:111]
    ds_read_b64_tr_b16 v[144:145], v4 offset:22528
    v_cvt_pk_bf16_f32 v65, v106, v107
    v_mfma_f32_16x16x32_bf16 v[108:111], a[220:223], v[156:159], v[108:111]
    ds_read_b64_tr_b16 v[146:147], v25 offset:22528
    v_cndmask_b32 v27, v74, v75, s[76:77]
    v_mfma_f32_16x16x32_bf16 v[108:111], a[244:247], v[160:163], v[108:111]
    ds_read_b64_tr_b16 v[148:149], v4 offset:23552
    ds_read_b64_tr_b16 v[150:151], v25 offset:23552
    v_mfma_f32_16x16x32_bf16 v[108:111], v[188:191], v[164:167], v[108:111]
    ds_read_b64_tr_b16 v[152:153], v4 offset:24576
    v_cndmask_b32 v28, v76, v77, s[76:77]
    v_mfma_f32_16x16x32_bf16 v[108:111], v[212:215], v[168:171], v[108:111]
    ds_read_b64_tr_b16 v[154:155], v25 offset:24576
    ds_read_b64_tr_b16 v[156:157], v4 offset:25600
    v_mfma_f32_16x16x32_bf16 v[108:111], v[236:239], v[172:175], v[108:111]
    ds_read_b64_tr_b16 v[158:159], v25 offset:25600
    v_cndmask_b32 v29, v78, v79, s[76:77]
    s_waitcnt lgkmcnt(15)
    v_mfma_f32_16x16x32_bf16 v[112:115], a[8:11], v[120:123], 0
    ds_read_b64_tr_b16 v[160:161], v4 offset:26624
    v_cndmask_b32 v26, v26, v28, s[78:79]
    v_mfma_f32_16x16x32_bf16 v[112:115], a[32:35], v[124:127], v[112:115]
    ds_read_b64_tr_b16 v[162:163], v25 offset:26624
    ds_read_b64_tr_b16 v[164:165], v4 offset:27648
    s_waitcnt lgkmcnt(15)
    v_mfma_f32_16x16x32_bf16 v[112:115], a[56:59], v[128:131], v[112:115]
    ds_read_b64_tr_b16 v[166:167], v25 offset:27648
    v_cndmask_b32 v27, v27, v29, s[80:81]
    v_mfma_f32_16x16x32_bf16 v[112:115], a[80:83], v[132:135], v[112:115]
    ds_read_b64_tr_b16 v[168:169], v4 offset:28672
    s_waitcnt lgkmcnt(13)
    v_mfma_f32_16x16x32_bf16 v[112:115], a[104:107], v[136:139], v[112:115]
    ds_read_b64_tr_b16 v[170:171], v25 offset:28672
    ds_read_b64_tr_b16 v[172:173], v4 offset:29696
    v_mfma_f32_16x16x32_bf16 v[112:115], a[128:131], v[140:143], v[112:115]
    ds_read_b64_tr_b16 v[174:175], v25 offset:29696
    v_mul_f32 v26, v26, v8
    s_waitcnt lgkmcnt(12)
    v_mfma_f32_16x16x32_bf16 v[112:115], a[152:155], v[144:147], v[112:115]
    v_cvt_pk_bf16_f32 v66, v108, v109
    v_cvt_pk_bf16_f32 v67, v110, v111
    v_mfma_f32_16x16x32_bf16 v[112:115], a[176:179], v[148:151], v[112:115]
    v_cndmask_b32 v66, v66, 0, s[82:83]
    v_cndmask_b32 v67, v67, 0, s[82:83]
    s_waitcnt lgkmcnt(8)
    v_mfma_f32_16x16x32_bf16 v[112:115], a[200:203], v[152:155], v[112:115]
    v_mul_f32 v27, v27, v9
    v_mul_f32 v11, s91, v10
    v_mfma_f32_16x16x32_bf16 v[112:115], a[224:227], v[156:159], v[112:115]
    v_max_f32 v28, v26, v27
    v_mov_b32 v29, v28
    s_waitcnt lgkmcnt(4)
    v_mfma_f32_16x16x32_bf16 v[112:115], a[248:251], v[160:163], v[112:115]
    v_mfma_f32_16x16x32_bf16 v[112:115], v[192:195], v[164:167], v[112:115]
    v_permlane16_swap_b32 v28, v29
    v_max_f32 v28, v28, v29
    s_waitcnt lgkmcnt(0)
    v_mfma_f32_16x16x32_bf16 v[112:115], v[216:219], v[168:171], v[112:115]
    v_mov_b32 v29, v28
    v_mfma_f32_16x16x32_bf16 v[112:115], v[240:243], v[172:175], v[112:115]
    v_mfma_f32_16x16x32_bf16 v[116:119], a[12:15], v[120:123], 0
    v_permlane32_swap_b32 v28, v29
    v_max_f32 v28, v28, v29
    v_mfma_f32_16x16x32_bf16 v[116:119], a[36:39], v[124:127], v[116:119]
    v_sub_f32 v26, v26, v28
    v_sub_f32 v27, v27, v28
    v_mfma_f32_16x16x32_bf16 v[116:119], a[60:63], v[128:131], v[116:119]
    v_mul_f32 v26, v11, v26
    v_mul_f32 v27, v11, v27
    v_mfma_f32_16x16x32_bf16 v[116:119], a[84:87], v[132:135], v[116:119]
    v_exp_f32 v26, v26
    v_mfma_f32_16x16x32_bf16 v[116:119], a[108:111], v[136:139], v[116:119]
    v_exp_f32 v27, v27
    v_mfma_f32_16x16x32_bf16 v[116:119], a[132:135], v[140:143], v[116:119]
    v_add_f32 v28, v26, v27
    v_mov_b32 v29, v28
    v_mfma_f32_16x16x32_bf16 v[116:119], a[156:159], v[144:147], v[116:119]
    v_cvt_pk_bf16_f32 v60, v112, v113
    v_cvt_pk_bf16_f32 v61, v114, v115
    v_mfma_f32_16x16x32_bf16 v[116:119], a[180:183], v[148:151], v[116:119]
    v_permlane16_swap_b32 v28, v29
    v_add_f32 v28, v28, v29
    v_mfma_f32_16x16x32_bf16 v[116:119], a[204:207], v[152:155], v[116:119]
    v_mov_b32 v29, v28
    v_mfma_f32_16x16x32_bf16 v[116:119], a[228:231], v[156:159], v[116:119]
    v_mfma_f32_16x16x32_bf16 v[116:119], a[252:255], v[160:163], v[116:119]
    v_permlane32_swap_b32 v28, v29
    v_add_f32 v28, v28, v29
    v_mfma_f32_16x16x32_bf16 v[116:119], v[196:199], v[164:167], v[116:119]
    v_rcp_f32 v28, v28
    v_mfma_f32_16x16x32_bf16 v[116:119], v[220:223], v[168:171], v[116:119]
    v_mul_f32 v26, v26, v8
    v_mul_f32 v27, v27, v9
    v_mfma_f32_16x16x32_bf16 v[116:119], v[244:247], v[172:175], v[116:119]
    v_mul_f32 v26, v26, v28
    v_mul_f32 v27, v27, v28
    v_mfma_f32_16x16x32_bf16 v[96:99], v[120:123], a[16:19], 0
    s_add_u32 s57, s75, 262144
    v_cvt_pk_bf16_f32 v26, v26, v26
    v_mfma_f32_16x16x32_bf16 v[96:99], v[124:127], a[40:43], v[96:99]
    buffer_load_dword v22, v20, s[12:15], s57 offen
    v_mfma_f32_16x16x32_bf16 v[96:99], v[128:131], a[64:67], v[96:99]
    v_cvt_pk_bf16_f32 v27, v27, v27
    v_and_b32 v80, v26, v14
    v_mfma_f32_16x16x32_bf16 v[96:99], v[132:135], a[88:91], v[96:99]
    v_and_b32 v81, v27, v15
    v_and_b32 v82, v26, v16
    v_mfma_f32_16x16x32_bf16 v[96:99], v[136:139], a[112:115], v[96:99]
    v_and_b32 v83, v27, v17
    v_mfma_f32_16x16x32_bf16 v[96:99], v[140:143], a[136:139], v[96:99]
    v_mfma_f32_16x16x32_bf16 v[96:99], v[144:147], a[160:163], v[96:99]
    v_cvt_pk_bf16_f32 v62, v116, v117
    v_cvt_pk_bf16_f32 v63, v118, v119
    v_mfma_f32_16x16x32_bf16 v[96:99], v[148:151], a[184:187], v[96:99]
    v_cndmask_b32 v62, v62, 0, s[82:83]
    v_cndmask_b32 v63, v63, 0, s[82:83]
    v_mfma_f32_16x16x32_bf16 v[96:99], v[152:155], a[208:211], v[96:99]
    v_mfma_f32_16x16x32_bf16 v[72:75], v[36:39], v[80:83], 0
    v_mfma_f32_16x16x32_bf16 v[96:99], v[156:159], a[232:235], v[96:99]
    v_mfma_f32_16x16x32_bf16 v[76:79], v[46:49], v[80:83], 0
    v_mfma_f32_16x16x32_bf16 v[96:99], v[160:163], v[176:179], v[96:99]
    s_add_u32 s53, s74, 32768
    v_mfma_f32_16x16x32_bf16 v[96:99], v[164:167], v[200:203], v[96:99]
    v_mfma_f32_16x16x32_bf16 v[96:99], v[168:171], v[224:227], v[96:99]
    v_mfma_f32_16x16x32_bf16 v[96:99], v[172:175], v[248:251], v[96:99]
    v_mfma_f32_16x16x32_bf16 v[100:103], v[120:123], a[20:23], 0
    v_mfma_f32_16x16x32_bf16 v[100:103], v[124:127], a[44:47], v[100:103]
    v_cvt_pk_bf16_f32 v84, v72, v73
    v_cvt_pk_bf16_f32 v85, v74, v75
    v_mfma_f32_16x16x32_bf16 v[100:103], v[128:131], a[68:71], v[100:103]
    v_cvt_pk_bf16_f32 v86, v76, v77
    v_cvt_pk_bf16_f32 v87, v78, v79
    v_mfma_f32_16x16x32_bf16 v[100:103], v[132:135], a[92:95], v[100:103]
    buffer_store_dwordx4 v[84:87], v23, s[24:27], s53 offen sc1
    v_mfma_f32_16x16x32_bf16 v[100:103], v[136:139], a[116:119], v[100:103]
    v_cndmask_b32 v80, v84, v86, s[88:89]
    v_cndmask_b32 v81, v85, v87, s[88:89]
    v_mfma_f32_16x16x32_bf16 v[100:103], v[140:143], a[140:143], v[100:103]
    ds_write_b64 v95, v[80:81] offset:512
    v_mfma_f32_16x16x32_bf16 v[100:103], v[144:147], a[164:167], v[100:103]
    v_cvt_pk_bf16_f32 v34, v96, v97
    v_cvt_pk_bf16_f32 v35, v98, v99
    v_mfma_f32_16x16x32_bf16 v[100:103], v[148:151], a[188:191], v[100:103]
    v_mfma_f32_16x16x32_bf16 v[72:75], v[52:55], v[64:67], 0
    v_mfma_f32_16x16x32_bf16 v[100:103], v[152:155], a[212:215], v[100:103]
    v_mfma_f32_16x16x32_bf16 v[76:79], v[56:59], v[64:67], 0
    v_mfma_f32_16x16x32_bf16 v[100:103], v[156:159], a[236:239], v[100:103]
    ds_read_u16_d16_hi v8, v93 offset:49152
    ds_read_u16_d16_hi v9, v94 offset:49152
    v_mfma_f32_16x16x32_bf16 v[100:103], v[160:163], v[180:183], v[100:103]
    ds_read_u16_d16_hi v10, v92 offset:49152
    v_mfma_f32_16x16x32_bf16 v[100:103], v[164:167], v[204:207], v[100:103]
    v_mfma_f32_16x16x32_bf16 v[100:103], v[168:171], v[228:231], v[100:103]
    v_mfma_f32_16x16x32_bf16 v[100:103], v[172:175], v[252:255], v[100:103]
    v_mfma_f32_16x16x32_bf16 v[104:107], a[0:3], v[120:123], 0
    v_cndmask_b32 v26, v72, v73, s[76:77]
    v_cndmask_b32 v27, v74, v75, s[76:77]
    v_mfma_f32_16x16x32_bf16 v[104:107], a[24:27], v[124:127], v[104:107]
    v_cndmask_b32 v28, v76, v77, s[76:77]
    v_cndmask_b32 v29, v78, v79, s[76:77]
    v_mfma_f32_16x16x32_bf16 v[104:107], a[48:51], v[128:131], v[104:107]
    v_cndmask_b32 v26, v26, v28, s[78:79]
    v_cndmask_b32 v27, v27, v29, s[80:81]
    v_mfma_f32_16x16x32_bf16 v[104:107], a[72:75], v[132:135], v[104:107]
    s_waitcnt lgkmcnt(0)
    v_mul_f32 v26, v26, v8
    v_mfma_f32_16x16x32_bf16 v[104:107], a[96:99], v[136:139], v[104:107]
    v_mul_f32 v27, v27, v9
    v_mul_f32 v11, s91, v10
    v_mfma_f32_16x16x32_bf16 v[104:107], a[120:123], v[140:143], v[104:107]
    v_max_f32 v28, v26, v27
    v_mov_b32 v29, v28
    v_mfma_f32_16x16x32_bf16 v[104:107], a[144:147], v[144:147], v[104:107]
    v_cvt_pk_bf16_f32 v44, v100, v101
    v_cvt_pk_bf16_f32 v45, v102, v103
    v_mfma_f32_16x16x32_bf16 v[104:107], a[168:171], v[148:151], v[104:107]
    v_permlane16_swap_b32 v28, v29
    v_max_f32 v28, v28, v29
    v_mfma_f32_16x16x32_bf16 v[104:107], a[192:195], v[152:155], v[104:107]
    v_mov_b32 v29, v28
    v_mfma_f32_16x16x32_bf16 v[104:107], a[216:219], v[156:159], v[104:107]
    v_mfma_f32_16x16x32_bf16 v[104:107], a[240:243], v[160:163], v[104:107]
    v_permlane32_swap_b32 v28, v29
    v_max_f32 v28, v28, v29
    v_mfma_f32_16x16x32_bf16 v[104:107], v[184:187], v[164:167], v[104:107]
    v_sub_f32 v26, v26, v28
    v_sub_f32 v27, v27, v28
    v_mfma_f32_16x16x32_bf16 v[104:107], v[208:211], v[168:171], v[104:107]
    v_mul_f32 v26, v11, v26
    v_mul_f32 v27, v11, v27
    v_mfma_f32_16x16x32_bf16 v[104:107], v[232:235], v[172:175], v[104:107]
    v_exp_f32 v26, v26
    v_mfma_f32_16x16x32_bf16 v[108:111], a[4:7], v[120:123], 0
    ds_read_b64_tr_b16 v[120:121], v4 offset:32768
    ds_read_b64_tr_b16 v[122:123], v25 offset:32768
    v_mfma_f32_16x16x32_bf16 v[108:111], a[28:31], v[124:127], v[108:111]
    ds_read_b64_tr_b16 v[124:125], v4 offset:33792
    v_exp_f32 v27, v27
    v_mfma_f32_16x16x32_bf16 v[108:111], a[52:55], v[128:131], v[108:111]
    ds_read_b64_tr_b16 v[126:127], v25 offset:33792
    ds_read_b64_tr_b16 v[128:129], v4 offset:34816
    v_mfma_f32_16x16x32_bf16 v[108:111], a[76:79], v[132:135], v[108:111]
    ds_read_b64_tr_b16 v[130:131], v25 offset:34816
    v_add_f32 v28, v26, v27
    v_mfma_f32_16x16x32_bf16 v[108:111], a[100:103], v[136:139], v[108:111]
    ds_read_b64_tr_b16 v[132:133], v4 offset:35840
    v_mov_b32 v29, v28
    v_mfma_f32_16x16x32_bf16 v[108:111], a[124:127], v[140:143], v[108:111]
    ds_read_b64_tr_b16 v[134:135], v25 offset:35840
    ds_read_b64_tr_b16 v[136:137], v4 offset:36864
    v_mfma_f32_16x16x32_bf16 v[108:111], a[148:151], v[144:147], v[108:111]
    ds_read_b64_tr_b16 v[138:139], v25 offset:36864
    v_cvt_pk_bf16_f32 v68, v104, v105
    v_mfma_f32_16x16x32_bf16 v[108:111], a[172:175], v[148:151], v[108:111]
    ds_read_b64_tr_b16 v[140:141], v4 offset:37888
    ds_read_b64_tr_b16 v[142:143], v25 offset:37888
    v_mfma_f32_16x16x32_bf16 v[108:111], a[196:199], v[152:155], v[108:111]
    ds_read_b64_tr_b16 v[144:145], v4 offset:38912
    v_cvt_pk_bf16_f32 v69, v106, v107
    v_mfma_f32_16x16x32_bf16 v[108:111], a[220:223], v[156:159], v[108:111]
    ds_read_b64_tr_b16 v[146:147], v25 offset:38912
    v_permlane16_swap_b32 v28, v29
    v_mfma_f32_16x16x32_bf16 v[108:111], a[244:247], v[160:163], v[108:111]
    ds_read_b64_tr_b16 v[148:149], v4 offset:39936
    ds_read_b64_tr_b16 v[150:151], v25 offset:39936
    v_mfma_f32_16x16x32_bf16 v[108:111], v[188:191], v[164:167], v[108:111]
    ds_read_b64_tr_b16 v[152:153], v4 offset:40960
    v_add_f32 v28, v28, v29
    v_mfma_f32_16x16x32_bf16 v[108:111], v[212:215], v[168:171], v[108:111]
    ds_read_b64_tr_b16 v[154:155], v25 offset:40960
    ds_read_b64_tr_b16 v[156:157], v4 offset:41984
    v_mfma_f32_16x16x32_bf16 v[108:111], v[236:239], v[172:175], v[108:111]
    ds_read_b64_tr_b16 v[158:159], v25 offset:41984
    v_mov_b32 v29, v28
    s_waitcnt lgkmcnt(15)
    v_mfma_f32_16x16x32_bf16 v[112:115], a[8:11], v[120:123], 0
    ds_read_b64_tr_b16 v[160:161], v4 offset:43008
    v_mfma_f32_16x16x32_bf16 v[112:115], a[32:35], v[124:127], v[112:115]
    ds_read_b64_tr_b16 v[162:163], v25 offset:43008
    ds_read_b64_tr_b16 v[164:165], v4 offset:44032
    s_waitcnt lgkmcnt(15)
    v_mfma_f32_16x16x32_bf16 v[112:115], a[56:59], v[128:131], v[112:115]
    ds_read_b64_tr_b16 v[166:167], v25 offset:44032
    v_permlane32_swap_b32 v28, v29
    v_mfma_f32_16x16x32_bf16 v[112:115], a[80:83], v[132:135], v[112:115]
    ds_read_b64_tr_b16 v[168:169], v4 offset:45056
    v_add_f32 v28, v28, v29
    s_waitcnt lgkmcnt(13)
    v_mfma_f32_16x16x32_bf16 v[112:115], a[104:107], v[136:139], v[112:115]
    ds_read_b64_tr_b16 v[170:171], v25 offset:45056
    ds_read_b64_tr_b16 v[172:173], v4 offset:46080
    v_mfma_f32_16x16x32_bf16 v[112:115], a[128:131], v[140:143], v[112:115]
    ds_read_b64_tr_b16 v[174:175], v25 offset:46080
    v_rcp_f32 v28, v28
    s_waitcnt lgkmcnt(12)
    v_mfma_f32_16x16x32_bf16 v[112:115], a[152:155], v[144:147], v[112:115]
    v_cvt_pk_bf16_f32 v70, v108, v109
    v_cvt_pk_bf16_f32 v71, v110, v111
    v_mfma_f32_16x16x32_bf16 v[112:115], a[176:179], v[148:151], v[112:115]
    v_cndmask_b32 v70, v70, 0, s[82:83]
    v_cndmask_b32 v71, v71, 0, s[82:83]
    s_waitcnt lgkmcnt(8)
    v_mfma_f32_16x16x32_bf16 v[112:115], a[200:203], v[152:155], v[112:115]
    v_mul_f32 v26, v26, v8
    v_mul_f32 v27, v27, v9
    v_mfma_f32_16x16x32_bf16 v[112:115], a[224:227], v[156:159], v[112:115]
    v_mul_f32 v26, v26, v28
    v_mul_f32 v27, v27, v28
    s_waitcnt lgkmcnt(4)
    v_mfma_f32_16x16x32_bf16 v[112:115], a[248:251], v[160:163], v[112:115]
    v_cvt_pk_bf16_f32 v26, v26, v26
    v_cvt_pk_bf16_f32 v27, v27, v27
    v_mfma_f32_16x16x32_bf16 v[112:115], v[192:195], v[164:167], v[112:115]
    v_and_b32 v80, v26, v14
    v_and_b32 v81, v27, v15
    s_waitcnt lgkmcnt(0)
    v_mfma_f32_16x16x32_bf16 v[112:115], v[216:219], v[168:171], v[112:115]
    v_and_b32 v82, v26, v16
    v_and_b32 v83, v27, v17
    v_mfma_f32_16x16x32_bf16 v[112:115], v[240:243], v[172:175], v[112:115]
    v_mfma_f32_16x16x32_bf16 v[116:119], a[12:15], v[120:123], 0
    v_mfma_f32_16x16x32_bf16 v[72:75], v[38:41], v[80:83], 0
    v_mfma_f32_16x16x32_bf16 v[116:119], a[36:39], v[124:127], v[116:119]
    v_mfma_f32_16x16x32_bf16 v[76:79], v[48:51], v[80:83], 0
    v_mfma_f32_16x16x32_bf16 v[116:119], a[60:63], v[128:131], v[116:119]
    s_add_u32 s53, s74, 49152
    v_mfma_f32_16x16x32_bf16 v[116:119], a[84:87], v[132:135], v[116:119]
    v_mfma_f32_16x16x32_bf16 v[116:119], a[108:111], v[136:139], v[116:119]
    v_mfma_f32_16x16x32_bf16 v[116:119], a[132:135], v[140:143], v[116:119]
    v_mfma_f32_16x16x32_bf16 v[116:119], a[156:159], v[144:147], v[116:119]
    v_cvt_pk_bf16_f32 v52, v112, v113
    v_cvt_pk_bf16_f32 v53, v114, v115
    v_mfma_f32_16x16x32_bf16 v[116:119], a[180:183], v[148:151], v[116:119]
    v_cvt_pk_bf16_f32 v84, v72, v73
    v_cvt_pk_bf16_f32 v85, v74, v75
    v_mfma_f32_16x16x32_bf16 v[116:119], a[204:207], v[152:155], v[116:119]
    v_cvt_pk_bf16_f32 v86, v76, v77
    v_cvt_pk_bf16_f32 v87, v78, v79
    v_mfma_f32_16x16x32_bf16 v[116:119], a[228:231], v[156:159], v[116:119]
    buffer_store_dwordx4 v[84:87], v23, s[24:27], s53 offen sc1
    v_mfma_f32_16x16x32_bf16 v[116:119], a[252:255], v[160:163], v[116:119]
    v_cndmask_b32 v80, v84, v86, s[88:89]
    v_cndmask_b32 v81, v85, v87, s[88:89]
    v_mfma_f32_16x16x32_bf16 v[116:119], v[196:199], v[164:167], v[116:119]
    ds_write_b64 v95, v[80:81] offset:768
    v_add_u32 v92, 65536, v92
    v_mfma_f32_16x16x32_bf16 v[116:119], v[220:223], v[168:171], v[116:119]
    v_add_u32 v93, 65536, v93
    v_add_u32 v94, 65536, v94
    v_mfma_f32_16x16x32_bf16 v[116:119], v[244:247], v[172:175], v[116:119]
    v_mfma_f32_16x16x32_bf16 v[72:75], v[56:59], v[68:71], 0
    v_mfma_f32_16x16x32_bf16 v[96:99], v[120:123], a[16:19], 0
    v_mfma_f32_16x16x32_bf16 v[76:79], v[60:63], v[68:71], 0
    v_mfma_f32_16x16x32_bf16 v[96:99], v[124:127], a[40:43], v[96:99]
    ds_read_u16_d16_hi v8, v93 offset:0
    ds_read_u16_d16_hi v9, v94 offset:0
    v_mfma_f32_16x16x32_bf16 v[96:99], v[128:131], a[64:67], v[96:99]
L_wa_3:
    s_cbranch_execz L_wa_ret
    ds_read_u16_d16_hi v10, v92 offset:0
    v_mfma_f32_16x16x32_bf16 v[96:99], v[132:135], a[88:91], v[96:99]
    v_mfma_f32_16x16x32_bf16 v[96:99], v[136:139], a[112:115], v[96:99]
    v_mfma_f32_16x16x32_bf16 v[96:99], v[140:143], a[136:139], v[96:99]
    v_mfma_f32_16x16x32_bf16 v[96:99], v[144:147], a[160:163], v[96:99]
    v_cvt_pk_bf16_f32 v54, v116, v117
    v_cvt_pk_bf16_f32 v55, v118, v119
    v_mfma_f32_16x16x32_bf16 v[96:99], v[148:151], a[184:187], v[96:99]
    v_cndmask_b32 v54, v54, 0, s[82:83]
    v_cndmask_b32 v55, v55, 0, s[82:83]
    v_mfma_f32_16x16x32_bf16 v[96:99], v[152:155], a[208:211], v[96:99]
    v_cndmask_b32 v26, v72, v73, s[76:77]
    v_cndmask_b32 v27, v74, v75, s[76:77]
    v_mfma_f32_16x16x32_bf16 v[96:99], v[156:159], a[232:235], v[96:99]
    v_cndmask_b32 v28, v76, v77, s[76:77]
    v_cndmask_b32 v29, v78, v79, s[76:77]
    v_mfma_f32_16x16x32_bf16 v[96:99], v[160:163], v[176:179], v[96:99]
    v_cndmask_b32 v26, v26, v28, s[78:79]
    v_cndmask_b32 v27, v27, v29, s[80:81]
    v_mfma_f32_16x16x32_bf16 v[96:99], v[164:167], v[200:203], v[96:99]
    s_waitcnt lgkmcnt(0)
    v_mul_f32 v26, v26, v8
    v_mfma_f32_16x16x32_bf16 v[96:99], v[168:171], v[224:227], v[96:99]
    v_mul_f32 v27, v27, v9
    v_mul_f32 v11, s91, v10
    v_mfma_f32_16x16x32_bf16 v[96:99], v[172:175], v[248:251], v[96:99]
    v_max_f32 v28, v26, v27
    v_mov_b32 v29, v28
    v_mfma_f32_16x16x32_bf16 v[100:103], v[120:123], a[20:23], 0
    v_mfma_f32_16x16x32_bf16 v[100:103], v[124:127], a[44:47], v[100:103]
    v_permlane16_swap_b32 v28, v29
    v_max_f32 v28, v28, v29
    v_mfma_f32_16x16x32_bf16 v[100:103], v[128:131], a[68:71], v[100:103]
    v_mov_b32 v29, v28
    v_mfma_f32_16x16x32_bf16 v[100:103], v[132:135], a[92:95], v[100:103]
    v_mfma_f32_16x16x32_bf16 v[100:103], v[136:139], a[116:119], v[100:103]
    v_permlane32_swap_b32 v28, v29
    v_max_f32 v28, v28, v29
    v_mfma_f32_16x16x32_bf16 v[100:103], v[140:143], a[140:143], v[100:103]
    v_sub_f32 v26, v26, v28
    v_sub_f32 v27, v27, v28
    v_mfma_f32_16x16x32_bf16 v[100:103], v[144:147], a[164:167], v[100:103]
    v_cvt_pk_bf16_f32 v36, v96, v97
    v_cvt_pk_bf16_f32 v37, v98, v99
    v_mfma_f32_16x16x32_bf16 v[100:103], v[148:151], a[188:191], v[100:103]
    v_mul_f32 v26, v11, v26
    v_mul_f32 v27, v11, v27
    v_mfma_f32_16x16x32_bf16 v[100:103], v[152:155], a[212:215], v[100:103]
    v_exp_f32 v26, v26
    v_mfma_f32_16x16x32_bf16 v[100:103], v[156:159], a[236:239], v[100:103]
    v_exp_f32 v27, v27
    v_mfma_f32_16x16x32_bf16 v[100:103], v[160:163], v[180:183], v[100:103]
    v_add_f32 v28, v26, v27
    v_mov_b32 v29, v28
    v_mfma_f32_16x16x32_bf16 v[100:103], v[164:167], v[204:207], v[100:103]
    v_mfma_f32_16x16x32_bf16 v[100:103], v[168:171], v[228:231], v[100:103]
    v_permlane16_swap_b32 v28, v29
    v_add_f32 v28, v28, v29
    v_mfma_f32_16x16x32_bf16 v[100:103], v[172:175], v[252:255], v[100:103]
    v_mov_b32 v29, v28
    v_mfma_f32_16x16x32_bf16 v[104:107], a[0:3], v[120:123], 0
    v_mfma_f32_16x16x32_bf16 v[104:107], a[24:27], v[124:127], v[104:107]
    v_permlane32_swap_b32 v28, v29
    v_add_f32 v28, v28, v29
    v_mfma_f32_16x16x32_bf16 v[104:107], a[48:51], v[128:131], v[104:107]
    v_rcp_f32 v28, v28
    v_mfma_f32_16x16x32_bf16 v[104:107], a[72:75], v[132:135], v[104:107]
    v_mul_f32 v26, v26, v8
    v_mul_f32 v27, v27, v9
    v_mfma_f32_16x16x32_bf16 v[104:107], a[96:99], v[136:139], v[104:107]
    v_mul_f32 v26, v26, v28
    v_mul_f32 v27, v27, v28
    v_mfma_f32_16x16x32_bf16 v[104:107], a[120:123], v[140:143], v[104:107]
    v_cvt_pk_bf16_f32 v26, v26, v26
    v_cvt_pk_bf16_f32 v27, v27, v27
    v_mfma_f32_16x16x32_bf16 v[104:107], a[144:147], v[144:147], v[104:107]
    v_cvt_pk_bf16_f32 v46, v100, v101
    v_cvt_pk_bf16_f32 v47, v102, v103
    v_mfma_f32_16x16x32_bf16 v[104:107], a[168:171], v[148:151], v[104:107]
    v_and_b32 v80, v26, v14
    v_and_b32 v81, v27, v15
    v_mfma_f32_16x16x32_bf16 v[104:107], a[192:195], v[152:155], v[104:107]
    v_and_b32 v82, v26, v16
    v_and_b32 v83, v27, v17
    v_mfma_f32_16x16x32_bf16 v[104:107], a[216:219], v[156:159], v[104:107]
    v_mfma_f32_16x16x32_bf16 v[104:107], a[240:243], v[160:163], v[104:107]
    v_mfma_f32_16x16x32_bf16 v[72:75], v[32:35], v[80:83], 0
    v_mfma_f32_16x16x32_bf16 v[104:107], v[184:187], v[164:167], v[104:107]
    v_mfma_f32_16x16x32_bf16 v[76:79], v[42:45], v[80:83], 0
    v_mfma_f32_16x16x32_bf16 v[104:107], v[208:211], v[168:171], v[104:107]
    s_add_u32 s53, s74, 65536
    v_mfma_f32_16x16x32_bf16 v[104:107], v[232:235], v[172:175], v[104:107]
    s_waitcnt vmcnt(8)
    s_barrier
    v_mfma_f32_16x16x32_bf16 v[108:111], a[4:7], v[120:123], 0
    ds_read_b64_tr_b16 v[120:121], v4 offset:49152
    ds_read_b64_tr_b16 v[122:123], v25 offset:49152
    v_mfma_f32_16x16x32_bf16 v[108:111], a[28:31], v[124:127], v[108:111]
    ds_read_b64_tr_b16 v[124:125], v4 offset:50176
    v_mfma_f32_16x16x32_bf16 v[108:111], a[52:55], v[128:131], v[108:111]
    ds_read_b64_tr_b16 v[126:127], v25 offset:50176
    ds_read_b64_tr_b16 v[128:129], v4 offset:51200
    v_mfma_f32_16x16x32_bf16 v[108:111], a[76:79], v[132:135], v[108:111]
    ds_read_b64_tr_b16 v[130:131], v25 offset:51200
    v_cvt_pk_bf16_f32 v84, v72, v73
    v_mfma_f32_16x16x32_bf16 v[108:111], a[100:103], v[136:139], v[108:111]
    ds_read_b64_tr_b16 v[132:133], v4 offset:52224
    v_cvt_pk_bf16_f32 v85, v74, v75
    v_mfma_f32_16x16x32_bf16 v[108:111], a[124:127], v[140:143], v[108:111]
    ds_read_b64_tr_b16 v[134:135], v25 offset:52224
    ds_read_b64_tr_b16 v[136:137], v4 offset:53248
    v_mfma_f32_16x16x32_bf16 v[108:111], a[148:151], v[144:147], v[108:111]
    ds_read_b64_tr_b16 v[138:139], v25 offset:53248
    v_cvt_pk_bf16_f32 v64, v104, v105
    v_mfma_f32_16x16x32_bf16 v[108:111], a[172:175], v[148:151], v[108:111]
    ds_read_b64_tr_b16 v[140:141], v4 offset:54272
    ds_read_b64_tr_b16 v[142:143], v25 offset:54272
    v_mfma_f32_16x16x32_bf16 v[108:111], a[196:199], v[152:155], v[108:111]
    ds_read_b64_tr_b16 v[144:145], v4 offset:55296
    v_cvt_pk_bf16_f32 v65, v106, v107
    v_mfma_f32_16x16x32_bf16 v[108:111], a[220:223], v[156:159], v[108:111]
    ds_read_b64_tr_b16 v[146:147], v25 offset:55296
    v_cvt_pk_bf16_f32 v86, v76, v77
    v_mfma_f32_16x16x32_bf16 v[108:111], a[244:247], v[160:163], v[108:111]
    ds_read_b64_tr_b16 v[148:149], v4 offset:56320
    ds_read_b64_tr_b16 v[150:151], v25 offset:56320
    v_mfma_f32_16x16x32_bf16 v[108:111], v[188:191], v[164:167], v[108:111]
    ds_read_b64_tr_b16 v[152:153], v4 offset:57344
    v_cvt_pk_bf16_f32 v87, v78, v79
    v_mfma_f32_16x16x32_bf16 v[108:111], v[212:215], v[168:171], v[108:111]
    ds_read_b64_tr_b16 v[154:155], v25 offset:57344
    ds_read_b64_tr_b16 v[156:157], v4 offset:58368
    v_mfma_f32_16x16x32_bf16 v[108:111], v[236:239], v[172:175], v[108:111]
    ds_read_b64_tr_b16 v[158:159], v25 offset:58368
    buffer_store_dwordx4 v[84:87], v23, s[24:27], s53 offen sc1
    s_waitcnt lgkmcnt(15)
    v_mfma_f32_16x16x32_bf16 v[112:115], a[8:11], v[120:123], 0
    ds_read_b64_tr_b16 v[160:161], v4 offset:59392
    v_cndmask_b32 v80, v84, v86, s[88:89]
    v_mfma_f32_16x16x32_bf16 v[112:115], a[32:35], v[124:127], v[112:115]
    ds_read_b64_tr_b16 v[162:163], v25 offset:59392
    ds_read_b64_tr_b16 v[164:165], v4 offset:60416
    s_waitcnt lgkmcnt(15)
    v_mfma_f32_16x16x32_bf16 v[112:115], a[56:59], v[128:131], v[112:115]
    ds_read_b64_tr_b16 v[166:167], v25 offset:60416
    v_cndmask_b32 v81, v85, v87, s[88:89]
    v_mfma_f32_16x16x32_bf16 v[112:115], a[80:83], v[132:135], v[112:115]
    ds_read_b64_tr_b16 v[168:169], v4 offset:61440
    ds_write_b64 v95, v[80:81] offset:1024
    s_waitcnt lgkmcnt(14)
    v_mfma_f32_16x16x32_bf16 v[112:115], a[104:107], v[136:139], v[112:115]
    ds_read_b64_tr_b16 v[170:171], v25 offset:61440
    ds_read_b64_tr_b16 v[172:173], v4 offset:62464
    v_mfma_f32_16x16x32_bf16 v[112:115], a[128:131], v[140:143], v[112:115]
    ds_read_b64_tr_b16 v[174:175], v25 offset:62464
    s_waitcnt lgkmcnt(13)
    v_mfma_f32_16x16x32_bf16 v[112:115], a[152:155], v[144:147], v[112:115]
    v_cvt_pk_bf16_f32 v66, v108, v109
    v_cvt_pk_bf16_f32 v67, v110, v111
    v_mfma_f32_16x16x32_bf16 v[112:115], a[176:179], v[148:151], v[112:115]
    v_cndmask_b32 v66, v66, 0, s[82:83]
    v_cndmask_b32 v67, v67, 0, s[82:83]
    s_waitcnt lgkmcnt(9)
    v_mfma_f32_16x16x32_bf16 v[112:115], a[200:203], v[152:155], v[112:115]
    v_mfma_f32_16x16x32_bf16 v[112:115], a[224:227], v[156:159], v[112:115]
    v_mfma_f32_16x16x32_bf16 v[72:75], v[60:63], v[64:67], 0
    s_waitcnt lgkmcnt(5)
    v_mfma_f32_16x16x32_bf16 v[112:115], a[248:251], v[160:163], v[112:115]
    v_mfma_f32_16x16x32_bf16 v[76:79], v[52:55], v[64:67], 0
    v_mfma_f32_16x16x32_bf16 v[112:115], v[192:195], v[164:167], v[112:115]
    ds_read_u16_d16_hi v8, v93 offset:16384
    ds_read_u16_d16_hi v9, v94 offset:16384
    s_waitcnt lgkmcnt(2)
    v_mfma_f32_16x16x32_bf16 v[112:115], v[216:219], v[168:171], v[112:115]
    ds_read_u16_d16_hi v10, v92 offset:16384
    v_mfma_f32_16x16x32_bf16 v[112:115], v[240:243], v[172:175], v[112:115]
    v_mfma_f32_16x16x32_bf16 v[116:119], a[12:15], v[120:123], 0
    v_mfma_f32_16x16x32_bf16 v[116:119], a[36:39], v[124:127], v[116:119]
    v_mfma_f32_16x16x32_bf16 v[116:119], a[60:63], v[128:131], v[116:119]
    v_cndmask_b32 v26, v72, v73, s[76:77]
    v_cndmask_b32 v27, v74, v75, s[76:77]
    v_mfma_f32_16x16x32_bf16 v[116:119], a[84:87], v[132:135], v[116:119]
    v_cndmask_b32 v28, v76, v77, s[76:77]
    v_cndmask_b32 v29, v78, v79, s[76:77]
    v_mfma_f32_16x16x32_bf16 v[116:119], a[108:111], v[136:139], v[116:119]
    v_cndmask_b32 v26, v26, v28, s[78:79]
    v_cndmask_b32 v27, v27, v29, s[80:81]
    v_mfma_f32_16x16x32_bf16 v[116:119], a[132:135], v[140:143], v[116:119]
    s_waitcnt lgkmcnt(0)
    v_mul_f32 v26, v26, v8
    v_mfma_f32_16x16x32_bf16 v[116:119], a[156:159], v[144:147], v[116:119]
    v_cvt_pk_bf16_f32 v56, v112, v113
    v_cvt_pk_bf16_f32 v57, v114, v115
    v_mfma_f32_16x16x32_bf16 v[116:119], a[180:183], v[148:151], v[116:119]
    v_mul_f32 v27, v27, v9
    v_mul_f32 v11, s91, v10
    v_mfma_f32_16x16x32_bf16 v[116:119], a[204:207], v[152:155], v[116:119]
    v_max_f32 v28, v26, v27
    v_mov_b32 v29, v28
    v_mfma_f32_16x16x32_bf16 v[116:119], a[228:231], v[156:159], v[116:119]
    v_mfma_f32_16x16x32_bf16 v[116:119], a[252:255], v[160:163], v[116:119]
    v_permlane16_swap_b32 v28, v29
    v_max_f32 v28, v28, v29
    v_mfma_f32_16x16x32_bf16 v[116:119], v[196:199], v[164:167], v[116:119]
    v_mov_b32 v29, v28
    v_mfma_f32_16x16x32_bf16 v[116:119], v[220:223], v[168:171], v[116:119]
    v_mfma_f32_16x16x32_bf16 v[116:119], v[244:247], v[172:175], v[116:119]
    v_permlane32_swap_b32 v28, v29
    v_max_f32 v28, v28, v29
    v_mfma_f32_16x16x32_bf16 v[96:99], v[120:123], a[16:19], 0
    v_sub_f32 v26, v26, v28
    v_sub_f32 v27, v27, v28
    v_mfma_f32_16x16x32_bf16 v[96:99], v[124:127], a[40:43], v[96:99]
    v_mul_f32 v26, v11, v26
    v_mul_f32 v27, v11, v27
    v_mfma_f32_16x16x32_bf16 v[96:99], v[128:131], a[64:67], v[96:99]
    v_exp_f32 v26, v26
    v_mfma_f32_16x16x32_bf16 v[96:99], v[132:135], a[88:91], v[96:99]
    v_exp_f32 v27, v27
    v_mfma_f32_16x16x32_bf16 v[96:99], v[136:139], a[112:115], v[96:99]
    v_add_f32 v28, v26, v27
    v_mov_b32 v29, v28
    v_mfma_f32_16x16x32_bf16 v[96:99], v[140:143], a[136:139], v[96:99]
    v_mfma_f32_16x16x32_bf16 v[96:99], v[144:147], a[160:163], v[96:99]
    v_cvt_pk_bf16_f32 v58, v116, v117
    v_cvt_pk_bf16_f32 v59, v118, v119
    v_mfma_f32_16x16x32_bf16 v[96:99], v[148:151], a[184:187], v[96:99]
    v_cndmask_b32 v58, v58, 0, s[82:83]
    v_cndmask_b32 v59, v59, 0, s[82:83]
    v_mfma_f32_16x16x32_bf16 v[96:99], v[152:155], a[208:211], v[96:99]
    v_permlane16_swap_b32 v28, v29
    v_add_f32 v28, v28, v29
    v_mfma_f32_16x16x32_bf16 v[96:99], v[156:159], a[232:235], v[96:99]
    v_mov_b32 v29, v28
    v_mfma_f32_16x16x32_bf16 v[96:99], v[160:163], v[176:179], v[96:99]
    v_mfma_f32_16x16x32_bf16 v[96:99], v[164:167], v[200:203], v[96:99]
    v_permlane32_swap_b32 v28, v29
    v_add_f32 v28, v28, v29
    v_mfma_f32_16x16x32_bf16 v[96:99], v[168:171], v[224:227], v[96:99]
    v_rcp_f32 v28, v28
    v_mfma_f32_16x16x32_bf16 v[96:99], v[172:175], v[248:251], v[96:99]
    v_mul_f32 v26, v26, v8
    v_mul_f32 v27, v27, v9
    v_mfma_f32_16x16x32_bf16 v[100:103], v[120:123], a[20:23], 0
    v_mul_f32 v26, v26, v28
    v_mul_f32 v27, v27, v28
    v_mfma_f32_16x16x32_bf16 v[100:103], v[124:127], a[44:47], v[100:103]
    v_cvt_pk_bf16_f32 v26, v26, v26
    v_cvt_pk_bf16_f32 v27, v27, v27
    v_mfma_f32_16x16x32_bf16 v[100:103], v[128:131], a[68:71], v[100:103]
    v_and_b32 v80, v26, v14
    v_and_b32 v81, v27, v15
    v_mfma_f32_16x16x32_bf16 v[100:103], v[132:135], a[92:95], v[100:103]
    v_and_b32 v82, v26, v16
    v_and_b32 v83, v27, v17
    v_mfma_f32_16x16x32_bf16 v[100:103], v[136:139], a[116:119], v[100:103]
    v_mfma_f32_16x16x32_bf16 v[100:103], v[140:143], a[140:143], v[100:103]
    v_mfma_f32_16x16x32_bf16 v[72:75], v[34:37], v[80:83], 0
    v_mfma_f32_16x16x32_bf16 v[100:103], v[144:147], a[164:167], v[100:103]
    v_cvt_pk_bf16_f32 v38, v96, v97
    v_cvt_pk_bf16_f32 v39, v98, v99
    v_mfma_f32_16x16x32_bf16 v[100:103], v[148:151], a[188:191], v[100:103]
    v_mfma_f32_16x16x32_bf16 v[76:79], v[44:47], v[80:83], 0
    v_mfma_f32_16x16x32_bf16 v[100:103], v[152:155], a[212:215], v[100:103]
    s_add_u32 s53, s74, 81920
    v_mfma_f32_16x16x32_bf16 v[100:103], v[156:159], a[236:239], v[100:103]
    v_mfma_f32_16x16x32_bf16 v[100:103], v[160:163], v[180:183], v[100:103]
    v_mfma_f32_16x16x32_bf16 v[100:103], v[164:167], v[204:207], v[100:103]
    v_mfma_f32_16x16x32_bf16 v[100:103], v[168:171], v[228:231], v[100:103]
    v_mfma_f32_16x16x32_bf16 v[100:103], v[172:175], v[252:255], v[100:103]
    v_cvt_pk_bf16_f32 v84, v72, v73
    v_cvt_pk_bf16_f32 v85, v74, v75
    v_mfma_f32_16x16x32_bf16 v[104:107], a[0:3], v[120:123], 0
    v_cvt_pk_bf16_f32 v86, v76, v77
    v_cvt_pk_bf16_f32 v87, v78, v79
    v_mfma_f32_16x16x32_bf16 v[104:107], a[24:27], v[124:127], v[104:107]
    buffer_store_dwordx4 v[84:87], v23, s[24:27], s53 offen sc1
    v_mfma_f32_16x16x32_bf16 v[104:107], a[48:51], v[128:131], v[104:107]
    v_cndmask_b32 v80, v84, v86, s[88:89]
    v_cndmask_b32 v81, v85, v87, s[88:89]
    v_mfma_f32_16x16x32_bf16 v[104:107], a[72:75], v[132:135], v[104:107]
    ds_write_b64 v95, v[80:81] offset:1280
    v_mfma_f32_16x16x32_bf16 v[104:107], a[96:99], v[136:139], v[104:107]
    v_mfma_f32_16x16x32_bf16 v[104:107], a[120:123], v[140:143], v[104:107]
    v_mfma_f32_16x16x32_bf16 v[104:107], a[144:147], v[144:147], v[104:107]
    v_cvt_pk_bf16_f32 v48, v100, v101
    v_cvt_pk_bf16_f32 v49, v102, v103
    v_mfma_f32_16x16x32_bf16 v[104:107], a[168:171], v[148:151], v[104:107]
    v_mfma_f32_16x16x32_bf16 v[104:107], a[192:195], v[152:155], v[104:107]
    v_mfma_f32_16x16x32_bf16 v[104:107], a[216:219], v[156:159], v[104:107]
    v_mfma_f32_16x16x32_bf16 v[104:107], a[240:243], v[160:163], v[104:107]
    v_mfma_f32_16x16x32_bf16 v[104:107], v[184:187], v[164:167], v[104:107]
    v_mfma_f32_16x16x32_bf16 v[104:107], v[208:211], v[168:171], v[104:107]
    v_mfma_f32_16x16x32_bf16 v[104:107], v[232:235], v[172:175], v[104:107]
    v_mfma_f32_16x16x32_bf16 v[108:111], a[4:7], v[120:123], 0
    v_add_u32 v4, 65536, v4
    v_add_u32 v25, 65536, v25
    ds_read_b64_tr_b16 v[120:121], v4 offset:0
    ds_read_b64_tr_b16 v[122:123], v25 offset:0
    v_mfma_f32_16x16x32_bf16 v[108:111], a[28:31], v[124:127], v[108:111]
    ds_read_b64_tr_b16 v[124:125], v4 offset:1024
    v_mfma_f32_16x16x32_bf16 v[108:111], a[52:55], v[128:131], v[108:111]
    ds_read_b64_tr_b16 v[126:127], v25 offset:1024
    ds_read_b64_tr_b16 v[128:129], v4 offset:2048
    v_mfma_f32_16x16x32_bf16 v[108:111], a[76:79], v[132:135], v[108:111]
    ds_read_b64_tr_b16 v[130:131], v25 offset:2048
    v_mfma_f32_16x16x32_bf16 v[108:111], a[100:103], v[136:139], v[108:111]
    ds_read_b64_tr_b16 v[132:133], v4 offset:3072
    v_mfma_f32_16x16x32_bf16 v[108:111], a[124:127], v[140:143], v[108:111]
    ds_read_b64_tr_b16 v[134:135], v25 offset:3072
    ds_read_b64_tr_b16 v[136:137], v4 offset:4096
    v_mfma_f32_16x16x32_bf16 v[108:111], a[148:151], v[144:147], v[108:111]
    ds_read_b64_tr_b16 v[138:139], v25 offset:4096
    v_cvt_pk_bf16_f32 v68, v104, v105
    v_mfma_f32_16x16x32_bf16 v[108:111], a[172:175], v[148:151], v[108:111]
    ds_read_b64_tr_b16 v[140:141], v4 offset:5120
    ds_read_b64_tr_b16 v[142:143], v25 offset:5120
    v_mfma_f32_16x16x32_bf16 v[108:111], a[196:199], v[152:155], v[108:111]
    ds_read_b64_tr_b16 v[144:145], v4 offset:6144
    v_cvt_pk_bf16_f32 v69, v106, v107
    v_mfma_f32_16x16x32_bf16 v[108:111], a[220:223], v[156:159], v[108:111]
    ds_read_b64_tr_b16 v[146:147], v25 offset:6144
    v_mfma_f32_16x16x32_bf16 v[108:111], a[244:247], v[160:163], v[108:111]
    ds_read_b64_tr_b16 v[148:149], v4 offset:7168
    ds_read_b64_tr_b16 v[150:151], v25 offset:7168
    v_mfma_f32_16x16x32_bf16 v[108:111], v[188:191], v[164:167], v[108:111]
    ds_read_b64_tr_b16 v[152:153], v4 offset:8192
    v_mfma_f32_16x16x32_bf16 v[108:111], v[212:215], v[168:171], v[108:111]
    ds_read_b64_tr_b16 v[154:155], v25 offset:8192
    ds_read_b64_tr_b16 v[156:157], v4 offset:9216
    v_mfma_f32_16x16x32_bf16 v[108:111], v[236:239], v[172:175], v[108:111]
    ds_read_b64_tr_b16 v[158:159], v25 offset:9216
    s_waitcnt lgkmcnt(15)
    v_mfma_f32_16x16x32_bf16 v[112:115], a[0:3], v[120:123], 0
    ds_read_b64_tr_b16 v[160:161], v4 offset:10240
    v_mfma_f32_16x16x32_bf16 v[112:115], a[24:27], v[124:127], v[112:115]
    ds_read_b64_tr_b16 v[162:163], v25 offset:10240
    ds_read_b64_tr_b16 v[164:165], v4 offset:11264
    s_waitcnt lgkmcnt(15)
    v_mfma_f32_16x16x32_bf16 v[112:115], a[48:51], v[128:131], v[112:115]
    ds_read_b64_tr_b16 v[166:167], v25 offset:11264
    v_mfma_f32_16x16x32_bf16 v[112:115], a[72:75], v[132:135], v[112:115]
    ds_read_b64_tr_b16 v[168:169], v4 offset:12288
    s_waitcnt lgkmcnt(13)
    v_mfma_f32_16x16x32_bf16 v[112:115], a[96:99], v[136:139], v[112:115]
    ds_read_b64_tr_b16 v[170:171], v25 offset:12288
    ds_read_b64_tr_b16 v[172:173], v4 offset:13312
    v_mfma_f32_16x16x32_bf16 v[112:115], a[120:123], v[140:143], v[112:115]
    ds_read_b64_tr_b16 v[174:175], v25 offset:13312
    s_waitcnt lgkmcnt(12)
    v_mfma_f32_16x16x32_bf16 v[112:115], a[144:147], v[144:147], v[112:115]
    v_cvt_pk_bf16_f32 v70, v108, v109
    v_cvt_pk_bf16_f32 v71, v110, v111
    v_mfma_f32_16x16x32_bf16 v[112:115], a[168:171], v[148:151], v[112:115]
    v_cndmask_b32 v70, v70, 0, s[82:83]
    v_cndmask_b32 v71, v71, 0, s[82:83]
    s_waitcnt lgkmcnt(8)
    v_mfma_f32_16x16x32_bf16 v[112:115], a[192:195], v[152:155], v[112:115]
    v_mfma_f32_16x16x32_bf16 v[112:115], a[216:219], v[156:159], v[112:115]
    v_mfma_f32_16x16x32_bf16 v[72:75], v[52:55], v[68:71], 0
    s_waitcnt lgkmcnt(4)
    v_mfma_f32_16x16x32_bf16 v[112:115], a[240:243], v[160:163], v[112:115]
    v_mfma_f32_16x16x32_bf16 v[76:79], v[56:59], v[68:71], 0
    v_mfma_f32_16x16x32_bf16 v[112:115], v[184:187], v[164:167], v[112:115]
    ds_read_u16_d16_hi v8, v93 offset:32768
    ds_read_u16_d16_hi v9, v94 offset:32768
    s_waitcnt lgkmcnt(2)
    v_mfma_f32_16x16x32_bf16 v[112:115], v[208:211], v[168:171], v[112:115]
    ds_read_u16_d16_hi v10, v92 offset:32768
    v_mfma_f32_16x16x32_bf16 v[112:115], v[232:235], v[172:175], v[112:115]
    v_mfma_f32_16x16x32_bf16 v[116:119], a[4:7], v[120:123], 0
    v_mfma_f32_16x16x32_bf16 v[116:119], a[28:31], v[124:127], v[116:119]
    v_mfma_f32_16x16x32_bf16 v[116:119], a[52:55], v[128:131], v[116:119]
    v_cndmask_b32 v26, v72, v73, s[76:77]
    v_cndmask_b32 v27, v74, v75, s[76:77]
    v_mfma_f32_16x16x32_bf16 v[116:119], a[76:79], v[132:135], v[116:119]
    v_cndmask_b32 v28, v76, v77, s[76:77]
    v_cndmask_b32 v29, v78, v79, s[76:77]
    v_mfma_f32_16x16x32_bf16 v[116:119], a[100:103], v[136:139], v[116:119]
    v_cndmask_b32 v26, v26, v28, s[78:79]
    v_cndmask_b32 v27, v27, v29, s[80:81]
    v_mfma_f32_16x16x32_bf16 v[116:119], a[124:127], v[140:143], v[116:119]
    s_waitcnt lgkmcnt(0)
    v_mul_f32 v26, v26, v8
    v_mfma_f32_16x16x32_bf16 v[116:119], a[148:151], v[144:147], v[116:119]
    v_cvt_pk_bf16_f32 v64, v112, v113
    v_cvt_pk_bf16_f32 v65, v114, v115
    v_mfma_f32_16x16x32_bf16 v[116:119], a[172:175], v[148:151], v[116:119]
    v_mul_f32 v27, v27, v9
    v_mul_f32 v11, s91, v10
    v_mfma_f32_16x16x32_bf16 v[116:119], a[196:199], v[152:155], v[116:119]
    v_max_f32 v28, v26, v27
    v_mov_b32 v29, v28
    v_mfma_f32_16x16x32_bf16 v[116:119], a[220:223], v[156:159], v[116:119]
    v_mfma_f32_16x16x32_bf16 v[116:119], a[244:247], v[160:163], v[116:119]
    v_permlane16_swap_b32 v28, v29
    v_max_f32 v28, v28, v29
    v_mfma_f32_16x16x32_bf16 v[116:119], v[188:191], v[164:167], v[116:119]
    v_mov_b32 v29, v28
    v_mfma_f32_16x16x32_bf16 v[116:119], v[212:215], v[168:171], v[116:119]
    v_mfma_f32_16x16x32_bf16 v[116:119], v[236:239], v[172:175], v[116:119]
    v_permlane32_swap_b32 v28, v29
    v_max_f32 v28, v28, v29
    v_mfma_f32_16x16x32_bf16 v[96:99], a[8:11], v[120:123], 0
    v_sub_f32 v26, v26, v28
    v_sub_f32 v27, v27, v28
    v_mfma_f32_16x16x32_bf16 v[96:99], a[32:35], v[124:127], v[96:99]
    v_mul_f32 v26, v11, v26
    v_mul_f32 v27, v11, v27
    v_mfma_f32_16x16x32_bf16 v[96:99], a[56:59], v[128:131], v[96:99]
    v_exp_f32 v26, v26
    v_mfma_f32_16x16x32_bf16 v[96:99], a[80:83], v[132:135], v[96:99]
    v_exp_f32 v27, v27
    v_mfma_f32_16x16x32_bf16 v[96:99], a[104:107], v[136:139], v[96:99]
    v_add_f32 v28, v26, v27
    v_mov_b32 v29, v28
    v_mfma_f32_16x16x32_bf16 v[96:99], a[128:131], v[140:143], v[96:99]
    v_mfma_f32_16x16x32_bf16 v[96:99], a[152:155], v[144:147], v[96:99]
    v_cvt_pk_bf16_f32 v66, v116, v117
    v_cvt_pk_bf16_f32 v67, v118, v119
    v_mfma_f32_16x16x32_bf16 v[96:99], a[176:179], v[148:151], v[96:99]
    v_cndmask_b32 v66, v66, 0, s[82:83]
    v_cndmask_b32 v67, v67, 0, s[82:83]
    v_mfma_f32_16x16x32_bf16 v[96:99], a[200:203], v[152:155], v[96:99]
    v_permlane16_swap_b32 v28, v29
    v_add_f32 v28, v28, v29
    v_mfma_f32_16x16x32_bf16 v[96:99], a[224:227], v[156:159], v[96:99]
    v_mov_b32 v29, v28
    v_mfma_f32_16x16x32_bf16 v[96:99], a[248:251], v[160:163], v[96:99]
    v_mfma_f32_16x16x32_bf16 v[96:99], v[192:195], v[164:167], v[96:99]
    v_permlane32_swap_b32 v28, v29
    v_add_f32 v28, v28, v29
    v_mfma_f32_16x16x32_bf16 v[96:99], v[216:219], v[168:171], v[96:99]
    v_rcp_f32 v28, v28
    v_mfma_f32_16x16x32_bf16 v[96:99], v[240:243], v[172:175], v[96:99]
    v_mul_f32 v26, v26, v8
    v_mul_f32 v27, v27, v9
    v_mfma_f32_16x16x32_bf16 v[100:103], a[12:15], v[120:123], 0
    v_mul_f32 v26, v26, v28
    v_mul_f32 v27, v27, v28
    v_mfma_f32_16x16x32_bf16 v[100:103], a[36:39], v[124:127], v[100:103]
    v_cvt_pk_bf16_f32 v26, v26, v26
    v_cvt_pk_bf16_f32 v27, v27, v27
    v_mfma_f32_16x16x32_bf16 v[100:103], a[60:63], v[128:131], v[100:103]
    v_and_b32 v80, v26, v14
    v_and_b32 v81, v27, v15
    v_mfma_f32_16x16x32_bf16 v[100:103], a[84:87], v[132:135], v[100:103]
    v_and_b32 v82, v26, v16
    v_and_b32 v83, v27, v17
    v_mfma_f32_16x16x32_bf16 v[100:103], a[108:111], v[136:139], v[100:103]
    v_mfma_f32_16x16x32_bf16 v[100:103], a[132:135], v[140:143], v[100:103]
    v_mfma_f32_16x16x32_bf16 v[72:75], v[36:39], v[80:83], 0
    v_mfma_f32_16x16x32_bf16 v[100:103], a[156:159], v[144:147], v[100:103]
    v_cvt_pk_bf16_f32 v60, v96, v97
    v_cvt_pk_bf16_f32 v61, v98, v99
    v_mfma_f32_16x16x32_bf16 v[100:103], a[180:183], v[148:151], v[100:103]
    v_mfma_f32_16x16x32_bf16 v[76:79], v[46:49], v[80:83], 0
    v_mfma_f32_16x16x32_bf16 v[100:103], a[204:207], v[152:155], v[100:103]
    s_add_u32 s53, s74, 98304
    v_mfma_f32_16x16x32_bf16 v[100:103], a[228:231], v[156:159], v[100:103]
    v_mfma_f32_16x16x32_bf16 v[100:103], a[252:255], v[160:163], v[100:103]
    v_mfma_f32_16x16x32_bf16 v[100:103], v[196:199], v[164:167], v[100:103]
    v_mfma_f32_16x16x32_bf16 v[100:103], v[220:223], v[168:171], v[100:103]
    v_mfma_f32_16x16x32_bf16 v[100:103], v[244:247], v[172:175], v[100:103]
    v_cvt_pk_bf16_f32 v84, v72, v73
    v_cvt_pk_bf16_f32 v85, v74, v75
    v_mfma_f32_16x16x32_bf16 v[104:107], v[120:123], a[16:19], 0
    v_cvt_pk_bf16_f32 v86, v76, v77
    v_cvt_pk_bf16_f32 v87, v78, v79
    v_mfma_f32_16x16x32_bf16 v[104:107], v[124:127], a[40:43], v[104:107]
    buffer_store_dwordx4 v[84:87], v23, s[24:27], s53 offen sc1
    v_mfma_f32_16x16x32_bf16 v[104:107], v[128:131], a[64:67], v[104:107]
    v_cndmask_b32 v80, v84, v86, s[88:89]
    v_cndmask_b32 v81, v85, v87, s[88:89]
    v_mfma_f32_16x16x32_bf16 v[104:107], v[132:135], a[88:91], v[104:107]
    ds_write_b64 v95, v[80:81] offset:1536
    v_mfma_f32_16x16x32_bf16 v[104:107], v[136:139], a[112:115], v[104:107]
    v_mfma_f32_16x16x32_bf16 v[104:107], v[140:143], a[136:139], v[104:107]
    v_mfma_f32_16x16x32_bf16 v[104:107], v[144:147], a[160:163], v[104:107]
    v_cvt_pk_bf16_f32 v62, v100, v101
    v_cvt_pk_bf16_f32 v63, v102, v103
    v_mfma_f32_16x16x32_bf16 v[104:107], v[148:151], a[184:187], v[104:107]
    v_cndmask_b32 v62, v62, 0, s[82:83]
    v_cndmask_b32 v63, v63, 0, s[82:83]
    v_mfma_f32_16x16x32_bf16 v[104:107], v[152:155], a[208:211], v[104:107]
    v_mfma_f32_16x16x32_bf16 v[104:107], v[156:159], a[232:235], v[104:107]
    v_mfma_f32_16x16x32_bf16 v[72:75], v[56:59], v[64:67], 0
    v_mfma_f32_16x16x32_bf16 v[104:107], v[160:163], v[176:179], v[104:107]
    v_mfma_f32_16x16x32_bf16 v[76:79], v[60:63], v[64:67], 0
    v_mfma_f32_16x16x32_bf16 v[104:107], v[164:167], v[200:203], v[104:107]
    ds_read_u16_d16_hi v8, v93 offset:49152
    ds_read_u16_d16_hi v9, v94 offset:49152
    v_mfma_f32_16x16x32_bf16 v[104:107], v[168:171], v[224:227], v[104:107]
    ds_read_u16_d16_hi v10, v92 offset:49152
    v_mfma_f32_16x16x32_bf16 v[104:107], v[172:175], v[248:251], v[104:107]
    v_mfma_f32_16x16x32_bf16 v[108:111], v[120:123], a[20:23], 0
    v_mfma_f32_16x16x32_bf16 v[108:111], v[124:127], a[44:47], v[108:111]
    v_mfma_f32_16x16x32_bf16 v[108:111], v[128:131], a[68:71], v[108:111]
    v_cndmask_b32 v26, v72, v73, s[76:77]
    v_cndmask_b32 v27, v74, v75, s[76:77]
    v_mfma_f32_16x16x32_bf16 v[108:111], v[132:135], a[92:95], v[108:111]
    v_cndmask_b32 v28, v76, v77, s[76:77]
    v_cndmask_b32 v29, v78, v79, s[76:77]
    v_mfma_f32_16x16x32_bf16 v[108:111], v[136:139], a[116:119], v[108:111]
    v_cndmask_b32 v26, v26, v28, s[78:79]
    v_cndmask_b32 v27, v27, v29, s[80:81]
    v_mfma_f32_16x16x32_bf16 v[108:111], v[140:143], a[140:143], v[108:111]
    s_waitcnt lgkmcnt(0)
    v_mul_f32 v26, v26, v8
    v_mfma_f32_16x16x32_bf16 v[108:111], v[144:147], a[164:167], v[108:111]
    v_cvt_pk_bf16_f32 v40, v104, v105
    v_cvt_pk_bf16_f32 v41, v106, v107
    v_mfma_f32_16x16x32_bf16 v[108:111], v[148:151], a[188:191], v[108:111]
    v_mul_f32 v27, v27, v9
    v_mul_f32 v11, s91, v10
    v_mfma_f32_16x16x32_bf16 v[108:111], v[152:155], a[212:215], v[108:111]
    v_max_f32 v28, v26, v27
    v_mov_b32 v29, v28
    v_mfma_f32_16x16x32_bf16 v[108:111], v[156:159], a[236:239], v[108:111]
    v_mfma_f32_16x16x32_bf16 v[108:111], v[160:163], v[180:183], v[108:111]
    v_permlane16_swap_b32 v28, v29
    v_max_f32 v28, v28, v29
    v_mfma_f32_16x16x32_bf16 v[108:111], v[164:167], v[204:207], v[108:111]
    v_mov_b32 v29, v28
    v_mfma_f32_16x16x32_bf16 v[108:111], v[168:171], v[228:231], v[108:111]
    v_mfma_f32_16x16x32_bf16 v[108:111], v[172:175], v[252:255], v[108:111]
    v_permlane32_swap_b32 v28, v29
    v_max_f32 v28, v28, v29
    s_nop 5
    v_cvt_pk_bf16_f32 v50, v108, v109
    v_cvt_pk_bf16_f32 v51, v110, v111
    v_sub_f32 v26, v26, v28
    v_sub_f32 v27, v27, v28
    v_mul_f32 v26, v11, v26
    v_mul_f32 v27, v11, v27
    v_exp_f32 v26, v26
    v_exp_f32 v27, v27
    s_nop 0
    v_add_f32 v28, v26, v27
    v_mov_b32 v29, v28
    s_nop 1
    v_permlane16_swap_b32 v28, v29
    v_add_f32 v28, v28, v29
    v_mov_b32 v29, v28
    s_nop 1
    v_permlane32_swap_b32 v28, v29
    v_add_f32 v28, v28, v29
    v_rcp_f32 v28, v28
    v_mul_f32 v26, v26, v8
    v_mul_f32 v27, v27, v9
    v_mul_f32 v26, v26, v28
    v_mul_f32 v27, v27, v28
    v_cvt_pk_bf16_f32 v26, v26, v26
    v_cvt_pk_bf16_f32 v27, v27, v27
    v_and_b32 v80, v26, v14
    v_and_b32 v81, v27, v15
    v_and_b32 v82, v26, v16
    v_and_b32 v83, v27, v17
    s_nop 1
    v_mfma_f32_16x16x32_bf16 v[72:75], v[38:41], v[80:83], 0
    v_mfma_f32_16x16x32_bf16 v[76:79], v[48:51], v[80:83], 0
    s_add_u32 s53, s74, 114688
    s_nop 5
    v_cvt_pk_bf16_f32 v84, v72, v73
    v_cvt_pk_bf16_f32 v85, v74, v75
    v_cvt_pk_bf16_f32 v86, v76, v77
    v_cvt_pk_bf16_f32 v87, v78, v79
    buffer_store_dwordx4 v[84:87], v23, s[24:27], s53 offen sc1
    v_cndmask_b32 v80, v84, v86, s[88:89]
    v_cndmask_b32 v81, v85, v87, s[88:89]
    ds_write_b64 v95, v[80:81] offset:1792
    v_lshlrev_b32 v6, 4, v0
    v_add_u32 v6, 147456, v6
    v_lshrrev_b32 v7, 4, v1
    v_and_b32 v12, 15, v1
    v_lshlrev_b32 v7, 14, v7
    v_lshl_add_u32 v7, v12, 4, v7
    s_waitcnt lgkmcnt(0)
    s_barrier
    ds_read_b128 v[72:75], v6
    s_waitcnt lgkmcnt(0)
    buffer_store_dwordx4 v[72:75], v7, s[24:27], s95 offen sc1
    s_waitcnt vmcnt(0) lgkmcnt(0)
    s_barrier
    s_cmp_lg_u32 s44, 0
    s_cbranch_scc1 L_nopub21
    s_lshl_b32 s60, s48, 4
    s_add_u32 s60, s60, s49
    s_lshl_b32 s60, s60, 7
    s_add_u32 s60, s60, 12779520
    v_mov_b32 v30, s47
    s_mov_b64 exec, 1
    buffer_store_dword v30, off, s[24:27], s60 sc1
    s_mov_b64 exec, -1
L_nopub21:
    s_endpgm
L_codeend:
.section .rodata,"a"
.p2align 6
.amdhsa_kernel parallel_sum__sliding_local_dilated__mixer_token_mlp__prompt_kernel
  .amdhsa_next_free_vgpr 512
  .amdhsa_next_free_sgpr 102
  .amdhsa_accum_offset 256
  .amdhsa_group_segment_fixed_size 0
  .amdhsa_kernarg_size 88
  .amdhsa_user_sgpr_count 2
  .amdhsa_user_sgpr_kernarg_segment_ptr 1
  .amdhsa_system_sgpr_workgroup_id_x 1
  .amdhsa_float_denorm_mode_32 3
.end_amdhsa_kernel
```

```asm
; @launch grid=(256,1,1) block=(256,1,1) lds=163840
.amdgcn_target "amdgcn-amd-amdhsa--gfx950"
.text
.globl parallel_sum__sliding_local_dilated__mixer_token_mlp__prompt_kernel
.p2align 8
.type parallel_sum__sliding_local_dilated__mixer_token_mlp__prompt_kernel,@function
parallel_sum__sliding_local_dilated__mixer_token_mlp__prompt_kernel:
    s_cmp_ge_u32 s2, 256
    s_cbranch_scc1 L_end
    s_load_dwordx2 s[4:5], s[0:1], 0
    s_load_dwordx16 s[76:91], s[0:1], 0
    s_load_dwordx4 s[92:95], s[0:1], 64
    s_load_dwordx2 s[24:25], s[0:1], 80
    s_lshr_b32 s46, s2, 3
    s_getpc_b64 s[98:99]
L_pc:
    s_mul_i32 s53, s46, 1536
    v_lshrrev_b32 v26, 4, v0
    v_min_u32 v26, 11, v26
    v_lshl_add_u32 v26, v26, 7, s53
    v_lshrrev_b32 v25, 5, v0
    v_min_u32 v26, L_codeend-L_pc-4, v26
    v_mov_b32 v29, s99
    v_add_co_u32 v28, vcc, s98, v26
    s_nop 1
    v_addc_co_u32 v29, vcc, 0, v29, vcc
    global_load_dword v108, v[28:29], off
    v_and_b32 v26, 31, v0
    v_mul_u32_u24 v24, 896, v25
    v_lshl_add_u32 v24, v26, 4, v24
    s_mul_i32 s53, s2, 7168
    v_add_u32 v24, s53, v24
    v_cmp_gt_u32 vcc, 24, v26
    v_mov_b32 v27, 2130706432
    s_mov_b32 s6, 1835008
    s_mov_b32 s7, 0x20000
    v_cndmask_b32 v22, v27, v24, vcc
    v_lshrrev_b32 v27, 6, v0
    v_and_b32 v1, 63, v0
    s_waitcnt lgkmcnt(0)
    buffer_load_dwordx4 v[32:35], v24, s[4:7], 0 offen
    buffer_load_dwordx4 v[36:39], v22, s[4:7], 0 offen offset:512
    v_readfirstlane_b32 s44, v27
    s_and_b32 s45, s2, 7
    s_mov_b64 s[8:9], s[78:79]
    s_mov_b32 s10, 1204224
    s_mov_b32 s11, s7
    s_and_b32 s53, s45, 6
    s_lshr_b32 s53, 0xc9, s53
    s_and_b32 s53, s53, 3
    s_add_u32 s54, s53, 1
    s_bfe_u32 s54, s54, 0x10001
    s_add_u32 s54, s54, 1
    s_mul_i32 s53, s53, 224
    s_andn2_b32 s53, s53, 127
    s_sub_u32 s55, s46, 3
    s_cmp_lt_u32 s46, 24
    s_cselect_b32 s55, 63, s55
    s_cmp_lt_u32 s46, 21
    s_cselect_b32 s55, s46, s55
    s_mul_i32 s55, s55, 43008
    s_add_u32 s53, s53, s55
    v_and_b32 v27, 3, v0
    v_min_u32 v27, s54, v27
    v_bfe_u32 v28, v0, 2, 2
    v_min_u32 v28, 2, v28
    v_mul_u32_u24 v28, 7, v28
    v_add_u32 v27, v27, v28
    v_lshrrev_b32 v28, 4, v0
    v_min_u32 v28, 15, v28
    v_mul_u32_u24 v28, 21, v28
    v_add_lshl_u32 v27, v27, v28, 7
    buffer_load_dword v108, v27, s[8:11], s53 offen
    s_mov_b64 s[40:41], s[94:95]
    s_mov_b32 s42, 256
    s_mov_b32 s43, s7
    s_or_b32 s53, s2, s44
    s_cbranch_scc1 L_nononce
    s_memrealtime s[98:99]
    s_waitcnt lgkmcnt(0)
    s_or_b32 s98, s98, 1
    v_mov_b32 v28, s98
    s_mov_b64 exec, 1
    buffer_store_dword v28, off, s[40:43], 0 sc1
    s_mov_b64 exec, -1
L_nononce:
    s_mov_b64 s[16:17], s[84:85]
    s_mov_b32 s18, 7340032
    s_mov_b32 s19, s7
    s_mov_b32 s26, 16777216
    s_mov_b32 s27, s7
    s_mov_b64 s[20:21], s[88:89]
    s_mov_b32 s22, 7340032
    s_mov_b32 s23, s7
    s_mov_b64 s[12:13], s[80:81]
    s_mov_b32 s14, 401408
    s_mov_b32 s15, s7
    s_mov_b64 s[28:29], s[92:93]
    s_mov_b32 s30, 1835008
    s_mov_b32 s31, s7
    s_mov_b64 s[32:33], s[86:87]
    s_mov_b32 s34, 3584
    s_mov_b32 s35, s7
    s_mov_b64 s[36:37], s[90:91]
    s_mov_b32 s38, 4096
    s_mov_b32 s39, s7
    s_lshl_b32 s52, s44, 12
    v_lshlrev_b32 v23, 4, v1
    s_cmp_ge_u32 s46, 24
    s_cbranch_scc1 L_role_a
    v_lshrrev_b32 v208, 4, v1
    v_bfe_u32 v209, v1, 2, 2
    v_and_b32 v210, 3, v1
    v_and_b32 v211, 15, v1
    v_lshrrev_b32 v212, 5, v1
    s_mul_i32 s55, s45, 3
    s_max_u32 s55, s55, 1
    s_add_u32 s55, s55, s46
    s_sub_u32 s55, s55, 1
    s_sub_u32 s56, s55, 21
    s_min_u32 s55, s55, s56
    s_and_b32 s54, s45, 1
    s_mul_i32 s54, s54, 24
    s_sub_u32 s54, s46, s54
    s_cmp_ge_u32 s46, 21
    s_cselect_b32 s54, s54, s55
    s_mul_i32 s53, s45, 21
    s_add_u32 s53, s53, s54
    s_mul_i32 s50, s53, 171
    s_lshr_b32 s50, s50, 10
    s_mul_i32 s54, s50, 6
    s_sub_u32 s88, s53, s54
    s_mul_i32 s51, s50, 2
    s_add_u32 s51, s51, s88
    s_mul_i32 s54, s51, 43
    s_lshr_b32 s54, s54, 8
    s_mul_i32 s54, s54, 6
    s_sub_u32 s51, s51, s54
    s_mul_i32 s65, s51, 14
    s_add_u32 s65, s65, 2
    s_mul_i32 s65, s65, 171
    s_lshr_b32 s65, s65, 10
    v_lshl_add_u32 v213, v212, 2, v209
    v_and_b32 v215, 1, v208
    v_lshlrev_b32 v214, 4, v210
    v_lshl_add_u32 v214, v215, 6, v214
    s_mul_i32 s53, s44, 1835008
    s_lshl_b32 s54, s50, 7
    s_add_u32 s53, s53, s54
    v_mul_u32_u24 v10, 3584, v213
    v_add3_u32 v10, v10, v214, s53
    v_xor_b32 v11, 32, v10
    s_cmp_ge_u32 s46, 21
    s_cbranch_scc1 L_help
    s_add_u32 m0, s52, 49152
    s_add_u32 s57, s65, 0
    s_sub_u32 s3, s57, 14
    s_min_u32 s57, s57, s3
    s_mul_i32 s57, s57, 114688
    buffer_load_dwordx4 v10, s[16:19], s57 offen offset:0 lds
    s_add_u32 s57, s57, 27648
    buffer_load_dwordx4 v11, s[16:19], s57 offen offset:1024 lds
    v_mul_u32_u24 v109, 1088, v25
    v_lshl_add_u32 v109, v26, 4, v109
    v_mul_u32_u24 v110, 1088, v209
    v_lshl_add_u32 v110, v208, 5, v110
    v_lshl_add_u32 v110, v210, 3, v110
    s_lshl_b32 s53, s44, 7
    v_add_u32 v110, s53, v110
    v_mul_u32_u24 v111, 66816, v208
    v_lshl_add_u32 v111, v211, 4, v111
    s_mul_i32 s63, s44, 267264
    s_lshl_b32 s53, s2, 8
    s_add_u32 s63, s63, s53
    s_add_u32 s64, s63, 1069056
    v_cmp_gt_u32 vcc, 208, v0
    v_mov_b32 v100, 2130706432
    v_cmp_le_u32 s[92:93], 24, v26
    v_cndmask_b32 v22, v100, v111, vcc
    s_mov_b32 s62, 0x3f803f80
    s_mov_b32 s61, 0xffff0000
    v_mov_b32 v96, 0
    v_mov_b32 v97, 0
    v_lshlrev_b32 v216, 6, v209
    v_lshl_add_u32 v216, v210, 3, v216
    v_lshl_add_u32 v216, v215, 5, v216
    s_add_u32 s53, s52, 49152
    v_lshl_add_u32 v2, v208, 10, v216
    v_add_u32 v2, s53, v2
    v_xor_b32 v3, 32, v2
    v_add_u32 v4, 65536, v2
    v_add_u32 v5, 65536, v3
    v_lshl_add_u32 v6, v208, 9, v216
    v_add_u32 v6, s53, v6
    v_xor_b32 v7, 32, v6
    v_add_u32 v8, 65536, v6
    v_add_u32 v9, 65536, v7
    s_waitcnt vmcnt(4)
    v_dot2c_f32_bf16 v96, s62, v32
    v_dot2c_f32_bf16 v97, v32, v32
    v_lshlrev_b32 v40, 16, v32
    v_and_b32 v41, s61, v32
    v_dot2c_f32_bf16 v96, s62, v33
    v_dot2c_f32_bf16 v97, v33, v33
    v_lshlrev_b32 v42, 16, v33
    v_and_b32 v43, s61, v33
    v_dot2c_f32_bf16 v96, s62, v34
    v_dot2c_f32_bf16 v97, v34, v34
    v_lshlrev_b32 v44, 16, v34
    v_and_b32 v45, s61, v34
    v_dot2c_f32_bf16 v96, s62, v35
    v_dot2c_f32_bf16 v97, v35, v35
    v_lshlrev_b32 v46, 16, v35
    v_and_b32 v47, s61, v35
    s_waitcnt vmcnt(3)
    v_dot2c_f32_bf16 v96, s62, v36
    v_dot2c_f32_bf16 v97, v36, v36
    v_lshlrev_b32 v48, 16, v36
    v_and_b32 v49, s61, v36
    v_dot2c_f32_bf16 v96, s62, v37
    v_dot2c_f32_bf16 v97, v37, v37
    v_lshlrev_b32 v50, 16, v37
    v_and_b32 v51, s61, v37
    v_dot2c_f32_bf16 v96, s62, v38
    v_dot2c_f32_bf16 v97, v38, v38
    v_lshlrev_b32 v52, 16, v38
    v_and_b32 v53, s61, v38
    v_dot2c_f32_bf16 v96, s62, v39
    v_dot2c_f32_bf16 v97, v39, v39
    v_lshlrev_b32 v54, 16, v39
    v_and_b32 v55, s61, v39
    buffer_load_dword v29, off, s[40:43], 0 sc1
    v_add_f32_dpp v96, v96, v96 quad_perm:[1,0,3,2] row_mask:0xf bank_mask:0xf
    v_add_f32_dpp v97, v97, v97 quad_perm:[1,0,3,2] row_mask:0xf bank_mask:0xf
    s_nop 0
    v_add_f32_dpp v96, v96, v96 quad_perm:[2,3,0,1] row_mask:0xf bank_mask:0xf
    v_add_f32_dpp v97, v97, v97 quad_perm:[2,3,0,1] row_mask:0xf bank_mask:0xf
    s_nop 0
    v_add_f32_dpp v96, v96, v96 row_half_mirror row_mask:0xf bank_mask:0xf
    v_add_f32_dpp v97, v97, v97 row_half_mirror row_mask:0xf bank_mask:0xf
    s_nop 0
    v_add_f32_dpp v96, v96, v96 row_mirror row_mask:0xf bank_mask:0xf
    v_add_f32_dpp v97, v97, v97 row_mirror row_mask:0xf bank_mask:0xf
    v_mov_b32 v98, v96
    v_mov_b32 v99, v97
    s_nop 0
    v_permlane16_swap_b32 v96, v98
    v_permlane16_swap_b32 v97, v99
    v_add_f32 v96, v96, v98
    v_add_f32 v97, v97, v99
    v_mul_f32 v98, 0x3b124925, v96
    v_mul_f32 v99, 0x3b124925, v97
    v_fma_f32 v99, -v98, v98, v99
    v_max_f32 v99, 0, v99
    v_cvt_pk_bf16_f32 v100, 0, v99
    v_add_f32 v100, 0x3727c5ac, v100
    v_cvt_pk_bf16_f32 v100, 0, v100
    v_sqrt_f32 v100, v100
    s_nop 0
    v_cvt_pk_bf16_f32 v100, 0, v100
    v_rcp_f32 v100, v100
    s_nop 0
    v_mul_f32 v99, v99, v100
    v_mul_f32 v99, v99, v100
    v_cvt_pk_bf16_f32 v104, 0, v99
    v_add_f32 v104, 0x3727c5ac, v104
    v_cvt_pk_bf16_f32 v104, 0, v104
    v_sqrt_f32 v104, v104
    s_nop 0
    v_cvt_pk_bf16_f32 v102, 0, v104
    v_rcp_f32 v104, v102
    s_nop 0
    v_mul_f32 v104, v104, v100
    v_mul_f32 v106, v98, v104
    v_pk_fma_f32 v[56:57], v[40:41], v[104:105], v[106:107] op_sel_hi:[1,0,0] neg_lo:[0,0,1] neg_hi:[0,0,1]
    v_pk_fma_f32 v[58:59], v[42:43], v[104:105], v[106:107] op_sel_hi:[1,0,0] neg_lo:[0,0,1] neg_hi:[0,0,1]
    v_pk_fma_f32 v[60:61], v[44:45], v[104:105], v[106:107] op_sel_hi:[1,0,0] neg_lo:[0,0,1] neg_hi:[0,0,1]
    v_pk_fma_f32 v[62:63], v[46:47], v[104:105], v[106:107] op_sel_hi:[1,0,0] neg_lo:[0,0,1] neg_hi:[0,0,1]
    v_pk_fma_f32 v[64:65], v[48:49], v[104:105], v[106:107] op_sel_hi:[1,0,0] neg_lo:[0,0,1] neg_hi:[0,0,1]
    v_pk_fma_f32 v[66:67], v[50:51], v[104:105], v[106:107] op_sel_hi:[1,0,0] neg_lo:[0,0,1] neg_hi:[0,0,1]
    v_pk_fma_f32 v[68:69], v[52:53], v[104:105], v[106:107] op_sel_hi:[1,0,0] neg_lo:[0,0,1] neg_hi:[0,0,1]
    v_pk_fma_f32 v[70:71], v[54:55], v[104:105], v[106:107] op_sel_hi:[1,0,0] neg_lo:[0,0,1] neg_hi:[0,0,1]
    v_cvt_pk_bf16_f32 v80, v56, v57
    v_cvt_pk_bf16_f32 v81, v58, v59
    v_cvt_pk_bf16_f32 v82, v60, v61
    v_cvt_pk_bf16_f32 v83, v62, v63
    v_cvt_pk_bf16_f32 v84, v64, v65
    v_cvt_pk_bf16_f32 v85, v66, v67
    v_cvt_pk_bf16_f32 v86, v68, v69
    v_cvt_pk_bf16_f32 v87, v70, v71
    v_lshrrev_b32 v102, 16, v102
    v_cndmask_b32 v84, v84, v102, s[92:93]
    ds_write_b128 v109, v[80:83] offset:0
    ds_write_b128 v109, v[84:87] offset:512
    s_waitcnt lgkmcnt(0)
    s_barrier
    ds_read_b64_tr_b16 v[88:89], v110 offset:0
    ds_read_b64_tr_b16 v[90:91], v110 offset:4352
    ds_read_b64_tr_b16 v[92:93], v110 offset:512
    ds_read_b64_tr_b16 v[94:95], v110 offset:4864
    s_waitcnt lgkmcnt(2)
    buffer_store_dwordx4 v[88:91], v111, s[24:27], s63 offen sc1
    s_waitcnt lgkmcnt(0)
    buffer_store_dwordx4 v[92:95], v22, s[24:27], s64 offen sc1
    s_add_u32 s57, s57, 27648
    buffer_load_dwordx4 v10, s[16:19], s57 offen offset:2048 lds
    s_add_u32 s57, s57, 27648
    buffer_load_dwordx4 v11, s[16:19], s57 offen offset:3072 lds
    s_add_u32 m0, s52, 65536
    s_add_u32 s57, s65, 1
    s_sub_u32 s3, s57, 14
    s_min_u32 s57, s57, s3
    s_mul_i32 s57, s57, 114688
    buffer_load_dwordx4 v10, s[16:19], s57 offen offset:0 lds
    s_add_u32 s57, s57, 27648
    buffer_load_dwordx4 v11, s[16:19], s57 offen offset:1024 lds
    s_add_u32 s57, s57, 27648
    buffer_load_dwordx4 v10, s[16:19], s57 offen offset:2048 lds
    s_add_u32 s57, s57, 27648
    buffer_load_dwordx4 v11, s[16:19], s57 offen offset:3072 lds
    s_branch L_body
.p2align 12
L_body:
    s_mov_b32 s59, s44
    s_mov_b64 exec, 0
    s_branch L_wb_go
L_wb_ret:
    s_add_u32 s59, s59, 4
L_wb_go:
    s_cmp_eq_u32 s59, 0
    s_cbranch_scc1 L_wb_0
    s_cmp_eq_u32 s59, 1
    s_cbranch_scc1 L_wb_1
    s_cmp_eq_u32 s59, 2
    s_cbranch_scc1 L_wb_2
    s_cmp_eq_u32 s59, 3
    s_cbranch_scc1 L_wb_3
    s_cmp_eq_u32 s59, 4
    s_cbranch_scc1 L_wb_3
    s_cmp_eq_u32 s59, 5
    s_cbranch_scc1 L_wb_3
    s_mov_b64 exec, -1
    s_waitcnt vmcnt(6)
    v_cmp_eq_u32 vcc, 0, v29
    s_nop 0
    s_cbranch_vccz L_ok2
    s_mov_b32 s59, 100000
L_spin1:
    buffer_load_dword v29, off, s[40:43], 0 sc1
    s_waitcnt vmcnt(0)
    v_cmp_eq_u32 vcc, 0, v29
    s_nop 0
    s_cbranch_vccz L_ok2
    s_sub_u32 s59, s59, 1
    s_cbranch_scc0 L_spin1
L_ok2:
    v_readfirstlane_b32 s47, v29
    s_barrier
    s_cmp_lg_u32 s44, 0
    s_cbranch_scc1 L_nopub3
    s_lshl_b32 s60, s2, 5
    s_add_u32 s60, s60, 12582912
    v_mov_b32 v30, s47
    s_mov_b64 exec, 1
    buffer_store_dword v30, off, s[24:27], s60 sc1
    s_mov_b64 exec, -1
L_nopub3:
    s_lshl_b32 s53, s44, 11
    s_add_u32 s53, s53, 12582912
    v_lshl_add_u32 v18, v1, 5, s53
    s_lshl_b32 s53, s50, 7
    s_add_u32 m0, s52, 81920
    s_add_u32 s57, s65, 2
    s_sub_u32 s3, s57, 14
    s_min_u32 s57, s57, s3
    s_mul_i32 s57, s57, 114688
    buffer_load_dwordx4 v10, s[16:19], s57 offen offset:0 lds
    v_lshl_add_u32 v19, v208, 3, s53
    s_lshl2_add_u32 s67, s51, s44
    s_mul_i32 s67, s67, 58624
    s_lshl_b32 s53, s50, 11
    s_add_u32 s57, s57, 27648
    buffer_load_dwordx4 v11, s[16:19], s57 offen offset:1024 lds
    s_add_u32 s67, s67, s53
    s_add_u32 s67, s67, 2097152
    v_mov_b32 v236, 0xbdd2d3e8
    v_mov_b32 v237, 0xc0135761
    s_add_u32 s57, s57, 27648
    buffer_load_dwordx4 v10, s[16:19], s57 offen offset:2048 lds
    s_or_b32 s88, s88, 0
    s_add_u32 s54, s88, 24
    s_mul_i32 s84, s54, 66816
    s_lshl2_add_u32 s84, s52, s84
    s_mul_i32 s83, s54, 58624
    s_add_u32 s83, s83, s53
    s_and_b32 s54, s44, 1
    s_lshl_b32 s54, s54, 10
    s_add_u32 s57, s57, 27648
    buffer_load_dwordx4 v11, s[16:19], s57 offen offset:3072 lds
    s_add_u32 s83, s83, s54
    s_add_u32 s83, s83, 2097152
    s_lshl1_add_u32 s54, s54, 49152
    v_add_u32 v243, s54, v23
    s_add_u32 m0, s52, 98304
    s_add_u32 s57, s65, 3
    s_sub_u32 s3, s57, 14
    s_min_u32 s57, s57, s3
    s_mul_i32 s57, s57, 114688
    buffer_load_dwordx4 v10, s[16:19], s57 offen offset:0 lds
    s_cmp_lt_u32 s88, 4
    s_cselect_b32 s84, s84, 2130706432
    s_cselect_b32 s83, s83, 2130706432
    s_cmp_lt_u32 s44, 2
    s_cselect_b32 s83, s83, 2130706432
    s_cmp_eq_u32 s44, 0
    s_cselect_b32 s85, 1.0, 0
    s_mul_i32 s53, s45, 7
    s_lshr_b32 s53, s53, 1
    s_sub_u32 s53, s50, s53
    s_lshl1_add_u32 s53, s53, s88
    s_sub_u32 s53, s53, 4
    s_mul_i32 s54, s44, 28
    s_add_u32 s54, s54, s53
    s_lshl_b32 s87, s54, 16
    s_lshl_b32 s54, s45, 9
    s_add_u32 s87, s87, s54
    s_cmp_ge_u32 s88, 4
    s_cselect_b32 s87, s87, 2130706432
    v_lshrrev_b32 v254, 2, v1
    v_lshlrev_b32 v254, 12, v254
    v_lshl_add_u32 v254, v210, 7, v254
    s_add_u32 s57, s57, 27648
    buffer_load_dwordx4 v11, s[16:19], s57 offen offset:1024 lds
    s_waitcnt vmcnt(10)
    ds_read_b64_tr_b16 a[0:1], v2 offset:0
    ds_read_b64_tr_b16 a[2:3], v2 offset:512
    ds_read_b64_tr_b16 a[4:5], v3 offset:0
    ds_read_b64_tr_b16 a[6:7], v3 offset:512
    s_add_u32 s57, s57, 27648
    buffer_load_dwordx4 v10, s[16:19], s57 offen offset:2048 lds
    ds_read_b64_tr_b16 a[8:9], v2 offset:256
    ds_read_b64_tr_b16 a[10:11], v2 offset:768
    ds_read_b64_tr_b16 a[12:13], v3 offset:256
    ds_read_b64_tr_b16 a[14:15], v3 offset:768
    s_add_u32 s57, s57, 27648
    buffer_load_dwordx4 v11, s[16:19], s57 offen offset:3072 lds
    s_lshr_b32 s53, s46, 2
    s_and_b32 s89, s46, 3
    s_bfe_u32 s54, s46, 0x20001
    s_and_b32 s55, s46, 1
    s_add_u32 s55, s55, 4
    s_cmp_lt_u32 s46, 16
    s_cselect_b32 s53, s53, s54
    s_cselect_b32 s89, s89, s55
    s_mul_i32 s49, s53, 2
    s_add_u32 s49, s49, s89
    s_sub_u32 s54, s49, 6
    s_min_u32 s49, s49, s54
    s_or_b32 s89, s89, 0
    s_add_u32 m0, s52, 114688
    s_add_u32 s57, s65, 4
    s_sub_u32 s3, s57, 14
    s_min_u32 s57, s57, s3
    s_mul_i32 s57, s57, 114688
    buffer_load_dwordx4 v10, s[16:19], s57 offen offset:0 lds
    s_lshl2_add_u32 s48, s45, s53
    s_mul_i32 s53, s44, 1835008
    s_lshl_b32 s74, s48, 7
    s_add_u32 s53, s53, s74
    s_add_u32 s57, s57, 27648
    buffer_load_dwordx4 v11, s[16:19], s57 offen offset:1024 lds
    s_waitcnt vmcnt(10)
    ds_read_b64_tr_b16 a[16:17], v2 offset:16384
    ds_read_b64_tr_b16 a[18:19], v2 offset:16896
    ds_read_b64_tr_b16 a[20:21], v3 offset:16384
    ds_read_b64_tr_b16 a[22:23], v3 offset:16896
    s_add_u32 s57, s57, 27648
    buffer_load_dwordx4 v10, s[16:19], s57 offen offset:2048 lds
    ds_read_b64_tr_b16 a[24:25], v2 offset:16640
    ds_read_b64_tr_b16 a[26:27], v2 offset:17152
    ds_read_b64_tr_b16 a[28:29], v3 offset:16640
    ds_read_b64_tr_b16 a[30:31], v3 offset:17152
    s_lshl_b32 s56, s44, 5
    v_lshlrev_b32 v217, 5, v212
    v_xor_b32 v217, v217, v214
    v_xor_b32 v217, s56, v217
    s_add_u32 s57, s57, 27648
    buffer_load_dwordx4 v11, s[16:19], s57 offen offset:3072 lds
    s_add_u32 s74, s74, s56
    v_lshlrev_b32 v12, 12, v213
    v_add3_u32 v12, v12, v217, s53
    s_mul_i32 s53, s44, 28672
    s_add_u32 m0, s52, 131072
    s_add_u32 s57, s65, 5
    s_sub_u32 s3, s57, 14
    s_min_u32 s57, s57, s3
    s_mul_i32 s57, s57, 114688
    buffer_load_dwordx4 v10, s[16:19], s57 offen offset:0 lds
    s_lshl_b32 s54, s49, 7
    s_add_u32 s55, s53, s54
    v_mul_u32_u24 v13, 896, v213
    v_add3_u32 v13, v13, v214, s55
    s_add_u32 s57, s57, 27648
    buffer_load_dwordx4 v11, s[16:19], s57 offen offset:1024 lds
    s_waitcnt vmcnt(10)
    ds_read_b64_tr_b16 a[32:33], v2 offset:32768
    ds_read_b64_tr_b16 a[34:35], v2 offset:33280
    ds_read_b64_tr_b16 a[36:37], v3 offset:32768
    ds_read_b64_tr_b16 a[38:39], v3 offset:33280
    v_xor_b32 v14, 32, v13
    s_mul_i32 s55, s44, 21504
    v_subrev_u32 v239, s55, v13
    s_and_b32 s55, s56, 32
    ds_read_b64_tr_b16 a[40:41], v2 offset:33024
    ds_read_b64_tr_b16 a[42:43], v2 offset:33536
    ds_read_b64_tr_b16 a[44:45], v3 offset:33024
    ds_read_b64_tr_b16 a[46:47], v3 offset:33536
    s_add_u32 s57, s57, 27648
    buffer_load_dwordx4 v10, s[16:19], s57 offen offset:2048 lds
    v_xor_b32 v239, s55, v239
    s_mul_i32 s73, s48, 57344
    s_add_u32 s71, s73, s54
    s_mul_i32 s55, s44, 14336
    s_add_u32 s57, s57, 27648
    buffer_load_dwordx4 v11, s[16:19], s57 offen offset:3072 lds
    s_add_u32 s71, s71, s55
    s_add_u32 s72, s71, 7168
    v_bfe_u32 v217, v1, 1, 2
    v_lshl_add_u32 v217, v212, 2, v217
    s_add_u32 m0, s52, 147456
    s_add_u32 s57, s65, 6
    s_sub_u32 s3, s57, 14
    s_min_u32 s57, s57, s3
    s_mul_i32 s57, s57, 114688
    buffer_load_dwordx4 v10, s[16:19], s57 offen offset:0 lds
    v_and_b32 v218, 24, v1
    v_add_u32 v217, v217, v218
    v_mul_u32_u24 v15, 896, v217
    v_and_b32 v217, 1, v1
    v_lshl_add_u32 v15, v217, 4, v15
    v_add_u32 v15, s53, v15
    s_lshl_b32 s54, s89, 5
    s_add_u32 s54, s54, 768
    s_add_u32 s57, s57, 27648
    buffer_load_dwordx4 v11, s[16:19], s57 offen offset:1024 lds
    s_waitcnt vmcnt(10)
    ds_read_b64_tr_b16 a[48:49], v2 offset:49152
    ds_read_b64_tr_b16 a[50:51], v2 offset:49664
    ds_read_b64_tr_b16 a[52:53], v3 offset:49152
    ds_read_b64_tr_b16 a[54:55], v3 offset:49664
    s_add_u32 s57, s57, 27648
    buffer_load_dwordx4 v10, s[16:19], s57 offen offset:2048 lds
    ds_read_b64_tr_b16 a[56:57], v2 offset:49408
    ds_read_b64_tr_b16 a[58:59], v2 offset:49920
    ds_read_b64_tr_b16 a[60:61], v3 offset:49408
    ds_read_b64_tr_b16 a[62:63], v3 offset:49920
    s_add_u32 s57, s57, 27648
    buffer_load_dwordx4 v11, s[16:19], s57 offen offset:3072 lds
    s_add_u32 s68, s89, 24
    s_mul_i32 s68, s68, 58624
    s_mul_i32 s69, s44, 14336
    s_add_u32 s69, s69, 2097152
    s_add_u32 s68, s68, s69
    s_mul_i32 s55, s49, 234496
    s_add_u32 s69, s69, s55
    s_add_u32 s73, s73, s54
    s_waitcnt lgkmcnt(15)
    s_add_u32 m0, s52, 49152
    s_add_u32 s57, s65, 7
    s_sub_u32 s3, s57, 14
    s_min_u32 s57, s57, s3
    s_mul_i32 s57, s57, 114688
    buffer_load_dwordx4 v10, s[16:19], s57 offen offset:0 lds
    s_mov_b32 s76, 0
    s_add_u32 s77, s76, 2048
    s_cmp_eq_u32 s77, 14336
    s_cselect_b32 s77, 0, s77
    s_add_u32 s78, s77, 2048
    s_cmp_eq_u32 s78, 14336
    s_cselect_b32 s78, 0, s78
    s_add_u32 s79, s78, 2048
    s_cmp_eq_u32 s79, 14336
    s_cselect_b32 s79, 0, s79
    s_add_u32 s80, s79, 2048
    s_cmp_eq_u32 s80, 14336
    s_cselect_b32 s80, 0, s80
    s_add_u32 s81, s80, 2048
    s_cmp_eq_u32 s81, 14336
    s_cselect_b32 s81, 0, s81
    s_add_u32 s82, s81, 2048
    s_cmp_eq_u32 s82, 14336
    s_cselect_b32 s82, 0, s82
    s_add_u32 s57, s57, 27648
    buffer_load_dwordx4 v11, s[16:19], s57 offen offset:1024 lds
    s_waitcnt vmcnt(10)
    ds_read_b64_tr_b16 a[64:65], v4 offset:0
    ds_read_b64_tr_b16 a[66:67], v4 offset:512
    ds_read_b64_tr_b16 a[68:69], v5 offset:0
    ds_read_b64_tr_b16 a[70:71], v5 offset:512
    s_add_u32 s57, s57, 27648
    buffer_load_dwordx4 v10, s[16:19], s57 offen offset:2048 lds
    ds_read_b64_tr_b16 a[72:73], v4 offset:256
    ds_read_b64_tr_b16 a[74:75], v4 offset:768
    ds_read_b64_tr_b16 a[76:77], v5 offset:256
    ds_read_b64_tr_b16 a[78:79], v5 offset:768
    s_add_u32 s57, s57, 27648
    buffer_load_dwordx4 v11, s[16:19], s57 offen offset:3072 lds
    s_cmp_lt_u32 s89, 4
    s_cselect_b32 s75, s54, 2130706432
    s_cselect_b32 s68, s68, 2130706432
    s_cselect_b32 s73, s73, 2130706432
    v_lshlrev_b32 v16, 3, v1
    v_add_u32 v16, 81920, v16
    v_and_b32 v217, 7, v1
    v_min_u32 v218, 6, v217
    s_add_u32 m0, s52, 65536
    s_add_u32 s57, s65, 8
    s_sub_u32 s3, s57, 14
    s_min_u32 s57, s57, s3
    s_mul_i32 s57, s57, 114688
    buffer_load_dwordx4 v10, s[16:19], s57 offen offset:0 lds
    s_mul_i32 s54, s44, 7
    v_add_u32 v218, s54, v218
    v_mul_u32_u24 v219, 2, v218
    v_add_u32 v219, s89, v219
    s_add_u32 s57, s57, 27648
    buffer_load_dwordx4 v11, s[16:19], s57 offen offset:1024 lds
    s_waitcnt vmcnt(10)
    ds_read_b64_tr_b16 a[80:81], v4 offset:16384
    ds_read_b64_tr_b16 a[82:83], v4 offset:16896
    ds_read_b64_tr_b16 a[84:85], v5 offset:16384
    ds_read_b64_tr_b16 a[86:87], v5 offset:16896
    s_add_u32 s57, s57, 27648
    buffer_load_dwordx4 v10, s[16:19], s57 offen offset:2048 lds
    ds_read_b64_tr_b16 a[88:89], v4 offset:16640
    ds_read_b64_tr_b16 a[90:91], v4 offset:17152
    ds_read_b64_tr_b16 a[92:93], v5 offset:16640
    ds_read_b64_tr_b16 a[94:95], v5 offset:17152
    v_mul_u32_u24 v220, 43, v219
    v_lshrrev_b32 v220, 8, v220
    v_mul_u32_u24 v220, 6, v220
    v_sub_u32 v219, v219, v220
    s_add_u32 s57, s57, 27648
    buffer_load_dwordx4 v11, s[16:19], s57 offen offset:3072 lds
    v_subrev_u32 v219, s49, v219
    v_bfe_u32 v220, v1, 3, 1
    v_mul_i32_i24 v219, v219, v220
    v_add_u32 v219, s49, v219
    s_waitcnt lgkmcnt(15)
    s_add_u32 m0, s52, 81920
    s_add_u32 s57, s65, 9
    s_sub_u32 s3, s57, 14
    s_min_u32 s57, s57, s3
    s_mul_i32 s57, s57, 114688
    buffer_load_dwordx4 v10, s[16:19], s57 offen offset:0 lds
    v_lshl_add_u32 v218, v219, 5, v218
    v_lshlrev_b32 v20, 7, v218
    v_add_u32 v20, 12713984, v20
    s_lshr_b32 s53, s48, 1
    s_add_u32 s57, s57, 27648
    buffer_load_dwordx4 v11, s[16:19], s57 offen offset:1024 lds
    s_waitcnt vmcnt(10)
    ds_read_b64_tr_b16 a[96:97], v4 offset:32768
    ds_read_b64_tr_b16 a[98:99], v4 offset:33280
    ds_read_b64_tr_b16 a[100:101], v5 offset:32768
    ds_read_b64_tr_b16 a[102:103], v5 offset:33280
    s_lshl_b32 s53, s53, 7
    s_add_u32 s53, s53, 12779520
    v_lshl_add_u32 v21, v210, 11, s53
    s_lshl_b32 s70, s48, 16
    ds_read_b64_tr_b16 a[104:105], v4 offset:33024
    ds_read_b64_tr_b16 a[106:107], v4 offset:33536
    ds_read_b64_tr_b16 a[108:109], v5 offset:33024
    ds_read_b64_tr_b16 a[110:111], v5 offset:33536
    s_add_u32 s57, s57, 27648
    buffer_load_dwordx4 v10, s[16:19], s57 offen offset:2048 lds
    s_lshl2_add_u32 s70, s52, s70
    s_add_u32 s70, s70, 4194304
    v_lshrrev_b32 v218, 3, v1
    v_mul_u32_u24 v22, 896, v218
    s_add_u32 s57, s57, 27648
    buffer_load_dwordx4 v11, s[16:19], s57 offen offset:3072 lds
    v_lshl_add_u32 v22, v217, 4, v22
    v_lshlrev_b32 v25, 1, v211
    s_add_u32 s53, s52, 65536
    v_mul_u32_u24 v244, 176, v218
    buffer_load_dwordx2 v[224:225], v19, s[32:35], 0 offen offset:0
    v_lshl_add_u32 v244, v217, 4, v244
    v_add_u32 v244, s53, v244
    v_mul_u32_u24 v238, 176, v211
    v_lshl_add_u32 v238, v208, 3, v238
    buffer_load_dwordx2 v[226:227], v19, s[32:35], 0 offen offset:32
    s_waitcnt vmcnt(10)
    ds_read_b64_tr_b16 a[112:113], v2 offset:0
    ds_read_b64_tr_b16 a[114:115], v2 offset:512
    ds_read_b64_tr_b16 a[116:117], v3 offset:0
    ds_read_b64_tr_b16 a[118:119], v3 offset:512
    buffer_load_dwordx2 v[228:229], v19, s[32:35], 0 offen offset:64
    ds_read_b64_tr_b16 a[120:121], v2 offset:256
    ds_read_b64_tr_b16 a[122:123], v2 offset:768
    ds_read_b64_tr_b16 a[124:125], v3 offset:256
    ds_read_b64_tr_b16 a[126:127], v3 offset:768
    buffer_load_dwordx2 v[230:231], v19, s[32:35], 0 offen offset:96
    v_add_u32 v238, s53, v238
    v_lshrrev_b32 v218, 2, v0
    v_mul_u32_u24 v26, 896, v218
    v_lshl_add_u32 v26, v210, 3, v26
    s_add_u32 m0, s52, 98304
    s_add_u32 s57, s65, 10
    s_sub_u32 s3, s57, 14
    s_min_u32 s57, s57, s3
    s_mul_i32 s57, s57, 114688
    buffer_load_dwordx4 v10, s[16:19], s57 offen offset:0 lds
    v_lshrrev_b32 v218, 2, v1
    v_mul_u32_u24 v252, 176, v218
    v_lshl_add_u32 v252, v210, 3, v252
    v_add_u32 v252, s53, v252
    s_sub_u32 s53, 49152, s52
    v_add_u32 v246, s53, v2
    v_add_u32 v247, s53, v3
    v_mul_u32_u24 v218, 3072, v208
    s_add_u32 s57, s57, 27648
    buffer_load_dwordx4 v11, s[16:19], s57 offen offset:1024 lds
    s_waitcnt vmcnt(10)
    ds_read_b64_tr_b16 a[128:129], v2 offset:16384
    ds_read_b64_tr_b16 a[130:131], v2 offset:16896
    ds_read_b64_tr_b16 a[132:133], v3 offset:16384
    ds_read_b64_tr_b16 a[134:135], v3 offset:16896
    s_add_u32 s57, s57, 27648
    buffer_load_dwordx4 v10, s[16:19], s57 offen offset:2048 lds
    ds_read_b64_tr_b16 a[136:137], v2 offset:16640
    ds_read_b64_tr_b16 a[138:139], v2 offset:17152
    ds_read_b64_tr_b16 a[140:141], v3 offset:16640
    ds_read_b64_tr_b16 a[142:143], v3 offset:17152
    s_add_u32 s57, s57, 27648
    buffer_load_dwordx4 v11, s[16:19], s57 offen offset:3072 lds
    v_add_u32 v248, v218, v246
    v_add_u32 v249, v218, v247
    v_add_u32 v232, s52, v23
    v_xor_b32 v233, 4096, v232
    v_xor_b32 v234, 8192, v232
    v_xor_b32 v235, 12288, v232
    s_waitcnt lgkmcnt(15)
    s_add_u32 m0, s52, 114688
    s_add_u32 s57, s65, 11
    s_sub_u32 s3, s57, 14
    s_min_u32 s57, s57, s3
    s_mul_i32 s57, s57, 114688
    buffer_load_dwordx4 v10, s[16:19], s57 offen offset:0 lds
    s_add_u32 s57, s57, 27648
    buffer_load_dwordx4 v11, s[16:19], s57 offen offset:1024 lds
    s_waitcnt vmcnt(10)
    ds_read_b64_tr_b16 a[144:145], v2 offset:32768
    ds_read_b64_tr_b16 a[146:147], v2 offset:33280
    ds_read_b64_tr_b16 a[148:149], v3 offset:32768
    ds_read_b64_tr_b16 a[150:151], v3 offset:33280
    s_add_u32 s57, s57, 27648
    buffer_load_dwordx4 v10, s[16:19], s57 offen offset:2048 lds
    ds_read_b64_tr_b16 a[152:153], v2 offset:33024
    ds_read_b64_tr_b16 a[154:155], v2 offset:33536
    ds_read_b64_tr_b16 a[156:157], v3 offset:33024
    ds_read_b64_tr_b16 a[158:159], v3 offset:33536
    s_add_u32 s57, s57, 27648
    buffer_load_dwordx4 v11, s[16:19], s57 offen offset:3072 lds
    s_add_u32 m0, s52, 131072
    s_add_u32 s57, s65, 12
    s_sub_u32 s3, s57, 14
    s_min_u32 s57, s57, s3
    s_mul_i32 s57, s57, 114688
    buffer_load_dwordx4 v10, s[16:19], s57 offen offset:0 lds
    s_add_u32 s57, s57, 27648
    buffer_load_dwordx4 v11, s[16:19], s57 offen offset:1024 lds
    s_add_u32 s57, s57, 27648
    buffer_load_dwordx4 v10, s[16:19], s57 offen offset:2048 lds
    s_waitcnt vmcnt(11)
    v_lshlrev_b32 v32, 16, v224
    v_and_b32 v33, s61, v224
    v_lshlrev_b32 v34, 16, v225
    v_and_b32 v35, s61, v225
    v_lshlrev_b32 v36, 16, v226
    v_and_b32 v37, s61, v226
    v_lshlrev_b32 v38, 16, v227
    v_and_b32 v39, s61, v227
    s_add_u32 s57, s57, 27648
    buffer_load_dwordx4 v11, s[16:19], s57 offen offset:3072 lds
    v_lshlrev_b32 v40, 16, v228
    v_and_b32 v41, s61, v228
    v_lshlrev_b32 v42, 16, v229
    v_and_b32 v43, s61, v229
    buffer_load_dword v17, v18, s[24:27], 0 offen sc1
    v_lshlrev_b32 v44, 16, v230
    v_and_b32 v45, s61, v230
    v_lshlrev_b32 v46, 16, v231
    v_and_b32 v47, s61, v231
    v_mul_f32 v96, s85, v32
    v_mul_f32 v97, s85, v33
    v_mul_f32 v98, s85, v34
    v_mul_f32 v99, s85, v35
    s_add_u32 m0, s52, 147456
    s_add_u32 s57, s65, 13
    s_sub_u32 s3, s57, 14
    s_min_u32 s57, s57, s3
    s_mul_i32 s57, s57, 114688
    buffer_load_dwordx4 v10, s[16:19], s57 offen offset:0 lds
    s_waitcnt vmcnt(10)
    ds_read_b64_tr_b16 a[160:161], v2 offset:49152
    ds_read_b64_tr_b16 a[162:163], v2 offset:49664
    ds_read_b64_tr_b16 a[164:165], v3 offset:49152
    ds_read_b64_tr_b16 a[166:167], v3 offset:49664
    v_mul_f32 v100, s85, v36
    v_mul_f32 v101, s85, v37
    v_mul_f32 v102, s85, v38
    v_mul_f32 v103, s85, v39
    ds_read_b64_tr_b16 a[168:169], v2 offset:49408
    ds_read_b64_tr_b16 a[170:171], v2 offset:49920
    ds_read_b64_tr_b16 a[172:173], v3 offset:49408
    ds_read_b64_tr_b16 a[174:175], v3 offset:49920
    s_add_u32 s57, s57, 27648
    buffer_load_dwordx4 v11, s[16:19], s57 offen offset:1024 lds
    v_mul_f32 v104, s85, v40
    v_mul_f32 v105, s85, v41
    v_mul_f32 v106, s85, v42
    v_mul_f32 v107, s85, v43
    s_add_u32 s57, s57, 27648
    buffer_load_dwordx4 v10, s[16:19], s57 offen offset:2048 lds
    v_mul_f32 v108, s85, v44
    v_mul_f32 v109, s85, v45
    v_mul_f32 v110, s85, v46
    v_mul_f32 v111, s85, v47
    s_add_u32 s57, s57, 27648
    buffer_load_dwordx4 v11, s[16:19], s57 offen offset:3072 lds
    s_waitcnt lgkmcnt(15)
    s_add_u32 m0, s52, 49152
    s_mov_b32 s57, 1605632
    buffer_load_dwordx4 v10, s[16:19], s57 offen offset:0 lds
    s_waitcnt vmcnt(10)
    ds_read_b64_tr_b16 a[176:177], v4 offset:0
    ds_read_b64_tr_b16 a[178:179], v4 offset:512
    ds_read_b64_tr_b16 a[180:181], v5 offset:0
    ds_read_b64_tr_b16 a[182:183], v5 offset:512
    s_add_u32 s57, s57, 27648
    buffer_load_dwordx4 v11, s[16:19], s57 offen offset:1024 lds
    ds_read_b64_tr_b16 a[184:185], v4 offset:256
    ds_read_b64_tr_b16 a[186:187], v4 offset:768
    ds_read_b64_tr_b16 a[188:189], v5 offset:256
    ds_read_b64_tr_b16 a[190:191], v5 offset:768
    s_add_u32 s57, s57, 27648
    buffer_load_dwordx4 v10, s[16:19], s57 offen offset:2048 lds
    s_add_u32 s57, s57, 27648
    buffer_load_dwordx4 v11, s[16:19], s57 offen offset:3072 lds
    s_add_u32 m0, s52, 65536
    s_mov_b32 s57, 1720320
    buffer_load_dwordx4 v10, s[16:19], s57 offen offset:0 lds
    s_waitcnt vmcnt(10)
    ds_read_b64_tr_b16 a[192:193], v4 offset:16384
    ds_read_b64_tr_b16 a[194:195], v4 offset:16896
    ds_read_b64_tr_b16 a[196:197], v5 offset:16384
    ds_read_b64_tr_b16 a[198:199], v5 offset:16896
    s_add_u32 s57, s57, 27648
    buffer_load_dwordx4 v11, s[16:19], s57 offen offset:1024 lds
    ds_read_b64_tr_b16 a[200:201], v4 offset:16640
    ds_read_b64_tr_b16 a[202:203], v4 offset:17152
    ds_read_b64_tr_b16 a[204:205], v5 offset:16640
    ds_read_b64_tr_b16 a[206:207], v5 offset:17152
    s_add_u32 s57, s57, 27648
    buffer_load_dwordx4 v10, s[16:19], s57 offen offset:2048 lds
    s_waitcnt vmcnt(11)
    v_cmp_ne_u32 vcc, s47, v17
    s_nop 0
    s_cbranch_vccz L_ok5
    s_mov_b32 s59, 100000
L_spin4:
    buffer_load_dword v17, v18, s[24:27], 0 offen sc1
    s_waitcnt vmcnt(0)
    v_cmp_ne_u32 vcc, s47, v17
    s_nop 0
    s_cbranch_vccz L_ok5
    s_sub_u32 s59, s59, 1
    s_cbranch_scc0 L_spin4
L_ok5:
    s_cmp_ge_u32 s88, 4
    s_cbranch_scc1 L_p2_alt
    s_add_u32 s57, s57, 27648
    buffer_load_dwordx4 v11, s[16:19], s57 offen offset:3072 lds
    s_mov_b32 s66, s84
    s_lshl_b32 s86, s65, 10
    s_add_u32 s58, s86, s66
    s_add_u32 s86, s66, 14336
    buffer_load_dwordx4 v[112:115], v23, s[24:27], s58 offen offset:0 sc1
    s_add_u32 s58, s58, 1024
    s_cmp_eq_u32 s58, s86
    s_cselect_b32 s58, s66, s58
    buffer_load_dwordx4 v[116:119], v23, s[24:27], s58 offen offset:0 sc1
    s_waitcnt vmcnt(10)
    ds_read_b64_tr_b16 a[208:209], v4 offset:32768
    ds_read_b64_tr_b16 a[210:211], v4 offset:33280
    ds_read_b64_tr_b16 a[212:213], v5 offset:32768
    ds_read_b64_tr_b16 a[214:215], v5 offset:33280
    s_add_u32 s58, s58, 1024
    s_cmp_eq_u32 s58, s86
    s_cselect_b32 s58, s66, s58
    buffer_load_dwordx4 v[120:123], v23, s[24:27], s58 offen offset:0 sc1
    ds_read_b64_tr_b16 a[216:217], v4 offset:33024
    ds_read_b64_tr_b16 a[218:219], v4 offset:33536
    ds_read_b64_tr_b16 a[220:221], v5 offset:33024
    ds_read_b64_tr_b16 a[222:223], v5 offset:33536
    s_add_u32 s58, s58, 1024
    s_cmp_eq_u32 s58, s86
    s_cselect_b32 s58, s66, s58
    buffer_load_dwordx4 v[124:127], v23, s[24:27], s58 offen offset:0 sc1
    s_add_u32 s58, s58, 1024
    s_cmp_eq_u32 s58, s86
    s_cselect_b32 s58, s66, s58
    buffer_load_dwordx4 v[128:131], v23, s[24:27], s58 offen offset:0 sc1
    s_add_u32 s58, s58, 1024
    s_cmp_eq_u32 s58, s86
    s_cselect_b32 s58, s66, s58
    buffer_load_dwordx4 v[132:135], v23, s[24:27], s58 offen offset:0 sc1
    s_waitcnt vmcnt(10)
    ds_read_b64_tr_b16 a[224:225], v2 offset:0
    ds_read_b64_tr_b16 a[226:227], v2 offset:512
    ds_read_b64_tr_b16 a[228:229], v3 offset:0
    ds_read_b64_tr_b16 a[230:231], v3 offset:512
    s_add_u32 s58, s58, 1024
    s_cmp_eq_u32 s58, s86
    s_cselect_b32 s58, s66, s58
    buffer_load_dwordx4 v[136:139], v23, s[24:27], s58 offen offset:0 sc1
    ds_read_b64_tr_b16 a[232:233], v2 offset:256
    ds_read_b64_tr_b16 a[234:235], v2 offset:768
    ds_read_b64_tr_b16 a[236:237], v3 offset:256
    ds_read_b64_tr_b16 a[238:239], v3 offset:768
    s_add_u32 s58, s58, 1024
    s_cmp_eq_u32 s58, s86
    s_cselect_b32 s58, s66, s58
    buffer_load_dwordx4 v[140:143], v23, s[24:27], s58 offen offset:0 sc1
    s_add_u32 s58, s58, 1024
    s_cmp_eq_u32 s58, s86
    s_cselect_b32 s58, s66, s58
    buffer_load_dwordx4 v[144:147], v23, s[24:27], s58 offen offset:0 sc1
    s_add_u32 s58, s58, 1024
    s_cmp_eq_u32 s58, s86
    s_cselect_b32 s58, s66, s58
    buffer_load_dwordx4 v[148:151], v23, s[24:27], s58 offen offset:0 sc1
    s_waitcnt vmcnt(10)
    ds_read_b64_tr_b16 a[240:241], v2 offset:16384
    ds_read_b64_tr_b16 a[242:243], v2 offset:16896
    ds_read_b64_tr_b16 a[244:245], v3 offset:16384
    ds_read_b64_tr_b16 a[246:247], v3 offset:16896
    s_add_u32 s58, s58, 1024
    s_cmp_eq_u32 s58, s86
    s_cselect_b32 s58, s66, s58
    buffer_load_dwordx4 v[152:155], v23, s[24:27], s58 offen offset:0 sc1
    ds_read_b64_tr_b16 a[248:249], v2 offset:16640
    ds_read_b64_tr_b16 a[250:251], v2 offset:17152
    ds_read_b64_tr_b16 a[252:253], v3 offset:16640
    ds_read_b64_tr_b16 a[254:255], v3 offset:17152
    s_waitcnt vmcnt(10)
    v_mfma_f32_16x16x32_bf16 v[96:99], a[0:3], v[112:115], v[96:99]
    s_add_u32 s58, s58, 1024
    s_cmp_eq_u32 s58, s86
    s_cselect_b32 s58, s66, s58
    v_mfma_f32_16x16x32_bf16 v[100:103], a[4:7], v[112:115], v[100:103]
    buffer_load_dwordx4 v[156:159], v23, s[24:27], s58 offen offset:0 sc1
    v_mfma_f32_16x16x32_bf16 v[104:107], a[8:11], v[112:115], v[104:107]
    v_mfma_f32_16x16x32_bf16 v[108:111], a[12:15], v[112:115], v[108:111]
    s_waitcnt vmcnt(10)
    v_mfma_f32_16x16x32_bf16 v[96:99], a[16:19], v[116:119], v[96:99]
    s_add_u32 s58, s58, 1024
    s_cmp_eq_u32 s58, s86
    s_cselect_b32 s58, s66, s58
    v_mfma_f32_16x16x32_bf16 v[100:103], a[20:23], v[116:119], v[100:103]
    buffer_load_dwordx4 v[112:115], v23, s[24:27], s58 offen offset:0 sc1
    v_mfma_f32_16x16x32_bf16 v[104:107], a[24:27], v[116:119], v[104:107]
    v_mfma_f32_16x16x32_bf16 v[108:111], a[28:31], v[116:119], v[108:111]
    s_waitcnt vmcnt(10)
    v_mfma_f32_16x16x32_bf16 v[96:99], a[32:35], v[120:123], v[96:99]
    s_add_u32 s58, s58, 1024
    s_cmp_eq_u32 s58, s86
    s_cselect_b32 s58, s66, s58
    v_mfma_f32_16x16x32_bf16 v[100:103], a[36:39], v[120:123], v[100:103]
L_wb_0:
    s_cbranch_execz L_wb_ret
    buffer_load_dwordx4 v[116:119], v23, s[24:27], s58 offen offset:0 sc1
    v_mfma_f32_16x16x32_bf16 v[104:107], a[40:43], v[120:123], v[104:107]
    v_mfma_f32_16x16x32_bf16 v[108:111], a[44:47], v[120:123], v[108:111]
    s_waitcnt vmcnt(10)
    v_mfma_f32_16x16x32_bf16 v[96:99], a[48:51], v[124:127], v[96:99]
    s_add_u32 s58, s66, 14336
    v_mfma_f32_16x16x32_bf16 v[100:103], a[52:55], v[124:127], v[100:103]
    buffer_load_dwordx4 v[120:123], v23, s[24:27], s58 offen offset:0 sc1
    v_mfma_f32_16x16x32_bf16 v[104:107], a[56:59], v[124:127], v[104:107]
    v_mfma_f32_16x16x32_bf16 v[108:111], a[60:63], v[124:127], v[108:111]
    s_waitcnt vmcnt(10)
    v_mfma_f32_16x16x32_bf16 v[96:99], a[64:67], v[128:131], v[96:99]
    s_add_u32 s58, s66, 15360
    v_mfma_f32_16x16x32_bf16 v[100:103], a[68:71], v[128:131], v[100:103]
    buffer_load_dwordx4 v[124:127], v23, s[24:27], s58 offen offset:0 sc1
    v_mfma_f32_16x16x32_bf16 v[104:107], a[72:75], v[128:131], v[104:107]
    v_mfma_f32_16x16x32_bf16 v[108:111], a[76:79], v[128:131], v[108:111]
    s_waitcnt vmcnt(10)
    v_mfma_f32_16x16x32_bf16 v[96:99], a[80:83], v[132:135], v[96:99]
    s_xor_b32 s66, s44, 3
    s_lshl2_add_u32 s66, s51, s66
    s_mul_i32 s66, s66, 66816
    s_lshl2_add_u32 s66, s52, s66
    s_lshl_b32 s86, s65, 10
    s_add_u32 s58, s86, s66
    s_add_u32 s86, s66, 14336
    v_mfma_f32_16x16x32_bf16 v[100:103], a[84:87], v[132:135], v[100:103]
    buffer_load_dwordx4 v[128:131], v23, s[24:27], s58 offen offset:0 sc1
    v_mfma_f32_16x16x32_bf16 v[104:107], a[88:91], v[132:135], v[104:107]
    v_mfma_f32_16x16x32_bf16 v[108:111], a[92:95], v[132:135], v[108:111]
    s_waitcnt vmcnt(10)
    v_mfma_f32_16x16x32_bf16 v[96:99], a[96:99], v[136:139], v[96:99]
    s_add_u32 s58, s58, 1024
    s_cmp_eq_u32 s58, s86
    s_cselect_b32 s58, s66, s58
    v_mfma_f32_16x16x32_bf16 v[100:103], a[100:103], v[136:139], v[100:103]
    buffer_load_dwordx4 v[132:135], v23, s[24:27], s58 offen offset:0 sc1
    v_mfma_f32_16x16x32_bf16 v[104:107], a[104:107], v[136:139], v[104:107]
    v_mfma_f32_16x16x32_bf16 v[108:111], a[108:111], v[136:139], v[108:111]
    s_waitcnt vmcnt(10)
    v_mfma_f32_16x16x32_bf16 v[96:99], a[112:115], v[140:143], v[96:99]
    s_add_u32 s58, s58, 1024
    s_cmp_eq_u32 s58, s86
    s_cselect_b32 s58, s66, s58
    v_mfma_f32_16x16x32_bf16 v[100:103], a[116:119], v[140:143], v[100:103]
    buffer_load_dwordx4 v[136:139], v23, s[24:27], s58 offen offset:0 sc1
    v_mfma_f32_16x16x32_bf16 v[104:107], a[120:123], v[140:143], v[104:107]
    v_mfma_f32_16x16x32_bf16 v[108:111], a[124:127], v[140:143], v[108:111]
    s_waitcnt vmcnt(10)
    v_mfma_f32_16x16x32_bf16 v[96:99], a[128:131], v[144:147], v[96:99]
    s_add_u32 s58, s58, 1024
    s_cmp_eq_u32 s58, s86
    s_cselect_b32 s58, s66, s58
    v_mfma_f32_16x16x32_bf16 v[100:103], a[132:135], v[144:147], v[100:103]
    buffer_load_dwordx4 v[140:143], v23, s[24:27], s58 offen offset:0 sc1
    v_mfma_f32_16x16x32_bf16 v[104:107], a[136:139], v[144:147], v[104:107]
    v_mfma_f32_16x16x32_bf16 v[108:111], a[140:143], v[144:147], v[108:111]
    s_waitcnt vmcnt(10)
    s_waitcnt lgkmcnt(15)
    v_mfma_f32_16x16x32_bf16 v[96:99], a[144:147], v[148:151], v[96:99]
    s_add_u32 s58, s58, 1024
    s_cmp_eq_u32 s58, s86
    s_cselect_b32 s58, s66, s58
    v_mfma_f32_16x16x32_bf16 v[100:103], a[148:151], v[148:151], v[100:103]
    buffer_load_dwordx4 v[144:147], v23, s[24:27], s58 offen offset:0 sc1
    v_mfma_f32_16x16x32_bf16 v[104:107], a[152:155], v[148:151], v[104:107]
    v_mfma_f32_16x16x32_bf16 v[108:111], a[156:159], v[148:151], v[108:111]
    s_waitcnt vmcnt(10)
    v_mfma_f32_16x16x32_bf16 v[96:99], a[160:163], v[152:155], v[96:99]
    s_add_u32 s58, s58, 1024
    s_cmp_eq_u32 s58, s86
    s_cselect_b32 s58, s66, s58
    v_mfma_f32_16x16x32_bf16 v[100:103], a[164:167], v[152:155], v[100:103]
    buffer_load_dwordx4 v[148:151], v23, s[24:27], s58 offen offset:0 sc1
    v_mfma_f32_16x16x32_bf16 v[104:107], a[168:171], v[152:155], v[104:107]
    v_mfma_f32_16x16x32_bf16 v[108:111], a[172:175], v[152:155], v[108:111]
    s_waitcnt vmcnt(10)
    v_mfma_f32_16x16x32_bf16 v[96:99], a[176:179], v[156:159], v[96:99]
    s_add_u32 s58, s58, 1024
    s_cmp_eq_u32 s58, s86
    s_cselect_b32 s58, s66, s58
    v_mfma_f32_16x16x32_bf16 v[100:103], a[180:183], v[156:159], v[100:103]
    buffer_load_dwordx4 v[152:155], v23, s[24:27], s58 offen offset:0 sc1
    v_mfma_f32_16x16x32_bf16 v[104:107], a[184:187], v[156:159], v[104:107]
    v_mfma_f32_16x16x32_bf16 v[108:111], a[188:191], v[156:159], v[108:111]
    s_waitcnt vmcnt(10)
    v_mfma_f32_16x16x32_bf16 v[96:99], a[192:195], v[112:115], v[96:99]
    s_add_u32 s58, s58, 1024
    s_cmp_eq_u32 s58, s86
    s_cselect_b32 s58, s66, s58
    v_mfma_f32_16x16x32_bf16 v[100:103], a[196:199], v[112:115], v[100:103]
    buffer_load_dwordx4 v[156:159], v23, s[24:27], s58 offen offset:0 sc1
    v_mfma_f32_16x16x32_bf16 v[104:107], a[200:203], v[112:115], v[104:107]
    v_mfma_f32_16x16x32_bf16 v[108:111], a[204:207], v[112:115], v[108:111]
    s_waitcnt vmcnt(10)
    v_mfma_f32_16x16x32_bf16 v[96:99], a[208:211], v[116:119], v[96:99]
    s_add_u32 s58, s58, 1024
    s_cmp_eq_u32 s58, s86
    s_cselect_b32 s58, s66, s58
    v_mfma_f32_16x16x32_bf16 v[100:103], a[212:215], v[116:119], v[100:103]
    buffer_load_dwordx4 v[112:115], v23, s[24:27], s58 offen offset:0 sc1
    v_mfma_f32_16x16x32_bf16 v[104:107], a[216:219], v[116:119], v[104:107]
    v_mfma_f32_16x16x32_bf16 v[108:111], a[220:223], v[116:119], v[108:111]
    s_waitcnt vmcnt(10)
    s_waitcnt lgkmcnt(8)
    v_mfma_f32_16x16x32_bf16 v[96:99], a[224:227], v[120:123], v[96:99]
    s_add_u32 s58, s58, 1024
    s_cmp_eq_u32 s58, s86
    s_cselect_b32 s58, s66, s58
    v_mfma_f32_16x16x32_bf16 v[100:103], a[228:231], v[120:123], v[100:103]
    buffer_load_dwordx4 v[116:119], v23, s[24:27], s58 offen offset:0 sc1
    v_mfma_f32_16x16x32_bf16 v[104:107], a[232:235], v[120:123], v[104:107]
    v_mfma_f32_16x16x32_bf16 v[108:111], a[236:239], v[120:123], v[108:111]
    s_waitcnt vmcnt(10)
    s_waitcnt lgkmcnt(0)
    v_mfma_f32_16x16x32_bf16 v[96:99], a[240:243], v[124:127], v[96:99]
    s_add_u32 s58, s58, 1024
    s_cmp_eq_u32 s58, s86
    s_cselect_b32 s58, s66, s58
    v_mfma_f32_16x16x32_bf16 v[100:103], a[244:247], v[124:127], v[100:103]
    buffer_load_dwordx4 v[120:123], v23, s[24:27], s58 offen offset:0 sc1
    v_mfma_f32_16x16x32_bf16 v[104:107], a[248:251], v[124:127], v[104:107]
    v_mfma_f32_16x16x32_bf16 v[108:111], a[252:255], v[124:127], v[108:111]
L_p2_join:
    s_waitcnt vmcnt(10)
    v_mfma_f32_16x16x32_bf16 v[80:83], a[0:3], v[128:131], 0
    s_add_u32 s58, s58, 1024
    s_cmp_eq_u32 s58, s86
    s_cselect_b32 s58, s66, s58
    v_mfma_f32_16x16x32_bf16 v[84:87], a[4:7], v[128:131], 0
    buffer_load_dwordx4 v[124:127], v23, s[24:27], s58 offen offset:0 sc1
    v_mfma_f32_16x16x32_bf16 v[88:91], a[8:11], v[128:131], 0
    v_mfma_f32_16x16x32_bf16 v[92:95], a[12:15], v[128:131], 0
    s_waitcnt vmcnt(10)
    v_mfma_f32_16x16x32_bf16 v[80:83], a[16:19], v[132:135], v[80:83]
    v_mfma_f32_16x16x32_bf16 v[84:87], a[20:23], v[132:135], v[84:87]
    buffer_load_dwordx4 v[216:219], v22, s[4:7], s71 offen
    v_mfma_f32_16x16x32_bf16 v[88:91], a[24:27], v[132:135], v[88:91]
    ds_write_b128 v232, v[96:99] offset:49152
    v_mfma_f32_16x16x32_bf16 v[92:95], a[28:31], v[132:135], v[92:95]
    s_waitcnt vmcnt(10)
    v_mfma_f32_16x16x32_bf16 v[80:83], a[32:35], v[136:139], v[80:83]
    s_add_u32 s58, s58, 1024
    s_cmp_eq_u32 s58, s86
    s_cselect_b32 s58, s66, s58
    v_mfma_f32_16x16x32_bf16 v[84:87], a[36:39], v[136:139], v[84:87]
    buffer_load_dwordx4 v[128:131], v23, s[24:27], s58 offen offset:0 sc1
    v_mfma_f32_16x16x32_bf16 v[88:91], a[40:43], v[136:139], v[88:91]
    ds_write_b128 v232, v[100:103] offset:50176
    v_mfma_f32_16x16x32_bf16 v[92:95], a[44:47], v[136:139], v[92:95]
    s_waitcnt vmcnt(10)
    v_mfma_f32_16x16x32_bf16 v[80:83], a[48:51], v[140:143], v[80:83]
    v_mfma_f32_16x16x32_bf16 v[84:87], a[52:55], v[140:143], v[84:87]
    buffer_load_dwordx4 v[220:223], v22, s[4:7], s72 offen
    v_mfma_f32_16x16x32_bf16 v[88:91], a[56:59], v[140:143], v[88:91]
    ds_write_b128 v232, v[104:107] offset:51200
    v_mfma_f32_16x16x32_bf16 v[92:95], a[60:63], v[140:143], v[92:95]
    s_waitcnt vmcnt(10)
    v_mfma_f32_16x16x32_bf16 v[80:83], a[64:67], v[144:147], v[80:83]
    s_add_u32 s58, s58, 1024
    s_cmp_eq_u32 s58, s86
    s_cselect_b32 s58, s66, s58
    v_mfma_f32_16x16x32_bf16 v[84:87], a[68:71], v[144:147], v[84:87]
    buffer_load_dwordx4 v[132:135], v23, s[24:27], s58 offen offset:0 sc1
    v_mfma_f32_16x16x32_bf16 v[88:91], a[72:75], v[144:147], v[88:91]
    ds_write_b128 v232, v[108:111] offset:52224
    v_mfma_f32_16x16x32_bf16 v[92:95], a[76:79], v[144:147], v[92:95]
    s_waitcnt vmcnt(10)
    v_mfma_f32_16x16x32_bf16 v[80:83], a[80:83], v[148:151], v[80:83]
    v_mfma_f32_16x16x32_bf16 v[84:87], a[84:87], v[148:151], v[84:87]
    buffer_load_dwordx2 v[224:225], v26, s[4:7], s73 offen
    v_mfma_f32_16x16x32_bf16 v[88:91], a[88:91], v[148:151], v[88:91]
    v_mfma_f32_16x16x32_bf16 v[92:95], a[92:95], v[148:151], v[92:95]
    s_waitcnt vmcnt(10)
    v_mfma_f32_16x16x32_bf16 v[80:83], a[96:99], v[152:155], v[80:83]
    s_add_u32 s58, s66, 14336
    v_mfma_f32_16x16x32_bf16 v[84:87], a[100:103], v[152:155], v[84:87]
    buffer_load_dwordx4 v[136:139], v23, s[24:27], s58 offen offset:0 sc1
    v_mfma_f32_16x16x32_bf16 v[88:91], a[104:107], v[152:155], v[88:91]
    v_mfma_f32_16x16x32_bf16 v[92:95], a[108:111], v[152:155], v[92:95]
    s_waitcnt vmcnt(10)
    v_mfma_f32_16x16x32_bf16 v[80:83], a[112:115], v[156:159], v[80:83]
    v_mfma_f32_16x16x32_bf16 v[84:87], a[116:119], v[156:159], v[84:87]
    buffer_load_ushort v228, v25, s[36:39], s74 offen
    v_mfma_f32_16x16x32_bf16 v[88:91], a[120:123], v[156:159], v[88:91]
    s_waitcnt lgkmcnt(0)
    s_barrier
    v_mfma_f32_16x16x32_bf16 v[92:95], a[124:127], v[156:159], v[92:95]
    s_waitcnt vmcnt(10)
    v_mfma_f32_16x16x32_bf16 v[80:83], a[128:131], v[112:115], v[80:83]
    s_add_u32 s58, s66, 15360
    v_mfma_f32_16x16x32_bf16 v[84:87], a[132:135], v[112:115], v[84:87]
    buffer_load_dwordx4 v[140:143], v23, s[24:27], s58 offen offset:0 sc1
    v_mfma_f32_16x16x32_bf16 v[88:91], a[136:139], v[112:115], v[88:91]
    ds_read_b128 v[160:163], v243 offset:0
    ds_read_b128 v[164:167], v243 offset:1024
    v_mfma_f32_16x16x32_bf16 v[92:95], a[140:143], v[112:115], v[92:95]
    ds_read_b128 v[168:171], v243 offset:4096
    s_waitcnt vmcnt(10)
    v_mfma_f32_16x16x32_bf16 v[80:83], a[144:147], v[116:119], v[80:83]
    s_xor_b32 s66, s44, 2
    s_lshl2_add_u32 s66, s51, s66
    s_mul_i32 s66, s66, 66816
    s_lshl2_add_u32 s66, s52, s66
    s_lshl_b32 s86, s65, 10
    s_add_u32 s58, s86, s66
    s_add_u32 s86, s66, 14336
    v_mfma_f32_16x16x32_bf16 v[84:87], a[148:151], v[116:119], v[84:87]
    buffer_load_dwordx4 v[144:147], v23, s[24:27], s58 offen offset:0 sc1
    v_mfma_f32_16x16x32_bf16 v[88:91], a[152:155], v[116:119], v[88:91]
    ds_read_b128 v[172:175], v243 offset:5120
    ds_read_b128 v[176:179], v243 offset:8192
    v_mfma_f32_16x16x32_bf16 v[92:95], a[156:159], v[116:119], v[92:95]
    ds_read_b128 v[180:183], v243 offset:9216
    s_waitcnt vmcnt(10)
    v_mfma_f32_16x16x32_bf16 v[80:83], a[160:163], v[120:123], v[80:83]
    s_add_u32 s58, s58, 1024
    s_cmp_eq_u32 s58, s86
    s_cselect_b32 s58, s66, s58
    v_mfma_f32_16x16x32_bf16 v[84:87], a[164:167], v[120:123], v[84:87]
    buffer_load_dwordx4 v[148:151], v23, s[24:27], s58 offen offset:0 sc1
    v_mfma_f32_16x16x32_bf16 v[88:91], a[168:171], v[120:123], v[88:91]
    ds_read_b128 v[184:187], v243 offset:12288
    v_mfma_f32_16x16x32_bf16 v[92:95], a[172:175], v[120:123], v[92:95]
    ds_read_b128 v[188:191], v243 offset:13312
    s_waitcnt vmcnt(10)
    v_mfma_f32_16x16x32_bf16 v[80:83], a[176:179], v[124:127], v[80:83]
    s_add_u32 s58, s58, 1024
    s_cmp_eq_u32 s58, s86
    s_cselect_b32 s58, s66, s58
    v_mfma_f32_16x16x32_bf16 v[84:87], a[180:183], v[124:127], v[84:87]
    buffer_load_dwordx4 v[152:155], v23, s[24:27], s58 offen offset:0 sc1
    v_mfma_f32_16x16x32_bf16 v[88:91], a[184:187], v[124:127], v[88:91]
    v_mfma_f32_16x16x32_bf16 v[92:95], a[188:191], v[124:127], v[92:95]
    s_add_u32 s58, s58, 1024
    s_cmp_eq_u32 s58, s86
    s_cselect_b32 s58, s66, s58
    buffer_load_dwordx4 v[156:159], v23, s[24:27], s58 offen offset:0 sc1
    s_waitcnt vmcnt(10)
    v_mfma_f32_16x16x32_bf16 v[80:83], a[192:195], v[128:131], v[80:83]
    s_add_u32 s58, s58, 1024
    s_cmp_eq_u32 s58, s86
    s_cselect_b32 s58, s66, s58
    v_mfma_f32_16x16x32_bf16 v[84:87], a[196:199], v[128:131], v[84:87]
    buffer_load_dwordx4 v[112:115], v23, s[24:27], s58 offen offset:0 sc1
    v_mfma_f32_16x16x32_bf16 v[88:91], a[200:203], v[128:131], v[88:91]
    s_waitcnt lgkmcnt(0)
    v_add_f32 v160, v160, v168
    v_mfma_f32_16x16x32_bf16 v[92:95], a[204:207], v[128:131], v[92:95]
    v_add_f32 v161, v161, v169
    s_add_u32 s58, s58, 1024
    s_cmp_eq_u32 s58, s86
    s_cselect_b32 s58, s66, s58
    buffer_load_dwordx4 v[116:119], v23, s[24:27], s58 offen offset:0 sc1
    s_waitcnt vmcnt(10)
    v_mfma_f32_16x16x32_bf16 v[80:83], a[208:211], v[132:135], v[80:83]
    s_add_u32 s58, s58, 1024
    s_cmp_eq_u32 s58, s86
    s_cselect_b32 s58, s66, s58
    v_mfma_f32_16x16x32_bf16 v[84:87], a[212:215], v[132:135], v[84:87]
    buffer_load_dwordx4 v[120:123], v23, s[24:27], s58 offen offset:0 sc1
    v_mfma_f32_16x16x32_bf16 v[88:91], a[216:219], v[132:135], v[88:91]
    v_add_f32 v162, v162, v170
    v_add_f32 v163, v163, v171
    v_mfma_f32_16x16x32_bf16 v[92:95], a[220:223], v[132:135], v[92:95]
    v_add_f32 v164, v164, v172
    s_add_u32 s58, s58, 1024
    s_cmp_eq_u32 s58, s86
    s_cselect_b32 s58, s66, s58
    buffer_load_dwordx4 v[124:127], v23, s[24:27], s58 offen offset:0 sc1
    s_waitcnt vmcnt(10)
    v_mfma_f32_16x16x32_bf16 v[80:83], a[224:227], v[136:139], v[80:83]
    s_add_u32 s58, s58, 1024
    s_cmp_eq_u32 s58, s86
    s_cselect_b32 s58, s66, s58
    v_mfma_f32_16x16x32_bf16 v[84:87], a[228:231], v[136:139], v[84:87]
    buffer_load_dwordx4 v[128:131], v23, s[24:27], s58 offen offset:0 sc1
    v_mfma_f32_16x16x32_bf16 v[88:91], a[232:235], v[136:139], v[88:91]
    v_add_f32 v165, v165, v173
    v_add_f32 v166, v166, v174
    v_mfma_f32_16x16x32_bf16 v[92:95], a[236:239], v[136:139], v[92:95]
    v_add_f32 v167, v167, v175
    s_add_u32 s58, s58, 1024
    s_cmp_eq_u32 s58, s86
    s_cselect_b32 s58, s66, s58
    buffer_load_dwordx4 v[132:135], v23, s[24:27], s58 offen offset:0 sc1
    s_waitcnt vmcnt(10)
    v_mfma_f32_16x16x32_bf16 v[80:83], a[240:243], v[140:143], v[80:83]
    s_add_u32 s58, s58, 1024
    s_cmp_eq_u32 s58, s86
    s_cselect_b32 s58, s66, s58
    v_mfma_f32_16x16x32_bf16 v[84:87], a[244:247], v[140:143], v[84:87]
    buffer_load_dwordx4 v[136:139], v23, s[24:27], s58 offen offset:0 sc1
    v_mfma_f32_16x16x32_bf16 v[88:91], a[248:251], v[140:143], v[88:91]
    v_add_f32 v160, v160, v176
    v_add_f32 v161, v161, v177
    v_mfma_f32_16x16x32_bf16 v[92:95], a[252:255], v[140:143], v[92:95]
    v_add_f32 v162, v162, v178
    s_waitcnt vmcnt(10)
    v_mfma_f32_16x16x32_bf16 v[64:67], a[0:3], v[144:147], 0
    s_add_u32 s58, s58, 1024
    s_cmp_eq_u32 s58, s86
    s_cselect_b32 s58, s66, s58
    v_mfma_f32_16x16x32_bf16 v[68:71], a[4:7], v[144:147], 0
    buffer_load_dwordx4 v[140:143], v23, s[24:27], s58 offen offset:0 sc1
    v_mfma_f32_16x16x32_bf16 v[72:75], a[8:11], v[144:147], 0
    v_mfma_f32_16x16x32_bf16 v[76:79], a[12:15], v[144:147], 0
    s_waitcnt vmcnt(10)
    v_mfma_f32_16x16x32_bf16 v[64:67], a[16:19], v[148:151], v[64:67]
    s_add_u32 s58, s58, 1024
    s_cmp_eq_u32 s58, s86
    s_cselect_b32 s58, s66, s58
    v_mfma_f32_16x16x32_bf16 v[68:71], a[20:23], v[148:151], v[68:71]
    buffer_load_dwordx4 v[144:147], v23, s[24:27], s58 offen offset:0 sc1
    v_mfma_f32_16x16x32_bf16 v[72:75], a[24:27], v[148:151], v[72:75]
    ds_write_b128 v232, v[80:83] offset:32768
    v_mfma_f32_16x16x32_bf16 v[76:79], a[28:31], v[148:151], v[76:79]
    s_waitcnt vmcnt(10)
    v_mfma_f32_16x16x32_bf16 v[64:67], a[32:35], v[152:155], v[64:67]
    s_add_u32 s58, s58, 1024
    s_cmp_eq_u32 s58, s86
    s_cselect_b32 s58, s66, s58
    v_mfma_f32_16x16x32_bf16 v[68:71], a[36:39], v[152:155], v[68:71]
    buffer_load_dwordx4 v[148:151], v23, s[24:27], s58 offen offset:0 sc1
    v_mfma_f32_16x16x32_bf16 v[72:75], a[40:43], v[152:155], v[72:75]
    ds_write_b128 v232, v[84:87] offset:33792
    v_mfma_f32_16x16x32_bf16 v[76:79], a[44:47], v[152:155], v[76:79]
    s_waitcnt vmcnt(10)
    v_mfma_f32_16x16x32_bf16 v[64:67], a[48:51], v[156:159], v[64:67]
    s_add_u32 s58, s66, 14336
    ds_write_b128 v232, v[88:91] offset:34816
    v_mfma_f32_16x16x32_bf16 v[68:71], a[52:55], v[156:159], v[68:71]
    buffer_load_dwordx4 v[152:155], v23, s[24:27], s58 offen offset:0 sc1
    v_mfma_f32_16x16x32_bf16 v[72:75], a[56:59], v[156:159], v[72:75]
    v_add_f32 v163, v163, v179
    v_add_f32 v164, v164, v180
    v_mfma_f32_16x16x32_bf16 v[76:79], a[60:63], v[156:159], v[76:79]
    v_add_f32 v165, v165, v181
    s_waitcnt vmcnt(10)
    v_mfma_f32_16x16x32_bf16 v[64:67], a[64:67], v[112:115], v[64:67]
    s_add_u32 s58, s66, 15360
    ds_write_b128 v232, v[92:95] offset:35840
    v_mfma_f32_16x16x32_bf16 v[68:71], a[68:71], v[112:115], v[68:71]
    buffer_load_dwordx4 v[156:159], v23, s[24:27], s58 offen offset:0 sc1
    v_mfma_f32_16x16x32_bf16 v[72:75], a[72:75], v[112:115], v[72:75]
    v_add_f32 v166, v166, v182
    v_add_f32 v167, v167, v183
    v_mfma_f32_16x16x32_bf16 v[76:79], a[76:79], v[112:115], v[76:79]
    v_add_f32 v160, v160, v184
    s_waitcnt vmcnt(10)
    v_mfma_f32_16x16x32_bf16 v[64:67], a[80:83], v[116:119], v[64:67]
    s_xor_b32 s66, s44, 1
    s_lshl2_add_u32 s66, s51, s66
    s_mul_i32 s66, s66, 66816
    s_lshl2_add_u32 s66, s52, s66
    s_lshl_b32 s86, s65, 10
    s_add_u32 s58, s86, s66
    s_add_u32 s86, s66, 14336
    v_mfma_f32_16x16x32_bf16 v[68:71], a[84:87], v[116:119], v[68:71]
    buffer_load_dwordx4 v[112:115], v23, s[24:27], s58 offen offset:0 sc1
    v_mfma_f32_16x16x32_bf16 v[72:75], a[88:91], v[116:119], v[72:75]
    v_add_f32 v161, v161, v185
    v_add_f32 v162, v162, v186
    v_mfma_f32_16x16x32_bf16 v[76:79], a[92:95], v[116:119], v[76:79]
    v_add_f32 v163, v163, v187
    s_waitcnt vmcnt(10)
    v_mfma_f32_16x16x32_bf16 v[64:67], a[96:99], v[120:123], v[64:67]
    s_add_u32 s58, s58, 1024
    s_cmp_eq_u32 s58, s86
    s_cselect_b32 s58, s66, s58
    v_mfma_f32_16x16x32_bf16 v[68:71], a[100:103], v[120:123], v[68:71]
    buffer_load_dwordx4 v[116:119], v23, s[24:27], s58 offen offset:0 sc1
    v_mfma_f32_16x16x32_bf16 v[72:75], a[104:107], v[120:123], v[72:75]
    v_add_f32 v164, v164, v188
    v_add_f32 v165, v165, v189
    v_mfma_f32_16x16x32_bf16 v[76:79], a[108:111], v[120:123], v[76:79]
    v_add_f32 v166, v166, v190
    s_waitcnt vmcnt(10)
    v_mfma_f32_16x16x32_bf16 v[64:67], a[112:115], v[124:127], v[64:67]
    s_add_u32 s58, s58, 1024
    s_cmp_eq_u32 s58, s86
    s_cselect_b32 s58, s66, s58
    v_mfma_f32_16x16x32_bf16 v[68:71], a[116:119], v[124:127], v[68:71]
    buffer_load_dwordx4 v[120:123], v23, s[24:27], s58 offen offset:0 sc1
    v_mfma_f32_16x16x32_bf16 v[72:75], a[120:123], v[124:127], v[72:75]
    v_add_f32 v167, v167, v191
    v_mul_f32 v192, v160, v160
    v_mfma_f32_16x16x32_bf16 v[76:79], a[124:127], v[124:127], v[76:79]
    v_mul_f32 v193, v161, v161
    s_waitcnt vmcnt(10)
    v_mfma_f32_16x16x32_bf16 v[64:67], a[128:131], v[128:131], v[64:67]
    s_add_u32 s58, s58, 1024
    s_cmp_eq_u32 s58, s86
    s_cselect_b32 s58, s66, s58
    v_mfma_f32_16x16x32_bf16 v[68:71], a[132:135], v[128:131], v[68:71]
    buffer_load_dwordx4 v[124:127], v23, s[24:27], s58 offen offset:0 sc1
    v_mfma_f32_16x16x32_bf16 v[72:75], a[136:139], v[128:131], v[72:75]
    v_mul_f32 v194, v162, v162
    v_mul_f32 v195, v163, v163
    v_mfma_f32_16x16x32_bf16 v[76:79], a[140:143], v[128:131], v[76:79]
    v_mul_f32 v196, v164, v164
    s_waitcnt vmcnt(10)
    v_mfma_f32_16x16x32_bf16 v[64:67], a[144:147], v[132:135], v[64:67]
    s_add_u32 s58, s58, 1024
    s_cmp_eq_u32 s58, s86
    s_cselect_b32 s58, s66, s58
    v_mfma_f32_16x16x32_bf16 v[68:71], a[148:151], v[132:135], v[68:71]
    buffer_load_dwordx4 v[128:131], v23, s[24:27], s58 offen offset:0 sc1
    v_mfma_f32_16x16x32_bf16 v[72:75], a[152:155], v[132:135], v[72:75]
    v_mul_f32 v197, v165, v165
    v_mul_f32 v198, v166, v166
    v_mfma_f32_16x16x32_bf16 v[76:79], a[156:159], v[132:135], v[76:79]
    v_mul_f32 v199, v167, v167
    ds_write_b128 v244, v[216:219]
    s_waitcnt vmcnt(10)
    v_mfma_f32_16x16x32_bf16 v[64:67], a[160:163], v[136:139], v[64:67]
    s_add_u32 s58, s58, 1024
    s_cmp_eq_u32 s58, s86
    s_cselect_b32 s58, s66, s58
    v_mfma_f32_16x16x32_bf16 v[68:71], a[164:167], v[136:139], v[68:71]
    buffer_load_dwordx4 v[132:135], v23, s[24:27], s58 offen offset:0 sc1
    v_mfma_f32_16x16x32_bf16 v[72:75], a[168:171], v[136:139], v[72:75]
    v_fma_f32 v192, v192, v236, v237
    v_fma_f32 v193, v193, v236, v237
    v_mfma_f32_16x16x32_bf16 v[76:79], a[172:175], v[136:139], v[76:79]
    v_fma_f32 v194, v194, v236, v237
    s_waitcnt vmcnt(10)
    v_mfma_f32_16x16x32_bf16 v[64:67], a[176:179], v[140:143], v[64:67]
    s_add_u32 s58, s58, 1024
    s_cmp_eq_u32 s58, s86
    s_cselect_b32 s58, s66, s58
    v_mfma_f32_16x16x32_bf16 v[68:71], a[180:183], v[140:143], v[68:71]
    buffer_load_dwordx4 v[136:139], v23, s[24:27], s58 offen offset:0 sc1
    v_mfma_f32_16x16x32_bf16 v[72:75], a[184:187], v[140:143], v[72:75]
    v_fma_f32 v195, v195, v236, v237
    v_fma_f32 v196, v196, v236, v237
    v_mfma_f32_16x16x32_bf16 v[76:79], a[188:191], v[140:143], v[76:79]
    v_fma_f32 v197, v197, v236, v237
    ds_write_b128 v244, v[220:223] offset:1408
    s_waitcnt vmcnt(10)
    v_mfma_f32_16x16x32_bf16 v[64:67], a[192:195], v[144:147], v[64:67]
    s_add_u32 s58, s58, 1024
    s_cmp_eq_u32 s58, s86
    s_cselect_b32 s58, s66, s58
    v_mfma_f32_16x16x32_bf16 v[68:71], a[196:199], v[144:147], v[68:71]
    buffer_load_dwordx4 v[140:143], v23, s[24:27], s58 offen offset:0 sc1
    v_mfma_f32_16x16x32_bf16 v[72:75], a[200:203], v[144:147], v[72:75]
    v_fma_f32 v198, v198, v236, v237
    v_fma_f32 v199, v199, v236, v237
    v_mfma_f32_16x16x32_bf16 v[76:79], a[204:207], v[144:147], v[76:79]
    v_mul_f32 v192, v192, v160
    s_waitcnt vmcnt(10)
    v_mfma_f32_16x16x32_bf16 v[64:67], a[208:211], v[148:151], v[64:67]
    s_add_u32 s58, s58, 1024
    s_cmp_eq_u32 s58, s86
    s_cselect_b32 s58, s66, s58
    v_mfma_f32_16x16x32_bf16 v[68:71], a[212:215], v[148:151], v[68:71]
    buffer_load_dwordx4 v[144:147], v23, s[24:27], s58 offen offset:0 sc1
    v_mfma_f32_16x16x32_bf16 v[72:75], a[216:219], v[148:151], v[72:75]
    v_mul_f32 v193, v193, v161
    v_mul_f32 v194, v194, v162
    v_mfma_f32_16x16x32_bf16 v[76:79], a[220:223], v[148:151], v[76:79]
    v_mul_f32 v195, v195, v163
    ds_write_b64 v252, v[224:225] offset:128
    s_waitcnt vmcnt(10)
    v_mfma_f32_16x16x32_bf16 v[64:67], a[224:227], v[152:155], v[64:67]
    s_add_u32 s58, s58, 1024
    s_cmp_eq_u32 s58, s86
    s_cselect_b32 s58, s66, s58
    v_mfma_f32_16x16x32_bf16 v[68:71], a[228:231], v[152:155], v[68:71]
    buffer_load_dwordx4 v[148:151], v23, s[24:27], s58 offen offset:0 sc1
    v_mfma_f32_16x16x32_bf16 v[72:75], a[232:235], v[152:155], v[72:75]
    v_mul_f32 v196, v196, v164
    v_mul_f32 v197, v197, v165
    v_mfma_f32_16x16x32_bf16 v[76:79], a[236:239], v[152:155], v[76:79]
    v_mul_f32 v198, v198, v166
    s_waitcnt vmcnt(10)
    v_mfma_f32_16x16x32_bf16 v[64:67], a[240:243], v[156:159], v[64:67]
    s_add_u32 s58, s58, 1024
    s_cmp_eq_u32 s58, s86
    s_cselect_b32 s58, s66, s58
    v_mfma_f32_16x16x32_bf16 v[68:71], a[244:247], v[156:159], v[68:71]
    buffer_load_dwordx4 v[152:155], v23, s[24:27], s58 offen offset:0 sc1
    v_mfma_f32_16x16x32_bf16 v[72:75], a[248:251], v[156:159], v[72:75]
    v_mul_f32 v199, v199, v167
    v_mfma_f32_16x16x32_bf16 v[76:79], a[252:255], v[156:159], v[76:79]
    ds_read_b64 v[216:217], v238 offset:0
    ds_read_b64 v[218:219], v238 offset:32
    ds_read_b64 v[220:221], v238 offset:64
    ds_read_b64 v[222:223], v238 offset:96
    ds_read_b64 v[224:225], v238 offset:128
    s_waitcnt vmcnt(10)
    v_mfma_f32_16x16x32_bf16 v[48:51], a[0:3], v[112:115], 0
    s_add_u32 s58, s58, 1024
    s_cmp_eq_u32 s58, s86
    s_cselect_b32 s58, s66, s58
    v_mfma_f32_16x16x32_bf16 v[52:55], a[4:7], v[112:115], 0
    buffer_load_dwordx4 v[156:159], v23, s[24:27], s58 offen offset:0 sc1
    v_mfma_f32_16x16x32_bf16 v[56:59], a[8:11], v[112:115], 0
    v_mfma_f32_16x16x32_bf16 v[60:63], a[12:15], v[112:115], 0
    s_waitcnt vmcnt(10)
    v_mfma_f32_16x16x32_bf16 v[48:51], a[16:19], v[116:119], v[48:51]
    s_add_u32 s58, s58, 1024
    s_cmp_eq_u32 s58, s86
    s_cselect_b32 s58, s66, s58
    v_mfma_f32_16x16x32_bf16 v[52:55], a[20:23], v[116:119], v[52:55]
    buffer_load_dwordx4 v[112:115], v23, s[24:27], s58 offen offset:0 sc1
    v_mfma_f32_16x16x32_bf16 v[56:59], a[24:27], v[116:119], v[56:59]
    ds_write_b128 v232, v[64:67] offset:16384
    v_mfma_f32_16x16x32_bf16 v[60:63], a[28:31], v[116:119], v[60:63]
    s_waitcnt vmcnt(10)
    v_mfma_f32_16x16x32_bf16 v[48:51], a[32:35], v[120:123], v[48:51]
    s_add_u32 s58, s58, 1024
    s_cmp_eq_u32 s58, s86
    s_cselect_b32 s58, s66, s58
    v_mfma_f32_16x16x32_bf16 v[52:55], a[36:39], v[120:123], v[52:55]
    buffer_load_dwordx4 v[116:119], v23, s[24:27], s58 offen offset:0 sc1
    v_mfma_f32_16x16x32_bf16 v[56:59], a[40:43], v[120:123], v[56:59]
    ds_write_b128 v232, v[68:71] offset:17408
    v_mfma_f32_16x16x32_bf16 v[60:63], a[44:47], v[120:123], v[60:63]
    s_waitcnt vmcnt(10)
    v_mfma_f32_16x16x32_bf16 v[48:51], a[48:51], v[124:127], v[48:51]
    s_add_u32 s58, s66, 14336
    ds_write_b128 v232, v[72:75] offset:18432
    v_mfma_f32_16x16x32_bf16 v[52:55], a[52:55], v[124:127], v[52:55]
    buffer_load_dwordx4 v[120:123], v23, s[24:27], s58 offen offset:0 sc1
    v_mfma_f32_16x16x32_bf16 v[56:59], a[56:59], v[124:127], v[56:59]
    v_exp_f32 v192, v192
    v_exp_f32 v193, v193
    v_mfma_f32_16x16x32_bf16 v[60:63], a[60:63], v[124:127], v[60:63]
    v_exp_f32 v194, v194
    s_waitcnt vmcnt(10)
    v_mfma_f32_16x16x32_bf16 v[48:51], a[64:67], v[128:131], v[48:51]
    s_add_u32 s58, s66, 15360
    ds_write_b128 v232, v[76:79] offset:19456
    v_mfma_f32_16x16x32_bf16 v[52:55], a[68:71], v[128:131], v[52:55]
    buffer_load_dwordx4 v[124:127], v23, s[24:27], s58 offen offset:0 sc1
    v_mfma_f32_16x16x32_bf16 v[56:59], a[72:75], v[128:131], v[56:59]
    v_exp_f32 v195, v195
    v_exp_f32 v196, v196
    v_mfma_f32_16x16x32_bf16 v[60:63], a[76:79], v[128:131], v[60:63]
    v_exp_f32 v197, v197
    s_waitcnt vmcnt(10)
    v_mfma_f32_16x16x32_bf16 v[48:51], a[80:83], v[132:135], v[48:51]
    s_xor_b32 s66, s44, 0
    s_lshl2_add_u32 s66, s51, s66
    s_mul_i32 s66, s66, 66816
    s_lshl2_add_u32 s66, s52, s66
    s_lshl_b32 s86, s65, 10
    s_add_u32 s58, s86, s66
    s_add_u32 s86, s66, 14336
    v_mfma_f32_16x16x32_bf16 v[52:55], a[84:87], v[132:135], v[52:55]
    buffer_load_dwordx4 v[128:131], v23, s[24:27], s58 offen offset:0 sc1
    v_mfma_f32_16x16x32_bf16 v[56:59], a[88:91], v[132:135], v[56:59]
    v_exp_f32 v198, v198
    v_exp_f32 v199, v199
    v_mfma_f32_16x16x32_bf16 v[60:63], a[92:95], v[132:135], v[60:63]
    v_add_f32 v192, 1.0, v192
    s_waitcnt vmcnt(10)
    v_mfma_f32_16x16x32_bf16 v[48:51], a[96:99], v[136:139], v[48:51]
    s_add_u32 s58, s58, 1024
    s_cmp_eq_u32 s58, s86
    s_cselect_b32 s58, s66, s58
    v_mfma_f32_16x16x32_bf16 v[52:55], a[100:103], v[136:139], v[52:55]
    buffer_load_dwordx4 v[132:135], v23, s[24:27], s58 offen offset:0 sc1
    v_mfma_f32_16x16x32_bf16 v[56:59], a[104:107], v[136:139], v[56:59]
    v_add_f32 v193, 1.0, v193
    v_add_f32 v194, 1.0, v194
    v_mfma_f32_16x16x32_bf16 v[60:63], a[108:111], v[136:139], v[60:63]
    v_add_f32 v195, 1.0, v195
    s_waitcnt vmcnt(10)
    v_mfma_f32_16x16x32_bf16 v[48:51], a[112:115], v[140:143], v[48:51]
    s_add_u32 s58, s58, 1024
    s_cmp_eq_u32 s58, s86
    s_cselect_b32 s58, s66, s58
    v_mfma_f32_16x16x32_bf16 v[52:55], a[116:119], v[140:143], v[52:55]
    buffer_load_dwordx4 v[136:139], v23, s[24:27], s58 offen offset:0 sc1
    v_mfma_f32_16x16x32_bf16 v[56:59], a[120:123], v[140:143], v[56:59]
    v_add_f32 v196, 1.0, v196
    v_add_f32 v197, 1.0, v197
    v_mfma_f32_16x16x32_bf16 v[60:63], a[124:127], v[140:143], v[60:63]
    v_add_f32 v198, 1.0, v198
    s_waitcnt vmcnt(10)
    v_mfma_f32_16x16x32_bf16 v[48:51], a[128:131], v[144:147], v[48:51]
    s_add_u32 s58, s58, 1024
    s_cmp_eq_u32 s58, s86
    s_cselect_b32 s58, s66, s58
    v_mfma_f32_16x16x32_bf16 v[52:55], a[132:135], v[144:147], v[52:55]
    buffer_load_dwordx4 v[140:143], v23, s[24:27], s58 offen offset:0 sc1
    v_mfma_f32_16x16x32_bf16 v[56:59], a[136:139], v[144:147], v[56:59]
    v_add_f32 v199, 1.0, v199
    v_rcp_f32 v192, v192
    v_mfma_f32_16x16x32_bf16 v[60:63], a[140:143], v[144:147], v[60:63]
    v_rcp_f32 v193, v193
    s_waitcnt vmcnt(10)
    v_mfma_f32_16x16x32_bf16 v[48:51], a[144:147], v[148:151], v[48:51]
    s_add_u32 s58, s58, 1024
    s_cmp_eq_u32 s58, s86
    s_cselect_b32 s58, s66, s58
    v_mfma_f32_16x16x32_bf16 v[52:55], a[148:151], v[148:151], v[52:55]
    buffer_load_dwordx4 v[144:147], v23, s[24:27], s58 offen offset:0 sc1
    v_mfma_f32_16x16x32_bf16 v[56:59], a[152:155], v[148:151], v[56:59]
    v_rcp_f32 v194, v194
    v_rcp_f32 v195, v195
    v_mfma_f32_16x16x32_bf16 v[60:63], a[156:159], v[148:151], v[60:63]
    v_rcp_f32 v196, v196
    s_waitcnt vmcnt(10)
    v_mfma_f32_16x16x32_bf16 v[48:51], a[160:163], v[152:155], v[48:51]
    s_add_u32 s58, s58, 1024
    s_cmp_eq_u32 s58, s86
    s_cselect_b32 s58, s66, s58
    v_mfma_f32_16x16x32_bf16 v[52:55], a[164:167], v[152:155], v[52:55]
    buffer_load_dwordx4 v[148:151], v23, s[24:27], s58 offen offset:0 sc1
    v_mfma_f32_16x16x32_bf16 v[56:59], a[168:171], v[152:155], v[56:59]
    v_rcp_f32 v197, v197
    v_rcp_f32 v198, v198
    v_mfma_f32_16x16x32_bf16 v[60:63], a[172:175], v[152:155], v[60:63]
    v_rcp_f32 v199, v199
    s_waitcnt vmcnt(10)
    v_mfma_f32_16x16x32_bf16 v[48:51], a[176:179], v[156:159], v[48:51]
    s_add_u32 s58, s58, 1024
    s_cmp_eq_u32 s58, s86
    s_cselect_b32 s58, s66, s58
    v_mfma_f32_16x16x32_bf16 v[52:55], a[180:183], v[156:159], v[52:55]
    buffer_load_dwordx4 v[152:155], v23, s[24:27], s58 offen offset:0 sc1
    v_mfma_f32_16x16x32_bf16 v[56:59], a[184:187], v[156:159], v[56:59]
    v_mul_f32 v192, v192, v160
    v_mul_f32 v193, v193, v161
    v_mfma_f32_16x16x32_bf16 v[60:63], a[188:191], v[156:159], v[60:63]
    v_mul_f32 v194, v194, v162
    s_waitcnt vmcnt(10)
    v_mfma_f32_16x16x32_bf16 v[48:51], a[192:195], v[112:115], v[48:51]
    s_add_u32 s58, s58, 1024
L_wb_1:
    s_cbranch_execz L_wb_ret
    s_cmp_eq_u32 s58, s86
    s_cselect_b32 s58, s66, s58
    v_mfma_f32_16x16x32_bf16 v[52:55], a[196:199], v[112:115], v[52:55]
    buffer_load_dwordx4 v[156:159], v23, s[24:27], s58 offen offset:0 sc1
    v_mfma_f32_16x16x32_bf16 v[56:59], a[200:203], v[112:115], v[56:59]
    v_mul_f32 v195, v195, v163
    v_mul_f32 v196, v196, v164
    v_mfma_f32_16x16x32_bf16 v[60:63], a[204:207], v[112:115], v[60:63]
    v_mul_f32 v197, v197, v165
    s_waitcnt vmcnt(10)
    v_mfma_f32_16x16x32_bf16 v[48:51], a[208:211], v[116:119], v[48:51]
    s_add_u32 s58, s58, 1024
    s_cmp_eq_u32 s58, s86
    s_cselect_b32 s58, s66, s58
    v_mfma_f32_16x16x32_bf16 v[52:55], a[212:215], v[116:119], v[52:55]
    buffer_load_dwordx4 v[112:115], v23, s[24:27], s58 offen offset:0 sc1
    v_mfma_f32_16x16x32_bf16 v[56:59], a[216:219], v[116:119], v[56:59]
    v_mul_f32 v198, v198, v166
    v_mul_f32 v199, v199, v167
    v_mfma_f32_16x16x32_bf16 v[60:63], a[220:223], v[116:119], v[60:63]
    v_cvt_pk_bf16_f32 v96, v192, v193
    s_waitcnt vmcnt(10)
    v_mfma_f32_16x16x32_bf16 v[48:51], a[224:227], v[120:123], v[48:51]
    s_add_u32 s58, s58, 1024
    s_cmp_eq_u32 s58, s86
    s_cselect_b32 s58, s66, s58
    v_mfma_f32_16x16x32_bf16 v[52:55], a[228:231], v[120:123], v[52:55]
    buffer_load_dwordx4 v[116:119], v23, s[24:27], s58 offen offset:0 sc1
    v_mfma_f32_16x16x32_bf16 v[56:59], a[232:235], v[120:123], v[56:59]
    v_cvt_pk_bf16_f32 v97, v194, v195
    v_cvt_pk_bf16_f32 v98, v196, v197
    v_mfma_f32_16x16x32_bf16 v[60:63], a[236:239], v[120:123], v[60:63]
    v_cvt_pk_bf16_f32 v99, v198, v199
    s_waitcnt vmcnt(10)
    v_mfma_f32_16x16x32_bf16 v[48:51], a[240:243], v[124:127], v[48:51]
    s_add_u32 s58, s58, 1024
    s_cmp_eq_u32 s58, s86
    s_cselect_b32 s58, s66, s58
    v_mfma_f32_16x16x32_bf16 v[52:55], a[244:247], v[124:127], v[52:55]
    buffer_load_dwordx4 v[120:123], v23, s[24:27], s58 offen offset:0 sc1
    v_mfma_f32_16x16x32_bf16 v[56:59], a[248:251], v[124:127], v[56:59]
    v_mfma_f32_16x16x32_bf16 v[60:63], a[252:255], v[124:127], v[60:63]
    s_waitcnt vmcnt(10)
    v_mfma_f32_16x16x32_bf16 v[32:35], a[0:3], v[128:131], v[32:35]
    s_add_u32 s58, s58, 1024
    s_cmp_eq_u32 s58, s86
    s_cselect_b32 s58, s66, s58
    v_mfma_f32_16x16x32_bf16 v[36:39], a[4:7], v[128:131], v[36:39]
    buffer_load_dwordx4 v[124:127], v23, s[24:27], s58 offen offset:0 sc1
    v_mfma_f32_16x16x32_bf16 v[40:43], a[8:11], v[128:131], v[40:43]
    v_mfma_f32_16x16x32_bf16 v[44:47], a[12:15], v[128:131], v[44:47]
    s_waitcnt vmcnt(10)
    v_mfma_f32_16x16x32_bf16 v[32:35], a[16:19], v[132:135], v[32:35]
    s_add_u32 s58, s58, 1024
    s_cmp_eq_u32 s58, s86
    s_cselect_b32 s58, s66, s58
    v_mfma_f32_16x16x32_bf16 v[36:39], a[20:23], v[132:135], v[36:39]
    buffer_load_dwordx4 v[128:131], v23, s[24:27], s58 offen offset:0 sc1
    v_mfma_f32_16x16x32_bf16 v[40:43], a[24:27], v[132:135], v[40:43]
    ds_write_b128 v232, v[48:51] offset:0
    v_mfma_f32_16x16x32_bf16 v[44:47], a[28:31], v[132:135], v[44:47]
    ds_write_b128 v232, v[52:55] offset:1024
    s_waitcnt vmcnt(10)
    v_mfma_f32_16x16x32_bf16 v[32:35], a[32:35], v[136:139], v[32:35]
    s_add_u32 s58, s58, 1024
    s_cmp_eq_u32 s58, s86
    s_cselect_b32 s58, s66, s58
    v_mfma_f32_16x16x32_bf16 v[36:39], a[36:39], v[136:139], v[36:39]
    buffer_load_dwordx4 v[132:135], v23, s[24:27], s58 offen offset:0 sc1
    v_mfma_f32_16x16x32_bf16 v[40:43], a[40:43], v[136:139], v[40:43]
    ds_write_b128 v232, v[56:59] offset:2048
    v_mfma_f32_16x16x32_bf16 v[44:47], a[44:47], v[136:139], v[44:47]
    ds_write_b128 v232, v[60:63] offset:3072
    s_waitcnt vmcnt(10)
    v_mfma_f32_16x16x32_bf16 v[32:35], a[48:51], v[140:143], v[32:35]
    s_add_u32 s58, s66, 14336
    v_mfma_f32_16x16x32_bf16 v[36:39], a[52:55], v[140:143], v[36:39]
    buffer_load_dwordx4 v[136:139], v23, s[24:27], s58 offen offset:0 sc1
    v_mfma_f32_16x16x32_bf16 v[40:43], a[56:59], v[140:143], v[40:43]
    v_mfma_f32_16x16x32_bf16 v[44:47], a[60:63], v[140:143], v[44:47]
    s_waitcnt vmcnt(10)
    v_mfma_f32_16x16x32_bf16 v[32:35], a[64:67], v[144:147], v[32:35]
    s_add_u32 s58, s66, 15360
    v_mfma_f32_16x16x32_bf16 v[36:39], a[68:71], v[144:147], v[36:39]
    buffer_load_dwordx4 v[140:143], v23, s[24:27], s58 offen offset:0 sc1
    v_mfma_f32_16x16x32_bf16 v[40:43], a[72:75], v[144:147], v[40:43]
    v_mfma_f32_16x16x32_bf16 v[44:47], a[76:79], v[144:147], v[44:47]
    s_waitcnt vmcnt(10)
    v_mfma_f32_16x16x32_bf16 v[32:35], a[80:83], v[148:151], v[32:35]
    s_add_u32 m0, s52, 81920
    s_lshl_b32 s57, s76, 7
    v_mfma_f32_16x16x32_bf16 v[36:39], a[84:87], v[148:151], v[36:39]
    buffer_load_dwordx4 v12, s[20:23], s57 offen offset:0 lds
    v_mfma_f32_16x16x32_bf16 v[40:43], a[88:91], v[148:151], v[40:43]
    s_waitcnt lgkmcnt(0)
    s_barrier
    v_mfma_f32_16x16x32_bf16 v[44:47], a[92:95], v[148:151], v[44:47]
    s_waitcnt vmcnt(10)
    v_mfma_f32_16x16x32_bf16 v[32:35], a[96:99], v[152:155], v[32:35]
    s_add_u32 s57, s57, 31744
    v_mfma_f32_16x16x32_bf16 v[36:39], a[100:103], v[152:155], v[36:39]
    buffer_load_dwordx4 v12, s[20:23], s57 offen offset:1024 lds
    v_mfma_f32_16x16x32_bf16 v[40:43], a[104:107], v[152:155], v[40:43]
    ds_read_b128 v[160:163], v233 offset:0
    ds_read_b128 v[176:179], v234 offset:16384
    v_mfma_f32_16x16x32_bf16 v[44:47], a[108:111], v[152:155], v[44:47]
    ds_read_b128 v[192:195], v235 offset:32768
    s_waitcnt vmcnt(10)
    v_mfma_f32_16x16x32_bf16 v[32:35], a[112:115], v[156:159], v[32:35]
    s_add_u32 s57, s57, 31744
    v_mfma_f32_16x16x32_bf16 v[36:39], a[116:119], v[156:159], v[36:39]
    buffer_load_dwordx4 v12, s[20:23], s57 offen offset:2048 lds
    v_mfma_f32_16x16x32_bf16 v[40:43], a[120:123], v[156:159], v[40:43]
    ds_read_b128 v[164:167], v233 offset:1024
    ds_read_b128 v[180:183], v234 offset:17408
    v_mfma_f32_16x16x32_bf16 v[44:47], a[124:127], v[156:159], v[44:47]
    ds_read_b128 v[196:199], v235 offset:33792
    s_waitcnt vmcnt(10)
    v_mfma_f32_16x16x32_bf16 v[32:35], a[128:131], v[112:115], v[32:35]
    s_add_u32 s57, s57, 31744
    v_mfma_f32_16x16x32_bf16 v[36:39], a[132:135], v[112:115], v[36:39]
    buffer_load_dwordx4 v12, s[20:23], s57 offen offset:3072 lds
    v_mfma_f32_16x16x32_bf16 v[40:43], a[136:139], v[112:115], v[40:43]
    ds_read_b128 v[168:171], v233 offset:2048
    ds_read_b128 v[184:187], v234 offset:18432
    v_mfma_f32_16x16x32_bf16 v[44:47], a[140:143], v[112:115], v[44:47]
    ds_read_b128 v[200:203], v235 offset:34816
    s_waitcnt vmcnt(10)
    v_mfma_f32_16x16x32_bf16 v[32:35], a[144:147], v[116:119], v[32:35]
    s_add_u32 m0, s52, 98304
    s_lshl_b32 s57, s76, 7
    s_add_u32 s57, s57, 131072
    v_mfma_f32_16x16x32_bf16 v[36:39], a[148:151], v[116:119], v[36:39]
    buffer_load_dwordx4 v12, s[20:23], s57 offen offset:0 lds
    v_mfma_f32_16x16x32_bf16 v[40:43], a[152:155], v[116:119], v[40:43]
    ds_read_b128 v[172:175], v233 offset:3072
    ds_read_b128 v[188:191], v234 offset:19456
    v_mfma_f32_16x16x32_bf16 v[44:47], a[156:159], v[116:119], v[44:47]
    ds_read_b128 v[204:207], v235 offset:35840
    s_waitcnt vmcnt(10)
    v_mfma_f32_16x16x32_bf16 v[32:35], a[160:163], v[120:123], v[32:35]
    s_add_u32 s57, s57, 31744
    v_mfma_f32_16x16x32_bf16 v[36:39], a[164:167], v[120:123], v[36:39]
    buffer_load_dwordx4 v12, s[20:23], s57 offen offset:1024 lds
    v_mfma_f32_16x16x32_bf16 v[40:43], a[168:171], v[120:123], v[40:43]
    v_mfma_f32_16x16x32_bf16 v[44:47], a[172:175], v[120:123], v[44:47]
    s_waitcnt vmcnt(10)
    v_mfma_f32_16x16x32_bf16 v[32:35], a[176:179], v[124:127], v[32:35]
    s_add_u32 s57, s57, 31744
    s_waitcnt lgkmcnt(9)
    v_mfma_f32_16x16x32_bf16 v[36:39], a[180:183], v[124:127], v[36:39]
    buffer_load_dwordx4 v12, s[20:23], s57 offen offset:2048 lds
    v_mfma_f32_16x16x32_bf16 v[40:43], a[184:187], v[124:127], v[40:43]
    v_add_f32 v160, v160, v176
    v_add_f32 v161, v161, v177
    v_mfma_f32_16x16x32_bf16 v[44:47], a[188:191], v[124:127], v[44:47]
    v_add_f32 v162, v162, v178
    s_waitcnt vmcnt(10)
    v_mfma_f32_16x16x32_bf16 v[32:35], a[192:195], v[128:131], v[32:35]
    s_add_u32 s57, s57, 31744
    v_add_f32 v163, v163, v179
    v_mfma_f32_16x16x32_bf16 v[36:39], a[196:199], v[128:131], v[36:39]
    buffer_load_dwordx4 v12, s[20:23], s57 offen offset:3072 lds
    v_mfma_f32_16x16x32_bf16 v[40:43], a[200:203], v[128:131], v[40:43]
    s_waitcnt lgkmcnt(6)
    v_add_f32 v164, v164, v180
    v_mfma_f32_16x16x32_bf16 v[44:47], a[204:207], v[128:131], v[44:47]
    v_add_f32 v165, v165, v181
    s_waitcnt vmcnt(10)
    v_mfma_f32_16x16x32_bf16 v[32:35], a[208:211], v[132:135], v[32:35]
    s_add_u32 m0, s52, 114688
    s_lshl_b32 s57, s77, 7
    v_add_f32 v166, v166, v182
    v_mfma_f32_16x16x32_bf16 v[36:39], a[212:215], v[132:135], v[36:39]
    buffer_load_dwordx4 v12, s[20:23], s57 offen offset:0 lds
    v_mfma_f32_16x16x32_bf16 v[40:43], a[216:219], v[132:135], v[40:43]
    v_add_f32 v167, v167, v183
    s_waitcnt lgkmcnt(3)
    v_mfma_f32_16x16x32_bf16 v[44:47], a[220:223], v[132:135], v[44:47]
    v_add_f32 v168, v168, v184
    s_waitcnt vmcnt(10)
    v_mfma_f32_16x16x32_bf16 v[32:35], a[224:227], v[136:139], v[32:35]
    s_add_u32 s57, s57, 31744
    v_add_f32 v169, v169, v185
    v_mfma_f32_16x16x32_bf16 v[36:39], a[228:231], v[136:139], v[36:39]
    buffer_load_dwordx4 v12, s[20:23], s57 offen offset:1024 lds
    v_mfma_f32_16x16x32_bf16 v[40:43], a[232:235], v[136:139], v[40:43]
    v_add_f32 v170, v170, v186
    v_add_f32 v171, v171, v187
    v_mfma_f32_16x16x32_bf16 v[44:47], a[236:239], v[136:139], v[44:47]
    s_waitcnt lgkmcnt(0)
    s_waitcnt vmcnt(10)
    v_mfma_f32_16x16x32_bf16 v[32:35], a[240:243], v[140:143], v[32:35]
    s_add_u32 s57, s57, 31744
    v_add_f32 v172, v172, v188
    v_mfma_f32_16x16x32_bf16 v[36:39], a[244:247], v[140:143], v[36:39]
    buffer_load_dwordx4 v12, s[20:23], s57 offen offset:2048 lds
    v_mfma_f32_16x16x32_bf16 v[40:43], a[248:251], v[140:143], v[40:43]
    v_add_f32 v173, v173, v189
    v_add_f32 v174, v174, v190
    v_mfma_f32_16x16x32_bf16 v[44:47], a[252:255], v[140:143], v[44:47]
    v_add_f32 v175, v175, v191
    v_pk_add_f32 v[160:161], v[160:161], v[192:193]
    v_pk_add_f32 v[162:163], v[162:163], v[194:195]
    v_pk_add_f32 v[164:165], v[164:165], v[196:197]
    v_pk_add_f32 v[166:167], v[166:167], v[198:199]
    v_pk_add_f32 v[168:169], v[168:169], v[200:201]
    v_pk_add_f32 v[170:171], v[170:171], v[202:203]
    v_pk_add_f32 v[172:173], v[172:173], v[204:205]
    v_pk_add_f32 v[174:175], v[174:175], v[206:207]
    buffer_store_dwordx4 v[96:99], v23, s[24:27], s83 offen sc1
    s_add_u32 s57, s57, 31744
    buffer_load_dwordx4 v12, s[20:23], s57 offen offset:3072 lds
    v_pk_add_f32 v[32:33], v[32:33], v[160:161]
    v_pk_add_f32 v[34:35], v[34:35], v[162:163]
    v_pk_add_f32 v[36:37], v[36:37], v[164:165]
    v_pk_add_f32 v[38:39], v[38:39], v[166:167]
    v_pk_mul_f32 v[48:49], v[32:33], v[32:33]
    v_pk_mul_f32 v[50:51], v[34:35], v[34:35]
    v_pk_mul_f32 v[52:53], v[36:37], v[36:37]
    v_pk_mul_f32 v[54:55], v[38:39], v[38:39]
    s_add_u32 m0, s52, 131072
    s_lshl_b32 s57, s77, 7
    s_add_u32 s57, s57, 131072
    buffer_load_dwordx4 v12, s[20:23], s57 offen offset:0 lds
    v_pk_fma_f32 v[48:49], v[48:49], v[236:237], v[236:237] op_sel:[0,0,1] op_sel_hi:[1,0,1]
    v_pk_fma_f32 v[50:51], v[50:51], v[236:237], v[236:237] op_sel:[0,0,1] op_sel_hi:[1,0,1]
    v_pk_fma_f32 v[52:53], v[52:53], v[236:237], v[236:237] op_sel:[0,0,1] op_sel_hi:[1,0,1]
    v_pk_fma_f32 v[54:55], v[54:55], v[236:237], v[236:237] op_sel:[0,0,1] op_sel_hi:[1,0,1]
    v_pk_mul_f32 v[48:49], v[48:49], v[32:33]
    v_pk_mul_f32 v[50:51], v[50:51], v[34:35]
    v_pk_mul_f32 v[52:53], v[52:53], v[36:37]
    v_pk_mul_f32 v[54:55], v[54:55], v[38:39]
    s_add_u32 s57, s57, 31744
    buffer_load_dwordx4 v12, s[20:23], s57 offen offset:1024 lds
    s_waitcnt vmcnt(11)
    ds_read_b64_tr_b16 a[0:1], v6 offset:32768
    ds_read_b64_tr_b16 a[2:3], v6 offset:34816
    ds_read_b64_tr_b16 a[4:5], v7 offset:32768
    ds_read_b64_tr_b16 a[6:7], v7 offset:34816
    v_exp_f32 v48, v48
    v_exp_f32 v49, v49
    v_exp_f32 v50, v50
    v_exp_f32 v51, v51
    ds_read_b64_tr_b16 a[8:9], v6 offset:33024
    ds_read_b64_tr_b16 a[10:11], v6 offset:35072
    ds_read_b64_tr_b16 a[12:13], v7 offset:33024
    ds_read_b64_tr_b16 a[14:15], v7 offset:35072
    s_add_u32 s57, s57, 31744
    buffer_load_dwordx4 v12, s[20:23], s57 offen offset:2048 lds
    v_exp_f32 v52, v52
    v_exp_f32 v53, v53
    v_exp_f32 v54, v54
    v_exp_f32 v55, v55
    v_pk_add_f32 v[48:49], v[48:49], 1.0 op_sel_hi:[1,0]
    v_pk_add_f32 v[50:51], v[50:51], 1.0 op_sel_hi:[1,0]
    v_pk_add_f32 v[52:53], v[52:53], 1.0 op_sel_hi:[1,0]
    v_pk_add_f32 v[54:55], v[54:55], 1.0 op_sel_hi:[1,0]
    s_add_u32 s57, s57, 31744
    buffer_load_dwordx4 v12, s[20:23], s57 offen offset:3072 lds
    v_rcp_f32 v48, v48
    v_rcp_f32 v49, v49
    v_rcp_f32 v50, v50
    v_rcp_f32 v51, v51
    v_rcp_f32 v52, v52
    v_rcp_f32 v53, v53
    v_rcp_f32 v54, v54
    v_rcp_f32 v55, v55
    v_pk_mul_f32 v[48:49], v[48:49], v[32:33]
    v_pk_mul_f32 v[50:51], v[50:51], v[34:35]
    v_pk_mul_f32 v[52:53], v[52:53], v[36:37]
    v_pk_mul_f32 v[54:55], v[54:55], v[38:39]
    s_add_u32 m0, s52, 147456
    s_lshl_b32 s57, s78, 7
    buffer_load_dwordx4 v12, s[20:23], s57 offen offset:0 lds
    v_cvt_pk_bf16_f32 v56, v48, v49
    v_cvt_pk_bf16_f32 v57, v50, v51
    v_cvt_pk_bf16_f32 v58, v52, v53
    v_cvt_pk_bf16_f32 v59, v54, v55
    buffer_store_dwordx4 v[56:59], v23, s[24:27], s67 offen offset:0 sc1
    v_pk_add_f32 v[40:41], v[40:41], v[168:169]
    v_pk_add_f32 v[42:43], v[42:43], v[170:171]
    v_pk_add_f32 v[44:45], v[44:45], v[172:173]
    v_pk_add_f32 v[46:47], v[46:47], v[174:175]
    s_add_u32 s57, s57, 31744
    buffer_load_dwordx4 v12, s[20:23], s57 offen offset:1024 lds
    s_waitcnt vmcnt(12)
    ds_read_b64_tr_b16 a[16:17], v6 offset:49152
    ds_read_b64_tr_b16 a[18:19], v6 offset:51200
    ds_read_b64_tr_b16 a[20:21], v7 offset:49152
    ds_read_b64_tr_b16 a[22:23], v7 offset:51200
    v_pk_mul_f32 v[48:49], v[40:41], v[40:41]
    v_pk_mul_f32 v[50:51], v[42:43], v[42:43]
    v_pk_mul_f32 v[52:53], v[44:45], v[44:45]
    v_pk_mul_f32 v[54:55], v[46:47], v[46:47]
    ds_read_b64_tr_b16 a[24:25], v6 offset:49408
    ds_read_b64_tr_b16 a[26:27], v6 offset:51456
    ds_read_b64_tr_b16 a[28:29], v7 offset:49408
    ds_read_b64_tr_b16 a[30:31], v7 offset:51456
    s_add_u32 s57, s57, 31744
    buffer_load_dwordx4 v12, s[20:23], s57 offen offset:2048 lds
    v_pk_fma_f32 v[48:49], v[48:49], v[236:237], v[236:237] op_sel:[0,0,1] op_sel_hi:[1,0,1]
    v_pk_fma_f32 v[50:51], v[50:51], v[236:237], v[236:237] op_sel:[0,0,1] op_sel_hi:[1,0,1]
    v_pk_fma_f32 v[52:53], v[52:53], v[236:237], v[236:237] op_sel:[0,0,1] op_sel_hi:[1,0,1]
    v_pk_fma_f32 v[54:55], v[54:55], v[236:237], v[236:237] op_sel:[0,0,1] op_sel_hi:[1,0,1]
    v_pk_mul_f32 v[48:49], v[48:49], v[40:41]
    v_pk_mul_f32 v[50:51], v[50:51], v[42:43]
    v_pk_mul_f32 v[52:53], v[52:53], v[44:45]
    v_pk_mul_f32 v[54:55], v[54:55], v[46:47]
    s_add_u32 s57, s57, 31744
    buffer_load_dwordx4 v12, s[20:23], s57 offen offset:3072 lds
    v_exp_f32 v48, v48
    v_exp_f32 v49, v49
    v_exp_f32 v50, v50
    v_exp_f32 v51, v51
    v_exp_f32 v52, v52
    v_exp_f32 v53, v53
    v_exp_f32 v54, v54
    v_exp_f32 v55, v55
    v_pk_add_f32 v[48:49], v[48:49], 1.0 op_sel_hi:[1,0]
    v_pk_add_f32 v[50:51], v[50:51], 1.0 op_sel_hi:[1,0]
    v_pk_add_f32 v[52:53], v[52:53], 1.0 op_sel_hi:[1,0]
    v_pk_add_f32 v[54:55], v[54:55], 1.0 op_sel_hi:[1,0]
    s_add_u32 m0, s52, 49152
    s_lshl_b32 s57, s78, 7
    s_add_u32 s57, s57, 131072
    buffer_load_dwordx4 v12, s[20:23], s57 offen offset:0 lds
    v_rcp_f32 v48, v48
    v_rcp_f32 v49, v49
    v_rcp_f32 v50, v50
    v_rcp_f32 v51, v51
    v_rcp_f32 v52, v52
    v_rcp_f32 v53, v53
    v_rcp_f32 v54, v54
    v_rcp_f32 v55, v55
    s_add_u32 s57, s57, 31744
    buffer_load_dwordx4 v12, s[20:23], s57 offen offset:1024 lds
    s_waitcnt vmcnt(11)
    ds_read_b64_tr_b16 a[32:33], v8 offset:0
    ds_read_b64_tr_b16 a[34:35], v8 offset:2048
    ds_read_b64_tr_b16 a[36:37], v9 offset:0
    ds_read_b64_tr_b16 a[38:39], v9 offset:2048
    v_pk_mul_f32 v[48:49], v[48:49], v[40:41]
    v_pk_mul_f32 v[50:51], v[50:51], v[42:43]
    v_pk_mul_f32 v[52:53], v[52:53], v[44:45]
    v_pk_mul_f32 v[54:55], v[54:55], v[46:47]
    ds_read_b64_tr_b16 a[40:41], v8 offset:256
    ds_read_b64_tr_b16 a[42:43], v8 offset:2304
    ds_read_b64_tr_b16 a[44:45], v9 offset:256
    ds_read_b64_tr_b16 a[46:47], v9 offset:2304
    s_add_u32 s57, s57, 31744
    buffer_load_dwordx4 v12, s[20:23], s57 offen offset:2048 lds
    v_cvt_pk_bf16_f32 v60, v48, v49
    v_cvt_pk_bf16_f32 v61, v50, v51
    v_cvt_pk_bf16_f32 v62, v52, v53
    v_cvt_pk_bf16_f32 v63, v54, v55
    buffer_store_dwordx4 v[60:63], v23, s[24:27], s67 offen offset:1024 sc1
    s_add_u32 s57, s57, 31744
    buffer_load_dwordx4 v12, s[20:23], s57 offen offset:3072 lds
    s_add_u32 m0, s52, 65536
    s_lshl_b32 s57, s79, 7
    buffer_load_dwordx4 v12, s[20:23], s57 offen offset:0 lds
    s_add_u32 s57, s57, 31744
    buffer_load_dwordx4 v12, s[20:23], s57 offen offset:1024 lds
    s_waitcnt vmcnt(12)
    ds_read_b64_tr_b16 a[48:49], v8 offset:16384
    ds_read_b64_tr_b16 a[50:51], v8 offset:18432
    ds_read_b64_tr_b16 a[52:53], v9 offset:16384
    ds_read_b64_tr_b16 a[54:55], v9 offset:18432
    s_add_u32 s57, s57, 31744
    buffer_load_dwordx4 v12, s[20:23], s57 offen offset:2048 lds
    ds_read_b64_tr_b16 a[56:57], v8 offset:16640
    ds_read_b64_tr_b16 a[58:59], v8 offset:18688
    ds_read_b64_tr_b16 a[60:61], v9 offset:16640
    ds_read_b64_tr_b16 a[62:63], v9 offset:18688
    s_add_u32 s57, s57, 31744
    buffer_load_dwordx4 v12, s[20:23], s57 offen offset:3072 lds
    s_waitcnt lgkmcnt(15)
    s_add_u32 m0, s52, 81920
    s_lshl_b32 s57, s79, 7
    s_add_u32 s57, s57, 131072
    buffer_load_dwordx4 v12, s[20:23], s57 offen offset:0 lds
    s_add_u32 s57, s57, 31744
    buffer_load_dwordx4 v12, s[20:23], s57 offen offset:1024 lds
    s_waitcnt vmcnt(11)
    ds_read_b64_tr_b16 a[64:65], v8 offset:32768
    ds_read_b64_tr_b16 a[66:67], v8 offset:34816
    ds_read_b64_tr_b16 a[68:69], v9 offset:32768
    ds_read_b64_tr_b16 a[70:71], v9 offset:34816
    s_add_u32 s57, s57, 31744
    buffer_load_dwordx4 v12, s[20:23], s57 offen offset:2048 lds
    ds_read_b64_tr_b16 a[72:73], v8 offset:33024
    ds_read_b64_tr_b16 a[74:75], v8 offset:35072
    ds_read_b64_tr_b16 a[76:77], v9 offset:33024
    ds_read_b64_tr_b16 a[78:79], v9 offset:35072
    s_add_u32 s57, s57, 31744
    buffer_load_dwordx4 v12, s[20:23], s57 offen offset:3072 lds
    s_add_u32 m0, s52, 98304
    s_lshl_b32 s57, s80, 7
    buffer_load_dwordx4 v12, s[20:23], s57 offen offset:0 lds
    s_add_u32 s57, s57, 31744
    buffer_load_dwordx4 v12, s[20:23], s57 offen offset:1024 lds
    s_waitcnt vmcnt(10)
    ds_read_b64_tr_b16 a[80:81], v6 offset:0
    ds_read_b64_tr_b16 a[82:83], v6 offset:2048
    ds_read_b64_tr_b16 a[84:85], v7 offset:0
    ds_read_b64_tr_b16 a[86:87], v7 offset:2048
    s_add_u32 s57, s57, 31744
    buffer_load_dwordx4 v12, s[20:23], s57 offen offset:2048 lds
    ds_read_b64_tr_b16 a[88:89], v6 offset:256
    ds_read_b64_tr_b16 a[90:91], v6 offset:2304
    ds_read_b64_tr_b16 a[92:93], v7 offset:256
    ds_read_b64_tr_b16 a[94:95], v7 offset:2304
    s_barrier
    s_cmp_lg_u32 s44, 0
    s_cbranch_scc1 L_nopub6
    s_lshl_b32 s60, s51, 5
    s_add_u32 s60, s60, s50
    s_lshl_b32 s60, s60, 7
    s_add_u32 s60, s60, 12713984
    v_mov_b32 v30, s47
    s_mov_b64 exec, 1
    buffer_store_dword v30, off, s[24:27], s60 sc1
    s_mov_b64 exec, -1
L_nopub6:
L_p3join:
    s_add_u32 s57, s57, 31744
    buffer_load_dwordx4 v12, s[20:23], s57 offen offset:3072 lds
    v_lshlrev_b32 v228, 16, v228
    v_lshlrev_b32 v32, 16, v216
    v_and_b32 v33, s61, v216
    v_lshlrev_b32 v34, 16, v217
    s_waitcnt lgkmcnt(15)
    s_add_u32 m0, s52, 114688
    s_lshl_b32 s57, s80, 7
    s_add_u32 s57, s57, 131072
    buffer_load_dwordx4 v12, s[20:23], s57 offen offset:0 lds
    v_and_b32 v35, s61, v217
    v_add_f32 v32, v32, v228
    v_add_f32 v33, v33, v228
    v_add_f32 v34, v34, v228
    s_add_u32 s57, s57, 31744
    buffer_load_dwordx4 v12, s[20:23], s57 offen offset:1024 lds
    s_waitcnt vmcnt(10)
    ds_read_b64_tr_b16 a[96:97], v6 offset:16384
    ds_read_b64_tr_b16 a[98:99], v6 offset:18432
    ds_read_b64_tr_b16 a[100:101], v7 offset:16384
    ds_read_b64_tr_b16 a[102:103], v7 offset:18432
    v_add_f32 v35, v35, v228
    v_lshlrev_b32 v48, 16, v218
    v_and_b32 v49, s61, v218
    v_lshlrev_b32 v50, 16, v219
    ds_read_b64_tr_b16 a[104:105], v6 offset:16640
    ds_read_b64_tr_b16 a[106:107], v6 offset:18688
    ds_read_b64_tr_b16 a[108:109], v7 offset:16640
    ds_read_b64_tr_b16 a[110:111], v7 offset:18688
    s_add_u32 s57, s57, 31744
    buffer_load_dwordx4 v12, s[20:23], s57 offen offset:2048 lds
    v_and_b32 v51, s61, v219
    v_add_f32 v48, v48, v228
    v_add_f32 v49, v49, v228
    v_add_f32 v50, v50, v228
    s_add_u32 s57, s57, 31744
    buffer_load_dwordx4 v12, s[20:23], s57 offen offset:3072 lds
    v_add_f32 v51, v51, v228
    v_lshlrev_b32 v64, 16, v220
    v_and_b32 v65, s61, v220
    v_lshlrev_b32 v66, 16, v221
    s_add_u32 m0, s52, 131072
    s_lshl_b32 s57, s81, 7
    buffer_load_dwordx4 v12, s[20:23], s57 offen offset:0 lds
    v_and_b32 v67, s61, v221
    v_add_f32 v64, v64, v228
    v_add_f32 v65, v65, v228
    v_add_f32 v66, v66, v228
    v_add_f32 v67, v67, v228
    v_lshlrev_b32 v80, 16, v222
    v_and_b32 v81, s61, v222
    v_lshlrev_b32 v82, 16, v223
    s_add_u32 s57, s57, 31744
    buffer_load_dwordx4 v12, s[20:23], s57 offen offset:1024 lds
    s_waitcnt vmcnt(10)
    ds_read_b64_tr_b16 a[112:113], v6 offset:32768
    ds_read_b64_tr_b16 a[114:115], v6 offset:34816
    ds_read_b64_tr_b16 a[116:117], v7 offset:32768
    ds_read_b64_tr_b16 a[118:119], v7 offset:34816
    s_add_u32 s57, s57, 31744
    buffer_load_dwordx4 v12, s[20:23], s57 offen offset:2048 lds
    ds_read_b64_tr_b16 a[120:121], v6 offset:33024
    ds_read_b64_tr_b16 a[122:123], v6 offset:35072
    ds_read_b64_tr_b16 a[124:125], v7 offset:33024
    ds_read_b64_tr_b16 a[126:127], v7 offset:35072
    s_add_u32 s57, s57, 31744
    buffer_load_dwordx4 v12, s[20:23], s57 offen offset:3072 lds
    v_and_b32 v83, s61, v223
    v_add_f32 v80, v80, v228
    v_add_f32 v81, v81, v228
    v_add_f32 v82, v82, v228
    v_add_f32 v83, v83, v228
    v_lshlrev_b32 v96, 16, v224
    v_and_b32 v97, s61, v224
    v_lshlrev_b32 v98, 16, v225
    s_waitcnt lgkmcnt(15)
    s_add_u32 m0, s52, 147456
    s_lshl_b32 s57, s81, 7
    s_add_u32 s57, s57, 131072
    buffer_load_dwordx4 v12, s[20:23], s57 offen offset:0 lds
    v_and_b32 v99, s61, v225
    v_add_f32 v96, v96, v228
    v_add_f32 v97, v97, v228
    v_add_f32 v98, v98, v228
    s_add_u32 s57, s57, 31744
    buffer_load_dwordx4 v12, s[20:23], s57 offen offset:1024 lds
    s_waitcnt vmcnt(10)
    ds_read_b64_tr_b16 a[128:129], v6 offset:49152
    ds_read_b64_tr_b16 a[130:131], v6 offset:51200
    ds_read_b64_tr_b16 a[132:133], v7 offset:49152
    ds_read_b64_tr_b16 a[134:135], v7 offset:51200
    s_add_u32 s57, s57, 31744
    buffer_load_dwordx4 v12, s[20:23], s57 offen offset:2048 lds
    ds_read_b64_tr_b16 a[136:137], v6 offset:49408
    ds_read_b64_tr_b16 a[138:139], v6 offset:51456
    ds_read_b64_tr_b16 a[140:141], v7 offset:49408
    ds_read_b64_tr_b16 a[142:143], v7 offset:51456
    v_add_f32 v99, v99, v228
    s_add_u32 s57, s57, 31744
    buffer_load_dwordx4 v12, s[20:23], s57 offen offset:3072 lds
    s_add_u32 m0, s52, 49152
    s_lshl_b32 s57, s82, 7
    buffer_load_dwordx4 v12, s[20:23], s57 offen offset:0 lds
    s_add_u32 s57, s57, 31744
    buffer_load_dwordx4 v12, s[20:23], s57 offen offset:1024 lds
    s_waitcnt vmcnt(10)
    ds_read_b64_tr_b16 a[144:145], v8 offset:0
    ds_read_b64_tr_b16 a[146:147], v8 offset:2048
    ds_read_b64_tr_b16 a[148:149], v9 offset:0
    ds_read_b64_tr_b16 a[150:151], v9 offset:2048
    s_add_u32 s57, s57, 31744
    buffer_load_dwordx4 v12, s[20:23], s57 offen offset:2048 lds
    ds_read_b64_tr_b16 a[152:153], v8 offset:256
    ds_read_b64_tr_b16 a[154:155], v8 offset:2304
    ds_read_b64_tr_b16 a[156:157], v9 offset:256
    ds_read_b64_tr_b16 a[158:159], v9 offset:2304
    s_add_u32 s57, s57, 31744
    buffer_load_dwordx4 v12, s[20:23], s57 offen offset:3072 lds
    s_waitcnt lgkmcnt(15)
    s_add_u32 m0, s52, 65536
    s_lshl_b32 s57, s82, 7
    s_add_u32 s57, s57, 131072
    buffer_load_dwordx4 v12, s[20:23], s57 offen offset:0 lds
    s_add_u32 s57, s57, 31744
    buffer_load_dwordx4 v12, s[20:23], s57 offen offset:1024 lds
    s_waitcnt vmcnt(10)
    ds_read_b64_tr_b16 a[160:161], v8 offset:16384
    ds_read_b64_tr_b16 a[162:163], v8 offset:18432
    ds_read_b64_tr_b16 a[164:165], v9 offset:16384
    ds_read_b64_tr_b16 a[166:167], v9 offset:18432
    s_add_u32 s57, s57, 31744
    buffer_load_dwordx4 v12, s[20:23], s57 offen offset:2048 lds
    ds_read_b64_tr_b16 a[168:169], v8 offset:16640
    ds_read_b64_tr_b16 a[170:171], v8 offset:18688
    ds_read_b64_tr_b16 a[172:173], v9 offset:16640
    ds_read_b64_tr_b16 a[174:175], v9 offset:18688
    s_add_u32 s57, s57, 31744
    buffer_load_dwordx4 v12, s[20:23], s57 offen offset:3072 lds
    s_add_u32 m0, s52, 81920
    s_mov_b32 s57, s75
    buffer_load_dwordx4 v15, s[12:15], s57 offen offset:0 lds
    s_add_u32 s57, s57, 113664
    buffer_load_dwordx4 v15, s[12:15], s57 offen offset:1024 lds
    s_waitcnt vmcnt(10)
    ds_read_b64_tr_b16 a[176:177], v8 offset:32768
    ds_read_b64_tr_b16 a[178:179], v8 offset:34816
    ds_read_b64_tr_b16 a[180:181], v9 offset:32768
    ds_read_b64_tr_b16 a[182:183], v9 offset:34816
    s_add_u32 s57, s57, 113664
    buffer_load_dwordx4 v15, s[12:15], s57 offen offset:2048 lds
    ds_read_b64_tr_b16 a[184:185], v8 offset:33024
    ds_read_b64_tr_b16 a[186:187], v8 offset:35072
    ds_read_b64_tr_b16 a[188:189], v9 offset:33024
    ds_read_b64_tr_b16 a[190:191], v9 offset:35072
    s_add_u32 s57, s57, 113664
    buffer_load_dwordx4 v15, s[12:15], s57 offen offset:3072 lds
    s_waitcnt lgkmcnt(15)
    s_add_u32 m0, s52, 98304
    s_mov_b32 s57, 0
    buffer_load_dwordx4 v13, s[12:15], s57 offen offset:0 lds
    s_add_u32 s57, s57, 6144
    buffer_load_dwordx4 v14, s[12:15], s57 offen offset:1024 lds
    s_waitcnt vmcnt(10)
    ds_read_b64_tr_b16 a[192:193], v6 offset:0
    ds_read_b64_tr_b16 a[194:195], v6 offset:2048
    ds_read_b64_tr_b16 a[196:197], v7 offset:0
    ds_read_b64_tr_b16 a[198:199], v7 offset:2048
    s_add_u32 s57, s57, 6144
    buffer_load_dwordx4 v13, s[12:15], s57 offen offset:2048 lds
    ds_read_b64_tr_b16 a[200:201], v6 offset:256
    ds_read_b64_tr_b16 a[202:203], v6 offset:2304
    ds_read_b64_tr_b16 a[204:205], v7 offset:256
    ds_read_b64_tr_b16 a[206:207], v7 offset:2304
    s_add_u32 s57, s57, 6144
L_wb_2:
    s_cbranch_execz L_wb_ret
    buffer_load_dwordx4 v14, s[12:15], s57 offen offset:3072 lds
    buffer_load_dword v17, v20, s[24:27], 0 offen sc1
    s_add_u32 m0, s52, 114688
    s_mov_b32 s57, 114688
    buffer_load_dwordx4 v13, s[12:15], s57 offen offset:0 lds
    s_waitcnt vmcnt(10)
    ds_read_b64_tr_b16 a[208:209], v6 offset:16384
    ds_read_b64_tr_b16 a[210:211], v6 offset:18432
    ds_read_b64_tr_b16 a[212:213], v7 offset:16384
    ds_read_b64_tr_b16 a[214:215], v7 offset:18432
    s_add_u32 s57, s57, 6144
    buffer_load_dwordx4 v14, s[12:15], s57 offen offset:1024 lds
    ds_read_b64_tr_b16 a[216:217], v6 offset:16640
    ds_read_b64_tr_b16 a[218:219], v6 offset:18688
    ds_read_b64_tr_b16 a[220:221], v7 offset:16640
    ds_read_b64_tr_b16 a[222:223], v7 offset:18688
    s_add_u32 s57, s57, 6144
    buffer_load_dwordx4 v13, s[12:15], s57 offen offset:2048 lds
    s_add_u32 s57, s57, 6144
    buffer_load_dwordx4 v14, s[12:15], s57 offen offset:3072 lds
    s_waitcnt lgkmcnt(15)
    s_add_u32 m0, s52, 131072
    s_mov_b32 s57, 229376
    buffer_load_dwordx4 v13, s[12:15], s57 offen offset:0 lds
    s_add_u32 s57, s57, 6144
    buffer_load_dwordx4 v14, s[12:15], s57 offen offset:1024 lds
    s_add_u32 s57, s57, 6144
    buffer_load_dwordx4 v13, s[12:15], s57 offen offset:2048 lds
    s_add_u32 s57, s57, 6144
    buffer_load_dwordx4 v14, s[12:15], s57 offen offset:3072 lds
    s_add_u32 m0, s52, 147456
    s_mov_b32 s57, 344064
    buffer_load_dwordx4 v239, s[12:15], s57 offen offset:0 lds
    s_add_u32 s57, s57, 27648
    buffer_load_dwordx4 v239, s[12:15], s57 offen offset:1024 lds
    s_waitcnt vmcnt(10)
    v_cmp_ne_u32 vcc, s47, v17
    s_nop 0
    s_cbranch_vccz L_ok8
    s_mov_b32 s59, 100000
L_spin7:
    buffer_load_dword v17, v20, s[24:27], 0 offen sc1
    s_waitcnt vmcnt(0)
    v_cmp_ne_u32 vcc, s47, v17
    s_nop 0
    s_cbranch_vccz L_ok8
    s_sub_u32 s59, s59, 1
    s_cbranch_scc0 L_spin7
L_ok8:
    s_cmp_ge_u32 s89, 4
    s_cbranch_scc1 L_p3_alt
    s_mov_b32 s66, s68
    s_add_u32 s58, s66, s76
    buffer_load_dwordx4 v[144:147], v23, s[24:27], s58 offen offset:0 sc1
    buffer_load_dwordx4 v[148:151], v23, s[24:27], s58 offen offset:1024 sc1
    s_add_u32 s58, s66, s77
    buffer_load_dwordx4 v[152:155], v23, s[24:27], s58 offen offset:0 sc1
    buffer_load_dwordx4 v[156:159], v23, s[24:27], s58 offen offset:1024 sc1
    s_add_u32 s58, s66, s78
    buffer_load_dwordx4 v[112:115], v23, s[24:27], s58 offen offset:0 sc1
    buffer_load_dwordx4 v[116:119], v23, s[24:27], s58 offen offset:1024 sc1
    s_add_u32 s58, s66, s79
    buffer_load_dwordx4 v[120:123], v23, s[24:27], s58 offen offset:0 sc1
    buffer_load_dwordx4 v[124:127], v23, s[24:27], s58 offen offset:1024 sc1
    s_add_u32 s58, s66, s80
    buffer_load_dwordx4 v[128:131], v23, s[24:27], s58 offen offset:0 sc1
    buffer_load_dwordx4 v[132:135], v23, s[24:27], s58 offen offset:1024 sc1
    s_add_u32 s58, s66, s81
    buffer_load_dwordx4 v[136:139], v23, s[24:27], s58 offen offset:0 sc1
    s_waitcnt vmcnt(10)
    v_mfma_f32_16x16x32_bf16 v[96:99], v[144:147], a[0:3], v[96:99]
    v_mfma_f32_16x16x32_bf16 v[100:103], v[144:147], a[4:7], 0
    buffer_load_dwordx4 v[140:143], v23, s[24:27], s58 offen offset:1024 sc1
    v_mfma_f32_16x16x32_bf16 v[104:107], v[144:147], a[8:11], 0
    v_mfma_f32_16x16x32_bf16 v[108:111], v[144:147], a[12:15], 0
    s_waitcnt vmcnt(10)
    v_mfma_f32_16x16x32_bf16 v[96:99], v[148:151], a[16:19], v[96:99]
    s_add_u32 s58, s66, s82
    v_mfma_f32_16x16x32_bf16 v[100:103], v[148:151], a[20:23], v[100:103]
    buffer_load_dwordx4 v[144:147], v23, s[24:27], s58 offen offset:0 sc1
    v_mfma_f32_16x16x32_bf16 v[104:107], v[148:151], a[24:27], v[104:107]
    v_mfma_f32_16x16x32_bf16 v[108:111], v[148:151], a[28:31], v[108:111]
    s_waitcnt vmcnt(10)
    v_mfma_f32_16x16x32_bf16 v[96:99], v[152:155], a[32:35], v[96:99]
    v_mfma_f32_16x16x32_bf16 v[100:103], v[152:155], a[36:39], v[100:103]
    buffer_load_dwordx4 v[148:151], v23, s[24:27], s58 offen offset:1024 sc1
    v_mfma_f32_16x16x32_bf16 v[104:107], v[152:155], a[40:43], v[104:107]
    v_mfma_f32_16x16x32_bf16 v[108:111], v[152:155], a[44:47], v[108:111]
    s_waitcnt vmcnt(10)
    v_mfma_f32_16x16x32_bf16 v[96:99], v[156:159], a[48:51], v[96:99]
    s_add_u32 s66, s69, 175872
    s_add_u32 s58, s66, s76
    v_mfma_f32_16x16x32_bf16 v[100:103], v[156:159], a[52:55], v[100:103]
    buffer_load_dwordx4 v[152:155], v23, s[24:27], s58 offen offset:0 sc1
    v_mfma_f32_16x16x32_bf16 v[104:107], v[156:159], a[56:59], v[104:107]
    v_mfma_f32_16x16x32_bf16 v[108:111], v[156:159], a[60:63], v[108:111]
    s_waitcnt vmcnt(10)
    v_mfma_f32_16x16x32_bf16 v[96:99], v[112:115], a[64:67], v[96:99]
    v_mfma_f32_16x16x32_bf16 v[100:103], v[112:115], a[68:71], v[100:103]
    buffer_load_dwordx4 v[156:159], v23, s[24:27], s58 offen offset:1024 sc1
    v_mfma_f32_16x16x32_bf16 v[104:107], v[112:115], a[72:75], v[104:107]
    v_mfma_f32_16x16x32_bf16 v[108:111], v[112:115], a[76:79], v[108:111]
    s_waitcnt vmcnt(10)
    v_mfma_f32_16x16x32_bf16 v[96:99], v[116:119], a[80:83], v[96:99]
    s_add_u32 s58, s66, s77
    v_mfma_f32_16x16x32_bf16 v[100:103], v[116:119], a[84:87], v[100:103]
    buffer_load_dwordx4 v[112:115], v23, s[24:27], s58 offen offset:0 sc1
    v_mfma_f32_16x16x32_bf16 v[104:107], v[116:119], a[88:91], v[104:107]
    v_mfma_f32_16x16x32_bf16 v[108:111], v[116:119], a[92:95], v[108:111]
    s_waitcnt vmcnt(10)
    v_mfma_f32_16x16x32_bf16 v[96:99], v[120:123], a[96:99], v[96:99]
    v_mfma_f32_16x16x32_bf16 v[100:103], v[120:123], a[100:103], v[100:103]
    buffer_load_dwordx4 v[116:119], v23, s[24:27], s58 offen offset:1024 sc1
    v_mfma_f32_16x16x32_bf16 v[104:107], v[120:123], a[104:107], v[104:107]
    v_mfma_f32_16x16x32_bf16 v[108:111], v[120:123], a[108:111], v[108:111]
    s_waitcnt vmcnt(10)
    v_mfma_f32_16x16x32_bf16 v[96:99], v[124:127], a[112:115], v[96:99]
    s_add_u32 s58, s66, s78
    v_mfma_f32_16x16x32_bf16 v[100:103], v[124:127], a[116:119], v[100:103]
    buffer_load_dwordx4 v[120:123], v23, s[24:27], s58 offen offset:0 sc1
    v_mfma_f32_16x16x32_bf16 v[104:107], v[124:127], a[120:123], v[104:107]
    v_mfma_f32_16x16x32_bf16 v[108:111], v[124:127], a[124:127], v[108:111]
    s_waitcnt vmcnt(10)
    v_mfma_f32_16x16x32_bf16 v[96:99], v[128:131], a[128:131], v[96:99]
    v_mfma_f32_16x16x32_bf16 v[100:103], v[128:131], a[132:135], v[100:103]
    buffer_load_dwordx4 v[124:127], v23, s[24:27], s58 offen offset:1024 sc1
    v_mfma_f32_16x16x32_bf16 v[104:107], v[128:131], a[136:139], v[104:107]
    v_mfma_f32_16x16x32_bf16 v[108:111], v[128:131], a[140:143], v[108:111]
    s_waitcnt vmcnt(10)
    v_mfma_f32_16x16x32_bf16 v[96:99], v[132:135], a[144:147], v[96:99]
    s_add_u32 s58, s66, s79
    v_mfma_f32_16x16x32_bf16 v[100:103], v[132:135], a[148:151], v[100:103]
    buffer_load_dwordx4 v[128:131], v23, s[24:27], s58 offen offset:0 sc1
    v_mfma_f32_16x16x32_bf16 v[104:107], v[132:135], a[152:155], v[104:107]
    v_mfma_f32_16x16x32_bf16 v[108:111], v[132:135], a[156:159], v[108:111]
    s_waitcnt vmcnt(10)
    v_mfma_f32_16x16x32_bf16 v[96:99], v[136:139], a[160:163], v[96:99]
    v_mfma_f32_16x16x32_bf16 v[100:103], v[136:139], a[164:167], v[100:103]
    buffer_load_dwordx4 v[132:135], v23, s[24:27], s58 offen offset:1024 sc1
    v_mfma_f32_16x16x32_bf16 v[104:107], v[136:139], a[168:171], v[104:107]
    v_mfma_f32_16x16x32_bf16 v[108:111], v[136:139], a[172:175], v[108:111]
    s_waitcnt vmcnt(10)
    v_mfma_f32_16x16x32_bf16 v[96:99], v[140:143], a[176:179], v[96:99]
    s_add_u32 s58, s66, s80
    v_mfma_f32_16x16x32_bf16 v[100:103], v[140:143], a[180:183], v[100:103]
    buffer_load_dwordx4 v[136:139], v23, s[24:27], s58 offen offset:0 sc1
    v_mfma_f32_16x16x32_bf16 v[104:107], v[140:143], a[184:187], v[104:107]
    v_mfma_f32_16x16x32_bf16 v[108:111], v[140:143], a[188:191], v[108:111]
    s_waitcnt vmcnt(10)
    s_waitcnt lgkmcnt(8)
    v_mfma_f32_16x16x32_bf16 v[96:99], v[144:147], a[192:195], v[96:99]
    v_mfma_f32_16x16x32_bf16 v[100:103], v[144:147], a[196:199], v[100:103]
    buffer_load_dwordx4 v[140:143], v23, s[24:27], s58 offen offset:1024 sc1
    v_mfma_f32_16x16x32_bf16 v[104:107], v[144:147], a[200:203], v[104:107]
    v_mfma_f32_16x16x32_bf16 v[108:111], v[144:147], a[204:207], v[108:111]
    s_waitcnt vmcnt(10)
    s_waitcnt lgkmcnt(0)
    v_mfma_f32_16x16x32_bf16 v[96:99], v[148:151], a[208:211], v[96:99]
    s_add_u32 s58, s66, s81
    v_mfma_f32_16x16x32_bf16 v[100:103], v[148:151], a[212:215], v[100:103]
    buffer_load_dwordx4 v[144:147], v23, s[24:27], s58 offen offset:0 sc1
    v_mfma_f32_16x16x32_bf16 v[104:107], v[148:151], a[216:219], v[104:107]
    v_mfma_f32_16x16x32_bf16 v[108:111], v[148:151], a[220:223], v[108:111]
L_p3_join:
    s_waitcnt vmcnt(10)
    v_mfma_f32_16x16x32_bf16 v[80:83], v[152:155], a[0:3], v[80:83]
    v_mfma_f32_16x16x32_bf16 v[84:87], v[152:155], a[4:7], 0
    buffer_load_dwordx4 v[148:151], v23, s[24:27], s58 offen offset:1024 sc1
    v_mfma_f32_16x16x32_bf16 v[88:91], v[152:155], a[8:11], 0
    v_mfma_f32_16x16x32_bf16 v[92:95], v[152:155], a[12:15], 0
    s_waitcnt vmcnt(10)
    v_mfma_f32_16x16x32_bf16 v[80:83], v[156:159], a[16:19], v[80:83]
    s_add_u32 s58, s66, s82
    v_mfma_f32_16x16x32_bf16 v[84:87], v[156:159], a[20:23], v[84:87]
    buffer_load_dwordx4 v[152:155], v23, s[24:27], s58 offen offset:0 sc1
    v_mfma_f32_16x16x32_bf16 v[88:91], v[156:159], a[24:27], v[88:91]
    ds_write_b128 v232, v[100:103] offset:3072
    v_mfma_f32_16x16x32_bf16 v[92:95], v[156:159], a[28:31], v[92:95]
    s_waitcnt vmcnt(10)
    v_mfma_f32_16x16x32_bf16 v[80:83], v[112:115], a[32:35], v[80:83]
    v_mfma_f32_16x16x32_bf16 v[84:87], v[112:115], a[36:39], v[84:87]
    buffer_load_dwordx4 v[156:159], v23, s[24:27], s58 offen offset:1024 sc1
    v_mfma_f32_16x16x32_bf16 v[88:91], v[112:115], a[40:43], v[88:91]
    ds_write_b128 v232, v[104:107] offset:19456
    v_mfma_f32_16x16x32_bf16 v[92:95], v[112:115], a[44:47], v[92:95]
    s_waitcnt vmcnt(10)
    v_mfma_f32_16x16x32_bf16 v[80:83], v[116:119], a[48:51], v[80:83]
    s_add_u32 s66, s69, 117248
    s_add_u32 s58, s66, s76
    v_mfma_f32_16x16x32_bf16 v[84:87], v[116:119], a[52:55], v[84:87]
    buffer_load_dwordx4 v[112:115], v23, s[24:27], s58 offen offset:0 sc1
    v_mfma_f32_16x16x32_bf16 v[88:91], v[116:119], a[56:59], v[88:91]
    ds_write_b128 v232, v[108:111] offset:35840
    v_mfma_f32_16x16x32_bf16 v[92:95], v[116:119], a[60:63], v[92:95]
    s_waitcnt vmcnt(10)
    v_mfma_f32_16x16x32_bf16 v[80:83], v[120:123], a[64:67], v[80:83]
    v_mfma_f32_16x16x32_bf16 v[84:87], v[120:123], a[68:71], v[84:87]
    buffer_load_dwordx4 v[116:119], v23, s[24:27], s58 offen offset:1024 sc1
    v_mfma_f32_16x16x32_bf16 v[88:91], v[120:123], a[72:75], v[88:91]
    v_mfma_f32_16x16x32_bf16 v[92:95], v[120:123], a[76:79], v[92:95]
    s_waitcnt vmcnt(10)
    v_mfma_f32_16x16x32_bf16 v[80:83], v[124:127], a[80:83], v[80:83]
    s_add_u32 s58, s66, s77
    v_mfma_f32_16x16x32_bf16 v[84:87], v[124:127], a[84:87], v[84:87]
    buffer_load_dwordx4 v[120:123], v23, s[24:27], s58 offen offset:0 sc1
    v_mfma_f32_16x16x32_bf16 v[88:91], v[124:127], a[88:91], v[88:91]
    s_waitcnt lgkmcnt(0)
    s_barrier
    v_mfma_f32_16x16x32_bf16 v[92:95], v[124:127], a[92:95], v[92:95]
    s_waitcnt vmcnt(10)
    v_mfma_f32_16x16x32_bf16 v[80:83], v[128:131], a[96:99], v[80:83]
    v_mfma_f32_16x16x32_bf16 v[84:87], v[128:131], a[100:103], v[84:87]
    buffer_load_dwordx4 v[124:127], v23, s[24:27], s58 offen offset:1024 sc1
    v_mfma_f32_16x16x32_bf16 v[88:91], v[128:131], a[104:107], v[88:91]
    ds_read_b128 v[100:103], v233 offset:3072
    ds_read_b128 v[104:107], v234 offset:19456
    v_mfma_f32_16x16x32_bf16 v[92:95], v[128:131], a[108:111], v[92:95]
    ds_read_b128 v[108:111], v235 offset:35840
    s_waitcnt vmcnt(10)
    v_mfma_f32_16x16x32_bf16 v[80:83], v[132:135], a[112:115], v[80:83]
    s_add_u32 s58, s66, s78
    v_mfma_f32_16x16x32_bf16 v[84:87], v[132:135], a[116:119], v[84:87]
    buffer_load_dwordx4 v[128:131], v23, s[24:27], s58 offen offset:0 sc1
    v_mfma_f32_16x16x32_bf16 v[88:91], v[132:135], a[120:123], v[88:91]
    ds_read_b64_tr_b16 v[160:161], v16 offset:0
    v_mfma_f32_16x16x32_bf16 v[92:95], v[132:135], a[124:127], v[92:95]
    ds_read_b64_tr_b16 v[162:163], v16 offset:512
    s_waitcnt vmcnt(10)
    v_mfma_f32_16x16x32_bf16 v[80:83], v[136:139], a[128:131], v[80:83]
    s_waitcnt lgkmcnt(2)
    v_mfma_f32_16x16x32_bf16 v[84:87], v[136:139], a[132:135], v[84:87]
    buffer_load_dwordx4 v[132:135], v23, s[24:27], s58 offen offset:1024 sc1
    v_mfma_f32_16x16x32_bf16 v[88:91], v[136:139], a[136:139], v[88:91]
    v_add_f32 v96, v96, v100
    v_add_f32 v97, v97, v101
    ds_read_b64_tr_b16 v[164:165], v16 offset:4096
    v_mfma_f32_16x16x32_bf16 v[92:95], v[136:139], a[140:143], v[92:95]
    ds_read_b64_tr_b16 v[166:167], v16 offset:4608
    s_waitcnt vmcnt(10)
    v_mfma_f32_16x16x32_bf16 v[80:83], v[140:143], a[144:147], v[80:83]
    s_add_u32 s58, s66, s79
    v_add_f32 v98, v98, v102
    v_mfma_f32_16x16x32_bf16 v[84:87], v[140:143], a[148:151], v[84:87]
    buffer_load_dwordx4 v[136:139], v23, s[24:27], s58 offen offset:0 sc1
    v_mfma_f32_16x16x32_bf16 v[88:91], v[140:143], a[152:155], v[88:91]
    v_add_f32 v99, v99, v103
    v_add_f32 v96, v96, v104
    ds_read_b64_tr_b16 v[168:169], v16 offset:8192
    v_mfma_f32_16x16x32_bf16 v[92:95], v[140:143], a[156:159], v[92:95]
    ds_read_b64_tr_b16 v[170:171], v16 offset:8704
    s_waitcnt vmcnt(10)
    v_mfma_f32_16x16x32_bf16 v[80:83], v[144:147], a[160:163], v[80:83]
    v_add_f32 v97, v97, v105
    v_mfma_f32_16x16x32_bf16 v[84:87], v[144:147], a[164:167], v[84:87]
    buffer_load_dwordx4 v[140:143], v23, s[24:27], s58 offen offset:1024 sc1
    v_mfma_f32_16x16x32_bf16 v[88:91], v[144:147], a[168:171], v[88:91]
    v_add_f32 v98, v98, v106
    v_add_f32 v99, v99, v107
    ds_read_b64_tr_b16 v[172:173], v16 offset:12288
    v_mfma_f32_16x16x32_bf16 v[92:95], v[144:147], a[172:175], v[92:95]
    ds_read_b64_tr_b16 v[174:175], v16 offset:12800
    s_waitcnt vmcnt(10)
    v_mfma_f32_16x16x32_bf16 v[80:83], v[148:151], a[176:179], v[80:83]
    s_add_u32 s58, s66, s80
    v_mfma_f32_16x16x32_bf16 v[84:87], v[148:151], a[180:183], v[84:87]
    buffer_load_dwordx4 v[144:147], v23, s[24:27], s58 offen offset:0 sc1
    v_mfma_f32_16x16x32_bf16 v[88:91], v[148:151], a[184:187], v[88:91]
    v_add_f32 v96, v96, v108
    v_add_f32 v97, v97, v109
    v_mfma_f32_16x16x32_bf16 v[92:95], v[148:151], a[188:191], v[92:95]
    v_add_f32 v98, v98, v110
    s_waitcnt vmcnt(10)
    v_mfma_f32_16x16x32_bf16 v[80:83], v[152:155], a[192:195], v[80:83]
    v_mfma_f32_16x16x32_bf16 v[84:87], v[152:155], a[196:199], v[84:87]
    buffer_load_dwordx4 v[148:151], v23, s[24:27], s58 offen offset:1024 sc1
    v_mfma_f32_16x16x32_bf16 v[88:91], v[152:155], a[200:203], v[88:91]
    v_add_f32 v99, v99, v111
    v_mfma_f32_16x16x32_bf16 v[92:95], v[152:155], a[204:207], v[92:95]
    s_waitcnt vmcnt(10)
    v_mfma_f32_16x16x32_bf16 v[80:83], v[156:159], a[208:211], v[80:83]
    s_add_u32 s58, s66, s81
    v_mfma_f32_16x16x32_bf16 v[84:87], v[156:159], a[212:215], v[84:87]
    buffer_load_dwordx4 v[152:155], v23, s[24:27], s58 offen offset:0 sc1
    v_mfma_f32_16x16x32_bf16 v[88:91], v[156:159], a[216:219], v[88:91]
    v_mfma_f32_16x16x32_bf16 v[92:95], v[156:159], a[220:223], v[92:95]
    s_waitcnt vmcnt(10)
    v_mfma_f32_16x16x32_bf16 v[64:67], v[112:115], a[0:3], v[64:67]
    v_mfma_f32_16x16x32_bf16 v[68:71], v[112:115], a[4:7], 0
    buffer_load_dwordx4 v[156:159], v23, s[24:27], s58 offen offset:1024 sc1
    v_mfma_f32_16x16x32_bf16 v[72:75], v[112:115], a[8:11], 0
    ds_read_b64_tr_b16 v[192:193], v16 offset:1024
    v_mfma_f32_16x16x32_bf16 v[76:79], v[112:115], a[12:15], 0
    ds_read_b64_tr_b16 v[194:195], v16 offset:1536
    s_waitcnt vmcnt(10)
    v_mfma_f32_16x16x32_bf16 v[64:67], v[116:119], a[16:19], v[64:67]
    s_add_u32 s58, s66, s82
    v_mfma_f32_16x16x32_bf16 v[68:71], v[116:119], a[20:23], v[68:71]
    buffer_load_dwordx4 v[112:115], v23, s[24:27], s58 offen offset:0 sc1
    v_mfma_f32_16x16x32_bf16 v[72:75], v[116:119], a[24:27], v[72:75]
    ds_read_b64_tr_b16 v[196:197], v16 offset:5120
    ds_read_b64_tr_b16 v[198:199], v16 offset:5632
    v_mfma_f32_16x16x32_bf16 v[76:79], v[116:119], a[28:31], v[76:79]
    ds_write_b128 v232, v[84:87] offset:49152
    s_waitcnt vmcnt(10)
    v_mfma_f32_16x16x32_bf16 v[64:67], v[120:123], a[32:35], v[64:67]
    v_mfma_f32_16x16x32_bf16 v[68:71], v[120:123], a[36:39], v[68:71]
    buffer_load_dwordx4 v[116:119], v23, s[24:27], s58 offen offset:1024 sc1
    v_mfma_f32_16x16x32_bf16 v[72:75], v[120:123], a[40:43], v[72:75]
    ds_read_b64_tr_b16 v[200:201], v16 offset:9216
    ds_read_b64_tr_b16 v[202:203], v16 offset:9728
    v_mfma_f32_16x16x32_bf16 v[76:79], v[120:123], a[44:47], v[76:79]
    ds_write_b128 v232, v[88:91] offset:50176
    s_waitcnt vmcnt(10)
    v_mfma_f32_16x16x32_bf16 v[64:67], v[124:127], a[48:51], v[64:67]
    s_add_u32 s66, s69, 58624
    s_add_u32 s58, s66, s76
    v_mfma_f32_16x16x32_bf16 v[68:71], v[124:127], a[52:55], v[68:71]
    buffer_load_dwordx4 v[120:123], v23, s[24:27], s58 offen offset:0 sc1
    v_mfma_f32_16x16x32_bf16 v[72:75], v[124:127], a[56:59], v[72:75]
    ds_read_b64_tr_b16 v[204:205], v16 offset:13312
    ds_read_b64_tr_b16 v[206:207], v16 offset:13824
    v_mfma_f32_16x16x32_bf16 v[76:79], v[124:127], a[60:63], v[76:79]
    ds_write_b128 v232, v[92:95] offset:51200
    s_waitcnt vmcnt(10)
    v_mfma_f32_16x16x32_bf16 v[64:67], v[128:131], a[64:67], v[64:67]
    v_mfma_f32_16x16x32_bf16 v[68:71], v[128:131], a[68:71], v[68:71]
    buffer_load_dwordx4 v[124:127], v23, s[24:27], s58 offen offset:1024 sc1
    v_mfma_f32_16x16x32_bf16 v[72:75], v[128:131], a[72:75], v[72:75]
    ds_read_b64_tr_b16 v[100:101], v16 offset:2048
    v_mfma_f32_16x16x32_bf16 v[76:79], v[128:131], a[76:79], v[76:79]
    ds_read_b64_tr_b16 v[102:103], v16 offset:2560
    s_waitcnt vmcnt(10)
    v_mfma_f32_16x16x32_bf16 v[64:67], v[132:135], a[80:83], v[64:67]
    s_add_u32 s58, s66, s77
    v_mfma_f32_16x16x32_bf16 v[68:71], v[132:135], a[84:87], v[68:71]
    buffer_load_dwordx4 v[128:131], v23, s[24:27], s58 offen offset:0 sc1
    v_mfma_f32_16x16x32_bf16 v[72:75], v[132:135], a[88:91], v[72:75]
    s_waitcnt lgkmcnt(2)
    s_barrier
    v_mfma_f32_16x16x32_bf16 v[76:79], v[132:135], a[92:95], v[76:79]
    s_waitcnt vmcnt(10)
    v_mfma_f32_16x16x32_bf16 v[64:67], v[136:139], a[96:99], v[64:67]
    v_mfma_f32_16x16x32_bf16 v[68:71], v[136:139], a[100:103], v[68:71]
    buffer_load_dwordx4 v[132:135], v23, s[24:27], s58 offen offset:1024 sc1
    v_mfma_f32_16x16x32_bf16 v[72:75], v[136:139], a[104:107], v[72:75]
    ds_read_b128 v[84:87], v233 offset:49152
    ds_read_b128 v[88:91], v234 offset:50176
    v_mfma_f32_16x16x32_bf16 v[76:79], v[136:139], a[108:111], v[76:79]
    ds_read_b128 v[92:95], v235 offset:51200
    s_waitcnt vmcnt(10)
    v_mfma_f32_16x16x32_bf16 v[64:67], v[140:143], a[112:115], v[64:67]
    s_add_u32 s58, s66, s78
    v_mfma_f32_16x16x32_bf16 v[68:71], v[140:143], a[116:119], v[68:71]
    buffer_load_dwordx4 v[136:139], v23, s[24:27], s58 offen offset:0 sc1
    v_mfma_f32_16x16x32_bf16 v[72:75], v[140:143], a[120:123], v[72:75]
    ds_read_b64_tr_b16 a[224:225], v246 offset:0
    v_mfma_f32_16x16x32_bf16 v[76:79], v[140:143], a[124:127], v[76:79]
    ds_read_b64_tr_b16 a[226:227], v246 offset:512
    s_waitcnt vmcnt(10)
    v_mfma_f32_16x16x32_bf16 v[64:67], v[144:147], a[128:131], v[64:67]
    s_waitcnt lgkmcnt(2)
    v_mfma_f32_16x16x32_bf16 v[68:71], v[144:147], a[132:135], v[68:71]
    buffer_load_dwordx4 v[140:143], v23, s[24:27], s58 offen offset:1024 sc1
    v_mfma_f32_16x16x32_bf16 v[72:75], v[144:147], a[136:139], v[72:75]
    v_add_f32 v80, v80, v84
    v_add_f32 v81, v81, v85
    ds_read_b64_tr_b16 a[228:229], v247 offset:0
    v_mfma_f32_16x16x32_bf16 v[76:79], v[144:147], a[140:143], v[76:79]
    ds_read_b64_tr_b16 a[230:231], v247 offset:512
    s_waitcnt vmcnt(10)
    v_mfma_f32_16x16x32_bf16 v[64:67], v[148:151], a[144:147], v[64:67]
    s_add_u32 s58, s66, s79
    v_add_f32 v82, v82, v86
    v_mfma_f32_16x16x32_bf16 v[68:71], v[148:151], a[148:151], v[68:71]
    buffer_load_dwordx4 v[144:147], v23, s[24:27], s58 offen offset:0 sc1
    v_mfma_f32_16x16x32_bf16 v[72:75], v[148:151], a[152:155], v[72:75]
    v_add_f32 v83, v83, v87
    v_add_f32 v80, v80, v88
    ds_read_b64_tr_b16 a[232:233], v246 offset:256
    v_mfma_f32_16x16x32_bf16 v[76:79], v[148:151], a[156:159], v[76:79]
    ds_read_b64_tr_b16 a[234:235], v246 offset:768
    s_waitcnt vmcnt(10)
    v_mfma_f32_16x16x32_bf16 v[64:67], v[152:155], a[160:163], v[64:67]
    v_add_f32 v81, v81, v89
    v_mfma_f32_16x16x32_bf16 v[68:71], v[152:155], a[164:167], v[68:71]
    buffer_load_dwordx4 v[148:151], v23, s[24:27], s58 offen offset:1024 sc1
    v_mfma_f32_16x16x32_bf16 v[72:75], v[152:155], a[168:171], v[72:75]
    v_add_f32 v82, v82, v90
    v_add_f32 v83, v83, v91
    ds_read_b64_tr_b16 a[236:237], v247 offset:256
    v_mfma_f32_16x16x32_bf16 v[76:79], v[152:155], a[172:175], v[76:79]
    ds_read_b64_tr_b16 a[238:239], v247 offset:768
    s_waitcnt vmcnt(10)
    v_mfma_f32_16x16x32_bf16 v[64:67], v[156:159], a[176:179], v[64:67]
    s_add_u32 s58, s66, s80
    v_mfma_f32_16x16x32_bf16 v[68:71], v[156:159], a[180:183], v[68:71]
    buffer_load_dwordx4 v[152:155], v23, s[24:27], s58 offen offset:0 sc1
    v_mfma_f32_16x16x32_bf16 v[72:75], v[156:159], a[184:187], v[72:75]
    v_add_f32 v80, v80, v92
    v_add_f32 v81, v81, v93
    v_mfma_f32_16x16x32_bf16 v[76:79], v[156:159], a[188:191], v[76:79]
    v_add_f32 v82, v82, v94
    s_waitcnt vmcnt(10)
    v_mfma_f32_16x16x32_bf16 v[64:67], v[112:115], a[192:195], v[64:67]
    v_mfma_f32_16x16x32_bf16 v[68:71], v[112:115], a[196:199], v[68:71]
    buffer_load_dwordx4 v[156:159], v23, s[24:27], s58 offen offset:1024 sc1
    v_mfma_f32_16x16x32_bf16 v[72:75], v[112:115], a[200:203], v[72:75]
    v_add_f32 v83, v83, v95
    v_mfma_f32_16x16x32_bf16 v[76:79], v[112:115], a[204:207], v[76:79]
    s_waitcnt vmcnt(10)
    v_mfma_f32_16x16x32_bf16 v[64:67], v[116:119], a[208:211], v[64:67]
    s_add_u32 s58, s66, s81
    v_mfma_f32_16x16x32_bf16 v[68:71], v[116:119], a[212:215], v[68:71]
    buffer_load_dwordx4 v[112:115], v23, s[24:27], s58 offen offset:0 sc1
    v_mfma_f32_16x16x32_bf16 v[72:75], v[116:119], a[216:219], v[72:75]
    v_mfma_f32_16x16x32_bf16 v[76:79], v[116:119], a[220:223], v[76:79]
    s_waitcnt vmcnt(10)
    v_mfma_f32_16x16x32_bf16 v[48:51], v[120:123], a[0:3], v[48:51]
    v_mfma_f32_16x16x32_bf16 v[52:55], v[120:123], a[4:7], 0
    buffer_load_dwordx4 v[116:119], v23, s[24:27], s58 offen offset:1024 sc1
    v_mfma_f32_16x16x32_bf16 v[56:59], v[120:123], a[8:11], 0
    ds_read_b64_tr_b16 v[104:105], v16 offset:6144
    v_mfma_f32_16x16x32_bf16 v[60:63], v[120:123], a[12:15], 0
    ds_read_b64_tr_b16 v[106:107], v16 offset:6656
    s_waitcnt vmcnt(10)
    v_mfma_f32_16x16x32_bf16 v[48:51], v[124:127], a[16:19], v[48:51]
    s_add_u32 s58, s66, s82
    v_mfma_f32_16x16x32_bf16 v[52:55], v[124:127], a[20:23], v[52:55]
    buffer_load_dwordx4 v[120:123], v23, s[24:27], s58 offen offset:0 sc1
    v_mfma_f32_16x16x32_bf16 v[56:59], v[124:127], a[24:27], v[56:59]
    ds_read_b64_tr_b16 v[108:109], v16 offset:10240
    ds_read_b64_tr_b16 v[110:111], v16 offset:10752
    v_mfma_f32_16x16x32_bf16 v[60:63], v[124:127], a[28:31], v[60:63]
    ds_write_b128 v232, v[68:71] offset:32768
    s_waitcnt vmcnt(10)
    v_mfma_f32_16x16x32_bf16 v[48:51], v[128:131], a[32:35], v[48:51]
    v_mfma_f32_16x16x32_bf16 v[52:55], v[128:131], a[36:39], v[52:55]
    buffer_load_dwordx4 v[124:127], v23, s[24:27], s58 offen offset:1024 sc1
    v_mfma_f32_16x16x32_bf16 v[56:59], v[128:131], a[40:43], v[56:59]
    ds_read_b64_tr_b16 v[84:85], v16 offset:14336
    ds_read_b64_tr_b16 v[86:87], v16 offset:14848
    v_mfma_f32_16x16x32_bf16 v[60:63], v[128:131], a[44:47], v[60:63]
    ds_write_b128 v232, v[72:75] offset:33792
    s_waitcnt vmcnt(10)
    v_mfma_f32_16x16x32_bf16 v[48:51], v[132:135], a[48:51], v[48:51]
    s_add_u32 s66, s69, 0
    s_add_u32 s58, s66, s76
    v_mfma_f32_16x16x32_bf16 v[52:55], v[132:135], a[52:55], v[52:55]
    buffer_load_dwordx4 v[128:131], v23, s[24:27], s58 offen offset:0 sc1
    v_mfma_f32_16x16x32_bf16 v[56:59], v[132:135], a[56:59], v[56:59]
    ds_read_b64_tr_b16 v[88:89], v16 offset:3072
    ds_read_b64_tr_b16 v[90:91], v16 offset:3584
    v_mfma_f32_16x16x32_bf16 v[60:63], v[132:135], a[60:63], v[60:63]
    ds_write_b128 v232, v[76:79] offset:34816
    s_waitcnt vmcnt(10)
    v_mfma_f32_16x16x32_bf16 v[48:51], v[136:139], a[64:67], v[48:51]
    v_mfma_f32_16x16x32_bf16 v[52:55], v[136:139], a[68:71], v[52:55]
    buffer_load_dwordx4 v[132:135], v23, s[24:27], s58 offen offset:1024 sc1
    v_mfma_f32_16x16x32_bf16 v[56:59], v[136:139], a[72:75], v[56:59]
    ds_read_b64_tr_b16 v[92:93], v16 offset:7168
    v_mfma_f32_16x16x32_bf16 v[60:63], v[136:139], a[76:79], v[60:63]
    ds_read_b64_tr_b16 v[94:95], v16 offset:7680
    s_waitcnt vmcnt(10)
    v_mfma_f32_16x16x32_bf16 v[48:51], v[140:143], a[80:83], v[48:51]
    s_add_u32 s58, s66, s77
    v_mfma_f32_16x16x32_bf16 v[52:55], v[140:143], a[84:87], v[52:55]
    buffer_load_dwordx4 v[136:139], v23, s[24:27], s58 offen offset:0 sc1
    v_mfma_f32_16x16x32_bf16 v[56:59], v[140:143], a[88:91], v[56:59]
    s_waitcnt lgkmcnt(2)
    s_barrier
    v_mfma_f32_16x16x32_bf16 v[60:63], v[140:143], a[92:95], v[60:63]
    s_waitcnt vmcnt(10)
    v_mfma_f32_16x16x32_bf16 v[48:51], v[144:147], a[96:99], v[48:51]
    v_mfma_f32_16x16x32_bf16 v[52:55], v[144:147], a[100:103], v[52:55]
    buffer_load_dword v19, v21, s[24:27], 0 offen sc1
    v_mfma_f32_16x16x32_bf16 v[56:59], v[144:147], a[104:107], v[56:59]
    ds_read_b128 v[68:71], v233 offset:32768
    ds_read_b128 v[72:75], v234 offset:33792
    v_mfma_f32_16x16x32_bf16 v[60:63], v[144:147], a[108:111], v[60:63]
    ds_read_b128 v[76:79], v235 offset:34816
    s_waitcnt vmcnt(10)
    v_mfma_f32_16x16x32_bf16 v[48:51], v[148:151], a[112:115], v[48:51]
    v_mfma_f32_16x16x32_bf16 v[52:55], v[148:151], a[116:119], v[52:55]
    buffer_load_dwordx4 v[140:143], v23, s[24:27], s58 offen offset:1024 sc1
    v_mfma_f32_16x16x32_bf16 v[56:59], v[148:151], a[120:123], v[56:59]
    ds_read_b64_tr_b16 a[240:241], v246 offset:4096
    v_mfma_f32_16x16x32_bf16 v[60:63], v[148:151], a[124:127], v[60:63]
    ds_read_b64_tr_b16 a[242:243], v246 offset:4608
    s_waitcnt vmcnt(10)
    v_mfma_f32_16x16x32_bf16 v[48:51], v[152:155], a[128:131], v[48:51]
    s_add_u32 s58, s66, s78
    s_waitcnt lgkmcnt(2)
    v_mfma_f32_16x16x32_bf16 v[52:55], v[152:155], a[132:135], v[52:55]
    buffer_load_dwordx4 v[144:147], v23, s[24:27], s58 offen offset:0 sc1
    v_mfma_f32_16x16x32_bf16 v[56:59], v[152:155], a[136:139], v[56:59]
    v_add_f32 v64, v64, v68
    v_add_f32 v65, v65, v69
    ds_read_b64_tr_b16 a[244:245], v247 offset:4096
    v_mfma_f32_16x16x32_bf16 v[60:63], v[152:155], a[140:143], v[60:63]
    ds_read_b64_tr_b16 a[246:247], v247 offset:4608
    s_waitcnt vmcnt(10)
    v_mfma_f32_16x16x32_bf16 v[48:51], v[156:159], a[144:147], v[48:51]
    v_add_f32 v66, v66, v70
    v_mfma_f32_16x16x32_bf16 v[52:55], v[156:159], a[148:151], v[52:55]
    buffer_load_dwordx4 v[148:151], v23, s[24:27], s58 offen offset:1024 sc1
    v_mfma_f32_16x16x32_bf16 v[56:59], v[156:159], a[152:155], v[56:59]
    v_add_f32 v67, v67, v71
    v_add_f32 v64, v64, v72
    ds_read_b64_tr_b16 a[248:249], v246 offset:4352
    v_mfma_f32_16x16x32_bf16 v[60:63], v[156:159], a[156:159], v[60:63]
    ds_read_b64_tr_b16 a[250:251], v246 offset:4864
    s_waitcnt vmcnt(10)
    v_mfma_f32_16x16x32_bf16 v[48:51], v[112:115], a[160:163], v[48:51]
    s_add_u32 s58, s66, s79
    v_add_f32 v65, v65, v73
    v_mfma_f32_16x16x32_bf16 v[52:55], v[112:115], a[164:167], v[52:55]
    buffer_load_dwordx4 v[152:155], v23, s[24:27], s58 offen offset:0 sc1
    v_mfma_f32_16x16x32_bf16 v[56:59], v[112:115], a[168:171], v[56:59]
    v_add_f32 v66, v66, v74
    v_add_f32 v67, v67, v75
    ds_read_b64_tr_b16 a[252:253], v247 offset:4352
    v_mfma_f32_16x16x32_bf16 v[60:63], v[112:115], a[172:175], v[60:63]
    ds_read_b64_tr_b16 a[254:255], v247 offset:4864
    s_waitcnt vmcnt(10)
    v_mfma_f32_16x16x32_bf16 v[48:51], v[116:119], a[176:179], v[48:51]
    v_mfma_f32_16x16x32_bf16 v[52:55], v[116:119], a[180:183], v[52:55]
    buffer_load_dwordx4 v[156:159], v23, s[24:27], s58 offen offset:1024 sc1
    v_mfma_f32_16x16x32_bf16 v[56:59], v[116:119], a[184:187], v[56:59]
    v_add_f32 v64, v64, v76
    v_add_f32 v65, v65, v77
    v_mfma_f32_16x16x32_bf16 v[60:63], v[116:119], a[188:191], v[60:63]
    v_add_f32 v66, v66, v78
    s_waitcnt vmcnt(10)
    v_mfma_f32_16x16x32_bf16 v[48:51], v[120:123], a[192:195], v[48:51]
    s_add_u32 s58, s66, s80
    v_mfma_f32_16x16x32_bf16 v[52:55], v[120:123], a[196:199], v[52:55]
    buffer_load_dwordx4 v[112:115], v23, s[24:27], s58 offen offset:0 sc1
    v_mfma_f32_16x16x32_bf16 v[56:59], v[120:123], a[200:203], v[56:59]
    v_add_f32 v67, v67, v79
    v_mfma_f32_16x16x32_bf16 v[60:63], v[120:123], a[204:207], v[60:63]
    s_waitcnt vmcnt(10)
    v_mfma_f32_16x16x32_bf16 v[48:51], v[124:127], a[208:211], v[48:51]
    v_mfma_f32_16x16x32_bf16 v[52:55], v[124:127], a[212:215], v[52:55]
    buffer_load_dwordx4 v[116:119], v23, s[24:27], s58 offen offset:1024 sc1
    v_mfma_f32_16x16x32_bf16 v[56:59], v[124:127], a[216:219], v[56:59]
    v_mfma_f32_16x16x32_bf16 v[60:63], v[124:127], a[220:223], v[60:63]
    s_waitcnt vmcnt(10)
    v_mfma_f32_16x16x32_bf16 v[32:35], v[128:131], a[0:3], v[32:35]
    s_add_u32 s58, s66, s81
    v_mfma_f32_16x16x32_bf16 v[36:39], v[128:131], a[4:7], 0
    buffer_load_dwordx4 v[120:123], v23, s[24:27], s58 offen offset:0 sc1
    v_mfma_f32_16x16x32_bf16 v[40:43], v[128:131], a[8:11], 0
    v_mfma_f32_16x16x32_bf16 v[44:47], v[128:131], a[12:15], 0
    s_waitcnt vmcnt(10)
    v_mfma_f32_16x16x32_bf16 v[32:35], v[132:135], a[16:19], v[32:35]
    ds_write_b128 v232, v[52:55] offset:16384
    v_mfma_f32_16x16x32_bf16 v[36:39], v[132:135], a[20:23], v[36:39]
    buffer_load_dwordx4 v[124:127], v23, s[24:27], s58 offen offset:1024 sc1
    v_mfma_f32_16x16x32_bf16 v[40:43], v[132:135], a[24:27], v[40:43]
    ds_read_b64_tr_b16 a[0:1], v246 offset:8192
    ds_read_b64_tr_b16 a[2:3], v246 offset:8704
    ds_read_b64_tr_b16 a[4:5], v247 offset:8192
    v_mfma_f32_16x16x32_bf16 v[44:47], v[132:135], a[28:31], v[44:47]
    ds_read_b64_tr_b16 a[6:7], v247 offset:8704
    s_waitcnt vmcnt(10)
    v_mfma_f32_16x16x32_bf16 v[32:35], v[136:139], a[32:35], v[32:35]
    s_add_u32 s58, s66, s82
    ds_write_b128 v232, v[56:59] offset:17408
    v_mfma_f32_16x16x32_bf16 v[36:39], v[136:139], a[36:39], v[36:39]
    buffer_load_dwordx4 v[128:131], v23, s[24:27], s58 offen offset:0 sc1
    v_mfma_f32_16x16x32_bf16 v[40:43], v[136:139], a[40:43], v[40:43]
    ds_read_b64_tr_b16 a[8:9], v246 offset:8448
    ds_read_b64_tr_b16 a[10:11], v246 offset:8960
    ds_read_b64_tr_b16 a[12:13], v247 offset:8448
    v_mfma_f32_16x16x32_bf16 v[44:47], v[136:139], a[44:47], v[44:47]
    ds_read_b64_tr_b16 a[14:15], v247 offset:8960
    buffer_load_dwordx4 v[132:135], v23, s[24:27], s58 offen offset:1024 sc1
    s_waitcnt vmcnt(11)
    v_cmp_ne_u32 vcc, s47, v19
    s_nop 0
    s_cbranch_vccz L_ok10
    s_mov_b32 s59, 100000
L_spin9:
    buffer_load_dword v19, v21, s[24:27], 0 offen sc1
    s_waitcnt vmcnt(0)
    v_cmp_ne_u32 vcc, s47, v19
    s_nop 0
    s_cbranch_vccz L_ok10
    s_sub_u32 s59, s59, 1
    s_cbranch_scc0 L_spin9
L_ok10:
    s_waitcnt vmcnt(10)
    v_mfma_f32_16x16x32_bf16 v[32:35], v[140:143], a[48:51], v[32:35]
    s_add_u32 s58, s70, 0
    ds_write_b128 v232, v[60:63] offset:18432
    v_mfma_f32_16x16x32_bf16 v[36:39], v[140:143], a[52:55], v[36:39]
    buffer_load_dwordx4 v[136:139], v23, s[24:27], s58 offen offset:0 sc1
    v_mfma_f32_16x16x32_bf16 v[40:43], v[140:143], a[56:59], v[40:43]
    ds_read_b64_tr_b16 a[16:17], v246 offset:12288
    ds_read_b64_tr_b16 a[18:19], v246 offset:12800
    ds_read_b64_tr_b16 a[20:21], v247 offset:12288
L_wb_3:
    s_cbranch_execz L_wb_ret
    v_mfma_f32_16x16x32_bf16 v[44:47], v[140:143], a[60:63], v[44:47]
    ds_read_b64_tr_b16 a[22:23], v247 offset:12800
    s_waitcnt vmcnt(10)
    v_mfma_f32_16x16x32_bf16 v[32:35], v[144:147], a[64:67], v[32:35]
    ds_read_b64_tr_b16 a[24:25], v246 offset:12544
    v_mfma_f32_16x16x32_bf16 v[36:39], v[144:147], a[68:71], v[36:39]
    buffer_load_dwordx4 v[140:143], v23, s[24:27], s58 offen offset:1024 sc1
    v_mfma_f32_16x16x32_bf16 v[40:43], v[144:147], a[72:75], v[40:43]
    ds_read_b64_tr_b16 a[26:27], v246 offset:13056
    ds_read_b64_tr_b16 a[28:29], v247 offset:12544
    v_mfma_f32_16x16x32_bf16 v[44:47], v[144:147], a[76:79], v[44:47]
    ds_read_b64_tr_b16 a[30:31], v247 offset:13056
    s_waitcnt vmcnt(10)
    v_mfma_f32_16x16x32_bf16 v[32:35], v[148:151], a[80:83], v[32:35]
    ds_read_b64_tr_b16 a[32:33], v246 offset:16384
    v_mfma_f32_16x16x32_bf16 v[36:39], v[148:151], a[84:87], v[36:39]
    buffer_load_dwordx4 v[144:147], v23, s[24:27], s58 offen offset:2048 sc1
    v_mfma_f32_16x16x32_bf16 v[40:43], v[148:151], a[88:91], v[40:43]
    ds_read_b64_tr_b16 a[34:35], v246 offset:16896
    ds_read_b64_tr_b16 a[36:37], v247 offset:16384
    v_mfma_f32_16x16x32_bf16 v[44:47], v[148:151], a[92:95], v[44:47]
    ds_read_b64_tr_b16 a[38:39], v247 offset:16896
    s_waitcnt vmcnt(10)
    v_mfma_f32_16x16x32_bf16 v[32:35], v[152:155], a[96:99], v[32:35]
    ds_read_b64_tr_b16 a[40:41], v246 offset:16640
    v_mfma_f32_16x16x32_bf16 v[36:39], v[152:155], a[100:103], v[36:39]
    buffer_load_dwordx4 v[148:151], v23, s[24:27], s58 offen offset:3072 sc1
    v_mfma_f32_16x16x32_bf16 v[40:43], v[152:155], a[104:107], v[40:43]
    ds_read_b64_tr_b16 a[42:43], v246 offset:17152
    ds_read_b64_tr_b16 a[44:45], v247 offset:16640
    v_mfma_f32_16x16x32_bf16 v[44:47], v[152:155], a[108:111], v[44:47]
    ds_read_b64_tr_b16 a[46:47], v247 offset:17152
    s_waitcnt vmcnt(10)
    v_mfma_f32_16x16x32_bf16 v[32:35], v[156:159], a[112:115], v[32:35]
    s_add_u32 s58, s70, 4096
    ds_read_b64_tr_b16 a[48:49], v246 offset:20480
    v_mfma_f32_16x16x32_bf16 v[36:39], v[156:159], a[116:119], v[36:39]
    buffer_load_dwordx4 v[152:155], v23, s[24:27], s58 offen offset:0 sc1
    v_mfma_f32_16x16x32_bf16 v[40:43], v[156:159], a[120:123], v[40:43]
    ds_read_b64_tr_b16 a[50:51], v246 offset:20992
    ds_read_b64_tr_b16 a[52:53], v247 offset:20480
    v_mfma_f32_16x16x32_bf16 v[44:47], v[156:159], a[124:127], v[44:47]
    ds_read_b64_tr_b16 a[54:55], v247 offset:20992
    s_waitcnt vmcnt(10)
    v_mfma_f32_16x16x32_bf16 v[32:35], v[112:115], a[128:131], v[32:35]
    ds_read_b64_tr_b16 a[56:57], v246 offset:20736
    v_mfma_f32_16x16x32_bf16 v[36:39], v[112:115], a[132:135], v[36:39]
    buffer_load_dwordx4 v[156:159], v23, s[24:27], s58 offen offset:1024 sc1
    v_mfma_f32_16x16x32_bf16 v[40:43], v[112:115], a[136:139], v[40:43]
    ds_read_b64_tr_b16 a[58:59], v246 offset:21248
    ds_read_b64_tr_b16 a[60:61], v247 offset:20736
    v_mfma_f32_16x16x32_bf16 v[44:47], v[112:115], a[140:143], v[44:47]
    ds_read_b64_tr_b16 a[62:63], v247 offset:21248
    s_waitcnt vmcnt(10)
    v_mfma_f32_16x16x32_bf16 v[32:35], v[116:119], a[144:147], v[32:35]
    ds_read_b64_tr_b16 a[64:65], v246 offset:24576
    v_mfma_f32_16x16x32_bf16 v[36:39], v[116:119], a[148:151], v[36:39]
    buffer_load_dwordx4 v[112:115], v23, s[24:27], s58 offen offset:2048 sc1
    v_mfma_f32_16x16x32_bf16 v[40:43], v[116:119], a[152:155], v[40:43]
    ds_read_b64_tr_b16 a[66:67], v246 offset:25088
    ds_read_b64_tr_b16 a[68:69], v247 offset:24576
    v_mfma_f32_16x16x32_bf16 v[44:47], v[116:119], a[156:159], v[44:47]
    ds_read_b64_tr_b16 a[70:71], v247 offset:25088
    s_waitcnt vmcnt(10)
    v_mfma_f32_16x16x32_bf16 v[32:35], v[120:123], a[160:163], v[32:35]
    ds_read_b64_tr_b16 a[72:73], v246 offset:24832
    v_mfma_f32_16x16x32_bf16 v[36:39], v[120:123], a[164:167], v[36:39]
    buffer_load_dwordx4 v[116:119], v23, s[24:27], s58 offen offset:3072 sc1
    v_mfma_f32_16x16x32_bf16 v[40:43], v[120:123], a[168:171], v[40:43]
    ds_read_b64_tr_b16 a[74:75], v246 offset:25344
    ds_read_b64_tr_b16 a[76:77], v247 offset:24832
    v_mfma_f32_16x16x32_bf16 v[44:47], v[120:123], a[172:175], v[44:47]
    ds_read_b64_tr_b16 a[78:79], v247 offset:25344
    s_waitcnt vmcnt(10)
    v_mfma_f32_16x16x32_bf16 v[32:35], v[124:127], a[176:179], v[32:35]
    s_add_u32 s58, s70, 8192
    ds_read_b64_tr_b16 a[80:81], v246 offset:28672
    v_mfma_f32_16x16x32_bf16 v[36:39], v[124:127], a[180:183], v[36:39]
    buffer_load_dwordx4 v[120:123], v23, s[24:27], s58 offen offset:0 sc1
    v_mfma_f32_16x16x32_bf16 v[40:43], v[124:127], a[184:187], v[40:43]
    ds_read_b64_tr_b16 a[82:83], v246 offset:29184
    ds_read_b64_tr_b16 a[84:85], v247 offset:28672
    v_mfma_f32_16x16x32_bf16 v[44:47], v[124:127], a[188:191], v[44:47]
    ds_read_b64_tr_b16 a[86:87], v247 offset:29184
    s_waitcnt vmcnt(10)
    v_mfma_f32_16x16x32_bf16 v[32:35], v[128:131], a[192:195], v[32:35]
    ds_read_b64_tr_b16 a[88:89], v246 offset:28928
    v_mfma_f32_16x16x32_bf16 v[36:39], v[128:131], a[196:199], v[36:39]
    buffer_load_dwordx4 v[124:127], v23, s[24:27], s58 offen offset:1024 sc1
    v_mfma_f32_16x16x32_bf16 v[40:43], v[128:131], a[200:203], v[40:43]
    ds_read_b64_tr_b16 a[90:91], v246 offset:29440
    ds_read_b64_tr_b16 a[92:93], v247 offset:28928
    v_mfma_f32_16x16x32_bf16 v[44:47], v[128:131], a[204:207], v[44:47]
    ds_read_b64_tr_b16 a[94:95], v247 offset:29440
    s_waitcnt vmcnt(10)
    v_mfma_f32_16x16x32_bf16 v[32:35], v[132:135], a[208:211], v[32:35]
    ds_read_b64_tr_b16 a[96:97], v246 offset:32768
    v_mfma_f32_16x16x32_bf16 v[36:39], v[132:135], a[212:215], v[36:39]
    buffer_load_dwordx4 v[128:131], v23, s[24:27], s58 offen offset:2048 sc1
    v_mfma_f32_16x16x32_bf16 v[40:43], v[132:135], a[216:219], v[40:43]
    ds_read_b64_tr_b16 a[98:99], v246 offset:33280
    ds_read_b64_tr_b16 a[100:101], v247 offset:32768
    v_mfma_f32_16x16x32_bf16 v[44:47], v[132:135], a[220:223], v[44:47]
    ds_read_b64_tr_b16 a[102:103], v247 offset:33280
    s_waitcnt vmcnt(10)
    v_mfma_f32_16x16x32_bf16 v[32:35], a[224:227], v[136:139], v[32:35]
    v_mfma_f32_16x16x32_bf16 v[48:51], a[228:231], v[136:139], v[48:51]
    buffer_load_dwordx4 v[132:135], v23, s[24:27], s58 offen offset:3072 sc1
    v_mfma_f32_16x16x32_bf16 v[64:67], a[232:235], v[136:139], v[64:67]
    ds_read_b64_tr_b16 a[104:105], v246 offset:33024
    ds_read_b64_tr_b16 a[106:107], v246 offset:33536
    v_mfma_f32_16x16x32_bf16 v[80:83], a[236:239], v[136:139], v[80:83]
    ds_read_b64_tr_b16 a[108:109], v247 offset:33024
    ds_read_b64_tr_b16 a[110:111], v247 offset:33536
    v_mfma_f32_16x16x32_bf16 v[96:99], v[160:163], v[136:139], v[96:99]
    ds_read_b64_tr_b16 a[112:113], v246 offset:36864
    s_waitcnt lgkmcnt(15)
    s_waitcnt vmcnt(10)
    v_mfma_f32_16x16x32_bf16 v[32:35], a[240:243], v[140:143], v[32:35]
    s_add_u32 s58, s70, 12288
    v_mfma_f32_16x16x32_bf16 v[48:51], a[244:247], v[140:143], v[48:51]
    buffer_load_dwordx4 v[136:139], v23, s[24:27], s58 offen offset:0 sc1
    v_mfma_f32_16x16x32_bf16 v[64:67], a[248:251], v[140:143], v[64:67]
    ds_read_b64_tr_b16 a[114:115], v246 offset:37376
    ds_read_b64_tr_b16 a[116:117], v247 offset:36864
    v_mfma_f32_16x16x32_bf16 v[80:83], a[252:255], v[140:143], v[80:83]
    ds_read_b64_tr_b16 a[118:119], v247 offset:37376
    ds_read_b64_tr_b16 a[120:121], v246 offset:37120
    v_mfma_f32_16x16x32_bf16 v[96:99], v[164:167], v[140:143], v[96:99]
    ds_write_b128 v232, v[36:39] offset:0
    s_waitcnt vmcnt(10)
    v_mfma_f32_16x16x32_bf16 v[32:35], a[0:3], v[144:147], v[32:35]
    v_mfma_f32_16x16x32_bf16 v[48:51], a[4:7], v[144:147], v[48:51]
    buffer_load_dwordx4 v[140:143], v23, s[24:27], s58 offen offset:1024 sc1
    v_mfma_f32_16x16x32_bf16 v[64:67], a[8:11], v[144:147], v[64:67]
    ds_read_b64_tr_b16 a[122:123], v246 offset:37632
    ds_read_b64_tr_b16 a[124:125], v247 offset:37120
    v_mfma_f32_16x16x32_bf16 v[80:83], a[12:15], v[144:147], v[80:83]
    ds_read_b64_tr_b16 a[126:127], v247 offset:37632
    ds_read_b64_tr_b16 a[128:129], v246 offset:40960
    v_mfma_f32_16x16x32_bf16 v[96:99], v[168:171], v[144:147], v[96:99]
    ds_write_b128 v232, v[40:43] offset:1024
    s_waitcnt vmcnt(10)
    v_mfma_f32_16x16x32_bf16 v[32:35], a[16:19], v[148:151], v[32:35]
    ds_read_b64_tr_b16 a[130:131], v246 offset:41472
    v_mfma_f32_16x16x32_bf16 v[48:51], a[20:23], v[148:151], v[48:51]
    ds_read_b64_tr_b16 a[132:133], v247 offset:40960
    v_mfma_f32_16x16x32_bf16 v[64:67], a[24:27], v[148:151], v[64:67]
    ds_read_b64_tr_b16 a[134:135], v247 offset:41472
    v_mfma_f32_16x16x32_bf16 v[80:83], a[28:31], v[148:151], v[80:83]
    ds_read_b64_tr_b16 a[136:137], v246 offset:41216
    v_mfma_f32_16x16x32_bf16 v[96:99], v[172:175], v[148:151], v[96:99]
    ds_write_b128 v232, v[44:47] offset:2048
    s_waitcnt vmcnt(9)
    v_mfma_f32_16x16x32_bf16 v[32:35], a[32:35], v[152:155], v[32:35]
    ds_read_b64_tr_b16 a[138:139], v246 offset:41728
    v_mfma_f32_16x16x32_bf16 v[48:51], a[36:39], v[152:155], v[48:51]
    ds_read_b64_tr_b16 a[140:141], v247 offset:41216
    v_mfma_f32_16x16x32_bf16 v[64:67], a[40:43], v[152:155], v[64:67]
    ds_read_b64_tr_b16 a[142:143], v247 offset:41728
    v_mfma_f32_16x16x32_bf16 v[80:83], a[44:47], v[152:155], v[80:83]
    ds_read_b64_tr_b16 a[144:145], v246 offset:45056
    v_mfma_f32_16x16x32_bf16 v[96:99], v[192:195], v[152:155], v[96:99]
    ds_read_b64_tr_b16 a[146:147], v246 offset:45568
    s_waitcnt vmcnt(8)
    v_mfma_f32_16x16x32_bf16 v[32:35], a[48:51], v[156:159], v[32:35]
    ds_read_b64_tr_b16 a[148:149], v247 offset:45056
    v_mfma_f32_16x16x32_bf16 v[48:51], a[52:55], v[156:159], v[48:51]
    ds_read_b64_tr_b16 a[150:151], v247 offset:45568
    v_mfma_f32_16x16x32_bf16 v[64:67], a[56:59], v[156:159], v[64:67]
    ds_read_b64_tr_b16 a[152:153], v246 offset:45312
    v_mfma_f32_16x16x32_bf16 v[80:83], a[60:63], v[156:159], v[80:83]
    ds_read_b64_tr_b16 a[154:155], v246 offset:45824
    v_mfma_f32_16x16x32_bf16 v[96:99], v[196:199], v[156:159], v[96:99]
    s_waitcnt lgkmcnt(9)
    s_barrier
    s_waitcnt vmcnt(7)
    v_mfma_f32_16x16x32_bf16 v[32:35], a[64:67], v[112:115], v[32:35]
    ds_read_b64_tr_b16 a[156:157], v247 offset:45312
    ds_read_b64_tr_b16 a[158:159], v247 offset:45824
    v_mfma_f32_16x16x32_bf16 v[48:51], a[68:71], v[112:115], v[48:51]
    ds_read_b64_tr_b16 a[160:161], v248 offset:49152
    ds_read_b64_tr_b16 a[162:163], v248 offset:49664
    v_mfma_f32_16x16x32_bf16 v[64:67], a[72:75], v[112:115], v[64:67]
    ds_read_b128 v[52:55], v233 offset:16384
    v_mfma_f32_16x16x32_bf16 v[80:83], a[76:79], v[112:115], v[80:83]
    ds_read_b128 v[56:59], v234 offset:17408
    v_mfma_f32_16x16x32_bf16 v[96:99], v[200:203], v[112:115], v[96:99]
    ds_read_b128 v[60:63], v235 offset:18432
    s_waitcnt vmcnt(6)
    v_mfma_f32_16x16x32_bf16 v[32:35], a[80:83], v[116:119], v[32:35]
    ds_read_b64_tr_b16 a[164:165], v249 offset:49152
    ds_read_b64_tr_b16 a[166:167], v249 offset:49664
    v_mfma_f32_16x16x32_bf16 v[48:51], a[84:87], v[116:119], v[48:51]
    ds_read_b64_tr_b16 a[168:169], v248 offset:49408
    ds_read_b64_tr_b16 a[170:171], v248 offset:49920
    v_mfma_f32_16x16x32_bf16 v[64:67], a[88:91], v[116:119], v[64:67]
    ds_read_b128 v[36:39], v233 offset:0
    v_mfma_f32_16x16x32_bf16 v[80:83], a[92:95], v[116:119], v[80:83]
    ds_read_b128 v[40:43], v234 offset:1024
    v_mfma_f32_16x16x32_bf16 v[96:99], v[204:207], v[116:119], v[96:99]
    ds_read_b128 v[44:47], v235 offset:2048
    s_waitcnt vmcnt(5)
    v_mfma_f32_16x16x32_bf16 v[32:35], a[96:99], v[120:123], v[32:35]
    ds_read_b64_tr_b16 a[172:173], v249 offset:49408
    v_mfma_f32_16x16x32_bf16 v[48:51], a[100:103], v[120:123], v[48:51]
    ds_read_b64_tr_b16 a[174:175], v249 offset:49920
    v_mfma_f32_16x16x32_bf16 v[64:67], a[104:107], v[120:123], v[64:67]
    ds_read_b64_tr_b16 a[176:177], v248 offset:50176
    v_mfma_f32_16x16x32_bf16 v[80:83], a[108:111], v[120:123], v[80:83]
    ds_read_b64_tr_b16 a[178:179], v248 offset:50688
    v_mfma_f32_16x16x32_bf16 v[96:99], v[100:103], v[120:123], v[96:99]
    ds_read_b64_tr_b16 a[180:181], v249 offset:50176
    s_waitcnt vmcnt(4)
    v_mfma_f32_16x16x32_bf16 v[32:35], a[112:115], v[124:127], v[32:35]
    ds_read_b64_tr_b16 a[182:183], v249 offset:50688
    v_mfma_f32_16x16x32_bf16 v[48:51], a[116:119], v[124:127], v[48:51]
    ds_read_b64_tr_b16 a[184:185], v248 offset:50432
    v_mfma_f32_16x16x32_bf16 v[64:67], a[120:123], v[124:127], v[64:67]
    ds_read_b64_tr_b16 a[186:187], v248 offset:50944
    v_mfma_f32_16x16x32_bf16 v[80:83], a[124:127], v[124:127], v[80:83]
    ds_read_b64_tr_b16 a[188:189], v249 offset:50432
    v_mfma_f32_16x16x32_bf16 v[96:99], v[104:107], v[124:127], v[96:99]
    ds_read_b64_tr_b16 a[190:191], v249 offset:50944
    s_waitcnt lgkmcnt(15)
    s_waitcnt vmcnt(3)
    v_mfma_f32_16x16x32_bf16 v[32:35], a[128:131], v[128:131], v[32:35]
    v_mfma_f32_16x16x32_bf16 v[48:51], a[132:135], v[128:131], v[48:51]
    v_add_f32 v52, v52, v56
    v_mfma_f32_16x16x32_bf16 v[64:67], a[136:139], v[128:131], v[64:67]
    v_add_f32 v53, v53, v57
    v_mfma_f32_16x16x32_bf16 v[80:83], a[140:143], v[128:131], v[80:83]
    v_add_f32 v54, v54, v58
    v_mfma_f32_16x16x32_bf16 v[96:99], v[108:111], v[128:131], v[96:99]
    v_add_f32 v55, v55, v59
    s_waitcnt vmcnt(2)
    v_mfma_f32_16x16x32_bf16 v[32:35], a[144:147], v[132:135], v[32:35]
    v_add_f32 v52, v52, v60
    v_mfma_f32_16x16x32_bf16 v[48:51], a[148:151], v[132:135], v[48:51]
    v_add_f32 v53, v53, v61
    v_mfma_f32_16x16x32_bf16 v[64:67], a[152:155], v[132:135], v[64:67]
    v_add_f32 v54, v54, v62
    v_mfma_f32_16x16x32_bf16 v[80:83], a[156:159], v[132:135], v[80:83]
    v_add_f32 v55, v55, v63
    v_mfma_f32_16x16x32_bf16 v[96:99], v[84:87], v[132:135], v[96:99]
    s_waitcnt lgkmcnt(10)
    s_waitcnt lgkmcnt(8)
    s_waitcnt vmcnt(1)
    v_mfma_f32_16x16x32_bf16 v[32:35], a[160:163], v[136:139], v[32:35]
    v_add_f32 v36, v36, v40
    v_mfma_f32_16x16x32_bf16 v[48:51], a[164:167], v[136:139], v[48:51]
    v_add_f32 v37, v37, v41
    v_mfma_f32_16x16x32_bf16 v[64:67], a[168:171], v[136:139], v[64:67]
    v_add_f32 v38, v38, v42
    v_mfma_f32_16x16x32_bf16 v[80:83], a[172:175], v[136:139], v[80:83]
    v_add_f32 v39, v39, v43
    v_mfma_f32_16x16x32_bf16 v[96:99], v[88:91], v[136:139], v[96:99]
    v_add_f32 v36, v36, v44
    s_waitcnt lgkmcnt(0)
    s_waitcnt vmcnt(0)
    v_mfma_f32_16x16x32_bf16 v[32:35], a[176:179], v[140:143], v[32:35]
    v_add_f32 v37, v37, v45
    v_mfma_f32_16x16x32_bf16 v[48:51], a[180:183], v[140:143], v[48:51]
    v_add_f32 v38, v38, v46
    v_mfma_f32_16x16x32_bf16 v[64:67], a[184:187], v[140:143], v[64:67]
    v_add_f32 v39, v39, v47
    v_mfma_f32_16x16x32_bf16 v[80:83], a[188:191], v[140:143], v[80:83]
    v_mfma_f32_16x16x32_bf16 v[96:99], v[92:95], v[140:143], v[96:99]
    s_nop 0
    v_pk_add_f32 v[32:33], v[32:33], v[36:37]
    v_pk_add_f32 v[34:35], v[34:35], v[38:39]
    v_pk_add_f32 v[48:49], v[48:49], v[52:53]
    v_pk_add_f32 v[50:51], v[50:51], v[54:55]
    v_cvt_pk_bf16_f32 v176, v32, v33
    v_cvt_pk_bf16_f32 v177, v34, v35
    ds_write_b64 v238, v[176:177] offset:0
    v_cvt_pk_bf16_f32 v178, v48, v49
    v_cvt_pk_bf16_f32 v179, v50, v51
    ds_write_b64 v238, v[178:179] offset:32
    v_cvt_pk_bf16_f32 v180, v64, v65
    v_cvt_pk_bf16_f32 v181, v66, v67
    ds_write_b64 v238, v[180:181] offset:64
    v_cvt_pk_bf16_f32 v182, v80, v81
    v_cvt_pk_bf16_f32 v183, v82, v83
    ds_write_b64 v238, v[182:183] offset:96
    ds_read_b128 v[216:219], v244 offset:0
    ds_read_b128 v[220:223], v244 offset:1408
    v_cvt_pk_bf16_f32 v184, v96, v97
    v_cvt_pk_bf16_f32 v185, v98, v99
    ds_write_b64 v238, v[184:185] offset:128
    ds_read_b64 v[224:225], v252 offset:128
    s_waitcnt lgkmcnt(3)
    buffer_store_dwordx4 v[216:219], v22, s[28:31], s71 offen
    s_waitcnt lgkmcnt(2)
    buffer_store_dwordx4 v[220:223], v22, s[28:31], s72 offen
    s_waitcnt lgkmcnt(0)
    buffer_store_dwordx2 v[224:225], v26, s[28:31], s73 offen
L_end:
    s_endpgm
L_p2_alt:
    s_add_u32 s57, s57, 27648
    buffer_load_dwordx4 v11, s[16:19], s57 offen offset:3072 lds
    s_xor_b32 s66, s44, 3
    s_lshl2_add_u32 s66, s51, s66
    s_mul_i32 s66, s66, 66816
    s_lshl2_add_u32 s66, s52, s66
    s_lshl_b32 s86, s65, 10
    s_add_u32 s58, s86, s66
    s_add_u32 s86, s66, 14336
    buffer_load_dwordx4 v[128:131], v23, s[24:27], s58 offen offset:0 sc1
    s_add_u32 s58, s58, 1024
    s_cmp_eq_u32 s58, s86
    s_cselect_b32 s58, s66, s58
    buffer_load_dwordx4 v[132:135], v23, s[24:27], s58 offen offset:0 sc1
    s_add_u32 s58, s58, 1024
    s_cmp_eq_u32 s58, s86
    s_cselect_b32 s58, s66, s58
    buffer_load_dwordx4 v[136:139], v23, s[24:27], s58 offen offset:0 sc1
    s_add_u32 s58, s58, 1024
    s_cmp_eq_u32 s58, s86
    s_cselect_b32 s58, s66, s58
    buffer_load_dwordx4 v[140:143], v23, s[24:27], s58 offen offset:0 sc1
    s_add_u32 s58, s58, 1024
    s_cmp_eq_u32 s58, s86
    s_cselect_b32 s58, s66, s58
    buffer_load_dwordx4 v[144:147], v23, s[24:27], s58 offen offset:0 sc1
    s_add_u32 s58, s58, 1024
    s_cmp_eq_u32 s58, s86
    s_cselect_b32 s58, s66, s58
    buffer_load_dwordx4 v[148:151], v23, s[24:27], s58 offen offset:0 sc1
    s_add_u32 s58, s58, 1024
    s_cmp_eq_u32 s58, s86
    s_cselect_b32 s58, s66, s58
    buffer_load_dwordx4 v[152:155], v23, s[24:27], s58 offen offset:0 sc1
    s_add_u32 s58, s58, 1024
    s_cmp_eq_u32 s58, s86
    s_cselect_b32 s58, s66, s58
    buffer_load_dwordx4 v[156:159], v23, s[24:27], s58 offen offset:0 sc1
    s_add_u32 s58, s58, 1024
    s_cmp_eq_u32 s58, s86
    s_cselect_b32 s58, s66, s58
    buffer_load_dwordx4 v[112:115], v23, s[24:27], s58 offen offset:0 sc1
    s_add_u32 s58, s58, 1024
    s_cmp_eq_u32 s58, s86
    s_cselect_b32 s58, s66, s58
    buffer_load_dwordx4 v[116:119], v23, s[24:27], s58 offen offset:0 sc1
    s_add_u32 s58, s58, 1024
    s_cmp_eq_u32 s58, s86
    s_cselect_b32 s58, s66, s58
    buffer_load_dwordx4 v[120:123], v23, s[24:27], s58 offen offset:0 sc1
    s_waitcnt vmcnt(19)
    ds_read_b64_tr_b16 a[208:209], v4 offset:32768
    ds_read_b64_tr_b16 a[210:211], v4 offset:33280
    ds_read_b64_tr_b16 a[212:213], v5 offset:32768
    ds_read_b64_tr_b16 a[214:215], v5 offset:33280
    ds_read_b64_tr_b16 a[216:217], v4 offset:33024
    ds_read_b64_tr_b16 a[218:219], v4 offset:33536
    ds_read_b64_tr_b16 a[220:221], v5 offset:33024
    ds_read_b64_tr_b16 a[222:223], v5 offset:33536
    s_waitcnt vmcnt(15)
    ds_read_b64_tr_b16 a[224:225], v2 offset:0
    ds_read_b64_tr_b16 a[226:227], v2 offset:512
    ds_read_b64_tr_b16 a[228:229], v3 offset:0
    ds_read_b64_tr_b16 a[230:231], v3 offset:512
    ds_read_b64_tr_b16 a[232:233], v2 offset:256
    ds_read_b64_tr_b16 a[234:235], v2 offset:768
    ds_read_b64_tr_b16 a[236:237], v3 offset:256
    ds_read_b64_tr_b16 a[238:239], v3 offset:768
    s_waitcnt vmcnt(11)
    ds_read_b64_tr_b16 a[240:241], v2 offset:16384
    ds_read_b64_tr_b16 a[242:243], v2 offset:16896
    ds_read_b64_tr_b16 a[244:245], v3 offset:16384
    ds_read_b64_tr_b16 a[246:247], v3 offset:16896
    ds_read_b64_tr_b16 a[248:249], v2 offset:16640
    ds_read_b64_tr_b16 a[250:251], v2 offset:17152
    ds_read_b64_tr_b16 a[252:253], v3 offset:16640
    ds_read_b64_tr_b16 a[254:255], v3 offset:17152
    s_waitcnt lgkmcnt(0)
    s_branch L_p2_join
L_p3_alt:
    s_add_u32 s66, s69, 175872
    s_add_u32 s58, s66, s76
    buffer_load_dwordx4 v[152:155], v23, s[24:27], s58 offen offset:0 sc1
    buffer_load_dwordx4 v[156:159], v23, s[24:27], s58 offen offset:1024 sc1
    s_add_u32 s58, s66, s77
    buffer_load_dwordx4 v[112:115], v23, s[24:27], s58 offen offset:0 sc1
    buffer_load_dwordx4 v[116:119], v23, s[24:27], s58 offen offset:1024 sc1
    s_add_u32 s58, s66, s78
    buffer_load_dwordx4 v[120:123], v23, s[24:27], s58 offen offset:0 sc1
    buffer_load_dwordx4 v[124:127], v23, s[24:27], s58 offen offset:1024 sc1
    s_add_u32 s58, s66, s79
    buffer_load_dwordx4 v[128:131], v23, s[24:27], s58 offen offset:0 sc1
    buffer_load_dwordx4 v[132:135], v23, s[24:27], s58 offen offset:1024 sc1
    s_add_u32 s58, s66, s80
    buffer_load_dwordx4 v[136:139], v23, s[24:27], s58 offen offset:0 sc1
    buffer_load_dwordx4 v[140:143], v23, s[24:27], s58 offen offset:1024 sc1
    s_add_u32 s58, s66, s81
    buffer_load_dwordx4 v[144:147], v23, s[24:27], s58 offen offset:0 sc1
    s_waitcnt vmcnt(11) lgkmcnt(0)
    s_branch L_p3_join
L_help:
    s_sub_u32 s55, s46, 21
    v_lshlrev_b32 v217, 7, v1
    v_lshrrev_b32 v218, 2, v1
    v_lshlrev_b32 v218, 12, v218
    v_lshl_add_u32 v218, v210, 7, v218
    v_mul_u32_u24 v220, 3584, v1
    s_lshl4_add_u32 s54, s44, s65
    s_mul_i32 s54, s54, 114688
    s_lshl_b32 s56, s50, 7
    s_add_u32 s54, s54, s56
    buffer_load_dword v108, v220, s[16:19], s54 offen
    v_mul_u32_u24 v109, 1088, v25
    v_lshl_add_u32 v109, v26, 4, v109
    v_mul_u32_u24 v110, 1088, v209
    v_lshl_add_u32 v110, v208, 5, v110
    v_lshl_add_u32 v110, v210, 3, v110
    s_lshl_b32 s53, s44, 7
    v_add_u32 v110, s53, v110
    v_mul_u32_u24 v111, 66816, v208
    v_lshl_add_u32 v111, v211, 4, v111
    s_mul_i32 s63, s44, 267264
    s_lshl_b32 s53, s2, 8
    s_add_u32 s63, s63, s53
    s_add_u32 s64, s63, 1069056
    v_cmp_gt_u32 vcc, 208, v0
    v_mov_b32 v100, 2130706432
    v_cmp_le_u32 s[92:93], 24, v26
    v_cndmask_b32 v22, v100, v111, vcc
    s_mov_b32 s62, 0x3f803f80
    s_mov_b32 s61, 0xffff0000
    v_mov_b32 v96, 0
    v_mov_b32 v97, 0
    s_waitcnt vmcnt(3)
    v_dot2c_f32_bf16 v96, s62, v32
    v_dot2c_f32_bf16 v97, v32, v32
    v_lshlrev_b32 v40, 16, v32
    v_and_b32 v41, s61, v32
    v_dot2c_f32_bf16 v96, s62, v33
    v_dot2c_f32_bf16 v97, v33, v33
    v_lshlrev_b32 v42, 16, v33
    v_and_b32 v43, s61, v33
    v_dot2c_f32_bf16 v96, s62, v34
    v_dot2c_f32_bf16 v97, v34, v34
    v_lshlrev_b32 v44, 16, v34
    v_and_b32 v45, s61, v34
    v_dot2c_f32_bf16 v96, s62, v35
    v_dot2c_f32_bf16 v97, v35, v35
    v_lshlrev_b32 v46, 16, v35
    v_and_b32 v47, s61, v35
    s_waitcnt vmcnt(2)
    v_dot2c_f32_bf16 v96, s62, v36
    v_dot2c_f32_bf16 v97, v36, v36
    v_lshlrev_b32 v48, 16, v36
    v_and_b32 v49, s61, v36
    v_dot2c_f32_bf16 v96, s62, v37
    v_dot2c_f32_bf16 v97, v37, v37
    v_lshlrev_b32 v50, 16, v37
    v_and_b32 v51, s61, v37
    v_dot2c_f32_bf16 v96, s62, v38
    v_dot2c_f32_bf16 v97, v38, v38
    v_lshlrev_b32 v52, 16, v38
    v_and_b32 v53, s61, v38
    v_dot2c_f32_bf16 v96, s62, v39
    v_dot2c_f32_bf16 v97, v39, v39
    v_lshlrev_b32 v54, 16, v39
    v_and_b32 v55, s61, v39
    buffer_load_dword v29, off, s[40:43], 0 sc1
    v_add_f32_dpp v96, v96, v96 quad_perm:[1,0,3,2] row_mask:0xf bank_mask:0xf
    v_add_f32_dpp v97, v97, v97 quad_perm:[1,0,3,2] row_mask:0xf bank_mask:0xf
    s_nop 0
    v_add_f32_dpp v96, v96, v96 quad_perm:[2,3,0,1] row_mask:0xf bank_mask:0xf
    v_add_f32_dpp v97, v97, v97 quad_perm:[2,3,0,1] row_mask:0xf bank_mask:0xf
    s_nop 0
    v_add_f32_dpp v96, v96, v96 row_half_mirror row_mask:0xf bank_mask:0xf
    v_add_f32_dpp v97, v97, v97 row_half_mirror row_mask:0xf bank_mask:0xf
    s_nop 0
    v_add_f32_dpp v96, v96, v96 row_mirror row_mask:0xf bank_mask:0xf
    v_add_f32_dpp v97, v97, v97 row_mirror row_mask:0xf bank_mask:0xf
    v_mov_b32 v98, v96
    v_mov_b32 v99, v97
    s_nop 0
    v_permlane16_swap_b32 v96, v98
    v_permlane16_swap_b32 v97, v99
    v_add_f32 v96, v96, v98
    v_add_f32 v97, v97, v99
    v_mul_f32 v98, 0x3b124925, v96
    v_mul_f32 v99, 0x3b124925, v97
    v_fma_f32 v99, -v98, v98, v99
    v_max_f32 v99, 0, v99
    v_cvt_pk_bf16_f32 v100, 0, v99
    v_add_f32 v100, 0x3727c5ac, v100
    v_cvt_pk_bf16_f32 v100, 0, v100
    v_sqrt_f32 v100, v100
    s_nop 0
    v_cvt_pk_bf16_f32 v100, 0, v100
    v_rcp_f32 v100, v100
    s_nop 0
    v_mul_f32 v99, v99, v100
    v_mul_f32 v99, v99, v100
    v_cvt_pk_bf16_f32 v104, 0, v99
    v_add_f32 v104, 0x3727c5ac, v104
    v_cvt_pk_bf16_f32 v104, 0, v104
    v_sqrt_f32 v104, v104
    s_nop 0
    v_cvt_pk_bf16_f32 v102, 0, v104
    v_rcp_f32 v104, v102
    s_nop 0
    v_mul_f32 v104, v104, v100
    v_mul_f32 v106, v98, v104
    v_pk_fma_f32 v[56:57], v[40:41], v[104:105], v[106:107] op_sel_hi:[1,0,0] neg_lo:[0,0,1] neg_hi:[0,0,1]
    v_pk_fma_f32 v[58:59], v[42:43], v[104:105], v[106:107] op_sel_hi:[1,0,0] neg_lo:[0,0,1] neg_hi:[0,0,1]
    v_pk_fma_f32 v[60:61], v[44:45], v[104:105], v[106:107] op_sel_hi:[1,0,0] neg_lo:[0,0,1] neg_hi:[0,0,1]
    v_pk_fma_f32 v[62:63], v[46:47], v[104:105], v[106:107] op_sel_hi:[1,0,0] neg_lo:[0,0,1] neg_hi:[0,0,1]
    v_pk_fma_f32 v[64:65], v[48:49], v[104:105], v[106:107] op_sel_hi:[1,0,0] neg_lo:[0,0,1] neg_hi:[0,0,1]
    v_pk_fma_f32 v[66:67], v[50:51], v[104:105], v[106:107] op_sel_hi:[1,0,0] neg_lo:[0,0,1] neg_hi:[0,0,1]
    v_pk_fma_f32 v[68:69], v[52:53], v[104:105], v[106:107] op_sel_hi:[1,0,0] neg_lo:[0,0,1] neg_hi:[0,0,1]
    v_pk_fma_f32 v[70:71], v[54:55], v[104:105], v[106:107] op_sel_hi:[1,0,0] neg_lo:[0,0,1] neg_hi:[0,0,1]
    v_cvt_pk_bf16_f32 v80, v56, v57
    v_cvt_pk_bf16_f32 v81, v58, v59
    v_cvt_pk_bf16_f32 v82, v60, v61
    v_cvt_pk_bf16_f32 v83, v62, v63
    v_cvt_pk_bf16_f32 v84, v64, v65
    v_cvt_pk_bf16_f32 v85, v66, v67
    v_cvt_pk_bf16_f32 v86, v68, v69
    v_cvt_pk_bf16_f32 v87, v70, v71
    v_lshrrev_b32 v102, 16, v102
    v_cndmask_b32 v84, v84, v102, s[92:93]
    ds_write_b128 v109, v[80:83] offset:0
    ds_write_b128 v109, v[84:87] offset:512
    s_waitcnt lgkmcnt(0)
    s_barrier
    ds_read_b64_tr_b16 v[88:89], v110 offset:0
    ds_read_b64_tr_b16 v[90:91], v110 offset:4352
    ds_read_b64_tr_b16 v[92:93], v110 offset:512
    ds_read_b64_tr_b16 v[94:95], v110 offset:4864
    s_waitcnt lgkmcnt(2)
    buffer_store_dwordx4 v[88:91], v111, s[24:27], s63 offen sc1
    s_waitcnt lgkmcnt(0)
    buffer_store_dwordx4 v[92:95], v22, s[24:27], s64 offen sc1
    v_min_u32 v220, 111104, v220
    s_add_u32 s54, s54, 229376
    buffer_load_dword v108, v220, s[16:19], s54 offen
    s_waitcnt vmcnt(1)
    v_cmp_eq_u32 vcc, 0, v29
    s_nop 0
    s_cbranch_vccz L_ok12
    s_mov_b32 s59, 100000
L_spin11:
    buffer_load_dword v29, off, s[40:43], 0 sc1
    s_waitcnt vmcnt(0)
    v_cmp_eq_u32 vcc, 0, v29
    s_nop 0
    s_cbranch_vccz L_ok12
    s_sub_u32 s59, s59, 1
    s_cbranch_scc0 L_spin11
L_ok12:
    v_readfirstlane_b32 s47, v29
    s_barrier
    s_cmp_lg_u32 s44, 0
    s_cbranch_scc1 L_nopub13
    s_lshl_b32 s60, s2, 5
    s_add_u32 s60, s60, 12582912
    v_mov_b32 v30, s47
    s_mov_b64 exec, 1
    buffer_store_dword v30, off, s[24:27], s60 sc1
    s_mov_b64 exec, -1
L_nopub13:
    buffer_load_dword v108, v217, s[32:35], 0 offen
    v_lshrrev_b32 v219, 2, v1
    v_min_u32 v219, 10, v219
    v_mul_u32_u24 v219, 3584, v219
    v_lshl_add_u32 v219, v210, 7, v219
    s_mul_i32 s54, s55, 11
    s_lshl_b32 s56, s44, 9
    s_add_u32 s54, s54, s56
    s_add_u32 s54, s54, 448
    s_mul_i32 s54, s54, 3584
    s_mul_i32 s56, s45, 7
    s_lshr_b32 s56, s56, 1
    s_lshl_b32 s56, s56, 7
    s_add_u32 s54, s54, s56
    buffer_load_dword v108, v219, s[16:19], s54 offen
    s_add_u32 s54, s54, 118272
    buffer_load_dword v108, v219, s[16:19], s54 offen
    s_add_u32 s54, s54, 118272
    s_lshl_b32 s54, s44, 11
    s_add_u32 s54, s54, 12582912
    v_lshl_add_u32 v221, v1, 5, s54
    buffer_load_dword v222, v221, s[24:27], 0 offen sc1
    s_waitcnt vmcnt(0)
    v_cmp_ne_u32 vcc, s47, v222
    s_nop 0
    s_cbranch_vccz L_ok15
    s_mov_b32 s59, 100000
L_spin14:
    buffer_load_dword v222, v221, s[24:27], 0 offen sc1
    s_waitcnt vmcnt(0)
    v_cmp_ne_u32 vcc, s47, v222
    s_nop 0
    s_cbranch_vccz L_ok15
    s_sub_u32 s59, s59, 1
    s_cbranch_scc0 L_spin14
L_ok15:
    s_add_u32 s54, s55, 0
    s_lshr_b32 s56, s54, 1
    s_add_u32 s56, s56, 24
    s_mul_i32 s56, s56, 66816
    s_lshl2_add_u32 s56, s52, s56
    s_and_b32 s54, s54, 1
    s_lshl_b32 s54, s54, 13
    s_add_u32 s56, s56, s54
    buffer_load_dword v108, v217, s[24:27], s56 offen sc1
    s_add_u32 s54, s55, 3
    s_lshr_b32 s56, s54, 1
    s_add_u32 s56, s56, 24
    s_mul_i32 s56, s56, 66816
    s_lshl2_add_u32 s56, s52, s56
    s_and_b32 s54, s54, 1
    s_lshl_b32 s54, s54, 13
    s_add_u32 s56, s56, s54
    buffer_load_dword v108, v217, s[24:27], s56 offen sc1
    s_add_u32 s54, s55, 6
    s_lshr_b32 s56, s54, 1
    s_add_u32 s56, s56, 24
    s_mul_i32 s56, s56, 66816
    s_lshl2_add_u32 s56, s52, s56
    s_and_b32 s54, s54, 1
    s_lshl_b32 s54, s54, 13
    s_add_u32 s56, s56, s54
    s_cmp_lt_u32 s55, 2
    s_cselect_b32 s56, s56, 2130706432
    buffer_load_dword v108, v217, s[24:27], s56 offen sc1
    s_mul_i32 s54, s44, 28
    s_add_u32 s54, s54, s55
    s_add_u32 s54, s54, 0
    s_lshl_b32 s54, s54, 16
    s_lshl_b32 s56, s45, 9
    s_add_u32 s54, s54, s56
    buffer_load_dword v108, v218, s[20:23], s54 offen
    s_add_u32 s54, s54, 196608
    buffer_load_dword v108, v218, s[20:23], s54 offen
    s_add_u32 s54, s54, 196608
    buffer_load_dword v108, v218, s[20:23], s54 offen
    s_add_u32 s54, s54, 196608
    buffer_load_dword v108, v218, s[20:23], s54 offen
    s_add_u32 s54, s54, 196608
    buffer_load_dword v108, v217, s[36:39], 0 offen
    s_waitcnt vmcnt(0) lgkmcnt(0)
    v_lshlrev_b32 v216, 6, v209
    v_lshl_add_u32 v216, v210, 3, v216
    v_lshl_add_u32 v216, v215, 5, v216
    s_add_u32 s53, s52, 49152
    v_lshl_add_u32 v2, v208, 10, v216
    v_add_u32 v2, s53, v2
    v_xor_b32 v3, 32, v2
    v_add_u32 v4, 65536, v2
    v_add_u32 v5, 65536, v3
    v_lshl_add_u32 v6, v208, 9, v216
    v_add_u32 v6, s53, v6
    v_xor_b32 v7, 32, v6
    v_add_u32 v8, 65536, v6
    v_add_u32 v9, 65536, v7
    s_lshr_b32 s53, s46, 2
    s_and_b32 s89, s46, 3
    s_bfe_u32 s54, s46, 0x20001
    s_and_b32 s55, s46, 1
    s_add_u32 s55, s55, 4
    s_cmp_lt_u32 s46, 16
    s_cselect_b32 s53, s53, s54
    s_cselect_b32 s89, s89, s55
    s_mul_i32 s49, s53, 2
    s_add_u32 s49, s49, s89
    s_sub_u32 s54, s49, 6
    s_min_u32 s49, s49, s54
    s_or_b32 s89, s89, 0
    s_lshl2_add_u32 s48, s45, s53
    s_mul_i32 s53, s44, 1835008
    s_lshl_b32 s74, s48, 7
    s_add_u32 s53, s53, s74
    s_lshl_b32 s56, s44, 5
    v_lshlrev_b32 v217, 5, v212
    v_xor_b32 v217, v217, v214
    v_xor_b32 v217, s56, v217
    s_add_u32 s74, s74, s56
    v_lshlrev_b32 v12, 12, v213
    v_add3_u32 v12, v12, v217, s53
    s_mul_i32 s53, s44, 28672
    s_lshl_b32 s54, s49, 7
    s_add_u32 s55, s53, s54
    v_mul_u32_u24 v13, 896, v213
    v_add3_u32 v13, v13, v214, s55
    v_xor_b32 v14, 32, v13
    s_mul_i32 s55, s44, 21504
    v_subrev_u32 v239, s55, v13
    s_and_b32 s55, s56, 32
    v_xor_b32 v239, s55, v239
    s_mul_i32 s73, s48, 57344
    s_add_u32 s71, s73, s54
    s_mul_i32 s55, s44, 14336
    s_add_u32 s71, s71, s55
    s_add_u32 s72, s71, 7168
    v_bfe_u32 v217, v1, 1, 2
    v_lshl_add_u32 v217, v212, 2, v217
    v_and_b32 v218, 24, v1
    v_add_u32 v217, v217, v218
    v_mul_u32_u24 v15, 896, v217
    v_and_b32 v217, 1, v1
    v_lshl_add_u32 v15, v217, 4, v15
    v_add_u32 v15, s53, v15
    s_lshl_b32 s54, s89, 5
    s_add_u32 s54, s54, 768
    s_add_u32 s68, s89, 24
    s_mul_i32 s68, s68, 58624
    s_mul_i32 s69, s44, 14336
    s_add_u32 s69, s69, 2097152
    s_add_u32 s68, s68, s69
    s_mul_i32 s55, s49, 234496
    s_add_u32 s69, s69, s55
    s_add_u32 s73, s73, s54
    s_mov_b32 s76, 0
    s_add_u32 s77, s76, 2048
    s_cmp_eq_u32 s77, 14336
    s_cselect_b32 s77, 0, s77
    s_add_u32 s78, s77, 2048
    s_cmp_eq_u32 s78, 14336
    s_cselect_b32 s78, 0, s78
    s_add_u32 s79, s78, 2048
    s_cmp_eq_u32 s79, 14336
    s_cselect_b32 s79, 0, s79
    s_add_u32 s80, s79, 2048
    s_cmp_eq_u32 s80, 14336
    s_cselect_b32 s80, 0, s80
    s_add_u32 s81, s80, 2048
    s_cmp_eq_u32 s81, 14336
    s_cselect_b32 s81, 0, s81
    s_add_u32 s82, s81, 2048
    s_cmp_eq_u32 s82, 14336
    s_cselect_b32 s82, 0, s82
    s_cmp_lt_u32 s89, 4
    s_cselect_b32 s75, s54, 2130706432
    s_cselect_b32 s68, s68, 2130706432
    s_cselect_b32 s73, s73, 2130706432
    v_lshlrev_b32 v16, 3, v1
    v_add_u32 v16, 81920, v16
    v_and_b32 v217, 7, v1
    v_min_u32 v218, 6, v217
    s_mul_i32 s54, s44, 7
    v_add_u32 v218, s54, v218
    v_mul_u32_u24 v219, 2, v218
    v_add_u32 v219, s89, v219
    v_mul_u32_u24 v220, 43, v219
    v_lshrrev_b32 v220, 8, v220
    v_mul_u32_u24 v220, 6, v220
    v_sub_u32 v219, v219, v220
    v_subrev_u32 v219, s49, v219
    v_bfe_u32 v220, v1, 3, 1
    v_mul_i32_i24 v219, v219, v220
    v_add_u32 v219, s49, v219
    v_lshl_add_u32 v218, v219, 5, v218
    v_lshlrev_b32 v20, 7, v218
    v_add_u32 v20, 12713984, v20
    s_lshr_b32 s53, s48, 1
    s_lshl_b32 s53, s53, 7
    s_add_u32 s53, s53, 12779520
    v_lshl_add_u32 v21, v210, 11, s53
    s_lshl_b32 s70, s48, 16
    s_lshl2_add_u32 s70, s52, s70
    s_add_u32 s70, s70, 4194304
    v_lshrrev_b32 v218, 3, v1
    v_mul_u32_u24 v22, 896, v218
    v_lshl_add_u32 v22, v217, 4, v22
    v_lshlrev_b32 v25, 1, v211
    s_add_u32 s53, s52, 65536
    v_mul_u32_u24 v244, 176, v218
    v_lshl_add_u32 v244, v217, 4, v244
    v_add_u32 v244, s53, v244
    v_mul_u32_u24 v238, 176, v211
    v_lshl_add_u32 v238, v208, 3, v238
    v_add_u32 v238, s53, v238
    v_lshrrev_b32 v218, 2, v0
    v_mul_u32_u24 v26, 896, v218
    v_lshl_add_u32 v26, v210, 3, v26
    v_lshrrev_b32 v218, 2, v1
    v_mul_u32_u24 v252, 176, v218
    v_lshl_add_u32 v252, v210, 3, v252
    v_add_u32 v252, s53, v252
    s_sub_u32 s53, 49152, s52
    v_add_u32 v246, s53, v2
    v_add_u32 v247, s53, v3
    v_mul_u32_u24 v218, 3072, v208
    v_add_u32 v248, v218, v246
    v_add_u32 v249, v218, v247
    v_add_u32 v232, s52, v23
    v_xor_b32 v233, 4096, v232
    v_xor_b32 v234, 8192, v232
    v_xor_b32 v235, 12288, v232
    buffer_load_dwordx4 v[216:219], v22, s[4:7], s71 offen
    buffer_load_dwordx4 v[220:223], v22, s[4:7], s72 offen
    buffer_load_dwordx2 v[224:225], v26, s[4:7], s73 offen
    buffer_load_ushort v228, v25, s[36:39], s74 offen
    s_waitcnt vmcnt(0)
    ds_write_b128 v244, v[216:219]
    ds_write_b128 v244, v[220:223] offset:1408
    ds_write_b64 v252, v[224:225] offset:128
    ds_read_b64 v[216:217], v238 offset:0
    ds_read_b64 v[218:219], v238 offset:32
    ds_read_b64 v[220:221], v238 offset:64
    ds_read_b64 v[222:223], v238 offset:96
    ds_read_b64 v[224:225], v238 offset:128
    s_add_u32 m0, s52, 81920
    s_lshl_b32 s57, s76, 7
    buffer_load_dwordx4 v12, s[20:23], s57 offen offset:0 lds
    s_add_u32 s57, s57, 31744
    buffer_load_dwordx4 v12, s[20:23], s57 offen offset:1024 lds
    s_add_u32 s57, s57, 31744
    buffer_load_dwordx4 v12, s[20:23], s57 offen offset:2048 lds
    s_add_u32 s57, s57, 31744
    buffer_load_dwordx4 v12, s[20:23], s57 offen offset:3072 lds
    s_add_u32 m0, s52, 98304
    s_lshl_b32 s57, s76, 7
    s_add_u32 s57, s57, 131072
    buffer_load_dwordx4 v12, s[20:23], s57 offen offset:0 lds
    s_add_u32 s57, s57, 31744
    buffer_load_dwordx4 v12, s[20:23], s57 offen offset:1024 lds
    s_add_u32 s57, s57, 31744
    buffer_load_dwordx4 v12, s[20:23], s57 offen offset:2048 lds
    s_add_u32 s57, s57, 31744
    buffer_load_dwordx4 v12, s[20:23], s57 offen offset:3072 lds
    s_add_u32 m0, s52, 114688
    s_lshl_b32 s57, s77, 7
    buffer_load_dwordx4 v12, s[20:23], s57 offen offset:0 lds
    s_add_u32 s57, s57, 31744
    buffer_load_dwordx4 v12, s[20:23], s57 offen offset:1024 lds
    s_add_u32 s57, s57, 31744
    buffer_load_dwordx4 v12, s[20:23], s57 offen offset:2048 lds
    s_add_u32 s57, s57, 31744
    buffer_load_dwordx4 v12, s[20:23], s57 offen offset:3072 lds
    s_add_u32 m0, s52, 131072
    s_lshl_b32 s57, s77, 7
    s_add_u32 s57, s57, 131072
    buffer_load_dwordx4 v12, s[20:23], s57 offen offset:0 lds
    s_add_u32 s57, s57, 31744
    buffer_load_dwordx4 v12, s[20:23], s57 offen offset:1024 lds
    s_waitcnt vmcnt(10)
    ds_read_b64_tr_b16 a[0:1], v6 offset:32768
    ds_read_b64_tr_b16 a[2:3], v6 offset:34816
    ds_read_b64_tr_b16 a[4:5], v7 offset:32768
    ds_read_b64_tr_b16 a[6:7], v7 offset:34816
    ds_read_b64_tr_b16 a[8:9], v6 offset:33024
    ds_read_b64_tr_b16 a[10:11], v6 offset:35072
    ds_read_b64_tr_b16 a[12:13], v7 offset:33024
    ds_read_b64_tr_b16 a[14:15], v7 offset:35072
    s_add_u32 s57, s57, 31744
    buffer_load_dwordx4 v12, s[20:23], s57 offen offset:2048 lds
    s_add_u32 s57, s57, 31744
    buffer_load_dwordx4 v12, s[20:23], s57 offen offset:3072 lds
    s_add_u32 m0, s52, 147456
    s_lshl_b32 s57, s78, 7
    buffer_load_dwordx4 v12, s[20:23], s57 offen offset:0 lds
    s_add_u32 s57, s57, 31744
    buffer_load_dwordx4 v12, s[20:23], s57 offen offset:1024 lds
    s_waitcnt vmcnt(10)
    ds_read_b64_tr_b16 a[16:17], v6 offset:49152
    ds_read_b64_tr_b16 a[18:19], v6 offset:51200
    ds_read_b64_tr_b16 a[20:21], v7 offset:49152
    ds_read_b64_tr_b16 a[22:23], v7 offset:51200
    ds_read_b64_tr_b16 a[24:25], v6 offset:49408
    ds_read_b64_tr_b16 a[26:27], v6 offset:51456
    ds_read_b64_tr_b16 a[28:29], v7 offset:49408
    ds_read_b64_tr_b16 a[30:31], v7 offset:51456
    s_add_u32 s57, s57, 31744
    buffer_load_dwordx4 v12, s[20:23], s57 offen offset:2048 lds
    s_add_u32 s57, s57, 31744
    buffer_load_dwordx4 v12, s[20:23], s57 offen offset:3072 lds
    s_add_u32 m0, s52, 49152
    s_lshl_b32 s57, s78, 7
    s_add_u32 s57, s57, 131072
    buffer_load_dwordx4 v12, s[20:23], s57 offen offset:0 lds
    s_add_u32 s57, s57, 31744
    buffer_load_dwordx4 v12, s[20:23], s57 offen offset:1024 lds
    s_waitcnt vmcnt(10)
    ds_read_b64_tr_b16 a[32:33], v8 offset:0
    ds_read_b64_tr_b16 a[34:35], v8 offset:2048
    ds_read_b64_tr_b16 a[36:37], v9 offset:0
    ds_read_b64_tr_b16 a[38:39], v9 offset:2048
    ds_read_b64_tr_b16 a[40:41], v8 offset:256
    ds_read_b64_tr_b16 a[42:43], v8 offset:2304
    ds_read_b64_tr_b16 a[44:45], v9 offset:256
    ds_read_b64_tr_b16 a[46:47], v9 offset:2304
    s_add_u32 s57, s57, 31744
    buffer_load_dwordx4 v12, s[20:23], s57 offen offset:2048 lds
    s_add_u32 s57, s57, 31744
    buffer_load_dwordx4 v12, s[20:23], s57 offen offset:3072 lds
    s_waitcnt lgkmcnt(15)
    s_add_u32 m0, s52, 65536
    s_lshl_b32 s57, s79, 7
    buffer_load_dwordx4 v12, s[20:23], s57 offen offset:0 lds
    s_add_u32 s57, s57, 31744
    buffer_load_dwordx4 v12, s[20:23], s57 offen offset:1024 lds
    s_waitcnt vmcnt(10)
    ds_read_b64_tr_b16 a[48:49], v8 offset:16384
    ds_read_b64_tr_b16 a[50:51], v8 offset:18432
    ds_read_b64_tr_b16 a[52:53], v9 offset:16384
    ds_read_b64_tr_b16 a[54:55], v9 offset:18432
    s_add_u32 s57, s57, 31744
    buffer_load_dwordx4 v12, s[20:23], s57 offen offset:2048 lds
    ds_read_b64_tr_b16 a[56:57], v8 offset:16640
    ds_read_b64_tr_b16 a[58:59], v8 offset:18688
    ds_read_b64_tr_b16 a[60:61], v9 offset:16640
    ds_read_b64_tr_b16 a[62:63], v9 offset:18688
    s_add_u32 s57, s57, 31744
    buffer_load_dwordx4 v12, s[20:23], s57 offen offset:3072 lds
    s_add_u32 m0, s52, 81920
    s_lshl_b32 s57, s79, 7
    s_add_u32 s57, s57, 131072
    buffer_load_dwordx4 v12, s[20:23], s57 offen offset:0 lds
    s_add_u32 s57, s57, 31744
    buffer_load_dwordx4 v12, s[20:23], s57 offen offset:1024 lds
    s_waitcnt vmcnt(10)
    ds_read_b64_tr_b16 a[64:65], v8 offset:32768
    ds_read_b64_tr_b16 a[66:67], v8 offset:34816
    ds_read_b64_tr_b16 a[68:69], v9 offset:32768
    ds_read_b64_tr_b16 a[70:71], v9 offset:34816
    s_add_u32 s57, s57, 31744
    buffer_load_dwordx4 v12, s[20:23], s57 offen offset:2048 lds
    ds_read_b64_tr_b16 a[72:73], v8 offset:33024
    ds_read_b64_tr_b16 a[74:75], v8 offset:35072
    ds_read_b64_tr_b16 a[76:77], v9 offset:33024
    ds_read_b64_tr_b16 a[78:79], v9 offset:35072
    s_add_u32 s57, s57, 31744
    buffer_load_dwordx4 v12, s[20:23], s57 offen offset:3072 lds
    s_waitcnt lgkmcnt(15)
    s_add_u32 m0, s52, 98304
    s_lshl_b32 s57, s80, 7
    buffer_load_dwordx4 v12, s[20:23], s57 offen offset:0 lds
    s_add_u32 s57, s57, 31744
    buffer_load_dwordx4 v12, s[20:23], s57 offen offset:1024 lds
    s_waitcnt vmcnt(10)
    ds_read_b64_tr_b16 a[80:81], v6 offset:0
    ds_read_b64_tr_b16 a[82:83], v6 offset:2048
    ds_read_b64_tr_b16 a[84:85], v7 offset:0
    ds_read_b64_tr_b16 a[86:87], v7 offset:2048
    s_add_u32 s57, s57, 31744
    buffer_load_dwordx4 v12, s[20:23], s57 offen offset:2048 lds
    ds_read_b64_tr_b16 a[88:89], v6 offset:256
    ds_read_b64_tr_b16 a[90:91], v6 offset:2304
    ds_read_b64_tr_b16 a[92:93], v7 offset:256
    ds_read_b64_tr_b16 a[94:95], v7 offset:2304
    s_waitcnt vmcnt(0) lgkmcnt(0)
    s_branch L_p3join
L_role_a:
    v_lshrrev_b32 v112, 4, v1
    v_bfe_u32 v113, v1, 2, 2
    v_and_b32 v114, 3, v1
    v_and_b32 v115, 15, v1
    v_lshrrev_b32 v116, 5, v1
    s_and_b32 s48, s45, 6
    s_lshr_b32 s48, 0xc9, s48
    s_and_b32 s48, s48, 3
    s_and_b32 s53, s45, 1
    s_lshl3_add_u32 s49, s53, s46
    s_sub_u32 s49, s49, 24
    s_lshl_b32 s90, s44, 11
    s_and_b32 s53, s44, 1
    s_lshl_b32 s53, s53, 1
    v_lshlrev_b32 v117, 2, v112
    v_sub_u32 v117, v115, v117
    v_and_b32 v117, 15, v117
    v_xor_b32 v117, s53, v117
    v_mul_u32_u24 v2, 2688, v112
    v_lshl_add_u32 v2, v117, 4, v2
    s_mul_i32 s53, s44, 21504
    s_mul_i32 s54, s48, 224
    s_andn2_b32 s54, s54, 63
    s_add_u32 s53, s53, s54
    v_add_u32 v2, s53, v2
    s_add_u32 m0, s90, 65536
    s_mov_b32 s57, 896
    buffer_load_dwordx4 v2, s[8:11], s57 offen offset:0 lds
    s_mov_b32 s57, 10624
    buffer_load_dwordx4 v2, s[8:11], s57 offen offset:1024 lds
    v_mul_u32_u24 v109, 1088, v25
    v_lshl_add_u32 v109, v26, 4, v109
    v_mul_u32_u24 v110, 1088, v113
    v_lshl_add_u32 v110, v112, 5, v110
    v_lshl_add_u32 v110, v114, 3, v110
    s_lshl_b32 s53, s44, 7
    v_add_u32 v110, s53, v110
    v_mul_u32_u24 v111, 66816, v112
    v_lshl_add_u32 v111, v115, 4, v111
    s_mul_i32 s63, s44, 267264
    s_lshl_b32 s53, s2, 8
    s_add_u32 s63, s63, s53
    s_add_u32 s64, s63, 1069056
    v_cmp_gt_u32 vcc, 208, v0
    v_mov_b32 v100, 2130706432
    v_cmp_le_u32 s[92:93], 24, v26
    v_cndmask_b32 v22, v100, v111, vcc
    s_mov_b32 s62, 0x3f803f80
    s_mov_b32 s61, 0xffff0000
    v_mov_b32 v96, 0
    v_mov_b32 v97, 0
    v_and_b32 v117, 1, v112
    v_lshlrev_b32 v117, 5, v117
    s_mul_i32 s53, s44, 56
    s_and_b32 s54, s48, 1
    s_lshl_b32 s54, s54, 5
    s_add_u32 s53, s53, s54
    v_lshlrev_b32 v118, 11, v112
    v_lshl_add_u32 v118, v113, 8, v118
    v_add_u32 v118, 65536, v118
    v_lshl_add_u32 v119, v114, 3, s53
    v_add_u32 v119, 0, v119
    v_xor_b32 v119, v119, v117
    v_lshl_add_u32 v119, v113, 6, v119
    v_and_b32 v119, 255, v119
    v_add_u32 v6, v118, v119
    v_add_u32 v10, 49152, v6
    v_subrev_u32 v120, 65536, v6
    v_lshl_add_u32 v119, v114, 3, s53
    v_add_u32 v119, 32, v119
    v_xor_b32 v119, v119, v117
    v_lshl_add_u32 v119, v113, 6, v119
    v_and_b32 v119, 255, v119
    v_add_u32 v7, v118, v119
    v_add_u32 v11, 49152, v7
    v_subrev_u32 v121, 65536, v7
    s_and_b32 s54, s44, 1
    s_lshl_b32 s54, s54, 3
    s_sub_u32 s53, s53, s54
    v_lshl_add_u32 v119, v114, 4, s53
    v_add_u32 v119, 0, v119
    v_xor_b32 v119, v119, v117
    v_lshl_add_u32 v119, v113, 6, v119
    v_and_b32 v119, 255, v119
    v_add_u32 v8, v118, v119
    v_add_u32 v12, 49152, v8
    v_subrev_u32 v122, 65536, v8
    v_lshl_add_u32 v119, v114, 4, s53
    v_add_u32 v119, 8, v119
    v_xor_b32 v119, v119, v117
    v_lshl_add_u32 v119, v113, 6, v119
    v_and_b32 v119, 255, v119
    v_add_u32 v9, v118, v119
    v_add_u32 v13, 49152, v9
    v_subrev_u32 v123, 65536, v9
    s_waitcnt vmcnt(4)
    v_dot2c_f32_bf16 v96, s62, v32
    v_dot2c_f32_bf16 v97, v32, v32
    v_lshlrev_b32 v40, 16, v32
    v_and_b32 v41, s61, v32
    v_dot2c_f32_bf16 v96, s62, v33
    v_dot2c_f32_bf16 v97, v33, v33
    v_lshlrev_b32 v42, 16, v33
    v_and_b32 v43, s61, v33
    v_dot2c_f32_bf16 v96, s62, v34
    v_dot2c_f32_bf16 v97, v34, v34
    v_lshlrev_b32 v44, 16, v34
    v_and_b32 v45, s61, v34
    v_dot2c_f32_bf16 v96, s62, v35
    v_dot2c_f32_bf16 v97, v35, v35
    v_lshlrev_b32 v46, 16, v35
    v_and_b32 v47, s61, v35
    s_waitcnt vmcnt(3)
    v_dot2c_f32_bf16 v96, s62, v36
    v_dot2c_f32_bf16 v97, v36, v36
    v_lshlrev_b32 v48, 16, v36
    v_and_b32 v49, s61, v36
    v_dot2c_f32_bf16 v96, s62, v37
    v_dot2c_f32_bf16 v97, v37, v37
    v_lshlrev_b32 v50, 16, v37
    v_and_b32 v51, s61, v37
    v_dot2c_f32_bf16 v96, s62, v38
    v_dot2c_f32_bf16 v97, v38, v38
    v_lshlrev_b32 v52, 16, v38
    v_and_b32 v53, s61, v38
    v_dot2c_f32_bf16 v96, s62, v39
    v_dot2c_f32_bf16 v97, v39, v39
    v_lshlrev_b32 v54, 16, v39
    v_and_b32 v55, s61, v39
    buffer_load_dword v29, off, s[40:43], 0 sc1
    v_add_f32_dpp v96, v96, v96 quad_perm:[1,0,3,2] row_mask:0xf bank_mask:0xf
    v_add_f32_dpp v97, v97, v97 quad_perm:[1,0,3,2] row_mask:0xf bank_mask:0xf
    s_nop 0
    v_add_f32_dpp v96, v96, v96 quad_perm:[2,3,0,1] row_mask:0xf bank_mask:0xf
    v_add_f32_dpp v97, v97, v97 quad_perm:[2,3,0,1] row_mask:0xf bank_mask:0xf
    s_nop 0
    v_add_f32_dpp v96, v96, v96 row_half_mirror row_mask:0xf bank_mask:0xf
    v_add_f32_dpp v97, v97, v97 row_half_mirror row_mask:0xf bank_mask:0xf
    s_nop 0
    v_add_f32_dpp v96, v96, v96 row_mirror row_mask:0xf bank_mask:0xf
    v_add_f32_dpp v97, v97, v97 row_mirror row_mask:0xf bank_mask:0xf
    v_mov_b32 v98, v96
    v_mov_b32 v99, v97
    s_nop 0
    v_permlane16_swap_b32 v96, v98
    v_permlane16_swap_b32 v97, v99
    v_add_f32 v96, v96, v98
    v_add_f32 v97, v97, v99
    v_mul_f32 v98, 0x3b124925, v96
    v_mul_f32 v99, 0x3b124925, v97
    v_fma_f32 v99, -v98, v98, v99
    v_max_f32 v99, 0, v99
    v_cvt_pk_bf16_f32 v100, 0, v99
    v_add_f32 v100, 0x3727c5ac, v100
    v_cvt_pk_bf16_f32 v100, 0, v100
    v_sqrt_f32 v100, v100
    s_nop 0
    v_cvt_pk_bf16_f32 v100, 0, v100
    v_rcp_f32 v100, v100
    s_nop 0
    v_mul_f32 v99, v99, v100
    v_mul_f32 v99, v99, v100
    v_cvt_pk_bf16_f32 v104, 0, v99
    v_add_f32 v104, 0x3727c5ac, v104
    v_cvt_pk_bf16_f32 v104, 0, v104
    v_sqrt_f32 v104, v104
    s_nop 0
    v_cvt_pk_bf16_f32 v102, 0, v104
    v_rcp_f32 v104, v102
    s_nop 0
    v_mul_f32 v104, v104, v100
    v_mul_f32 v106, v98, v104
    v_pk_fma_f32 v[56:57], v[40:41], v[104:105], v[106:107] op_sel_hi:[1,0,0] neg_lo:[0,0,1] neg_hi:[0,0,1]
    v_pk_fma_f32 v[58:59], v[42:43], v[104:105], v[106:107] op_sel_hi:[1,0,0] neg_lo:[0,0,1] neg_hi:[0,0,1]
    v_pk_fma_f32 v[60:61], v[44:45], v[104:105], v[106:107] op_sel_hi:[1,0,0] neg_lo:[0,0,1] neg_hi:[0,0,1]
    v_pk_fma_f32 v[62:63], v[46:47], v[104:105], v[106:107] op_sel_hi:[1,0,0] neg_lo:[0,0,1] neg_hi:[0,0,1]
    v_pk_fma_f32 v[64:65], v[48:49], v[104:105], v[106:107] op_sel_hi:[1,0,0] neg_lo:[0,0,1] neg_hi:[0,0,1]
    v_pk_fma_f32 v[66:67], v[50:51], v[104:105], v[106:107] op_sel_hi:[1,0,0] neg_lo:[0,0,1] neg_hi:[0,0,1]
    v_pk_fma_f32 v[68:69], v[52:53], v[104:105], v[106:107] op_sel_hi:[1,0,0] neg_lo:[0,0,1] neg_hi:[0,0,1]
    v_pk_fma_f32 v[70:71], v[54:55], v[104:105], v[106:107] op_sel_hi:[1,0,0] neg_lo:[0,0,1] neg_hi:[0,0,1]
    v_cvt_pk_bf16_f32 v80, v56, v57
    v_cvt_pk_bf16_f32 v81, v58, v59
    v_cvt_pk_bf16_f32 v82, v60, v61
    v_cvt_pk_bf16_f32 v83, v62, v63
    v_cvt_pk_bf16_f32 v84, v64, v65
    v_cvt_pk_bf16_f32 v85, v66, v67
    v_cvt_pk_bf16_f32 v86, v68, v69
    v_cvt_pk_bf16_f32 v87, v70, v71
    v_lshrrev_b32 v102, 16, v102
    v_cndmask_b32 v84, v84, v102, s[92:93]
    ds_write_b128 v109, v[80:83] offset:49152
    ds_write_b128 v109, v[84:87] offset:49664
    s_waitcnt lgkmcnt(0)
    s_barrier
    ds_read_b64_tr_b16 v[88:89], v110 offset:49152
    ds_read_b64_tr_b16 v[90:91], v110 offset:53504
    ds_read_b64_tr_b16 v[92:93], v110 offset:49664
    ds_read_b64_tr_b16 v[94:95], v110 offset:54016
    s_waitcnt lgkmcnt(2)
    buffer_store_dwordx4 v[88:91], v111, s[24:27], s63 offen sc1
    s_waitcnt lgkmcnt(0)
    buffer_store_dwordx4 v[92:95], v22, s[24:27], s64 offen sc1
    s_add_u32 m0, s90, 73728
    s_mov_b32 s57, 86912
    buffer_load_dwordx4 v2, s[8:11], s57 offen offset:0 lds
    s_movk_i32 s94, 224
    v_mul_u32_u24 v3, 66816, v116
    v_and_b32 v118, 1, v112
    v_lshlrev_b32 v119, 2, v118
    v_xor_b32 v119, v119, v115
    v_lshl_add_u32 v3, v118, 8, v3
    v_lshl_add_u32 v3, v119, 4, v3
    v_cmp_gt_u32 s[92:93], s94, v0
    v_mov_b32 v119, 2130706432
    s_mov_b32 s57, 96640
    buffer_load_dwordx4 v2, s[8:11], s57 offen offset:1024 lds
    v_lshlrev_b32 v4, 9, v116
    v_cndmask_b32 v24, v119, v3, s[92:93]
    v_lshl_add_u32 v4, v118, 7, v4
    v_lshl_add_u32 v4, v113, 4, v4
    v_lshrrev_b32 v118, 1, v114
    v_mul_u32_u24 v118, 320, v118
    v_add_u32 v4, v118, v4
    v_and_b32 v118, 1, v114
    v_lshl_add_u32 v4, v118, 3, v4
    v_xor_b32 v25, 64, v4
    s_lshl_b32 s53, s49, 4
    s_sub_u32 s53, s53, 2
    v_min_u32 v117, 17, v1
    v_add_u32 v117, s53, v117
    v_max_i32 v117, 0, v117
    v_lshlrev_b32 v19, 5, v117
    s_add_u32 m0, s90, 81920
    s_mov_b32 s57, 172928
    buffer_load_dwordx4 v2, s[8:11], s57 offen offset:0 lds
    v_add_u32 v19, 12582912, v19
    v_and_b32 v117, 1, v115
    v_cmp_eq_u32 s[76:77], 1, v117
    v_lshl_add_u32 v117, v112, 2, v117
    v_cmp_le_u32 s[78:79], v117, v115
    v_mul_u32_u24 v118, 304, v116
    v_lshl_add_u32 v93, v117, 1, v118
    v_add_u32 v117, 2, v117
    v_cmp_le_u32 s[80:81], v117, v115
    v_add_u32 v94, 4, v93
    v_mov_b32 v118, 14336
    v_mov_b32 v119, 30720
    v_cndmask_b32 v117, v118, v119, s[78:79]
    v_add_u32 v93, v117, v93
    v_cndmask_b32 v117, v118, v119, s[80:81]
    v_add_u32 v94, v117, v94
    s_mov_b32 s57, 182656
    buffer_load_dwordx4 v2, s[8:11], s57 offen offset:1024 lds
    v_lshrrev_b32 v117, 3, v115
    v_mul_u32_u24 v117, 304, v117
    v_lshl_add_u32 v92, v115, 1, v117
    v_add_u32 v92, v119, v92
    v_cmp_eq_u32 s[82:83], 3, v112
    v_mov_b32 v117, 0xffff
    v_mov_b32 v118, 0xffff0000
    v_cndmask_b32 v117, v117, v118, s[76:77]
    v_cndmask_b32 v14, v117, 0, s[78:79]
    v_cndmask_b32 v15, v117, 0, s[80:81]
    v_cndmask_b32 v16, 0, v117, s[78:79]
    v_cndmask_b32 v17, 0, v117, s[80:81]
    s_mov_b32 s91, 0x3e8b97f6
    v_mov_b32 v18, 0xf149f2ca
    s_lshl_b32 s53, s49, 3
    s_lshl_b32 s72, s53, 9
    s_add_u32 m0, s90, 90112
    s_mov_b32 s57, 258944
    buffer_load_dwordx4 v2, s[8:11], s57 offen offset:0 lds
    s_lshl_b32 s74, s53, 14
    s_lshl2_add_u32 s54, s48, s44
    s_mul_i32 s54, s54, 7
    s_lshr_b32 s54, s54, 1
    s_lshl_b32 s54, s54, 8
    s_add_u32 s74, s74, s54
    s_add_u32 s74, s74, 4194304
    s_mul_i32 s68, s44, 534528
    s_add_u32 s68, s68, 0
    s_mul_i32 s69, s44, 534528
    s_add_u32 s69, s69, 132608
    s_mul_i32 s70, s44, 534528
    s_add_u32 s70, s70, 265216
    s_mul_i32 s71, s44, 534528
    s_add_u32 s71, s71, 397824
    s_cmp_eq_u32 s44, 3
    s_cselect_b32 s71, 2130706432, s71
    s_cmp_eq_u32 s49, 0
    s_cselect_b64 s[84:85], -1, 0
    s_andn2_b64 s[86:87], s[84:85], s[80:81]
    s_andn2_b64 s[84:85], s[84:85], s[78:79]
    s_bitcmp1_b32 s44, 0
    s_cselect_b64 s[88:89], -1, 0
    s_cselect_b32 s53, 0, 3
    s_cselect_b32 s54, 8, 0
    v_cmp_eq_u32 vcc, s53, v112
    s_lshr_b32 s53, s44, 1
    s_lshl_b32 s55, s53, 11
    s_add_u32 s54, s54, s55
    s_add_u32 s54, s54, 147456
    v_lshl_add_u32 v118, v115, 4, s54
    v_add_u32 v117, 151552, v23
    v_cndmask_b32 v95, v117, v118, vcc
    v_mov_b32 v117, 2130706432
    v_cndmask_b32 v23, v23, v117, vcc
    s_lshl1_add_u32 s53, s48, s53
    s_mul_i32 s53, s53, 1792
    s_and_b32 s54, s44, 1
    s_lshl1_add_u32 s54, s49, s54
    s_lshl_b32 s54, s54, 16
    s_add_u32 s53, s53, s54
    s_add_u32 s95, s53, 4195072
    s_and_b32 s53, s46, 7
    s_mul_i32 s54, s44, 28
    s_add_u32 s54, s54, s53
    s_add_u32 s54, s54, 12
    s_lshl_b32 s73, s54, 16
    s_lshl_b32 s54, s45, 9
    s_add_u32 s73, s73, s54
    s_lshl3_add_u32 s75, s44, s53
    s_lshl_b32 s75, s75, 13
    v_lshrrev_b32 v5, 2, v1
    v_lshlrev_b32 v5, 12, v5
    v_lshl_add_u32 v5, v114, 7, v5
    v_lshlrev_b32 v20, 7, v1
    s_mov_b32 s57, 268672
    buffer_load_dwordx4 v2, s[8:11], s57 offen offset:1024 lds
    s_add_u32 m0, s90, 98304
    s_mov_b32 s57, 344960
    buffer_load_dwordx4 v2, s[8:11], s57 offen offset:0 lds
    s_mov_b32 s57, 354688
    buffer_load_dwordx4 v2, s[8:11], s57 offen offset:1024 lds
    s_mov_b32 s59, s44
    s_mov_b64 exec, 0
    s_branch L_wa_go
L_wa_ret:
    s_add_u32 s59, s59, 4
L_wa_go:
    s_cmp_eq_u32 s59, 0
    s_cbranch_scc1 L_wa_0
    s_cmp_eq_u32 s59, 1
    s_cbranch_scc1 L_wa_1
    s_cmp_eq_u32 s59, 2
    s_cbranch_scc1 L_wa_2
    s_cmp_eq_u32 s59, 3
    s_cbranch_scc1 L_wa_3
    s_cmp_eq_u32 s59, 4
    s_cbranch_scc1 L_wa_3
    s_mov_b64 exec, -1
    s_add_u32 m0, s90, 106496
    s_mov_b32 s57, 430976
    buffer_load_dwordx4 v2, s[8:11], s57 offen offset:0 lds
    s_mov_b32 s57, 440704
    buffer_load_dwordx4 v2, s[8:11], s57 offen offset:1024 lds
    s_add_u32 m0, s90, 114688
    s_mov_b32 s57, 516992
    buffer_load_dwordx4 v2, s[8:11], s57 offen offset:0 lds
    s_mov_b32 s57, 526720
    buffer_load_dwordx4 v2, s[8:11], s57 offen offset:1024 lds
    s_add_u32 m0, s90, 122880
    s_mov_b32 s57, 603008
    buffer_load_dwordx4 v2, s[8:11], s57 offen offset:0 lds
    s_mov_b32 s57, 612736
    buffer_load_dwordx4 v2, s[8:11], s57 offen offset:1024 lds
    s_add_u32 m0, s90, 131072
    s_mov_b32 s57, 689024
    buffer_load_dwordx4 v2, s[8:11], s57 offen offset:0 lds
    s_mov_b32 s57, 698752
    buffer_load_dwordx4 v2, s[8:11], s57 offen offset:1024 lds
    s_add_u32 m0, s90, 139264
    s_mov_b32 s57, 775040
    buffer_load_dwordx4 v2, s[8:11], s57 offen offset:0 lds
    s_mov_b32 s57, 784768
    buffer_load_dwordx4 v2, s[8:11], s57 offen offset:1024 lds
    s_add_u32 m0, s90, 147456
    s_mov_b32 s57, 861056
    buffer_load_dwordx4 v2, s[8:11], s57 offen offset:0 lds
    s_mov_b32 s57, 870784
    buffer_load_dwordx4 v2, s[8:11], s57 offen offset:1024 lds
    s_waitcnt vmcnt(20)
    v_cmp_eq_u32 vcc, 0, v29
    s_nop 0
    s_cbranch_vccz L_ok17
    s_mov_b32 s59, 100000
L_spin16:
    buffer_load_dword v29, off, s[40:43], 0 sc1
    s_waitcnt vmcnt(0)
    v_cmp_eq_u32 vcc, 0, v29
    s_nop 0
    s_cbranch_vccz L_ok17
    s_sub_u32 s59, s59, 1
    s_cbranch_scc0 L_spin16
L_ok17:
    v_readfirstlane_b32 s47, v29
    s_barrier
    s_cmp_lg_u32 s44, 0
    s_cbranch_scc1 L_nopub18
    s_lshl_b32 s60, s2, 5
    s_add_u32 s60, s60, 12582912
    v_mov_b32 v30, s47
    s_mov_b64 exec, 1
    buffer_store_dword v30, off, s[24:27], s60 sc1
    s_mov_b64 exec, -1
L_nopub18:
    s_waitcnt vmcnt(16)
    s_barrier
    s_add_u32 m0, s90, 155648
    s_mov_b32 s57, 947072
    buffer_load_dwordx4 v2, s[8:11], s57 offen offset:0 lds
    s_mov_b32 s57, 956800
    buffer_load_dwordx4 v2, s[8:11], s57 offen offset:1024 lds
    ds_read_b64_tr_b16 a[8:9], v6 offset:0
    ds_read_b64_tr_b16 a[10:11], v6 offset:1024
    ds_read_b64_tr_b16 a[12:13], v7 offset:0
    ds_read_b64_tr_b16 a[14:15], v7 offset:1024
    s_add_u32 m0, s90, 0
    s_mov_b32 s57, 1033088
    buffer_load_dwordx4 v2, s[8:11], s57 offen offset:0 lds
    s_mov_b32 s57, 1042816
    buffer_load_dwordx4 v2, s[8:11], s57 offen offset:1024 lds
    ds_read_b64_tr_b16 a[32:33], v6 offset:8192
    ds_read_b64_tr_b16 a[34:35], v6 offset:9216
    ds_read_b64_tr_b16 a[36:37], v7 offset:8192
    ds_read_b64_tr_b16 a[38:39], v7 offset:9216
    s_add_u32 m0, s90, 8192
    s_mov_b32 s57, 1119104
    buffer_load_dwordx4 v2, s[8:11], s57 offen offset:0 lds
    s_mov_b32 s57, 1128832
    buffer_load_dwordx4 v2, s[8:11], s57 offen offset:1024 lds
    ds_read_b64_tr_b16 a[56:57], v6 offset:16384
    ds_read_b64_tr_b16 a[58:59], v6 offset:17408
    ds_read_b64_tr_b16 a[60:61], v7 offset:16384
    ds_read_b64_tr_b16 a[62:63], v7 offset:17408
    s_waitcnt vmcnt(16)
    s_waitcnt lgkmcnt(0)
    s_barrier
    s_add_u32 m0, s90, 16384
    s_mov_b32 s57, 1792
    buffer_load_dwordx4 v2, s[8:11], s57 offen offset:0 lds
    s_mov_b32 s57, 11520
    buffer_load_dwordx4 v2, s[8:11], s57 offen offset:1024 lds
    ds_read_b64_tr_b16 a[80:81], v6 offset:24576
    ds_read_b64_tr_b16 a[82:83], v6 offset:25600
    ds_read_b64_tr_b16 a[84:85], v7 offset:24576
    ds_read_b64_tr_b16 a[86:87], v7 offset:25600
    s_add_u32 m0, s90, 24576
    s_mov_b32 s57, 87808
    buffer_load_dwordx4 v2, s[8:11], s57 offen offset:0 lds
    s_mov_b32 s57, 97536
    buffer_load_dwordx4 v2, s[8:11], s57 offen offset:1024 lds
    ds_read_b64_tr_b16 a[104:105], v6 offset:32768
    ds_read_b64_tr_b16 a[106:107], v6 offset:33792
    ds_read_b64_tr_b16 a[108:109], v7 offset:32768
    ds_read_b64_tr_b16 a[110:111], v7 offset:33792
    s_add_u32 m0, s90, 32768
    s_mov_b32 s57, 173824
    buffer_load_dwordx4 v2, s[8:11], s57 offen offset:0 lds
    s_mov_b32 s57, 183552
    buffer_load_dwordx4 v2, s[8:11], s57 offen offset:1024 lds
    ds_read_b64_tr_b16 a[128:129], v6 offset:40960
    ds_read_b64_tr_b16 a[130:131], v6 offset:41984
    ds_read_b64_tr_b16 a[132:133], v7 offset:40960
    ds_read_b64_tr_b16 a[134:135], v7 offset:41984
    s_waitcnt vmcnt(16)
    s_waitcnt lgkmcnt(0)
    s_barrier
    s_add_u32 m0, s90, 40960
    s_mov_b32 s57, 259840
    buffer_load_dwordx4 v2, s[8:11], s57 offen offset:0 lds
    s_mov_b32 s57, 269568
    buffer_load_dwordx4 v2, s[8:11], s57 offen offset:1024 lds
    ds_read_b64_tr_b16 a[152:153], v10 offset:0
    ds_read_b64_tr_b16 a[154:155], v10 offset:1024
    ds_read_b64_tr_b16 a[156:157], v11 offset:0
    ds_read_b64_tr_b16 a[158:159], v11 offset:1024
    s_add_u32 m0, s90, 65536
    s_mov_b32 s57, 345856
    buffer_load_dwordx4 v2, s[8:11], s57 offen offset:0 lds
    s_mov_b32 s57, 355584
    buffer_load_dwordx4 v2, s[8:11], s57 offen offset:1024 lds
    ds_read_b64_tr_b16 a[176:177], v10 offset:8192
    ds_read_b64_tr_b16 a[178:179], v10 offset:9216
    ds_read_b64_tr_b16 a[180:181], v11 offset:8192
    ds_read_b64_tr_b16 a[182:183], v11 offset:9216
    s_add_u32 m0, s90, 73728
    s_mov_b32 s57, 431872
    buffer_load_dwordx4 v2, s[8:11], s57 offen offset:0 lds
    s_mov_b32 s57, 441600
    buffer_load_dwordx4 v2, s[8:11], s57 offen offset:1024 lds
    ds_read_b64_tr_b16 a[200:201], v10 offset:16384
    ds_read_b64_tr_b16 a[202:203], v10 offset:17408
    ds_read_b64_tr_b16 a[204:205], v11 offset:16384
    ds_read_b64_tr_b16 a[206:207], v11 offset:17408
    s_waitcnt vmcnt(16)
    s_waitcnt lgkmcnt(0)
    s_barrier
    ds_read_b64_tr_b16 a[224:225], v10 offset:24576
    ds_read_b64_tr_b16 a[226:227], v10 offset:25600
    ds_read_b64_tr_b16 a[228:229], v11 offset:24576
    ds_read_b64_tr_b16 a[230:231], v11 offset:25600
    ds_read_b64_tr_b16 a[248:249], v10 offset:32768
    ds_read_b64_tr_b16 a[250:251], v10 offset:33792
    ds_read_b64_tr_b16 a[252:253], v11 offset:32768
    ds_read_b64_tr_b16 a[254:255], v11 offset:33792
    s_add_u32 m0, s90, 81920
    s_mov_b32 s57, 517888
    buffer_load_dwordx4 v2, s[8:11], s57 offen offset:0 lds
    ds_read_b64_tr_b16 v[192:193], v10 offset:40960
    ds_read_b64_tr_b16 v[194:195], v10 offset:41984
    ds_read_b64_tr_b16 v[196:197], v11 offset:40960
    ds_read_b64_tr_b16 v[198:199], v11 offset:41984
    s_mov_b32 s57, 527616
    buffer_load_dwordx4 v2, s[8:11], s57 offen offset:1024 lds
    s_waitcnt vmcnt(12)
    s_waitcnt lgkmcnt(0)
    s_barrier
    ds_read_b64_tr_b16 v[216:217], v120 offset:0
    ds_read_b64_tr_b16 v[218:219], v120 offset:1024
    ds_read_b64_tr_b16 v[220:221], v121 offset:0
    ds_read_b64_tr_b16 v[222:223], v121 offset:1024
    ds_read_b64_tr_b16 v[240:241], v120 offset:8192
    ds_read_b64_tr_b16 v[242:243], v120 offset:9216
    ds_read_b64_tr_b16 v[244:245], v121 offset:8192
    ds_read_b64_tr_b16 v[246:247], v121 offset:9216
    ds_read_b64_tr_b16 a[16:17], v122 offset:16384
    ds_read_b64_tr_b16 a[18:19], v122 offset:17408
    ds_read_b64_tr_b16 a[20:21], v123 offset:16384
    ds_read_b64_tr_b16 a[22:23], v123 offset:17408
    buffer_load_dword v21, v19, s[24:27], 0 offen sc1
    s_add_u32 m0, s90, 90112
    s_mov_b32 s57, 603904
    buffer_load_dwordx4 v2, s[8:11], s57 offen offset:0 lds
    s_mov_b32 s57, 613632
    buffer_load_dwordx4 v2, s[8:11], s57 offen offset:1024 lds
    s_add_u32 m0, s90, 98304
    s_mov_b32 s57, 689920
    buffer_load_dwordx4 v2, s[8:11], s57 offen offset:0 lds
    s_mov_b32 s57, 699648
    buffer_load_dwordx4 v2, s[8:11], s57 offen offset:1024 lds
    s_add_u32 m0, s90, 106496
    s_mov_b32 s57, 775936
    buffer_load_dwordx4 v2, s[8:11], s57 offen offset:0 lds
    s_waitcnt vmcnt(12)
    s_waitcnt lgkmcnt(0)
    s_barrier
    ds_read_b64_tr_b16 a[40:41], v122 offset:24576
    ds_read_b64_tr_b16 a[42:43], v122 offset:25600
    ds_read_b64_tr_b16 a[44:45], v123 offset:24576
    ds_read_b64_tr_b16 a[46:47], v123 offset:25600
    ds_read_b64_tr_b16 a[64:65], v122 offset:32768
    ds_read_b64_tr_b16 a[66:67], v122 offset:33792
    ds_read_b64_tr_b16 a[68:69], v123 offset:32768
    ds_read_b64_tr_b16 a[70:71], v123 offset:33792
    ds_read_b64_tr_b16 a[88:89], v122 offset:40960
    ds_read_b64_tr_b16 a[90:91], v122 offset:41984
    ds_read_b64_tr_b16 a[92:93], v123 offset:40960
    ds_read_b64_tr_b16 a[94:95], v123 offset:41984
    s_mov_b32 s57, 785664
    buffer_load_dwordx4 v2, s[8:11], s57 offen offset:1024 lds
    s_waitcnt vmcnt(7)
    s_waitcnt lgkmcnt(0)
    s_barrier
    ds_read_b64_tr_b16 a[112:113], v8 offset:0
    ds_read_b64_tr_b16 a[114:115], v8 offset:1024
    ds_read_b64_tr_b16 a[116:117], v9 offset:0
    ds_read_b64_tr_b16 a[118:119], v9 offset:1024
    ds_read_b64_tr_b16 a[136:137], v8 offset:8192
    ds_read_b64_tr_b16 a[138:139], v8 offset:9216
    ds_read_b64_tr_b16 a[140:141], v9 offset:8192
    ds_read_b64_tr_b16 a[142:143], v9 offset:9216
    ds_read_b64_tr_b16 a[160:161], v8 offset:16384
    ds_read_b64_tr_b16 a[162:163], v8 offset:17408
    ds_read_b64_tr_b16 a[164:165], v9 offset:16384
    ds_read_b64_tr_b16 a[166:167], v9 offset:17408
    s_waitcnt vmcnt(6)
    v_cmp_ne_u32 vcc, s47, v21
    s_nop 0
    s_cbranch_vccz L_ok20
    s_mov_b32 s59, 100000
L_spin19:
    buffer_load_dword v21, v19, s[24:27], 0 offen sc1
    s_waitcnt vmcnt(0)
    v_cmp_ne_u32 vcc, s47, v21
    s_nop 0
    s_cbranch_vccz L_ok20
    s_sub_u32 s59, s59, 1
    s_cbranch_scc0 L_spin19
L_ok20:
    s_add_u32 m0, s52, 0
    s_sub_u32 s58, s72, 512
    s_max_i32 s58, s58, 0
    s_add_u32 s57, s58, s68
    buffer_load_dwordx4 v3, s[24:27], s57 offen offset:0 sc1 lds
    s_add_u32 s57, s58, s69
    buffer_load_dwordx4 v3, s[24:27], s57 offen offset:1024 sc1 lds
    s_add_u32 s57, s58, s70
    buffer_load_dwordx4 v24, s[24:27], s57 offen offset:2048 sc1 lds
    s_add_u32 s57, s58, s71
    buffer_load_dwordx4 v3, s[24:27], s57 offen offset:3072 sc1 lds
    s_add_u32 m0, s52, 16384
    s_add_u32 s58, s72, 0
    s_add_u32 s57, s58, s68
    buffer_load_dwordx4 v3, s[24:27], s57 offen offset:0 sc1 lds
    s_add_u32 s57, s58, s69
    buffer_load_dwordx4 v3, s[24:27], s57 offen offset:1024 sc1 lds
    s_add_u32 s57, s58, s70
    buffer_load_dwordx4 v24, s[24:27], s57 offen offset:2048 sc1 lds
    s_add_u32 s57, s58, s71
    buffer_load_dwordx4 v3, s[24:27], s57 offen offset:3072 sc1 lds
    s_add_u32 m0, s90, 114688
    s_mov_b32 s57, 861952
    buffer_load_dwordx4 v2, s[8:11], s57 offen offset:0 lds
    s_mov_b32 s57, 871680
    buffer_load_dwordx4 v2, s[8:11], s57 offen offset:1024 lds
    s_add_u32 m0, s90, 122880
    s_mov_b32 s57, 947968
    buffer_load_dwordx4 v2, s[8:11], s57 offen offset:0 lds
    s_mov_b32 s57, 957696
    buffer_load_dwordx4 v2, s[8:11], s57 offen offset:1024 lds
    s_add_u32 m0, s90, 131072
    s_mov_b32 s57, 1033984
    buffer_load_dwordx4 v2, s[8:11], s57 offen offset:0 lds
    s_mov_b32 s57, 1043712
    buffer_load_dwordx4 v2, s[8:11], s57 offen offset:1024 lds
    s_add_u32 m0, s52, 32768
    s_add_u32 s58, s72, 512
    s_add_u32 s57, s58, s68
    buffer_load_dwordx4 v3, s[24:27], s57 offen offset:0 sc1 lds
    s_add_u32 s57, s58, s69
    buffer_load_dwordx4 v3, s[24:27], s57 offen offset:1024 sc1 lds
    s_waitcnt vmcnt(12)
    s_waitcnt lgkmcnt(0)
    s_barrier
    ds_read_b64_tr_b16 v[120:121], v4 offset:0
    ds_read_b64_tr_b16 v[122:123], v25 offset:0
    ds_read_b64_tr_b16 v[124:125], v4 offset:1024
    ds_read_b64_tr_b16 v[126:127], v25 offset:1024
    ds_read_b64_tr_b16 v[128:129], v4 offset:2048
    ds_read_b64_tr_b16 v[130:131], v25 offset:2048
    ds_read_b64_tr_b16 v[132:133], v4 offset:3072
    ds_read_b64_tr_b16 v[134:135], v25 offset:3072
    ds_read_b64_tr_b16 v[136:137], v4 offset:4096
    ds_read_b64_tr_b16 v[138:139], v25 offset:4096
    ds_read_b64_tr_b16 v[140:141], v4 offset:5120
    ds_read_b64_tr_b16 v[142:143], v25 offset:5120
    ds_read_b64_tr_b16 v[144:145], v4 offset:6144
    ds_read_b64_tr_b16 v[146:147], v25 offset:6144
    ds_read_b64_tr_b16 v[148:149], v4 offset:7168
    ds_read_b64_tr_b16 v[150:151], v25 offset:7168
    ds_read_b64_tr_b16 v[152:153], v4 offset:8192
    ds_read_b64_tr_b16 v[154:155], v25 offset:8192
    ds_read_b64_tr_b16 v[156:157], v4 offset:9216
    ds_read_b64_tr_b16 v[158:159], v25 offset:9216
    ds_read_b64_tr_b16 v[160:161], v4 offset:10240
    ds_read_b64_tr_b16 v[162:163], v25 offset:10240
    ds_read_b64_tr_b16 v[164:165], v4 offset:11264
    ds_read_b64_tr_b16 v[166:167], v25 offset:11264
    ds_read_b64_tr_b16 v[168:169], v4 offset:12288
    ds_read_b64_tr_b16 v[170:171], v25 offset:12288
    ds_read_b64_tr_b16 v[172:173], v4 offset:13312
    ds_read_b64_tr_b16 v[174:175], v25 offset:13312
    s_waitcnt lgkmcnt(15)
    v_mfma_f32_16x16x32_bf16 v[96:99], a[8:11], v[120:123], 0
    s_add_u32 s57, s58, s70
    ds_read_b64_tr_b16 a[184:185], v8 offset:24576
    v_mfma_f32_16x16x32_bf16 v[96:99], a[32:35], v[124:127], v[96:99]
    buffer_load_dwordx4 v24, s[24:27], s57 offen offset:2048 sc1 lds
    v_mfma_f32_16x16x32_bf16 v[96:99], a[56:59], v[128:131], v[96:99]
    ds_read_b64_tr_b16 a[186:187], v8 offset:25600
    ds_read_b64_tr_b16 a[188:189], v9 offset:24576
    v_mfma_f32_16x16x32_bf16 v[96:99], a[80:83], v[132:135], v[96:99]
    ds_read_b64_tr_b16 a[190:191], v9 offset:25600
    ds_read_b64_tr_b16 a[208:209], v8 offset:32768
    v_mfma_f32_16x16x32_bf16 v[96:99], a[104:107], v[136:139], v[96:99]
    s_add_u32 s57, s58, s71
    ds_read_b64_tr_b16 a[210:211], v8 offset:33792
    v_mfma_f32_16x16x32_bf16 v[96:99], a[128:131], v[140:143], v[96:99]
    buffer_load_dwordx4 v3, s[24:27], s57 offen offset:3072 sc1 lds
    s_waitcnt lgkmcnt(15)
    v_mfma_f32_16x16x32_bf16 v[96:99], a[152:155], v[144:147], v[96:99]
    ds_read_b64_tr_b16 a[212:213], v9 offset:32768
    ds_read_b64_tr_b16 a[214:215], v9 offset:33792
    v_mfma_f32_16x16x32_bf16 v[96:99], a[176:179], v[148:151], v[96:99]
    ds_read_b64_tr_b16 a[232:233], v8 offset:40960
    ds_read_b64_tr_b16 a[234:235], v8 offset:41984
    s_waitcnt lgkmcnt(15)
    v_mfma_f32_16x16x32_bf16 v[96:99], a[200:203], v[152:155], v[96:99]
    s_add_u32 m0, s90, 139264
    s_mov_b32 s57, 1120000
    ds_read_b64_tr_b16 a[236:237], v9 offset:40960
    v_mfma_f32_16x16x32_bf16 v[96:99], a[224:227], v[156:159], v[96:99]
    buffer_load_dwordx4 v2, s[8:11], s57 offen offset:0 lds
    s_waitcnt lgkmcnt(15)
    v_mfma_f32_16x16x32_bf16 v[96:99], a[248:251], v[160:163], v[96:99]
    ds_read_b64_tr_b16 a[238:239], v9 offset:41984
    v_mfma_f32_16x16x32_bf16 v[96:99], v[192:195], v[164:167], v[96:99]
    s_waitcnt lgkmcnt(12)
    v_mfma_f32_16x16x32_bf16 v[96:99], v[216:219], v[168:171], v[96:99]
    s_mov_b32 s57, 1129728
    v_mfma_f32_16x16x32_bf16 v[96:99], v[240:243], v[172:175], v[96:99]
    buffer_load_dwordx4 v2, s[8:11], s57 offen offset:1024 lds
    s_waitcnt vmcnt(12)
    s_barrier
    v_mfma_f32_16x16x32_bf16 v[100:103], a[12:15], v[120:123], 0
    ds_read_b64_tr_b16 v[120:121], v4 offset:16384
    ds_read_b64_tr_b16 v[122:123], v25 offset:16384
    v_mfma_f32_16x16x32_bf16 v[100:103], a[36:39], v[124:127], v[100:103]
    ds_read_b64_tr_b16 v[124:125], v4 offset:17408
    v_mfma_f32_16x16x32_bf16 v[100:103], a[60:63], v[128:131], v[100:103]
    ds_read_b64_tr_b16 v[126:127], v25 offset:17408
    ds_read_b64_tr_b16 v[128:129], v4 offset:18432
    s_add_u32 m0, s90, 147456
    s_mov_b32 s57, 0
    v_mfma_f32_16x16x32_bf16 v[100:103], a[84:87], v[132:135], v[100:103]
    buffer_load_dwordx4 v2, s[8:11], s57 offen offset:0 lds
    v_mfma_f32_16x16x32_bf16 v[100:103], a[108:111], v[136:139], v[100:103]
    ds_read_b64_tr_b16 v[130:131], v25 offset:18432
    ds_read_b64_tr_b16 v[132:133], v4 offset:19456
    v_mfma_f32_16x16x32_bf16 v[100:103], a[132:135], v[140:143], v[100:103]
    ds_read_b64_tr_b16 v[134:135], v25 offset:19456
    ds_read_b64_tr_b16 v[136:137], v4 offset:20480
    v_mfma_f32_16x16x32_bf16 v[100:103], a[156:159], v[144:147], v[100:103]
    ds_read_b64_tr_b16 v[138:139], v25 offset:20480
    s_mov_b32 s57, 9728
    v_mfma_f32_16x16x32_bf16 v[100:103], a[180:183], v[148:151], v[100:103]
    buffer_load_dwordx4 v2, s[8:11], s57 offen offset:1024 lds
    v_mfma_f32_16x16x32_bf16 v[100:103], a[204:207], v[152:155], v[100:103]
    ds_read_b64_tr_b16 v[140:141], v4 offset:21504
    ds_read_b64_tr_b16 v[142:143], v25 offset:21504
    v_mfma_f32_16x16x32_bf16 v[100:103], a[228:231], v[156:159], v[100:103]
    ds_read_b64_tr_b16 v[144:145], v4 offset:22528
    ds_read_b64_tr_b16 v[146:147], v25 offset:22528
    v_mfma_f32_16x16x32_bf16 v[100:103], a[252:255], v[160:163], v[100:103]
    ds_read_b64_tr_b16 v[148:149], v4 offset:23552
    ds_read_b64_tr_b16 v[150:151], v25 offset:23552
    s_add_u32 m0, s90, 155648
    s_mov_b32 s57, 86016
    v_mfma_f32_16x16x32_bf16 v[100:103], v[196:199], v[164:167], v[100:103]
    buffer_load_dwordx4 v2, s[8:11], s57 offen offset:0 lds
    v_mfma_f32_16x16x32_bf16 v[100:103], v[220:223], v[168:171], v[100:103]
    ds_read_b64_tr_b16 v[152:153], v4 offset:24576
    ds_read_b64_tr_b16 v[154:155], v25 offset:24576
    v_mfma_f32_16x16x32_bf16 v[100:103], v[244:247], v[172:175], v[100:103]
    ds_read_b64_tr_b16 v[156:157], v4 offset:25600
    ds_read_b64_tr_b16 v[158:159], v25 offset:25600
    s_waitcnt lgkmcnt(15)
    v_mfma_f32_16x16x32_bf16 v[104:107], a[8:11], v[120:123], 0
    ds_read_b64_tr_b16 v[160:161], v4 offset:26624
    s_mov_b32 s57, 95744
    v_mfma_f32_16x16x32_bf16 v[104:107], a[32:35], v[124:127], v[104:107]
    buffer_load_dwordx4 v2, s[8:11], s57 offen offset:1024 lds
    s_waitcnt lgkmcnt(13)
    v_mfma_f32_16x16x32_bf16 v[104:107], a[56:59], v[128:131], v[104:107]
    ds_read_b64_tr_b16 v[162:163], v25 offset:26624
    ds_read_b64_tr_b16 v[164:165], v4 offset:27648
    v_mfma_f32_16x16x32_bf16 v[104:107], a[80:83], v[132:135], v[104:107]
    ds_read_b64_tr_b16 v[166:167], v25 offset:27648
    ds_read_b64_tr_b16 v[168:169], v4 offset:28672
    s_waitcnt vmcnt(10)
    s_barrier
    s_waitcnt lgkmcnt(13)
    v_mfma_f32_16x16x32_bf16 v[104:107], a[104:107], v[136:139], v[104:107]
    ds_read_b64_tr_b16 v[170:171], v25 offset:28672
    ds_read_b64_tr_b16 v[172:173], v4 offset:29696
    s_add_u32 m0, s90, 65536
    s_mov_b32 s57, 172032
    v_mfma_f32_16x16x32_bf16 v[104:107], a[128:131], v[140:143], v[104:107]
    buffer_load_dwordx4 v2, s[8:11], s57 offen offset:0 lds
    s_waitcnt lgkmcnt(11)
    v_mfma_f32_16x16x32_bf16 v[104:107], a[152:155], v[144:147], v[104:107]
    ds_read_b64_tr_b16 v[174:175], v25 offset:29696
    v_cvt_pk_bf16_f32 v52, v96, v97
    v_mfma_f32_16x16x32_bf16 v[104:107], a[176:179], v[148:151], v[104:107]
    v_cvt_pk_bf16_f32 v53, v98, v99
    v_cvt_pk_bf16_f32 v54, v100, v101
    s_waitcnt lgkmcnt(8)
    v_mfma_f32_16x16x32_bf16 v[104:107], a[200:203], v[152:155], v[104:107]
    s_mov_b32 s57, 181760
    v_cvt_pk_bf16_f32 v55, v102, v103
    v_mfma_f32_16x16x32_bf16 v[104:107], a[224:227], v[156:159], v[104:107]
    buffer_load_dwordx4 v2, s[8:11], s57 offen offset:1024 lds
    s_waitcnt lgkmcnt(4)
    v_mfma_f32_16x16x32_bf16 v[104:107], a[248:251], v[160:163], v[104:107]
    v_cndmask_b32 v54, v54, 0, s[82:83]
    v_cndmask_b32 v55, v55, 0, s[82:83]
    v_mfma_f32_16x16x32_bf16 v[104:107], v[192:195], v[164:167], v[104:107]
    ds_read_b64_tr_b16 v[176:177], v12 offset:0
    ds_read_b64_tr_b16 v[178:179], v12 offset:1024
    s_waitcnt lgkmcnt(2)
    v_mfma_f32_16x16x32_bf16 v[104:107], v[216:219], v[168:171], v[104:107]
    s_add_u32 m0, s90, 73728
    s_mov_b32 s57, 258048
    ds_read_b64_tr_b16 v[180:181], v13 offset:0
    v_mfma_f32_16x16x32_bf16 v[104:107], v[240:243], v[172:175], v[104:107]
    buffer_load_dwordx4 v2, s[8:11], s57 offen offset:0 lds
    v_mfma_f32_16x16x32_bf16 v[108:111], a[12:15], v[120:123], 0
    ds_read_b64_tr_b16 v[182:183], v13 offset:1024
    ds_read_b64_tr_b16 v[200:201], v12 offset:8192
    v_mfma_f32_16x16x32_bf16 v[108:111], a[36:39], v[124:127], v[108:111]
    ds_read_b64_tr_b16 v[202:203], v12 offset:9216
    ds_read_b64_tr_b16 v[204:205], v13 offset:8192
    v_mfma_f32_16x16x32_bf16 v[108:111], a[60:63], v[128:131], v[108:111]
    s_mov_b32 s57, 267776
    ds_read_b64_tr_b16 v[206:207], v13 offset:9216
    v_mfma_f32_16x16x32_bf16 v[108:111], a[84:87], v[132:135], v[108:111]
    buffer_load_dwordx4 v2, s[8:11], s57 offen offset:1024 lds
    v_mfma_f32_16x16x32_bf16 v[108:111], a[108:111], v[136:139], v[108:111]
    ds_read_b64_tr_b16 v[224:225], v12 offset:16384
    ds_read_b64_tr_b16 v[226:227], v12 offset:17408
    v_mfma_f32_16x16x32_bf16 v[108:111], a[132:135], v[140:143], v[108:111]
    ds_read_b64_tr_b16 v[228:229], v13 offset:16384
    ds_read_b64_tr_b16 v[230:231], v13 offset:17408
    v_mfma_f32_16x16x32_bf16 v[108:111], a[156:159], v[144:147], v[108:111]
    s_add_u32 m0, s90, 81920
    s_mov_b32 s57, 344064
    v_cvt_pk_bf16_f32 v56, v104, v105
    v_mfma_f32_16x16x32_bf16 v[108:111], a[180:183], v[148:151], v[108:111]
    buffer_load_dwordx4 v2, s[8:11], s57 offen offset:0 lds
    v_mfma_f32_16x16x32_bf16 v[108:111], a[204:207], v[152:155], v[108:111]
    v_cvt_pk_bf16_f32 v57, v106, v107
    v_mfma_f32_16x16x32_bf16 v[108:111], a[228:231], v[156:159], v[108:111]
    v_mfma_f32_16x16x32_bf16 v[108:111], a[252:255], v[160:163], v[108:111]
    s_mov_b32 s57, 353792
    v_mfma_f32_16x16x32_bf16 v[108:111], v[196:199], v[164:167], v[108:111]
    buffer_load_dwordx4 v2, s[8:11], s57 offen offset:1024 lds
    v_mfma_f32_16x16x32_bf16 v[108:111], v[220:223], v[168:171], v[108:111]
    v_mfma_f32_16x16x32_bf16 v[108:111], v[244:247], v[172:175], v[108:111]
    v_mfma_f32_16x16x32_bf16 v[112:115], v[120:123], a[16:19], 0
    s_add_u32 m0, s90, 90112
    s_mov_b32 s57, 430080
    v_mfma_f32_16x16x32_bf16 v[112:115], v[124:127], a[40:43], v[112:115]
    buffer_load_dwordx4 v2, s[8:11], s57 offen offset:0 lds
    v_mfma_f32_16x16x32_bf16 v[112:115], v[128:131], a[64:67], v[112:115]
    v_mfma_f32_16x16x32_bf16 v[112:115], v[132:135], a[88:91], v[112:115]
    v_mfma_f32_16x16x32_bf16 v[112:115], v[136:139], a[112:115], v[112:115]
    s_mov_b32 s57, 439808
    v_mfma_f32_16x16x32_bf16 v[112:115], v[140:143], a[136:139], v[112:115]
    buffer_load_dwordx4 v2, s[8:11], s57 offen offset:1024 lds
    v_mfma_f32_16x16x32_bf16 v[112:115], v[144:147], a[160:163], v[112:115]
    v_cvt_pk_bf16_f32 v58, v108, v109
    v_cvt_pk_bf16_f32 v59, v110, v111
    v_mfma_f32_16x16x32_bf16 v[112:115], v[148:151], a[184:187], v[112:115]
    v_cndmask_b32 v58, v58, 0, s[82:83]
    v_cndmask_b32 v59, v59, 0, s[82:83]
    v_mfma_f32_16x16x32_bf16 v[112:115], v[152:155], a[208:211], v[112:115]
    s_add_u32 m0, s90, 98304
    s_mov_b32 s57, 516096
    buffer_load_dwordx4 v2, s[8:11], s57 offen offset:0 lds
    s_waitcnt vmcnt(9)
    s_waitcnt lgkmcnt(0)
    s_barrier
    ds_read_b64_tr_b16 v[248:249], v12 offset:24576
    ds_read_b64_tr_b16 v[250:251], v12 offset:25600
    ds_read_b64_tr_b16 v[252:253], v13 offset:24576
    ds_read_b64_tr_b16 v[254:255], v13 offset:25600
    v_mfma_f32_16x16x32_bf16 v[112:115], v[156:159], a[232:235], v[112:115]
    ds_read_b64_tr_b16 a[0:1], v10 offset:32768
    ds_read_b64_tr_b16 a[2:3], v10 offset:33792
    v_mfma_f32_16x16x32_bf16 v[112:115], v[160:163], v[176:179], v[112:115]
    ds_read_b64_tr_b16 a[4:5], v11 offset:32768
    ds_read_b64_tr_b16 a[6:7], v11 offset:33792
    v_mfma_f32_16x16x32_bf16 v[112:115], v[164:167], v[200:203], v[112:115]
    ds_read_b64_tr_b16 a[24:25], v10 offset:40960
    ds_read_b64_tr_b16 a[26:27], v10 offset:41984
    s_waitcnt lgkmcnt(6)
    v_mfma_f32_16x16x32_bf16 v[112:115], v[168:171], v[224:227], v[112:115]
    s_mov_b32 s57, 525824
    ds_read_b64_tr_b16 a[28:29], v11 offset:40960
    v_mfma_f32_16x16x32_bf16 v[112:115], v[172:175], v[248:251], v[112:115]
    buffer_load_dwordx4 v2, s[8:11], s57 offen offset:1024 lds
    v_mfma_f32_16x16x32_bf16 v[116:119], v[120:123], a[20:23], 0
    ds_read_b64_tr_b16 v[120:121], v4 offset:0
    ds_read_b64_tr_b16 v[122:123], v25 offset:0
    v_mfma_f32_16x16x32_bf16 v[116:119], v[124:127], a[44:47], v[116:119]
    ds_read_b64_tr_b16 v[124:125], v4 offset:1024
    ds_read_b64_tr_b16 a[30:31], v11 offset:41984
    v_mfma_f32_16x16x32_bf16 v[116:119], v[128:131], a[68:71], v[116:119]
    ds_read_b64_tr_b16 v[126:127], v25 offset:1024
    ds_read_b64_tr_b16 v[128:129], v4 offset:2048
    s_add_u32 m0, s90, 106496
    s_mov_b32 s57, 602112
    v_mfma_f32_16x16x32_bf16 v[116:119], v[132:135], a[92:95], v[116:119]
    buffer_load_dwordx4 v2, s[8:11], s57 offen offset:0 lds
    v_mfma_f32_16x16x32_bf16 v[116:119], v[136:139], a[116:119], v[116:119]
    ds_read_b64_tr_b16 v[130:131], v25 offset:2048
    ds_read_b64_tr_b16 v[132:133], v4 offset:3072
    v_mfma_f32_16x16x32_bf16 v[116:119], v[140:143], a[140:143], v[116:119]
    ds_read_b64_tr_b16 v[134:135], v25 offset:3072
    ds_read_b64_tr_b16 v[136:137], v4 offset:4096
    v_mfma_f32_16x16x32_bf16 v[116:119], v[144:147], a[164:167], v[116:119]
    ds_read_b64_tr_b16 v[138:139], v25 offset:4096
    s_mov_b32 s57, 611840
    v_mfma_f32_16x16x32_bf16 v[116:119], v[148:151], a[188:191], v[116:119]
    buffer_load_dwordx4 v2, s[8:11], s57 offen offset:1024 lds
    v_mfma_f32_16x16x32_bf16 v[116:119], v[152:155], a[212:215], v[116:119]
    ds_read_b64_tr_b16 v[140:141], v4 offset:5120
    ds_read_b64_tr_b16 v[142:143], v25 offset:5120
    v_mfma_f32_16x16x32_bf16 v[116:119], v[156:159], a[236:239], v[116:119]
    ds_read_b64_tr_b16 v[144:145], v4 offset:6144
    ds_read_b64_tr_b16 v[146:147], v25 offset:6144
    v_mfma_f32_16x16x32_bf16 v[116:119], v[160:163], v[180:183], v[116:119]
    ds_read_b64_tr_b16 v[148:149], v4 offset:7168
    ds_read_b64_tr_b16 v[150:151], v25 offset:7168
    s_add_u32 m0, s90, 114688
L_wa_0:
    s_cbranch_execz L_wa_ret
    s_mov_b32 s57, 688128
    v_mfma_f32_16x16x32_bf16 v[116:119], v[164:167], v[204:207], v[116:119]
    buffer_load_dwordx4 v2, s[8:11], s57 offen offset:0 lds
    v_mfma_f32_16x16x32_bf16 v[116:119], v[168:171], v[228:231], v[116:119]
    ds_read_b64_tr_b16 v[152:153], v4 offset:8192
    ds_read_b64_tr_b16 v[154:155], v25 offset:8192
    v_mfma_f32_16x16x32_bf16 v[116:119], v[172:175], v[252:255], v[116:119]
    ds_read_b64_tr_b16 v[156:157], v4 offset:9216
    ds_read_b64_tr_b16 v[158:159], v25 offset:9216
    s_waitcnt lgkmcnt(15)
    v_mfma_f32_16x16x32_bf16 v[96:99], v[120:123], a[16:19], 0
    ds_read_b64_tr_b16 v[160:161], v4 offset:10240
    s_mov_b32 s57, 697856
    v_mfma_f32_16x16x32_bf16 v[96:99], v[124:127], a[40:43], v[96:99]
    buffer_load_dwordx4 v2, s[8:11], s57 offen offset:1024 lds
    s_waitcnt lgkmcnt(13)
    v_mfma_f32_16x16x32_bf16 v[96:99], v[128:131], a[64:67], v[96:99]
    ds_read_b64_tr_b16 v[162:163], v25 offset:10240
    ds_read_b64_tr_b16 v[164:165], v4 offset:11264
    v_mfma_f32_16x16x32_bf16 v[96:99], v[132:135], a[88:91], v[96:99]
    ds_read_b64_tr_b16 v[166:167], v25 offset:11264
    ds_read_b64_tr_b16 v[168:169], v4 offset:12288
    s_waitcnt lgkmcnt(13)
    v_mfma_f32_16x16x32_bf16 v[96:99], v[136:139], a[112:115], v[96:99]
    ds_read_b64_tr_b16 v[170:171], v25 offset:12288
    ds_read_b64_tr_b16 v[172:173], v4 offset:13312
    s_add_u32 m0, s90, 122880
    s_mov_b32 s57, 774144
    v_mfma_f32_16x16x32_bf16 v[96:99], v[140:143], a[136:139], v[96:99]
    buffer_load_dwordx4 v2, s[8:11], s57 offen offset:0 lds
    s_waitcnt lgkmcnt(11)
    v_mfma_f32_16x16x32_bf16 v[96:99], v[144:147], a[160:163], v[96:99]
    ds_read_b64_tr_b16 v[174:175], v25 offset:13312
    v_cvt_pk_bf16_f32 v34, v112, v113
    v_mfma_f32_16x16x32_bf16 v[96:99], v[148:151], a[184:187], v[96:99]
    v_cvt_pk_bf16_f32 v35, v114, v115
    v_cvt_pk_bf16_f32 v44, v116, v117
    s_waitcnt lgkmcnt(8)
    v_mfma_f32_16x16x32_bf16 v[96:99], v[152:155], a[208:211], v[96:99]
    s_mov_b32 s57, 783872
    v_cvt_pk_bf16_f32 v45, v118, v119
    v_mfma_f32_16x16x32_bf16 v[96:99], v[156:159], a[232:235], v[96:99]
    buffer_load_dwordx4 v2, s[8:11], s57 offen offset:1024 lds
    s_waitcnt lgkmcnt(4)
    v_mfma_f32_16x16x32_bf16 v[96:99], v[160:163], v[176:179], v[96:99]
    v_mfma_f32_16x16x32_bf16 v[96:99], v[164:167], v[200:203], v[96:99]
    s_waitcnt vmcnt(10)
    s_barrier
    s_waitcnt lgkmcnt(0)
    v_mfma_f32_16x16x32_bf16 v[96:99], v[168:171], v[224:227], v[96:99]
    s_add_u32 m0, s90, 131072
    s_mov_b32 s57, 860160
    ds_read_b64_tr_b16 a[48:49], v6 offset:0
    v_mfma_f32_16x16x32_bf16 v[96:99], v[172:175], v[248:251], v[96:99]
    buffer_load_dwordx4 v2, s[8:11], s57 offen offset:0 lds
    v_mfma_f32_16x16x32_bf16 v[100:103], v[120:123], a[20:23], 0
    ds_read_b64_tr_b16 v[120:121], v4 offset:32768
    ds_read_b64_tr_b16 v[122:123], v25 offset:32768
    v_mfma_f32_16x16x32_bf16 v[100:103], v[124:127], a[44:47], v[100:103]
    ds_read_b64_tr_b16 v[124:125], v4 offset:33792
    ds_read_b64_tr_b16 a[50:51], v6 offset:1024
    v_mfma_f32_16x16x32_bf16 v[100:103], v[128:131], a[68:71], v[100:103]
    ds_read_b64_tr_b16 v[126:127], v25 offset:33792
    ds_read_b64_tr_b16 v[128:129], v4 offset:34816
    s_mov_b32 s57, 869888
    v_mfma_f32_16x16x32_bf16 v[100:103], v[132:135], a[92:95], v[100:103]
    buffer_load_dwordx4 v2, s[8:11], s57 offen offset:1024 lds
    v_mfma_f32_16x16x32_bf16 v[100:103], v[136:139], a[116:119], v[100:103]
    ds_read_b64_tr_b16 v[130:131], v25 offset:34816
    ds_read_b64_tr_b16 v[132:133], v4 offset:35840
    v_mfma_f32_16x16x32_bf16 v[100:103], v[140:143], a[140:143], v[100:103]
    ds_read_b64_tr_b16 v[134:135], v25 offset:35840
    ds_read_b64_tr_b16 v[136:137], v4 offset:36864
    v_mfma_f32_16x16x32_bf16 v[100:103], v[144:147], a[164:167], v[100:103]
    ds_read_b64_tr_b16 v[138:139], v25 offset:36864
    s_add_u32 m0, s90, 139264
    s_mov_b32 s57, 946176
    v_mfma_f32_16x16x32_bf16 v[100:103], v[148:151], a[188:191], v[100:103]
    buffer_load_dwordx4 v2, s[8:11], s57 offen offset:0 lds
    v_mfma_f32_16x16x32_bf16 v[100:103], v[152:155], a[212:215], v[100:103]
    ds_read_b64_tr_b16 v[140:141], v4 offset:37888
    ds_read_b64_tr_b16 v[142:143], v25 offset:37888
    v_mfma_f32_16x16x32_bf16 v[100:103], v[156:159], a[236:239], v[100:103]
    ds_read_b64_tr_b16 v[144:145], v4 offset:38912
    ds_read_b64_tr_b16 v[146:147], v25 offset:38912
    v_mfma_f32_16x16x32_bf16 v[100:103], v[160:163], v[180:183], v[100:103]
    ds_read_b64_tr_b16 v[148:149], v4 offset:39936
    ds_read_b64_tr_b16 v[150:151], v25 offset:39936
    s_mov_b32 s57, 955904
    v_mfma_f32_16x16x32_bf16 v[100:103], v[164:167], v[204:207], v[100:103]
    buffer_load_dwordx4 v2, s[8:11], s57 offen offset:1024 lds
    v_mfma_f32_16x16x32_bf16 v[100:103], v[168:171], v[228:231], v[100:103]
    ds_read_b64_tr_b16 v[152:153], v4 offset:40960
    ds_read_b64_tr_b16 v[154:155], v25 offset:40960
    v_mfma_f32_16x16x32_bf16 v[100:103], v[172:175], v[252:255], v[100:103]
    ds_read_b64_tr_b16 v[156:157], v4 offset:41984
    ds_read_b64_tr_b16 v[158:159], v25 offset:41984
    s_waitcnt lgkmcnt(15)
    v_mfma_f32_16x16x32_bf16 v[104:107], a[8:11], v[120:123], 0
    ds_read_b64_tr_b16 v[160:161], v4 offset:43008
    s_add_u32 m0, s90, 147456
    s_mov_b32 s57, 1032192
    v_mfma_f32_16x16x32_bf16 v[104:107], a[32:35], v[124:127], v[104:107]
    buffer_load_dwordx4 v2, s[8:11], s57 offen offset:0 lds
    s_waitcnt lgkmcnt(13)
    v_mfma_f32_16x16x32_bf16 v[104:107], a[56:59], v[128:131], v[104:107]
    ds_read_b64_tr_b16 v[162:163], v25 offset:43008
    ds_read_b64_tr_b16 v[164:165], v4 offset:44032
    v_mfma_f32_16x16x32_bf16 v[104:107], a[80:83], v[132:135], v[104:107]
    ds_read_b64_tr_b16 v[166:167], v25 offset:44032
    ds_read_b64_tr_b16 v[168:169], v4 offset:45056
    s_waitcnt lgkmcnt(13)
    v_mfma_f32_16x16x32_bf16 v[104:107], a[104:107], v[136:139], v[104:107]
    ds_read_b64_tr_b16 v[170:171], v25 offset:45056
    ds_read_b64_tr_b16 v[172:173], v4 offset:46080
    s_mov_b32 s57, 1041920
    v_mfma_f32_16x16x32_bf16 v[104:107], a[128:131], v[140:143], v[104:107]
    buffer_load_dwordx4 v2, s[8:11], s57 offen offset:1024 lds
    s_waitcnt lgkmcnt(11)
    v_mfma_f32_16x16x32_bf16 v[104:107], a[152:155], v[144:147], v[104:107]
    ds_read_b64_tr_b16 v[174:175], v25 offset:46080
    v_cvt_pk_bf16_f32 v32, v96, v97
    v_mfma_f32_16x16x32_bf16 v[104:107], a[176:179], v[148:151], v[104:107]
    v_cvt_pk_bf16_f32 v33, v98, v99
    v_cvt_pk_bf16_f32 v42, v100, v101
    s_waitcnt lgkmcnt(8)
    v_mfma_f32_16x16x32_bf16 v[104:107], a[200:203], v[152:155], v[104:107]
    s_add_u32 m0, s90, 155648
    s_mov_b32 s57, 1118208
    v_cvt_pk_bf16_f32 v43, v102, v103
    v_mfma_f32_16x16x32_bf16 v[104:107], a[224:227], v[156:159], v[104:107]
    buffer_load_dwordx4 v2, s[8:11], s57 offen offset:0 lds
    s_waitcnt lgkmcnt(4)
    v_mfma_f32_16x16x32_bf16 v[104:107], a[248:251], v[160:163], v[104:107]
    ds_read_b64_tr_b16 a[52:53], v7 offset:0
    ds_read_b64_tr_b16 a[54:55], v7 offset:1024
    v_mfma_f32_16x16x32_bf16 v[104:107], v[192:195], v[164:167], v[104:107]
    ds_read_b64_tr_b16 a[72:73], v6 offset:8192
    ds_read_b64_tr_b16 a[74:75], v6 offset:9216
    s_waitcnt lgkmcnt(4)
    v_mfma_f32_16x16x32_bf16 v[104:107], v[216:219], v[168:171], v[104:107]
    s_mov_b32 s57, 1127936
    ds_read_b64_tr_b16 a[76:77], v7 offset:8192
    v_mfma_f32_16x16x32_bf16 v[104:107], v[240:243], v[172:175], v[104:107]
    buffer_load_dwordx4 v2, s[8:11], s57 offen offset:1024 lds
    v_mfma_f32_16x16x32_bf16 v[108:111], a[12:15], v[120:123], 0
    ds_read_b64_tr_b16 a[78:79], v7 offset:9216
    ds_read_b64_tr_b16 a[96:97], v6 offset:16384
    v_mfma_f32_16x16x32_bf16 v[108:111], a[36:39], v[124:127], v[108:111]
    ds_read_b64_tr_b16 a[98:99], v6 offset:17408
    ds_read_b64_tr_b16 a[100:101], v7 offset:16384
    v_mfma_f32_16x16x32_bf16 v[108:111], a[60:63], v[128:131], v[108:111]
    s_add_u32 m0, s52, 49152
    s_add_u32 s58, s72, 1024
    s_add_u32 s57, s58, s68
    ds_read_b64_tr_b16 a[102:103], v7 offset:17408
    v_mfma_f32_16x16x32_bf16 v[108:111], a[84:87], v[132:135], v[108:111]
    buffer_load_dwordx4 v3, s[24:27], s57 offen offset:0 sc1 lds
    s_waitcnt vmcnt(13)
    s_waitcnt lgkmcnt(0)
    s_barrier
    v_mfma_f32_16x16x32_bf16 v[108:111], a[108:111], v[136:139], v[108:111]
    ds_read_b64_tr_b16 a[120:121], v6 offset:24576
    ds_read_b64_tr_b16 a[122:123], v6 offset:25600
    v_mfma_f32_16x16x32_bf16 v[108:111], a[132:135], v[140:143], v[108:111]
    ds_read_b64_tr_b16 a[124:125], v7 offset:24576
    ds_read_b64_tr_b16 a[126:127], v7 offset:25600
    v_mfma_f32_16x16x32_bf16 v[108:111], a[156:159], v[144:147], v[108:111]
    s_add_u32 s57, s58, s69
    v_cvt_pk_bf16_f32 v60, v104, v105
    v_mfma_f32_16x16x32_bf16 v[108:111], a[180:183], v[148:151], v[108:111]
    buffer_load_dwordx4 v3, s[24:27], s57 offen offset:1024 sc1 lds
    v_mfma_f32_16x16x32_bf16 v[108:111], a[204:207], v[152:155], v[108:111]
    v_cvt_pk_bf16_f32 v61, v106, v107
    ds_read_b64_tr_b16 a[144:145], v6 offset:32768
    v_mfma_f32_16x16x32_bf16 v[108:111], a[228:231], v[156:159], v[108:111]
    ds_read_b64_tr_b16 a[146:147], v6 offset:33792
    ds_read_b64_tr_b16 a[148:149], v7 offset:32768
    v_mfma_f32_16x16x32_bf16 v[108:111], a[252:255], v[160:163], v[108:111]
    s_add_u32 s57, s58, s70
    ds_read_b64_tr_b16 a[150:151], v7 offset:33792
    v_mfma_f32_16x16x32_bf16 v[108:111], v[196:199], v[164:167], v[108:111]
    buffer_load_dwordx4 v24, s[24:27], s57 offen offset:2048 sc1 lds
    v_mfma_f32_16x16x32_bf16 v[108:111], v[220:223], v[168:171], v[108:111]
    ds_read_b64_tr_b16 a[168:169], v6 offset:40960
    ds_read_b64_tr_b16 a[170:171], v6 offset:41984
    v_mfma_f32_16x16x32_bf16 v[108:111], v[244:247], v[172:175], v[108:111]
    ds_read_b64_tr_b16 a[172:173], v7 offset:40960
    ds_read_b64_tr_b16 a[174:175], v7 offset:41984
    v_mfma_f32_16x16x32_bf16 v[112:115], v[120:123], a[16:19], 0
    s_add_u32 s57, s58, s71
    v_mfma_f32_16x16x32_bf16 v[112:115], v[124:127], a[40:43], v[112:115]
    buffer_load_dwordx4 v3, s[24:27], s57 offen offset:3072 sc1 lds
    v_mfma_f32_16x16x32_bf16 v[112:115], v[128:131], a[64:67], v[112:115]
    v_mfma_f32_16x16x32_bf16 v[112:115], v[132:135], a[88:91], v[112:115]
    s_waitcnt vmcnt(10)
    s_waitcnt lgkmcnt(0)
    s_barrier
    v_mfma_f32_16x16x32_bf16 v[112:115], v[136:139], a[112:115], v[112:115]
    ds_read_b64_tr_b16 a[192:193], v10 offset:0
    ds_read_b64_tr_b16 a[194:195], v10 offset:1024
    v_mfma_f32_16x16x32_bf16 v[112:115], v[140:143], a[136:139], v[112:115]
    ds_read_b64_tr_b16 a[196:197], v11 offset:0
    ds_read_b64_tr_b16 a[198:199], v11 offset:1024
    v_mfma_f32_16x16x32_bf16 v[112:115], v[144:147], a[160:163], v[112:115]
    v_cvt_pk_bf16_f32 v62, v108, v109
    v_cvt_pk_bf16_f32 v63, v110, v111
    v_mfma_f32_16x16x32_bf16 v[112:115], v[148:151], a[184:187], v[112:115]
    v_cndmask_b32 v62, v62, 0, s[82:83]
    v_cndmask_b32 v63, v63, 0, s[82:83]
    v_mfma_f32_16x16x32_bf16 v[112:115], v[152:155], a[208:211], v[112:115]
    ds_read_b64_tr_b16 a[216:217], v10 offset:8192
    ds_read_b64_tr_b16 a[218:219], v10 offset:9216
    v_mfma_f32_16x16x32_bf16 v[112:115], v[156:159], a[232:235], v[112:115]
    ds_read_b64_tr_b16 a[220:221], v11 offset:8192
    ds_read_b64_tr_b16 a[222:223], v11 offset:9216
    v_mfma_f32_16x16x32_bf16 v[112:115], v[160:163], v[176:179], v[112:115]
    ds_read_b64_tr_b16 a[240:241], v10 offset:16384
    ds_read_b64_tr_b16 a[242:243], v10 offset:17408
    v_mfma_f32_16x16x32_bf16 v[112:115], v[164:167], v[200:203], v[112:115]
    ds_read_b64_tr_b16 a[244:245], v11 offset:16384
    ds_read_b64_tr_b16 a[246:247], v11 offset:17408
    v_mfma_f32_16x16x32_bf16 v[112:115], v[168:171], v[224:227], v[112:115]
    v_mfma_f32_16x16x32_bf16 v[112:115], v[172:175], v[248:251], v[112:115]
    v_mfma_f32_16x16x32_bf16 v[116:119], v[120:123], a[20:23], 0
    v_mfma_f32_16x16x32_bf16 v[116:119], v[124:127], a[44:47], v[116:119]
    v_mfma_f32_16x16x32_bf16 v[116:119], v[128:131], a[68:71], v[116:119]
    v_mfma_f32_16x16x32_bf16 v[116:119], v[132:135], a[92:95], v[116:119]
    v_mfma_f32_16x16x32_bf16 v[116:119], v[136:139], a[116:119], v[116:119]
    v_mfma_f32_16x16x32_bf16 v[116:119], v[140:143], a[140:143], v[116:119]
    v_mfma_f32_16x16x32_bf16 v[116:119], v[144:147], a[164:167], v[116:119]
    s_nop 0
    v_cvt_pk_bf16_f32 v36, v112, v113
    v_cvt_pk_bf16_f32 v37, v114, v115
    v_mfma_f32_16x16x32_bf16 v[116:119], v[148:151], a[188:191], v[116:119]
    v_mfma_f32_16x16x32_bf16 v[116:119], v[152:155], a[212:215], v[116:119]
    v_mfma_f32_16x16x32_bf16 v[116:119], v[156:159], a[236:239], v[116:119]
    v_mfma_f32_16x16x32_bf16 v[116:119], v[160:163], v[180:183], v[116:119]
    v_mfma_f32_16x16x32_bf16 v[116:119], v[164:167], v[204:207], v[116:119]
    v_mfma_f32_16x16x32_bf16 v[116:119], v[168:171], v[228:231], v[116:119]
    v_mfma_f32_16x16x32_bf16 v[116:119], v[172:175], v[252:255], v[116:119]
    s_waitcnt vmcnt(4)
    s_waitcnt lgkmcnt(0)
    s_barrier
    v_mfma_f32_16x16x32_bf16 v[96:99], a[0:3], v[120:123], 0
    ds_read_b64_tr_b16 v[184:185], v10 offset:24576
    ds_read_b64_tr_b16 v[186:187], v10 offset:25600
    v_mfma_f32_16x16x32_bf16 v[96:99], a[24:27], v[124:127], v[96:99]
    ds_read_b64_tr_b16 v[188:189], v11 offset:24576
    ds_read_b64_tr_b16 v[190:191], v11 offset:25600
    v_mfma_f32_16x16x32_bf16 v[96:99], a[48:51], v[128:131], v[96:99]
    ds_read_b64_tr_b16 v[208:209], v10 offset:32768
    ds_read_b64_tr_b16 v[210:211], v10 offset:33792
    v_mfma_f32_16x16x32_bf16 v[96:99], a[72:75], v[132:135], v[96:99]
    ds_read_b64_tr_b16 v[212:213], v11 offset:32768
    ds_read_b64_tr_b16 v[214:215], v11 offset:33792
    v_mfma_f32_16x16x32_bf16 v[96:99], a[96:99], v[136:139], v[96:99]
    ds_read_b64_tr_b16 v[232:233], v10 offset:40960
    ds_read_b64_tr_b16 v[234:235], v10 offset:41984
    v_mfma_f32_16x16x32_bf16 v[96:99], a[120:123], v[140:143], v[96:99]
    ds_read_b64_tr_b16 v[236:237], v11 offset:40960
    ds_read_b64_tr_b16 v[238:239], v11 offset:41984
    v_mfma_f32_16x16x32_bf16 v[96:99], a[144:147], v[144:147], v[96:99]
    v_cvt_pk_bf16_f32 v46, v116, v117
    v_cvt_pk_bf16_f32 v47, v118, v119
    v_mfma_f32_16x16x32_bf16 v[96:99], a[168:171], v[148:151], v[96:99]
    v_mfma_f32_16x16x32_bf16 v[96:99], a[192:195], v[152:155], v[96:99]
    v_mfma_f32_16x16x32_bf16 v[96:99], a[216:219], v[156:159], v[96:99]
    s_waitcnt lgkmcnt(8)
    v_mfma_f32_16x16x32_bf16 v[96:99], a[240:243], v[160:163], v[96:99]
    v_mfma_f32_16x16x32_bf16 v[96:99], v[184:187], v[164:167], v[96:99]
    s_waitcnt lgkmcnt(0)
    s_barrier
    v_mfma_f32_16x16x32_bf16 v[96:99], v[208:211], v[168:171], v[96:99]
    s_add_u32 m0, s52, 65536
    s_add_u32 s58, s72, 1536
    s_add_u32 s57, s58, s68
    v_mfma_f32_16x16x32_bf16 v[96:99], v[232:235], v[172:175], v[96:99]
    buffer_load_dwordx4 v3, s[24:27], s57 offen offset:0 sc1 lds
    v_mfma_f32_16x16x32_bf16 v[100:103], a[4:7], v[120:123], 0
    ds_read_b64_tr_b16 v[120:121], v4 offset:16384
    ds_read_b64_tr_b16 v[122:123], v25 offset:16384
    v_mfma_f32_16x16x32_bf16 v[100:103], a[28:31], v[124:127], v[100:103]
    ds_read_b64_tr_b16 v[124:125], v4 offset:17408
    v_mfma_f32_16x16x32_bf16 v[100:103], a[52:55], v[128:131], v[100:103]
    ds_read_b64_tr_b16 v[126:127], v25 offset:17408
    ds_read_b64_tr_b16 v[128:129], v4 offset:18432
    v_mfma_f32_16x16x32_bf16 v[100:103], a[76:79], v[132:135], v[100:103]
    ds_read_b64_tr_b16 v[130:131], v25 offset:18432
    v_mfma_f32_16x16x32_bf16 v[100:103], a[100:103], v[136:139], v[100:103]
    ds_read_b64_tr_b16 v[132:133], v4 offset:19456
    s_add_u32 s57, s58, s69
    v_mfma_f32_16x16x32_bf16 v[100:103], a[124:127], v[140:143], v[100:103]
    buffer_load_dwordx4 v3, s[24:27], s57 offen offset:1024 sc1 lds
    v_mfma_f32_16x16x32_bf16 v[100:103], a[148:151], v[144:147], v[100:103]
    ds_read_b64_tr_b16 v[134:135], v25 offset:19456
    ds_read_b64_tr_b16 v[136:137], v4 offset:20480
    v_mfma_f32_16x16x32_bf16 v[100:103], a[172:175], v[148:151], v[100:103]
    ds_read_b64_tr_b16 v[138:139], v25 offset:20480
    ds_read_b64_tr_b16 v[140:141], v4 offset:21504
    v_mfma_f32_16x16x32_bf16 v[100:103], a[196:199], v[152:155], v[100:103]
    ds_read_b64_tr_b16 v[142:143], v25 offset:21504
    ds_read_b64_tr_b16 v[144:145], v4 offset:22528
    v_mfma_f32_16x16x32_bf16 v[100:103], a[220:223], v[156:159], v[100:103]
    ds_read_b64_tr_b16 v[146:147], v25 offset:22528
    v_cvt_pk_bf16_f32 v64, v96, v97
    v_mfma_f32_16x16x32_bf16 v[100:103], a[244:247], v[160:163], v[100:103]
    ds_read_b64_tr_b16 v[148:149], v4 offset:23552
    ds_read_b64_tr_b16 v[150:151], v25 offset:23552
    s_add_u32 s57, s58, s70
    v_mfma_f32_16x16x32_bf16 v[100:103], v[188:191], v[164:167], v[100:103]
    buffer_load_dwordx4 v24, s[24:27], s57 offen offset:2048 sc1 lds
    v_mfma_f32_16x16x32_bf16 v[100:103], v[212:215], v[168:171], v[100:103]
    ds_read_b64_tr_b16 v[152:153], v4 offset:24576
    ds_read_b64_tr_b16 v[154:155], v25 offset:24576
    v_mfma_f32_16x16x32_bf16 v[100:103], v[236:239], v[172:175], v[100:103]
    ds_read_b64_tr_b16 v[156:157], v4 offset:25600
    ds_read_b64_tr_b16 v[158:159], v25 offset:25600
    s_waitcnt lgkmcnt(15)
    v_mfma_f32_16x16x32_bf16 v[104:107], a[0:3], v[120:123], 0
    ds_read_b64_tr_b16 v[160:161], v4 offset:26624
    v_cvt_pk_bf16_f32 v65, v98, v99
    v_mfma_f32_16x16x32_bf16 v[104:107], a[24:27], v[124:127], v[104:107]
    ds_read_b64_tr_b16 v[162:163], v25 offset:26624
    ds_read_b64_tr_b16 v[164:165], v4 offset:27648
    s_waitcnt lgkmcnt(15)
    v_mfma_f32_16x16x32_bf16 v[104:107], a[48:51], v[128:131], v[104:107]
    ds_read_b64_tr_b16 v[166:167], v25 offset:27648
    s_add_u32 s57, s58, s71
    v_mfma_f32_16x16x32_bf16 v[104:107], a[72:75], v[132:135], v[104:107]
    buffer_load_dwordx4 v3, s[24:27], s57 offen offset:3072 sc1 lds
    s_waitcnt lgkmcnt(12)
    v_mfma_f32_16x16x32_bf16 v[104:107], a[96:99], v[136:139], v[104:107]
    ds_read_b64_tr_b16 v[168:169], v4 offset:28672
    ds_read_b64_tr_b16 v[170:171], v25 offset:28672
    v_mfma_f32_16x16x32_bf16 v[104:107], a[120:123], v[140:143], v[104:107]
    ds_read_b64_tr_b16 v[172:173], v4 offset:29696
    ds_read_b64_tr_b16 v[174:175], v25 offset:29696
    s_waitcnt lgkmcnt(12)
    v_mfma_f32_16x16x32_bf16 v[104:107], a[144:147], v[144:147], v[104:107]
    v_cvt_pk_bf16_f32 v66, v100, v101
    v_cvt_pk_bf16_f32 v67, v102, v103
    v_mfma_f32_16x16x32_bf16 v[104:107], a[168:171], v[148:151], v[104:107]
    v_cndmask_b32 v66, v66, 0, s[82:83]
    v_cndmask_b32 v67, v67, 0, s[82:83]
    s_waitcnt lgkmcnt(8)
    v_mfma_f32_16x16x32_bf16 v[104:107], a[192:195], v[152:155], v[104:107]
    s_add_u32 m0, s52, 81920
    s_add_u32 s58, s72, 2048
    s_add_u32 s57, s58, s68
    v_mfma_f32_16x16x32_bf16 v[104:107], a[216:219], v[156:159], v[104:107]
    buffer_load_dwordx4 v3, s[24:27], s57 offen offset:0 sc1 lds
    s_waitcnt lgkmcnt(4)
    v_mfma_f32_16x16x32_bf16 v[104:107], a[240:243], v[160:163], v[104:107]
    v_mfma_f32_16x16x32_bf16 v[104:107], v[184:187], v[164:167], v[104:107]
    s_waitcnt lgkmcnt(0)
    v_mfma_f32_16x16x32_bf16 v[104:107], v[208:211], v[168:171], v[104:107]
    v_mfma_f32_16x16x32_bf16 v[104:107], v[232:235], v[172:175], v[104:107]
    s_waitcnt vmcnt(5)
    s_barrier
    v_mfma_f32_16x16x32_bf16 v[108:111], a[4:7], v[120:123], 0
    ds_read_b64_tr_b16 v[120:121], v4 offset:49152
    ds_read_b64_tr_b16 v[122:123], v25 offset:49152
    s_add_u32 s57, s58, s69
    v_mfma_f32_16x16x32_bf16 v[108:111], a[28:31], v[124:127], v[108:111]
    buffer_load_dwordx4 v3, s[24:27], s57 offen offset:1024 sc1 lds
    v_mfma_f32_16x16x32_bf16 v[108:111], a[52:55], v[128:131], v[108:111]
    ds_read_b64_tr_b16 v[124:125], v4 offset:50176
    ds_read_b64_tr_b16 v[126:127], v25 offset:50176
    v_mfma_f32_16x16x32_bf16 v[108:111], a[76:79], v[132:135], v[108:111]
    ds_read_b64_tr_b16 v[128:129], v4 offset:51200
    ds_read_b64_tr_b16 v[130:131], v25 offset:51200
    v_mfma_f32_16x16x32_bf16 v[108:111], a[100:103], v[136:139], v[108:111]
    ds_read_b64_tr_b16 v[132:133], v4 offset:52224
    v_mfma_f32_16x16x32_bf16 v[108:111], a[124:127], v[140:143], v[108:111]
    ds_read_b64_tr_b16 v[134:135], v25 offset:52224
    ds_read_b64_tr_b16 v[136:137], v4 offset:53248
    v_mfma_f32_16x16x32_bf16 v[108:111], a[148:151], v[144:147], v[108:111]
    ds_read_b64_tr_b16 v[138:139], v25 offset:53248
    s_add_u32 s57, s58, s70
    v_mfma_f32_16x16x32_bf16 v[108:111], a[172:175], v[148:151], v[108:111]
    buffer_load_dwordx4 v24, s[24:27], s57 offen offset:2048 sc1 lds
    v_mfma_f32_16x16x32_bf16 v[108:111], a[196:199], v[152:155], v[108:111]
    ds_read_b64_tr_b16 v[140:141], v4 offset:54272
    ds_read_b64_tr_b16 v[142:143], v25 offset:54272
    v_mfma_f32_16x16x32_bf16 v[108:111], a[220:223], v[156:159], v[108:111]
    ds_read_b64_tr_b16 v[144:145], v4 offset:55296
    ds_read_b64_tr_b16 v[146:147], v25 offset:55296
    v_mfma_f32_16x16x32_bf16 v[108:111], a[244:247], v[160:163], v[108:111]
    ds_read_b64_tr_b16 v[148:149], v4 offset:56320
    ds_read_b64_tr_b16 v[150:151], v25 offset:56320
    v_mfma_f32_16x16x32_bf16 v[108:111], v[188:191], v[164:167], v[108:111]
    ds_read_b64_tr_b16 v[152:153], v4 offset:57344
    v_cvt_pk_bf16_f32 v68, v104, v105
    v_mfma_f32_16x16x32_bf16 v[108:111], v[212:215], v[168:171], v[108:111]
    ds_read_b64_tr_b16 v[154:155], v25 offset:57344
    ds_read_b64_tr_b16 v[156:157], v4 offset:58368
    s_add_u32 s57, s58, s71
    v_mfma_f32_16x16x32_bf16 v[108:111], v[236:239], v[172:175], v[108:111]
    buffer_load_dwordx4 v3, s[24:27], s57 offen offset:3072 sc1 lds
    s_waitcnt lgkmcnt(15)
    v_mfma_f32_16x16x32_bf16 v[112:115], a[8:11], v[120:123], 0
    ds_read_b64_tr_b16 v[158:159], v25 offset:58368
    ds_read_b64_tr_b16 v[160:161], v4 offset:59392
    v_mfma_f32_16x16x32_bf16 v[112:115], a[32:35], v[124:127], v[112:115]
    ds_read_b64_tr_b16 v[162:163], v25 offset:59392
    ds_read_b64_tr_b16 v[164:165], v4 offset:60416
    s_waitcnt lgkmcnt(15)
    v_mfma_f32_16x16x32_bf16 v[112:115], a[56:59], v[128:131], v[112:115]
    ds_read_b64_tr_b16 v[166:167], v25 offset:60416
    v_cvt_pk_bf16_f32 v69, v106, v107
    v_mfma_f32_16x16x32_bf16 v[112:115], a[80:83], v[132:135], v[112:115]
    ds_read_b64_tr_b16 v[168:169], v4 offset:61440
    s_waitcnt lgkmcnt(13)
    v_mfma_f32_16x16x32_bf16 v[112:115], a[104:107], v[136:139], v[112:115]
    ds_read_b64_tr_b16 v[170:171], v25 offset:61440
    ds_read_b64_tr_b16 v[172:173], v4 offset:62464
    s_add_u32 m0, s52, 98304
    s_add_u32 s58, s72, 2560
    s_add_u32 s57, s58, s68
    v_mfma_f32_16x16x32_bf16 v[112:115], a[128:131], v[140:143], v[112:115]
    buffer_load_dwordx4 v3, s[24:27], s57 offen offset:0 sc1 lds
    s_waitcnt lgkmcnt(11)
    v_mfma_f32_16x16x32_bf16 v[112:115], a[152:155], v[144:147], v[112:115]
    ds_read_b64_tr_b16 v[174:175], v25 offset:62464
    v_cvt_pk_bf16_f32 v70, v108, v109
    v_mfma_f32_16x16x32_bf16 v[112:115], a[176:179], v[148:151], v[112:115]
    v_cvt_pk_bf16_f32 v71, v110, v111
    v_cndmask_b32 v70, v70, 0, s[82:83]
    s_waitcnt lgkmcnt(8)
    v_mfma_f32_16x16x32_bf16 v[112:115], a[200:203], v[152:155], v[112:115]
    v_cndmask_b32 v71, v71, 0, s[82:83]
    v_mov_b32 v8, 0
    v_mfma_f32_16x16x32_bf16 v[112:115], a[224:227], v[156:159], v[112:115]
    v_mov_b32 v9, 0
    v_mov_b32 v10, 0
    s_waitcnt lgkmcnt(4)
    v_mfma_f32_16x16x32_bf16 v[112:115], a[248:251], v[160:163], v[112:115]
    s_add_u32 s57, s58, s69
    v_mfma_f32_16x16x32_bf16 v[72:75], v[52:55], v[68:71], 0
    v_mfma_f32_16x16x32_bf16 v[112:115], v[192:195], v[164:167], v[112:115]
    buffer_load_dwordx4 v3, s[24:27], s57 offen offset:1024 sc1 lds
    s_waitcnt lgkmcnt(0)
    v_mfma_f32_16x16x32_bf16 v[112:115], v[216:219], v[168:171], v[112:115]
    v_mfma_f32_16x16x32_bf16 v[76:79], v[56:59], v[68:71], 0
    v_mfma_f32_16x16x32_bf16 v[112:115], v[240:243], v[172:175], v[112:115]
    ds_read_u16_d16_hi v8, v93 offset:0
    ds_read_u16_d16_hi v9, v94 offset:0
    v_mfma_f32_16x16x32_bf16 v[116:119], a[12:15], v[120:123], 0
    ds_read_u16_d16_hi v10, v92 offset:0
    v_mfma_f32_16x16x32_bf16 v[116:119], a[36:39], v[124:127], v[116:119]
    v_mfma_f32_16x16x32_bf16 v[116:119], a[60:63], v[128:131], v[116:119]
    s_add_u32 s57, s58, s70
    v_mfma_f32_16x16x32_bf16 v[116:119], a[84:87], v[132:135], v[116:119]
    buffer_load_dwordx4 v24, s[24:27], s57 offen offset:2048 sc1 lds
    v_mfma_f32_16x16x32_bf16 v[116:119], a[108:111], v[136:139], v[116:119]
    v_cndmask_b32 v26, v72, v73, s[76:77]
    v_cndmask_b32 v27, v74, v75, s[76:77]
    v_mfma_f32_16x16x32_bf16 v[116:119], a[132:135], v[140:143], v[116:119]
    v_cndmask_b32 v28, v76, v77, s[76:77]
    v_cndmask_b32 v29, v78, v79, s[76:77]
    v_mfma_f32_16x16x32_bf16 v[116:119], a[156:159], v[144:147], v[116:119]
    v_cvt_pk_bf16_f32 v52, v112, v113
    v_cvt_pk_bf16_f32 v53, v114, v115
    v_mfma_f32_16x16x32_bf16 v[116:119], a[180:183], v[148:151], v[116:119]
    v_cndmask_b32 v26, v26, v28, s[78:79]
    v_cndmask_b32 v27, v27, v29, s[80:81]
    v_mfma_f32_16x16x32_bf16 v[116:119], a[204:207], v[152:155], v[116:119]
    s_add_u32 s57, s58, s71
    s_waitcnt lgkmcnt(0)
    v_mfma_f32_16x16x32_bf16 v[116:119], a[228:231], v[156:159], v[116:119]
    buffer_load_dwordx4 v3, s[24:27], s57 offen offset:3072 sc1 lds
    v_mfma_f32_16x16x32_bf16 v[116:119], a[252:255], v[160:163], v[116:119]
    v_mul_f32 v26, v26, v8
    v_mul_f32 v27, v27, v9
    v_mfma_f32_16x16x32_bf16 v[116:119], v[196:199], v[164:167], v[116:119]
    v_mul_f32 v11, s91, v10
    v_cndmask_b32 v26, v26, v18, s[84:85]
    v_mfma_f32_16x16x32_bf16 v[116:119], v[220:223], v[168:171], v[116:119]
    v_cndmask_b32 v27, v27, v18, s[86:87]
    v_max_f32 v28, v26, v27
    v_mfma_f32_16x16x32_bf16 v[116:119], v[244:247], v[172:175], v[116:119]
    v_mov_b32 v29, v28
    v_mfma_f32_16x16x32_bf16 v[96:99], v[120:123], a[16:19], 0
    s_add_u32 m0, s52, 114688
    s_add_u32 s58, s72, 3072
    s_add_u32 s57, s58, s68
    v_mfma_f32_16x16x32_bf16 v[96:99], v[124:127], a[40:43], v[96:99]
    buffer_load_dwordx4 v3, s[24:27], s57 offen offset:0 sc1 lds
    v_mfma_f32_16x16x32_bf16 v[96:99], v[128:131], a[64:67], v[96:99]
    v_permlane16_swap_b32 v28, v29
    v_max_f32 v28, v28, v29
    v_mfma_f32_16x16x32_bf16 v[96:99], v[132:135], a[88:91], v[96:99]
    v_mov_b32 v29, v28
    v_mfma_f32_16x16x32_bf16 v[96:99], v[136:139], a[112:115], v[96:99]
    v_mfma_f32_16x16x32_bf16 v[96:99], v[140:143], a[136:139], v[96:99]
    v_permlane32_swap_b32 v28, v29
    v_max_f32 v28, v28, v29
    v_mfma_f32_16x16x32_bf16 v[96:99], v[144:147], a[160:163], v[96:99]
    s_add_u32 s57, s58, s69
    v_cvt_pk_bf16_f32 v54, v116, v117
    v_mfma_f32_16x16x32_bf16 v[96:99], v[148:151], a[184:187], v[96:99]
    buffer_load_dwordx4 v3, s[24:27], s57 offen offset:1024 sc1 lds
    v_mfma_f32_16x16x32_bf16 v[96:99], v[152:155], a[208:211], v[96:99]
    v_cvt_pk_bf16_f32 v55, v118, v119
    v_cndmask_b32 v54, v54, 0, s[82:83]
    v_mfma_f32_16x16x32_bf16 v[96:99], v[156:159], a[232:235], v[96:99]
    v_cndmask_b32 v55, v55, 0, s[82:83]
    v_sub_f32 v26, v26, v28
    v_mfma_f32_16x16x32_bf16 v[96:99], v[160:163], v[176:179], v[96:99]
    v_sub_f32 v27, v27, v28
    v_mul_f32 v26, v11, v26
    v_mfma_f32_16x16x32_bf16 v[96:99], v[164:167], v[200:203], v[96:99]
    v_mul_f32 v27, v11, v27
    v_exp_f32 v26, v26
    v_mfma_f32_16x16x32_bf16 v[96:99], v[168:171], v[224:227], v[96:99]
    s_add_u32 s57, s58, s70
    v_exp_f32 v27, v27
    v_mfma_f32_16x16x32_bf16 v[96:99], v[172:175], v[248:251], v[96:99]
    buffer_load_dwordx4 v24, s[24:27], s57 offen offset:2048 sc1 lds
    v_mfma_f32_16x16x32_bf16 v[100:103], v[120:123], a[20:23], 0
    v_add_f32 v28, v26, v27
    v_mov_b32 v29, v28
    v_mfma_f32_16x16x32_bf16 v[100:103], v[124:127], a[44:47], v[100:103]
    v_mfma_f32_16x16x32_bf16 v[100:103], v[128:131], a[68:71], v[100:103]
    v_permlane16_swap_b32 v28, v29
    v_add_f32 v28, v28, v29
    v_mfma_f32_16x16x32_bf16 v[100:103], v[132:135], a[92:95], v[100:103]
    v_mov_b32 v29, v28
    v_mfma_f32_16x16x32_bf16 v[100:103], v[136:139], a[116:119], v[100:103]
    s_add_u32 s57, s58, s71
    v_mfma_f32_16x16x32_bf16 v[100:103], v[140:143], a[140:143], v[100:103]
    buffer_load_dwordx4 v3, s[24:27], s57 offen offset:3072 sc1 lds
    v_mfma_f32_16x16x32_bf16 v[100:103], v[144:147], a[164:167], v[100:103]
    v_cvt_pk_bf16_f32 v38, v96, v97
    v_cvt_pk_bf16_f32 v39, v98, v99
    v_mfma_f32_16x16x32_bf16 v[100:103], v[148:151], a[188:191], v[100:103]
    v_permlane32_swap_b32 v28, v29
    v_add_f32 v28, v28, v29
    v_mfma_f32_16x16x32_bf16 v[100:103], v[152:155], a[212:215], v[100:103]
    v_rcp_f32 v28, v28
    v_mfma_f32_16x16x32_bf16 v[100:103], v[156:159], a[236:239], v[100:103]
    v_mul_f32 v26, v26, v8
    v_mul_f32 v27, v27, v9
    v_mfma_f32_16x16x32_bf16 v[100:103], v[160:163], v[180:183], v[100:103]
    s_add_u32 m0, s52, 131072
    s_add_u32 s58, s72, 3584
    s_add_u32 s57, s58, s68
    v_mul_f32 v26, v26, v28
    v_mfma_f32_16x16x32_bf16 v[100:103], v[164:167], v[204:207], v[100:103]
    buffer_load_dwordx4 v3, s[24:27], s57 offen offset:0 sc1 lds
    v_mfma_f32_16x16x32_bf16 v[100:103], v[168:171], v[228:231], v[100:103]
    v_mul_f32 v27, v27, v28
    v_cvt_pk_bf16_f32 v26, v26, v26
    v_mfma_f32_16x16x32_bf16 v[100:103], v[172:175], v[252:255], v[100:103]
    v_cvt_pk_bf16_f32 v27, v27, v27
    v_and_b32 v80, v26, v14
    v_mfma_f32_16x16x32_bf16 v[104:107], a[0:3], v[120:123], 0
    v_and_b32 v81, v27, v15
    v_and_b32 v82, v26, v16
    v_mfma_f32_16x16x32_bf16 v[104:107], a[24:27], v[124:127], v[104:107]
    v_and_b32 v83, v27, v17
    v_mfma_f32_16x16x32_bf16 v[104:107], a[48:51], v[128:131], v[104:107]
L_wa_1:
    s_cbranch_execz L_wa_ret
    s_add_u32 s57, s58, s69
    v_mfma_f32_16x16x32_bf16 v[104:107], a[72:75], v[132:135], v[104:107]
    buffer_load_dwordx4 v3, s[24:27], s57 offen offset:1024 sc1 lds
    v_mfma_f32_16x16x32_bf16 v[104:107], a[96:99], v[136:139], v[104:107]
    v_mfma_f32_16x16x32_bf16 v[72:75], v[32:35], v[80:83], 0
    v_mfma_f32_16x16x32_bf16 v[104:107], a[120:123], v[140:143], v[104:107]
    v_mfma_f32_16x16x32_bf16 v[76:79], v[42:45], v[80:83], 0
    v_mfma_f32_16x16x32_bf16 v[104:107], a[144:147], v[144:147], v[104:107]
    v_cvt_pk_bf16_f32 v48, v100, v101
    v_cvt_pk_bf16_f32 v49, v102, v103
    v_mfma_f32_16x16x32_bf16 v[104:107], a[168:171], v[148:151], v[104:107]
    s_add_u32 s53, s74, 0
    v_mfma_f32_16x16x32_bf16 v[104:107], a[192:195], v[152:155], v[104:107]
    s_add_u32 s57, s58, s70
    v_mfma_f32_16x16x32_bf16 v[104:107], a[216:219], v[156:159], v[104:107]
    buffer_load_dwordx4 v24, s[24:27], s57 offen offset:2048 sc1 lds
    v_mfma_f32_16x16x32_bf16 v[104:107], a[240:243], v[160:163], v[104:107]
    v_mfma_f32_16x16x32_bf16 v[104:107], v[184:187], v[164:167], v[104:107]
    v_mfma_f32_16x16x32_bf16 v[104:107], v[208:211], v[168:171], v[104:107]
    v_cvt_pk_bf16_f32 v84, v72, v73
    v_cvt_pk_bf16_f32 v85, v74, v75
    v_mfma_f32_16x16x32_bf16 v[104:107], v[232:235], v[172:175], v[104:107]
    v_cvt_pk_bf16_f32 v86, v76, v77
    v_cvt_pk_bf16_f32 v87, v78, v79
    s_waitcnt vmcnt(7)
    s_barrier
    v_mfma_f32_16x16x32_bf16 v[108:111], a[4:7], v[120:123], 0
    v_add_u32 v4, 65536, v4
    v_add_u32 v25, 65536, v25
    ds_read_b64_tr_b16 v[120:121], v4 offset:0
    ds_read_b64_tr_b16 v[122:123], v25 offset:0
    s_add_u32 s57, s58, s71
    v_mfma_f32_16x16x32_bf16 v[108:111], a[28:31], v[124:127], v[108:111]
    buffer_load_dwordx4 v3, s[24:27], s57 offen offset:3072 sc1 lds
    v_mfma_f32_16x16x32_bf16 v[108:111], a[52:55], v[128:131], v[108:111]
    ds_read_b64_tr_b16 v[124:125], v4 offset:1024
    ds_read_b64_tr_b16 v[126:127], v25 offset:1024
    v_mfma_f32_16x16x32_bf16 v[108:111], a[76:79], v[132:135], v[108:111]
    ds_read_b64_tr_b16 v[128:129], v4 offset:2048
    ds_read_b64_tr_b16 v[130:131], v25 offset:2048
    v_mfma_f32_16x16x32_bf16 v[108:111], a[100:103], v[136:139], v[108:111]
    ds_read_b64_tr_b16 v[132:133], v4 offset:3072
    buffer_store_dwordx4 v[84:87], v23, s[24:27], s53 offen sc1
    v_mfma_f32_16x16x32_bf16 v[108:111], a[124:127], v[140:143], v[108:111]
    ds_read_b64_tr_b16 v[134:135], v25 offset:3072
    ds_read_b64_tr_b16 v[136:137], v4 offset:4096
    v_mfma_f32_16x16x32_bf16 v[108:111], a[148:151], v[144:147], v[108:111]
    ds_read_b64_tr_b16 v[138:139], v25 offset:4096
    s_add_u32 s57, s73, 0
    v_mfma_f32_16x16x32_bf16 v[108:111], a[172:175], v[148:151], v[108:111]
    buffer_load_dword v22, v5, s[20:23], s57 offen
    v_mfma_f32_16x16x32_bf16 v[108:111], a[196:199], v[152:155], v[108:111]
    ds_read_b64_tr_b16 v[140:141], v4 offset:5120
    ds_read_b64_tr_b16 v[142:143], v25 offset:5120
    v_mfma_f32_16x16x32_bf16 v[108:111], a[220:223], v[156:159], v[108:111]
    ds_read_b64_tr_b16 v[144:145], v4 offset:6144
    ds_read_b64_tr_b16 v[146:147], v25 offset:6144
    v_mfma_f32_16x16x32_bf16 v[108:111], a[244:247], v[160:163], v[108:111]
    ds_read_b64_tr_b16 v[148:149], v4 offset:7168
    ds_read_b64_tr_b16 v[150:151], v25 offset:7168
    v_mfma_f32_16x16x32_bf16 v[108:111], v[188:191], v[164:167], v[108:111]
    ds_read_b64_tr_b16 v[152:153], v4 offset:8192
    v_cvt_pk_bf16_f32 v68, v104, v105
    v_mfma_f32_16x16x32_bf16 v[108:111], v[212:215], v[168:171], v[108:111]
    ds_read_b64_tr_b16 v[154:155], v25 offset:8192
    ds_read_b64_tr_b16 v[156:157], v4 offset:9216
    v_mfma_f32_16x16x32_bf16 v[108:111], v[236:239], v[172:175], v[108:111]
    ds_read_b64_tr_b16 v[158:159], v25 offset:9216
    v_cvt_pk_bf16_f32 v69, v106, v107
    s_waitcnt lgkmcnt(15)
    v_mfma_f32_16x16x32_bf16 v[112:115], a[8:11], v[120:123], 0
    ds_read_b64_tr_b16 v[160:161], v4 offset:10240
    v_cndmask_b32 v80, v84, v86, s[88:89]
    v_mfma_f32_16x16x32_bf16 v[112:115], a[32:35], v[124:127], v[112:115]
    ds_read_b64_tr_b16 v[162:163], v25 offset:10240
    ds_read_b64_tr_b16 v[164:165], v4 offset:11264
    s_waitcnt lgkmcnt(15)
    v_mfma_f32_16x16x32_bf16 v[112:115], a[56:59], v[128:131], v[112:115]
    ds_read_b64_tr_b16 v[166:167], v25 offset:11264
    v_cndmask_b32 v81, v85, v87, s[88:89]
    v_mfma_f32_16x16x32_bf16 v[112:115], a[80:83], v[132:135], v[112:115]
    ds_read_b64_tr_b16 v[168:169], v4 offset:12288
    ds_write_b64 v95, v[80:81] offset:0
    s_waitcnt lgkmcnt(14)
    v_mfma_f32_16x16x32_bf16 v[112:115], a[104:107], v[136:139], v[112:115]
    ds_read_b64_tr_b16 v[170:171], v25 offset:12288
    ds_read_b64_tr_b16 v[172:173], v4 offset:13312
    v_mfma_f32_16x16x32_bf16 v[112:115], a[128:131], v[140:143], v[112:115]
    ds_read_b64_tr_b16 v[174:175], v25 offset:13312
    s_waitcnt lgkmcnt(13)
    v_mfma_f32_16x16x32_bf16 v[112:115], a[152:155], v[144:147], v[112:115]
    v_cvt_pk_bf16_f32 v70, v108, v109
    v_cvt_pk_bf16_f32 v71, v110, v111
    v_mfma_f32_16x16x32_bf16 v[112:115], a[176:179], v[148:151], v[112:115]
    v_cndmask_b32 v70, v70, 0, s[82:83]
    v_cndmask_b32 v71, v71, 0, s[82:83]
    s_waitcnt lgkmcnt(9)
    v_mfma_f32_16x16x32_bf16 v[112:115], a[200:203], v[152:155], v[112:115]
    v_mfma_f32_16x16x32_bf16 v[72:75], v[56:59], v[64:67], 0
    v_mfma_f32_16x16x32_bf16 v[112:115], a[224:227], v[156:159], v[112:115]
    v_mfma_f32_16x16x32_bf16 v[76:79], v[60:63], v[64:67], 0
    s_waitcnt lgkmcnt(5)
    v_mfma_f32_16x16x32_bf16 v[112:115], a[248:251], v[160:163], v[112:115]
    ds_read_u16_d16_hi v8, v93 offset:16384
    ds_read_u16_d16_hi v9, v94 offset:16384
    v_mfma_f32_16x16x32_bf16 v[112:115], v[192:195], v[164:167], v[112:115]
    ds_read_u16_d16_hi v10, v92 offset:16384
    s_waitcnt lgkmcnt(3)
    v_mfma_f32_16x16x32_bf16 v[112:115], v[216:219], v[168:171], v[112:115]
    v_mfma_f32_16x16x32_bf16 v[112:115], v[240:243], v[172:175], v[112:115]
    v_mfma_f32_16x16x32_bf16 v[116:119], a[12:15], v[120:123], 0
    v_mfma_f32_16x16x32_bf16 v[116:119], a[36:39], v[124:127], v[116:119]
    v_cndmask_b32 v26, v72, v73, s[76:77]
    v_cndmask_b32 v27, v74, v75, s[76:77]
    v_mfma_f32_16x16x32_bf16 v[116:119], a[60:63], v[128:131], v[116:119]
    v_cndmask_b32 v28, v76, v77, s[76:77]
    v_cndmask_b32 v29, v78, v79, s[76:77]
    v_mfma_f32_16x16x32_bf16 v[116:119], a[84:87], v[132:135], v[116:119]
    v_cndmask_b32 v26, v26, v28, s[78:79]
    v_cndmask_b32 v27, v27, v29, s[80:81]
    v_mfma_f32_16x16x32_bf16 v[116:119], a[108:111], v[136:139], v[116:119]
    s_waitcnt lgkmcnt(0)
    v_mul_f32 v26, v26, v8
    v_mfma_f32_16x16x32_bf16 v[116:119], a[132:135], v[140:143], v[116:119]
    v_mul_f32 v27, v27, v9
    v_mul_f32 v11, s91, v10
    v_mfma_f32_16x16x32_bf16 v[116:119], a[156:159], v[144:147], v[116:119]
    v_cvt_pk_bf16_f32 v56, v112, v113
    v_cvt_pk_bf16_f32 v57, v114, v115
    v_mfma_f32_16x16x32_bf16 v[116:119], a[180:183], v[148:151], v[116:119]
    v_max_f32 v28, v26, v27
    v_mov_b32 v29, v28
    v_mfma_f32_16x16x32_bf16 v[116:119], a[204:207], v[152:155], v[116:119]
    v_mfma_f32_16x16x32_bf16 v[116:119], a[228:231], v[156:159], v[116:119]
    v_permlane16_swap_b32 v28, v29
    v_max_f32 v28, v28, v29
    v_mfma_f32_16x16x32_bf16 v[116:119], a[252:255], v[160:163], v[116:119]
    v_mov_b32 v29, v28
    v_mfma_f32_16x16x32_bf16 v[116:119], v[196:199], v[164:167], v[116:119]
    v_mfma_f32_16x16x32_bf16 v[116:119], v[220:223], v[168:171], v[116:119]
    v_permlane32_swap_b32 v28, v29
    v_max_f32 v28, v28, v29
    v_mfma_f32_16x16x32_bf16 v[116:119], v[244:247], v[172:175], v[116:119]
    v_sub_f32 v26, v26, v28
    v_sub_f32 v27, v27, v28
    v_mfma_f32_16x16x32_bf16 v[96:99], v[120:123], a[16:19], 0
    v_mul_f32 v26, v11, v26
    v_mul_f32 v27, v11, v27
    v_mfma_f32_16x16x32_bf16 v[96:99], v[124:127], a[40:43], v[96:99]
    v_exp_f32 v26, v26
    v_mfma_f32_16x16x32_bf16 v[96:99], v[128:131], a[64:67], v[96:99]
    v_exp_f32 v27, v27
    v_mfma_f32_16x16x32_bf16 v[96:99], v[132:135], a[88:91], v[96:99]
    v_add_f32 v28, v26, v27
    v_mov_b32 v29, v28
    v_mfma_f32_16x16x32_bf16 v[96:99], v[136:139], a[112:115], v[96:99]
    v_mfma_f32_16x16x32_bf16 v[96:99], v[140:143], a[136:139], v[96:99]
    v_permlane16_swap_b32 v28, v29
    v_add_f32 v28, v28, v29
    v_mfma_f32_16x16x32_bf16 v[96:99], v[144:147], a[160:163], v[96:99]
    v_cvt_pk_bf16_f32 v58, v116, v117
    v_cvt_pk_bf16_f32 v59, v118, v119
    v_mfma_f32_16x16x32_bf16 v[96:99], v[148:151], a[184:187], v[96:99]
    v_cndmask_b32 v58, v58, 0, s[82:83]
    v_cndmask_b32 v59, v59, 0, s[82:83]
    v_mfma_f32_16x16x32_bf16 v[96:99], v[152:155], a[208:211], v[96:99]
    v_mov_b32 v29, v28
    v_mfma_f32_16x16x32_bf16 v[96:99], v[156:159], a[232:235], v[96:99]
    v_mfma_f32_16x16x32_bf16 v[96:99], v[160:163], v[176:179], v[96:99]
    v_permlane32_swap_b32 v28, v29
    v_add_f32 v28, v28, v29
    v_mfma_f32_16x16x32_bf16 v[96:99], v[164:167], v[200:203], v[96:99]
    v_rcp_f32 v28, v28
    v_mfma_f32_16x16x32_bf16 v[96:99], v[168:171], v[224:227], v[96:99]
    v_mul_f32 v26, v26, v8
    v_mul_f32 v27, v27, v9
    v_mfma_f32_16x16x32_bf16 v[96:99], v[172:175], v[248:251], v[96:99]
    v_mul_f32 v26, v26, v28
    v_mul_f32 v27, v27, v28
    v_mfma_f32_16x16x32_bf16 v[100:103], v[120:123], a[20:23], 0
    v_cvt_pk_bf16_f32 v26, v26, v26
    v_cvt_pk_bf16_f32 v27, v27, v27
    v_mfma_f32_16x16x32_bf16 v[100:103], v[124:127], a[44:47], v[100:103]
    v_and_b32 v80, v26, v14
    v_and_b32 v81, v27, v15
    v_mfma_f32_16x16x32_bf16 v[100:103], v[128:131], a[68:71], v[100:103]
    v_and_b32 v82, v26, v16
    v_and_b32 v83, v27, v17
    v_mfma_f32_16x16x32_bf16 v[100:103], v[132:135], a[92:95], v[100:103]
    v_mfma_f32_16x16x32_bf16 v[100:103], v[136:139], a[116:119], v[100:103]
    v_mfma_f32_16x16x32_bf16 v[72:75], v[34:37], v[80:83], 0
    v_mfma_f32_16x16x32_bf16 v[100:103], v[140:143], a[140:143], v[100:103]
    v_mfma_f32_16x16x32_bf16 v[76:79], v[44:47], v[80:83], 0
    v_mfma_f32_16x16x32_bf16 v[100:103], v[144:147], a[164:167], v[100:103]
    s_add_u32 s57, s73, 524288
    v_cvt_pk_bf16_f32 v40, v96, v97
    v_mfma_f32_16x16x32_bf16 v[100:103], v[148:151], a[188:191], v[100:103]
    buffer_load_dword v22, v5, s[20:23], s57 offen
    v_mfma_f32_16x16x32_bf16 v[100:103], v[152:155], a[212:215], v[100:103]
    v_cvt_pk_bf16_f32 v41, v98, v99
    v_cvt_pk_bf16_f32 v32, v96, v97
    v_mfma_f32_16x16x32_bf16 v[100:103], v[156:159], a[236:239], v[100:103]
    v_cvt_pk_bf16_f32 v33, v98, v99
    s_add_u32 s53, s74, 16384
    v_mfma_f32_16x16x32_bf16 v[100:103], v[160:163], v[180:183], v[100:103]
    v_mfma_f32_16x16x32_bf16 v[100:103], v[164:167], v[204:207], v[100:103]
    v_mfma_f32_16x16x32_bf16 v[100:103], v[168:171], v[228:231], v[100:103]
    v_mfma_f32_16x16x32_bf16 v[100:103], v[172:175], v[252:255], v[100:103]
    v_mfma_f32_16x16x32_bf16 v[104:107], a[0:3], v[120:123], 0
    v_cvt_pk_bf16_f32 v84, v72, v73
    v_cvt_pk_bf16_f32 v85, v74, v75
    v_mfma_f32_16x16x32_bf16 v[104:107], a[24:27], v[124:127], v[104:107]
    v_cvt_pk_bf16_f32 v86, v76, v77
    v_cvt_pk_bf16_f32 v87, v78, v79
    v_mfma_f32_16x16x32_bf16 v[104:107], a[48:51], v[128:131], v[104:107]
    buffer_store_dwordx4 v[84:87], v23, s[24:27], s53 offen sc1
    v_mfma_f32_16x16x32_bf16 v[104:107], a[72:75], v[132:135], v[104:107]
    v_cndmask_b32 v80, v84, v86, s[88:89]
    v_cndmask_b32 v81, v85, v87, s[88:89]
    v_mfma_f32_16x16x32_bf16 v[104:107], a[96:99], v[136:139], v[104:107]
    ds_write_b64 v95, v[80:81] offset:256
    v_mfma_f32_16x16x32_bf16 v[104:107], a[120:123], v[140:143], v[104:107]
    v_mfma_f32_16x16x32_bf16 v[72:75], v[60:63], v[68:71], 0
    v_mfma_f32_16x16x32_bf16 v[104:107], a[144:147], v[144:147], v[104:107]
    v_cvt_pk_bf16_f32 v50, v100, v101
    v_cvt_pk_bf16_f32 v51, v102, v103
    v_mfma_f32_16x16x32_bf16 v[104:107], a[168:171], v[148:151], v[104:107]
    v_cvt_pk_bf16_f32 v42, v100, v101
    v_cvt_pk_bf16_f32 v43, v102, v103
    v_mfma_f32_16x16x32_bf16 v[104:107], a[192:195], v[152:155], v[104:107]
    v_mfma_f32_16x16x32_bf16 v[76:79], v[52:55], v[68:71], 0
    v_mfma_f32_16x16x32_bf16 v[104:107], a[216:219], v[156:159], v[104:107]
    ds_read_u16_d16_hi v8, v93 offset:32768
    ds_read_u16_d16_hi v9, v94 offset:32768
    v_mfma_f32_16x16x32_bf16 v[104:107], a[240:243], v[160:163], v[104:107]
    ds_read_u16_d16_hi v10, v92 offset:32768
    v_mfma_f32_16x16x32_bf16 v[104:107], v[184:187], v[164:167], v[104:107]
    v_mfma_f32_16x16x32_bf16 v[104:107], v[208:211], v[168:171], v[104:107]
    v_mfma_f32_16x16x32_bf16 v[104:107], v[232:235], v[172:175], v[104:107]
    v_mfma_f32_16x16x32_bf16 v[108:111], a[4:7], v[120:123], 0
    ds_read_b64_tr_b16 v[120:121], v4 offset:16384
    ds_read_b64_tr_b16 v[122:123], v25 offset:16384
    v_mfma_f32_16x16x32_bf16 v[108:111], a[28:31], v[124:127], v[108:111]
    ds_read_b64_tr_b16 v[124:125], v4 offset:17408
    v_cndmask_b32 v26, v72, v73, s[76:77]
    v_mfma_f32_16x16x32_bf16 v[108:111], a[52:55], v[128:131], v[108:111]
    ds_read_b64_tr_b16 v[126:127], v25 offset:17408
    ds_read_b64_tr_b16 v[128:129], v4 offset:18432
    v_mfma_f32_16x16x32_bf16 v[108:111], a[76:79], v[132:135], v[108:111]
    ds_read_b64_tr_b16 v[130:131], v25 offset:18432
    v_cndmask_b32 v27, v74, v75, s[76:77]
    v_mfma_f32_16x16x32_bf16 v[108:111], a[100:103], v[136:139], v[108:111]
    ds_read_b64_tr_b16 v[132:133], v4 offset:19456
    v_cndmask_b32 v28, v76, v77, s[76:77]
    v_mfma_f32_16x16x32_bf16 v[108:111], a[124:127], v[140:143], v[108:111]
    ds_read_b64_tr_b16 v[134:135], v25 offset:19456
    ds_read_b64_tr_b16 v[136:137], v4 offset:20480
    v_mfma_f32_16x16x32_bf16 v[108:111], a[148:151], v[144:147], v[108:111]
    ds_read_b64_tr_b16 v[138:139], v25 offset:20480
    v_cvt_pk_bf16_f32 v64, v104, v105
    v_mfma_f32_16x16x32_bf16 v[108:111], a[172:175], v[148:151], v[108:111]
    ds_read_b64_tr_b16 v[140:141], v4 offset:21504
    ds_read_b64_tr_b16 v[142:143], v25 offset:21504
    v_mfma_f32_16x16x32_bf16 v[108:111], a[196:199], v[152:155], v[108:111]
    ds_read_b64_tr_b16 v[144:145], v4 offset:22528
    v_cvt_pk_bf16_f32 v65, v106, v107
    v_mfma_f32_16x16x32_bf16 v[108:111], a[220:223], v[156:159], v[108:111]
    ds_read_b64_tr_b16 v[146:147], v25 offset:22528
    v_cndmask_b32 v29, v78, v79, s[76:77]
    v_mfma_f32_16x16x32_bf16 v[108:111], a[244:247], v[160:163], v[108:111]
    ds_read_b64_tr_b16 v[148:149], v4 offset:23552
    ds_read_b64_tr_b16 v[150:151], v25 offset:23552
    v_mfma_f32_16x16x32_bf16 v[108:111], v[188:191], v[164:167], v[108:111]
    ds_read_b64_tr_b16 v[152:153], v4 offset:24576
    v_cndmask_b32 v26, v26, v28, s[78:79]
    v_mfma_f32_16x16x32_bf16 v[108:111], v[212:215], v[168:171], v[108:111]
    ds_read_b64_tr_b16 v[154:155], v25 offset:24576
    ds_read_b64_tr_b16 v[156:157], v4 offset:25600
    v_mfma_f32_16x16x32_bf16 v[108:111], v[236:239], v[172:175], v[108:111]
    ds_read_b64_tr_b16 v[158:159], v25 offset:25600
    v_cndmask_b32 v27, v27, v29, s[80:81]
    s_waitcnt lgkmcnt(15)
    v_mfma_f32_16x16x32_bf16 v[112:115], a[8:11], v[120:123], 0
    ds_read_b64_tr_b16 v[160:161], v4 offset:26624
    v_mfma_f32_16x16x32_bf16 v[112:115], a[32:35], v[124:127], v[112:115]
    ds_read_b64_tr_b16 v[162:163], v25 offset:26624
    ds_read_b64_tr_b16 v[164:165], v4 offset:27648
    s_waitcnt lgkmcnt(15)
    v_mfma_f32_16x16x32_bf16 v[112:115], a[56:59], v[128:131], v[112:115]
    ds_read_b64_tr_b16 v[166:167], v25 offset:27648
    v_mul_f32 v26, v26, v8
    v_mfma_f32_16x16x32_bf16 v[112:115], a[80:83], v[132:135], v[112:115]
    ds_read_b64_tr_b16 v[168:169], v4 offset:28672
    v_mul_f32 v27, v27, v9
    s_waitcnt lgkmcnt(13)
    v_mfma_f32_16x16x32_bf16 v[112:115], a[104:107], v[136:139], v[112:115]
    ds_read_b64_tr_b16 v[170:171], v25 offset:28672
    ds_read_b64_tr_b16 v[172:173], v4 offset:29696
    v_mfma_f32_16x16x32_bf16 v[112:115], a[128:131], v[140:143], v[112:115]
    ds_read_b64_tr_b16 v[174:175], v25 offset:29696
    v_mul_f32 v11, s91, v10
    s_waitcnt lgkmcnt(12)
    v_mfma_f32_16x16x32_bf16 v[112:115], a[152:155], v[144:147], v[112:115]
    v_cvt_pk_bf16_f32 v66, v108, v109
    v_cvt_pk_bf16_f32 v67, v110, v111
    v_mfma_f32_16x16x32_bf16 v[112:115], a[176:179], v[148:151], v[112:115]
    v_cndmask_b32 v66, v66, 0, s[82:83]
    v_cndmask_b32 v67, v67, 0, s[82:83]
    s_waitcnt lgkmcnt(8)
    v_mfma_f32_16x16x32_bf16 v[112:115], a[200:203], v[152:155], v[112:115]
    v_max_f32 v28, v26, v27
    v_mov_b32 v29, v28
    v_mfma_f32_16x16x32_bf16 v[112:115], a[224:227], v[156:159], v[112:115]
    s_waitcnt lgkmcnt(4)
    v_mfma_f32_16x16x32_bf16 v[112:115], a[248:251], v[160:163], v[112:115]
    v_permlane16_swap_b32 v28, v29
    v_max_f32 v28, v28, v29
    v_mfma_f32_16x16x32_bf16 v[112:115], v[192:195], v[164:167], v[112:115]
    v_mov_b32 v29, v28
    s_waitcnt lgkmcnt(0)
    v_mfma_f32_16x16x32_bf16 v[112:115], v[216:219], v[168:171], v[112:115]
    v_mfma_f32_16x16x32_bf16 v[112:115], v[240:243], v[172:175], v[112:115]
    v_permlane32_swap_b32 v28, v29
    v_max_f32 v28, v28, v29
    v_mfma_f32_16x16x32_bf16 v[116:119], a[12:15], v[120:123], 0
    v_sub_f32 v26, v26, v28
    v_sub_f32 v27, v27, v28
    v_mfma_f32_16x16x32_bf16 v[116:119], a[36:39], v[124:127], v[116:119]
    v_mul_f32 v26, v11, v26
    v_mul_f32 v27, v11, v27
    v_mfma_f32_16x16x32_bf16 v[116:119], a[60:63], v[128:131], v[116:119]
    v_exp_f32 v26, v26
    v_mfma_f32_16x16x32_bf16 v[116:119], a[84:87], v[132:135], v[116:119]
    v_exp_f32 v27, v27
    v_mfma_f32_16x16x32_bf16 v[116:119], a[108:111], v[136:139], v[116:119]
    v_add_f32 v28, v26, v27
    v_mov_b32 v29, v28
    v_mfma_f32_16x16x32_bf16 v[116:119], a[132:135], v[140:143], v[116:119]
    v_mfma_f32_16x16x32_bf16 v[116:119], a[156:159], v[144:147], v[116:119]
    s_add_u32 s57, s75, 0
    v_cvt_pk_bf16_f32 v60, v112, v113
    v_mfma_f32_16x16x32_bf16 v[116:119], a[180:183], v[148:151], v[116:119]
    buffer_load_dword v22, v20, s[12:15], s57 offen
    v_mfma_f32_16x16x32_bf16 v[116:119], a[204:207], v[152:155], v[116:119]
    v_cvt_pk_bf16_f32 v61, v114, v115
    v_permlane16_swap_b32 v28, v29
    v_mfma_f32_16x16x32_bf16 v[116:119], a[228:231], v[156:159], v[116:119]
    v_add_f32 v28, v28, v29
    v_mov_b32 v29, v28
    v_mfma_f32_16x16x32_bf16 v[116:119], a[252:255], v[160:163], v[116:119]
    v_mfma_f32_16x16x32_bf16 v[116:119], v[196:199], v[164:167], v[116:119]
    v_permlane32_swap_b32 v28, v29
    v_add_f32 v28, v28, v29
    v_mfma_f32_16x16x32_bf16 v[116:119], v[220:223], v[168:171], v[116:119]
    v_rcp_f32 v28, v28
    v_mfma_f32_16x16x32_bf16 v[116:119], v[244:247], v[172:175], v[116:119]
    v_mul_f32 v26, v26, v8
    v_mul_f32 v27, v27, v9
    v_mfma_f32_16x16x32_bf16 v[96:99], v[120:123], a[16:19], 0
    v_mul_f32 v26, v26, v28
    v_mul_f32 v27, v27, v28
    v_mfma_f32_16x16x32_bf16 v[96:99], v[124:127], a[40:43], v[96:99]
    v_cvt_pk_bf16_f32 v26, v26, v26
    v_cvt_pk_bf16_f32 v27, v27, v27
    v_mfma_f32_16x16x32_bf16 v[96:99], v[128:131], a[64:67], v[96:99]
    v_and_b32 v80, v26, v14
    v_and_b32 v81, v27, v15
    v_mfma_f32_16x16x32_bf16 v[96:99], v[132:135], a[88:91], v[96:99]
    v_and_b32 v82, v26, v16
    v_and_b32 v83, v27, v17
    v_mfma_f32_16x16x32_bf16 v[96:99], v[136:139], a[112:115], v[96:99]
    v_mfma_f32_16x16x32_bf16 v[96:99], v[140:143], a[136:139], v[96:99]
    v_mfma_f32_16x16x32_bf16 v[72:75], v[36:39], v[80:83], 0
    v_mfma_f32_16x16x32_bf16 v[96:99], v[144:147], a[160:163], v[96:99]
    v_cvt_pk_bf16_f32 v62, v116, v117
    v_cvt_pk_bf16_f32 v63, v118, v119
    v_mfma_f32_16x16x32_bf16 v[96:99], v[148:151], a[184:187], v[96:99]
    v_cndmask_b32 v62, v62, 0, s[82:83]
    v_cndmask_b32 v63, v63, 0, s[82:83]
    v_mfma_f32_16x16x32_bf16 v[96:99], v[152:155], a[208:211], v[96:99]
    v_mfma_f32_16x16x32_bf16 v[76:79], v[46:49], v[80:83], 0
    v_mfma_f32_16x16x32_bf16 v[96:99], v[156:159], a[232:235], v[96:99]
    s_add_u32 s53, s74, 32768
    v_mfma_f32_16x16x32_bf16 v[96:99], v[160:163], v[176:179], v[96:99]
    v_mfma_f32_16x16x32_bf16 v[96:99], v[164:167], v[200:203], v[96:99]
    v_mfma_f32_16x16x32_bf16 v[96:99], v[168:171], v[224:227], v[96:99]
    v_mfma_f32_16x16x32_bf16 v[96:99], v[172:175], v[248:251], v[96:99]
    v_mfma_f32_16x16x32_bf16 v[100:103], v[120:123], a[20:23], 0
    v_cvt_pk_bf16_f32 v84, v72, v73
    v_cvt_pk_bf16_f32 v85, v74, v75
    v_mfma_f32_16x16x32_bf16 v[100:103], v[124:127], a[44:47], v[100:103]
    v_cvt_pk_bf16_f32 v86, v76, v77
    v_cvt_pk_bf16_f32 v87, v78, v79
    v_mfma_f32_16x16x32_bf16 v[100:103], v[128:131], a[68:71], v[100:103]
    buffer_store_dwordx4 v[84:87], v23, s[24:27], s53 offen sc1
    v_mfma_f32_16x16x32_bf16 v[100:103], v[132:135], a[92:95], v[100:103]
    v_cndmask_b32 v80, v84, v86, s[88:89]
    v_cndmask_b32 v81, v85, v87, s[88:89]
    v_mfma_f32_16x16x32_bf16 v[100:103], v[136:139], a[116:119], v[100:103]
    ds_write_b64 v95, v[80:81] offset:512
    v_mfma_f32_16x16x32_bf16 v[100:103], v[140:143], a[140:143], v[100:103]
    v_mfma_f32_16x16x32_bf16 v[72:75], v[52:55], v[64:67], 0
    v_mfma_f32_16x16x32_bf16 v[100:103], v[144:147], a[164:167], v[100:103]
    v_cvt_pk_bf16_f32 v34, v96, v97
    v_cvt_pk_bf16_f32 v35, v98, v99
    v_mfma_f32_16x16x32_bf16 v[100:103], v[148:151], a[188:191], v[100:103]
    v_mfma_f32_16x16x32_bf16 v[76:79], v[56:59], v[64:67], 0
    v_mfma_f32_16x16x32_bf16 v[100:103], v[152:155], a[212:215], v[100:103]
    ds_read_u16_d16_hi v8, v93 offset:49152
    ds_read_u16_d16_hi v9, v94 offset:49152
    v_mfma_f32_16x16x32_bf16 v[100:103], v[156:159], a[236:239], v[100:103]
    ds_read_u16_d16_hi v10, v92 offset:49152
    v_mfma_f32_16x16x32_bf16 v[100:103], v[160:163], v[180:183], v[100:103]
    v_mfma_f32_16x16x32_bf16 v[100:103], v[164:167], v[204:207], v[100:103]
    v_mfma_f32_16x16x32_bf16 v[100:103], v[168:171], v[228:231], v[100:103]
    v_mfma_f32_16x16x32_bf16 v[100:103], v[172:175], v[252:255], v[100:103]
    v_cndmask_b32 v26, v72, v73, s[76:77]
    v_cndmask_b32 v27, v74, v75, s[76:77]
    v_mfma_f32_16x16x32_bf16 v[104:107], a[0:3], v[120:123], 0
    v_cndmask_b32 v28, v76, v77, s[76:77]
    v_cndmask_b32 v29, v78, v79, s[76:77]
    v_mfma_f32_16x16x32_bf16 v[104:107], a[24:27], v[124:127], v[104:107]
    v_cndmask_b32 v26, v26, v28, s[78:79]
    v_cndmask_b32 v27, v27, v29, s[80:81]
    v_mfma_f32_16x16x32_bf16 v[104:107], a[48:51], v[128:131], v[104:107]
    s_waitcnt lgkmcnt(0)
    v_mul_f32 v26, v26, v8
    v_mfma_f32_16x16x32_bf16 v[104:107], a[72:75], v[132:135], v[104:107]
    v_mul_f32 v27, v27, v9
    v_mul_f32 v11, s91, v10
    v_mfma_f32_16x16x32_bf16 v[104:107], a[96:99], v[136:139], v[104:107]
    v_max_f32 v28, v26, v27
    v_mov_b32 v29, v28
    v_mfma_f32_16x16x32_bf16 v[104:107], a[120:123], v[140:143], v[104:107]
    v_mfma_f32_16x16x32_bf16 v[104:107], a[144:147], v[144:147], v[104:107]
    v_cvt_pk_bf16_f32 v44, v100, v101
    v_cvt_pk_bf16_f32 v45, v102, v103
    v_mfma_f32_16x16x32_bf16 v[104:107], a[168:171], v[148:151], v[104:107]
    v_permlane16_swap_b32 v28, v29
    v_max_f32 v28, v28, v29
    v_mfma_f32_16x16x32_bf16 v[104:107], a[192:195], v[152:155], v[104:107]
    v_mov_b32 v29, v28
    v_mfma_f32_16x16x32_bf16 v[104:107], a[216:219], v[156:159], v[104:107]
    v_mfma_f32_16x16x32_bf16 v[104:107], a[240:243], v[160:163], v[104:107]
    v_permlane32_swap_b32 v28, v29
    v_max_f32 v28, v28, v29
    v_mfma_f32_16x16x32_bf16 v[104:107], v[184:187], v[164:167], v[104:107]
    v_sub_f32 v26, v26, v28
    v_sub_f32 v27, v27, v28
    v_mfma_f32_16x16x32_bf16 v[104:107], v[208:211], v[168:171], v[104:107]
    v_mul_f32 v26, v11, v26
    v_mul_f32 v27, v11, v27
    v_mfma_f32_16x16x32_bf16 v[104:107], v[232:235], v[172:175], v[104:107]
    v_exp_f32 v26, v26
    v_mfma_f32_16x16x32_bf16 v[108:111], a[4:7], v[120:123], 0
    ds_read_b64_tr_b16 v[120:121], v4 offset:32768
    ds_read_b64_tr_b16 v[122:123], v25 offset:32768
    v_mfma_f32_16x16x32_bf16 v[108:111], a[28:31], v[124:127], v[108:111]
    ds_read_b64_tr_b16 v[124:125], v4 offset:33792
    v_exp_f32 v27, v27
    v_mfma_f32_16x16x32_bf16 v[108:111], a[52:55], v[128:131], v[108:111]
    ds_read_b64_tr_b16 v[126:127], v25 offset:33792
    ds_read_b64_tr_b16 v[128:129], v4 offset:34816
    v_mfma_f32_16x16x32_bf16 v[108:111], a[76:79], v[132:135], v[108:111]
    ds_read_b64_tr_b16 v[130:131], v25 offset:34816
    v_add_f32 v28, v26, v27
    v_mfma_f32_16x16x32_bf16 v[108:111], a[100:103], v[136:139], v[108:111]
    ds_read_b64_tr_b16 v[132:133], v4 offset:35840
    v_mov_b32 v29, v28
    v_mfma_f32_16x16x32_bf16 v[108:111], a[124:127], v[140:143], v[108:111]
    ds_read_b64_tr_b16 v[134:135], v25 offset:35840
    ds_read_b64_tr_b16 v[136:137], v4 offset:36864
    v_mfma_f32_16x16x32_bf16 v[108:111], a[148:151], v[144:147], v[108:111]
    ds_read_b64_tr_b16 v[138:139], v25 offset:36864
    s_add_u32 s57, s75, 262144
    v_mfma_f32_16x16x32_bf16 v[108:111], a[172:175], v[148:151], v[108:111]
    buffer_load_dword v22, v20, s[12:15], s57 offen
    v_mfma_f32_16x16x32_bf16 v[108:111], a[196:199], v[152:155], v[108:111]
    ds_read_b64_tr_b16 v[140:141], v4 offset:37888
    ds_read_b64_tr_b16 v[142:143], v25 offset:37888
    v_mfma_f32_16x16x32_bf16 v[108:111], a[220:223], v[156:159], v[108:111]
    ds_read_b64_tr_b16 v[144:145], v4 offset:38912
    ds_read_b64_tr_b16 v[146:147], v25 offset:38912
    v_mfma_f32_16x16x32_bf16 v[108:111], a[244:247], v[160:163], v[108:111]
    ds_read_b64_tr_b16 v[148:149], v4 offset:39936
    ds_read_b64_tr_b16 v[150:151], v25 offset:39936
    v_mfma_f32_16x16x32_bf16 v[108:111], v[188:191], v[164:167], v[108:111]
    ds_read_b64_tr_b16 v[152:153], v4 offset:40960
    v_cvt_pk_bf16_f32 v68, v104, v105
    v_mfma_f32_16x16x32_bf16 v[108:111], v[212:215], v[168:171], v[108:111]
    ds_read_b64_tr_b16 v[154:155], v25 offset:40960
    ds_read_b64_tr_b16 v[156:157], v4 offset:41984
    v_mfma_f32_16x16x32_bf16 v[108:111], v[236:239], v[172:175], v[108:111]
    ds_read_b64_tr_b16 v[158:159], v25 offset:41984
    v_cvt_pk_bf16_f32 v69, v106, v107
    s_waitcnt lgkmcnt(15)
    v_mfma_f32_16x16x32_bf16 v[112:115], a[8:11], v[120:123], 0
    ds_read_b64_tr_b16 v[160:161], v4 offset:43008
    v_permlane16_swap_b32 v28, v29
    v_mfma_f32_16x16x32_bf16 v[112:115], a[32:35], v[124:127], v[112:115]
    ds_read_b64_tr_b16 v[162:163], v25 offset:43008
    ds_read_b64_tr_b16 v[164:165], v4 offset:44032
    s_waitcnt lgkmcnt(15)
    v_mfma_f32_16x16x32_bf16 v[112:115], a[56:59], v[128:131], v[112:115]
    ds_read_b64_tr_b16 v[166:167], v25 offset:44032
    v_add_f32 v28, v28, v29
    v_mfma_f32_16x16x32_bf16 v[112:115], a[80:83], v[132:135], v[112:115]
    ds_read_b64_tr_b16 v[168:169], v4 offset:45056
    v_mov_b32 v29, v28
    s_waitcnt lgkmcnt(13)
    v_mfma_f32_16x16x32_bf16 v[112:115], a[104:107], v[136:139], v[112:115]
    ds_read_b64_tr_b16 v[170:171], v25 offset:45056
    ds_read_b64_tr_b16 v[172:173], v4 offset:46080
    v_mfma_f32_16x16x32_bf16 v[112:115], a[128:131], v[140:143], v[112:115]
    ds_read_b64_tr_b16 v[174:175], v25 offset:46080
    v_permlane32_swap_b32 v28, v29
    s_waitcnt lgkmcnt(12)
    v_mfma_f32_16x16x32_bf16 v[112:115], a[152:155], v[144:147], v[112:115]
    v_cvt_pk_bf16_f32 v70, v108, v109
    v_cvt_pk_bf16_f32 v71, v110, v111
    v_mfma_f32_16x16x32_bf16 v[112:115], a[176:179], v[148:151], v[112:115]
    v_cndmask_b32 v70, v70, 0, s[82:83]
    v_cndmask_b32 v71, v71, 0, s[82:83]
    s_waitcnt lgkmcnt(8)
    v_mfma_f32_16x16x32_bf16 v[112:115], a[200:203], v[152:155], v[112:115]
    v_add_f32 v28, v28, v29
    v_rcp_f32 v28, v28
    v_mfma_f32_16x16x32_bf16 v[112:115], a[224:227], v[156:159], v[112:115]
    v_mul_f32 v26, v26, v8
    v_mul_f32 v27, v27, v9
    s_waitcnt lgkmcnt(4)
    v_mfma_f32_16x16x32_bf16 v[112:115], a[248:251], v[160:163], v[112:115]
    v_mul_f32 v26, v26, v28
    v_mul_f32 v27, v27, v28
    v_mfma_f32_16x16x32_bf16 v[112:115], v[192:195], v[164:167], v[112:115]
    v_cvt_pk_bf16_f32 v26, v26, v26
    v_cvt_pk_bf16_f32 v27, v27, v27
    s_waitcnt lgkmcnt(0)
    v_mfma_f32_16x16x32_bf16 v[112:115], v[216:219], v[168:171], v[112:115]
    v_and_b32 v80, v26, v14
    v_and_b32 v81, v27, v15
    v_mfma_f32_16x16x32_bf16 v[112:115], v[240:243], v[172:175], v[112:115]
    v_and_b32 v82, v26, v16
    v_and_b32 v83, v27, v17
    v_mfma_f32_16x16x32_bf16 v[116:119], a[12:15], v[120:123], 0
    v_mfma_f32_16x16x32_bf16 v[116:119], a[36:39], v[124:127], v[116:119]
    v_mfma_f32_16x16x32_bf16 v[72:75], v[38:41], v[80:83], 0
    v_mfma_f32_16x16x32_bf16 v[116:119], a[60:63], v[128:131], v[116:119]
    v_mfma_f32_16x16x32_bf16 v[76:79], v[48:51], v[80:83], 0
    v_mfma_f32_16x16x32_bf16 v[116:119], a[84:87], v[132:135], v[116:119]
    s_add_u32 s53, s74, 49152
    v_mfma_f32_16x16x32_bf16 v[116:119], a[108:111], v[136:139], v[116:119]
    v_mfma_f32_16x16x32_bf16 v[116:119], a[132:135], v[140:143], v[116:119]
    v_mfma_f32_16x16x32_bf16 v[116:119], a[156:159], v[144:147], v[116:119]
    v_cvt_pk_bf16_f32 v52, v112, v113
    v_cvt_pk_bf16_f32 v53, v114, v115
    v_mfma_f32_16x16x32_bf16 v[116:119], a[180:183], v[148:151], v[116:119]
    v_mfma_f32_16x16x32_bf16 v[116:119], a[204:207], v[152:155], v[116:119]
    v_cvt_pk_bf16_f32 v84, v72, v73
    v_cvt_pk_bf16_f32 v85, v74, v75
    v_mfma_f32_16x16x32_bf16 v[116:119], a[228:231], v[156:159], v[116:119]
    v_cvt_pk_bf16_f32 v86, v76, v77
    v_cvt_pk_bf16_f32 v87, v78, v79
    v_mfma_f32_16x16x32_bf16 v[116:119], a[252:255], v[160:163], v[116:119]
    buffer_store_dwordx4 v[84:87], v23, s[24:27], s53 offen sc1
    v_mfma_f32_16x16x32_bf16 v[116:119], v[196:199], v[164:167], v[116:119]
    v_cndmask_b32 v80, v84, v86, s[88:89]
    v_cndmask_b32 v81, v85, v87, s[88:89]
    v_mfma_f32_16x16x32_bf16 v[116:119], v[220:223], v[168:171], v[116:119]
    ds_write_b64 v95, v[80:81] offset:768
    v_add_u32 v92, 65536, v92
    v_mfma_f32_16x16x32_bf16 v[116:119], v[244:247], v[172:175], v[116:119]
    v_add_u32 v93, 65536, v93
    v_add_u32 v94, 65536, v94
    v_mfma_f32_16x16x32_bf16 v[96:99], v[120:123], a[16:19], 0
L_wa_2:
    s_cbranch_execz L_wa_ret
    v_mfma_f32_16x16x32_bf16 v[72:75], v[56:59], v[68:71], 0
    v_mfma_f32_16x16x32_bf16 v[96:99], v[124:127], a[40:43], v[96:99]
    v_mfma_f32_16x16x32_bf16 v[76:79], v[60:63], v[68:71], 0
    v_mfma_f32_16x16x32_bf16 v[96:99], v[128:131], a[64:67], v[96:99]
    ds_read_u16_d16_hi v8, v93 offset:0
    ds_read_u16_d16_hi v9, v94 offset:0
    v_mfma_f32_16x16x32_bf16 v[96:99], v[132:135], a[88:91], v[96:99]
    ds_read_u16_d16_hi v10, v92 offset:0
    v_mfma_f32_16x16x32_bf16 v[96:99], v[136:139], a[112:115], v[96:99]
    v_mfma_f32_16x16x32_bf16 v[96:99], v[140:143], a[136:139], v[96:99]
    v_mfma_f32_16x16x32_bf16 v[96:99], v[144:147], a[160:163], v[96:99]
    v_cvt_pk_bf16_f32 v54, v116, v117
    v_cvt_pk_bf16_f32 v55, v118, v119
    v_mfma_f32_16x16x32_bf16 v[96:99], v[148:151], a[184:187], v[96:99]
    v_cndmask_b32 v54, v54, 0, s[82:83]
    v_cndmask_b32 v55, v55, 0, s[82:83]
    v_mfma_f32_16x16x32_bf16 v[96:99], v[152:155], a[208:211], v[96:99]
    v_cndmask_b32 v26, v72, v73, s[76:77]
    v_cndmask_b32 v27, v74, v75, s[76:77]
    v_mfma_f32_16x16x32_bf16 v[96:99], v[156:159], a[232:235], v[96:99]
    v_cndmask_b32 v28, v76, v77, s[76:77]
    v_cndmask_b32 v29, v78, v79, s[76:77]
    v_mfma_f32_16x16x32_bf16 v[96:99], v[160:163], v[176:179], v[96:99]
    v_cndmask_b32 v26, v26, v28, s[78:79]
    v_cndmask_b32 v27, v27, v29, s[80:81]
    v_mfma_f32_16x16x32_bf16 v[96:99], v[164:167], v[200:203], v[96:99]
    s_waitcnt lgkmcnt(0)
    v_mul_f32 v26, v26, v8
    v_mfma_f32_16x16x32_bf16 v[96:99], v[168:171], v[224:227], v[96:99]
    v_mul_f32 v27, v27, v9
    v_mul_f32 v11, s91, v10
    v_mfma_f32_16x16x32_bf16 v[96:99], v[172:175], v[248:251], v[96:99]
    v_max_f32 v28, v26, v27
    v_mov_b32 v29, v28
    v_mfma_f32_16x16x32_bf16 v[100:103], v[120:123], a[20:23], 0
    v_mfma_f32_16x16x32_bf16 v[100:103], v[124:127], a[44:47], v[100:103]
    v_permlane16_swap_b32 v28, v29
    v_max_f32 v28, v28, v29
    v_mfma_f32_16x16x32_bf16 v[100:103], v[128:131], a[68:71], v[100:103]
    v_mov_b32 v29, v28
    v_mfma_f32_16x16x32_bf16 v[100:103], v[132:135], a[92:95], v[100:103]
    v_mfma_f32_16x16x32_bf16 v[100:103], v[136:139], a[116:119], v[100:103]
    v_permlane32_swap_b32 v28, v29
    v_max_f32 v28, v28, v29
    v_mfma_f32_16x16x32_bf16 v[100:103], v[140:143], a[140:143], v[100:103]
    v_sub_f32 v26, v26, v28
    v_sub_f32 v27, v27, v28
    v_mfma_f32_16x16x32_bf16 v[100:103], v[144:147], a[164:167], v[100:103]
    v_cvt_pk_bf16_f32 v36, v96, v97
    v_cvt_pk_bf16_f32 v37, v98, v99
    v_mfma_f32_16x16x32_bf16 v[100:103], v[148:151], a[188:191], v[100:103]
    v_mul_f32 v26, v11, v26
    v_mul_f32 v27, v11, v27
    v_mfma_f32_16x16x32_bf16 v[100:103], v[152:155], a[212:215], v[100:103]
    v_exp_f32 v26, v26
    v_mfma_f32_16x16x32_bf16 v[100:103], v[156:159], a[236:239], v[100:103]
    v_exp_f32 v27, v27
    v_mfma_f32_16x16x32_bf16 v[100:103], v[160:163], v[180:183], v[100:103]
    v_add_f32 v28, v26, v27
    v_mov_b32 v29, v28
    v_mfma_f32_16x16x32_bf16 v[100:103], v[164:167], v[204:207], v[100:103]
    v_mfma_f32_16x16x32_bf16 v[100:103], v[168:171], v[228:231], v[100:103]
    v_permlane16_swap_b32 v28, v29
    v_add_f32 v28, v28, v29
    v_mfma_f32_16x16x32_bf16 v[100:103], v[172:175], v[252:255], v[100:103]
    v_mov_b32 v29, v28
    v_mfma_f32_16x16x32_bf16 v[104:107], a[0:3], v[120:123], 0
    v_mfma_f32_16x16x32_bf16 v[104:107], a[24:27], v[124:127], v[104:107]
    v_permlane32_swap_b32 v28, v29
    v_add_f32 v28, v28, v29
    v_mfma_f32_16x16x32_bf16 v[104:107], a[48:51], v[128:131], v[104:107]
    v_rcp_f32 v28, v28
    v_mfma_f32_16x16x32_bf16 v[104:107], a[72:75], v[132:135], v[104:107]
    v_mul_f32 v26, v26, v8
    v_mul_f32 v27, v27, v9
    v_mfma_f32_16x16x32_bf16 v[104:107], a[96:99], v[136:139], v[104:107]
    v_mul_f32 v26, v26, v28
    v_mul_f32 v27, v27, v28
    v_mfma_f32_16x16x32_bf16 v[104:107], a[120:123], v[140:143], v[104:107]
    v_cvt_pk_bf16_f32 v26, v26, v26
    v_cvt_pk_bf16_f32 v27, v27, v27
    v_mfma_f32_16x16x32_bf16 v[104:107], a[144:147], v[144:147], v[104:107]
    v_cvt_pk_bf16_f32 v46, v100, v101
    v_cvt_pk_bf16_f32 v47, v102, v103
    v_mfma_f32_16x16x32_bf16 v[104:107], a[168:171], v[148:151], v[104:107]
    v_and_b32 v80, v26, v14
    v_and_b32 v81, v27, v15
    v_mfma_f32_16x16x32_bf16 v[104:107], a[192:195], v[152:155], v[104:107]
    v_and_b32 v82, v26, v16
    v_and_b32 v83, v27, v17
    v_mfma_f32_16x16x32_bf16 v[104:107], a[216:219], v[156:159], v[104:107]
    v_mfma_f32_16x16x32_bf16 v[104:107], a[240:243], v[160:163], v[104:107]
    v_mfma_f32_16x16x32_bf16 v[72:75], v[32:35], v[80:83], 0
    v_mfma_f32_16x16x32_bf16 v[104:107], v[184:187], v[164:167], v[104:107]
    v_mfma_f32_16x16x32_bf16 v[76:79], v[42:45], v[80:83], 0
    v_mfma_f32_16x16x32_bf16 v[104:107], v[208:211], v[168:171], v[104:107]
    s_add_u32 s53, s74, 65536
    v_mfma_f32_16x16x32_bf16 v[104:107], v[232:235], v[172:175], v[104:107]
    s_waitcnt vmcnt(8)
    s_barrier
    v_mfma_f32_16x16x32_bf16 v[108:111], a[4:7], v[120:123], 0
    ds_read_b64_tr_b16 v[120:121], v4 offset:49152
    ds_read_b64_tr_b16 v[122:123], v25 offset:49152
    v_mfma_f32_16x16x32_bf16 v[108:111], a[28:31], v[124:127], v[108:111]
    ds_read_b64_tr_b16 v[124:125], v4 offset:50176
    v_mfma_f32_16x16x32_bf16 v[108:111], a[52:55], v[128:131], v[108:111]
    ds_read_b64_tr_b16 v[126:127], v25 offset:50176
    ds_read_b64_tr_b16 v[128:129], v4 offset:51200
    v_mfma_f32_16x16x32_bf16 v[108:111], a[76:79], v[132:135], v[108:111]
    ds_read_b64_tr_b16 v[130:131], v25 offset:51200
    v_cvt_pk_bf16_f32 v84, v72, v73
    v_mfma_f32_16x16x32_bf16 v[108:111], a[100:103], v[136:139], v[108:111]
    ds_read_b64_tr_b16 v[132:133], v4 offset:52224
    v_cvt_pk_bf16_f32 v85, v74, v75
    v_mfma_f32_16x16x32_bf16 v[108:111], a[124:127], v[140:143], v[108:111]
    ds_read_b64_tr_b16 v[134:135], v25 offset:52224
    ds_read_b64_tr_b16 v[136:137], v4 offset:53248
    v_mfma_f32_16x16x32_bf16 v[108:111], a[148:151], v[144:147], v[108:111]
    ds_read_b64_tr_b16 v[138:139], v25 offset:53248
    v_cvt_pk_bf16_f32 v64, v104, v105
    v_mfma_f32_16x16x32_bf16 v[108:111], a[172:175], v[148:151], v[108:111]
    ds_read_b64_tr_b16 v[140:141], v4 offset:54272
    ds_read_b64_tr_b16 v[142:143], v25 offset:54272
    v_mfma_f32_16x16x32_bf16 v[108:111], a[196:199], v[152:155], v[108:111]
    ds_read_b64_tr_b16 v[144:145], v4 offset:55296
    v_cvt_pk_bf16_f32 v65, v106, v107
    v_mfma_f32_16x16x32_bf16 v[108:111], a[220:223], v[156:159], v[108:111]
    ds_read_b64_tr_b16 v[146:147], v25 offset:55296
    v_cvt_pk_bf16_f32 v86, v76, v77
    v_mfma_f32_16x16x32_bf16 v[108:111], a[244:247], v[160:163], v[108:111]
    ds_read_b64_tr_b16 v[148:149], v4 offset:56320
    ds_read_b64_tr_b16 v[150:151], v25 offset:56320
    v_mfma_f32_16x16x32_bf16 v[108:111], v[188:191], v[164:167], v[108:111]
    ds_read_b64_tr_b16 v[152:153], v4 offset:57344
    v_cvt_pk_bf16_f32 v87, v78, v79
    v_mfma_f32_16x16x32_bf16 v[108:111], v[212:215], v[168:171], v[108:111]
    ds_read_b64_tr_b16 v[154:155], v25 offset:57344
    ds_read_b64_tr_b16 v[156:157], v4 offset:58368
    v_mfma_f32_16x16x32_bf16 v[108:111], v[236:239], v[172:175], v[108:111]
    ds_read_b64_tr_b16 v[158:159], v25 offset:58368
    buffer_store_dwordx4 v[84:87], v23, s[24:27], s53 offen sc1
    s_waitcnt lgkmcnt(15)
    v_mfma_f32_16x16x32_bf16 v[112:115], a[8:11], v[120:123], 0
    ds_read_b64_tr_b16 v[160:161], v4 offset:59392
    v_cndmask_b32 v80, v84, v86, s[88:89]
    v_mfma_f32_16x16x32_bf16 v[112:115], a[32:35], v[124:127], v[112:115]
    ds_read_b64_tr_b16 v[162:163], v25 offset:59392
    ds_read_b64_tr_b16 v[164:165], v4 offset:60416
    s_waitcnt lgkmcnt(15)
    v_mfma_f32_16x16x32_bf16 v[112:115], a[56:59], v[128:131], v[112:115]
    ds_read_b64_tr_b16 v[166:167], v25 offset:60416
    v_cndmask_b32 v81, v85, v87, s[88:89]
    v_mfma_f32_16x16x32_bf16 v[112:115], a[80:83], v[132:135], v[112:115]
    ds_read_b64_tr_b16 v[168:169], v4 offset:61440
    ds_write_b64 v95, v[80:81] offset:1024
    s_waitcnt lgkmcnt(14)
    v_mfma_f32_16x16x32_bf16 v[112:115], a[104:107], v[136:139], v[112:115]
    ds_read_b64_tr_b16 v[170:171], v25 offset:61440
    ds_read_b64_tr_b16 v[172:173], v4 offset:62464
    v_mfma_f32_16x16x32_bf16 v[112:115], a[128:131], v[140:143], v[112:115]
    ds_read_b64_tr_b16 v[174:175], v25 offset:62464
    s_waitcnt lgkmcnt(13)
    v_mfma_f32_16x16x32_bf16 v[112:115], a[152:155], v[144:147], v[112:115]
    v_cvt_pk_bf16_f32 v66, v108, v109
    v_cvt_pk_bf16_f32 v67, v110, v111
    v_mfma_f32_16x16x32_bf16 v[112:115], a[176:179], v[148:151], v[112:115]
    v_cndmask_b32 v66, v66, 0, s[82:83]
    v_cndmask_b32 v67, v67, 0, s[82:83]
    s_waitcnt lgkmcnt(9)
    v_mfma_f32_16x16x32_bf16 v[112:115], a[200:203], v[152:155], v[112:115]
    v_mfma_f32_16x16x32_bf16 v[112:115], a[224:227], v[156:159], v[112:115]
    v_mfma_f32_16x16x32_bf16 v[72:75], v[60:63], v[64:67], 0
    s_waitcnt lgkmcnt(5)
    v_mfma_f32_16x16x32_bf16 v[112:115], a[248:251], v[160:163], v[112:115]
    v_mfma_f32_16x16x32_bf16 v[76:79], v[52:55], v[64:67], 0
    v_mfma_f32_16x16x32_bf16 v[112:115], v[192:195], v[164:167], v[112:115]
    ds_read_u16_d16_hi v8, v93 offset:16384
    ds_read_u16_d16_hi v9, v94 offset:16384
    s_waitcnt lgkmcnt(2)
    v_mfma_f32_16x16x32_bf16 v[112:115], v[216:219], v[168:171], v[112:115]
    ds_read_u16_d16_hi v10, v92 offset:16384
    v_mfma_f32_16x16x32_bf16 v[112:115], v[240:243], v[172:175], v[112:115]
    v_mfma_f32_16x16x32_bf16 v[116:119], a[12:15], v[120:123], 0
    v_mfma_f32_16x16x32_bf16 v[116:119], a[36:39], v[124:127], v[116:119]
    v_mfma_f32_16x16x32_bf16 v[116:119], a[60:63], v[128:131], v[116:119]
    v_cndmask_b32 v26, v72, v73, s[76:77]
    v_cndmask_b32 v27, v74, v75, s[76:77]
    v_mfma_f32_16x16x32_bf16 v[116:119], a[84:87], v[132:135], v[116:119]
    v_cndmask_b32 v28, v76, v77, s[76:77]
    v_cndmask_b32 v29, v78, v79, s[76:77]
    v_mfma_f32_16x16x32_bf16 v[116:119], a[108:111], v[136:139], v[116:119]
    v_cndmask_b32 v26, v26, v28, s[78:79]
    v_cndmask_b32 v27, v27, v29, s[80:81]
    v_mfma_f32_16x16x32_bf16 v[116:119], a[132:135], v[140:143], v[116:119]
    s_waitcnt lgkmcnt(0)
    v_mul_f32 v26, v26, v8
    v_mfma_f32_16x16x32_bf16 v[116:119], a[156:159], v[144:147], v[116:119]
    v_cvt_pk_bf16_f32 v56, v112, v113
    v_cvt_pk_bf16_f32 v57, v114, v115
    v_mfma_f32_16x16x32_bf16 v[116:119], a[180:183], v[148:151], v[116:119]
    v_mul_f32 v27, v27, v9
    v_mul_f32 v11, s91, v10
    v_mfma_f32_16x16x32_bf16 v[116:119], a[204:207], v[152:155], v[116:119]
    v_max_f32 v28, v26, v27
    v_mov_b32 v29, v28
    v_mfma_f32_16x16x32_bf16 v[116:119], a[228:231], v[156:159], v[116:119]
    v_mfma_f32_16x16x32_bf16 v[116:119], a[252:255], v[160:163], v[116:119]
    v_permlane16_swap_b32 v28, v29
    v_max_f32 v28, v28, v29
    v_mfma_f32_16x16x32_bf16 v[116:119], v[196:199], v[164:167], v[116:119]
    v_mov_b32 v29, v28
    v_mfma_f32_16x16x32_bf16 v[116:119], v[220:223], v[168:171], v[116:119]
    v_mfma_f32_16x16x32_bf16 v[116:119], v[244:247], v[172:175], v[116:119]
    v_permlane32_swap_b32 v28, v29
    v_max_f32 v28, v28, v29
    v_mfma_f32_16x16x32_bf16 v[96:99], v[120:123], a[16:19], 0
    v_sub_f32 v26, v26, v28
    v_sub_f32 v27, v27, v28
    v_mfma_f32_16x16x32_bf16 v[96:99], v[124:127], a[40:43], v[96:99]
    v_mul_f32 v26, v11, v26
    v_mul_f32 v27, v11, v27
    v_mfma_f32_16x16x32_bf16 v[96:99], v[128:131], a[64:67], v[96:99]
    v_exp_f32 v26, v26
    v_mfma_f32_16x16x32_bf16 v[96:99], v[132:135], a[88:91], v[96:99]
    v_exp_f32 v27, v27
    v_mfma_f32_16x16x32_bf16 v[96:99], v[136:139], a[112:115], v[96:99]
    v_add_f32 v28, v26, v27
    v_mov_b32 v29, v28
    v_mfma_f32_16x16x32_bf16 v[96:99], v[140:143], a[136:139], v[96:99]
    v_mfma_f32_16x16x32_bf16 v[96:99], v[144:147], a[160:163], v[96:99]
    v_cvt_pk_bf16_f32 v58, v116, v117
    v_cvt_pk_bf16_f32 v59, v118, v119
    v_mfma_f32_16x16x32_bf16 v[96:99], v[148:151], a[184:187], v[96:99]
    v_cndmask_b32 v58, v58, 0, s[82:83]
    v_cndmask_b32 v59, v59, 0, s[82:83]
    v_mfma_f32_16x16x32_bf16 v[96:99], v[152:155], a[208:211], v[96:99]
    v_permlane16_swap_b32 v28, v29
    v_add_f32 v28, v28, v29
    v_mfma_f32_16x16x32_bf16 v[96:99], v[156:159], a[232:235], v[96:99]
    v_mov_b32 v29, v28
    v_mfma_f32_16x16x32_bf16 v[96:99], v[160:163], v[176:179], v[96:99]
    v_mfma_f32_16x16x32_bf16 v[96:99], v[164:167], v[200:203], v[96:99]
    v_permlane32_swap_b32 v28, v29
    v_add_f32 v28, v28, v29
    v_mfma_f32_16x16x32_bf16 v[96:99], v[168:171], v[224:227], v[96:99]
    v_rcp_f32 v28, v28
    v_mfma_f32_16x16x32_bf16 v[96:99], v[172:175], v[248:251], v[96:99]
    v_mul_f32 v26, v26, v8
    v_mul_f32 v27, v27, v9
    v_mfma_f32_16x16x32_bf16 v[100:103], v[120:123], a[20:23], 0
    v_mul_f32 v26, v26, v28
    v_mul_f32 v27, v27, v28
    v_mfma_f32_16x16x32_bf16 v[100:103], v[124:127], a[44:47], v[100:103]
    v_cvt_pk_bf16_f32 v26, v26, v26
    v_cvt_pk_bf16_f32 v27, v27, v27
    v_mfma_f32_16x16x32_bf16 v[100:103], v[128:131], a[68:71], v[100:103]
    v_and_b32 v80, v26, v14
    v_and_b32 v81, v27, v15
    v_mfma_f32_16x16x32_bf16 v[100:103], v[132:135], a[92:95], v[100:103]
    v_and_b32 v82, v26, v16
    v_and_b32 v83, v27, v17
    v_mfma_f32_16x16x32_bf16 v[100:103], v[136:139], a[116:119], v[100:103]
    v_mfma_f32_16x16x32_bf16 v[100:103], v[140:143], a[140:143], v[100:103]
    v_mfma_f32_16x16x32_bf16 v[72:75], v[34:37], v[80:83], 0
    v_mfma_f32_16x16x32_bf16 v[100:103], v[144:147], a[164:167], v[100:103]
    v_cvt_pk_bf16_f32 v38, v96, v97
    v_cvt_pk_bf16_f32 v39, v98, v99
    v_mfma_f32_16x16x32_bf16 v[100:103], v[148:151], a[188:191], v[100:103]
    v_mfma_f32_16x16x32_bf16 v[76:79], v[44:47], v[80:83], 0
    v_mfma_f32_16x16x32_bf16 v[100:103], v[152:155], a[212:215], v[100:103]
    s_add_u32 s53, s74, 81920
    v_mfma_f32_16x16x32_bf16 v[100:103], v[156:159], a[236:239], v[100:103]
    v_mfma_f32_16x16x32_bf16 v[100:103], v[160:163], v[180:183], v[100:103]
    v_mfma_f32_16x16x32_bf16 v[100:103], v[164:167], v[204:207], v[100:103]
    v_mfma_f32_16x16x32_bf16 v[100:103], v[168:171], v[228:231], v[100:103]
    v_mfma_f32_16x16x32_bf16 v[100:103], v[172:175], v[252:255], v[100:103]
    v_cvt_pk_bf16_f32 v84, v72, v73
    v_cvt_pk_bf16_f32 v85, v74, v75
    v_mfma_f32_16x16x32_bf16 v[104:107], a[0:3], v[120:123], 0
    v_cvt_pk_bf16_f32 v86, v76, v77
    v_cvt_pk_bf16_f32 v87, v78, v79
    v_mfma_f32_16x16x32_bf16 v[104:107], a[24:27], v[124:127], v[104:107]
    buffer_store_dwordx4 v[84:87], v23, s[24:27], s53 offen sc1
    v_mfma_f32_16x16x32_bf16 v[104:107], a[48:51], v[128:131], v[104:107]
    v_cndmask_b32 v80, v84, v86, s[88:89]
    v_cndmask_b32 v81, v85, v87, s[88:89]
    v_mfma_f32_16x16x32_bf16 v[104:107], a[72:75], v[132:135], v[104:107]
    ds_write_b64 v95, v[80:81] offset:1280
    v_mfma_f32_16x16x32_bf16 v[104:107], a[96:99], v[136:139], v[104:107]
    v_mfma_f32_16x16x32_bf16 v[104:107], a[120:123], v[140:143], v[104:107]
    v_mfma_f32_16x16x32_bf16 v[104:107], a[144:147], v[144:147], v[104:107]
    v_cvt_pk_bf16_f32 v48, v100, v101
    v_cvt_pk_bf16_f32 v49, v102, v103
    v_mfma_f32_16x16x32_bf16 v[104:107], a[168:171], v[148:151], v[104:107]
    v_mfma_f32_16x16x32_bf16 v[104:107], a[192:195], v[152:155], v[104:107]
    v_mfma_f32_16x16x32_bf16 v[104:107], a[216:219], v[156:159], v[104:107]
    v_mfma_f32_16x16x32_bf16 v[104:107], a[240:243], v[160:163], v[104:107]
    v_mfma_f32_16x16x32_bf16 v[104:107], v[184:187], v[164:167], v[104:107]
    v_mfma_f32_16x16x32_bf16 v[104:107], v[208:211], v[168:171], v[104:107]
    v_mfma_f32_16x16x32_bf16 v[104:107], v[232:235], v[172:175], v[104:107]
    v_mfma_f32_16x16x32_bf16 v[108:111], a[4:7], v[120:123], 0
    v_add_u32 v4, 65536, v4
    v_add_u32 v25, 65536, v25
    ds_read_b64_tr_b16 v[120:121], v4 offset:0
    ds_read_b64_tr_b16 v[122:123], v25 offset:0
    v_mfma_f32_16x16x32_bf16 v[108:111], a[28:31], v[124:127], v[108:111]
    ds_read_b64_tr_b16 v[124:125], v4 offset:1024
    v_mfma_f32_16x16x32_bf16 v[108:111], a[52:55], v[128:131], v[108:111]
    ds_read_b64_tr_b16 v[126:127], v25 offset:1024
    ds_read_b64_tr_b16 v[128:129], v4 offset:2048
    v_mfma_f32_16x16x32_bf16 v[108:111], a[76:79], v[132:135], v[108:111]
    ds_read_b64_tr_b16 v[130:131], v25 offset:2048
    v_mfma_f32_16x16x32_bf16 v[108:111], a[100:103], v[136:139], v[108:111]
    ds_read_b64_tr_b16 v[132:133], v4 offset:3072
    v_mfma_f32_16x16x32_bf16 v[108:111], a[124:127], v[140:143], v[108:111]
    ds_read_b64_tr_b16 v[134:135], v25 offset:3072
    ds_read_b64_tr_b16 v[136:137], v4 offset:4096
    v_mfma_f32_16x16x32_bf16 v[108:111], a[148:151], v[144:147], v[108:111]
    ds_read_b64_tr_b16 v[138:139], v25 offset:4096
    v_cvt_pk_bf16_f32 v68, v104, v105
    v_mfma_f32_16x16x32_bf16 v[108:111], a[172:175], v[148:151], v[108:111]
    ds_read_b64_tr_b16 v[140:141], v4 offset:5120
    ds_read_b64_tr_b16 v[142:143], v25 offset:5120
    v_mfma_f32_16x16x32_bf16 v[108:111], a[196:199], v[152:155], v[108:111]
    ds_read_b64_tr_b16 v[144:145], v4 offset:6144
    v_cvt_pk_bf16_f32 v69, v106, v107
    v_mfma_f32_16x16x32_bf16 v[108:111], a[220:223], v[156:159], v[108:111]
    ds_read_b64_tr_b16 v[146:147], v25 offset:6144
    v_mfma_f32_16x16x32_bf16 v[108:111], a[244:247], v[160:163], v[108:111]
    ds_read_b64_tr_b16 v[148:149], v4 offset:7168
    ds_read_b64_tr_b16 v[150:151], v25 offset:7168
    v_mfma_f32_16x16x32_bf16 v[108:111], v[188:191], v[164:167], v[108:111]
    ds_read_b64_tr_b16 v[152:153], v4 offset:8192
    v_mfma_f32_16x16x32_bf16 v[108:111], v[212:215], v[168:171], v[108:111]
    ds_read_b64_tr_b16 v[154:155], v25 offset:8192
    ds_read_b64_tr_b16 v[156:157], v4 offset:9216
    v_mfma_f32_16x16x32_bf16 v[108:111], v[236:239], v[172:175], v[108:111]
    ds_read_b64_tr_b16 v[158:159], v25 offset:9216
    s_waitcnt lgkmcnt(15)
    v_mfma_f32_16x16x32_bf16 v[112:115], a[0:3], v[120:123], 0
    ds_read_b64_tr_b16 v[160:161], v4 offset:10240
    v_mfma_f32_16x16x32_bf16 v[112:115], a[24:27], v[124:127], v[112:115]
    ds_read_b64_tr_b16 v[162:163], v25 offset:10240
    ds_read_b64_tr_b16 v[164:165], v4 offset:11264
    s_waitcnt lgkmcnt(15)
    v_mfma_f32_16x16x32_bf16 v[112:115], a[48:51], v[128:131], v[112:115]
    ds_read_b64_tr_b16 v[166:167], v25 offset:11264
    v_mfma_f32_16x16x32_bf16 v[112:115], a[72:75], v[132:135], v[112:115]
    ds_read_b64_tr_b16 v[168:169], v4 offset:12288
    s_waitcnt lgkmcnt(13)
    v_mfma_f32_16x16x32_bf16 v[112:115], a[96:99], v[136:139], v[112:115]
    ds_read_b64_tr_b16 v[170:171], v25 offset:12288
    ds_read_b64_tr_b16 v[172:173], v4 offset:13312
    v_mfma_f32_16x16x32_bf16 v[112:115], a[120:123], v[140:143], v[112:115]
    ds_read_b64_tr_b16 v[174:175], v25 offset:13312
    s_waitcnt lgkmcnt(12)
    v_mfma_f32_16x16x32_bf16 v[112:115], a[144:147], v[144:147], v[112:115]
    v_cvt_pk_bf16_f32 v70, v108, v109
    v_cvt_pk_bf16_f32 v71, v110, v111
    v_mfma_f32_16x16x32_bf16 v[112:115], a[168:171], v[148:151], v[112:115]
    v_cndmask_b32 v70, v70, 0, s[82:83]
    v_cndmask_b32 v71, v71, 0, s[82:83]
    s_waitcnt lgkmcnt(8)
    v_mfma_f32_16x16x32_bf16 v[112:115], a[192:195], v[152:155], v[112:115]
    v_mfma_f32_16x16x32_bf16 v[112:115], a[216:219], v[156:159], v[112:115]
    v_mfma_f32_16x16x32_bf16 v[72:75], v[52:55], v[68:71], 0
    s_waitcnt lgkmcnt(4)
    v_mfma_f32_16x16x32_bf16 v[112:115], a[240:243], v[160:163], v[112:115]
    v_mfma_f32_16x16x32_bf16 v[76:79], v[56:59], v[68:71], 0
    v_mfma_f32_16x16x32_bf16 v[112:115], v[184:187], v[164:167], v[112:115]
    ds_read_u16_d16_hi v8, v93 offset:32768
    ds_read_u16_d16_hi v9, v94 offset:32768
    s_waitcnt lgkmcnt(2)
    v_mfma_f32_16x16x32_bf16 v[112:115], v[208:211], v[168:171], v[112:115]
    ds_read_u16_d16_hi v10, v92 offset:32768
    v_mfma_f32_16x16x32_bf16 v[112:115], v[232:235], v[172:175], v[112:115]
    v_mfma_f32_16x16x32_bf16 v[116:119], a[4:7], v[120:123], 0
    v_mfma_f32_16x16x32_bf16 v[116:119], a[28:31], v[124:127], v[116:119]
    v_mfma_f32_16x16x32_bf16 v[116:119], a[52:55], v[128:131], v[116:119]
    v_cndmask_b32 v26, v72, v73, s[76:77]
    v_cndmask_b32 v27, v74, v75, s[76:77]
    v_mfma_f32_16x16x32_bf16 v[116:119], a[76:79], v[132:135], v[116:119]
    v_cndmask_b32 v28, v76, v77, s[76:77]
    v_cndmask_b32 v29, v78, v79, s[76:77]
    v_mfma_f32_16x16x32_bf16 v[116:119], a[100:103], v[136:139], v[116:119]
    v_cndmask_b32 v26, v26, v28, s[78:79]
    v_cndmask_b32 v27, v27, v29, s[80:81]
    v_mfma_f32_16x16x32_bf16 v[116:119], a[124:127], v[140:143], v[116:119]
    s_waitcnt lgkmcnt(0)
    v_mul_f32 v26, v26, v8
    v_mfma_f32_16x16x32_bf16 v[116:119], a[148:151], v[144:147], v[116:119]
    v_cvt_pk_bf16_f32 v64, v112, v113
    v_cvt_pk_bf16_f32 v65, v114, v115
    v_mfma_f32_16x16x32_bf16 v[116:119], a[172:175], v[148:151], v[116:119]
    v_mul_f32 v27, v27, v9
    v_mul_f32 v11, s91, v10
    v_mfma_f32_16x16x32_bf16 v[116:119], a[196:199], v[152:155], v[116:119]
    v_max_f32 v28, v26, v27
    v_mov_b32 v29, v28
    v_mfma_f32_16x16x32_bf16 v[116:119], a[220:223], v[156:159], v[116:119]
    v_mfma_f32_16x16x32_bf16 v[116:119], a[244:247], v[160:163], v[116:119]
    v_permlane16_swap_b32 v28, v29
    v_max_f32 v28, v28, v29
    v_mfma_f32_16x16x32_bf16 v[116:119], v[188:191], v[164:167], v[116:119]
    v_mov_b32 v29, v28
    v_mfma_f32_16x16x32_bf16 v[116:119], v[212:215], v[168:171], v[116:119]
    v_mfma_f32_16x16x32_bf16 v[116:119], v[236:239], v[172:175], v[116:119]
    v_permlane32_swap_b32 v28, v29
    v_max_f32 v28, v28, v29
    v_mfma_f32_16x16x32_bf16 v[96:99], a[8:11], v[120:123], 0
    v_sub_f32 v26, v26, v28
    v_sub_f32 v27, v27, v28
    v_mfma_f32_16x16x32_bf16 v[96:99], a[32:35], v[124:127], v[96:99]
    v_mul_f32 v26, v11, v26
    v_mul_f32 v27, v11, v27
    v_mfma_f32_16x16x32_bf16 v[96:99], a[56:59], v[128:131], v[96:99]
    v_exp_f32 v26, v26
    v_mfma_f32_16x16x32_bf16 v[96:99], a[80:83], v[132:135], v[96:99]
    v_exp_f32 v27, v27
    v_mfma_f32_16x16x32_bf16 v[96:99], a[104:107], v[136:139], v[96:99]
    v_add_f32 v28, v26, v27
    v_mov_b32 v29, v28
    v_mfma_f32_16x16x32_bf16 v[96:99], a[128:131], v[140:143], v[96:99]
    v_mfma_f32_16x16x32_bf16 v[96:99], a[152:155], v[144:147], v[96:99]
    v_cvt_pk_bf16_f32 v66, v116, v117
    v_cvt_pk_bf16_f32 v67, v118, v119
    v_mfma_f32_16x16x32_bf16 v[96:99], a[176:179], v[148:151], v[96:99]
    v_cndmask_b32 v66, v66, 0, s[82:83]
    v_cndmask_b32 v67, v67, 0, s[82:83]
    v_mfma_f32_16x16x32_bf16 v[96:99], a[200:203], v[152:155], v[96:99]
    v_permlane16_swap_b32 v28, v29
    v_add_f32 v28, v28, v29
    v_mfma_f32_16x16x32_bf16 v[96:99], a[224:227], v[156:159], v[96:99]
    v_mov_b32 v29, v28
    v_mfma_f32_16x16x32_bf16 v[96:99], a[248:251], v[160:163], v[96:99]
    v_mfma_f32_16x16x32_bf16 v[96:99], v[192:195], v[164:167], v[96:99]
    v_permlane32_swap_b32 v28, v29
    v_add_f32 v28, v28, v29
    v_mfma_f32_16x16x32_bf16 v[96:99], v[216:219], v[168:171], v[96:99]
    v_rcp_f32 v28, v28
    v_mfma_f32_16x16x32_bf16 v[96:99], v[240:243], v[172:175], v[96:99]
    v_mul_f32 v26, v26, v8
    v_mul_f32 v27, v27, v9
    v_mfma_f32_16x16x32_bf16 v[100:103], a[12:15], v[120:123], 0
    v_mul_f32 v26, v26, v28
    v_mul_f32 v27, v27, v28
    v_mfma_f32_16x16x32_bf16 v[100:103], a[36:39], v[124:127], v[100:103]
    v_cvt_pk_bf16_f32 v26, v26, v26
    v_cvt_pk_bf16_f32 v27, v27, v27
    v_mfma_f32_16x16x32_bf16 v[100:103], a[60:63], v[128:131], v[100:103]
    v_and_b32 v80, v26, v14
    v_and_b32 v81, v27, v15
    v_mfma_f32_16x16x32_bf16 v[100:103], a[84:87], v[132:135], v[100:103]
    v_and_b32 v82, v26, v16
    v_and_b32 v83, v27, v17
    v_mfma_f32_16x16x32_bf16 v[100:103], a[108:111], v[136:139], v[100:103]
    v_mfma_f32_16x16x32_bf16 v[100:103], a[132:135], v[140:143], v[100:103]
    v_mfma_f32_16x16x32_bf16 v[72:75], v[36:39], v[80:83], 0
    v_mfma_f32_16x16x32_bf16 v[100:103], a[156:159], v[144:147], v[100:103]
    v_cvt_pk_bf16_f32 v60, v96, v97
    v_cvt_pk_bf16_f32 v61, v98, v99
    v_mfma_f32_16x16x32_bf16 v[100:103], a[180:183], v[148:151], v[100:103]
    v_mfma_f32_16x16x32_bf16 v[76:79], v[46:49], v[80:83], 0
    v_mfma_f32_16x16x32_bf16 v[100:103], a[204:207], v[152:155], v[100:103]
    s_add_u32 s53, s74, 98304
    v_mfma_f32_16x16x32_bf16 v[100:103], a[228:231], v[156:159], v[100:103]
    v_mfma_f32_16x16x32_bf16 v[100:103], a[252:255], v[160:163], v[100:103]
    v_mfma_f32_16x16x32_bf16 v[100:103], v[196:199], v[164:167], v[100:103]
    v_mfma_f32_16x16x32_bf16 v[100:103], v[220:223], v[168:171], v[100:103]
    v_mfma_f32_16x16x32_bf16 v[100:103], v[244:247], v[172:175], v[100:103]
    v_cvt_pk_bf16_f32 v84, v72, v73
    v_cvt_pk_bf16_f32 v85, v74, v75
    v_mfma_f32_16x16x32_bf16 v[104:107], v[120:123], a[16:19], 0
    v_cvt_pk_bf16_f32 v86, v76, v77
    v_cvt_pk_bf16_f32 v87, v78, v79
    v_mfma_f32_16x16x32_bf16 v[104:107], v[124:127], a[40:43], v[104:107]
    buffer_store_dwordx4 v[84:87], v23, s[24:27], s53 offen sc1
    v_mfma_f32_16x16x32_bf16 v[104:107], v[128:131], a[64:67], v[104:107]
    v_cndmask_b32 v80, v84, v86, s[88:89]
    v_cndmask_b32 v81, v85, v87, s[88:89]
    v_mfma_f32_16x16x32_bf16 v[104:107], v[132:135], a[88:91], v[104:107]
    ds_write_b64 v95, v[80:81] offset:1536
    v_mfma_f32_16x16x32_bf16 v[104:107], v[136:139], a[112:115], v[104:107]
    v_mfma_f32_16x16x32_bf16 v[104:107], v[140:143], a[136:139], v[104:107]
    v_mfma_f32_16x16x32_bf16 v[104:107], v[144:147], a[160:163], v[104:107]
    v_cvt_pk_bf16_f32 v62, v100, v101
    v_cvt_pk_bf16_f32 v63, v102, v103
    v_mfma_f32_16x16x32_bf16 v[104:107], v[148:151], a[184:187], v[104:107]
    v_cndmask_b32 v62, v62, 0, s[82:83]
    v_cndmask_b32 v63, v63, 0, s[82:83]
    v_mfma_f32_16x16x32_bf16 v[104:107], v[152:155], a[208:211], v[104:107]
    v_mfma_f32_16x16x32_bf16 v[104:107], v[156:159], a[232:235], v[104:107]
    v_mfma_f32_16x16x32_bf16 v[72:75], v[56:59], v[64:67], 0
    v_mfma_f32_16x16x32_bf16 v[104:107], v[160:163], v[176:179], v[104:107]
    v_mfma_f32_16x16x32_bf16 v[76:79], v[60:63], v[64:67], 0
    v_mfma_f32_16x16x32_bf16 v[104:107], v[164:167], v[200:203], v[104:107]
    ds_read_u16_d16_hi v8, v93 offset:49152
    ds_read_u16_d16_hi v9, v94 offset:49152
    v_mfma_f32_16x16x32_bf16 v[104:107], v[168:171], v[224:227], v[104:107]
    ds_read_u16_d16_hi v10, v92 offset:49152
    v_mfma_f32_16x16x32_bf16 v[104:107], v[172:175], v[248:251], v[104:107]
    v_mfma_f32_16x16x32_bf16 v[108:111], v[120:123], a[20:23], 0
    v_mfma_f32_16x16x32_bf16 v[108:111], v[124:127], a[44:47], v[108:111]
    v_mfma_f32_16x16x32_bf16 v[108:111], v[128:131], a[68:71], v[108:111]
    v_cndmask_b32 v26, v72, v73, s[76:77]
    v_cndmask_b32 v27, v74, v75, s[76:77]
    v_mfma_f32_16x16x32_bf16 v[108:111], v[132:135], a[92:95], v[108:111]
    v_cndmask_b32 v28, v76, v77, s[76:77]
    v_cndmask_b32 v29, v78, v79, s[76:77]
    v_mfma_f32_16x16x32_bf16 v[108:111], v[136:139], a[116:119], v[108:111]
    v_cndmask_b32 v26, v26, v28, s[78:79]
    v_cndmask_b32 v27, v27, v29, s[80:81]
    v_mfma_f32_16x16x32_bf16 v[108:111], v[140:143], a[140:143], v[108:111]
    s_waitcnt lgkmcnt(0)
    v_mul_f32 v26, v26, v8
    v_mfma_f32_16x16x32_bf16 v[108:111], v[144:147], a[164:167], v[108:111]
    v_cvt_pk_bf16_f32 v40, v104, v105
    v_cvt_pk_bf16_f32 v41, v106, v107
    v_mfma_f32_16x16x32_bf16 v[108:111], v[148:151], a[188:191], v[108:111]
    v_mul_f32 v27, v27, v9
    v_mul_f32 v11, s91, v10
    v_mfma_f32_16x16x32_bf16 v[108:111], v[152:155], a[212:215], v[108:111]
    v_max_f32 v28, v26, v27
    v_mov_b32 v29, v28
    v_mfma_f32_16x16x32_bf16 v[108:111], v[156:159], a[236:239], v[108:111]
    v_mfma_f32_16x16x32_bf16 v[108:111], v[160:163], v[180:183], v[108:111]
    v_permlane16_swap_b32 v28, v29
    v_max_f32 v28, v28, v29
    v_mfma_f32_16x16x32_bf16 v[108:111], v[164:167], v[204:207], v[108:111]
    v_mov_b32 v29, v28
    v_mfma_f32_16x16x32_bf16 v[108:111], v[168:171], v[228:231], v[108:111]
    v_mfma_f32_16x16x32_bf16 v[108:111], v[172:175], v[252:255], v[108:111]
    v_permlane32_swap_b32 v28, v29
    v_max_f32 v28, v28, v29
    s_nop 5
    v_cvt_pk_bf16_f32 v50, v108, v109
    v_cvt_pk_bf16_f32 v51, v110, v111
    v_sub_f32 v26, v26, v28
    v_sub_f32 v27, v27, v28
    v_mul_f32 v26, v11, v26
    v_mul_f32 v27, v11, v27
    v_exp_f32 v26, v26
    v_exp_f32 v27, v27
    s_nop 0
    v_add_f32 v28, v26, v27
    v_mov_b32 v29, v28
    s_nop 1
    v_permlane16_swap_b32 v28, v29
    v_add_f32 v28, v28, v29
    v_mov_b32 v29, v28
    s_nop 1
    v_permlane32_swap_b32 v28, v29
    v_add_f32 v28, v28, v29
    v_rcp_f32 v28, v28
    v_mul_f32 v26, v26, v8
    v_mul_f32 v27, v27, v9
    v_mul_f32 v26, v26, v28
    v_mul_f32 v27, v27, v28
    v_cvt_pk_bf16_f32 v26, v26, v26
    v_cvt_pk_bf16_f32 v27, v27, v27
    v_and_b32 v80, v26, v14
    v_and_b32 v81, v27, v15
    v_and_b32 v82, v26, v16
    v_and_b32 v83, v27, v17
    s_nop 1
    v_mfma_f32_16x16x32_bf16 v[72:75], v[38:41], v[80:83], 0
    v_mfma_f32_16x16x32_bf16 v[76:79], v[48:51], v[80:83], 0
    s_add_u32 s53, s74, 114688
    s_nop 5
    v_cvt_pk_bf16_f32 v84, v72, v73
    v_cvt_pk_bf16_f32 v85, v74, v75
    v_cvt_pk_bf16_f32 v86, v76, v77
    v_cvt_pk_bf16_f32 v87, v78, v79
    buffer_store_dwordx4 v[84:87], v23, s[24:27], s53 offen sc1
    v_cndmask_b32 v80, v84, v86, s[88:89]
    v_cndmask_b32 v81, v85, v87, s[88:89]
    ds_write_b64 v95, v[80:81] offset:1792
    v_lshlrev_b32 v6, 4, v0
    v_add_u32 v6, 147456, v6
    v_lshrrev_b32 v7, 4, v1
    v_and_b32 v12, 15, v1
    v_lshlrev_b32 v7, 14, v7
    v_lshl_add_u32 v7, v12, 4, v7
    s_waitcnt lgkmcnt(0)
    s_barrier
    ds_read_b128 v[72:75], v6
    s_waitcnt lgkmcnt(0)
    buffer_store_dwordx4 v[72:75], v7, s[24:27], s95 offen sc1
    s_waitcnt vmcnt(0) lgkmcnt(0)
    s_barrier
    s_cmp_lg_u32 s44, 0
    s_cbranch_scc1 L_nopub21
    s_lshl_b32 s60, s48, 4
    s_add_u32 s60, s60, s49
    s_lshl_b32 s60, s60, 7
L_wa_3:
    s_cbranch_execz L_wa_ret
    s_add_u32 s60, s60, 12779520
    v_mov_b32 v30, s47
    s_mov_b64 exec, 1
    buffer_store_dword v30, off, s[24:27], s60 sc1
    s_mov_b64 exec, -1
L_nopub21:
    s_endpgm
L_codeend:
.section .rodata,"a"
.p2align 6
.amdhsa_kernel parallel_sum__sliding_local_dilated__mixer_token_mlp__prompt_kernel
  .amdhsa_next_free_vgpr 512
  .amdhsa_next_free_sgpr 102
  .amdhsa_accum_offset 256
  .amdhsa_group_segment_fixed_size 0
  .amdhsa_kernarg_size 88
  .amdhsa_user_sgpr_count 2
  .amdhsa_user_sgpr_kernarg_segment_ptr 1
  .amdhsa_system_sgpr_workgroup_id_x 1
  .amdhsa_float_denorm_mode_32 3
.end_amdhsa_kernel
```

```asm
; @launch grid=(256,1,1) block=(256,1,1) lds=163840
.amdgcn_target "amdgcn-amd-amdhsa--gfx950"
.text
.globl parallel_sum__sliding_local_dilated__mixer_token_mlp__prompt_kernel
.p2align 8
.type parallel_sum__sliding_local_dilated__mixer_token_mlp__prompt_kernel,@function
parallel_sum__sliding_local_dilated__mixer_token_mlp__prompt_kernel:
    s_cmp_ge_u32 s2, 256
    s_cbranch_scc1 L_end
    s_load_dwordx2 s[4:5], s[0:1], 0
    s_load_dwordx16 s[76:91], s[0:1], 0
    s_load_dwordx4 s[92:95], s[0:1], 64
    s_load_dwordx2 s[24:25], s[0:1], 80
    s_lshr_b32 s46, s2, 3
    s_getpc_b64 s[98:99]
L_pc:
    s_mul_i32 s53, s46, 1536
    v_lshrrev_b32 v26, 4, v0
    v_min_u32 v26, 11, v26
    v_lshl_add_u32 v26, v26, 7, s53
    v_lshrrev_b32 v25, 5, v0
    v_min_u32 v26, L_codeend-L_pc-4, v26
    v_mov_b32 v29, s99
    v_add_co_u32 v28, vcc, s98, v26
    s_nop 1
    v_addc_co_u32 v29, vcc, 0, v29, vcc
    global_load_dword v108, v[28:29], off
    v_and_b32 v26, 31, v0
    v_mul_u32_u24 v24, 896, v25
    v_lshl_add_u32 v24, v26, 4, v24
    s_mul_i32 s53, s2, 7168
    v_add_u32 v24, s53, v24
    v_cmp_gt_u32 vcc, 24, v26
    v_mov_b32 v27, 2130706432
    s_mov_b32 s6, 1835008
    s_mov_b32 s7, 0x20000
    v_cndmask_b32 v22, v27, v24, vcc
    v_lshrrev_b32 v27, 6, v0
    v_and_b32 v1, 63, v0
    s_waitcnt lgkmcnt(0)
    buffer_load_dwordx4 v[32:35], v24, s[4:7], 0 offen
    buffer_load_dwordx4 v[36:39], v22, s[4:7], 0 offen offset:512
    v_readfirstlane_b32 s44, v27
    s_and_b32 s45, s2, 7
    s_mov_b64 s[8:9], s[78:79]
    s_mov_b32 s10, 1204224
    s_mov_b32 s11, s7
    s_and_b32 s53, s45, 6
    s_lshr_b32 s53, 0xc9, s53
    s_and_b32 s53, s53, 3
    s_add_u32 s54, s53, 1
    s_bfe_u32 s54, s54, 0x10001
    s_add_u32 s54, s54, 1
    s_mul_i32 s53, s53, 224
    s_andn2_b32 s53, s53, 127
    s_sub_u32 s55, s46, 3
    s_cmp_lt_u32 s46, 24
    s_cselect_b32 s55, 63, s55
    s_cmp_lt_u32 s46, 21
    s_cselect_b32 s55, s46, s55
    s_mul_i32 s55, s55, 43008
    s_add_u32 s53, s53, s55
    v_and_b32 v27, 3, v0
    v_min_u32 v27, s54, v27
    v_bfe_u32 v28, v0, 2, 2
    v_med3_u32 v28, v28, 0, 2
    v_mul_u32_u24 v28, 7, v28
    v_add_u32 v27, v27, v28
    v_lshrrev_b32 v28, 4, v0
    v_min_u32 v28, 15, v28
    v_mul_u32_u24 v28, 21, v28
    v_add_lshl_u32 v27, v27, v28, 7
    buffer_load_dword v108, v27, s[8:11], s53 offen
    s_mov_b64 s[40:41], s[94:95]
    s_mov_b32 s42, 256
    s_mov_b32 s43, s7
    s_or_b32 s53, s2, s44
    s_cbranch_scc1 L_nononce
    s_memrealtime s[98:99]
    s_waitcnt lgkmcnt(0)
    s_or_b32 s98, s98, 1
    v_mov_b32 v28, s98
    s_mov_b64 exec, 1
    buffer_store_dword v28, off, s[40:43], 0 sc1
    s_mov_b64 exec, -1
L_nononce:
    s_mov_b64 s[16:17], s[84:85]
    s_mov_b32 s18, 7340032
    s_mov_b32 s19, s7
    s_mov_b32 s26, 16777216
    s_mov_b32 s27, s7
    s_mov_b64 s[20:21], s[88:89]
    s_mov_b32 s22, 7340032
    s_mov_b32 s23, s7
    s_mov_b64 s[12:13], s[80:81]
    s_mov_b32 s14, 401408
    s_mov_b32 s15, s7
    s_mov_b64 s[28:29], s[92:93]
    s_mov_b32 s30, 1835008
    s_mov_b32 s31, s7
    s_mov_b64 s[32:33], s[86:87]
    s_mov_b32 s34, 3584
    s_mov_b32 s35, s7
    s_mov_b64 s[36:37], s[90:91]
    s_mov_b32 s38, 4096
    s_mov_b32 s39, s7
    s_lshl_b32 s52, s44, 12
    v_lshlrev_b32 v23, 4, v1
    s_cmp_ge_u32 s46, 24
    s_cbranch_scc1 L_role_a
    v_lshrrev_b32 v208, 4, v1
    v_bfe_u32 v209, v1, 2, 2
    v_and_b32 v210, 3, v1
    v_and_b32 v211, 15, v1
    v_lshrrev_b32 v212, 5, v1
    s_mul_i32 s55, s45, 3
    s_max_u32 s55, s55, 1
    s_add_u32 s55, s55, s46
    s_sub_u32 s55, s55, 1
    s_sub_u32 s56, s55, 21
    s_min_u32 s55, s55, s56
    s_and_b32 s54, s45, 1
    s_mul_i32 s54, s54, 24
    s_sub_u32 s54, s46, s54
    s_cmp_ge_u32 s46, 21
    s_cselect_b32 s54, s54, s55
    s_mul_i32 s53, s45, 21
    s_add_u32 s53, s53, s54
    s_mul_i32 s50, s53, 171
    s_lshr_b32 s50, s50, 10
    s_mul_i32 s54, s50, 6
    s_sub_u32 s88, s53, s54
    s_mul_i32 s51, s50, 2
    s_add_u32 s51, s51, s88
    s_mul_i32 s54, s51, 43
    s_lshr_b32 s54, s54, 8
    s_mul_i32 s54, s54, 6
    s_sub_u32 s51, s51, s54
    s_mul_i32 s65, s51, 14
    s_add_u32 s65, s65, 2
    s_mul_i32 s65, s65, 171
    s_lshr_b32 s65, s65, 10
    v_lshl_add_u32 v213, v212, 2, v209
    v_and_b32 v215, 1, v208
    v_lshlrev_b32 v214, 4, v210
    v_lshl_add_u32 v214, v215, 6, v214
    s_mul_i32 s53, s44, 1835008
    s_lshl_b32 s54, s50, 7
    s_add_u32 s53, s53, s54
    v_mul_u32_u24 v10, 3584, v213
    v_add3_u32 v10, v10, v214, s53
    v_xor_b32 v11, 32, v10
    s_cmp_ge_u32 s46, 21
    s_cbranch_scc1 L_help
    s_add_u32 m0, s52, 49152
    s_add_u32 s57, s65, 0
    s_sub_u32 s3, s57, 14
    s_min_u32 s57, s57, s3
    s_mul_i32 s57, s57, 114688
    buffer_load_dwordx4 v10, s[16:19], s57 offen offset:0 lds
    s_add_u32 s57, s57, 27648
    buffer_load_dwordx4 v11, s[16:19], s57 offen offset:1024 lds
    v_mul_u32_u24 v109, 1088, v25
    v_lshl_add_u32 v109, v26, 4, v109
    v_mul_u32_u24 v110, 1088, v209
    v_lshl_add_u32 v110, v208, 5, v110
    v_lshl_add_u32 v110, v210, 3, v110
    s_lshl_b32 s53, s44, 7
    v_add_u32 v110, s53, v110
    v_mul_u32_u24 v111, 66816, v208
    v_lshl_add_u32 v111, v211, 4, v111
    s_mul_i32 s63, s44, 267264
    s_lshl_b32 s53, s2, 8
    s_add_u32 s63, s63, s53
    s_add_u32 s64, s63, 1069056
    v_cmp_gt_u32 vcc, 208, v0
    v_mov_b32 v100, 2130706432
    v_cmp_le_u32 s[92:93], 24, v26
    v_cndmask_b32 v22, v100, v111, vcc
    s_mov_b32 s62, 0x3f803f80
    s_mov_b32 s61, 0xffff0000
    v_mov_b32 v96, 0
    v_mov_b32 v97, 0
    v_lshlrev_b32 v216, 6, v209
    v_lshl_add_u32 v216, v210, 3, v216
    v_lshl_add_u32 v216, v215, 5, v216
    s_add_u32 s53, s52, 49152
    v_lshl_add_u32 v2, v208, 10, v216
    v_add_u32 v2, s53, v2
    v_xor_b32 v3, 32, v2
    v_add_u32 v4, 65536, v2
    v_add_u32 v5, 65536, v3
    v_lshl_add_u32 v6, v208, 9, v216
    v_add_u32 v6, s53, v6
    v_xor_b32 v7, 32, v6
    v_add_u32 v8, 65536, v6
    v_add_u32 v9, 65536, v7
    s_waitcnt vmcnt(4)
    v_dot2c_f32_bf16 v96, s62, v32
    v_dot2c_f32_bf16 v97, v32, v32
    v_lshlrev_b32 v40, 16, v32
    v_and_b32 v41, s61, v32
    v_dot2c_f32_bf16 v96, s62, v33
    v_dot2c_f32_bf16 v97, v33, v33
    v_lshlrev_b32 v42, 16, v33
    v_and_b32 v43, s61, v33
    v_dot2c_f32_bf16 v96, s62, v34
    v_dot2c_f32_bf16 v97, v34, v34
    v_lshlrev_b32 v44, 16, v34
    v_and_b32 v45, s61, v34
    v_dot2c_f32_bf16 v96, s62, v35
    v_dot2c_f32_bf16 v97, v35, v35
    v_lshlrev_b32 v46, 16, v35
    v_and_b32 v47, s61, v35
    s_waitcnt vmcnt(3)
    v_dot2c_f32_bf16 v96, s62, v36
    v_dot2c_f32_bf16 v97, v36, v36
    v_lshlrev_b32 v48, 16, v36
    v_and_b32 v49, s61, v36
    v_dot2c_f32_bf16 v96, s62, v37
    v_dot2c_f32_bf16 v97, v37, v37
    v_lshlrev_b32 v50, 16, v37
    v_and_b32 v51, s61, v37
    v_dot2c_f32_bf16 v96, s62, v38
    v_dot2c_f32_bf16 v97, v38, v38
    v_lshlrev_b32 v52, 16, v38
    v_and_b32 v53, s61, v38
    v_dot2c_f32_bf16 v96, s62, v39
    v_dot2c_f32_bf16 v97, v39, v39
    v_lshlrev_b32 v54, 16, v39
    v_and_b32 v55, s61, v39
    buffer_load_dword v29, off, s[40:43], 0 sc1
    v_add_f32_dpp v96, v96, v96 quad_perm:[1,0,3,2] row_mask:0xf bank_mask:0xf
    v_add_f32_dpp v97, v97, v97 quad_perm:[1,0,3,2] row_mask:0xf bank_mask:0xf
    s_nop 0
    v_add_f32_dpp v96, v96, v96 quad_perm:[2,3,0,1] row_mask:0xf bank_mask:0xf
    v_add_f32_dpp v97, v97, v97 quad_perm:[2,3,0,1] row_mask:0xf bank_mask:0xf
    s_nop 0
    v_add_f32_dpp v96, v96, v96 row_half_mirror row_mask:0xf bank_mask:0xf
    v_add_f32_dpp v97, v97, v97 row_half_mirror row_mask:0xf bank_mask:0xf
    s_nop 0
    v_add_f32_dpp v96, v96, v96 row_mirror row_mask:0xf bank_mask:0xf
    v_add_f32_dpp v97, v97, v97 row_mirror row_mask:0xf bank_mask:0xf
    v_mov_b32 v98, v96
    v_mov_b32 v99, v97
    s_nop 0
    v_permlane16_swap_b32 v96, v98
    v_permlane16_swap_b32 v97, v99
    v_add_f32 v96, v96, v98
    v_add_f32 v97, v97, v99
    v_mul_f32 v98, 0x3b124925, v96
    v_mul_f32 v99, 0x3b124925, v97
    v_fma_f32 v99, -v98, v98, v99
    v_max_f32 v99, 0, v99
    v_cvt_pk_bf16_f32 v100, 0, v99
    v_add_f32 v100, 0x3727c5ac, v100
    v_cvt_pk_bf16_f32 v100, 0, v100
    v_sqrt_f32 v100, v100
    s_nop 0
    v_cvt_pk_bf16_f32 v100, 0, v100
    v_rcp_f32 v100, v100
    s_nop 0
    v_mul_f32 v99, v99, v100
    v_mul_f32 v99, v99, v100
    v_cvt_pk_bf16_f32 v104, 0, v99
    v_add_f32 v104, 0x3727c5ac, v104
    v_cvt_pk_bf16_f32 v104, 0, v104
    v_sqrt_f32 v104, v104
    s_nop 0
    v_cvt_pk_bf16_f32 v102, 0, v104
    v_rcp_f32 v104, v102
    s_nop 0
    v_mul_f32 v104, v104, v100
    v_mul_f32 v106, v98, v104
    v_pk_fma_f32 v[56:57], v[40:41], v[104:105], v[106:107] op_sel_hi:[1,0,0] neg_lo:[0,0,1] neg_hi:[0,0,1]
    v_pk_fma_f32 v[58:59], v[42:43], v[104:105], v[106:107] op_sel_hi:[1,0,0] neg_lo:[0,0,1] neg_hi:[0,0,1]
    v_pk_fma_f32 v[60:61], v[44:45], v[104:105], v[106:107] op_sel_hi:[1,0,0] neg_lo:[0,0,1] neg_hi:[0,0,1]
    v_pk_fma_f32 v[62:63], v[46:47], v[104:105], v[106:107] op_sel_hi:[1,0,0] neg_lo:[0,0,1] neg_hi:[0,0,1]
    v_pk_fma_f32 v[64:65], v[48:49], v[104:105], v[106:107] op_sel_hi:[1,0,0] neg_lo:[0,0,1] neg_hi:[0,0,1]
    v_pk_fma_f32 v[66:67], v[50:51], v[104:105], v[106:107] op_sel_hi:[1,0,0] neg_lo:[0,0,1] neg_hi:[0,0,1]
    v_pk_fma_f32 v[68:69], v[52:53], v[104:105], v[106:107] op_sel_hi:[1,0,0] neg_lo:[0,0,1] neg_hi:[0,0,1]
    v_pk_fma_f32 v[70:71], v[54:55], v[104:105], v[106:107] op_sel_hi:[1,0,0] neg_lo:[0,0,1] neg_hi:[0,0,1]
    v_cvt_pk_bf16_f32 v80, v56, v57
    v_cvt_pk_bf16_f32 v81, v58, v59
    v_cvt_pk_bf16_f32 v82, v60, v61
    v_cvt_pk_bf16_f32 v83, v62, v63
    v_cvt_pk_bf16_f32 v84, v64, v65
    v_cvt_pk_bf16_f32 v85, v66, v67
    v_cvt_pk_bf16_f32 v86, v68, v69
    v_cvt_pk_bf16_f32 v87, v70, v71
    v_lshrrev_b32 v102, 16, v102
    v_cndmask_b32 v84, v84, v102, s[92:93]
    ds_write_b128 v109, v[80:83] offset:0
    ds_write_b128 v109, v[84:87] offset:512
    s_waitcnt lgkmcnt(0)
    s_barrier
    ds_read_b64_tr_b16 v[88:89], v110 offset:0
    ds_read_b64_tr_b16 v[90:91], v110 offset:4352
    ds_read_b64_tr_b16 v[92:93], v110 offset:512
    ds_read_b64_tr_b16 v[94:95], v110 offset:4864
    s_waitcnt lgkmcnt(2)
    buffer_store_dwordx4 v[88:91], v111, s[24:27], s63 offen sc1
    s_waitcnt lgkmcnt(0)
    buffer_store_dwordx4 v[92:95], v22, s[24:27], s64 offen sc1
    s_add_u32 s57, s57, 27648
    buffer_load_dwordx4 v10, s[16:19], s57 offen offset:2048 lds
    s_add_u32 s57, s57, 27648
    buffer_load_dwordx4 v11, s[16:19], s57 offen offset:3072 lds
    s_add_u32 m0, s52, 65536
    s_add_u32 s57, s65, 1
    s_sub_u32 s3, s57, 14
    s_min_u32 s57, s57, s3
    s_mul_i32 s57, s57, 114688
    buffer_load_dwordx4 v10, s[16:19], s57 offen offset:0 lds
    s_add_u32 s57, s57, 27648
    buffer_load_dwordx4 v11, s[16:19], s57 offen offset:1024 lds
    s_add_u32 s57, s57, 27648
    buffer_load_dwordx4 v10, s[16:19], s57 offen offset:2048 lds
    s_add_u32 s57, s57, 27648
    buffer_load_dwordx4 v11, s[16:19], s57 offen offset:3072 lds
    s_branch L_body
.p2align 12
L_body:
    s_mov_b32 s59, s44
    s_mov_b64 exec, 0
    s_branch L_wb_go
L_wb_ret:
    s_add_u32 s59, s59, 4
L_wb_go:
    s_cmp_eq_u32 s59, 0
    s_cbranch_scc1 L_wb_0
    s_cmp_eq_u32 s59, 1
    s_cbranch_scc1 L_wb_1
    s_cmp_eq_u32 s59, 2
    s_cbranch_scc1 L_wb_2
    s_cmp_eq_u32 s59, 3
    s_cbranch_scc1 L_wb_3
    s_cmp_eq_u32 s59, 4
    s_cbranch_scc1 L_wb_3
    s_cmp_eq_u32 s59, 5
    s_cbranch_scc1 L_wb_3
    s_mov_b64 exec, -1
    s_waitcnt vmcnt(6)
    v_cmp_eq_u32 vcc, 0, v29
    s_nop 0
    s_cbranch_vccz L_ok2
    s_mov_b32 s59, 100000
L_spin1:
    buffer_load_dword v29, off, s[40:43], 0 sc1
    s_waitcnt vmcnt(0)
    v_cmp_eq_u32 vcc, 0, v29
    s_nop 0
    s_cbranch_vccz L_ok2
    s_sub_u32 s59, s59, 1
    s_cbranch_scc0 L_spin1
L_ok2:
    v_readfirstlane_b32 s47, v29
    s_barrier
    s_cmp_lg_u32 s44, 0
    s_cbranch_scc1 L_nopub3
    s_lshl_b32 s60, s2, 5
    s_add_u32 s60, s60, 12582912
    v_mov_b32 v30, s47
    s_mov_b64 exec, 1
    buffer_store_dword v30, off, s[24:27], s60 sc1
    s_mov_b64 exec, -1
L_nopub3:
    s_lshl_b32 s53, s44, 11
    s_add_u32 s53, s53, 12582912
    v_lshl_add_u32 v18, v1, 5, s53
    s_lshl_b32 s53, s50, 7
    s_add_u32 m0, s52, 81920
    s_add_u32 s57, s65, 2
    s_sub_u32 s3, s57, 14
    s_min_u32 s57, s57, s3
    s_mul_i32 s57, s57, 114688
    buffer_load_dwordx4 v10, s[16:19], s57 offen offset:0 lds
    v_lshl_add_u32 v19, v208, 3, s53
    s_lshl2_add_u32 s67, s51, s44
    s_mul_i32 s67, s67, 58624
    s_lshl_b32 s53, s50, 11
    s_add_u32 s57, s57, 27648
    buffer_load_dwordx4 v11, s[16:19], s57 offen offset:1024 lds
    s_add_u32 s67, s67, s53
    s_add_u32 s67, s67, 2097152
    v_mov_b32 v236, 0xbdd2d3e8
    v_mov_b32 v237, 0xc0135761
    s_add_u32 s57, s57, 27648
    buffer_load_dwordx4 v10, s[16:19], s57 offen offset:2048 lds
    s_or_b32 s88, s88, 0
    s_add_u32 s54, s88, 24
    s_mul_i32 s84, s54, 66816
    s_lshl2_add_u32 s84, s52, s84
    s_mul_i32 s83, s54, 58624
    s_add_u32 s83, s83, s53
    s_and_b32 s54, s44, 1
    s_lshl_b32 s54, s54, 10
    s_add_u32 s57, s57, 27648
    buffer_load_dwordx4 v11, s[16:19], s57 offen offset:3072 lds
    s_add_u32 s83, s83, s54
    s_add_u32 s83, s83, 2097152
    s_lshl1_add_u32 s54, s54, 49152
    v_add_u32 v243, s54, v23
    s_add_u32 m0, s52, 98304
    s_add_u32 s57, s65, 3
    s_sub_u32 s3, s57, 14
    s_min_u32 s57, s57, s3
    s_mul_i32 s57, s57, 114688
    buffer_load_dwordx4 v10, s[16:19], s57 offen offset:0 lds
    s_cmp_lt_u32 s88, 4
    s_cselect_b32 s84, s84, 2130706432
    s_cselect_b32 s83, s83, 2130706432
    s_cmp_lt_u32 s44, 2
    s_cselect_b32 s83, s83, 2130706432
    s_cmp_eq_u32 s44, 0
    s_cselect_b32 s85, 1.0, 0
    s_mul_i32 s53, s45, 7
    s_lshr_b32 s53, s53, 1
    s_sub_u32 s53, s50, s53
    s_lshl1_add_u32 s53, s53, s88
    s_sub_u32 s53, s53, 4
    s_mul_i32 s54, s44, 28
    s_add_u32 s54, s54, s53
    s_lshl_b32 s87, s54, 16
    s_lshl_b32 s54, s45, 9
    s_add_u32 s87, s87, s54
    s_cmp_ge_u32 s88, 4
    s_cselect_b32 s87, s87, 2130706432
    v_lshrrev_b32 v254, 2, v1
    v_lshlrev_b32 v254, 12, v254
    v_lshl_add_u32 v254, v210, 7, v254
    s_add_u32 s57, s57, 27648
    buffer_load_dwordx4 v11, s[16:19], s57 offen offset:1024 lds
    s_waitcnt vmcnt(10)
    ds_read_b64_tr_b16 a[0:1], v2 offset:0
    ds_read_b64_tr_b16 a[2:3], v2 offset:512
    ds_read_b64_tr_b16 a[4:5], v3 offset:0
    ds_read_b64_tr_b16 a[6:7], v3 offset:512
    s_add_u32 s57, s57, 27648
    buffer_load_dwordx4 v10, s[16:19], s57 offen offset:2048 lds
    ds_read_b64_tr_b16 a[8:9], v2 offset:256
    ds_read_b64_tr_b16 a[10:11], v2 offset:768
    ds_read_b64_tr_b16 a[12:13], v3 offset:256
    ds_read_b64_tr_b16 a[14:15], v3 offset:768
    s_add_u32 s57, s57, 27648
    buffer_load_dwordx4 v11, s[16:19], s57 offen offset:3072 lds
    s_lshr_b32 s53, s46, 2
    s_and_b32 s89, s46, 3
    s_bfe_u32 s54, s46, 0x20001
    s_and_b32 s55, s46, 1
    s_add_u32 s55, s55, 4
    s_cmp_lt_u32 s46, 16
    s_cselect_b32 s53, s53, s54
    s_cselect_b32 s89, s89, s55
    s_mul_i32 s49, s53, 2
    s_add_u32 s49, s49, s89
    s_sub_u32 s54, s49, 6
    s_min_u32 s49, s49, s54
    s_or_b32 s89, s89, 0
    s_add_u32 m0, s52, 114688
    s_add_u32 s57, s65, 4
    s_sub_u32 s3, s57, 14
    s_min_u32 s57, s57, s3
    s_mul_i32 s57, s57, 114688
    buffer_load_dwordx4 v10, s[16:19], s57 offen offset:0 lds
    s_lshl2_add_u32 s48, s45, s53
    s_mul_i32 s53, s44, 1835008
    s_lshl_b32 s74, s48, 7
    s_add_u32 s53, s53, s74
    s_add_u32 s57, s57, 27648
    buffer_load_dwordx4 v11, s[16:19], s57 offen offset:1024 lds
    s_waitcnt vmcnt(10)
    ds_read_b64_tr_b16 a[16:17], v2 offset:16384
    ds_read_b64_tr_b16 a[18:19], v2 offset:16896
    ds_read_b64_tr_b16 a[20:21], v3 offset:16384
    ds_read_b64_tr_b16 a[22:23], v3 offset:16896
    s_add_u32 s57, s57, 27648
    buffer_load_dwordx4 v10, s[16:19], s57 offen offset:2048 lds
    ds_read_b64_tr_b16 a[24:25], v2 offset:16640
    ds_read_b64_tr_b16 a[26:27], v2 offset:17152
    ds_read_b64_tr_b16 a[28:29], v3 offset:16640
    ds_read_b64_tr_b16 a[30:31], v3 offset:17152
    s_lshl_b32 s56, s44, 5
    v_lshlrev_b32 v217, 5, v212
    v_xor_b32 v217, v217, v214
    v_xor_b32 v217, s56, v217
    s_add_u32 s57, s57, 27648
    buffer_load_dwordx4 v11, s[16:19], s57 offen offset:3072 lds
    s_add_u32 s74, s74, s56
    v_lshlrev_b32 v12, 12, v213
    v_add3_u32 v12, v12, v217, s53
    s_mul_i32 s53, s44, 28672
    s_add_u32 m0, s52, 131072
    s_add_u32 s57, s65, 5
    s_sub_u32 s3, s57, 14
    s_min_u32 s57, s57, s3
    s_mul_i32 s57, s57, 114688
    buffer_load_dwordx4 v10, s[16:19], s57 offen offset:0 lds
    s_lshl_b32 s54, s49, 7
    s_add_u32 s55, s53, s54
    v_mul_u32_u24 v13, 896, v213
    v_add3_u32 v13, v13, v214, s55
    s_add_u32 s57, s57, 27648
    buffer_load_dwordx4 v11, s[16:19], s57 offen offset:1024 lds
    s_waitcnt vmcnt(10)
    ds_read_b64_tr_b16 a[32:33], v2 offset:32768
    ds_read_b64_tr_b16 a[34:35], v2 offset:33280
    ds_read_b64_tr_b16 a[36:37], v3 offset:32768
    ds_read_b64_tr_b16 a[38:39], v3 offset:33280
    v_xor_b32 v14, 32, v13
    s_mul_i32 s55, s44, 21504
    v_subrev_u32 v239, s55, v13
    s_and_b32 s55, s56, 32
    ds_read_b64_tr_b16 a[40:41], v2 offset:33024
    ds_read_b64_tr_b16 a[42:43], v2 offset:33536
    ds_read_b64_tr_b16 a[44:45], v3 offset:33024
    ds_read_b64_tr_b16 a[46:47], v3 offset:33536
    s_add_u32 s57, s57, 27648
    buffer_load_dwordx4 v10, s[16:19], s57 offen offset:2048 lds
    v_xor_b32 v239, s55, v239
    s_mul_i32 s73, s48, 57344
    s_add_u32 s71, s73, s54
    s_mul_i32 s55, s44, 14336
    s_add_u32 s57, s57, 27648
    buffer_load_dwordx4 v11, s[16:19], s57 offen offset:3072 lds
    s_add_u32 s71, s71, s55
    s_add_u32 s72, s71, 7168
    v_bfe_u32 v217, v1, 1, 2
    v_lshl_add_u32 v217, v212, 2, v217
    s_add_u32 m0, s52, 147456
    s_add_u32 s57, s65, 6
    s_sub_u32 s3, s57, 14
    s_min_u32 s57, s57, s3
    s_mul_i32 s57, s57, 114688
    buffer_load_dwordx4 v10, s[16:19], s57 offen offset:0 lds
    v_and_b32 v218, 24, v1
    v_add_u32 v217, v217, v218
    v_mul_u32_u24 v15, 896, v217
    v_and_b32 v217, 1, v1
    v_lshl_add_u32 v15, v217, 4, v15
    v_add_u32 v15, s53, v15
    s_lshl_b32 s54, s89, 5
    s_add_u32 s54, s54, 768
    s_add_u32 s57, s57, 27648
    buffer_load_dwordx4 v11, s[16:19], s57 offen offset:1024 lds
    s_waitcnt vmcnt(10)
    ds_read_b64_tr_b16 a[48:49], v2 offset:49152
    ds_read_b64_tr_b16 a[50:51], v2 offset:49664
    ds_read_b64_tr_b16 a[52:53], v3 offset:49152
    ds_read_b64_tr_b16 a[54:55], v3 offset:49664
    s_add_u32 s57, s57, 27648
    buffer_load_dwordx4 v10, s[16:19], s57 offen offset:2048 lds
    ds_read_b64_tr_b16 a[56:57], v2 offset:49408
    ds_read_b64_tr_b16 a[58:59], v2 offset:49920
    ds_read_b64_tr_b16 a[60:61], v3 offset:49408
    ds_read_b64_tr_b16 a[62:63], v3 offset:49920
    s_add_u32 s57, s57, 27648
    buffer_load_dwordx4 v11, s[16:19], s57 offen offset:3072 lds
    s_add_u32 s68, s89, 24
    s_mul_i32 s68, s68, 58624
    s_mul_i32 s69, s44, 14336
    s_add_u32 s69, s69, 2097152
    s_add_u32 s68, s68, s69
    s_mul_i32 s55, s49, 234496
    s_add_u32 s69, s69, s55
    s_add_u32 s73, s73, s54
    s_waitcnt lgkmcnt(15)
    s_add_u32 m0, s52, 49152
    s_add_u32 s57, s65, 7
    s_sub_u32 s3, s57, 14
    s_min_u32 s57, s57, s3
    s_mul_i32 s57, s57, 114688
    buffer_load_dwordx4 v10, s[16:19], s57 offen offset:0 lds
    s_mov_b32 s76, 0
    s_add_u32 s77, s76, 2048
    s_cmp_eq_u32 s77, 14336
    s_cselect_b32 s77, 0, s77
    s_add_u32 s78, s77, 2048
    s_cmp_eq_u32 s78, 14336
    s_cselect_b32 s78, 0, s78
    s_add_u32 s79, s78, 2048
    s_cmp_eq_u32 s79, 14336
    s_cselect_b32 s79, 0, s79
    s_add_u32 s80, s79, 2048
    s_cmp_eq_u32 s80, 14336
    s_cselect_b32 s80, 0, s80
    s_add_u32 s81, s80, 2048
    s_cmp_eq_u32 s81, 14336
    s_cselect_b32 s81, 0, s81
    s_add_u32 s82, s81, 2048
    s_cmp_eq_u32 s82, 14336
    s_cselect_b32 s82, 0, s82
    s_add_u32 s57, s57, 27648
    buffer_load_dwordx4 v11, s[16:19], s57 offen offset:1024 lds
    s_waitcnt vmcnt(10)
    ds_read_b64_tr_b16 a[64:65], v4 offset:0
    ds_read_b64_tr_b16 a[66:67], v4 offset:512
    ds_read_b64_tr_b16 a[68:69], v5 offset:0
    ds_read_b64_tr_b16 a[70:71], v5 offset:512
    s_add_u32 s57, s57, 27648
    buffer_load_dwordx4 v10, s[16:19], s57 offen offset:2048 lds
    ds_read_b64_tr_b16 a[72:73], v4 offset:256
    ds_read_b64_tr_b16 a[74:75], v4 offset:768
    ds_read_b64_tr_b16 a[76:77], v5 offset:256
    ds_read_b64_tr_b16 a[78:79], v5 offset:768
    s_add_u32 s57, s57, 27648
    buffer_load_dwordx4 v11, s[16:19], s57 offen offset:3072 lds
    s_cmp_lt_u32 s89, 4
    s_cselect_b32 s75, s54, 2130706432
    s_cselect_b32 s68, s68, 2130706432
    s_cselect_b32 s73, s73, 2130706432
    v_lshlrev_b32 v16, 3, v1
    v_add_u32 v16, 81920, v16
    v_and_b32 v217, 7, v1
    v_min_u32 v218, 6, v217
    s_add_u32 m0, s52, 65536
    s_add_u32 s57, s65, 8
    s_sub_u32 s3, s57, 14
    s_min_u32 s57, s57, s3
    s_mul_i32 s57, s57, 114688
    buffer_load_dwordx4 v10, s[16:19], s57 offen offset:0 lds
    s_mul_i32 s54, s44, 7
    v_add_u32 v218, s54, v218
    v_mul_u32_u24 v219, 2, v218
    v_add_u32 v219, s89, v219
    s_add_u32 s57, s57, 27648
    buffer_load_dwordx4 v11, s[16:19], s57 offen offset:1024 lds
    s_waitcnt vmcnt(10)
    ds_read_b64_tr_b16 a[80:81], v4 offset:16384
    ds_read_b64_tr_b16 a[82:83], v4 offset:16896
    ds_read_b64_tr_b16 a[84:85], v5 offset:16384
    ds_read_b64_tr_b16 a[86:87], v5 offset:16896
    s_add_u32 s57, s57, 27648
    buffer_load_dwordx4 v10, s[16:19], s57 offen offset:2048 lds
    ds_read_b64_tr_b16 a[88:89], v4 offset:16640
    ds_read_b64_tr_b16 a[90:91], v4 offset:17152
    ds_read_b64_tr_b16 a[92:93], v5 offset:16640
    ds_read_b64_tr_b16 a[94:95], v5 offset:17152
    v_mul_u32_u24 v220, 43, v219
    v_lshrrev_b32 v220, 8, v220
    v_mul_u32_u24 v220, 6, v220
    v_sub_u32 v219, v219, v220
    s_add_u32 s57, s57, 27648
    buffer_load_dwordx4 v11, s[16:19], s57 offen offset:3072 lds
    v_subrev_u32 v219, s49, v219
    v_bfe_u32 v220, v1, 3, 1
    v_mul_i32_i24 v219, v219, v220
    v_add_u32 v219, s49, v219
    s_waitcnt lgkmcnt(15)
    s_add_u32 m0, s52, 81920
    s_add_u32 s57, s65, 9
    s_sub_u32 s3, s57, 14
    s_min_u32 s57, s57, s3
    s_mul_i32 s57, s57, 114688
    buffer_load_dwordx4 v10, s[16:19], s57 offen offset:0 lds
    v_lshl_add_u32 v218, v219, 5, v218
    v_lshlrev_b32 v20, 7, v218
    v_add_u32 v20, 12713984, v20
    s_lshr_b32 s53, s48, 1
    s_add_u32 s57, s57, 27648
    buffer_load_dwordx4 v11, s[16:19], s57 offen offset:1024 lds
    s_waitcnt vmcnt(10)
    ds_read_b64_tr_b16 a[96:97], v4 offset:32768
    ds_read_b64_tr_b16 a[98:99], v4 offset:33280
    ds_read_b64_tr_b16 a[100:101], v5 offset:32768
    ds_read_b64_tr_b16 a[102:103], v5 offset:33280
    s_lshl_b32 s53, s53, 7
    s_add_u32 s53, s53, 12779520
    v_lshl_add_u32 v21, v210, 11, s53
    s_lshl_b32 s70, s48, 16
    ds_read_b64_tr_b16 a[104:105], v4 offset:33024
    ds_read_b64_tr_b16 a[106:107], v4 offset:33536
    ds_read_b64_tr_b16 a[108:109], v5 offset:33024
    ds_read_b64_tr_b16 a[110:111], v5 offset:33536
    s_add_u32 s57, s57, 27648
    buffer_load_dwordx4 v10, s[16:19], s57 offen offset:2048 lds
    s_lshl2_add_u32 s70, s52, s70
    s_add_u32 s70, s70, 4194304
    v_lshrrev_b32 v218, 3, v1
    v_mul_u32_u24 v22, 896, v218
    s_add_u32 s57, s57, 27648
    buffer_load_dwordx4 v11, s[16:19], s57 offen offset:3072 lds
    v_lshl_add_u32 v22, v217, 4, v22
    v_lshlrev_b32 v25, 1, v211
    s_add_u32 s53, s52, 65536
    v_mul_u32_u24 v244, 176, v218
    buffer_load_dwordx2 v[224:225], v19, s[32:35], 0 offen offset:0
    v_lshl_add_u32 v244, v217, 4, v244
    v_add_u32 v244, s53, v244
    v_mul_u32_u24 v238, 176, v211
    v_lshl_add_u32 v238, v208, 3, v238
    buffer_load_dwordx2 v[226:227], v19, s[32:35], 0 offen offset:32
    s_waitcnt vmcnt(10)
    ds_read_b64_tr_b16 a[112:113], v2 offset:0
    ds_read_b64_tr_b16 a[114:115], v2 offset:512
    ds_read_b64_tr_b16 a[116:117], v3 offset:0
    ds_read_b64_tr_b16 a[118:119], v3 offset:512
    buffer_load_dwordx2 v[228:229], v19, s[32:35], 0 offen offset:64
    ds_read_b64_tr_b16 a[120:121], v2 offset:256
    ds_read_b64_tr_b16 a[122:123], v2 offset:768
    ds_read_b64_tr_b16 a[124:125], v3 offset:256
    ds_read_b64_tr_b16 a[126:127], v3 offset:768
    buffer_load_dwordx2 v[230:231], v19, s[32:35], 0 offen offset:96
    v_add_u32 v238, s53, v238
    v_lshrrev_b32 v218, 2, v0
    v_mul_u32_u24 v26, 896, v218
    v_lshl_add_u32 v26, v210, 3, v26
    s_add_u32 m0, s52, 98304
    s_add_u32 s57, s65, 10
    s_sub_u32 s3, s57, 14
    s_min_u32 s57, s57, s3
    s_mul_i32 s57, s57, 114688
    buffer_load_dwordx4 v10, s[16:19], s57 offen offset:0 lds
    v_lshrrev_b32 v218, 2, v1
    v_mul_u32_u24 v252, 176, v218
    v_lshl_add_u32 v252, v210, 3, v252
    v_add_u32 v252, s53, v252
    s_sub_u32 s53, 49152, s52
    v_add_u32 v246, s53, v2
    v_add_u32 v247, s53, v3
    v_mul_u32_u24 v218, 3072, v208
    s_add_u32 s57, s57, 27648
    buffer_load_dwordx4 v11, s[16:19], s57 offen offset:1024 lds
    s_waitcnt vmcnt(10)
    ds_read_b64_tr_b16 a[128:129], v2 offset:16384
    ds_read_b64_tr_b16 a[130:131], v2 offset:16896
    ds_read_b64_tr_b16 a[132:133], v3 offset:16384
    ds_read_b64_tr_b16 a[134:135], v3 offset:16896
    s_add_u32 s57, s57, 27648
    buffer_load_dwordx4 v10, s[16:19], s57 offen offset:2048 lds
    ds_read_b64_tr_b16 a[136:137], v2 offset:16640
    ds_read_b64_tr_b16 a[138:139], v2 offset:17152
    ds_read_b64_tr_b16 a[140:141], v3 offset:16640
    ds_read_b64_tr_b16 a[142:143], v3 offset:17152
    s_add_u32 s57, s57, 27648
    buffer_load_dwordx4 v11, s[16:19], s57 offen offset:3072 lds
    v_add_u32 v248, v218, v246
    v_add_u32 v249, v218, v247
    v_add_u32 v232, s52, v23
    v_xor_b32 v233, 4096, v232
    v_xor_b32 v234, 8192, v232
    v_xor_b32 v235, 12288, v232
    s_waitcnt lgkmcnt(15)
    s_add_u32 m0, s52, 114688
    s_add_u32 s57, s65, 11
    s_sub_u32 s3, s57, 14
    s_min_u32 s57, s57, s3
    s_mul_i32 s57, s57, 114688
    buffer_load_dwordx4 v10, s[16:19], s57 offen offset:0 lds
    s_add_u32 s57, s57, 27648
    buffer_load_dwordx4 v11, s[16:19], s57 offen offset:1024 lds
    s_waitcnt vmcnt(10)
    ds_read_b64_tr_b16 a[144:145], v2 offset:32768
    ds_read_b64_tr_b16 a[146:147], v2 offset:33280
    ds_read_b64_tr_b16 a[148:149], v3 offset:32768
    ds_read_b64_tr_b16 a[150:151], v3 offset:33280
    s_add_u32 s57, s57, 27648
    buffer_load_dwordx4 v10, s[16:19], s57 offen offset:2048 lds
    ds_read_b64_tr_b16 a[152:153], v2 offset:33024
    ds_read_b64_tr_b16 a[154:155], v2 offset:33536
    ds_read_b64_tr_b16 a[156:157], v3 offset:33024
    ds_read_b64_tr_b16 a[158:159], v3 offset:33536
    s_add_u32 s57, s57, 27648
    buffer_load_dwordx4 v11, s[16:19], s57 offen offset:3072 lds
    s_add_u32 m0, s52, 131072
    s_add_u32 s57, s65, 12
    s_sub_u32 s3, s57, 14
    s_min_u32 s57, s57, s3
    s_mul_i32 s57, s57, 114688
    buffer_load_dwordx4 v10, s[16:19], s57 offen offset:0 lds
    s_add_u32 s57, s57, 27648
    buffer_load_dwordx4 v11, s[16:19], s57 offen offset:1024 lds
    s_add_u32 s57, s57, 27648
    buffer_load_dwordx4 v10, s[16:19], s57 offen offset:2048 lds
    s_waitcnt vmcnt(11)
    v_lshlrev_b32 v32, 16, v224
    v_and_b32 v33, s61, v224
    v_lshlrev_b32 v34, 16, v225
    v_and_b32 v35, s61, v225
    v_lshlrev_b32 v36, 16, v226
    v_and_b32 v37, s61, v226
    v_lshlrev_b32 v38, 16, v227
    v_and_b32 v39, s61, v227
    s_add_u32 s57, s57, 27648
    buffer_load_dwordx4 v11, s[16:19], s57 offen offset:3072 lds
    v_lshlrev_b32 v40, 16, v228
    v_and_b32 v41, s61, v228
    v_lshlrev_b32 v42, 16, v229
    v_and_b32 v43, s61, v229
    buffer_load_dword v17, v18, s[24:27], 0 offen sc1
    v_lshlrev_b32 v44, 16, v230
    v_and_b32 v45, s61, v230
    v_lshlrev_b32 v46, 16, v231
    v_and_b32 v47, s61, v231
    v_mul_f32 v96, s85, v32
    v_mul_f32 v97, s85, v33
    v_mul_f32 v98, s85, v34
    v_mul_f32 v99, s85, v35
    s_add_u32 m0, s52, 147456
    s_add_u32 s57, s65, 13
    s_sub_u32 s3, s57, 14
    s_min_u32 s57, s57, s3
    s_mul_i32 s57, s57, 114688
    buffer_load_dwordx4 v10, s[16:19], s57 offen offset:0 lds
    s_waitcnt vmcnt(10)
    ds_read_b64_tr_b16 a[160:161], v2 offset:49152
    ds_read_b64_tr_b16 a[162:163], v2 offset:49664
    ds_read_b64_tr_b16 a[164:165], v3 offset:49152
    ds_read_b64_tr_b16 a[166:167], v3 offset:49664
    v_mul_f32 v100, s85, v36
    v_mul_f32 v101, s85, v37
    v_mul_f32 v102, s85, v38
    v_mul_f32 v103, s85, v39
    ds_read_b64_tr_b16 a[168:169], v2 offset:49408
    ds_read_b64_tr_b16 a[170:171], v2 offset:49920
    ds_read_b64_tr_b16 a[172:173], v3 offset:49408
    ds_read_b64_tr_b16 a[174:175], v3 offset:49920
    s_add_u32 s57, s57, 27648
    buffer_load_dwordx4 v11, s[16:19], s57 offen offset:1024 lds
    v_mul_f32 v104, s85, v40
    v_mul_f32 v105, s85, v41
    v_mul_f32 v106, s85, v42
    v_mul_f32 v107, s85, v43
    s_add_u32 s57, s57, 27648
    buffer_load_dwordx4 v10, s[16:19], s57 offen offset:2048 lds
    v_mul_f32 v108, s85, v44
    v_mul_f32 v109, s85, v45
    v_mul_f32 v110, s85, v46
    v_mul_f32 v111, s85, v47
    s_add_u32 s57, s57, 27648
    buffer_load_dwordx4 v11, s[16:19], s57 offen offset:3072 lds
    s_waitcnt lgkmcnt(15)
    s_add_u32 m0, s52, 49152
    s_mov_b32 s57, 1605632
    buffer_load_dwordx4 v10, s[16:19], s57 offen offset:0 lds
    s_waitcnt vmcnt(10)
    ds_read_b64_tr_b16 a[176:177], v4 offset:0
    ds_read_b64_tr_b16 a[178:179], v4 offset:512
    ds_read_b64_tr_b16 a[180:181], v5 offset:0
    ds_read_b64_tr_b16 a[182:183], v5 offset:512
    s_add_u32 s57, s57, 27648
    buffer_load_dwordx4 v11, s[16:19], s57 offen offset:1024 lds
    ds_read_b64_tr_b16 a[184:185], v4 offset:256
    ds_read_b64_tr_b16 a[186:187], v4 offset:768
    ds_read_b64_tr_b16 a[188:189], v5 offset:256
    ds_read_b64_tr_b16 a[190:191], v5 offset:768
    s_add_u32 s57, s57, 27648
    buffer_load_dwordx4 v10, s[16:19], s57 offen offset:2048 lds
    s_add_u32 s57, s57, 27648
    buffer_load_dwordx4 v11, s[16:19], s57 offen offset:3072 lds
    s_add_u32 m0, s52, 65536
    s_mov_b32 s57, 1720320
    buffer_load_dwordx4 v10, s[16:19], s57 offen offset:0 lds
    s_waitcnt vmcnt(10)
    ds_read_b64_tr_b16 a[192:193], v4 offset:16384
    ds_read_b64_tr_b16 a[194:195], v4 offset:16896
    ds_read_b64_tr_b16 a[196:197], v5 offset:16384
    ds_read_b64_tr_b16 a[198:199], v5 offset:16896
    s_add_u32 s57, s57, 27648
    buffer_load_dwordx4 v11, s[16:19], s57 offen offset:1024 lds
    ds_read_b64_tr_b16 a[200:201], v4 offset:16640
    ds_read_b64_tr_b16 a[202:203], v4 offset:17152
    ds_read_b64_tr_b16 a[204:205], v5 offset:16640
    ds_read_b64_tr_b16 a[206:207], v5 offset:17152
    s_add_u32 s57, s57, 27648
    buffer_load_dwordx4 v10, s[16:19], s57 offen offset:2048 lds
    s_waitcnt vmcnt(11)
    v_cmp_ne_u32 vcc, s47, v17
    s_nop 0
    s_cbranch_vccz L_ok5
    s_mov_b32 s59, 100000
L_spin4:
    buffer_load_dword v17, v18, s[24:27], 0 offen sc1
    s_waitcnt vmcnt(0)
    v_cmp_ne_u32 vcc, s47, v17
    s_nop 0
    s_cbranch_vccz L_ok5
    s_sub_u32 s59, s59, 1
    s_cbranch_scc0 L_spin4
L_ok5:
    s_cmp_ge_u32 s88, 4
    s_cbranch_scc1 L_p2_alt
    s_add_u32 s57, s57, 27648
    buffer_load_dwordx4 v11, s[16:19], s57 offen offset:3072 lds
    s_mov_b32 s66, s84
    s_lshl_b32 s86, s65, 10
    s_add_u32 s58, s86, s66
    s_add_u32 s86, s66, 14336
    buffer_load_dwordx4 v[112:115], v23, s[24:27], s58 offen offset:0 sc1
    s_add_u32 s58, s58, 1024
    s_cmp_eq_u32 s58, s86
    s_cselect_b32 s58, s66, s58
    buffer_load_dwordx4 v[116:119], v23, s[24:27], s58 offen offset:0 sc1
    s_waitcnt vmcnt(10)
    ds_read_b64_tr_b16 a[208:209], v4 offset:32768
    ds_read_b64_tr_b16 a[210:211], v4 offset:33280
    ds_read_b64_tr_b16 a[212:213], v5 offset:32768
    ds_read_b64_tr_b16 a[214:215], v5 offset:33280
    s_add_u32 s58, s58, 1024
    s_cmp_eq_u32 s58, s86
    s_cselect_b32 s58, s66, s58
    buffer_load_dwordx4 v[120:123], v23, s[24:27], s58 offen offset:0 sc1
    ds_read_b64_tr_b16 a[216:217], v4 offset:33024
    ds_read_b64_tr_b16 a[218:219], v4 offset:33536
    ds_read_b64_tr_b16 a[220:221], v5 offset:33024
    ds_read_b64_tr_b16 a[222:223], v5 offset:33536
    s_add_u32 s58, s58, 1024
    s_cmp_eq_u32 s58, s86
    s_cselect_b32 s58, s66, s58
    buffer_load_dwordx4 v[124:127], v23, s[24:27], s58 offen offset:0 sc1
    s_add_u32 s58, s58, 1024
    s_cmp_eq_u32 s58, s86
    s_cselect_b32 s58, s66, s58
    buffer_load_dwordx4 v[128:131], v23, s[24:27], s58 offen offset:0 sc1
    s_add_u32 s58, s58, 1024
    s_cmp_eq_u32 s58, s86
    s_cselect_b32 s58, s66, s58
    buffer_load_dwordx4 v[132:135], v23, s[24:27], s58 offen offset:0 sc1
    s_waitcnt vmcnt(10)
    ds_read_b64_tr_b16 a[224:225], v2 offset:0
    ds_read_b64_tr_b16 a[226:227], v2 offset:512
    ds_read_b64_tr_b16 a[228:229], v3 offset:0
    ds_read_b64_tr_b16 a[230:231], v3 offset:512
    s_add_u32 s58, s58, 1024
    s_cmp_eq_u32 s58, s86
    s_cselect_b32 s58, s66, s58
    buffer_load_dwordx4 v[136:139], v23, s[24:27], s58 offen offset:0 sc1
    ds_read_b64_tr_b16 a[232:233], v2 offset:256
    ds_read_b64_tr_b16 a[234:235], v2 offset:768
    ds_read_b64_tr_b16 a[236:237], v3 offset:256
    ds_read_b64_tr_b16 a[238:239], v3 offset:768
    s_add_u32 s58, s58, 1024
    s_cmp_eq_u32 s58, s86
    s_cselect_b32 s58, s66, s58
    buffer_load_dwordx4 v[140:143], v23, s[24:27], s58 offen offset:0 sc1
    s_add_u32 s58, s58, 1024
    s_cmp_eq_u32 s58, s86
    s_cselect_b32 s58, s66, s58
    buffer_load_dwordx4 v[144:147], v23, s[24:27], s58 offen offset:0 sc1
    s_add_u32 s58, s58, 1024
    s_cmp_eq_u32 s58, s86
    s_cselect_b32 s58, s66, s58
    buffer_load_dwordx4 v[148:151], v23, s[24:27], s58 offen offset:0 sc1
    s_waitcnt vmcnt(10)
    ds_read_b64_tr_b16 a[240:241], v2 offset:16384
    ds_read_b64_tr_b16 a[242:243], v2 offset:16896
    ds_read_b64_tr_b16 a[244:245], v3 offset:16384
    ds_read_b64_tr_b16 a[246:247], v3 offset:16896
    s_add_u32 s58, s58, 1024
    s_cmp_eq_u32 s58, s86
    s_cselect_b32 s58, s66, s58
    buffer_load_dwordx4 v[152:155], v23, s[24:27], s58 offen offset:0 sc1
    ds_read_b64_tr_b16 a[248:249], v2 offset:16640
    ds_read_b64_tr_b16 a[250:251], v2 offset:17152
    ds_read_b64_tr_b16 a[252:253], v3 offset:16640
    ds_read_b64_tr_b16 a[254:255], v3 offset:17152
    s_waitcnt vmcnt(10)
    v_mfma_f32_16x16x32_bf16 v[96:99], a[0:3], v[112:115], v[96:99]
    s_add_u32 s58, s58, 1024
    s_cmp_eq_u32 s58, s86
    s_cselect_b32 s58, s66, s58
    v_mfma_f32_16x16x32_bf16 v[100:103], a[4:7], v[112:115], v[100:103]
    buffer_load_dwordx4 v[156:159], v23, s[24:27], s58 offen offset:0 sc1
    v_mfma_f32_16x16x32_bf16 v[104:107], a[8:11], v[112:115], v[104:107]
    v_mfma_f32_16x16x32_bf16 v[108:111], a[12:15], v[112:115], v[108:111]
    s_waitcnt vmcnt(10)
    v_mfma_f32_16x16x32_bf16 v[96:99], a[16:19], v[116:119], v[96:99]
    s_add_u32 s58, s58, 1024
    s_cmp_eq_u32 s58, s86
    s_cselect_b32 s58, s66, s58
    v_mfma_f32_16x16x32_bf16 v[100:103], a[20:23], v[116:119], v[100:103]
    buffer_load_dwordx4 v[112:115], v23, s[24:27], s58 offen offset:0 sc1
    v_mfma_f32_16x16x32_bf16 v[104:107], a[24:27], v[116:119], v[104:107]
    v_mfma_f32_16x16x32_bf16 v[108:111], a[28:31], v[116:119], v[108:111]
    s_waitcnt vmcnt(10)
    v_mfma_f32_16x16x32_bf16 v[96:99], a[32:35], v[120:123], v[96:99]
    s_add_u32 s58, s58, 1024
    s_cmp_eq_u32 s58, s86
    s_cselect_b32 s58, s66, s58
    v_mfma_f32_16x16x32_bf16 v[100:103], a[36:39], v[120:123], v[100:103]
L_wb_0:
    s_cbranch_execz L_wb_ret
    buffer_load_dwordx4 v[116:119], v23, s[24:27], s58 offen offset:0 sc1
    v_mfma_f32_16x16x32_bf16 v[104:107], a[40:43], v[120:123], v[104:107]
    v_mfma_f32_16x16x32_bf16 v[108:111], a[44:47], v[120:123], v[108:111]
    s_waitcnt vmcnt(10)
    v_mfma_f32_16x16x32_bf16 v[96:99], a[48:51], v[124:127], v[96:99]
    s_add_u32 s58, s66, 14336
    v_mfma_f32_16x16x32_bf16 v[100:103], a[52:55], v[124:127], v[100:103]
    buffer_load_dwordx4 v[120:123], v23, s[24:27], s58 offen offset:0 sc1
    v_mfma_f32_16x16x32_bf16 v[104:107], a[56:59], v[124:127], v[104:107]
    v_mfma_f32_16x16x32_bf16 v[108:111], a[60:63], v[124:127], v[108:111]
    s_waitcnt vmcnt(10)
    v_mfma_f32_16x16x32_bf16 v[96:99], a[64:67], v[128:131], v[96:99]
    s_add_u32 s58, s66, 15360
    v_mfma_f32_16x16x32_bf16 v[100:103], a[68:71], v[128:131], v[100:103]
    buffer_load_dwordx4 v[124:127], v23, s[24:27], s58 offen offset:0 sc1
    v_mfma_f32_16x16x32_bf16 v[104:107], a[72:75], v[128:131], v[104:107]
    v_mfma_f32_16x16x32_bf16 v[108:111], a[76:79], v[128:131], v[108:111]
    s_waitcnt vmcnt(10)
    v_mfma_f32_16x16x32_bf16 v[96:99], a[80:83], v[132:135], v[96:99]
    s_xor_b32 s66, s44, 3
    s_lshl2_add_u32 s66, s51, s66
    s_mul_i32 s66, s66, 66816
    s_lshl2_add_u32 s66, s52, s66
    s_lshl_b32 s86, s65, 10
    s_add_u32 s58, s86, s66
    s_add_u32 s86, s66, 14336
    v_mfma_f32_16x16x32_bf16 v[100:103], a[84:87], v[132:135], v[100:103]
    buffer_load_dwordx4 v[128:131], v23, s[24:27], s58 offen offset:0 sc1
    v_mfma_f32_16x16x32_bf16 v[104:107], a[88:91], v[132:135], v[104:107]
    v_mfma_f32_16x16x32_bf16 v[108:111], a[92:95], v[132:135], v[108:111]
    s_waitcnt vmcnt(10)
    v_mfma_f32_16x16x32_bf16 v[96:99], a[96:99], v[136:139], v[96:99]
    s_add_u32 s58, s58, 1024
    s_cmp_eq_u32 s58, s86
    s_cselect_b32 s58, s66, s58
    v_mfma_f32_16x16x32_bf16 v[100:103], a[100:103], v[136:139], v[100:103]
    buffer_load_dwordx4 v[132:135], v23, s[24:27], s58 offen offset:0 sc1
    v_mfma_f32_16x16x32_bf16 v[104:107], a[104:107], v[136:139], v[104:107]
    v_mfma_f32_16x16x32_bf16 v[108:111], a[108:111], v[136:139], v[108:111]
    s_waitcnt vmcnt(10)
    v_mfma_f32_16x16x32_bf16 v[96:99], a[112:115], v[140:143], v[96:99]
    s_add_u32 s58, s58, 1024
    s_cmp_eq_u32 s58, s86
    s_cselect_b32 s58, s66, s58
    v_mfma_f32_16x16x32_bf16 v[100:103], a[116:119], v[140:143], v[100:103]
    buffer_load_dwordx4 v[136:139], v23, s[24:27], s58 offen offset:0 sc1
    v_mfma_f32_16x16x32_bf16 v[104:107], a[120:123], v[140:143], v[104:107]
    v_mfma_f32_16x16x32_bf16 v[108:111], a[124:127], v[140:143], v[108:111]
    s_waitcnt vmcnt(10)
    v_mfma_f32_16x16x32_bf16 v[96:99], a[128:131], v[144:147], v[96:99]
    s_add_u32 s58, s58, 1024
    s_cmp_eq_u32 s58, s86
    s_cselect_b32 s58, s66, s58
    v_mfma_f32_16x16x32_bf16 v[100:103], a[132:135], v[144:147], v[100:103]
    buffer_load_dwordx4 v[140:143], v23, s[24:27], s58 offen offset:0 sc1
    v_mfma_f32_16x16x32_bf16 v[104:107], a[136:139], v[144:147], v[104:107]
    v_mfma_f32_16x16x32_bf16 v[108:111], a[140:143], v[144:147], v[108:111]
    s_waitcnt vmcnt(10)
    s_waitcnt lgkmcnt(15)
    v_mfma_f32_16x16x32_bf16 v[96:99], a[144:147], v[148:151], v[96:99]
    s_add_u32 s58, s58, 1024
    s_cmp_eq_u32 s58, s86
    s_cselect_b32 s58, s66, s58
    v_mfma_f32_16x16x32_bf16 v[100:103], a[148:151], v[148:151], v[100:103]
    buffer_load_dwordx4 v[144:147], v23, s[24:27], s58 offen offset:0 sc1
    v_mfma_f32_16x16x32_bf16 v[104:107], a[152:155], v[148:151], v[104:107]
    v_mfma_f32_16x16x32_bf16 v[108:111], a[156:159], v[148:151], v[108:111]
    s_waitcnt vmcnt(10)
    v_mfma_f32_16x16x32_bf16 v[96:99], a[160:163], v[152:155], v[96:99]
    s_add_u32 s58, s58, 1024
    s_cmp_eq_u32 s58, s86
    s_cselect_b32 s58, s66, s58
    v_mfma_f32_16x16x32_bf16 v[100:103], a[164:167], v[152:155], v[100:103]
    buffer_load_dwordx4 v[148:151], v23, s[24:27], s58 offen offset:0 sc1
    v_mfma_f32_16x16x32_bf16 v[104:107], a[168:171], v[152:155], v[104:107]
    v_mfma_f32_16x16x32_bf16 v[108:111], a[172:175], v[152:155], v[108:111]
    s_waitcnt vmcnt(10)
    v_mfma_f32_16x16x32_bf16 v[96:99], a[176:179], v[156:159], v[96:99]
    s_add_u32 s58, s58, 1024
    s_cmp_eq_u32 s58, s86
    s_cselect_b32 s58, s66, s58
    v_mfma_f32_16x16x32_bf16 v[100:103], a[180:183], v[156:159], v[100:103]
    buffer_load_dwordx4 v[152:155], v23, s[24:27], s58 offen offset:0 sc1
    v_mfma_f32_16x16x32_bf16 v[104:107], a[184:187], v[156:159], v[104:107]
    v_mfma_f32_16x16x32_bf16 v[108:111], a[188:191], v[156:159], v[108:111]
    s_waitcnt vmcnt(10)
    v_mfma_f32_16x16x32_bf16 v[96:99], a[192:195], v[112:115], v[96:99]
    s_add_u32 s58, s58, 1024
    s_cmp_eq_u32 s58, s86
    s_cselect_b32 s58, s66, s58
    v_mfma_f32_16x16x32_bf16 v[100:103], a[196:199], v[112:115], v[100:103]
    buffer_load_dwordx4 v[156:159], v23, s[24:27], s58 offen offset:0 sc1
    v_mfma_f32_16x16x32_bf16 v[104:107], a[200:203], v[112:115], v[104:107]
    v_mfma_f32_16x16x32_bf16 v[108:111], a[204:207], v[112:115], v[108:111]
    s_waitcnt vmcnt(10)
    v_mfma_f32_16x16x32_bf16 v[96:99], a[208:211], v[116:119], v[96:99]
    s_add_u32 s58, s58, 1024
    s_cmp_eq_u32 s58, s86
    s_cselect_b32 s58, s66, s58
    v_mfma_f32_16x16x32_bf16 v[100:103], a[212:215], v[116:119], v[100:103]
    buffer_load_dwordx4 v[112:115], v23, s[24:27], s58 offen offset:0 sc1
    v_mfma_f32_16x16x32_bf16 v[104:107], a[216:219], v[116:119], v[104:107]
    v_mfma_f32_16x16x32_bf16 v[108:111], a[220:223], v[116:119], v[108:111]
    s_waitcnt vmcnt(10)
    s_waitcnt lgkmcnt(8)
    v_mfma_f32_16x16x32_bf16 v[96:99], a[224:227], v[120:123], v[96:99]
    s_add_u32 s58, s58, 1024
    s_cmp_eq_u32 s58, s86
    s_cselect_b32 s58, s66, s58
    v_mfma_f32_16x16x32_bf16 v[100:103], a[228:231], v[120:123], v[100:103]
    buffer_load_dwordx4 v[116:119], v23, s[24:27], s58 offen offset:0 sc1
    v_mfma_f32_16x16x32_bf16 v[104:107], a[232:235], v[120:123], v[104:107]
    v_mfma_f32_16x16x32_bf16 v[108:111], a[236:239], v[120:123], v[108:111]
    s_waitcnt vmcnt(10)
    s_waitcnt lgkmcnt(0)
    v_mfma_f32_16x16x32_bf16 v[96:99], a[240:243], v[124:127], v[96:99]
    s_add_u32 s58, s58, 1024
    s_cmp_eq_u32 s58, s86
    s_cselect_b32 s58, s66, s58
    v_mfma_f32_16x16x32_bf16 v[100:103], a[244:247], v[124:127], v[100:103]
    buffer_load_dwordx4 v[120:123], v23, s[24:27], s58 offen offset:0 sc1
    v_mfma_f32_16x16x32_bf16 v[104:107], a[248:251], v[124:127], v[104:107]
    v_mfma_f32_16x16x32_bf16 v[108:111], a[252:255], v[124:127], v[108:111]
L_p2_join:
    s_waitcnt vmcnt(10)
    v_mfma_f32_16x16x32_bf16 v[80:83], a[0:3], v[128:131], 0
    s_add_u32 s58, s58, 1024
    s_cmp_eq_u32 s58, s86
    s_cselect_b32 s58, s66, s58
    v_mfma_f32_16x16x32_bf16 v[84:87], a[4:7], v[128:131], 0
    buffer_load_dwordx4 v[124:127], v23, s[24:27], s58 offen offset:0 sc1
    v_mfma_f32_16x16x32_bf16 v[88:91], a[8:11], v[128:131], 0
    v_mfma_f32_16x16x32_bf16 v[92:95], a[12:15], v[128:131], 0
    s_waitcnt vmcnt(10)
    v_mfma_f32_16x16x32_bf16 v[80:83], a[16:19], v[132:135], v[80:83]
    v_mfma_f32_16x16x32_bf16 v[84:87], a[20:23], v[132:135], v[84:87]
    buffer_load_dwordx4 v[216:219], v22, s[4:7], s71 offen
    v_mfma_f32_16x16x32_bf16 v[88:91], a[24:27], v[132:135], v[88:91]
    ds_write_b128 v232, v[96:99] offset:49152
    v_mfma_f32_16x16x32_bf16 v[92:95], a[28:31], v[132:135], v[92:95]
    s_waitcnt vmcnt(10)
    v_mfma_f32_16x16x32_bf16 v[80:83], a[32:35], v[136:139], v[80:83]
    s_add_u32 s58, s58, 1024
    s_cmp_eq_u32 s58, s86
    s_cselect_b32 s58, s66, s58
    v_mfma_f32_16x16x32_bf16 v[84:87], a[36:39], v[136:139], v[84:87]
    buffer_load_dwordx4 v[128:131], v23, s[24:27], s58 offen offset:0 sc1
    v_mfma_f32_16x16x32_bf16 v[88:91], a[40:43], v[136:139], v[88:91]
    ds_write_b128 v232, v[100:103] offset:50176
    v_mfma_f32_16x16x32_bf16 v[92:95], a[44:47], v[136:139], v[92:95]
    s_waitcnt vmcnt(10)
    v_mfma_f32_16x16x32_bf16 v[80:83], a[48:51], v[140:143], v[80:83]
    v_mfma_f32_16x16x32_bf16 v[84:87], a[52:55], v[140:143], v[84:87]
    buffer_load_dwordx4 v[220:223], v22, s[4:7], s72 offen
    v_mfma_f32_16x16x32_bf16 v[88:91], a[56:59], v[140:143], v[88:91]
    ds_write_b128 v232, v[104:107] offset:51200
    v_mfma_f32_16x16x32_bf16 v[92:95], a[60:63], v[140:143], v[92:95]
    s_waitcnt vmcnt(10)
    v_mfma_f32_16x16x32_bf16 v[80:83], a[64:67], v[144:147], v[80:83]
    s_add_u32 s58, s58, 1024
    s_cmp_eq_u32 s58, s86
    s_cselect_b32 s58, s66, s58
    v_mfma_f32_16x16x32_bf16 v[84:87], a[68:71], v[144:147], v[84:87]
    buffer_load_dwordx4 v[132:135], v23, s[24:27], s58 offen offset:0 sc1
    v_mfma_f32_16x16x32_bf16 v[88:91], a[72:75], v[144:147], v[88:91]
    ds_write_b128 v232, v[108:111] offset:52224
    v_mfma_f32_16x16x32_bf16 v[92:95], a[76:79], v[144:147], v[92:95]
    s_waitcnt vmcnt(10)
    v_mfma_f32_16x16x32_bf16 v[80:83], a[80:83], v[148:151], v[80:83]
    v_mfma_f32_16x16x32_bf16 v[84:87], a[84:87], v[148:151], v[84:87]
    buffer_load_dwordx2 v[224:225], v26, s[4:7], s73 offen
    v_mfma_f32_16x16x32_bf16 v[88:91], a[88:91], v[148:151], v[88:91]
    v_mfma_f32_16x16x32_bf16 v[92:95], a[92:95], v[148:151], v[92:95]
    s_waitcnt vmcnt(10)
    v_mfma_f32_16x16x32_bf16 v[80:83], a[96:99], v[152:155], v[80:83]
    s_add_u32 s58, s66, 14336
    v_mfma_f32_16x16x32_bf16 v[84:87], a[100:103], v[152:155], v[84:87]
    buffer_load_dwordx4 v[136:139], v23, s[24:27], s58 offen offset:0 sc1
    v_mfma_f32_16x16x32_bf16 v[88:91], a[104:107], v[152:155], v[88:91]
    v_mfma_f32_16x16x32_bf16 v[92:95], a[108:111], v[152:155], v[92:95]
    s_waitcnt vmcnt(10)
    v_mfma_f32_16x16x32_bf16 v[80:83], a[112:115], v[156:159], v[80:83]
    v_mfma_f32_16x16x32_bf16 v[84:87], a[116:119], v[156:159], v[84:87]
    buffer_load_ushort v228, v25, s[36:39], s74 offen
    v_mfma_f32_16x16x32_bf16 v[88:91], a[120:123], v[156:159], v[88:91]
    s_waitcnt lgkmcnt(0)
    s_barrier
    v_mfma_f32_16x16x32_bf16 v[92:95], a[124:127], v[156:159], v[92:95]
    s_waitcnt vmcnt(10)
    v_mfma_f32_16x16x32_bf16 v[80:83], a[128:131], v[112:115], v[80:83]
    s_add_u32 s58, s66, 15360
    v_mfma_f32_16x16x32_bf16 v[84:87], a[132:135], v[112:115], v[84:87]
    buffer_load_dwordx4 v[140:143], v23, s[24:27], s58 offen offset:0 sc1
    v_mfma_f32_16x16x32_bf16 v[88:91], a[136:139], v[112:115], v[88:91]
    ds_read_b128 v[160:163], v243 offset:0
    ds_read_b128 v[164:167], v243 offset:1024
    v_mfma_f32_16x16x32_bf16 v[92:95], a[140:143], v[112:115], v[92:95]
    ds_read_b128 v[168:171], v243 offset:4096
    s_waitcnt vmcnt(10)
    v_mfma_f32_16x16x32_bf16 v[80:83], a[144:147], v[116:119], v[80:83]
    s_xor_b32 s66, s44, 2
    s_lshl2_add_u32 s66, s51, s66
    s_mul_i32 s66, s66, 66816
    s_lshl2_add_u32 s66, s52, s66
    s_lshl_b32 s86, s65, 10
    s_add_u32 s58, s86, s66
    s_add_u32 s86, s66, 14336
    v_mfma_f32_16x16x32_bf16 v[84:87], a[148:151], v[116:119], v[84:87]
    buffer_load_dwordx4 v[144:147], v23, s[24:27], s58 offen offset:0 sc1
    v_mfma_f32_16x16x32_bf16 v[88:91], a[152:155], v[116:119], v[88:91]
    ds_read_b128 v[172:175], v243 offset:5120
    ds_read_b128 v[176:179], v243 offset:8192
    v_mfma_f32_16x16x32_bf16 v[92:95], a[156:159], v[116:119], v[92:95]
    ds_read_b128 v[180:183], v243 offset:9216
    s_waitcnt vmcnt(10)
    v_mfma_f32_16x16x32_bf16 v[80:83], a[160:163], v[120:123], v[80:83]
    s_add_u32 s58, s58, 1024
    s_cmp_eq_u32 s58, s86
    s_cselect_b32 s58, s66, s58
    v_mfma_f32_16x16x32_bf16 v[84:87], a[164:167], v[120:123], v[84:87]
    buffer_load_dwordx4 v[148:151], v23, s[24:27], s58 offen offset:0 sc1
    v_mfma_f32_16x16x32_bf16 v[88:91], a[168:171], v[120:123], v[88:91]
    ds_read_b128 v[184:187], v243 offset:12288
    v_mfma_f32_16x16x32_bf16 v[92:95], a[172:175], v[120:123], v[92:95]
    ds_read_b128 v[188:191], v243 offset:13312
    s_waitcnt vmcnt(10)
    v_mfma_f32_16x16x32_bf16 v[80:83], a[176:179], v[124:127], v[80:83]
    s_add_u32 s58, s58, 1024
    s_cmp_eq_u32 s58, s86
    s_cselect_b32 s58, s66, s58
    v_mfma_f32_16x16x32_bf16 v[84:87], a[180:183], v[124:127], v[84:87]
    buffer_load_dwordx4 v[152:155], v23, s[24:27], s58 offen offset:0 sc1
    v_mfma_f32_16x16x32_bf16 v[88:91], a[184:187], v[124:127], v[88:91]
    v_mfma_f32_16x16x32_bf16 v[92:95], a[188:191], v[124:127], v[92:95]
    s_add_u32 s58, s58, 1024
    s_cmp_eq_u32 s58, s86
    s_cselect_b32 s58, s66, s58
    buffer_load_dwordx4 v[156:159], v23, s[24:27], s58 offen offset:0 sc1
    s_waitcnt vmcnt(10)
    v_mfma_f32_16x16x32_bf16 v[80:83], a[192:195], v[128:131], v[80:83]
    s_add_u32 s58, s58, 1024
    s_cmp_eq_u32 s58, s86
    s_cselect_b32 s58, s66, s58
    v_mfma_f32_16x16x32_bf16 v[84:87], a[196:199], v[128:131], v[84:87]
    buffer_load_dwordx4 v[112:115], v23, s[24:27], s58 offen offset:0 sc1
    v_mfma_f32_16x16x32_bf16 v[88:91], a[200:203], v[128:131], v[88:91]
    s_waitcnt lgkmcnt(0)
    v_add_f32 v160, v160, v168
    v_mfma_f32_16x16x32_bf16 v[92:95], a[204:207], v[128:131], v[92:95]
    v_add_f32 v161, v161, v169
    s_add_u32 s58, s58, 1024
    s_cmp_eq_u32 s58, s86
    s_cselect_b32 s58, s66, s58
    buffer_load_dwordx4 v[116:119], v23, s[24:27], s58 offen offset:0 sc1
    s_waitcnt vmcnt(10)
    v_mfma_f32_16x16x32_bf16 v[80:83], a[208:211], v[132:135], v[80:83]
    s_add_u32 s58, s58, 1024
    s_cmp_eq_u32 s58, s86
    s_cselect_b32 s58, s66, s58
    v_mfma_f32_16x16x32_bf16 v[84:87], a[212:215], v[132:135], v[84:87]
    buffer_load_dwordx4 v[120:123], v23, s[24:27], s58 offen offset:0 sc1
    v_mfma_f32_16x16x32_bf16 v[88:91], a[216:219], v[132:135], v[88:91]
    v_add_f32 v162, v162, v170
    v_add_f32 v163, v163, v171
    v_mfma_f32_16x16x32_bf16 v[92:95], a[220:223], v[132:135], v[92:95]
    v_add_f32 v164, v164, v172
    s_add_u32 s58, s58, 1024
    s_cmp_eq_u32 s58, s86
    s_cselect_b32 s58, s66, s58
    buffer_load_dwordx4 v[124:127], v23, s[24:27], s58 offen offset:0 sc1
    s_waitcnt vmcnt(10)
    v_mfma_f32_16x16x32_bf16 v[80:83], a[224:227], v[136:139], v[80:83]
    s_add_u32 s58, s58, 1024
    s_cmp_eq_u32 s58, s86
    s_cselect_b32 s58, s66, s58
    v_mfma_f32_16x16x32_bf16 v[84:87], a[228:231], v[136:139], v[84:87]
    buffer_load_dwordx4 v[128:131], v23, s[24:27], s58 offen offset:0 sc1
    v_mfma_f32_16x16x32_bf16 v[88:91], a[232:235], v[136:139], v[88:91]
    v_add_f32 v165, v165, v173
    v_add_f32 v166, v166, v174
    v_mfma_f32_16x16x32_bf16 v[92:95], a[236:239], v[136:139], v[92:95]
    v_add_f32 v167, v167, v175
    s_add_u32 s58, s58, 1024
    s_cmp_eq_u32 s58, s86
    s_cselect_b32 s58, s66, s58
    buffer_load_dwordx4 v[132:135], v23, s[24:27], s58 offen offset:0 sc1
    s_waitcnt vmcnt(10)
    v_mfma_f32_16x16x32_bf16 v[80:83], a[240:243], v[140:143], v[80:83]
    s_add_u32 s58, s58, 1024
    s_cmp_eq_u32 s58, s86
    s_cselect_b32 s58, s66, s58
    v_mfma_f32_16x16x32_bf16 v[84:87], a[244:247], v[140:143], v[84:87]
    buffer_load_dwordx4 v[136:139], v23, s[24:27], s58 offen offset:0 sc1
    v_mfma_f32_16x16x32_bf16 v[88:91], a[248:251], v[140:143], v[88:91]
    v_add_f32 v160, v160, v176
    v_add_f32 v161, v161, v177
    v_mfma_f32_16x16x32_bf16 v[92:95], a[252:255], v[140:143], v[92:95]
    v_add_f32 v162, v162, v178
    s_waitcnt vmcnt(10)
    v_mfma_f32_16x16x32_bf16 v[64:67], a[0:3], v[144:147], 0
    s_add_u32 s58, s58, 1024
    s_cmp_eq_u32 s58, s86
    s_cselect_b32 s58, s66, s58
    v_mfma_f32_16x16x32_bf16 v[68:71], a[4:7], v[144:147], 0
    buffer_load_dwordx4 v[140:143], v23, s[24:27], s58 offen offset:0 sc1
    v_mfma_f32_16x16x32_bf16 v[72:75], a[8:11], v[144:147], 0
    v_mfma_f32_16x16x32_bf16 v[76:79], a[12:15], v[144:147], 0
    s_waitcnt vmcnt(10)
    v_mfma_f32_16x16x32_bf16 v[64:67], a[16:19], v[148:151], v[64:67]
    s_add_u32 s58, s58, 1024
    s_cmp_eq_u32 s58, s86
    s_cselect_b32 s58, s66, s58
    v_mfma_f32_16x16x32_bf16 v[68:71], a[20:23], v[148:151], v[68:71]
    buffer_load_dwordx4 v[144:147], v23, s[24:27], s58 offen offset:0 sc1
    v_mfma_f32_16x16x32_bf16 v[72:75], a[24:27], v[148:151], v[72:75]
    ds_write_b128 v232, v[80:83] offset:32768
    v_mfma_f32_16x16x32_bf16 v[76:79], a[28:31], v[148:151], v[76:79]
    s_waitcnt vmcnt(10)
    v_mfma_f32_16x16x32_bf16 v[64:67], a[32:35], v[152:155], v[64:67]
    s_add_u32 s58, s58, 1024
    s_cmp_eq_u32 s58, s86
    s_cselect_b32 s58, s66, s58
    v_mfma_f32_16x16x32_bf16 v[68:71], a[36:39], v[152:155], v[68:71]
    buffer_load_dwordx4 v[148:151], v23, s[24:27], s58 offen offset:0 sc1
    v_mfma_f32_16x16x32_bf16 v[72:75], a[40:43], v[152:155], v[72:75]
    ds_write_b128 v232, v[84:87] offset:33792
    v_mfma_f32_16x16x32_bf16 v[76:79], a[44:47], v[152:155], v[76:79]
    s_waitcnt vmcnt(10)
    v_mfma_f32_16x16x32_bf16 v[64:67], a[48:51], v[156:159], v[64:67]
    s_add_u32 s58, s66, 14336
    ds_write_b128 v232, v[88:91] offset:34816
    v_mfma_f32_16x16x32_bf16 v[68:71], a[52:55], v[156:159], v[68:71]
    buffer_load_dwordx4 v[152:155], v23, s[24:27], s58 offen offset:0 sc1
    v_mfma_f32_16x16x32_bf16 v[72:75], a[56:59], v[156:159], v[72:75]
    v_add_f32 v163, v163, v179
    v_add_f32 v164, v164, v180
    v_mfma_f32_16x16x32_bf16 v[76:79], a[60:63], v[156:159], v[76:79]
    v_add_f32 v165, v165, v181
    s_waitcnt vmcnt(10)
    v_mfma_f32_16x16x32_bf16 v[64:67], a[64:67], v[112:115], v[64:67]
    s_add_u32 s58, s66, 15360
    ds_write_b128 v232, v[92:95] offset:35840
    v_mfma_f32_16x16x32_bf16 v[68:71], a[68:71], v[112:115], v[68:71]
    buffer_load_dwordx4 v[156:159], v23, s[24:27], s58 offen offset:0 sc1
    v_mfma_f32_16x16x32_bf16 v[72:75], a[72:75], v[112:115], v[72:75]
    v_add_f32 v166, v166, v182
    v_add_f32 v167, v167, v183
    v_mfma_f32_16x16x32_bf16 v[76:79], a[76:79], v[112:115], v[76:79]
    v_add_f32 v160, v160, v184
    s_waitcnt vmcnt(10)
    v_mfma_f32_16x16x32_bf16 v[64:67], a[80:83], v[116:119], v[64:67]
    s_xor_b32 s66, s44, 1
    s_lshl2_add_u32 s66, s51, s66
    s_mul_i32 s66, s66, 66816
    s_lshl2_add_u32 s66, s52, s66
    s_lshl_b32 s86, s65, 10
    s_add_u32 s58, s86, s66
    s_add_u32 s86, s66, 14336
    v_mfma_f32_16x16x32_bf16 v[68:71], a[84:87], v[116:119], v[68:71]
    buffer_load_dwordx4 v[112:115], v23, s[24:27], s58 offen offset:0 sc1
    v_mfma_f32_16x16x32_bf16 v[72:75], a[88:91], v[116:119], v[72:75]
    v_add_f32 v161, v161, v185
    v_add_f32 v162, v162, v186
    v_mfma_f32_16x16x32_bf16 v[76:79], a[92:95], v[116:119], v[76:79]
    v_add_f32 v163, v163, v187
    s_waitcnt vmcnt(10)
    v_mfma_f32_16x16x32_bf16 v[64:67], a[96:99], v[120:123], v[64:67]
    s_add_u32 s58, s58, 1024
    s_cmp_eq_u32 s58, s86
    s_cselect_b32 s58, s66, s58
    v_mfma_f32_16x16x32_bf16 v[68:71], a[100:103], v[120:123], v[68:71]
    buffer_load_dwordx4 v[116:119], v23, s[24:27], s58 offen offset:0 sc1
    v_mfma_f32_16x16x32_bf16 v[72:75], a[104:107], v[120:123], v[72:75]
    v_add_f32 v164, v164, v188
    v_add_f32 v165, v165, v189
    v_mfma_f32_16x16x32_bf16 v[76:79], a[108:111], v[120:123], v[76:79]
    v_add_f32 v166, v166, v190
    s_waitcnt vmcnt(10)
    v_mfma_f32_16x16x32_bf16 v[64:67], a[112:115], v[124:127], v[64:67]
    s_add_u32 s58, s58, 1024
    s_cmp_eq_u32 s58, s86
    s_cselect_b32 s58, s66, s58
    v_mfma_f32_16x16x32_bf16 v[68:71], a[116:119], v[124:127], v[68:71]
    buffer_load_dwordx4 v[120:123], v23, s[24:27], s58 offen offset:0 sc1
    v_mfma_f32_16x16x32_bf16 v[72:75], a[120:123], v[124:127], v[72:75]
    v_add_f32 v167, v167, v191
    v_mul_f32 v192, v160, v160
    v_mfma_f32_16x16x32_bf16 v[76:79], a[124:127], v[124:127], v[76:79]
    v_mul_f32 v193, v161, v161
    s_waitcnt vmcnt(10)
    v_mfma_f32_16x16x32_bf16 v[64:67], a[128:131], v[128:131], v[64:67]
    s_add_u32 s58, s58, 1024
    s_cmp_eq_u32 s58, s86
    s_cselect_b32 s58, s66, s58
    v_mfma_f32_16x16x32_bf16 v[68:71], a[132:135], v[128:131], v[68:71]
    buffer_load_dwordx4 v[124:127], v23, s[24:27], s58 offen offset:0 sc1
    v_mfma_f32_16x16x32_bf16 v[72:75], a[136:139], v[128:131], v[72:75]
    v_mul_f32 v194, v162, v162
    v_mul_f32 v195, v163, v163
    v_mfma_f32_16x16x32_bf16 v[76:79], a[140:143], v[128:131], v[76:79]
    v_mul_f32 v196, v164, v164
    s_waitcnt vmcnt(10)
    v_mfma_f32_16x16x32_bf16 v[64:67], a[144:147], v[132:135], v[64:67]
    s_add_u32 s58, s58, 1024
    s_cmp_eq_u32 s58, s86
    s_cselect_b32 s58, s66, s58
    v_mfma_f32_16x16x32_bf16 v[68:71], a[148:151], v[132:135], v[68:71]
    buffer_load_dwordx4 v[128:131], v23, s[24:27], s58 offen offset:0 sc1
    v_mfma_f32_16x16x32_bf16 v[72:75], a[152:155], v[132:135], v[72:75]
    v_mul_f32 v197, v165, v165
    v_mul_f32 v198, v166, v166
    v_mfma_f32_16x16x32_bf16 v[76:79], a[156:159], v[132:135], v[76:79]
    v_mul_f32 v199, v167, v167
    ds_write_b128 v244, v[216:219]
    s_waitcnt vmcnt(10)
    v_mfma_f32_16x16x32_bf16 v[64:67], a[160:163], v[136:139], v[64:67]
    s_add_u32 s58, s58, 1024
    s_cmp_eq_u32 s58, s86
    s_cselect_b32 s58, s66, s58
    v_mfma_f32_16x16x32_bf16 v[68:71], a[164:167], v[136:139], v[68:71]
    buffer_load_dwordx4 v[132:135], v23, s[24:27], s58 offen offset:0 sc1
    v_mfma_f32_16x16x32_bf16 v[72:75], a[168:171], v[136:139], v[72:75]
    v_fma_f32 v192, v192, v236, v237
    v_fma_f32 v193, v193, v236, v237
    v_mfma_f32_16x16x32_bf16 v[76:79], a[172:175], v[136:139], v[76:79]
    v_fma_f32 v194, v194, v236, v237
    s_waitcnt vmcnt(10)
    v_mfma_f32_16x16x32_bf16 v[64:67], a[176:179], v[140:143], v[64:67]
    s_add_u32 s58, s58, 1024
    s_cmp_eq_u32 s58, s86
    s_cselect_b32 s58, s66, s58
    v_mfma_f32_16x16x32_bf16 v[68:71], a[180:183], v[140:143], v[68:71]
    buffer_load_dwordx4 v[136:139], v23, s[24:27], s58 offen offset:0 sc1
    v_mfma_f32_16x16x32_bf16 v[72:75], a[184:187], v[140:143], v[72:75]
    v_fma_f32 v195, v195, v236, v237
    v_fma_f32 v196, v196, v236, v237
    v_mfma_f32_16x16x32_bf16 v[76:79], a[188:191], v[140:143], v[76:79]
    v_fma_f32 v197, v197, v236, v237
    ds_write_b128 v244, v[220:223] offset:1408
    s_waitcnt vmcnt(10)
    v_mfma_f32_16x16x32_bf16 v[64:67], a[192:195], v[144:147], v[64:67]
    s_add_u32 s58, s58, 1024
    s_cmp_eq_u32 s58, s86
    s_cselect_b32 s58, s66, s58
    v_mfma_f32_16x16x32_bf16 v[68:71], a[196:199], v[144:147], v[68:71]
    buffer_load_dwordx4 v[140:143], v23, s[24:27], s58 offen offset:0 sc1
    v_mfma_f32_16x16x32_bf16 v[72:75], a[200:203], v[144:147], v[72:75]
    v_fma_f32 v198, v198, v236, v237
    v_fma_f32 v199, v199, v236, v237
    v_mfma_f32_16x16x32_bf16 v[76:79], a[204:207], v[144:147], v[76:79]
    v_mul_f32 v192, v192, v160
    s_waitcnt vmcnt(10)
    v_mfma_f32_16x16x32_bf16 v[64:67], a[208:211], v[148:151], v[64:67]
    s_add_u32 s58, s58, 1024
    s_cmp_eq_u32 s58, s86
    s_cselect_b32 s58, s66, s58
    v_mfma_f32_16x16x32_bf16 v[68:71], a[212:215], v[148:151], v[68:71]
    buffer_load_dwordx4 v[144:147], v23, s[24:27], s58 offen offset:0 sc1
    v_mfma_f32_16x16x32_bf16 v[72:75], a[216:219], v[148:151], v[72:75]
    v_mul_f32 v193, v193, v161
    v_mul_f32 v194, v194, v162
    v_mfma_f32_16x16x32_bf16 v[76:79], a[220:223], v[148:151], v[76:79]
    v_mul_f32 v195, v195, v163
    ds_write_b64 v252, v[224:225] offset:128
    s_waitcnt vmcnt(10)
    v_mfma_f32_16x16x32_bf16 v[64:67], a[224:227], v[152:155], v[64:67]
    s_add_u32 s58, s58, 1024
    s_cmp_eq_u32 s58, s86
    s_cselect_b32 s58, s66, s58
    v_mfma_f32_16x16x32_bf16 v[68:71], a[228:231], v[152:155], v[68:71]
    buffer_load_dwordx4 v[148:151], v23, s[24:27], s58 offen offset:0 sc1
    v_mfma_f32_16x16x32_bf16 v[72:75], a[232:235], v[152:155], v[72:75]
    v_mul_f32 v196, v196, v164
    v_mul_f32 v197, v197, v165
    v_mfma_f32_16x16x32_bf16 v[76:79], a[236:239], v[152:155], v[76:79]
    v_mul_f32 v198, v198, v166
    s_waitcnt vmcnt(10)
    v_mfma_f32_16x16x32_bf16 v[64:67], a[240:243], v[156:159], v[64:67]
    s_add_u32 s58, s58, 1024
    s_cmp_eq_u32 s58, s86
    s_cselect_b32 s58, s66, s58
    v_mfma_f32_16x16x32_bf16 v[68:71], a[244:247], v[156:159], v[68:71]
    buffer_load_dwordx4 v[152:155], v23, s[24:27], s58 offen offset:0 sc1
    v_mfma_f32_16x16x32_bf16 v[72:75], a[248:251], v[156:159], v[72:75]
    v_mul_f32 v199, v199, v167
    v_mfma_f32_16x16x32_bf16 v[76:79], a[252:255], v[156:159], v[76:79]
    ds_read_b64 v[216:217], v238 offset:0
    ds_read_b64 v[218:219], v238 offset:32
    ds_read_b64 v[220:221], v238 offset:64
    ds_read_b64 v[222:223], v238 offset:96
    ds_read_b64 v[224:225], v238 offset:128
    s_waitcnt vmcnt(10)
    v_mfma_f32_16x16x32_bf16 v[48:51], a[0:3], v[112:115], 0
    s_add_u32 s58, s58, 1024
    s_cmp_eq_u32 s58, s86
    s_cselect_b32 s58, s66, s58
    v_mfma_f32_16x16x32_bf16 v[52:55], a[4:7], v[112:115], 0
    buffer_load_dwordx4 v[156:159], v23, s[24:27], s58 offen offset:0 sc1
    v_mfma_f32_16x16x32_bf16 v[56:59], a[8:11], v[112:115], 0
    v_mfma_f32_16x16x32_bf16 v[60:63], a[12:15], v[112:115], 0
    s_waitcnt vmcnt(10)
    v_mfma_f32_16x16x32_bf16 v[48:51], a[16:19], v[116:119], v[48:51]
    s_add_u32 s58, s58, 1024
    s_cmp_eq_u32 s58, s86
    s_cselect_b32 s58, s66, s58
    v_mfma_f32_16x16x32_bf16 v[52:55], a[20:23], v[116:119], v[52:55]
    buffer_load_dwordx4 v[112:115], v23, s[24:27], s58 offen offset:0 sc1
    v_mfma_f32_16x16x32_bf16 v[56:59], a[24:27], v[116:119], v[56:59]
    ds_write_b128 v232, v[64:67] offset:16384
    v_mfma_f32_16x16x32_bf16 v[60:63], a[28:31], v[116:119], v[60:63]
    s_waitcnt vmcnt(10)
    v_mfma_f32_16x16x32_bf16 v[48:51], a[32:35], v[120:123], v[48:51]
    s_add_u32 s58, s58, 1024
    s_cmp_eq_u32 s58, s86
    s_cselect_b32 s58, s66, s58
    v_mfma_f32_16x16x32_bf16 v[52:55], a[36:39], v[120:123], v[52:55]
    buffer_load_dwordx4 v[116:119], v23, s[24:27], s58 offen offset:0 sc1
    v_mfma_f32_16x16x32_bf16 v[56:59], a[40:43], v[120:123], v[56:59]
    ds_write_b128 v232, v[68:71] offset:17408
    v_mfma_f32_16x16x32_bf16 v[60:63], a[44:47], v[120:123], v[60:63]
    s_waitcnt vmcnt(10)
    v_mfma_f32_16x16x32_bf16 v[48:51], a[48:51], v[124:127], v[48:51]
    s_add_u32 s58, s66, 14336
    ds_write_b128 v232, v[72:75] offset:18432
    v_mfma_f32_16x16x32_bf16 v[52:55], a[52:55], v[124:127], v[52:55]
    buffer_load_dwordx4 v[120:123], v23, s[24:27], s58 offen offset:0 sc1
    v_mfma_f32_16x16x32_bf16 v[56:59], a[56:59], v[124:127], v[56:59]
    v_exp_f32 v192, v192
    v_exp_f32 v193, v193
    v_mfma_f32_16x16x32_bf16 v[60:63], a[60:63], v[124:127], v[60:63]
    v_exp_f32 v194, v194
    s_waitcnt vmcnt(10)
    v_mfma_f32_16x16x32_bf16 v[48:51], a[64:67], v[128:131], v[48:51]
    s_add_u32 s58, s66, 15360
    ds_write_b128 v232, v[76:79] offset:19456
    v_mfma_f32_16x16x32_bf16 v[52:55], a[68:71], v[128:131], v[52:55]
    buffer_load_dwordx4 v[124:127], v23, s[24:27], s58 offen offset:0 sc1
    v_mfma_f32_16x16x32_bf16 v[56:59], a[72:75], v[128:131], v[56:59]
    v_exp_f32 v195, v195
    v_exp_f32 v196, v196
    v_mfma_f32_16x16x32_bf16 v[60:63], a[76:79], v[128:131], v[60:63]
    v_exp_f32 v197, v197
    s_waitcnt vmcnt(10)
    v_mfma_f32_16x16x32_bf16 v[48:51], a[80:83], v[132:135], v[48:51]
    s_xor_b32 s66, s44, 0
    s_lshl2_add_u32 s66, s51, s66
    s_mul_i32 s66, s66, 66816
    s_lshl2_add_u32 s66, s52, s66
    s_lshl_b32 s86, s65, 10
    s_add_u32 s58, s86, s66
    s_add_u32 s86, s66, 14336
    v_mfma_f32_16x16x32_bf16 v[52:55], a[84:87], v[132:135], v[52:55]
    buffer_load_dwordx4 v[128:131], v23, s[24:27], s58 offen offset:0 sc1
    v_mfma_f32_16x16x32_bf16 v[56:59], a[88:91], v[132:135], v[56:59]
    v_exp_f32 v198, v198
    v_exp_f32 v199, v199
    v_mfma_f32_16x16x32_bf16 v[60:63], a[92:95], v[132:135], v[60:63]
    v_add_f32 v192, 1.0, v192
    s_waitcnt vmcnt(10)
    v_mfma_f32_16x16x32_bf16 v[48:51], a[96:99], v[136:139], v[48:51]
    s_add_u32 s58, s58, 1024
    s_cmp_eq_u32 s58, s86
    s_cselect_b32 s58, s66, s58
    v_mfma_f32_16x16x32_bf16 v[52:55], a[100:103], v[136:139], v[52:55]
    buffer_load_dwordx4 v[132:135], v23, s[24:27], s58 offen offset:0 sc1
    v_mfma_f32_16x16x32_bf16 v[56:59], a[104:107], v[136:139], v[56:59]
    v_add_f32 v193, 1.0, v193
    v_add_f32 v194, 1.0, v194
    v_mfma_f32_16x16x32_bf16 v[60:63], a[108:111], v[136:139], v[60:63]
    v_add_f32 v195, 1.0, v195
    s_waitcnt vmcnt(10)
    v_mfma_f32_16x16x32_bf16 v[48:51], a[112:115], v[140:143], v[48:51]
    s_add_u32 s58, s58, 1024
    s_cmp_eq_u32 s58, s86
    s_cselect_b32 s58, s66, s58
    v_mfma_f32_16x16x32_bf16 v[52:55], a[116:119], v[140:143], v[52:55]
    buffer_load_dwordx4 v[136:139], v23, s[24:27], s58 offen offset:0 sc1
    v_mfma_f32_16x16x32_bf16 v[56:59], a[120:123], v[140:143], v[56:59]
    v_add_f32 v196, 1.0, v196
    v_add_f32 v197, 1.0, v197
    v_mfma_f32_16x16x32_bf16 v[60:63], a[124:127], v[140:143], v[60:63]
    v_add_f32 v198, 1.0, v198
    s_waitcnt vmcnt(10)
    v_mfma_f32_16x16x32_bf16 v[48:51], a[128:131], v[144:147], v[48:51]
    s_add_u32 s58, s58, 1024
    s_cmp_eq_u32 s58, s86
    s_cselect_b32 s58, s66, s58
    v_mfma_f32_16x16x32_bf16 v[52:55], a[132:135], v[144:147], v[52:55]
    buffer_load_dwordx4 v[140:143], v23, s[24:27], s58 offen offset:0 sc1
    v_mfma_f32_16x16x32_bf16 v[56:59], a[136:139], v[144:147], v[56:59]
    v_add_f32 v199, 1.0, v199
    v_rcp_f32 v192, v192
    v_mfma_f32_16x16x32_bf16 v[60:63], a[140:143], v[144:147], v[60:63]
    v_rcp_f32 v193, v193
    s_waitcnt vmcnt(10)
    v_mfma_f32_16x16x32_bf16 v[48:51], a[144:147], v[148:151], v[48:51]
    s_add_u32 s58, s58, 1024
    s_cmp_eq_u32 s58, s86
    s_cselect_b32 s58, s66, s58
    v_mfma_f32_16x16x32_bf16 v[52:55], a[148:151], v[148:151], v[52:55]
    buffer_load_dwordx4 v[144:147], v23, s[24:27], s58 offen offset:0 sc1
    v_mfma_f32_16x16x32_bf16 v[56:59], a[152:155], v[148:151], v[56:59]
    v_rcp_f32 v194, v194
    v_rcp_f32 v195, v195
    v_mfma_f32_16x16x32_bf16 v[60:63], a[156:159], v[148:151], v[60:63]
    v_rcp_f32 v196, v196
    s_waitcnt vmcnt(10)
    v_mfma_f32_16x16x32_bf16 v[48:51], a[160:163], v[152:155], v[48:51]
    s_add_u32 s58, s58, 1024
    s_cmp_eq_u32 s58, s86
    s_cselect_b32 s58, s66, s58
    v_mfma_f32_16x16x32_bf16 v[52:55], a[164:167], v[152:155], v[52:55]
    buffer_load_dwordx4 v[148:151], v23, s[24:27], s58 offen offset:0 sc1
    v_mfma_f32_16x16x32_bf16 v[56:59], a[168:171], v[152:155], v[56:59]
    v_rcp_f32 v197, v197
    v_rcp_f32 v198, v198
    v_mfma_f32_16x16x32_bf16 v[60:63], a[172:175], v[152:155], v[60:63]
    v_rcp_f32 v199, v199
    s_waitcnt vmcnt(10)
    v_mfma_f32_16x16x32_bf16 v[48:51], a[176:179], v[156:159], v[48:51]
    s_add_u32 s58, s58, 1024
    s_cmp_eq_u32 s58, s86
    s_cselect_b32 s58, s66, s58
    v_mfma_f32_16x16x32_bf16 v[52:55], a[180:183], v[156:159], v[52:55]
    buffer_load_dwordx4 v[152:155], v23, s[24:27], s58 offen offset:0 sc1
    v_mfma_f32_16x16x32_bf16 v[56:59], a[184:187], v[156:159], v[56:59]
    v_mul_f32 v192, v192, v160
    v_mul_f32 v193, v193, v161
    v_mfma_f32_16x16x32_bf16 v[60:63], a[188:191], v[156:159], v[60:63]
    v_mul_f32 v194, v194, v162
    s_waitcnt vmcnt(10)
    v_mfma_f32_16x16x32_bf16 v[48:51], a[192:195], v[112:115], v[48:51]
    s_add_u32 s58, s58, 1024
L_wb_1:
    s_cbranch_execz L_wb_ret
    s_cmp_eq_u32 s58, s86
    s_cselect_b32 s58, s66, s58
    v_mfma_f32_16x16x32_bf16 v[52:55], a[196:199], v[112:115], v[52:55]
    buffer_load_dwordx4 v[156:159], v23, s[24:27], s58 offen offset:0 sc1
    v_mfma_f32_16x16x32_bf16 v[56:59], a[200:203], v[112:115], v[56:59]
    v_mul_f32 v195, v195, v163
    v_mul_f32 v196, v196, v164
    v_mfma_f32_16x16x32_bf16 v[60:63], a[204:207], v[112:115], v[60:63]
    v_mul_f32 v197, v197, v165
    s_waitcnt vmcnt(10)
    v_mfma_f32_16x16x32_bf16 v[48:51], a[208:211], v[116:119], v[48:51]
    s_add_u32 s58, s58, 1024
    s_cmp_eq_u32 s58, s86
    s_cselect_b32 s58, s66, s58
    v_mfma_f32_16x16x32_bf16 v[52:55], a[212:215], v[116:119], v[52:55]
    buffer_load_dwordx4 v[112:115], v23, s[24:27], s58 offen offset:0 sc1
    v_mfma_f32_16x16x32_bf16 v[56:59], a[216:219], v[116:119], v[56:59]
    v_mul_f32 v198, v198, v166
    v_mul_f32 v199, v199, v167
    v_mfma_f32_16x16x32_bf16 v[60:63], a[220:223], v[116:119], v[60:63]
    v_cvt_pk_bf16_f32 v96, v192, v193
    s_waitcnt vmcnt(10)
    v_mfma_f32_16x16x32_bf16 v[48:51], a[224:227], v[120:123], v[48:51]
    s_add_u32 s58, s58, 1024
    s_cmp_eq_u32 s58, s86
    s_cselect_b32 s58, s66, s58
    v_mfma_f32_16x16x32_bf16 v[52:55], a[228:231], v[120:123], v[52:55]
    buffer_load_dwordx4 v[116:119], v23, s[24:27], s58 offen offset:0 sc1
    v_mfma_f32_16x16x32_bf16 v[56:59], a[232:235], v[120:123], v[56:59]
    v_cvt_pk_bf16_f32 v97, v194, v195
    v_cvt_pk_bf16_f32 v98, v196, v197
    v_mfma_f32_16x16x32_bf16 v[60:63], a[236:239], v[120:123], v[60:63]
    v_cvt_pk_bf16_f32 v99, v198, v199
    s_waitcnt vmcnt(10)
    v_mfma_f32_16x16x32_bf16 v[48:51], a[240:243], v[124:127], v[48:51]
    s_add_u32 s58, s58, 1024
    s_cmp_eq_u32 s58, s86
    s_cselect_b32 s58, s66, s58
    v_mfma_f32_16x16x32_bf16 v[52:55], a[244:247], v[124:127], v[52:55]
    buffer_load_dwordx4 v[120:123], v23, s[24:27], s58 offen offset:0 sc1
    v_mfma_f32_16x16x32_bf16 v[56:59], a[248:251], v[124:127], v[56:59]
    v_mfma_f32_16x16x32_bf16 v[60:63], a[252:255], v[124:127], v[60:63]
    s_waitcnt vmcnt(10)
    v_mfma_f32_16x16x32_bf16 v[32:35], a[0:3], v[128:131], v[32:35]
    s_add_u32 s58, s58, 1024
    s_cmp_eq_u32 s58, s86
    s_cselect_b32 s58, s66, s58
    v_mfma_f32_16x16x32_bf16 v[36:39], a[4:7], v[128:131], v[36:39]
    buffer_load_dwordx4 v[124:127], v23, s[24:27], s58 offen offset:0 sc1
    v_mfma_f32_16x16x32_bf16 v[40:43], a[8:11], v[128:131], v[40:43]
    v_mfma_f32_16x16x32_bf16 v[44:47], a[12:15], v[128:131], v[44:47]
    s_waitcnt vmcnt(10)
    v_mfma_f32_16x16x32_bf16 v[32:35], a[16:19], v[132:135], v[32:35]
    s_add_u32 s58, s58, 1024
    s_cmp_eq_u32 s58, s86
    s_cselect_b32 s58, s66, s58
    v_mfma_f32_16x16x32_bf16 v[36:39], a[20:23], v[132:135], v[36:39]
    buffer_load_dwordx4 v[128:131], v23, s[24:27], s58 offen offset:0 sc1
    v_mfma_f32_16x16x32_bf16 v[40:43], a[24:27], v[132:135], v[40:43]
    ds_write_b128 v232, v[48:51] offset:0
    v_mfma_f32_16x16x32_bf16 v[44:47], a[28:31], v[132:135], v[44:47]
    ds_write_b128 v232, v[52:55] offset:1024
    s_waitcnt vmcnt(10)
    v_mfma_f32_16x16x32_bf16 v[32:35], a[32:35], v[136:139], v[32:35]
    s_add_u32 s58, s58, 1024
    s_cmp_eq_u32 s58, s86
    s_cselect_b32 s58, s66, s58
    v_mfma_f32_16x16x32_bf16 v[36:39], a[36:39], v[136:139], v[36:39]
    buffer_load_dwordx4 v[132:135], v23, s[24:27], s58 offen offset:0 sc1
    v_mfma_f32_16x16x32_bf16 v[40:43], a[40:43], v[136:139], v[40:43]
    ds_write_b128 v232, v[56:59] offset:2048
    v_mfma_f32_16x16x32_bf16 v[44:47], a[44:47], v[136:139], v[44:47]
    ds_write_b128 v232, v[60:63] offset:3072
    s_waitcnt vmcnt(10)
    v_mfma_f32_16x16x32_bf16 v[32:35], a[48:51], v[140:143], v[32:35]
    s_add_u32 s58, s66, 14336
    v_mfma_f32_16x16x32_bf16 v[36:39], a[52:55], v[140:143], v[36:39]
    buffer_load_dwordx4 v[136:139], v23, s[24:27], s58 offen offset:0 sc1
    v_mfma_f32_16x16x32_bf16 v[40:43], a[56:59], v[140:143], v[40:43]
    v_mfma_f32_16x16x32_bf16 v[44:47], a[60:63], v[140:143], v[44:47]
    s_waitcnt vmcnt(10)
    v_mfma_f32_16x16x32_bf16 v[32:35], a[64:67], v[144:147], v[32:35]
    s_add_u32 s58, s66, 15360
    v_mfma_f32_16x16x32_bf16 v[36:39], a[68:71], v[144:147], v[36:39]
    buffer_load_dwordx4 v[140:143], v23, s[24:27], s58 offen offset:0 sc1
    v_mfma_f32_16x16x32_bf16 v[40:43], a[72:75], v[144:147], v[40:43]
    v_mfma_f32_16x16x32_bf16 v[44:47], a[76:79], v[144:147], v[44:47]
    s_waitcnt vmcnt(10)
    v_mfma_f32_16x16x32_bf16 v[32:35], a[80:83], v[148:151], v[32:35]
    s_add_u32 m0, s52, 81920
    s_lshl_b32 s57, s76, 7
    v_mfma_f32_16x16x32_bf16 v[36:39], a[84:87], v[148:151], v[36:39]
    buffer_load_dwordx4 v12, s[20:23], s57 offen offset:0 lds
    v_mfma_f32_16x16x32_bf16 v[40:43], a[88:91], v[148:151], v[40:43]
    s_waitcnt lgkmcnt(0)
    s_barrier
    v_mfma_f32_16x16x32_bf16 v[44:47], a[92:95], v[148:151], v[44:47]
    s_waitcnt vmcnt(10)
    v_mfma_f32_16x16x32_bf16 v[32:35], a[96:99], v[152:155], v[32:35]
    s_add_u32 s57, s57, 31744
    v_mfma_f32_16x16x32_bf16 v[36:39], a[100:103], v[152:155], v[36:39]
    buffer_load_dwordx4 v12, s[20:23], s57 offen offset:1024 lds
    v_mfma_f32_16x16x32_bf16 v[40:43], a[104:107], v[152:155], v[40:43]
    ds_read_b128 v[160:163], v233 offset:0
    ds_read_b128 v[176:179], v234 offset:16384
    v_mfma_f32_16x16x32_bf16 v[44:47], a[108:111], v[152:155], v[44:47]
    ds_read_b128 v[192:195], v235 offset:32768
    s_waitcnt vmcnt(10)
    v_mfma_f32_16x16x32_bf16 v[32:35], a[112:115], v[156:159], v[32:35]
    s_add_u32 s57, s57, 31744
    v_mfma_f32_16x16x32_bf16 v[36:39], a[116:119], v[156:159], v[36:39]
    buffer_load_dwordx4 v12, s[20:23], s57 offen offset:2048 lds
    v_mfma_f32_16x16x32_bf16 v[40:43], a[120:123], v[156:159], v[40:43]
    ds_read_b128 v[164:167], v233 offset:1024
    ds_read_b128 v[180:183], v234 offset:17408
    v_mfma_f32_16x16x32_bf16 v[44:47], a[124:127], v[156:159], v[44:47]
    ds_read_b128 v[196:199], v235 offset:33792
    s_waitcnt vmcnt(10)
    v_mfma_f32_16x16x32_bf16 v[32:35], a[128:131], v[112:115], v[32:35]
    s_add_u32 s57, s57, 31744
    v_mfma_f32_16x16x32_bf16 v[36:39], a[132:135], v[112:115], v[36:39]
    buffer_load_dwordx4 v12, s[20:23], s57 offen offset:3072 lds
    v_mfma_f32_16x16x32_bf16 v[40:43], a[136:139], v[112:115], v[40:43]
    ds_read_b128 v[168:171], v233 offset:2048
    ds_read_b128 v[184:187], v234 offset:18432
    v_mfma_f32_16x16x32_bf16 v[44:47], a[140:143], v[112:115], v[44:47]
    ds_read_b128 v[200:203], v235 offset:34816
    s_waitcnt vmcnt(10)
    v_mfma_f32_16x16x32_bf16 v[32:35], a[144:147], v[116:119], v[32:35]
    s_add_u32 m0, s52, 98304
    s_lshl_b32 s57, s76, 7
    s_add_u32 s57, s57, 131072
    v_mfma_f32_16x16x32_bf16 v[36:39], a[148:151], v[116:119], v[36:39]
    buffer_load_dwordx4 v12, s[20:23], s57 offen offset:0 lds
    v_mfma_f32_16x16x32_bf16 v[40:43], a[152:155], v[116:119], v[40:43]
    ds_read_b128 v[172:175], v233 offset:3072
    ds_read_b128 v[188:191], v234 offset:19456
    v_mfma_f32_16x16x32_bf16 v[44:47], a[156:159], v[116:119], v[44:47]
    ds_read_b128 v[204:207], v235 offset:35840
    s_waitcnt vmcnt(10)
    v_mfma_f32_16x16x32_bf16 v[32:35], a[160:163], v[120:123], v[32:35]
    s_add_u32 s57, s57, 31744
    v_mfma_f32_16x16x32_bf16 v[36:39], a[164:167], v[120:123], v[36:39]
    buffer_load_dwordx4 v12, s[20:23], s57 offen offset:1024 lds
    v_mfma_f32_16x16x32_bf16 v[40:43], a[168:171], v[120:123], v[40:43]
    v_mfma_f32_16x16x32_bf16 v[44:47], a[172:175], v[120:123], v[44:47]
    s_waitcnt vmcnt(10)
    v_mfma_f32_16x16x32_bf16 v[32:35], a[176:179], v[124:127], v[32:35]
    s_add_u32 s57, s57, 31744
    s_waitcnt lgkmcnt(9)
    v_mfma_f32_16x16x32_bf16 v[36:39], a[180:183], v[124:127], v[36:39]
    buffer_load_dwordx4 v12, s[20:23], s57 offen offset:2048 lds
    v_mfma_f32_16x16x32_bf16 v[40:43], a[184:187], v[124:127], v[40:43]
    v_add_f32 v160, v160, v176
    v_add_f32 v161, v161, v177
    v_mfma_f32_16x16x32_bf16 v[44:47], a[188:191], v[124:127], v[44:47]
    v_add_f32 v162, v162, v178
    s_waitcnt vmcnt(10)
    v_mfma_f32_16x16x32_bf16 v[32:35], a[192:195], v[128:131], v[32:35]
    s_add_u32 s57, s57, 31744
    v_add_f32 v163, v163, v179
    v_mfma_f32_16x16x32_bf16 v[36:39], a[196:199], v[128:131], v[36:39]
    buffer_load_dwordx4 v12, s[20:23], s57 offen offset:3072 lds
    v_mfma_f32_16x16x32_bf16 v[40:43], a[200:203], v[128:131], v[40:43]
    s_waitcnt lgkmcnt(6)
    v_add_f32 v164, v164, v180
    v_mfma_f32_16x16x32_bf16 v[44:47], a[204:207], v[128:131], v[44:47]
    v_add_f32 v165, v165, v181
    s_waitcnt vmcnt(10)
    v_mfma_f32_16x16x32_bf16 v[32:35], a[208:211], v[132:135], v[32:35]
    s_add_u32 m0, s52, 114688
    s_lshl_b32 s57, s77, 7
    v_add_f32 v166, v166, v182
    v_mfma_f32_16x16x32_bf16 v[36:39], a[212:215], v[132:135], v[36:39]
    buffer_load_dwordx4 v12, s[20:23], s57 offen offset:0 lds
    v_mfma_f32_16x16x32_bf16 v[40:43], a[216:219], v[132:135], v[40:43]
    v_add_f32 v167, v167, v183
    s_waitcnt lgkmcnt(3)
    v_mfma_f32_16x16x32_bf16 v[44:47], a[220:223], v[132:135], v[44:47]
    v_add_f32 v168, v168, v184
    s_waitcnt vmcnt(10)
    v_mfma_f32_16x16x32_bf16 v[32:35], a[224:227], v[136:139], v[32:35]
    s_add_u32 s57, s57, 31744
    v_add_f32 v169, v169, v185
    v_mfma_f32_16x16x32_bf16 v[36:39], a[228:231], v[136:139], v[36:39]
    buffer_load_dwordx4 v12, s[20:23], s57 offen offset:1024 lds
    v_mfma_f32_16x16x32_bf16 v[40:43], a[232:235], v[136:139], v[40:43]
    v_add_f32 v170, v170, v186
    v_add_f32 v171, v171, v187
    v_mfma_f32_16x16x32_bf16 v[44:47], a[236:239], v[136:139], v[44:47]
    s_waitcnt lgkmcnt(0)
    s_waitcnt vmcnt(10)
    v_mfma_f32_16x16x32_bf16 v[32:35], a[240:243], v[140:143], v[32:35]
    s_add_u32 s57, s57, 31744
    v_add_f32 v172, v172, v188
    v_mfma_f32_16x16x32_bf16 v[36:39], a[244:247], v[140:143], v[36:39]
    buffer_load_dwordx4 v12, s[20:23], s57 offen offset:2048 lds
    v_mfma_f32_16x16x32_bf16 v[40:43], a[248:251], v[140:143], v[40:43]
    v_add_f32 v173, v173, v189
    v_add_f32 v174, v174, v190
    v_mfma_f32_16x16x32_bf16 v[44:47], a[252:255], v[140:143], v[44:47]
    v_add_f32 v175, v175, v191
    v_pk_add_f32 v[160:161], v[160:161], v[192:193]
    v_pk_add_f32 v[162:163], v[162:163], v[194:195]
    v_pk_add_f32 v[164:165], v[164:165], v[196:197]
    v_pk_add_f32 v[166:167], v[166:167], v[198:199]
    v_pk_add_f32 v[168:169], v[168:169], v[200:201]
    v_pk_add_f32 v[170:171], v[170:171], v[202:203]
    v_pk_add_f32 v[172:173], v[172:173], v[204:205]
    v_pk_add_f32 v[174:175], v[174:175], v[206:207]
    buffer_store_dwordx4 v[96:99], v23, s[24:27], s83 offen sc1
    s_add_u32 s57, s57, 31744
    buffer_load_dwordx4 v12, s[20:23], s57 offen offset:3072 lds
    v_pk_add_f32 v[32:33], v[32:33], v[160:161]
    v_pk_add_f32 v[34:35], v[34:35], v[162:163]
    v_pk_add_f32 v[36:37], v[36:37], v[164:165]
    v_pk_add_f32 v[38:39], v[38:39], v[166:167]
    v_pk_mul_f32 v[48:49], v[32:33], v[32:33]
    v_pk_mul_f32 v[50:51], v[34:35], v[34:35]
    v_pk_mul_f32 v[52:53], v[36:37], v[36:37]
    v_pk_mul_f32 v[54:55], v[38:39], v[38:39]
    s_add_u32 m0, s52, 131072
    s_lshl_b32 s57, s77, 7
    s_add_u32 s57, s57, 131072
    buffer_load_dwordx4 v12, s[20:23], s57 offen offset:0 lds
    v_pk_fma_f32 v[48:49], v[48:49], v[236:237], v[236:237] op_sel:[0,0,1] op_sel_hi:[1,0,1]
    v_pk_fma_f32 v[50:51], v[50:51], v[236:237], v[236:237] op_sel:[0,0,1] op_sel_hi:[1,0,1]
    v_pk_fma_f32 v[52:53], v[52:53], v[236:237], v[236:237] op_sel:[0,0,1] op_sel_hi:[1,0,1]
    v_pk_fma_f32 v[54:55], v[54:55], v[236:237], v[236:237] op_sel:[0,0,1] op_sel_hi:[1,0,1]
    v_pk_mul_f32 v[48:49], v[48:49], v[32:33]
    v_pk_mul_f32 v[50:51], v[50:51], v[34:35]
    v_pk_mul_f32 v[52:53], v[52:53], v[36:37]
    v_pk_mul_f32 v[54:55], v[54:55], v[38:39]
    s_add_u32 s57, s57, 31744
    buffer_load_dwordx4 v12, s[20:23], s57 offen offset:1024 lds
    s_waitcnt vmcnt(11)
    ds_read_b64_tr_b16 a[0:1], v6 offset:32768
    ds_read_b64_tr_b16 a[2:3], v6 offset:34816
    ds_read_b64_tr_b16 a[4:5], v7 offset:32768
    ds_read_b64_tr_b16 a[6:7], v7 offset:34816
    v_exp_f32 v48, v48
    v_exp_f32 v49, v49
    v_exp_f32 v50, v50
    v_exp_f32 v51, v51
    ds_read_b64_tr_b16 a[8:9], v6 offset:33024
    ds_read_b64_tr_b16 a[10:11], v6 offset:35072
    ds_read_b64_tr_b16 a[12:13], v7 offset:33024
    ds_read_b64_tr_b16 a[14:15], v7 offset:35072
    s_add_u32 s57, s57, 31744
    buffer_load_dwordx4 v12, s[20:23], s57 offen offset:2048 lds
    v_exp_f32 v52, v52
    v_exp_f32 v53, v53
    v_exp_f32 v54, v54
    v_exp_f32 v55, v55
    v_pk_add_f32 v[48:49], v[48:49], 1.0 op_sel_hi:[1,0]
    v_pk_add_f32 v[50:51], v[50:51], 1.0 op_sel_hi:[1,0]
    v_pk_add_f32 v[52:53], v[52:53], 1.0 op_sel_hi:[1,0]
    v_pk_add_f32 v[54:55], v[54:55], 1.0 op_sel_hi:[1,0]
    s_add_u32 s57, s57, 31744
    buffer_load_dwordx4 v12, s[20:23], s57 offen offset:3072 lds
    v_rcp_f32 v48, v48
    v_rcp_f32 v49, v49
    v_rcp_f32 v50, v50
    v_rcp_f32 v51, v51
    v_rcp_f32 v52, v52
    v_rcp_f32 v53, v53
    v_rcp_f32 v54, v54
    v_rcp_f32 v55, v55
    v_pk_mul_f32 v[48:49], v[48:49], v[32:33]
    v_pk_mul_f32 v[50:51], v[50:51], v[34:35]
    v_pk_mul_f32 v[52:53], v[52:53], v[36:37]
    v_pk_mul_f32 v[54:55], v[54:55], v[38:39]
    s_add_u32 m0, s52, 147456
    s_lshl_b32 s57, s78, 7
    buffer_load_dwordx4 v12, s[20:23], s57 offen offset:0 lds
    v_cvt_pk_bf16_f32 v56, v48, v49
    v_cvt_pk_bf16_f32 v57, v50, v51
    v_cvt_pk_bf16_f32 v58, v52, v53
    v_cvt_pk_bf16_f32 v59, v54, v55
    buffer_store_dwordx4 v[56:59], v23, s[24:27], s67 offen offset:0 sc1
    v_pk_add_f32 v[40:41], v[40:41], v[168:169]
    v_pk_add_f32 v[42:43], v[42:43], v[170:171]
    v_pk_add_f32 v[44:45], v[44:45], v[172:173]
    v_pk_add_f32 v[46:47], v[46:47], v[174:175]
    s_add_u32 s57, s57, 31744
    buffer_load_dwordx4 v12, s[20:23], s57 offen offset:1024 lds
    s_waitcnt vmcnt(12)
    ds_read_b64_tr_b16 a[16:17], v6 offset:49152
    ds_read_b64_tr_b16 a[18:19], v6 offset:51200
    ds_read_b64_tr_b16 a[20:21], v7 offset:49152
    ds_read_b64_tr_b16 a[22:23], v7 offset:51200
    v_pk_mul_f32 v[48:49], v[40:41], v[40:41]
    v_pk_mul_f32 v[50:51], v[42:43], v[42:43]
    v_pk_mul_f32 v[52:53], v[44:45], v[44:45]
    v_pk_mul_f32 v[54:55], v[46:47], v[46:47]
    ds_read_b64_tr_b16 a[24:25], v6 offset:49408
    ds_read_b64_tr_b16 a[26:27], v6 offset:51456
    ds_read_b64_tr_b16 a[28:29], v7 offset:49408
    ds_read_b64_tr_b16 a[30:31], v7 offset:51456
    s_add_u32 s57, s57, 31744
    buffer_load_dwordx4 v12, s[20:23], s57 offen offset:2048 lds
    v_pk_fma_f32 v[48:49], v[48:49], v[236:237], v[236:237] op_sel:[0,0,1] op_sel_hi:[1,0,1]
    v_pk_fma_f32 v[50:51], v[50:51], v[236:237], v[236:237] op_sel:[0,0,1] op_sel_hi:[1,0,1]
    v_pk_fma_f32 v[52:53], v[52:53], v[236:237], v[236:237] op_sel:[0,0,1] op_sel_hi:[1,0,1]
    v_pk_fma_f32 v[54:55], v[54:55], v[236:237], v[236:237] op_sel:[0,0,1] op_sel_hi:[1,0,1]
    v_pk_mul_f32 v[48:49], v[48:49], v[40:41]
    v_pk_mul_f32 v[50:51], v[50:51], v[42:43]
    v_pk_mul_f32 v[52:53], v[52:53], v[44:45]
    v_pk_mul_f32 v[54:55], v[54:55], v[46:47]
    s_add_u32 s57, s57, 31744
    buffer_load_dwordx4 v12, s[20:23], s57 offen offset:3072 lds
    v_exp_f32 v48, v48
    v_exp_f32 v49, v49
    v_exp_f32 v50, v50
    v_exp_f32 v51, v51
    v_exp_f32 v52, v52
    v_exp_f32 v53, v53
    v_exp_f32 v54, v54
    v_exp_f32 v55, v55
    v_pk_add_f32 v[48:49], v[48:49], 1.0 op_sel_hi:[1,0]
    v_pk_add_f32 v[50:51], v[50:51], 1.0 op_sel_hi:[1,0]
    v_pk_add_f32 v[52:53], v[52:53], 1.0 op_sel_hi:[1,0]
    v_pk_add_f32 v[54:55], v[54:55], 1.0 op_sel_hi:[1,0]
    s_add_u32 m0, s52, 49152
    s_lshl_b32 s57, s78, 7
    s_add_u32 s57, s57, 131072
    buffer_load_dwordx4 v12, s[20:23], s57 offen offset:0 lds
    v_rcp_f32 v48, v48
    v_rcp_f32 v49, v49
    v_rcp_f32 v50, v50
    v_rcp_f32 v51, v51
    v_rcp_f32 v52, v52
    v_rcp_f32 v53, v53
    v_rcp_f32 v54, v54
    v_rcp_f32 v55, v55
    s_add_u32 s57, s57, 31744
    buffer_load_dwordx4 v12, s[20:23], s57 offen offset:1024 lds
    s_waitcnt vmcnt(11)
    ds_read_b64_tr_b16 a[32:33], v8 offset:0
    ds_read_b64_tr_b16 a[34:35], v8 offset:2048
    ds_read_b64_tr_b16 a[36:37], v9 offset:0
    ds_read_b64_tr_b16 a[38:39], v9 offset:2048
    v_pk_mul_f32 v[48:49], v[48:49], v[40:41]
    v_pk_mul_f32 v[50:51], v[50:51], v[42:43]
    v_pk_mul_f32 v[52:53], v[52:53], v[44:45]
    v_pk_mul_f32 v[54:55], v[54:55], v[46:47]
    ds_read_b64_tr_b16 a[40:41], v8 offset:256
    ds_read_b64_tr_b16 a[42:43], v8 offset:2304
    ds_read_b64_tr_b16 a[44:45], v9 offset:256
    ds_read_b64_tr_b16 a[46:47], v9 offset:2304
    s_add_u32 s57, s57, 31744
    buffer_load_dwordx4 v12, s[20:23], s57 offen offset:2048 lds
    v_cvt_pk_bf16_f32 v60, v48, v49
    v_cvt_pk_bf16_f32 v61, v50, v51
    v_cvt_pk_bf16_f32 v62, v52, v53
    v_cvt_pk_bf16_f32 v63, v54, v55
    buffer_store_dwordx4 v[60:63], v23, s[24:27], s67 offen offset:1024 sc1
    s_add_u32 s57, s57, 31744
    buffer_load_dwordx4 v12, s[20:23], s57 offen offset:3072 lds
    s_add_u32 m0, s52, 65536
    s_lshl_b32 s57, s79, 7
    buffer_load_dwordx4 v12, s[20:23], s57 offen offset:0 lds
    s_add_u32 s57, s57, 31744
    buffer_load_dwordx4 v12, s[20:23], s57 offen offset:1024 lds
    s_waitcnt vmcnt(12)
    ds_read_b64_tr_b16 a[48:49], v8 offset:16384
    ds_read_b64_tr_b16 a[50:51], v8 offset:18432
    ds_read_b64_tr_b16 a[52:53], v9 offset:16384
    ds_read_b64_tr_b16 a[54:55], v9 offset:18432
    s_add_u32 s57, s57, 31744
    buffer_load_dwordx4 v12, s[20:23], s57 offen offset:2048 lds
    ds_read_b64_tr_b16 a[56:57], v8 offset:16640
    ds_read_b64_tr_b16 a[58:59], v8 offset:18688
    ds_read_b64_tr_b16 a[60:61], v9 offset:16640
    ds_read_b64_tr_b16 a[62:63], v9 offset:18688
    s_add_u32 s57, s57, 31744
    buffer_load_dwordx4 v12, s[20:23], s57 offen offset:3072 lds
    s_waitcnt lgkmcnt(15)
    s_add_u32 m0, s52, 81920
    s_lshl_b32 s57, s79, 7
    s_add_u32 s57, s57, 131072
    buffer_load_dwordx4 v12, s[20:23], s57 offen offset:0 lds
    s_add_u32 s57, s57, 31744
    buffer_load_dwordx4 v12, s[20:23], s57 offen offset:1024 lds
    s_waitcnt vmcnt(11)
    ds_read_b64_tr_b16 a[64:65], v8 offset:32768
    ds_read_b64_tr_b16 a[66:67], v8 offset:34816
    ds_read_b64_tr_b16 a[68:69], v9 offset:32768
    ds_read_b64_tr_b16 a[70:71], v9 offset:34816
    s_add_u32 s57, s57, 31744
    buffer_load_dwordx4 v12, s[20:23], s57 offen offset:2048 lds
    ds_read_b64_tr_b16 a[72:73], v8 offset:33024
    ds_read_b64_tr_b16 a[74:75], v8 offset:35072
    ds_read_b64_tr_b16 a[76:77], v9 offset:33024
    ds_read_b64_tr_b16 a[78:79], v9 offset:35072
    s_add_u32 s57, s57, 31744
    buffer_load_dwordx4 v12, s[20:23], s57 offen offset:3072 lds
    s_add_u32 m0, s52, 98304
    s_lshl_b32 s57, s80, 7
    buffer_load_dwordx4 v12, s[20:23], s57 offen offset:0 lds
    s_add_u32 s57, s57, 31744
    buffer_load_dwordx4 v12, s[20:23], s57 offen offset:1024 lds
    s_waitcnt vmcnt(10)
    ds_read_b64_tr_b16 a[80:81], v6 offset:0
    ds_read_b64_tr_b16 a[82:83], v6 offset:2048
    ds_read_b64_tr_b16 a[84:85], v7 offset:0
    ds_read_b64_tr_b16 a[86:87], v7 offset:2048
    s_add_u32 s57, s57, 31744
    buffer_load_dwordx4 v12, s[20:23], s57 offen offset:2048 lds
    ds_read_b64_tr_b16 a[88:89], v6 offset:256
    ds_read_b64_tr_b16 a[90:91], v6 offset:2304
    ds_read_b64_tr_b16 a[92:93], v7 offset:256
    ds_read_b64_tr_b16 a[94:95], v7 offset:2304
    s_barrier
    s_cmp_lg_u32 s44, 0
    s_cbranch_scc1 L_nopub6
    s_lshl_b32 s60, s51, 5
    s_add_u32 s60, s60, s50
    s_lshl_b32 s60, s60, 7
    s_add_u32 s60, s60, 12713984
    v_mov_b32 v30, s47
    s_mov_b64 exec, 1
    buffer_store_dword v30, off, s[24:27], s60 sc1
    v_mov_b32 v29, 0
    s_lshl_b32 s60, s2, 8
    buffer_store_dword v29, off, s[40:43], s60 sc1
    s_mov_b64 exec, -1
L_nopub6:
L_p3join:
    s_add_u32 s57, s57, 31744
    buffer_load_dwordx4 v12, s[20:23], s57 offen offset:3072 lds
    v_lshlrev_b32 v228, 16, v228
    v_lshlrev_b32 v32, 16, v216
    v_and_b32 v33, s61, v216
    v_lshlrev_b32 v34, 16, v217
    s_waitcnt lgkmcnt(15)
    s_add_u32 m0, s52, 114688
    s_lshl_b32 s57, s80, 7
    s_add_u32 s57, s57, 131072
    buffer_load_dwordx4 v12, s[20:23], s57 offen offset:0 lds
    v_and_b32 v35, s61, v217
    v_add_f32 v32, v32, v228
    v_add_f32 v33, v33, v228
    v_add_f32 v34, v34, v228
    s_add_u32 s57, s57, 31744
    buffer_load_dwordx4 v12, s[20:23], s57 offen offset:1024 lds
    s_waitcnt vmcnt(10)
    ds_read_b64_tr_b16 a[96:97], v6 offset:16384
    ds_read_b64_tr_b16 a[98:99], v6 offset:18432
    ds_read_b64_tr_b16 a[100:101], v7 offset:16384
    ds_read_b64_tr_b16 a[102:103], v7 offset:18432
    v_add_f32 v35, v35, v228
    v_lshlrev_b32 v48, 16, v218
    v_and_b32 v49, s61, v218
    v_lshlrev_b32 v50, 16, v219
    ds_read_b64_tr_b16 a[104:105], v6 offset:16640
    ds_read_b64_tr_b16 a[106:107], v6 offset:18688
    ds_read_b64_tr_b16 a[108:109], v7 offset:16640
    ds_read_b64_tr_b16 a[110:111], v7 offset:18688
    s_add_u32 s57, s57, 31744
    buffer_load_dwordx4 v12, s[20:23], s57 offen offset:2048 lds
    v_and_b32 v51, s61, v219
    v_add_f32 v48, v48, v228
    v_add_f32 v49, v49, v228
    v_add_f32 v50, v50, v228
    s_add_u32 s57, s57, 31744
    buffer_load_dwordx4 v12, s[20:23], s57 offen offset:3072 lds
    v_add_f32 v51, v51, v228
    v_lshlrev_b32 v64, 16, v220
    v_and_b32 v65, s61, v220
    v_lshlrev_b32 v66, 16, v221
    s_add_u32 m0, s52, 131072
    s_lshl_b32 s57, s81, 7
    buffer_load_dwordx4 v12, s[20:23], s57 offen offset:0 lds
    v_and_b32 v67, s61, v221
    v_add_f32 v64, v64, v228
    v_add_f32 v65, v65, v228
    v_add_f32 v66, v66, v228
    v_add_f32 v67, v67, v228
    v_lshlrev_b32 v80, 16, v222
    v_and_b32 v81, s61, v222
    v_lshlrev_b32 v82, 16, v223
    s_add_u32 s57, s57, 31744
    buffer_load_dwordx4 v12, s[20:23], s57 offen offset:1024 lds
    s_waitcnt vmcnt(10)
    ds_read_b64_tr_b16 a[112:113], v6 offset:32768
    ds_read_b64_tr_b16 a[114:115], v6 offset:34816
    ds_read_b64_tr_b16 a[116:117], v7 offset:32768
    ds_read_b64_tr_b16 a[118:119], v7 offset:34816
    s_add_u32 s57, s57, 31744
    buffer_load_dwordx4 v12, s[20:23], s57 offen offset:2048 lds
    ds_read_b64_tr_b16 a[120:121], v6 offset:33024
    ds_read_b64_tr_b16 a[122:123], v6 offset:35072
    ds_read_b64_tr_b16 a[124:125], v7 offset:33024
    ds_read_b64_tr_b16 a[126:127], v7 offset:35072
    s_add_u32 s57, s57, 31744
    buffer_load_dwordx4 v12, s[20:23], s57 offen offset:3072 lds
    v_and_b32 v83, s61, v223
    v_add_f32 v80, v80, v228
    v_add_f32 v81, v81, v228
    v_add_f32 v82, v82, v228
    v_add_f32 v83, v83, v228
    v_lshlrev_b32 v96, 16, v224
    v_and_b32 v97, s61, v224
    v_lshlrev_b32 v98, 16, v225
    s_waitcnt lgkmcnt(15)
    s_add_u32 m0, s52, 147456
    s_lshl_b32 s57, s81, 7
    s_add_u32 s57, s57, 131072
    buffer_load_dwordx4 v12, s[20:23], s57 offen offset:0 lds
    v_and_b32 v99, s61, v225
    v_add_f32 v96, v96, v228
    v_add_f32 v97, v97, v228
    v_add_f32 v98, v98, v228
    s_add_u32 s57, s57, 31744
    buffer_load_dwordx4 v12, s[20:23], s57 offen offset:1024 lds
    s_waitcnt vmcnt(10)
    ds_read_b64_tr_b16 a[128:129], v6 offset:49152
    ds_read_b64_tr_b16 a[130:131], v6 offset:51200
    ds_read_b64_tr_b16 a[132:133], v7 offset:49152
    ds_read_b64_tr_b16 a[134:135], v7 offset:51200
    s_add_u32 s57, s57, 31744
    buffer_load_dwordx4 v12, s[20:23], s57 offen offset:2048 lds
    ds_read_b64_tr_b16 a[136:137], v6 offset:49408
    ds_read_b64_tr_b16 a[138:139], v6 offset:51456
    ds_read_b64_tr_b16 a[140:141], v7 offset:49408
    ds_read_b64_tr_b16 a[142:143], v7 offset:51456
    v_add_f32 v99, v99, v228
    s_add_u32 s57, s57, 31744
    buffer_load_dwordx4 v12, s[20:23], s57 offen offset:3072 lds
    s_add_u32 m0, s52, 49152
    s_lshl_b32 s57, s82, 7
    buffer_load_dwordx4 v12, s[20:23], s57 offen offset:0 lds
    s_add_u32 s57, s57, 31744
    buffer_load_dwordx4 v12, s[20:23], s57 offen offset:1024 lds
    s_waitcnt vmcnt(10)
    ds_read_b64_tr_b16 a[144:145], v8 offset:0
    ds_read_b64_tr_b16 a[146:147], v8 offset:2048
    ds_read_b64_tr_b16 a[148:149], v9 offset:0
    ds_read_b64_tr_b16 a[150:151], v9 offset:2048
    s_add_u32 s57, s57, 31744
    buffer_load_dwordx4 v12, s[20:23], s57 offen offset:2048 lds
    ds_read_b64_tr_b16 a[152:153], v8 offset:256
    ds_read_b64_tr_b16 a[154:155], v8 offset:2304
    ds_read_b64_tr_b16 a[156:157], v9 offset:256
    ds_read_b64_tr_b16 a[158:159], v9 offset:2304
    s_add_u32 s57, s57, 31744
    buffer_load_dwordx4 v12, s[20:23], s57 offen offset:3072 lds
    s_waitcnt lgkmcnt(15)
    s_add_u32 m0, s52, 65536
    s_lshl_b32 s57, s82, 7
    s_add_u32 s57, s57, 131072
    buffer_load_dwordx4 v12, s[20:23], s57 offen offset:0 lds
    s_add_u32 s57, s57, 31744
    buffer_load_dwordx4 v12, s[20:23], s57 offen offset:1024 lds
    s_waitcnt vmcnt(10)
    ds_read_b64_tr_b16 a[160:161], v8 offset:16384
    ds_read_b64_tr_b16 a[162:163], v8 offset:18432
    ds_read_b64_tr_b16 a[164:165], v9 offset:16384
    ds_read_b64_tr_b16 a[166:167], v9 offset:18432
    s_add_u32 s57, s57, 31744
    buffer_load_dwordx4 v12, s[20:23], s57 offen offset:2048 lds
    ds_read_b64_tr_b16 a[168:169], v8 offset:16640
    ds_read_b64_tr_b16 a[170:171], v8 offset:18688
    ds_read_b64_tr_b16 a[172:173], v9 offset:16640
    ds_read_b64_tr_b16 a[174:175], v9 offset:18688
    s_add_u32 s57, s57, 31744
    buffer_load_dwordx4 v12, s[20:23], s57 offen offset:3072 lds
    s_add_u32 m0, s52, 81920
    s_mov_b32 s57, s75
    buffer_load_dwordx4 v15, s[12:15], s57 offen offset:0 lds
    s_add_u32 s57, s57, 113664
    buffer_load_dwordx4 v15, s[12:15], s57 offen offset:1024 lds
    s_waitcnt vmcnt(10)
    ds_read_b64_tr_b16 a[176:177], v8 offset:32768
    ds_read_b64_tr_b16 a[178:179], v8 offset:34816
    ds_read_b64_tr_b16 a[180:181], v9 offset:32768
    ds_read_b64_tr_b16 a[182:183], v9 offset:34816
    s_add_u32 s57, s57, 113664
    buffer_load_dwordx4 v15, s[12:15], s57 offen offset:2048 lds
    ds_read_b64_tr_b16 a[184:185], v8 offset:33024
    ds_read_b64_tr_b16 a[186:187], v8 offset:35072
    ds_read_b64_tr_b16 a[188:189], v9 offset:33024
    ds_read_b64_tr_b16 a[190:191], v9 offset:35072
    s_add_u32 s57, s57, 113664
    buffer_load_dwordx4 v15, s[12:15], s57 offen offset:3072 lds
    s_waitcnt lgkmcnt(15)
    s_add_u32 m0, s52, 98304
    s_mov_b32 s57, 0
    buffer_load_dwordx4 v13, s[12:15], s57 offen offset:0 lds
    s_add_u32 s57, s57, 6144
    buffer_load_dwordx4 v14, s[12:15], s57 offen offset:1024 lds
    s_waitcnt vmcnt(10)
    ds_read_b64_tr_b16 a[192:193], v6 offset:0
    ds_read_b64_tr_b16 a[194:195], v6 offset:2048
    ds_read_b64_tr_b16 a[196:197], v7 offset:0
    ds_read_b64_tr_b16 a[198:199], v7 offset:2048
    s_add_u32 s57, s57, 6144
    buffer_load_dwordx4 v13, s[12:15], s57 offen offset:2048 lds
    ds_read_b64_tr_b16 a[200:201], v6 offset:256
    ds_read_b64_tr_b16 a[202:203], v6 offset:2304
    ds_read_b64_tr_b16 a[204:205], v7 offset:256
L_wb_2:
    s_cbranch_execz L_wb_ret
    ds_read_b64_tr_b16 a[206:207], v7 offset:2304
    s_add_u32 s57, s57, 6144
    buffer_load_dwordx4 v14, s[12:15], s57 offen offset:3072 lds
    buffer_load_dword v17, v20, s[24:27], 0 offen sc1
    s_add_u32 m0, s52, 114688
    s_mov_b32 s57, 114688
    buffer_load_dwordx4 v13, s[12:15], s57 offen offset:0 lds
    s_waitcnt vmcnt(10)
    ds_read_b64_tr_b16 a[208:209], v6 offset:16384
    ds_read_b64_tr_b16 a[210:211], v6 offset:18432
    ds_read_b64_tr_b16 a[212:213], v7 offset:16384
    ds_read_b64_tr_b16 a[214:215], v7 offset:18432
    s_add_u32 s57, s57, 6144
    buffer_load_dwordx4 v14, s[12:15], s57 offen offset:1024 lds
    ds_read_b64_tr_b16 a[216:217], v6 offset:16640
    ds_read_b64_tr_b16 a[218:219], v6 offset:18688
    ds_read_b64_tr_b16 a[220:221], v7 offset:16640
    ds_read_b64_tr_b16 a[222:223], v7 offset:18688
    s_add_u32 s57, s57, 6144
    buffer_load_dwordx4 v13, s[12:15], s57 offen offset:2048 lds
    s_add_u32 s57, s57, 6144
    buffer_load_dwordx4 v14, s[12:15], s57 offen offset:3072 lds
    s_waitcnt lgkmcnt(15)
    s_add_u32 m0, s52, 131072
    s_mov_b32 s57, 229376
    buffer_load_dwordx4 v13, s[12:15], s57 offen offset:0 lds
    s_add_u32 s57, s57, 6144
    buffer_load_dwordx4 v14, s[12:15], s57 offen offset:1024 lds
    s_add_u32 s57, s57, 6144
    buffer_load_dwordx4 v13, s[12:15], s57 offen offset:2048 lds
    s_add_u32 s57, s57, 6144
    buffer_load_dwordx4 v14, s[12:15], s57 offen offset:3072 lds
    s_add_u32 m0, s52, 147456
    s_mov_b32 s57, 344064
    buffer_load_dwordx4 v239, s[12:15], s57 offen offset:0 lds
    s_add_u32 s57, s57, 27648
    buffer_load_dwordx4 v239, s[12:15], s57 offen offset:1024 lds
    s_waitcnt vmcnt(10)
    v_cmp_ne_u32 vcc, s47, v17
    s_nop 0
    s_cbranch_vccz L_ok8
    s_mov_b32 s59, 100000
L_spin7:
    buffer_load_dword v17, v20, s[24:27], 0 offen sc1
    s_waitcnt vmcnt(0)
    v_cmp_ne_u32 vcc, s47, v17
    s_nop 0
    s_cbranch_vccz L_ok8
    s_sub_u32 s59, s59, 1
    s_cbranch_scc0 L_spin7
L_ok8:
    s_cmp_ge_u32 s89, 4
    s_cbranch_scc1 L_p3_alt
    s_mov_b32 s66, s68
    s_add_u32 s58, s66, s76
    buffer_load_dwordx4 v[144:147], v23, s[24:27], s58 offen offset:0 sc1
    buffer_load_dwordx4 v[148:151], v23, s[24:27], s58 offen offset:1024 sc1
    s_add_u32 s58, s66, s77
    buffer_load_dwordx4 v[152:155], v23, s[24:27], s58 offen offset:0 sc1
    buffer_load_dwordx4 v[156:159], v23, s[24:27], s58 offen offset:1024 sc1
    s_add_u32 s58, s66, s78
    buffer_load_dwordx4 v[112:115], v23, s[24:27], s58 offen offset:0 sc1
    buffer_load_dwordx4 v[116:119], v23, s[24:27], s58 offen offset:1024 sc1
    s_add_u32 s58, s66, s79
    buffer_load_dwordx4 v[120:123], v23, s[24:27], s58 offen offset:0 sc1
    buffer_load_dwordx4 v[124:127], v23, s[24:27], s58 offen offset:1024 sc1
    s_add_u32 s58, s66, s80
    buffer_load_dwordx4 v[128:131], v23, s[24:27], s58 offen offset:0 sc1
    buffer_load_dwordx4 v[132:135], v23, s[24:27], s58 offen offset:1024 sc1
    s_add_u32 s58, s66, s81
    buffer_load_dwordx4 v[136:139], v23, s[24:27], s58 offen offset:0 sc1
    s_waitcnt vmcnt(10)
    v_mfma_f32_16x16x32_bf16 v[96:99], v[144:147], a[0:3], v[96:99]
    v_mfma_f32_16x16x32_bf16 v[100:103], v[144:147], a[4:7], 0
    buffer_load_dwordx4 v[140:143], v23, s[24:27], s58 offen offset:1024 sc1
    v_mfma_f32_16x16x32_bf16 v[104:107], v[144:147], a[8:11], 0
    v_mfma_f32_16x16x32_bf16 v[108:111], v[144:147], a[12:15], 0
    s_waitcnt vmcnt(10)
    v_mfma_f32_16x16x32_bf16 v[96:99], v[148:151], a[16:19], v[96:99]
    s_add_u32 s58, s66, s82
    v_mfma_f32_16x16x32_bf16 v[100:103], v[148:151], a[20:23], v[100:103]
    buffer_load_dwordx4 v[144:147], v23, s[24:27], s58 offen offset:0 sc1
    v_mfma_f32_16x16x32_bf16 v[104:107], v[148:151], a[24:27], v[104:107]
    v_mfma_f32_16x16x32_bf16 v[108:111], v[148:151], a[28:31], v[108:111]
    s_waitcnt vmcnt(10)
    v_mfma_f32_16x16x32_bf16 v[96:99], v[152:155], a[32:35], v[96:99]
    v_mfma_f32_16x16x32_bf16 v[100:103], v[152:155], a[36:39], v[100:103]
    buffer_load_dwordx4 v[148:151], v23, s[24:27], s58 offen offset:1024 sc1
    v_mfma_f32_16x16x32_bf16 v[104:107], v[152:155], a[40:43], v[104:107]
    v_mfma_f32_16x16x32_bf16 v[108:111], v[152:155], a[44:47], v[108:111]
    s_waitcnt vmcnt(10)
    v_mfma_f32_16x16x32_bf16 v[96:99], v[156:159], a[48:51], v[96:99]
    s_add_u32 s66, s69, 175872
    s_add_u32 s58, s66, s76
    v_mfma_f32_16x16x32_bf16 v[100:103], v[156:159], a[52:55], v[100:103]
    buffer_load_dwordx4 v[152:155], v23, s[24:27], s58 offen offset:0 sc1
    v_mfma_f32_16x16x32_bf16 v[104:107], v[156:159], a[56:59], v[104:107]
    v_mfma_f32_16x16x32_bf16 v[108:111], v[156:159], a[60:63], v[108:111]
    s_waitcnt vmcnt(10)
    v_mfma_f32_16x16x32_bf16 v[96:99], v[112:115], a[64:67], v[96:99]
    v_mfma_f32_16x16x32_bf16 v[100:103], v[112:115], a[68:71], v[100:103]
    buffer_load_dwordx4 v[156:159], v23, s[24:27], s58 offen offset:1024 sc1
    v_mfma_f32_16x16x32_bf16 v[104:107], v[112:115], a[72:75], v[104:107]
    v_mfma_f32_16x16x32_bf16 v[108:111], v[112:115], a[76:79], v[108:111]
    s_waitcnt vmcnt(10)
    v_mfma_f32_16x16x32_bf16 v[96:99], v[116:119], a[80:83], v[96:99]
    s_add_u32 s58, s66, s77
    v_mfma_f32_16x16x32_bf16 v[100:103], v[116:119], a[84:87], v[100:103]
    buffer_load_dwordx4 v[112:115], v23, s[24:27], s58 offen offset:0 sc1
    v_mfma_f32_16x16x32_bf16 v[104:107], v[116:119], a[88:91], v[104:107]
    v_mfma_f32_16x16x32_bf16 v[108:111], v[116:119], a[92:95], v[108:111]
    s_waitcnt vmcnt(10)
    v_mfma_f32_16x16x32_bf16 v[96:99], v[120:123], a[96:99], v[96:99]
    v_mfma_f32_16x16x32_bf16 v[100:103], v[120:123], a[100:103], v[100:103]
    buffer_load_dwordx4 v[116:119], v23, s[24:27], s58 offen offset:1024 sc1
    v_mfma_f32_16x16x32_bf16 v[104:107], v[120:123], a[104:107], v[104:107]
    v_mfma_f32_16x16x32_bf16 v[108:111], v[120:123], a[108:111], v[108:111]
    s_waitcnt vmcnt(10)
    v_mfma_f32_16x16x32_bf16 v[96:99], v[124:127], a[112:115], v[96:99]
    s_add_u32 s58, s66, s78
    v_mfma_f32_16x16x32_bf16 v[100:103], v[124:127], a[116:119], v[100:103]
    buffer_load_dwordx4 v[120:123], v23, s[24:27], s58 offen offset:0 sc1
    v_mfma_f32_16x16x32_bf16 v[104:107], v[124:127], a[120:123], v[104:107]
    v_mfma_f32_16x16x32_bf16 v[108:111], v[124:127], a[124:127], v[108:111]
    s_waitcnt vmcnt(10)
    v_mfma_f32_16x16x32_bf16 v[96:99], v[128:131], a[128:131], v[96:99]
    v_mfma_f32_16x16x32_bf16 v[100:103], v[128:131], a[132:135], v[100:103]
    buffer_load_dwordx4 v[124:127], v23, s[24:27], s58 offen offset:1024 sc1
    v_mfma_f32_16x16x32_bf16 v[104:107], v[128:131], a[136:139], v[104:107]
    v_mfma_f32_16x16x32_bf16 v[108:111], v[128:131], a[140:143], v[108:111]
    s_waitcnt vmcnt(10)
    v_mfma_f32_16x16x32_bf16 v[96:99], v[132:135], a[144:147], v[96:99]
    s_add_u32 s58, s66, s79
    v_mfma_f32_16x16x32_bf16 v[100:103], v[132:135], a[148:151], v[100:103]
    buffer_load_dwordx4 v[128:131], v23, s[24:27], s58 offen offset:0 sc1
    v_mfma_f32_16x16x32_bf16 v[104:107], v[132:135], a[152:155], v[104:107]
    v_mfma_f32_16x16x32_bf16 v[108:111], v[132:135], a[156:159], v[108:111]
    s_waitcnt vmcnt(10)
    v_mfma_f32_16x16x32_bf16 v[96:99], v[136:139], a[160:163], v[96:99]
    v_mfma_f32_16x16x32_bf16 v[100:103], v[136:139], a[164:167], v[100:103]
    buffer_load_dwordx4 v[132:135], v23, s[24:27], s58 offen offset:1024 sc1
    v_mfma_f32_16x16x32_bf16 v[104:107], v[136:139], a[168:171], v[104:107]
    v_mfma_f32_16x16x32_bf16 v[108:111], v[136:139], a[172:175], v[108:111]
    s_waitcnt vmcnt(10)
    v_mfma_f32_16x16x32_bf16 v[96:99], v[140:143], a[176:179], v[96:99]
    s_add_u32 s58, s66, s80
    v_mfma_f32_16x16x32_bf16 v[100:103], v[140:143], a[180:183], v[100:103]
    buffer_load_dwordx4 v[136:139], v23, s[24:27], s58 offen offset:0 sc1
    v_mfma_f32_16x16x32_bf16 v[104:107], v[140:143], a[184:187], v[104:107]
    v_mfma_f32_16x16x32_bf16 v[108:111], v[140:143], a[188:191], v[108:111]
    s_waitcnt vmcnt(10)
    s_waitcnt lgkmcnt(8)
    v_mfma_f32_16x16x32_bf16 v[96:99], v[144:147], a[192:195], v[96:99]
    v_mfma_f32_16x16x32_bf16 v[100:103], v[144:147], a[196:199], v[100:103]
    buffer_load_dwordx4 v[140:143], v23, s[24:27], s58 offen offset:1024 sc1
    v_mfma_f32_16x16x32_bf16 v[104:107], v[144:147], a[200:203], v[104:107]
    v_mfma_f32_16x16x32_bf16 v[108:111], v[144:147], a[204:207], v[108:111]
    s_waitcnt vmcnt(10)
    s_waitcnt lgkmcnt(0)
    v_mfma_f32_16x16x32_bf16 v[96:99], v[148:151], a[208:211], v[96:99]
    s_add_u32 s58, s66, s81
    v_mfma_f32_16x16x32_bf16 v[100:103], v[148:151], a[212:215], v[100:103]
    buffer_load_dwordx4 v[144:147], v23, s[24:27], s58 offen offset:0 sc1
    v_mfma_f32_16x16x32_bf16 v[104:107], v[148:151], a[216:219], v[104:107]
    v_mfma_f32_16x16x32_bf16 v[108:111], v[148:151], a[220:223], v[108:111]
L_p3_join:
    s_waitcnt vmcnt(10)
    v_mfma_f32_16x16x32_bf16 v[80:83], v[152:155], a[0:3], v[80:83]
    v_mfma_f32_16x16x32_bf16 v[84:87], v[152:155], a[4:7], 0
    buffer_load_dwordx4 v[148:151], v23, s[24:27], s58 offen offset:1024 sc1
    v_mfma_f32_16x16x32_bf16 v[88:91], v[152:155], a[8:11], 0
    v_mfma_f32_16x16x32_bf16 v[92:95], v[152:155], a[12:15], 0
    s_waitcnt vmcnt(10)
    v_mfma_f32_16x16x32_bf16 v[80:83], v[156:159], a[16:19], v[80:83]
    s_add_u32 s58, s66, s82
    v_mfma_f32_16x16x32_bf16 v[84:87], v[156:159], a[20:23], v[84:87]
    buffer_load_dwordx4 v[152:155], v23, s[24:27], s58 offen offset:0 sc1
    v_mfma_f32_16x16x32_bf16 v[88:91], v[156:159], a[24:27], v[88:91]
    ds_write_b128 v232, v[100:103] offset:3072
    v_mfma_f32_16x16x32_bf16 v[92:95], v[156:159], a[28:31], v[92:95]
    s_waitcnt vmcnt(10)
    v_mfma_f32_16x16x32_bf16 v[80:83], v[112:115], a[32:35], v[80:83]
    v_mfma_f32_16x16x32_bf16 v[84:87], v[112:115], a[36:39], v[84:87]
    buffer_load_dwordx4 v[156:159], v23, s[24:27], s58 offen offset:1024 sc1
    v_mfma_f32_16x16x32_bf16 v[88:91], v[112:115], a[40:43], v[88:91]
    ds_write_b128 v232, v[104:107] offset:19456
    v_mfma_f32_16x16x32_bf16 v[92:95], v[112:115], a[44:47], v[92:95]
    s_waitcnt vmcnt(10)
    v_mfma_f32_16x16x32_bf16 v[80:83], v[116:119], a[48:51], v[80:83]
    s_add_u32 s66, s69, 117248
    s_add_u32 s58, s66, s76
    v_mfma_f32_16x16x32_bf16 v[84:87], v[116:119], a[52:55], v[84:87]
    buffer_load_dwordx4 v[112:115], v23, s[24:27], s58 offen offset:0 sc1
    v_mfma_f32_16x16x32_bf16 v[88:91], v[116:119], a[56:59], v[88:91]
    ds_write_b128 v232, v[108:111] offset:35840
    v_mfma_f32_16x16x32_bf16 v[92:95], v[116:119], a[60:63], v[92:95]
    s_waitcnt vmcnt(10)
    v_mfma_f32_16x16x32_bf16 v[80:83], v[120:123], a[64:67], v[80:83]
    v_mfma_f32_16x16x32_bf16 v[84:87], v[120:123], a[68:71], v[84:87]
    buffer_load_dwordx4 v[116:119], v23, s[24:27], s58 offen offset:1024 sc1
    v_mfma_f32_16x16x32_bf16 v[88:91], v[120:123], a[72:75], v[88:91]
    v_mfma_f32_16x16x32_bf16 v[92:95], v[120:123], a[76:79], v[92:95]
    s_waitcnt vmcnt(10)
    v_mfma_f32_16x16x32_bf16 v[80:83], v[124:127], a[80:83], v[80:83]
    s_add_u32 s58, s66, s77
    v_mfma_f32_16x16x32_bf16 v[84:87], v[124:127], a[84:87], v[84:87]
    buffer_load_dwordx4 v[120:123], v23, s[24:27], s58 offen offset:0 sc1
    v_mfma_f32_16x16x32_bf16 v[88:91], v[124:127], a[88:91], v[88:91]
    s_waitcnt lgkmcnt(0)
    s_barrier
    v_mfma_f32_16x16x32_bf16 v[92:95], v[124:127], a[92:95], v[92:95]
    s_waitcnt vmcnt(10)
    v_mfma_f32_16x16x32_bf16 v[80:83], v[128:131], a[96:99], v[80:83]
    v_mfma_f32_16x16x32_bf16 v[84:87], v[128:131], a[100:103], v[84:87]
    buffer_load_dwordx4 v[124:127], v23, s[24:27], s58 offen offset:1024 sc1
    v_mfma_f32_16x16x32_bf16 v[88:91], v[128:131], a[104:107], v[88:91]
    ds_read_b128 v[100:103], v233 offset:3072
    ds_read_b128 v[104:107], v234 offset:19456
    v_mfma_f32_16x16x32_bf16 v[92:95], v[128:131], a[108:111], v[92:95]
    ds_read_b128 v[108:111], v235 offset:35840
    s_waitcnt vmcnt(10)
    v_mfma_f32_16x16x32_bf16 v[80:83], v[132:135], a[112:115], v[80:83]
    s_add_u32 s58, s66, s78
    v_mfma_f32_16x16x32_bf16 v[84:87], v[132:135], a[116:119], v[84:87]
    buffer_load_dwordx4 v[128:131], v23, s[24:27], s58 offen offset:0 sc1
    v_mfma_f32_16x16x32_bf16 v[88:91], v[132:135], a[120:123], v[88:91]
    ds_read_b64_tr_b16 v[160:161], v16 offset:0
    v_mfma_f32_16x16x32_bf16 v[92:95], v[132:135], a[124:127], v[92:95]
    ds_read_b64_tr_b16 v[162:163], v16 offset:512
    s_waitcnt vmcnt(10)
    v_mfma_f32_16x16x32_bf16 v[80:83], v[136:139], a[128:131], v[80:83]
    s_waitcnt lgkmcnt(2)
    v_mfma_f32_16x16x32_bf16 v[84:87], v[136:139], a[132:135], v[84:87]
    buffer_load_dwordx4 v[132:135], v23, s[24:27], s58 offen offset:1024 sc1
    v_mfma_f32_16x16x32_bf16 v[88:91], v[136:139], a[136:139], v[88:91]
    v_add_f32 v96, v96, v100
    v_add_f32 v97, v97, v101
    ds_read_b64_tr_b16 v[164:165], v16 offset:4096
    v_mfma_f32_16x16x32_bf16 v[92:95], v[136:139], a[140:143], v[92:95]
    ds_read_b64_tr_b16 v[166:167], v16 offset:4608
    s_waitcnt vmcnt(10)
    v_mfma_f32_16x16x32_bf16 v[80:83], v[140:143], a[144:147], v[80:83]
    s_add_u32 s58, s66, s79
    v_add_f32 v98, v98, v102
    v_mfma_f32_16x16x32_bf16 v[84:87], v[140:143], a[148:151], v[84:87]
    buffer_load_dwordx4 v[136:139], v23, s[24:27], s58 offen offset:0 sc1
    v_mfma_f32_16x16x32_bf16 v[88:91], v[140:143], a[152:155], v[88:91]
    v_add_f32 v99, v99, v103
    v_add_f32 v96, v96, v104
    ds_read_b64_tr_b16 v[168:169], v16 offset:8192
    v_mfma_f32_16x16x32_bf16 v[92:95], v[140:143], a[156:159], v[92:95]
    ds_read_b64_tr_b16 v[170:171], v16 offset:8704
    s_waitcnt vmcnt(10)
    v_mfma_f32_16x16x32_bf16 v[80:83], v[144:147], a[160:163], v[80:83]
    v_add_f32 v97, v97, v105
    v_mfma_f32_16x16x32_bf16 v[84:87], v[144:147], a[164:167], v[84:87]
    buffer_load_dwordx4 v[140:143], v23, s[24:27], s58 offen offset:1024 sc1
    v_mfma_f32_16x16x32_bf16 v[88:91], v[144:147], a[168:171], v[88:91]
    v_add_f32 v98, v98, v106
    v_add_f32 v99, v99, v107
    ds_read_b64_tr_b16 v[172:173], v16 offset:12288
    v_mfma_f32_16x16x32_bf16 v[92:95], v[144:147], a[172:175], v[92:95]
    ds_read_b64_tr_b16 v[174:175], v16 offset:12800
    s_waitcnt vmcnt(10)
    v_mfma_f32_16x16x32_bf16 v[80:83], v[148:151], a[176:179], v[80:83]
    s_add_u32 s58, s66, s80
    v_mfma_f32_16x16x32_bf16 v[84:87], v[148:151], a[180:183], v[84:87]
    buffer_load_dwordx4 v[144:147], v23, s[24:27], s58 offen offset:0 sc1
    v_mfma_f32_16x16x32_bf16 v[88:91], v[148:151], a[184:187], v[88:91]
    v_add_f32 v96, v96, v108
    v_add_f32 v97, v97, v109
    v_mfma_f32_16x16x32_bf16 v[92:95], v[148:151], a[188:191], v[92:95]
    v_add_f32 v98, v98, v110
    s_waitcnt vmcnt(10)
    v_mfma_f32_16x16x32_bf16 v[80:83], v[152:155], a[192:195], v[80:83]
    v_mfma_f32_16x16x32_bf16 v[84:87], v[152:155], a[196:199], v[84:87]
    buffer_load_dwordx4 v[148:151], v23, s[24:27], s58 offen offset:1024 sc1
    v_mfma_f32_16x16x32_bf16 v[88:91], v[152:155], a[200:203], v[88:91]
    v_add_f32 v99, v99, v111
    v_mfma_f32_16x16x32_bf16 v[92:95], v[152:155], a[204:207], v[92:95]
    s_waitcnt vmcnt(10)
    v_mfma_f32_16x16x32_bf16 v[80:83], v[156:159], a[208:211], v[80:83]
    s_add_u32 s58, s66, s81
    v_mfma_f32_16x16x32_bf16 v[84:87], v[156:159], a[212:215], v[84:87]
    buffer_load_dwordx4 v[152:155], v23, s[24:27], s58 offen offset:0 sc1
    v_mfma_f32_16x16x32_bf16 v[88:91], v[156:159], a[216:219], v[88:91]
    v_mfma_f32_16x16x32_bf16 v[92:95], v[156:159], a[220:223], v[92:95]
    s_waitcnt vmcnt(10)
    v_mfma_f32_16x16x32_bf16 v[64:67], v[112:115], a[0:3], v[64:67]
    v_mfma_f32_16x16x32_bf16 v[68:71], v[112:115], a[4:7], 0
    buffer_load_dwordx4 v[156:159], v23, s[24:27], s58 offen offset:1024 sc1
    v_mfma_f32_16x16x32_bf16 v[72:75], v[112:115], a[8:11], 0
    ds_read_b64_tr_b16 v[192:193], v16 offset:1024
    v_mfma_f32_16x16x32_bf16 v[76:79], v[112:115], a[12:15], 0
    ds_read_b64_tr_b16 v[194:195], v16 offset:1536
    s_waitcnt vmcnt(10)
    v_mfma_f32_16x16x32_bf16 v[64:67], v[116:119], a[16:19], v[64:67]
    s_add_u32 s58, s66, s82
    v_mfma_f32_16x16x32_bf16 v[68:71], v[116:119], a[20:23], v[68:71]
    buffer_load_dwordx4 v[112:115], v23, s[24:27], s58 offen offset:0 sc1
    v_mfma_f32_16x16x32_bf16 v[72:75], v[116:119], a[24:27], v[72:75]
    ds_read_b64_tr_b16 v[196:197], v16 offset:5120
    ds_read_b64_tr_b16 v[198:199], v16 offset:5632
    v_mfma_f32_16x16x32_bf16 v[76:79], v[116:119], a[28:31], v[76:79]
    ds_write_b128 v232, v[84:87] offset:49152
    s_waitcnt vmcnt(10)
    v_mfma_f32_16x16x32_bf16 v[64:67], v[120:123], a[32:35], v[64:67]
    v_mfma_f32_16x16x32_bf16 v[68:71], v[120:123], a[36:39], v[68:71]
    buffer_load_dwordx4 v[116:119], v23, s[24:27], s58 offen offset:1024 sc1
    v_mfma_f32_16x16x32_bf16 v[72:75], v[120:123], a[40:43], v[72:75]
    ds_read_b64_tr_b16 v[200:201], v16 offset:9216
    ds_read_b64_tr_b16 v[202:203], v16 offset:9728
    v_mfma_f32_16x16x32_bf16 v[76:79], v[120:123], a[44:47], v[76:79]
    ds_write_b128 v232, v[88:91] offset:50176
    s_waitcnt vmcnt(10)
    v_mfma_f32_16x16x32_bf16 v[64:67], v[124:127], a[48:51], v[64:67]
    s_add_u32 s66, s69, 58624
    s_add_u32 s58, s66, s76
    v_mfma_f32_16x16x32_bf16 v[68:71], v[124:127], a[52:55], v[68:71]
    buffer_load_dwordx4 v[120:123], v23, s[24:27], s58 offen offset:0 sc1
    v_mfma_f32_16x16x32_bf16 v[72:75], v[124:127], a[56:59], v[72:75]
    ds_read_b64_tr_b16 v[204:205], v16 offset:13312
    ds_read_b64_tr_b16 v[206:207], v16 offset:13824
    v_mfma_f32_16x16x32_bf16 v[76:79], v[124:127], a[60:63], v[76:79]
    ds_write_b128 v232, v[92:95] offset:51200
    s_waitcnt vmcnt(10)
    v_mfma_f32_16x16x32_bf16 v[64:67], v[128:131], a[64:67], v[64:67]
    v_mfma_f32_16x16x32_bf16 v[68:71], v[128:131], a[68:71], v[68:71]
    buffer_load_dwordx4 v[124:127], v23, s[24:27], s58 offen offset:1024 sc1
    v_mfma_f32_16x16x32_bf16 v[72:75], v[128:131], a[72:75], v[72:75]
    ds_read_b64_tr_b16 v[100:101], v16 offset:2048
    v_mfma_f32_16x16x32_bf16 v[76:79], v[128:131], a[76:79], v[76:79]
    ds_read_b64_tr_b16 v[102:103], v16 offset:2560
    s_waitcnt vmcnt(10)
    v_mfma_f32_16x16x32_bf16 v[64:67], v[132:135], a[80:83], v[64:67]
    s_add_u32 s58, s66, s77
    v_mfma_f32_16x16x32_bf16 v[68:71], v[132:135], a[84:87], v[68:71]
    buffer_load_dwordx4 v[128:131], v23, s[24:27], s58 offen offset:0 sc1
    v_mfma_f32_16x16x32_bf16 v[72:75], v[132:135], a[88:91], v[72:75]
    s_waitcnt lgkmcnt(2)
    s_barrier
    v_mfma_f32_16x16x32_bf16 v[76:79], v[132:135], a[92:95], v[76:79]
    s_waitcnt vmcnt(10)
    v_mfma_f32_16x16x32_bf16 v[64:67], v[136:139], a[96:99], v[64:67]
    v_mfma_f32_16x16x32_bf16 v[68:71], v[136:139], a[100:103], v[68:71]
    buffer_load_dwordx4 v[132:135], v23, s[24:27], s58 offen offset:1024 sc1
    v_mfma_f32_16x16x32_bf16 v[72:75], v[136:139], a[104:107], v[72:75]
    ds_read_b128 v[84:87], v233 offset:49152
    ds_read_b128 v[88:91], v234 offset:50176
    v_mfma_f32_16x16x32_bf16 v[76:79], v[136:139], a[108:111], v[76:79]
    ds_read_b128 v[92:95], v235 offset:51200
    s_waitcnt vmcnt(10)
    v_mfma_f32_16x16x32_bf16 v[64:67], v[140:143], a[112:115], v[64:67]
    s_add_u32 s58, s66, s78
    v_mfma_f32_16x16x32_bf16 v[68:71], v[140:143], a[116:119], v[68:71]
    buffer_load_dwordx4 v[136:139], v23, s[24:27], s58 offen offset:0 sc1
    v_mfma_f32_16x16x32_bf16 v[72:75], v[140:143], a[120:123], v[72:75]
    ds_read_b64_tr_b16 a[224:225], v246 offset:0
    v_mfma_f32_16x16x32_bf16 v[76:79], v[140:143], a[124:127], v[76:79]
    ds_read_b64_tr_b16 a[226:227], v246 offset:512
    s_waitcnt vmcnt(10)
    v_mfma_f32_16x16x32_bf16 v[64:67], v[144:147], a[128:131], v[64:67]
    s_waitcnt lgkmcnt(2)
    v_mfma_f32_16x16x32_bf16 v[68:71], v[144:147], a[132:135], v[68:71]
    buffer_load_dwordx4 v[140:143], v23, s[24:27], s58 offen offset:1024 sc1
    v_mfma_f32_16x16x32_bf16 v[72:75], v[144:147], a[136:139], v[72:75]
    v_add_f32 v80, v80, v84
    v_add_f32 v81, v81, v85
    ds_read_b64_tr_b16 a[228:229], v247 offset:0
    v_mfma_f32_16x16x32_bf16 v[76:79], v[144:147], a[140:143], v[76:79]
    ds_read_b64_tr_b16 a[230:231], v247 offset:512
    s_waitcnt vmcnt(10)
    v_mfma_f32_16x16x32_bf16 v[64:67], v[148:151], a[144:147], v[64:67]
    s_add_u32 s58, s66, s79
    v_add_f32 v82, v82, v86
    v_mfma_f32_16x16x32_bf16 v[68:71], v[148:151], a[148:151], v[68:71]
    buffer_load_dwordx4 v[144:147], v23, s[24:27], s58 offen offset:0 sc1
    v_mfma_f32_16x16x32_bf16 v[72:75], v[148:151], a[152:155], v[72:75]
    v_add_f32 v83, v83, v87
    v_add_f32 v80, v80, v88
    ds_read_b64_tr_b16 a[232:233], v246 offset:256
    v_mfma_f32_16x16x32_bf16 v[76:79], v[148:151], a[156:159], v[76:79]
    ds_read_b64_tr_b16 a[234:235], v246 offset:768
    s_waitcnt vmcnt(10)
    v_mfma_f32_16x16x32_bf16 v[64:67], v[152:155], a[160:163], v[64:67]
    v_add_f32 v81, v81, v89
    v_mfma_f32_16x16x32_bf16 v[68:71], v[152:155], a[164:167], v[68:71]
    buffer_load_dwordx4 v[148:151], v23, s[24:27], s58 offen offset:1024 sc1
    v_mfma_f32_16x16x32_bf16 v[72:75], v[152:155], a[168:171], v[72:75]
    v_add_f32 v82, v82, v90
    v_add_f32 v83, v83, v91
    ds_read_b64_tr_b16 a[236:237], v247 offset:256
    v_mfma_f32_16x16x32_bf16 v[76:79], v[152:155], a[172:175], v[76:79]
    ds_read_b64_tr_b16 a[238:239], v247 offset:768
    s_waitcnt vmcnt(10)
    v_mfma_f32_16x16x32_bf16 v[64:67], v[156:159], a[176:179], v[64:67]
    s_add_u32 s58, s66, s80
    v_mfma_f32_16x16x32_bf16 v[68:71], v[156:159], a[180:183], v[68:71]
    buffer_load_dwordx4 v[152:155], v23, s[24:27], s58 offen offset:0 sc1
    v_mfma_f32_16x16x32_bf16 v[72:75], v[156:159], a[184:187], v[72:75]
    v_add_f32 v80, v80, v92
    v_add_f32 v81, v81, v93
    v_mfma_f32_16x16x32_bf16 v[76:79], v[156:159], a[188:191], v[76:79]
    v_add_f32 v82, v82, v94
    s_waitcnt vmcnt(10)
    v_mfma_f32_16x16x32_bf16 v[64:67], v[112:115], a[192:195], v[64:67]
    v_mfma_f32_16x16x32_bf16 v[68:71], v[112:115], a[196:199], v[68:71]
    buffer_load_dwordx4 v[156:159], v23, s[24:27], s58 offen offset:1024 sc1
    v_mfma_f32_16x16x32_bf16 v[72:75], v[112:115], a[200:203], v[72:75]
    v_add_f32 v83, v83, v95
    v_mfma_f32_16x16x32_bf16 v[76:79], v[112:115], a[204:207], v[76:79]
    s_waitcnt vmcnt(10)
    v_mfma_f32_16x16x32_bf16 v[64:67], v[116:119], a[208:211], v[64:67]
    s_add_u32 s58, s66, s81
    v_mfma_f32_16x16x32_bf16 v[68:71], v[116:119], a[212:215], v[68:71]
    buffer_load_dwordx4 v[112:115], v23, s[24:27], s58 offen offset:0 sc1
    v_mfma_f32_16x16x32_bf16 v[72:75], v[116:119], a[216:219], v[72:75]
    v_mfma_f32_16x16x32_bf16 v[76:79], v[116:119], a[220:223], v[76:79]
    s_waitcnt vmcnt(10)
    v_mfma_f32_16x16x32_bf16 v[48:51], v[120:123], a[0:3], v[48:51]
    v_mfma_f32_16x16x32_bf16 v[52:55], v[120:123], a[4:7], 0
    buffer_load_dwordx4 v[116:119], v23, s[24:27], s58 offen offset:1024 sc1
    v_mfma_f32_16x16x32_bf16 v[56:59], v[120:123], a[8:11], 0
    ds_read_b64_tr_b16 v[104:105], v16 offset:6144
    v_mfma_f32_16x16x32_bf16 v[60:63], v[120:123], a[12:15], 0
    ds_read_b64_tr_b16 v[106:107], v16 offset:6656
    s_waitcnt vmcnt(10)
    v_mfma_f32_16x16x32_bf16 v[48:51], v[124:127], a[16:19], v[48:51]
    s_add_u32 s58, s66, s82
    v_mfma_f32_16x16x32_bf16 v[52:55], v[124:127], a[20:23], v[52:55]
    buffer_load_dwordx4 v[120:123], v23, s[24:27], s58 offen offset:0 sc1
    v_mfma_f32_16x16x32_bf16 v[56:59], v[124:127], a[24:27], v[56:59]
    ds_read_b64_tr_b16 v[108:109], v16 offset:10240
    ds_read_b64_tr_b16 v[110:111], v16 offset:10752
    v_mfma_f32_16x16x32_bf16 v[60:63], v[124:127], a[28:31], v[60:63]
    ds_write_b128 v232, v[68:71] offset:32768
    s_waitcnt vmcnt(10)
    v_mfma_f32_16x16x32_bf16 v[48:51], v[128:131], a[32:35], v[48:51]
    v_mfma_f32_16x16x32_bf16 v[52:55], v[128:131], a[36:39], v[52:55]
    buffer_load_dwordx4 v[124:127], v23, s[24:27], s58 offen offset:1024 sc1
    v_mfma_f32_16x16x32_bf16 v[56:59], v[128:131], a[40:43], v[56:59]
    ds_read_b64_tr_b16 v[84:85], v16 offset:14336
    ds_read_b64_tr_b16 v[86:87], v16 offset:14848
    v_mfma_f32_16x16x32_bf16 v[60:63], v[128:131], a[44:47], v[60:63]
    ds_write_b128 v232, v[72:75] offset:33792
    s_waitcnt vmcnt(10)
    v_mfma_f32_16x16x32_bf16 v[48:51], v[132:135], a[48:51], v[48:51]
    s_add_u32 s66, s69, 0
    s_add_u32 s58, s66, s76
    v_mfma_f32_16x16x32_bf16 v[52:55], v[132:135], a[52:55], v[52:55]
    buffer_load_dwordx4 v[128:131], v23, s[24:27], s58 offen offset:0 sc1
    v_mfma_f32_16x16x32_bf16 v[56:59], v[132:135], a[56:59], v[56:59]
    ds_read_b64_tr_b16 v[88:89], v16 offset:3072
    ds_read_b64_tr_b16 v[90:91], v16 offset:3584
    v_mfma_f32_16x16x32_bf16 v[60:63], v[132:135], a[60:63], v[60:63]
    ds_write_b128 v232, v[76:79] offset:34816
    s_waitcnt vmcnt(10)
    v_mfma_f32_16x16x32_bf16 v[48:51], v[136:139], a[64:67], v[48:51]
    v_mfma_f32_16x16x32_bf16 v[52:55], v[136:139], a[68:71], v[52:55]
    buffer_load_dwordx4 v[132:135], v23, s[24:27], s58 offen offset:1024 sc1
    v_mfma_f32_16x16x32_bf16 v[56:59], v[136:139], a[72:75], v[56:59]
    ds_read_b64_tr_b16 v[92:93], v16 offset:7168
    v_mfma_f32_16x16x32_bf16 v[60:63], v[136:139], a[76:79], v[60:63]
    ds_read_b64_tr_b16 v[94:95], v16 offset:7680
    s_waitcnt vmcnt(10)
    v_mfma_f32_16x16x32_bf16 v[48:51], v[140:143], a[80:83], v[48:51]
    s_add_u32 s58, s66, s77
    v_mfma_f32_16x16x32_bf16 v[52:55], v[140:143], a[84:87], v[52:55]
    buffer_load_dwordx4 v[136:139], v23, s[24:27], s58 offen offset:0 sc1
    v_mfma_f32_16x16x32_bf16 v[56:59], v[140:143], a[88:91], v[56:59]
    s_waitcnt lgkmcnt(2)
    s_barrier
    v_mfma_f32_16x16x32_bf16 v[60:63], v[140:143], a[92:95], v[60:63]
    s_waitcnt vmcnt(10)
    v_mfma_f32_16x16x32_bf16 v[48:51], v[144:147], a[96:99], v[48:51]
    v_mfma_f32_16x16x32_bf16 v[52:55], v[144:147], a[100:103], v[52:55]
    buffer_load_dword v19, v21, s[24:27], 0 offen sc1
    v_mfma_f32_16x16x32_bf16 v[56:59], v[144:147], a[104:107], v[56:59]
    ds_read_b128 v[68:71], v233 offset:32768
    ds_read_b128 v[72:75], v234 offset:33792
    v_mfma_f32_16x16x32_bf16 v[60:63], v[144:147], a[108:111], v[60:63]
    ds_read_b128 v[76:79], v235 offset:34816
    s_waitcnt vmcnt(10)
    v_mfma_f32_16x16x32_bf16 v[48:51], v[148:151], a[112:115], v[48:51]
    v_mfma_f32_16x16x32_bf16 v[52:55], v[148:151], a[116:119], v[52:55]
    buffer_load_dwordx4 v[140:143], v23, s[24:27], s58 offen offset:1024 sc1
    v_mfma_f32_16x16x32_bf16 v[56:59], v[148:151], a[120:123], v[56:59]
    ds_read_b64_tr_b16 a[240:241], v246 offset:4096
    v_mfma_f32_16x16x32_bf16 v[60:63], v[148:151], a[124:127], v[60:63]
    ds_read_b64_tr_b16 a[242:243], v246 offset:4608
    s_waitcnt vmcnt(10)
    v_mfma_f32_16x16x32_bf16 v[48:51], v[152:155], a[128:131], v[48:51]
    s_add_u32 s58, s66, s78
    s_waitcnt lgkmcnt(2)
    v_mfma_f32_16x16x32_bf16 v[52:55], v[152:155], a[132:135], v[52:55]
    buffer_load_dwordx4 v[144:147], v23, s[24:27], s58 offen offset:0 sc1
    v_mfma_f32_16x16x32_bf16 v[56:59], v[152:155], a[136:139], v[56:59]
    v_add_f32 v64, v64, v68
    v_add_f32 v65, v65, v69
    ds_read_b64_tr_b16 a[244:245], v247 offset:4096
    v_mfma_f32_16x16x32_bf16 v[60:63], v[152:155], a[140:143], v[60:63]
    ds_read_b64_tr_b16 a[246:247], v247 offset:4608
    s_waitcnt vmcnt(10)
    v_mfma_f32_16x16x32_bf16 v[48:51], v[156:159], a[144:147], v[48:51]
    v_add_f32 v66, v66, v70
    v_mfma_f32_16x16x32_bf16 v[52:55], v[156:159], a[148:151], v[52:55]
    buffer_load_dwordx4 v[148:151], v23, s[24:27], s58 offen offset:1024 sc1
    v_mfma_f32_16x16x32_bf16 v[56:59], v[156:159], a[152:155], v[56:59]
    v_add_f32 v67, v67, v71
    v_add_f32 v64, v64, v72
    ds_read_b64_tr_b16 a[248:249], v246 offset:4352
    v_mfma_f32_16x16x32_bf16 v[60:63], v[156:159], a[156:159], v[60:63]
    ds_read_b64_tr_b16 a[250:251], v246 offset:4864
    s_waitcnt vmcnt(10)
    v_mfma_f32_16x16x32_bf16 v[48:51], v[112:115], a[160:163], v[48:51]
    s_add_u32 s58, s66, s79
    v_add_f32 v65, v65, v73
    v_mfma_f32_16x16x32_bf16 v[52:55], v[112:115], a[164:167], v[52:55]
    buffer_load_dwordx4 v[152:155], v23, s[24:27], s58 offen offset:0 sc1
    v_mfma_f32_16x16x32_bf16 v[56:59], v[112:115], a[168:171], v[56:59]
    v_add_f32 v66, v66, v74
    v_add_f32 v67, v67, v75
    ds_read_b64_tr_b16 a[252:253], v247 offset:4352
    v_mfma_f32_16x16x32_bf16 v[60:63], v[112:115], a[172:175], v[60:63]
    ds_read_b64_tr_b16 a[254:255], v247 offset:4864
    s_waitcnt vmcnt(10)
    v_mfma_f32_16x16x32_bf16 v[48:51], v[116:119], a[176:179], v[48:51]
    v_mfma_f32_16x16x32_bf16 v[52:55], v[116:119], a[180:183], v[52:55]
    buffer_load_dwordx4 v[156:159], v23, s[24:27], s58 offen offset:1024 sc1
    v_mfma_f32_16x16x32_bf16 v[56:59], v[116:119], a[184:187], v[56:59]
    v_add_f32 v64, v64, v76
    v_add_f32 v65, v65, v77
    v_mfma_f32_16x16x32_bf16 v[60:63], v[116:119], a[188:191], v[60:63]
    v_add_f32 v66, v66, v78
    s_waitcnt vmcnt(10)
    v_mfma_f32_16x16x32_bf16 v[48:51], v[120:123], a[192:195], v[48:51]
    s_add_u32 s58, s66, s80
    v_mfma_f32_16x16x32_bf16 v[52:55], v[120:123], a[196:199], v[52:55]
    buffer_load_dwordx4 v[112:115], v23, s[24:27], s58 offen offset:0 sc1
    v_mfma_f32_16x16x32_bf16 v[56:59], v[120:123], a[200:203], v[56:59]
    v_add_f32 v67, v67, v79
    v_mfma_f32_16x16x32_bf16 v[60:63], v[120:123], a[204:207], v[60:63]
    s_waitcnt vmcnt(10)
    v_mfma_f32_16x16x32_bf16 v[48:51], v[124:127], a[208:211], v[48:51]
    v_mfma_f32_16x16x32_bf16 v[52:55], v[124:127], a[212:215], v[52:55]
    buffer_load_dwordx4 v[116:119], v23, s[24:27], s58 offen offset:1024 sc1
    v_mfma_f32_16x16x32_bf16 v[56:59], v[124:127], a[216:219], v[56:59]
    v_mfma_f32_16x16x32_bf16 v[60:63], v[124:127], a[220:223], v[60:63]
    s_waitcnt vmcnt(10)
    v_mfma_f32_16x16x32_bf16 v[32:35], v[128:131], a[0:3], v[32:35]
    s_add_u32 s58, s66, s81
    v_mfma_f32_16x16x32_bf16 v[36:39], v[128:131], a[4:7], 0
    buffer_load_dwordx4 v[120:123], v23, s[24:27], s58 offen offset:0 sc1
    v_mfma_f32_16x16x32_bf16 v[40:43], v[128:131], a[8:11], 0
    v_mfma_f32_16x16x32_bf16 v[44:47], v[128:131], a[12:15], 0
    s_waitcnt vmcnt(10)
    v_mfma_f32_16x16x32_bf16 v[32:35], v[132:135], a[16:19], v[32:35]
    ds_write_b128 v232, v[52:55] offset:16384
    v_mfma_f32_16x16x32_bf16 v[36:39], v[132:135], a[20:23], v[36:39]
    buffer_load_dwordx4 v[124:127], v23, s[24:27], s58 offen offset:1024 sc1
    v_mfma_f32_16x16x32_bf16 v[40:43], v[132:135], a[24:27], v[40:43]
    ds_read_b64_tr_b16 a[0:1], v246 offset:8192
    ds_read_b64_tr_b16 a[2:3], v246 offset:8704
    ds_read_b64_tr_b16 a[4:5], v247 offset:8192
    v_mfma_f32_16x16x32_bf16 v[44:47], v[132:135], a[28:31], v[44:47]
    ds_read_b64_tr_b16 a[6:7], v247 offset:8704
    s_waitcnt vmcnt(10)
    v_mfma_f32_16x16x32_bf16 v[32:35], v[136:139], a[32:35], v[32:35]
    s_add_u32 s58, s66, s82
    ds_write_b128 v232, v[56:59] offset:17408
    v_mfma_f32_16x16x32_bf16 v[36:39], v[136:139], a[36:39], v[36:39]
    buffer_load_dwordx4 v[128:131], v23, s[24:27], s58 offen offset:0 sc1
    v_mfma_f32_16x16x32_bf16 v[40:43], v[136:139], a[40:43], v[40:43]
    ds_read_b64_tr_b16 a[8:9], v246 offset:8448
    ds_read_b64_tr_b16 a[10:11], v246 offset:8960
    ds_read_b64_tr_b16 a[12:13], v247 offset:8448
    v_mfma_f32_16x16x32_bf16 v[44:47], v[136:139], a[44:47], v[44:47]
    ds_read_b64_tr_b16 a[14:15], v247 offset:8960
    buffer_load_dwordx4 v[132:135], v23, s[24:27], s58 offen offset:1024 sc1
    s_waitcnt vmcnt(11)
    v_cmp_ne_u32 vcc, s47, v19
    s_nop 0
    s_cbranch_vccz L_ok10
    s_mov_b32 s59, 100000
L_spin9:
    buffer_load_dword v19, v21, s[24:27], 0 offen sc1
    s_waitcnt vmcnt(0)
    v_cmp_ne_u32 vcc, s47, v19
    s_nop 0
    s_cbranch_vccz L_ok10
    s_sub_u32 s59, s59, 1
    s_cbranch_scc0 L_spin9
L_ok10:
    s_waitcnt vmcnt(10)
    v_mfma_f32_16x16x32_bf16 v[32:35], v[140:143], a[48:51], v[32:35]
    s_add_u32 s58, s70, 0
    ds_write_b128 v232, v[60:63] offset:18432
    v_mfma_f32_16x16x32_bf16 v[36:39], v[140:143], a[52:55], v[36:39]
    buffer_load_dwordx4 v[136:139], v23, s[24:27], s58 offen offset:0 sc1
    v_mfma_f32_16x16x32_bf16 v[40:43], v[140:143], a[56:59], v[40:43]
    ds_read_b64_tr_b16 a[16:17], v246 offset:12288
L_wb_3:
    s_cbranch_execz L_wb_ret
    ds_read_b64_tr_b16 a[18:19], v246 offset:12800
    ds_read_b64_tr_b16 a[20:21], v247 offset:12288
    v_mfma_f32_16x16x32_bf16 v[44:47], v[140:143], a[60:63], v[44:47]
    ds_read_b64_tr_b16 a[22:23], v247 offset:12800
    s_waitcnt vmcnt(10)
    v_mfma_f32_16x16x32_bf16 v[32:35], v[144:147], a[64:67], v[32:35]
    ds_read_b64_tr_b16 a[24:25], v246 offset:12544
    v_mfma_f32_16x16x32_bf16 v[36:39], v[144:147], a[68:71], v[36:39]
    buffer_load_dwordx4 v[140:143], v23, s[24:27], s58 offen offset:1024 sc1
    v_mfma_f32_16x16x32_bf16 v[40:43], v[144:147], a[72:75], v[40:43]
    ds_read_b64_tr_b16 a[26:27], v246 offset:13056
    ds_read_b64_tr_b16 a[28:29], v247 offset:12544
    v_mfma_f32_16x16x32_bf16 v[44:47], v[144:147], a[76:79], v[44:47]
    ds_read_b64_tr_b16 a[30:31], v247 offset:13056
    s_waitcnt vmcnt(10)
    v_mfma_f32_16x16x32_bf16 v[32:35], v[148:151], a[80:83], v[32:35]
    ds_read_b64_tr_b16 a[32:33], v246 offset:16384
    v_mfma_f32_16x16x32_bf16 v[36:39], v[148:151], a[84:87], v[36:39]
    buffer_load_dwordx4 v[144:147], v23, s[24:27], s58 offen offset:2048 sc1
    v_mfma_f32_16x16x32_bf16 v[40:43], v[148:151], a[88:91], v[40:43]
    ds_read_b64_tr_b16 a[34:35], v246 offset:16896
    ds_read_b64_tr_b16 a[36:37], v247 offset:16384
    v_mfma_f32_16x16x32_bf16 v[44:47], v[148:151], a[92:95], v[44:47]
    ds_read_b64_tr_b16 a[38:39], v247 offset:16896
    s_waitcnt vmcnt(10)
    v_mfma_f32_16x16x32_bf16 v[32:35], v[152:155], a[96:99], v[32:35]
    ds_read_b64_tr_b16 a[40:41], v246 offset:16640
    v_mfma_f32_16x16x32_bf16 v[36:39], v[152:155], a[100:103], v[36:39]
    buffer_load_dwordx4 v[148:151], v23, s[24:27], s58 offen offset:3072 sc1
    v_mfma_f32_16x16x32_bf16 v[40:43], v[152:155], a[104:107], v[40:43]
    ds_read_b64_tr_b16 a[42:43], v246 offset:17152
    ds_read_b64_tr_b16 a[44:45], v247 offset:16640
    v_mfma_f32_16x16x32_bf16 v[44:47], v[152:155], a[108:111], v[44:47]
    ds_read_b64_tr_b16 a[46:47], v247 offset:17152
    s_waitcnt vmcnt(10)
    v_mfma_f32_16x16x32_bf16 v[32:35], v[156:159], a[112:115], v[32:35]
    s_add_u32 s58, s70, 4096
    ds_read_b64_tr_b16 a[48:49], v246 offset:20480
    v_mfma_f32_16x16x32_bf16 v[36:39], v[156:159], a[116:119], v[36:39]
    buffer_load_dwordx4 v[152:155], v23, s[24:27], s58 offen offset:0 sc1
    v_mfma_f32_16x16x32_bf16 v[40:43], v[156:159], a[120:123], v[40:43]
    ds_read_b64_tr_b16 a[50:51], v246 offset:20992
    ds_read_b64_tr_b16 a[52:53], v247 offset:20480
    v_mfma_f32_16x16x32_bf16 v[44:47], v[156:159], a[124:127], v[44:47]
    ds_read_b64_tr_b16 a[54:55], v247 offset:20992
    s_waitcnt vmcnt(10)
    v_mfma_f32_16x16x32_bf16 v[32:35], v[112:115], a[128:131], v[32:35]
    ds_read_b64_tr_b16 a[56:57], v246 offset:20736
    v_mfma_f32_16x16x32_bf16 v[36:39], v[112:115], a[132:135], v[36:39]
    buffer_load_dwordx4 v[156:159], v23, s[24:27], s58 offen offset:1024 sc1
    v_mfma_f32_16x16x32_bf16 v[40:43], v[112:115], a[136:139], v[40:43]
    ds_read_b64_tr_b16 a[58:59], v246 offset:21248
    ds_read_b64_tr_b16 a[60:61], v247 offset:20736
    v_mfma_f32_16x16x32_bf16 v[44:47], v[112:115], a[140:143], v[44:47]
    ds_read_b64_tr_b16 a[62:63], v247 offset:21248
    s_waitcnt vmcnt(10)
    v_mfma_f32_16x16x32_bf16 v[32:35], v[116:119], a[144:147], v[32:35]
    ds_read_b64_tr_b16 a[64:65], v246 offset:24576
    v_mfma_f32_16x16x32_bf16 v[36:39], v[116:119], a[148:151], v[36:39]
    buffer_load_dwordx4 v[112:115], v23, s[24:27], s58 offen offset:2048 sc1
    v_mfma_f32_16x16x32_bf16 v[40:43], v[116:119], a[152:155], v[40:43]
    ds_read_b64_tr_b16 a[66:67], v246 offset:25088
    ds_read_b64_tr_b16 a[68:69], v247 offset:24576
    v_mfma_f32_16x16x32_bf16 v[44:47], v[116:119], a[156:159], v[44:47]
    ds_read_b64_tr_b16 a[70:71], v247 offset:25088
    s_waitcnt vmcnt(10)
    v_mfma_f32_16x16x32_bf16 v[32:35], v[120:123], a[160:163], v[32:35]
    ds_read_b64_tr_b16 a[72:73], v246 offset:24832
    v_mfma_f32_16x16x32_bf16 v[36:39], v[120:123], a[164:167], v[36:39]
    buffer_load_dwordx4 v[116:119], v23, s[24:27], s58 offen offset:3072 sc1
    v_mfma_f32_16x16x32_bf16 v[40:43], v[120:123], a[168:171], v[40:43]
    ds_read_b64_tr_b16 a[74:75], v246 offset:25344
    ds_read_b64_tr_b16 a[76:77], v247 offset:24832
    v_mfma_f32_16x16x32_bf16 v[44:47], v[120:123], a[172:175], v[44:47]
    ds_read_b64_tr_b16 a[78:79], v247 offset:25344
    s_waitcnt vmcnt(10)
    v_mfma_f32_16x16x32_bf16 v[32:35], v[124:127], a[176:179], v[32:35]
    s_add_u32 s58, s70, 8192
    ds_read_b64_tr_b16 a[80:81], v246 offset:28672
    v_mfma_f32_16x16x32_bf16 v[36:39], v[124:127], a[180:183], v[36:39]
    buffer_load_dwordx4 v[120:123], v23, s[24:27], s58 offen offset:0 sc1
    v_mfma_f32_16x16x32_bf16 v[40:43], v[124:127], a[184:187], v[40:43]
    ds_read_b64_tr_b16 a[82:83], v246 offset:29184
    ds_read_b64_tr_b16 a[84:85], v247 offset:28672
    v_mfma_f32_16x16x32_bf16 v[44:47], v[124:127], a[188:191], v[44:47]
    ds_read_b64_tr_b16 a[86:87], v247 offset:29184
    s_waitcnt vmcnt(10)
    v_mfma_f32_16x16x32_bf16 v[32:35], v[128:131], a[192:195], v[32:35]
    ds_read_b64_tr_b16 a[88:89], v246 offset:28928
    v_mfma_f32_16x16x32_bf16 v[36:39], v[128:131], a[196:199], v[36:39]
    buffer_load_dwordx4 v[124:127], v23, s[24:27], s58 offen offset:1024 sc1
    v_mfma_f32_16x16x32_bf16 v[40:43], v[128:131], a[200:203], v[40:43]
    ds_read_b64_tr_b16 a[90:91], v246 offset:29440
    ds_read_b64_tr_b16 a[92:93], v247 offset:28928
    v_mfma_f32_16x16x32_bf16 v[44:47], v[128:131], a[204:207], v[44:47]
    ds_read_b64_tr_b16 a[94:95], v247 offset:29440
    s_waitcnt vmcnt(10)
    v_mfma_f32_16x16x32_bf16 v[32:35], v[132:135], a[208:211], v[32:35]
    ds_read_b64_tr_b16 a[96:97], v246 offset:32768
    v_mfma_f32_16x16x32_bf16 v[36:39], v[132:135], a[212:215], v[36:39]
    buffer_load_dwordx4 v[128:131], v23, s[24:27], s58 offen offset:2048 sc1
    v_mfma_f32_16x16x32_bf16 v[40:43], v[132:135], a[216:219], v[40:43]
    ds_read_b64_tr_b16 a[98:99], v246 offset:33280
    ds_read_b64_tr_b16 a[100:101], v247 offset:32768
    v_mfma_f32_16x16x32_bf16 v[44:47], v[132:135], a[220:223], v[44:47]
    ds_read_b64_tr_b16 a[102:103], v247 offset:33280
    s_waitcnt vmcnt(10)
    v_mfma_f32_16x16x32_bf16 v[32:35], a[224:227], v[136:139], v[32:35]
    v_mfma_f32_16x16x32_bf16 v[48:51], a[228:231], v[136:139], v[48:51]
    buffer_load_dwordx4 v[132:135], v23, s[24:27], s58 offen offset:3072 sc1
    v_mfma_f32_16x16x32_bf16 v[64:67], a[232:235], v[136:139], v[64:67]
    ds_read_b64_tr_b16 a[104:105], v246 offset:33024
    ds_read_b64_tr_b16 a[106:107], v246 offset:33536
    v_mfma_f32_16x16x32_bf16 v[80:83], a[236:239], v[136:139], v[80:83]
    ds_read_b64_tr_b16 a[108:109], v247 offset:33024
    ds_read_b64_tr_b16 a[110:111], v247 offset:33536
    v_mfma_f32_16x16x32_bf16 v[96:99], v[160:163], v[136:139], v[96:99]
    ds_read_b64_tr_b16 a[112:113], v246 offset:36864
    s_waitcnt lgkmcnt(15)
    s_waitcnt vmcnt(10)
    v_mfma_f32_16x16x32_bf16 v[32:35], a[240:243], v[140:143], v[32:35]
    s_add_u32 s58, s70, 12288
    v_mfma_f32_16x16x32_bf16 v[48:51], a[244:247], v[140:143], v[48:51]
    buffer_load_dwordx4 v[136:139], v23, s[24:27], s58 offen offset:0 sc1
    v_mfma_f32_16x16x32_bf16 v[64:67], a[248:251], v[140:143], v[64:67]
    ds_read_b64_tr_b16 a[114:115], v246 offset:37376
    ds_read_b64_tr_b16 a[116:117], v247 offset:36864
    v_mfma_f32_16x16x32_bf16 v[80:83], a[252:255], v[140:143], v[80:83]
    ds_read_b64_tr_b16 a[118:119], v247 offset:37376
    ds_read_b64_tr_b16 a[120:121], v246 offset:37120
    v_mfma_f32_16x16x32_bf16 v[96:99], v[164:167], v[140:143], v[96:99]
    ds_write_b128 v232, v[36:39] offset:0
    s_waitcnt vmcnt(10)
    v_mfma_f32_16x16x32_bf16 v[32:35], a[0:3], v[144:147], v[32:35]
    v_mfma_f32_16x16x32_bf16 v[48:51], a[4:7], v[144:147], v[48:51]
    buffer_load_dwordx4 v[140:143], v23, s[24:27], s58 offen offset:1024 sc1
    v_mfma_f32_16x16x32_bf16 v[64:67], a[8:11], v[144:147], v[64:67]
    ds_read_b64_tr_b16 a[122:123], v246 offset:37632
    ds_read_b64_tr_b16 a[124:125], v247 offset:37120
    v_mfma_f32_16x16x32_bf16 v[80:83], a[12:15], v[144:147], v[80:83]
    ds_read_b64_tr_b16 a[126:127], v247 offset:37632
    ds_read_b64_tr_b16 a[128:129], v246 offset:40960
    v_mfma_f32_16x16x32_bf16 v[96:99], v[168:171], v[144:147], v[96:99]
    ds_write_b128 v232, v[40:43] offset:1024
    s_waitcnt vmcnt(10)
    v_mfma_f32_16x16x32_bf16 v[32:35], a[16:19], v[148:151], v[32:35]
    ds_read_b64_tr_b16 a[130:131], v246 offset:41472
    v_mfma_f32_16x16x32_bf16 v[48:51], a[20:23], v[148:151], v[48:51]
    ds_read_b64_tr_b16 a[132:133], v247 offset:40960
    v_mfma_f32_16x16x32_bf16 v[64:67], a[24:27], v[148:151], v[64:67]
    ds_read_b64_tr_b16 a[134:135], v247 offset:41472
    v_mfma_f32_16x16x32_bf16 v[80:83], a[28:31], v[148:151], v[80:83]
    ds_read_b64_tr_b16 a[136:137], v246 offset:41216
    v_mfma_f32_16x16x32_bf16 v[96:99], v[172:175], v[148:151], v[96:99]
    ds_write_b128 v232, v[44:47] offset:2048
    s_waitcnt vmcnt(9)
    v_mfma_f32_16x16x32_bf16 v[32:35], a[32:35], v[152:155], v[32:35]
    ds_read_b64_tr_b16 a[138:139], v246 offset:41728
    v_mfma_f32_16x16x32_bf16 v[48:51], a[36:39], v[152:155], v[48:51]
    ds_read_b64_tr_b16 a[140:141], v247 offset:41216
    v_mfma_f32_16x16x32_bf16 v[64:67], a[40:43], v[152:155], v[64:67]
    ds_read_b64_tr_b16 a[142:143], v247 offset:41728
    v_mfma_f32_16x16x32_bf16 v[80:83], a[44:47], v[152:155], v[80:83]
    ds_read_b64_tr_b16 a[144:145], v246 offset:45056
    v_mfma_f32_16x16x32_bf16 v[96:99], v[192:195], v[152:155], v[96:99]
    ds_read_b64_tr_b16 a[146:147], v246 offset:45568
    s_waitcnt vmcnt(8)
    v_mfma_f32_16x16x32_bf16 v[32:35], a[48:51], v[156:159], v[32:35]
    ds_read_b64_tr_b16 a[148:149], v247 offset:45056
    v_mfma_f32_16x16x32_bf16 v[48:51], a[52:55], v[156:159], v[48:51]
    ds_read_b64_tr_b16 a[150:151], v247 offset:45568
    v_mfma_f32_16x16x32_bf16 v[64:67], a[56:59], v[156:159], v[64:67]
    ds_read_b64_tr_b16 a[152:153], v246 offset:45312
    v_mfma_f32_16x16x32_bf16 v[80:83], a[60:63], v[156:159], v[80:83]
    ds_read_b64_tr_b16 a[154:155], v246 offset:45824
    v_mfma_f32_16x16x32_bf16 v[96:99], v[196:199], v[156:159], v[96:99]
    s_waitcnt lgkmcnt(9)
    s_barrier
    s_waitcnt vmcnt(7)
    v_mfma_f32_16x16x32_bf16 v[32:35], a[64:67], v[112:115], v[32:35]
    ds_read_b64_tr_b16 a[156:157], v247 offset:45312
    ds_read_b64_tr_b16 a[158:159], v247 offset:45824
    v_mfma_f32_16x16x32_bf16 v[48:51], a[68:71], v[112:115], v[48:51]
    ds_read_b64_tr_b16 a[160:161], v248 offset:49152
    ds_read_b64_tr_b16 a[162:163], v248 offset:49664
    v_mfma_f32_16x16x32_bf16 v[64:67], a[72:75], v[112:115], v[64:67]
    ds_read_b128 v[52:55], v233 offset:16384
    v_mfma_f32_16x16x32_bf16 v[80:83], a[76:79], v[112:115], v[80:83]
    ds_read_b128 v[56:59], v234 offset:17408
    v_mfma_f32_16x16x32_bf16 v[96:99], v[200:203], v[112:115], v[96:99]
    ds_read_b128 v[60:63], v235 offset:18432
    s_waitcnt vmcnt(6)
    v_mfma_f32_16x16x32_bf16 v[32:35], a[80:83], v[116:119], v[32:35]
    ds_read_b64_tr_b16 a[164:165], v249 offset:49152
    ds_read_b64_tr_b16 a[166:167], v249 offset:49664
    v_mfma_f32_16x16x32_bf16 v[48:51], a[84:87], v[116:119], v[48:51]
    ds_read_b64_tr_b16 a[168:169], v248 offset:49408
    ds_read_b64_tr_b16 a[170:171], v248 offset:49920
    v_mfma_f32_16x16x32_bf16 v[64:67], a[88:91], v[116:119], v[64:67]
    ds_read_b128 v[36:39], v233 offset:0
    v_mfma_f32_16x16x32_bf16 v[80:83], a[92:95], v[116:119], v[80:83]
    ds_read_b128 v[40:43], v234 offset:1024
    v_mfma_f32_16x16x32_bf16 v[96:99], v[204:207], v[116:119], v[96:99]
    ds_read_b128 v[44:47], v235 offset:2048
    s_waitcnt vmcnt(5)
    v_mfma_f32_16x16x32_bf16 v[32:35], a[96:99], v[120:123], v[32:35]
    ds_read_b64_tr_b16 a[172:173], v249 offset:49408
    v_mfma_f32_16x16x32_bf16 v[48:51], a[100:103], v[120:123], v[48:51]
    ds_read_b64_tr_b16 a[174:175], v249 offset:49920
    v_mfma_f32_16x16x32_bf16 v[64:67], a[104:107], v[120:123], v[64:67]
    ds_read_b64_tr_b16 a[176:177], v248 offset:50176
    v_mfma_f32_16x16x32_bf16 v[80:83], a[108:111], v[120:123], v[80:83]
    ds_read_b64_tr_b16 a[178:179], v248 offset:50688
    v_mfma_f32_16x16x32_bf16 v[96:99], v[100:103], v[120:123], v[96:99]
    ds_read_b64_tr_b16 a[180:181], v249 offset:50176
    s_waitcnt vmcnt(4)
    v_mfma_f32_16x16x32_bf16 v[32:35], a[112:115], v[124:127], v[32:35]
    ds_read_b64_tr_b16 a[182:183], v249 offset:50688
    v_mfma_f32_16x16x32_bf16 v[48:51], a[116:119], v[124:127], v[48:51]
    ds_read_b64_tr_b16 a[184:185], v248 offset:50432
    v_mfma_f32_16x16x32_bf16 v[64:67], a[120:123], v[124:127], v[64:67]
    ds_read_b64_tr_b16 a[186:187], v248 offset:50944
    v_mfma_f32_16x16x32_bf16 v[80:83], a[124:127], v[124:127], v[80:83]
    ds_read_b64_tr_b16 a[188:189], v249 offset:50432
    v_mfma_f32_16x16x32_bf16 v[96:99], v[104:107], v[124:127], v[96:99]
    ds_read_b64_tr_b16 a[190:191], v249 offset:50944
    s_waitcnt lgkmcnt(15)
    s_waitcnt vmcnt(3)
    v_mfma_f32_16x16x32_bf16 v[32:35], a[128:131], v[128:131], v[32:35]
    v_mfma_f32_16x16x32_bf16 v[48:51], a[132:135], v[128:131], v[48:51]
    v_add_f32 v52, v52, v56
    v_mfma_f32_16x16x32_bf16 v[64:67], a[136:139], v[128:131], v[64:67]
    v_add_f32 v53, v53, v57
    v_mfma_f32_16x16x32_bf16 v[80:83], a[140:143], v[128:131], v[80:83]
    v_add_f32 v54, v54, v58
    v_mfma_f32_16x16x32_bf16 v[96:99], v[108:111], v[128:131], v[96:99]
    v_add_f32 v55, v55, v59
    s_waitcnt vmcnt(2)
    v_mfma_f32_16x16x32_bf16 v[32:35], a[144:147], v[132:135], v[32:35]
    v_add_f32 v52, v52, v60
    v_mfma_f32_16x16x32_bf16 v[48:51], a[148:151], v[132:135], v[48:51]
    v_add_f32 v53, v53, v61
    v_mfma_f32_16x16x32_bf16 v[64:67], a[152:155], v[132:135], v[64:67]
    v_add_f32 v54, v54, v62
    v_mfma_f32_16x16x32_bf16 v[80:83], a[156:159], v[132:135], v[80:83]
    v_add_f32 v55, v55, v63
    v_mfma_f32_16x16x32_bf16 v[96:99], v[84:87], v[132:135], v[96:99]
    s_waitcnt lgkmcnt(10)
    s_waitcnt lgkmcnt(8)
    s_waitcnt vmcnt(1)
    v_mfma_f32_16x16x32_bf16 v[32:35], a[160:163], v[136:139], v[32:35]
    v_add_f32 v36, v36, v40
    v_mfma_f32_16x16x32_bf16 v[48:51], a[164:167], v[136:139], v[48:51]
    v_add_f32 v37, v37, v41
    v_mfma_f32_16x16x32_bf16 v[64:67], a[168:171], v[136:139], v[64:67]
    v_add_f32 v38, v38, v42
    v_mfma_f32_16x16x32_bf16 v[80:83], a[172:175], v[136:139], v[80:83]
    v_add_f32 v39, v39, v43
    v_mfma_f32_16x16x32_bf16 v[96:99], v[88:91], v[136:139], v[96:99]
    v_add_f32 v36, v36, v44
    s_waitcnt lgkmcnt(0)
    s_waitcnt vmcnt(0)
    v_mfma_f32_16x16x32_bf16 v[32:35], a[176:179], v[140:143], v[32:35]
    v_add_f32 v37, v37, v45
    v_mfma_f32_16x16x32_bf16 v[48:51], a[180:183], v[140:143], v[48:51]
    v_add_f32 v38, v38, v46
    v_mfma_f32_16x16x32_bf16 v[64:67], a[184:187], v[140:143], v[64:67]
    v_add_f32 v39, v39, v47
    v_mfma_f32_16x16x32_bf16 v[80:83], a[188:191], v[140:143], v[80:83]
    v_mfma_f32_16x16x32_bf16 v[96:99], v[92:95], v[140:143], v[96:99]
    s_nop 0
    v_pk_add_f32 v[32:33], v[32:33], v[36:37]
    v_pk_add_f32 v[34:35], v[34:35], v[38:39]
    v_pk_add_f32 v[48:49], v[48:49], v[52:53]
    v_pk_add_f32 v[50:51], v[50:51], v[54:55]
    v_cvt_pk_bf16_f32 v176, v32, v33
    v_cvt_pk_bf16_f32 v177, v34, v35
    ds_write_b64 v238, v[176:177] offset:0
    v_cvt_pk_bf16_f32 v178, v48, v49
    v_cvt_pk_bf16_f32 v179, v50, v51
    ds_write_b64 v238, v[178:179] offset:32
    v_cvt_pk_bf16_f32 v180, v64, v65
    v_cvt_pk_bf16_f32 v181, v66, v67
    ds_write_b64 v238, v[180:181] offset:64
    v_cvt_pk_bf16_f32 v182, v80, v81
    v_cvt_pk_bf16_f32 v183, v82, v83
    ds_write_b64 v238, v[182:183] offset:96
    ds_read_b128 v[216:219], v244 offset:0
    ds_read_b128 v[220:223], v244 offset:1408
    v_cvt_pk_bf16_f32 v184, v96, v97
    v_cvt_pk_bf16_f32 v185, v98, v99
    ds_write_b64 v238, v[184:185] offset:128
    ds_read_b64 v[224:225], v252 offset:128
    s_waitcnt lgkmcnt(3)
    buffer_store_dwordx4 v[216:219], v22, s[28:31], s71 offen
    s_waitcnt lgkmcnt(2)
    buffer_store_dwordx4 v[220:223], v22, s[28:31], s72 offen
    s_waitcnt lgkmcnt(0)
    buffer_store_dwordx2 v[224:225], v26, s[28:31], s73 offen
L_end:
    s_endpgm
L_p2_alt:
    s_add_u32 s57, s57, 27648
    buffer_load_dwordx4 v11, s[16:19], s57 offen offset:3072 lds
    s_xor_b32 s66, s44, 3
    s_lshl2_add_u32 s66, s51, s66
    s_mul_i32 s66, s66, 66816
    s_lshl2_add_u32 s66, s52, s66
    s_lshl_b32 s86, s65, 10
    s_add_u32 s58, s86, s66
    s_add_u32 s86, s66, 14336
    buffer_load_dwordx4 v[128:131], v23, s[24:27], s58 offen offset:0 sc1
    s_add_u32 s58, s58, 1024
    s_cmp_eq_u32 s58, s86
    s_cselect_b32 s58, s66, s58
    buffer_load_dwordx4 v[132:135], v23, s[24:27], s58 offen offset:0 sc1
    s_add_u32 s58, s58, 1024
    s_cmp_eq_u32 s58, s86
    s_cselect_b32 s58, s66, s58
    buffer_load_dwordx4 v[136:139], v23, s[24:27], s58 offen offset:0 sc1
    s_add_u32 s58, s58, 1024
    s_cmp_eq_u32 s58, s86
    s_cselect_b32 s58, s66, s58
    buffer_load_dwordx4 v[140:143], v23, s[24:27], s58 offen offset:0 sc1
    s_add_u32 s58, s58, 1024
    s_cmp_eq_u32 s58, s86
    s_cselect_b32 s58, s66, s58
    buffer_load_dwordx4 v[144:147], v23, s[24:27], s58 offen offset:0 sc1
    s_add_u32 s58, s58, 1024
    s_cmp_eq_u32 s58, s86
    s_cselect_b32 s58, s66, s58
    buffer_load_dwordx4 v[148:151], v23, s[24:27], s58 offen offset:0 sc1
    s_add_u32 s58, s58, 1024
    s_cmp_eq_u32 s58, s86
    s_cselect_b32 s58, s66, s58
    buffer_load_dwordx4 v[152:155], v23, s[24:27], s58 offen offset:0 sc1
    s_add_u32 s58, s58, 1024
    s_cmp_eq_u32 s58, s86
    s_cselect_b32 s58, s66, s58
    buffer_load_dwordx4 v[156:159], v23, s[24:27], s58 offen offset:0 sc1
    s_add_u32 s58, s58, 1024
    s_cmp_eq_u32 s58, s86
    s_cselect_b32 s58, s66, s58
    buffer_load_dwordx4 v[112:115], v23, s[24:27], s58 offen offset:0 sc1
    s_add_u32 s58, s58, 1024
    s_cmp_eq_u32 s58, s86
    s_cselect_b32 s58, s66, s58
    buffer_load_dwordx4 v[116:119], v23, s[24:27], s58 offen offset:0 sc1
    s_add_u32 s58, s58, 1024
    s_cmp_eq_u32 s58, s86
    s_cselect_b32 s58, s66, s58
    buffer_load_dwordx4 v[120:123], v23, s[24:27], s58 offen offset:0 sc1
    s_waitcnt vmcnt(19)
    ds_read_b64_tr_b16 a[208:209], v4 offset:32768
    ds_read_b64_tr_b16 a[210:211], v4 offset:33280
    ds_read_b64_tr_b16 a[212:213], v5 offset:32768
    ds_read_b64_tr_b16 a[214:215], v5 offset:33280
    ds_read_b64_tr_b16 a[216:217], v4 offset:33024
    ds_read_b64_tr_b16 a[218:219], v4 offset:33536
    ds_read_b64_tr_b16 a[220:221], v5 offset:33024
    ds_read_b64_tr_b16 a[222:223], v5 offset:33536
    s_waitcnt vmcnt(15)
    ds_read_b64_tr_b16 a[224:225], v2 offset:0
    ds_read_b64_tr_b16 a[226:227], v2 offset:512
    ds_read_b64_tr_b16 a[228:229], v3 offset:0
    ds_read_b64_tr_b16 a[230:231], v3 offset:512
    ds_read_b64_tr_b16 a[232:233], v2 offset:256
    ds_read_b64_tr_b16 a[234:235], v2 offset:768
    ds_read_b64_tr_b16 a[236:237], v3 offset:256
    ds_read_b64_tr_b16 a[238:239], v3 offset:768
    s_waitcnt vmcnt(11)
    ds_read_b64_tr_b16 a[240:241], v2 offset:16384
    ds_read_b64_tr_b16 a[242:243], v2 offset:16896
    ds_read_b64_tr_b16 a[244:245], v3 offset:16384
    ds_read_b64_tr_b16 a[246:247], v3 offset:16896
    ds_read_b64_tr_b16 a[248:249], v2 offset:16640
    ds_read_b64_tr_b16 a[250:251], v2 offset:17152
    ds_read_b64_tr_b16 a[252:253], v3 offset:16640
    ds_read_b64_tr_b16 a[254:255], v3 offset:17152
    s_waitcnt lgkmcnt(0)
    s_branch L_p2_join
L_p3_alt:
    s_add_u32 s66, s69, 175872
    s_add_u32 s58, s66, s76
    buffer_load_dwordx4 v[152:155], v23, s[24:27], s58 offen offset:0 sc1
    buffer_load_dwordx4 v[156:159], v23, s[24:27], s58 offen offset:1024 sc1
    s_add_u32 s58, s66, s77
    buffer_load_dwordx4 v[112:115], v23, s[24:27], s58 offen offset:0 sc1
    buffer_load_dwordx4 v[116:119], v23, s[24:27], s58 offen offset:1024 sc1
    s_add_u32 s58, s66, s78
    buffer_load_dwordx4 v[120:123], v23, s[24:27], s58 offen offset:0 sc1
    buffer_load_dwordx4 v[124:127], v23, s[24:27], s58 offen offset:1024 sc1
    s_add_u32 s58, s66, s79
    buffer_load_dwordx4 v[128:131], v23, s[24:27], s58 offen offset:0 sc1
    buffer_load_dwordx4 v[132:135], v23, s[24:27], s58 offen offset:1024 sc1
    s_add_u32 s58, s66, s80
    buffer_load_dwordx4 v[136:139], v23, s[24:27], s58 offen offset:0 sc1
    buffer_load_dwordx4 v[140:143], v23, s[24:27], s58 offen offset:1024 sc1
    s_add_u32 s58, s66, s81
    buffer_load_dwordx4 v[144:147], v23, s[24:27], s58 offen offset:0 sc1
    s_waitcnt vmcnt(11) lgkmcnt(0)
    s_branch L_p3_join
L_help:
    s_sub_u32 s55, s46, 21
    v_lshlrev_b32 v217, 7, v1
    v_lshrrev_b32 v218, 2, v1
    v_lshlrev_b32 v218, 12, v218
    v_lshl_add_u32 v218, v210, 7, v218
    v_mul_u32_u24 v220, 3584, v1
    s_lshl4_add_u32 s54, s44, s65
    s_mul_i32 s54, s54, 114688
    s_lshl_b32 s56, s50, 7
    s_add_u32 s54, s54, s56
    buffer_load_dword v108, v220, s[16:19], s54 offen
    v_mul_u32_u24 v109, 1088, v25
    v_lshl_add_u32 v109, v26, 4, v109
    v_mul_u32_u24 v110, 1088, v209
    v_lshl_add_u32 v110, v208, 5, v110
    v_lshl_add_u32 v110, v210, 3, v110
    s_lshl_b32 s53, s44, 7
    v_add_u32 v110, s53, v110
    v_mul_u32_u24 v111, 66816, v208
    v_lshl_add_u32 v111, v211, 4, v111
    s_mul_i32 s63, s44, 267264
    s_lshl_b32 s53, s2, 8
    s_add_u32 s63, s63, s53
    s_add_u32 s64, s63, 1069056
    v_cmp_gt_u32 vcc, 208, v0
    v_mov_b32 v100, 2130706432
    v_cmp_le_u32 s[92:93], 24, v26
    v_cndmask_b32 v22, v100, v111, vcc
    s_mov_b32 s62, 0x3f803f80
    s_mov_b32 s61, 0xffff0000
    v_mov_b32 v96, 0
    v_mov_b32 v97, 0
    s_waitcnt vmcnt(3)
    v_dot2c_f32_bf16 v96, s62, v32
    v_dot2c_f32_bf16 v97, v32, v32
    v_lshlrev_b32 v40, 16, v32
    v_and_b32 v41, s61, v32
    v_dot2c_f32_bf16 v96, s62, v33
    v_dot2c_f32_bf16 v97, v33, v33
    v_lshlrev_b32 v42, 16, v33
    v_and_b32 v43, s61, v33
    v_dot2c_f32_bf16 v96, s62, v34
    v_dot2c_f32_bf16 v97, v34, v34
    v_lshlrev_b32 v44, 16, v34
    v_and_b32 v45, s61, v34
    v_dot2c_f32_bf16 v96, s62, v35
    v_dot2c_f32_bf16 v97, v35, v35
    v_lshlrev_b32 v46, 16, v35
    v_and_b32 v47, s61, v35
    s_waitcnt vmcnt(2)
    v_dot2c_f32_bf16 v96, s62, v36
    v_dot2c_f32_bf16 v97, v36, v36
    v_lshlrev_b32 v48, 16, v36
    v_and_b32 v49, s61, v36
    v_dot2c_f32_bf16 v96, s62, v37
    v_dot2c_f32_bf16 v97, v37, v37
    v_lshlrev_b32 v50, 16, v37
    v_and_b32 v51, s61, v37
    v_dot2c_f32_bf16 v96, s62, v38
    v_dot2c_f32_bf16 v97, v38, v38
    v_lshlrev_b32 v52, 16, v38
    v_and_b32 v53, s61, v38
    v_dot2c_f32_bf16 v96, s62, v39
    v_dot2c_f32_bf16 v97, v39, v39
    v_lshlrev_b32 v54, 16, v39
    v_and_b32 v55, s61, v39
    buffer_load_dword v29, off, s[40:43], 0 sc1
    v_add_f32_dpp v96, v96, v96 quad_perm:[1,0,3,2] row_mask:0xf bank_mask:0xf
    v_add_f32_dpp v97, v97, v97 quad_perm:[1,0,3,2] row_mask:0xf bank_mask:0xf
    s_nop 0
    v_add_f32_dpp v96, v96, v96 quad_perm:[2,3,0,1] row_mask:0xf bank_mask:0xf
    v_add_f32_dpp v97, v97, v97 quad_perm:[2,3,0,1] row_mask:0xf bank_mask:0xf
    s_nop 0
    v_add_f32_dpp v96, v96, v96 row_half_mirror row_mask:0xf bank_mask:0xf
    v_add_f32_dpp v97, v97, v97 row_half_mirror row_mask:0xf bank_mask:0xf
    s_nop 0
    v_add_f32_dpp v96, v96, v96 row_mirror row_mask:0xf bank_mask:0xf
    v_add_f32_dpp v97, v97, v97 row_mirror row_mask:0xf bank_mask:0xf
    v_mov_b32 v98, v96
    v_mov_b32 v99, v97
    s_nop 0
    v_permlane16_swap_b32 v96, v98
    v_permlane16_swap_b32 v97, v99
    v_add_f32 v96, v96, v98
    v_add_f32 v97, v97, v99
    v_mul_f32 v98, 0x3b124925, v96
    v_mul_f32 v99, 0x3b124925, v97
    v_fma_f32 v99, -v98, v98, v99
    v_max_f32 v99, 0, v99
    v_cvt_pk_bf16_f32 v100, 0, v99
    v_add_f32 v100, 0x3727c5ac, v100
    v_cvt_pk_bf16_f32 v100, 0, v100
    v_sqrt_f32 v100, v100
    s_nop 0
    v_cvt_pk_bf16_f32 v100, 0, v100
    v_rcp_f32 v100, v100
    s_nop 0
    v_mul_f32 v99, v99, v100
    v_mul_f32 v99, v99, v100
    v_cvt_pk_bf16_f32 v104, 0, v99
    v_add_f32 v104, 0x3727c5ac, v104
    v_cvt_pk_bf16_f32 v104, 0, v104
    v_sqrt_f32 v104, v104
    s_nop 0
    v_cvt_pk_bf16_f32 v102, 0, v104
    v_rcp_f32 v104, v102
    s_nop 0
    v_mul_f32 v104, v104, v100
    v_mul_f32 v106, v98, v104
    v_pk_fma_f32 v[56:57], v[40:41], v[104:105], v[106:107] op_sel_hi:[1,0,0] neg_lo:[0,0,1] neg_hi:[0,0,1]
    v_pk_fma_f32 v[58:59], v[42:43], v[104:105], v[106:107] op_sel_hi:[1,0,0] neg_lo:[0,0,1] neg_hi:[0,0,1]
    v_pk_fma_f32 v[60:61], v[44:45], v[104:105], v[106:107] op_sel_hi:[1,0,0] neg_lo:[0,0,1] neg_hi:[0,0,1]
    v_pk_fma_f32 v[62:63], v[46:47], v[104:105], v[106:107] op_sel_hi:[1,0,0] neg_lo:[0,0,1] neg_hi:[0,0,1]
    v_pk_fma_f32 v[64:65], v[48:49], v[104:105], v[106:107] op_sel_hi:[1,0,0] neg_lo:[0,0,1] neg_hi:[0,0,1]
    v_pk_fma_f32 v[66:67], v[50:51], v[104:105], v[106:107] op_sel_hi:[1,0,0] neg_lo:[0,0,1] neg_hi:[0,0,1]
    v_pk_fma_f32 v[68:69], v[52:53], v[104:105], v[106:107] op_sel_hi:[1,0,0] neg_lo:[0,0,1] neg_hi:[0,0,1]
    v_pk_fma_f32 v[70:71], v[54:55], v[104:105], v[106:107] op_sel_hi:[1,0,0] neg_lo:[0,0,1] neg_hi:[0,0,1]
    v_cvt_pk_bf16_f32 v80, v56, v57
    v_cvt_pk_bf16_f32 v81, v58, v59
    v_cvt_pk_bf16_f32 v82, v60, v61
    v_cvt_pk_bf16_f32 v83, v62, v63
    v_cvt_pk_bf16_f32 v84, v64, v65
    v_cvt_pk_bf16_f32 v85, v66, v67
    v_cvt_pk_bf16_f32 v86, v68, v69
    v_cvt_pk_bf16_f32 v87, v70, v71
    v_lshrrev_b32 v102, 16, v102
    v_cndmask_b32 v84, v84, v102, s[92:93]
    ds_write_b128 v109, v[80:83] offset:0
    ds_write_b128 v109, v[84:87] offset:512
    s_waitcnt lgkmcnt(0)
    s_barrier
    ds_read_b64_tr_b16 v[88:89], v110 offset:0
    ds_read_b64_tr_b16 v[90:91], v110 offset:4352
    ds_read_b64_tr_b16 v[92:93], v110 offset:512
    ds_read_b64_tr_b16 v[94:95], v110 offset:4864
    s_waitcnt lgkmcnt(2)
    buffer_store_dwordx4 v[88:91], v111, s[24:27], s63 offen sc1
    s_waitcnt lgkmcnt(0)
    buffer_store_dwordx4 v[92:95], v22, s[24:27], s64 offen sc1
    v_min_u32 v220, 111104, v220
    s_add_u32 s54, s54, 229376
    buffer_load_dword v108, v220, s[16:19], s54 offen
    s_waitcnt vmcnt(1)
    v_cmp_eq_u32 vcc, 0, v29
    s_nop 0
    s_cbranch_vccz L_ok12
    s_mov_b32 s59, 100000
L_spin11:
    buffer_load_dword v29, off, s[40:43], 0 sc1
    s_waitcnt vmcnt(0)
    v_cmp_eq_u32 vcc, 0, v29
    s_nop 0
    s_cbranch_vccz L_ok12
    s_sub_u32 s59, s59, 1
    s_cbranch_scc0 L_spin11
L_ok12:
    v_readfirstlane_b32 s47, v29
    s_barrier
    s_cmp_lg_u32 s44, 0
    s_cbranch_scc1 L_nopub13
    s_lshl_b32 s60, s2, 5
    s_add_u32 s60, s60, 12582912
    v_mov_b32 v30, s47
    s_mov_b64 exec, 1
    buffer_store_dword v30, off, s[24:27], s60 sc1
    s_mov_b64 exec, -1
L_nopub13:
    buffer_load_dword v108, v217, s[32:35], 0 offen
    v_lshrrev_b32 v219, 2, v1
    v_min_u32 v219, 10, v219
    v_mul_u32_u24 v219, 3584, v219
    v_lshl_add_u32 v219, v210, 7, v219
    s_mul_i32 s54, s55, 11
    s_lshl_b32 s56, s44, 9
    s_add_u32 s54, s54, s56
    s_add_u32 s54, s54, 448
    s_mul_i32 s54, s54, 3584
    s_mul_i32 s56, s45, 7
    s_lshr_b32 s56, s56, 1
    s_lshl_b32 s56, s56, 7
    s_add_u32 s54, s54, s56
    buffer_load_dword v108, v219, s[16:19], s54 offen
    s_add_u32 s54, s54, 118272
    buffer_load_dword v108, v219, s[16:19], s54 offen
    s_add_u32 s54, s54, 118272
    s_lshl_b32 s54, s44, 11
    s_add_u32 s54, s54, 12582912
    v_lshl_add_u32 v221, v1, 5, s54
    buffer_load_dword v222, v221, s[24:27], 0 offen sc1
    s_waitcnt vmcnt(0)
    v_cmp_ne_u32 vcc, s47, v222
    s_nop 0
    s_cbranch_vccz L_ok15
    s_mov_b32 s59, 100000
L_spin14:
    buffer_load_dword v222, v221, s[24:27], 0 offen sc1
    s_waitcnt vmcnt(0)
    v_cmp_ne_u32 vcc, s47, v222
    s_nop 0
    s_cbranch_vccz L_ok15
    s_sub_u32 s59, s59, 1
    s_cbranch_scc0 L_spin14
L_ok15:
    s_add_u32 s54, s55, 0
    s_lshr_b32 s56, s54, 1
    s_add_u32 s56, s56, 24
    s_mul_i32 s56, s56, 66816
    s_lshl2_add_u32 s56, s52, s56
    s_and_b32 s54, s54, 1
    s_lshl_b32 s54, s54, 13
    s_add_u32 s56, s56, s54
    buffer_load_dword v108, v217, s[24:27], s56 offen sc1
    s_add_u32 s54, s55, 3
    s_lshr_b32 s56, s54, 1
    s_add_u32 s56, s56, 24
    s_mul_i32 s56, s56, 66816
    s_lshl2_add_u32 s56, s52, s56
    s_and_b32 s54, s54, 1
    s_lshl_b32 s54, s54, 13
    s_add_u32 s56, s56, s54
    buffer_load_dword v108, v217, s[24:27], s56 offen sc1
    s_add_u32 s54, s55, 6
    s_lshr_b32 s56, s54, 1
    s_add_u32 s56, s56, 24
    s_mul_i32 s56, s56, 66816
    s_lshl2_add_u32 s56, s52, s56
    s_and_b32 s54, s54, 1
    s_lshl_b32 s54, s54, 13
    s_add_u32 s56, s56, s54
    s_cmp_lt_u32 s55, 2
    s_cselect_b32 s56, s56, 2130706432
    buffer_load_dword v108, v217, s[24:27], s56 offen sc1
    s_mul_i32 s54, s44, 28
    s_add_u32 s54, s54, s55
    s_add_u32 s54, s54, 0
    s_lshl_b32 s54, s54, 16
    s_lshl_b32 s56, s45, 9
    s_add_u32 s54, s54, s56
    buffer_load_dword v108, v218, s[20:23], s54 offen
    s_add_u32 s54, s54, 196608
    buffer_load_dword v108, v218, s[20:23], s54 offen
    s_add_u32 s54, s54, 196608
    buffer_load_dword v108, v218, s[20:23], s54 offen
    s_add_u32 s54, s54, 196608
    buffer_load_dword v108, v218, s[20:23], s54 offen
    s_add_u32 s54, s54, 196608
    buffer_load_dword v108, v217, s[36:39], 0 offen
    s_waitcnt vmcnt(0) lgkmcnt(0)
    v_lshlrev_b32 v216, 6, v209
    v_lshl_add_u32 v216, v210, 3, v216
    v_lshl_add_u32 v216, v215, 5, v216
    s_add_u32 s53, s52, 49152
    v_lshl_add_u32 v2, v208, 10, v216
    v_add_u32 v2, s53, v2
    v_xor_b32 v3, 32, v2
    v_add_u32 v4, 65536, v2
    v_add_u32 v5, 65536, v3
    v_lshl_add_u32 v6, v208, 9, v216
    v_add_u32 v6, s53, v6
    v_xor_b32 v7, 32, v6
    v_add_u32 v8, 65536, v6
    v_add_u32 v9, 65536, v7
    s_lshr_b32 s53, s46, 2
    s_and_b32 s89, s46, 3
    s_bfe_u32 s54, s46, 0x20001
    s_and_b32 s55, s46, 1
    s_add_u32 s55, s55, 4
    s_cmp_lt_u32 s46, 16
    s_cselect_b32 s53, s53, s54
    s_cselect_b32 s89, s89, s55
    s_mul_i32 s49, s53, 2
    s_add_u32 s49, s49, s89
    s_sub_u32 s54, s49, 6
    s_min_u32 s49, s49, s54
    s_or_b32 s89, s89, 0
    s_lshl2_add_u32 s48, s45, s53
    s_mul_i32 s53, s44, 1835008
    s_lshl_b32 s74, s48, 7
    s_add_u32 s53, s53, s74
    s_lshl_b32 s56, s44, 5
    v_lshlrev_b32 v217, 5, v212
    v_xor_b32 v217, v217, v214
    v_xor_b32 v217, s56, v217
    s_add_u32 s74, s74, s56
    v_lshlrev_b32 v12, 12, v213
    v_add3_u32 v12, v12, v217, s53
    s_mul_i32 s53, s44, 28672
    s_lshl_b32 s54, s49, 7
    s_add_u32 s55, s53, s54
    v_mul_u32_u24 v13, 896, v213
    v_add3_u32 v13, v13, v214, s55
    v_xor_b32 v14, 32, v13
    s_mul_i32 s55, s44, 21504
    v_subrev_u32 v239, s55, v13
    s_and_b32 s55, s56, 32
    v_xor_b32 v239, s55, v239
    s_mul_i32 s73, s48, 57344
    s_add_u32 s71, s73, s54
    s_mul_i32 s55, s44, 14336
    s_add_u32 s71, s71, s55
    s_add_u32 s72, s71, 7168
    v_bfe_u32 v217, v1, 1, 2
    v_lshl_add_u32 v217, v212, 2, v217
    v_and_b32 v218, 24, v1
    v_add_u32 v217, v217, v218
    v_mul_u32_u24 v15, 896, v217
    v_and_b32 v217, 1, v1
    v_lshl_add_u32 v15, v217, 4, v15
    v_add_u32 v15, s53, v15
    s_lshl_b32 s54, s89, 5
    s_add_u32 s54, s54, 768
    s_add_u32 s68, s89, 24
    s_mul_i32 s68, s68, 58624
    s_mul_i32 s69, s44, 14336
    s_add_u32 s69, s69, 2097152
    s_add_u32 s68, s68, s69
    s_mul_i32 s55, s49, 234496
    s_add_u32 s69, s69, s55
    s_add_u32 s73, s73, s54
    s_mov_b32 s76, 0
    s_add_u32 s77, s76, 2048
    s_cmp_eq_u32 s77, 14336
    s_cselect_b32 s77, 0, s77
    s_add_u32 s78, s77, 2048
    s_cmp_eq_u32 s78, 14336
    s_cselect_b32 s78, 0, s78
    s_add_u32 s79, s78, 2048
    s_cmp_eq_u32 s79, 14336
    s_cselect_b32 s79, 0, s79
    s_add_u32 s80, s79, 2048
    s_cmp_eq_u32 s80, 14336
    s_cselect_b32 s80, 0, s80
    s_add_u32 s81, s80, 2048
    s_cmp_eq_u32 s81, 14336
    s_cselect_b32 s81, 0, s81
    s_add_u32 s82, s81, 2048
    s_cmp_eq_u32 s82, 14336
    s_cselect_b32 s82, 0, s82
    s_cmp_lt_u32 s89, 4
    s_cselect_b32 s75, s54, 2130706432
    s_cselect_b32 s68, s68, 2130706432
    s_cselect_b32 s73, s73, 2130706432
    v_lshlrev_b32 v16, 3, v1
    v_add_u32 v16, 81920, v16
    v_and_b32 v217, 7, v1
    v_min_u32 v218, 6, v217
    s_mul_i32 s54, s44, 7
    v_add_u32 v218, s54, v218
    v_mul_u32_u24 v219, 2, v218
    v_add_u32 v219, s89, v219
    v_mul_u32_u24 v220, 43, v219
    v_lshrrev_b32 v220, 8, v220
    v_mul_u32_u24 v220, 6, v220
    v_sub_u32 v219, v219, v220
    v_subrev_u32 v219, s49, v219
    v_bfe_u32 v220, v1, 3, 1
    v_mul_i32_i24 v219, v219, v220
    v_add_u32 v219, s49, v219
    v_lshl_add_u32 v218, v219, 5, v218
    v_lshlrev_b32 v20, 7, v218
    v_add_u32 v20, 12713984, v20
    s_lshr_b32 s53, s48, 1
    s_lshl_b32 s53, s53, 7
    s_add_u32 s53, s53, 12779520
    v_lshl_add_u32 v21, v210, 11, s53
    s_lshl_b32 s70, s48, 16
    s_lshl2_add_u32 s70, s52, s70
    s_add_u32 s70, s70, 4194304
    v_lshrrev_b32 v218, 3, v1
    v_mul_u32_u24 v22, 896, v218
    v_lshl_add_u32 v22, v217, 4, v22
    v_lshlrev_b32 v25, 1, v211
    s_add_u32 s53, s52, 65536
    v_mul_u32_u24 v244, 176, v218
    v_lshl_add_u32 v244, v217, 4, v244
    v_add_u32 v244, s53, v244
    v_mul_u32_u24 v238, 176, v211
    v_lshl_add_u32 v238, v208, 3, v238
    v_add_u32 v238, s53, v238
    v_lshrrev_b32 v218, 2, v0
    v_mul_u32_u24 v26, 896, v218
    v_lshl_add_u32 v26, v210, 3, v26
    v_lshrrev_b32 v218, 2, v1
    v_mul_u32_u24 v252, 176, v218
    v_lshl_add_u32 v252, v210, 3, v252
    v_add_u32 v252, s53, v252
    s_sub_u32 s53, 49152, s52
    v_add_u32 v246, s53, v2
    v_add_u32 v247, s53, v3
    v_mul_u32_u24 v218, 3072, v208
    v_add_u32 v248, v218, v246
    v_add_u32 v249, v218, v247
    v_add_u32 v232, s52, v23
    v_xor_b32 v233, 4096, v232
    v_xor_b32 v234, 8192, v232
    v_xor_b32 v235, 12288, v232
    buffer_load_dwordx4 v[216:219], v22, s[4:7], s71 offen
    buffer_load_dwordx4 v[220:223], v22, s[4:7], s72 offen
    buffer_load_dwordx2 v[224:225], v26, s[4:7], s73 offen
    buffer_load_ushort v228, v25, s[36:39], s74 offen
    s_waitcnt vmcnt(0)
    ds_write_b128 v244, v[216:219]
    ds_write_b128 v244, v[220:223] offset:1408
    ds_write_b64 v252, v[224:225] offset:128
    ds_read_b64 v[216:217], v238 offset:0
    ds_read_b64 v[218:219], v238 offset:32
    ds_read_b64 v[220:221], v238 offset:64
    ds_read_b64 v[222:223], v238 offset:96
    ds_read_b64 v[224:225], v238 offset:128
    s_add_u32 m0, s52, 81920
    s_lshl_b32 s57, s76, 7
    buffer_load_dwordx4 v12, s[20:23], s57 offen offset:0 lds
    s_add_u32 s57, s57, 31744
    buffer_load_dwordx4 v12, s[20:23], s57 offen offset:1024 lds
    s_add_u32 s57, s57, 31744
    buffer_load_dwordx4 v12, s[20:23], s57 offen offset:2048 lds
    s_add_u32 s57, s57, 31744
    buffer_load_dwordx4 v12, s[20:23], s57 offen offset:3072 lds
    s_add_u32 m0, s52, 98304
    s_lshl_b32 s57, s76, 7
    s_add_u32 s57, s57, 131072
    buffer_load_dwordx4 v12, s[20:23], s57 offen offset:0 lds
    s_add_u32 s57, s57, 31744
    buffer_load_dwordx4 v12, s[20:23], s57 offen offset:1024 lds
    s_add_u32 s57, s57, 31744
    buffer_load_dwordx4 v12, s[20:23], s57 offen offset:2048 lds
    s_add_u32 s57, s57, 31744
    buffer_load_dwordx4 v12, s[20:23], s57 offen offset:3072 lds
    s_add_u32 m0, s52, 114688
    s_lshl_b32 s57, s77, 7
    buffer_load_dwordx4 v12, s[20:23], s57 offen offset:0 lds
    s_add_u32 s57, s57, 31744
    buffer_load_dwordx4 v12, s[20:23], s57 offen offset:1024 lds
    s_add_u32 s57, s57, 31744
    buffer_load_dwordx4 v12, s[20:23], s57 offen offset:2048 lds
    s_add_u32 s57, s57, 31744
    buffer_load_dwordx4 v12, s[20:23], s57 offen offset:3072 lds
    s_add_u32 m0, s52, 131072
    s_lshl_b32 s57, s77, 7
    s_add_u32 s57, s57, 131072
    buffer_load_dwordx4 v12, s[20:23], s57 offen offset:0 lds
    s_add_u32 s57, s57, 31744
    buffer_load_dwordx4 v12, s[20:23], s57 offen offset:1024 lds
    s_waitcnt vmcnt(10)
    ds_read_b64_tr_b16 a[0:1], v6 offset:32768
    ds_read_b64_tr_b16 a[2:3], v6 offset:34816
    ds_read_b64_tr_b16 a[4:5], v7 offset:32768
    ds_read_b64_tr_b16 a[6:7], v7 offset:34816
    ds_read_b64_tr_b16 a[8:9], v6 offset:33024
    ds_read_b64_tr_b16 a[10:11], v6 offset:35072
    ds_read_b64_tr_b16 a[12:13], v7 offset:33024
    ds_read_b64_tr_b16 a[14:15], v7 offset:35072
    s_add_u32 s57, s57, 31744
    buffer_load_dwordx4 v12, s[20:23], s57 offen offset:2048 lds
    s_add_u32 s57, s57, 31744
    buffer_load_dwordx4 v12, s[20:23], s57 offen offset:3072 lds
    s_add_u32 m0, s52, 147456
    s_lshl_b32 s57, s78, 7
    buffer_load_dwordx4 v12, s[20:23], s57 offen offset:0 lds
    s_add_u32 s57, s57, 31744
    buffer_load_dwordx4 v12, s[20:23], s57 offen offset:1024 lds
    s_waitcnt vmcnt(10)
    ds_read_b64_tr_b16 a[16:17], v6 offset:49152
    ds_read_b64_tr_b16 a[18:19], v6 offset:51200
    ds_read_b64_tr_b16 a[20:21], v7 offset:49152
    ds_read_b64_tr_b16 a[22:23], v7 offset:51200
    ds_read_b64_tr_b16 a[24:25], v6 offset:49408
    ds_read_b64_tr_b16 a[26:27], v6 offset:51456
    ds_read_b64_tr_b16 a[28:29], v7 offset:49408
    ds_read_b64_tr_b16 a[30:31], v7 offset:51456
    s_add_u32 s57, s57, 31744
    buffer_load_dwordx4 v12, s[20:23], s57 offen offset:2048 lds
    s_add_u32 s57, s57, 31744
    buffer_load_dwordx4 v12, s[20:23], s57 offen offset:3072 lds
    s_add_u32 m0, s52, 49152
    s_lshl_b32 s57, s78, 7
    s_add_u32 s57, s57, 131072
    buffer_load_dwordx4 v12, s[20:23], s57 offen offset:0 lds
    s_add_u32 s57, s57, 31744
    buffer_load_dwordx4 v12, s[20:23], s57 offen offset:1024 lds
    s_waitcnt vmcnt(10)
    ds_read_b64_tr_b16 a[32:33], v8 offset:0
    ds_read_b64_tr_b16 a[34:35], v8 offset:2048
    ds_read_b64_tr_b16 a[36:37], v9 offset:0
    ds_read_b64_tr_b16 a[38:39], v9 offset:2048
    ds_read_b64_tr_b16 a[40:41], v8 offset:256
    ds_read_b64_tr_b16 a[42:43], v8 offset:2304
    ds_read_b64_tr_b16 a[44:45], v9 offset:256
    ds_read_b64_tr_b16 a[46:47], v9 offset:2304
    s_add_u32 s57, s57, 31744
    buffer_load_dwordx4 v12, s[20:23], s57 offen offset:2048 lds
    s_add_u32 s57, s57, 31744
    buffer_load_dwordx4 v12, s[20:23], s57 offen offset:3072 lds
    s_waitcnt lgkmcnt(15)
    s_add_u32 m0, s52, 65536
    s_lshl_b32 s57, s79, 7
    buffer_load_dwordx4 v12, s[20:23], s57 offen offset:0 lds
    s_add_u32 s57, s57, 31744
    buffer_load_dwordx4 v12, s[20:23], s57 offen offset:1024 lds
    s_waitcnt vmcnt(10)
    ds_read_b64_tr_b16 a[48:49], v8 offset:16384
    ds_read_b64_tr_b16 a[50:51], v8 offset:18432
    ds_read_b64_tr_b16 a[52:53], v9 offset:16384
    ds_read_b64_tr_b16 a[54:55], v9 offset:18432
    s_add_u32 s57, s57, 31744
    buffer_load_dwordx4 v12, s[20:23], s57 offen offset:2048 lds
    ds_read_b64_tr_b16 a[56:57], v8 offset:16640
    ds_read_b64_tr_b16 a[58:59], v8 offset:18688
    ds_read_b64_tr_b16 a[60:61], v9 offset:16640
    ds_read_b64_tr_b16 a[62:63], v9 offset:18688
    s_add_u32 s57, s57, 31744
    buffer_load_dwordx4 v12, s[20:23], s57 offen offset:3072 lds
    s_add_u32 m0, s52, 81920
    s_lshl_b32 s57, s79, 7
    s_add_u32 s57, s57, 131072
    buffer_load_dwordx4 v12, s[20:23], s57 offen offset:0 lds
    s_add_u32 s57, s57, 31744
    buffer_load_dwordx4 v12, s[20:23], s57 offen offset:1024 lds
    s_waitcnt vmcnt(10)
    ds_read_b64_tr_b16 a[64:65], v8 offset:32768
    ds_read_b64_tr_b16 a[66:67], v8 offset:34816
    ds_read_b64_tr_b16 a[68:69], v9 offset:32768
    ds_read_b64_tr_b16 a[70:71], v9 offset:34816
    s_add_u32 s57, s57, 31744
    buffer_load_dwordx4 v12, s[20:23], s57 offen offset:2048 lds
    ds_read_b64_tr_b16 a[72:73], v8 offset:33024
    ds_read_b64_tr_b16 a[74:75], v8 offset:35072
    ds_read_b64_tr_b16 a[76:77], v9 offset:33024
    ds_read_b64_tr_b16 a[78:79], v9 offset:35072
    s_add_u32 s57, s57, 31744
    buffer_load_dwordx4 v12, s[20:23], s57 offen offset:3072 lds
    s_waitcnt lgkmcnt(15)
    s_add_u32 m0, s52, 98304
    s_lshl_b32 s57, s80, 7
    buffer_load_dwordx4 v12, s[20:23], s57 offen offset:0 lds
    s_add_u32 s57, s57, 31744
    buffer_load_dwordx4 v12, s[20:23], s57 offen offset:1024 lds
    s_waitcnt vmcnt(10)
    ds_read_b64_tr_b16 a[80:81], v6 offset:0
    ds_read_b64_tr_b16 a[82:83], v6 offset:2048
    ds_read_b64_tr_b16 a[84:85], v7 offset:0
    ds_read_b64_tr_b16 a[86:87], v7 offset:2048
    s_add_u32 s57, s57, 31744
    buffer_load_dwordx4 v12, s[20:23], s57 offen offset:2048 lds
    ds_read_b64_tr_b16 a[88:89], v6 offset:256
    ds_read_b64_tr_b16 a[90:91], v6 offset:2304
    ds_read_b64_tr_b16 a[92:93], v7 offset:256
    ds_read_b64_tr_b16 a[94:95], v7 offset:2304
    s_waitcnt vmcnt(0) lgkmcnt(0)
    s_branch L_p3join
L_role_a:
    v_lshrrev_b32 v112, 4, v1
    v_bfe_u32 v113, v1, 2, 2
    v_and_b32 v114, 3, v1
    v_and_b32 v115, 15, v1
    v_lshrrev_b32 v116, 5, v1
    s_and_b32 s48, s45, 6
    s_lshr_b32 s48, 0xc9, s48
    s_and_b32 s48, s48, 3
    s_and_b32 s53, s45, 1
    s_lshl3_add_u32 s49, s53, s46
    s_sub_u32 s49, s49, 24
    s_lshl_b32 s90, s44, 11
    s_and_b32 s53, s44, 1
    s_lshl_b32 s53, s53, 1
    v_lshlrev_b32 v117, 2, v112
    v_sub_u32 v117, v115, v117
    v_and_b32 v117, 15, v117
    v_xor_b32 v117, s53, v117
    v_mul_u32_u24 v2, 2688, v112
    v_lshl_add_u32 v2, v117, 4, v2
    s_mul_i32 s53, s44, 21504
    s_mul_i32 s54, s48, 224
    s_andn2_b32 s54, s54, 63
    s_add_u32 s53, s53, s54
    v_add_u32 v2, s53, v2
    s_add_u32 m0, s90, 65536
    s_mov_b32 s57, 896
    buffer_load_dwordx4 v2, s[8:11], s57 offen offset:0 lds
    s_mov_b32 s57, 10624
    buffer_load_dwordx4 v2, s[8:11], s57 offen offset:1024 lds
    v_mul_u32_u24 v109, 1088, v25
    v_lshl_add_u32 v109, v26, 4, v109
    v_mul_u32_u24 v110, 1088, v113
    v_lshl_add_u32 v110, v112, 5, v110
    v_lshl_add_u32 v110, v114, 3, v110
    s_lshl_b32 s53, s44, 7
    v_add_u32 v110, s53, v110
    v_mul_u32_u24 v111, 66816, v112
    v_lshl_add_u32 v111, v115, 4, v111
    s_mul_i32 s63, s44, 267264
    s_lshl_b32 s53, s2, 8
    s_add_u32 s63, s63, s53
    s_add_u32 s64, s63, 1069056
    v_cmp_gt_u32 vcc, 208, v0
    v_mov_b32 v100, 2130706432
    v_cmp_le_u32 s[92:93], 24, v26
    v_cndmask_b32 v22, v100, v111, vcc
    s_mov_b32 s62, 0x3f803f80
    s_mov_b32 s61, 0xffff0000
    v_mov_b32 v96, 0
    v_mov_b32 v97, 0
    v_and_b32 v117, 1, v112
    v_lshlrev_b32 v117, 5, v117
    s_mul_i32 s53, s44, 56
    s_and_b32 s54, s48, 1
    s_lshl_b32 s54, s54, 5
    s_add_u32 s53, s53, s54
    v_lshlrev_b32 v118, 11, v112
    v_lshl_add_u32 v118, v113, 8, v118
    v_add_u32 v118, 65536, v118
    v_lshl_add_u32 v119, v114, 3, s53
    v_add_u32 v119, 0, v119
    v_xor_b32 v119, v119, v117
    v_lshl_add_u32 v119, v113, 6, v119
    v_and_b32 v119, 255, v119
    v_add_u32 v6, v118, v119
    v_add_u32 v10, 49152, v6
    v_subrev_u32 v120, 65536, v6
    v_lshl_add_u32 v119, v114, 3, s53
    v_add_u32 v119, 32, v119
    v_xor_b32 v119, v119, v117
    v_lshl_add_u32 v119, v113, 6, v119
    v_and_b32 v119, 255, v119
    v_add_u32 v7, v118, v119
    v_add_u32 v11, 49152, v7
    v_subrev_u32 v121, 65536, v7
    s_and_b32 s54, s44, 1
    s_lshl_b32 s54, s54, 3
    s_sub_u32 s53, s53, s54
    v_lshl_add_u32 v119, v114, 4, s53
    v_add_u32 v119, 0, v119
    v_xor_b32 v119, v119, v117
    v_lshl_add_u32 v119, v113, 6, v119
    v_and_b32 v119, 255, v119
    v_add_u32 v8, v118, v119
    v_add_u32 v12, 49152, v8
    v_subrev_u32 v122, 65536, v8
    v_lshl_add_u32 v119, v114, 4, s53
    v_add_u32 v119, 8, v119
    v_xor_b32 v119, v119, v117
    v_lshl_add_u32 v119, v113, 6, v119
    v_and_b32 v119, 255, v119
    v_add_u32 v9, v118, v119
    v_add_u32 v13, 49152, v9
    v_subrev_u32 v123, 65536, v9
    s_waitcnt vmcnt(4)
    v_dot2c_f32_bf16 v96, s62, v32
    v_dot2c_f32_bf16 v97, v32, v32
    v_lshlrev_b32 v40, 16, v32
    v_and_b32 v41, s61, v32
    v_dot2c_f32_bf16 v96, s62, v33
    v_dot2c_f32_bf16 v97, v33, v33
    v_lshlrev_b32 v42, 16, v33
    v_and_b32 v43, s61, v33
    v_dot2c_f32_bf16 v96, s62, v34
    v_dot2c_f32_bf16 v97, v34, v34
    v_lshlrev_b32 v44, 16, v34
    v_and_b32 v45, s61, v34
    v_dot2c_f32_bf16 v96, s62, v35
    v_dot2c_f32_bf16 v97, v35, v35
    v_lshlrev_b32 v46, 16, v35
    v_and_b32 v47, s61, v35
    s_waitcnt vmcnt(3)
    v_dot2c_f32_bf16 v96, s62, v36
    v_dot2c_f32_bf16 v97, v36, v36
    v_lshlrev_b32 v48, 16, v36
    v_and_b32 v49, s61, v36
    v_dot2c_f32_bf16 v96, s62, v37
    v_dot2c_f32_bf16 v97, v37, v37
    v_lshlrev_b32 v50, 16, v37
    v_and_b32 v51, s61, v37
    v_dot2c_f32_bf16 v96, s62, v38
    v_dot2c_f32_bf16 v97, v38, v38
    v_lshlrev_b32 v52, 16, v38
    v_and_b32 v53, s61, v38
    v_dot2c_f32_bf16 v96, s62, v39
    v_dot2c_f32_bf16 v97, v39, v39
    v_lshlrev_b32 v54, 16, v39
    v_and_b32 v55, s61, v39
    buffer_load_dword v29, off, s[40:43], 0 sc1
    v_add_f32_dpp v96, v96, v96 quad_perm:[1,0,3,2] row_mask:0xf bank_mask:0xf
    v_add_f32_dpp v97, v97, v97 quad_perm:[1,0,3,2] row_mask:0xf bank_mask:0xf
    s_nop 0
    v_add_f32_dpp v96, v96, v96 quad_perm:[2,3,0,1] row_mask:0xf bank_mask:0xf
    v_add_f32_dpp v97, v97, v97 quad_perm:[2,3,0,1] row_mask:0xf bank_mask:0xf
    s_nop 0
    v_add_f32_dpp v96, v96, v96 row_half_mirror row_mask:0xf bank_mask:0xf
    v_add_f32_dpp v97, v97, v97 row_half_mirror row_mask:0xf bank_mask:0xf
    s_nop 0
    v_add_f32_dpp v96, v96, v96 row_mirror row_mask:0xf bank_mask:0xf
    v_add_f32_dpp v97, v97, v97 row_mirror row_mask:0xf bank_mask:0xf
    v_mov_b32 v98, v96
    v_mov_b32 v99, v97
    s_nop 0
    v_permlane16_swap_b32 v96, v98
    v_permlane16_swap_b32 v97, v99
    v_add_f32 v96, v96, v98
    v_add_f32 v97, v97, v99
    v_mul_f32 v98, 0x3b124925, v96
    v_mul_f32 v99, 0x3b124925, v97
    v_fma_f32 v99, -v98, v98, v99
    v_max_f32 v99, 0, v99
    v_cvt_pk_bf16_f32 v100, 0, v99
    v_add_f32 v100, 0x3727c5ac, v100
    v_cvt_pk_bf16_f32 v100, 0, v100
    v_sqrt_f32 v100, v100
    s_nop 0
    v_cvt_pk_bf16_f32 v100, 0, v100
    v_rcp_f32 v100, v100
    s_nop 0
    v_mul_f32 v99, v99, v100
    v_mul_f32 v99, v99, v100
    v_cvt_pk_bf16_f32 v104, 0, v99
    v_add_f32 v104, 0x3727c5ac, v104
    v_cvt_pk_bf16_f32 v104, 0, v104
    v_sqrt_f32 v104, v104
    s_nop 0
    v_cvt_pk_bf16_f32 v102, 0, v104
    v_rcp_f32 v104, v102
    s_nop 0
    v_mul_f32 v104, v104, v100
    v_mul_f32 v106, v98, v104
    v_pk_fma_f32 v[56:57], v[40:41], v[104:105], v[106:107] op_sel_hi:[1,0,0] neg_lo:[0,0,1] neg_hi:[0,0,1]
    v_pk_fma_f32 v[58:59], v[42:43], v[104:105], v[106:107] op_sel_hi:[1,0,0] neg_lo:[0,0,1] neg_hi:[0,0,1]
    v_pk_fma_f32 v[60:61], v[44:45], v[104:105], v[106:107] op_sel_hi:[1,0,0] neg_lo:[0,0,1] neg_hi:[0,0,1]
    v_pk_fma_f32 v[62:63], v[46:47], v[104:105], v[106:107] op_sel_hi:[1,0,0] neg_lo:[0,0,1] neg_hi:[0,0,1]
    v_pk_fma_f32 v[64:65], v[48:49], v[104:105], v[106:107] op_sel_hi:[1,0,0] neg_lo:[0,0,1] neg_hi:[0,0,1]
    v_pk_fma_f32 v[66:67], v[50:51], v[104:105], v[106:107] op_sel_hi:[1,0,0] neg_lo:[0,0,1] neg_hi:[0,0,1]
    v_pk_fma_f32 v[68:69], v[52:53], v[104:105], v[106:107] op_sel_hi:[1,0,0] neg_lo:[0,0,1] neg_hi:[0,0,1]
    v_pk_fma_f32 v[70:71], v[54:55], v[104:105], v[106:107] op_sel_hi:[1,0,0] neg_lo:[0,0,1] neg_hi:[0,0,1]
    v_cvt_pk_bf16_f32 v80, v56, v57
    v_cvt_pk_bf16_f32 v81, v58, v59
    v_cvt_pk_bf16_f32 v82, v60, v61
    v_cvt_pk_bf16_f32 v83, v62, v63
    v_cvt_pk_bf16_f32 v84, v64, v65
    v_cvt_pk_bf16_f32 v85, v66, v67
    v_cvt_pk_bf16_f32 v86, v68, v69
    v_cvt_pk_bf16_f32 v87, v70, v71
    v_lshrrev_b32 v102, 16, v102
    v_cndmask_b32 v84, v84, v102, s[92:93]
    ds_write_b128 v109, v[80:83] offset:49152
    ds_write_b128 v109, v[84:87] offset:49664
    s_waitcnt lgkmcnt(0)
    s_barrier
    ds_read_b64_tr_b16 v[88:89], v110 offset:49152
    ds_read_b64_tr_b16 v[90:91], v110 offset:53504
    ds_read_b64_tr_b16 v[92:93], v110 offset:49664
    ds_read_b64_tr_b16 v[94:95], v110 offset:54016
    s_waitcnt lgkmcnt(2)
    buffer_store_dwordx4 v[88:91], v111, s[24:27], s63 offen sc1
    s_waitcnt lgkmcnt(0)
    buffer_store_dwordx4 v[92:95], v22, s[24:27], s64 offen sc1
    s_add_u32 m0, s90, 73728
    s_mov_b32 s57, 86912
    buffer_load_dwordx4 v2, s[8:11], s57 offen offset:0 lds
    s_movk_i32 s94, 224
    v_mul_u32_u24 v3, 66816, v116
    v_and_b32 v118, 1, v112
    v_lshlrev_b32 v119, 2, v118
    v_xor_b32 v119, v119, v115
    v_lshl_add_u32 v3, v118, 8, v3
    v_lshl_add_u32 v3, v119, 4, v3
    v_cmp_gt_u32 s[92:93], s94, v0
    v_mov_b32 v119, 2130706432
    s_mov_b32 s57, 96640
    buffer_load_dwordx4 v2, s[8:11], s57 offen offset:1024 lds
    v_lshlrev_b32 v4, 9, v116
    v_cndmask_b32 v24, v119, v3, s[92:93]
    v_lshl_add_u32 v4, v118, 7, v4
    v_lshl_add_u32 v4, v113, 4, v4
    v_lshrrev_b32 v118, 1, v114
    v_mul_u32_u24 v118, 320, v118
    v_add_u32 v4, v118, v4
    v_and_b32 v118, 1, v114
    v_lshl_add_u32 v4, v118, 3, v4
    v_xor_b32 v25, 64, v4
    s_lshl_b32 s53, s49, 4
    s_sub_u32 s53, s53, 2
    v_min_u32 v117, 17, v1
    v_add_u32 v117, s53, v117
    v_max_i32 v117, 0, v117
    v_lshlrev_b32 v19, 5, v117
    s_add_u32 m0, s90, 81920
    s_mov_b32 s57, 172928
    buffer_load_dwordx4 v2, s[8:11], s57 offen offset:0 lds
    v_add_u32 v19, 12582912, v19
    v_and_b32 v117, 1, v115
    v_cmp_eq_u32 s[76:77], 1, v117
    v_lshl_add_u32 v117, v112, 2, v117
    v_cmp_le_u32 s[78:79], v117, v115
    v_mul_u32_u24 v118, 304, v116
    v_lshl_add_u32 v93, v117, 1, v118
    v_add_u32 v117, 2, v117
    v_cmp_le_u32 s[80:81], v117, v115
    v_add_u32 v94, 4, v93
    v_mov_b32 v118, 14336
    v_mov_b32 v119, 30720
    v_cndmask_b32 v117, v118, v119, s[78:79]
    v_add_u32 v93, v117, v93
    v_cndmask_b32 v117, v118, v119, s[80:81]
    v_add_u32 v94, v117, v94
    s_mov_b32 s57, 182656
    buffer_load_dwordx4 v2, s[8:11], s57 offen offset:1024 lds
    v_lshrrev_b32 v117, 3, v115
    v_mul_u32_u24 v117, 304, v117
    v_lshl_add_u32 v92, v115, 1, v117
    v_add_u32 v92, v119, v92
    v_cmp_eq_u32 s[82:83], 3, v112
    v_mov_b32 v117, 0xffff
    v_mov_b32 v118, 0xffff0000
    v_cndmask_b32 v117, v117, v118, s[76:77]
    v_cndmask_b32 v14, v117, 0, s[78:79]
    v_cndmask_b32 v15, v117, 0, s[80:81]
    v_cndmask_b32 v16, 0, v117, s[78:79]
    v_cndmask_b32 v17, 0, v117, s[80:81]
    s_mov_b32 s91, 0x3e8b97f6
    v_mov_b32 v18, 0xf149f2ca
    s_lshl_b32 s53, s49, 3
    s_lshl_b32 s72, s53, 9
    s_add_u32 m0, s90, 90112
    s_mov_b32 s57, 258944
    buffer_load_dwordx4 v2, s[8:11], s57 offen offset:0 lds
    s_lshl_b32 s74, s53, 14
    s_lshl2_add_u32 s54, s48, s44
    s_mul_i32 s54, s54, 7
    s_lshr_b32 s54, s54, 1
    s_lshl_b32 s54, s54, 8
    s_add_u32 s74, s74, s54
    s_add_u32 s74, s74, 4194304
    s_mul_i32 s68, s44, 534528
    s_add_u32 s68, s68, 0
    s_mul_i32 s69, s44, 534528
    s_add_u32 s69, s69, 132608
    s_mul_i32 s70, s44, 534528
    s_add_u32 s70, s70, 265216
    s_mul_i32 s71, s44, 534528
    s_add_u32 s71, s71, 397824
    s_cmp_eq_u32 s44, 3
    s_cselect_b32 s71, 2130706432, s71
    s_cmp_eq_u32 s49, 0
    s_cselect_b64 s[84:85], -1, 0
    s_andn2_b64 s[86:87], s[84:85], s[80:81]
    s_andn2_b64 s[84:85], s[84:85], s[78:79]
    s_bitcmp1_b32 s44, 0
    s_cselect_b64 s[88:89], -1, 0
    s_cselect_b32 s53, 0, 3
    s_cselect_b32 s54, 8, 0
    v_cmp_eq_u32 vcc, s53, v112
    s_lshr_b32 s53, s44, 1
    s_lshl_b32 s55, s53, 11
    s_add_u32 s54, s54, s55
    s_add_u32 s54, s54, 147456
    v_lshl_add_u32 v118, v115, 4, s54
    v_add_u32 v117, 151552, v23
    v_cndmask_b32 v95, v117, v118, vcc
    v_mov_b32 v117, 2130706432
    v_cndmask_b32 v23, v23, v117, vcc
    s_lshl1_add_u32 s53, s48, s53
    s_mul_i32 s53, s53, 1792
    s_and_b32 s54, s44, 1
    s_lshl1_add_u32 s54, s49, s54
    s_lshl_b32 s54, s54, 16
    s_add_u32 s53, s53, s54
    s_add_u32 s95, s53, 4195072
    s_and_b32 s53, s46, 7
    s_mul_i32 s54, s44, 28
    s_add_u32 s54, s54, s53
    s_add_u32 s54, s54, 12
    s_lshl_b32 s73, s54, 16
    s_lshl_b32 s54, s45, 9
    s_add_u32 s73, s73, s54
    s_lshl3_add_u32 s75, s44, s53
    s_lshl_b32 s75, s75, 13
    v_lshrrev_b32 v5, 2, v1
    v_lshlrev_b32 v5, 12, v5
    v_lshl_add_u32 v5, v114, 7, v5
    v_lshlrev_b32 v20, 7, v1
    s_mov_b32 s57, 268672
    buffer_load_dwordx4 v2, s[8:11], s57 offen offset:1024 lds
    s_add_u32 m0, s90, 98304
    s_mov_b32 s57, 344960
    buffer_load_dwordx4 v2, s[8:11], s57 offen offset:0 lds
    s_mov_b32 s57, 354688
    buffer_load_dwordx4 v2, s[8:11], s57 offen offset:1024 lds
    s_mov_b32 s59, s44
    s_mov_b64 exec, 0
    s_branch L_wa_go
L_wa_ret:
    s_add_u32 s59, s59, 4
L_wa_go:
    s_cmp_eq_u32 s59, 0
    s_cbranch_scc1 L_wa_0
    s_cmp_eq_u32 s59, 1
    s_cbranch_scc1 L_wa_1
    s_cmp_eq_u32 s59, 2
    s_cbranch_scc1 L_wa_2
    s_cmp_eq_u32 s59, 3
    s_cbranch_scc1 L_wa_3
    s_cmp_eq_u32 s59, 4
    s_cbranch_scc1 L_wa_3
    s_mov_b64 exec, -1
    s_add_u32 m0, s90, 106496
    s_mov_b32 s57, 430976
    buffer_load_dwordx4 v2, s[8:11], s57 offen offset:0 lds
    s_mov_b32 s57, 440704
    buffer_load_dwordx4 v2, s[8:11], s57 offen offset:1024 lds
    s_add_u32 m0, s90, 114688
    s_mov_b32 s57, 516992
    buffer_load_dwordx4 v2, s[8:11], s57 offen offset:0 lds
    s_mov_b32 s57, 526720
    buffer_load_dwordx4 v2, s[8:11], s57 offen offset:1024 lds
    s_add_u32 m0, s90, 122880
    s_mov_b32 s57, 603008
    buffer_load_dwordx4 v2, s[8:11], s57 offen offset:0 lds
    s_mov_b32 s57, 612736
    buffer_load_dwordx4 v2, s[8:11], s57 offen offset:1024 lds
    s_add_u32 m0, s90, 131072
    s_mov_b32 s57, 689024
    buffer_load_dwordx4 v2, s[8:11], s57 offen offset:0 lds
    s_mov_b32 s57, 698752
    buffer_load_dwordx4 v2, s[8:11], s57 offen offset:1024 lds
    s_add_u32 m0, s90, 139264
    s_mov_b32 s57, 775040
    buffer_load_dwordx4 v2, s[8:11], s57 offen offset:0 lds
    s_mov_b32 s57, 784768
    buffer_load_dwordx4 v2, s[8:11], s57 offen offset:1024 lds
    s_add_u32 m0, s90, 147456
    s_mov_b32 s57, 861056
    buffer_load_dwordx4 v2, s[8:11], s57 offen offset:0 lds
    s_mov_b32 s57, 870784
    buffer_load_dwordx4 v2, s[8:11], s57 offen offset:1024 lds
    s_waitcnt vmcnt(20)
    v_cmp_eq_u32 vcc, 0, v29
    s_nop 0
    s_cbranch_vccz L_ok17
    s_mov_b32 s59, 100000
L_spin16:
    buffer_load_dword v29, off, s[40:43], 0 sc1
    s_waitcnt vmcnt(0)
    v_cmp_eq_u32 vcc, 0, v29
    s_nop 0
    s_cbranch_vccz L_ok17
    s_sub_u32 s59, s59, 1
    s_cbranch_scc0 L_spin16
L_ok17:
    v_readfirstlane_b32 s47, v29
    s_barrier
    s_cmp_lg_u32 s44, 0
    s_cbranch_scc1 L_nopub18
    s_lshl_b32 s60, s2, 5
    s_add_u32 s60, s60, 12582912
    v_mov_b32 v30, s47
    s_mov_b64 exec, 1
    buffer_store_dword v30, off, s[24:27], s60 sc1
    s_mov_b64 exec, -1
L_nopub18:
    s_waitcnt vmcnt(16)
    s_barrier
    s_add_u32 m0, s90, 155648
    s_mov_b32 s57, 947072
    buffer_load_dwordx4 v2, s[8:11], s57 offen offset:0 lds
    s_mov_b32 s57, 956800
    buffer_load_dwordx4 v2, s[8:11], s57 offen offset:1024 lds
    ds_read_b64_tr_b16 a[8:9], v6 offset:0
    ds_read_b64_tr_b16 a[10:11], v6 offset:1024
    ds_read_b64_tr_b16 a[12:13], v7 offset:0
    ds_read_b64_tr_b16 a[14:15], v7 offset:1024
    s_add_u32 m0, s90, 0
    s_mov_b32 s57, 1033088
    buffer_load_dwordx4 v2, s[8:11], s57 offen offset:0 lds
    s_mov_b32 s57, 1042816
    buffer_load_dwordx4 v2, s[8:11], s57 offen offset:1024 lds
    ds_read_b64_tr_b16 a[32:33], v6 offset:8192
    ds_read_b64_tr_b16 a[34:35], v6 offset:9216
    ds_read_b64_tr_b16 a[36:37], v7 offset:8192
    ds_read_b64_tr_b16 a[38:39], v7 offset:9216
    s_add_u32 m0, s90, 8192
    s_mov_b32 s57, 1119104
    buffer_load_dwordx4 v2, s[8:11], s57 offen offset:0 lds
    s_mov_b32 s57, 1128832
    buffer_load_dwordx4 v2, s[8:11], s57 offen offset:1024 lds
    ds_read_b64_tr_b16 a[56:57], v6 offset:16384
    ds_read_b64_tr_b16 a[58:59], v6 offset:17408
    ds_read_b64_tr_b16 a[60:61], v7 offset:16384
    ds_read_b64_tr_b16 a[62:63], v7 offset:17408
    s_waitcnt vmcnt(16)
    s_waitcnt lgkmcnt(0)
    s_barrier
    s_add_u32 m0, s90, 16384
    s_mov_b32 s57, 1792
    buffer_load_dwordx4 v2, s[8:11], s57 offen offset:0 lds
    s_mov_b32 s57, 11520
    buffer_load_dwordx4 v2, s[8:11], s57 offen offset:1024 lds
    ds_read_b64_tr_b16 a[80:81], v6 offset:24576
    ds_read_b64_tr_b16 a[82:83], v6 offset:25600
    ds_read_b64_tr_b16 a[84:85], v7 offset:24576
    ds_read_b64_tr_b16 a[86:87], v7 offset:25600
    s_add_u32 m0, s90, 24576
    s_mov_b32 s57, 87808
    buffer_load_dwordx4 v2, s[8:11], s57 offen offset:0 lds
    s_mov_b32 s57, 97536
    buffer_load_dwordx4 v2, s[8:11], s57 offen offset:1024 lds
    ds_read_b64_tr_b16 a[104:105], v6 offset:32768
    ds_read_b64_tr_b16 a[106:107], v6 offset:33792
    ds_read_b64_tr_b16 a[108:109], v7 offset:32768
    ds_read_b64_tr_b16 a[110:111], v7 offset:33792
    s_add_u32 m0, s90, 32768
    s_mov_b32 s57, 173824
    buffer_load_dwordx4 v2, s[8:11], s57 offen offset:0 lds
    s_mov_b32 s57, 183552
    buffer_load_dwordx4 v2, s[8:11], s57 offen offset:1024 lds
    ds_read_b64_tr_b16 a[128:129], v6 offset:40960
    ds_read_b64_tr_b16 a[130:131], v6 offset:41984
    ds_read_b64_tr_b16 a[132:133], v7 offset:40960
    ds_read_b64_tr_b16 a[134:135], v7 offset:41984
    s_waitcnt vmcnt(16)
    s_waitcnt lgkmcnt(0)
    s_barrier
    s_add_u32 m0, s90, 40960
    s_mov_b32 s57, 259840
    buffer_load_dwordx4 v2, s[8:11], s57 offen offset:0 lds
    s_mov_b32 s57, 269568
    buffer_load_dwordx4 v2, s[8:11], s57 offen offset:1024 lds
    ds_read_b64_tr_b16 a[152:153], v10 offset:0
    ds_read_b64_tr_b16 a[154:155], v10 offset:1024
    ds_read_b64_tr_b16 a[156:157], v11 offset:0
    ds_read_b64_tr_b16 a[158:159], v11 offset:1024
    s_add_u32 m0, s90, 65536
    s_mov_b32 s57, 345856
    buffer_load_dwordx4 v2, s[8:11], s57 offen offset:0 lds
    s_mov_b32 s57, 355584
    buffer_load_dwordx4 v2, s[8:11], s57 offen offset:1024 lds
    ds_read_b64_tr_b16 a[176:177], v10 offset:8192
    ds_read_b64_tr_b16 a[178:179], v10 offset:9216
    ds_read_b64_tr_b16 a[180:181], v11 offset:8192
    ds_read_b64_tr_b16 a[182:183], v11 offset:9216
    s_add_u32 m0, s90, 73728
    s_mov_b32 s57, 431872
    buffer_load_dwordx4 v2, s[8:11], s57 offen offset:0 lds
    s_mov_b32 s57, 441600
    buffer_load_dwordx4 v2, s[8:11], s57 offen offset:1024 lds
    ds_read_b64_tr_b16 a[200:201], v10 offset:16384
    ds_read_b64_tr_b16 a[202:203], v10 offset:17408
    ds_read_b64_tr_b16 a[204:205], v11 offset:16384
    ds_read_b64_tr_b16 a[206:207], v11 offset:17408
    s_waitcnt vmcnt(16)
    s_waitcnt lgkmcnt(0)
    s_barrier
    ds_read_b64_tr_b16 a[224:225], v10 offset:24576
    ds_read_b64_tr_b16 a[226:227], v10 offset:25600
    ds_read_b64_tr_b16 a[228:229], v11 offset:24576
    ds_read_b64_tr_b16 a[230:231], v11 offset:25600
    ds_read_b64_tr_b16 a[248:249], v10 offset:32768
    ds_read_b64_tr_b16 a[250:251], v10 offset:33792
    ds_read_b64_tr_b16 a[252:253], v11 offset:32768
    ds_read_b64_tr_b16 a[254:255], v11 offset:33792
    s_add_u32 m0, s90, 81920
    s_mov_b32 s57, 517888
    buffer_load_dwordx4 v2, s[8:11], s57 offen offset:0 lds
    ds_read_b64_tr_b16 v[192:193], v10 offset:40960
    ds_read_b64_tr_b16 v[194:195], v10 offset:41984
    ds_read_b64_tr_b16 v[196:197], v11 offset:40960
    ds_read_b64_tr_b16 v[198:199], v11 offset:41984
    s_mov_b32 s57, 527616
    buffer_load_dwordx4 v2, s[8:11], s57 offen offset:1024 lds
    s_waitcnt vmcnt(12)
    s_waitcnt lgkmcnt(0)
    s_barrier
    ds_read_b64_tr_b16 v[216:217], v120 offset:0
    ds_read_b64_tr_b16 v[218:219], v120 offset:1024
    ds_read_b64_tr_b16 v[220:221], v121 offset:0
    ds_read_b64_tr_b16 v[222:223], v121 offset:1024
    ds_read_b64_tr_b16 v[240:241], v120 offset:8192
    ds_read_b64_tr_b16 v[242:243], v120 offset:9216
    ds_read_b64_tr_b16 v[244:245], v121 offset:8192
    ds_read_b64_tr_b16 v[246:247], v121 offset:9216
    ds_read_b64_tr_b16 a[16:17], v122 offset:16384
    ds_read_b64_tr_b16 a[18:19], v122 offset:17408
    ds_read_b64_tr_b16 a[20:21], v123 offset:16384
    ds_read_b64_tr_b16 a[22:23], v123 offset:17408
    buffer_load_dword v21, v19, s[24:27], 0 offen sc1
    s_add_u32 m0, s90, 90112
    s_mov_b32 s57, 603904
    buffer_load_dwordx4 v2, s[8:11], s57 offen offset:0 lds
    s_mov_b32 s57, 613632
    buffer_load_dwordx4 v2, s[8:11], s57 offen offset:1024 lds
    s_add_u32 m0, s90, 98304
    s_mov_b32 s57, 689920
    buffer_load_dwordx4 v2, s[8:11], s57 offen offset:0 lds
    s_mov_b32 s57, 699648
    buffer_load_dwordx4 v2, s[8:11], s57 offen offset:1024 lds
    s_add_u32 m0, s90, 106496
    s_mov_b32 s57, 775936
    buffer_load_dwordx4 v2, s[8:11], s57 offen offset:0 lds
    s_waitcnt vmcnt(12)
    s_waitcnt lgkmcnt(0)
    s_barrier
    ds_read_b64_tr_b16 a[40:41], v122 offset:24576
    ds_read_b64_tr_b16 a[42:43], v122 offset:25600
    ds_read_b64_tr_b16 a[44:45], v123 offset:24576
    ds_read_b64_tr_b16 a[46:47], v123 offset:25600
    ds_read_b64_tr_b16 a[64:65], v122 offset:32768
    ds_read_b64_tr_b16 a[66:67], v122 offset:33792
    ds_read_b64_tr_b16 a[68:69], v123 offset:32768
    ds_read_b64_tr_b16 a[70:71], v123 offset:33792
    ds_read_b64_tr_b16 a[88:89], v122 offset:40960
    ds_read_b64_tr_b16 a[90:91], v122 offset:41984
    ds_read_b64_tr_b16 a[92:93], v123 offset:40960
    ds_read_b64_tr_b16 a[94:95], v123 offset:41984
    s_mov_b32 s57, 785664
    buffer_load_dwordx4 v2, s[8:11], s57 offen offset:1024 lds
    s_waitcnt vmcnt(7)
    s_waitcnt lgkmcnt(0)
    s_barrier
    ds_read_b64_tr_b16 a[112:113], v8 offset:0
    ds_read_b64_tr_b16 a[114:115], v8 offset:1024
    ds_read_b64_tr_b16 a[116:117], v9 offset:0
    ds_read_b64_tr_b16 a[118:119], v9 offset:1024
    ds_read_b64_tr_b16 a[136:137], v8 offset:8192
    ds_read_b64_tr_b16 a[138:139], v8 offset:9216
    ds_read_b64_tr_b16 a[140:141], v9 offset:8192
    ds_read_b64_tr_b16 a[142:143], v9 offset:9216
    ds_read_b64_tr_b16 a[160:161], v8 offset:16384
    ds_read_b64_tr_b16 a[162:163], v8 offset:17408
    ds_read_b64_tr_b16 a[164:165], v9 offset:16384
    ds_read_b64_tr_b16 a[166:167], v9 offset:17408
    s_waitcnt vmcnt(6)
    v_cmp_ne_u32 vcc, s47, v21
    s_nop 0
    s_cbranch_vccz L_ok20
    s_mov_b32 s59, 100000
L_spin19:
    buffer_load_dword v21, v19, s[24:27], 0 offen sc1
    s_waitcnt vmcnt(0)
    v_cmp_ne_u32 vcc, s47, v21
    s_nop 0
    s_cbranch_vccz L_ok20
    s_sub_u32 s59, s59, 1
    s_cbranch_scc0 L_spin19
L_ok20:
    s_add_u32 m0, s52, 0
    s_sub_u32 s58, s72, 512
    s_max_i32 s58, s58, 0
    s_add_u32 s57, s58, s68
    buffer_load_dwordx4 v3, s[24:27], s57 offen offset:0 sc1 lds
    s_add_u32 s57, s58, s69
    buffer_load_dwordx4 v3, s[24:27], s57 offen offset:1024 sc1 lds
    s_add_u32 s57, s58, s70
    buffer_load_dwordx4 v24, s[24:27], s57 offen offset:2048 sc1 lds
    s_add_u32 s57, s58, s71
    buffer_load_dwordx4 v3, s[24:27], s57 offen offset:3072 sc1 lds
    s_add_u32 m0, s52, 16384
    s_add_u32 s58, s72, 0
    s_add_u32 s57, s58, s68
    buffer_load_dwordx4 v3, s[24:27], s57 offen offset:0 sc1 lds
    s_add_u32 s57, s58, s69
    buffer_load_dwordx4 v3, s[24:27], s57 offen offset:1024 sc1 lds
    s_add_u32 s57, s58, s70
    buffer_load_dwordx4 v24, s[24:27], s57 offen offset:2048 sc1 lds
    s_add_u32 s57, s58, s71
    buffer_load_dwordx4 v3, s[24:27], s57 offen offset:3072 sc1 lds
    s_add_u32 m0, s90, 114688
    s_mov_b32 s57, 861952
    buffer_load_dwordx4 v2, s[8:11], s57 offen offset:0 lds
    s_mov_b32 s57, 871680
    buffer_load_dwordx4 v2, s[8:11], s57 offen offset:1024 lds
    s_add_u32 m0, s90, 122880
    s_mov_b32 s57, 947968
    buffer_load_dwordx4 v2, s[8:11], s57 offen offset:0 lds
    s_mov_b32 s57, 957696
    buffer_load_dwordx4 v2, s[8:11], s57 offen offset:1024 lds
    s_add_u32 m0, s90, 131072
    s_mov_b32 s57, 1033984
    buffer_load_dwordx4 v2, s[8:11], s57 offen offset:0 lds
    s_mov_b32 s57, 1043712
    buffer_load_dwordx4 v2, s[8:11], s57 offen offset:1024 lds
    s_add_u32 m0, s52, 32768
    s_add_u32 s58, s72, 512
    s_add_u32 s57, s58, s68
    buffer_load_dwordx4 v3, s[24:27], s57 offen offset:0 sc1 lds
    s_add_u32 s57, s58, s69
    buffer_load_dwordx4 v3, s[24:27], s57 offen offset:1024 sc1 lds
    s_waitcnt vmcnt(12)
    s_waitcnt lgkmcnt(0)
    s_barrier
    ds_read_b64_tr_b16 v[120:121], v4 offset:0
    ds_read_b64_tr_b16 v[122:123], v25 offset:0
    ds_read_b64_tr_b16 v[124:125], v4 offset:1024
    ds_read_b64_tr_b16 v[126:127], v25 offset:1024
    ds_read_b64_tr_b16 v[128:129], v4 offset:2048
    ds_read_b64_tr_b16 v[130:131], v25 offset:2048
    ds_read_b64_tr_b16 v[132:133], v4 offset:3072
    ds_read_b64_tr_b16 v[134:135], v25 offset:3072
    ds_read_b64_tr_b16 v[136:137], v4 offset:4096
    ds_read_b64_tr_b16 v[138:139], v25 offset:4096
    ds_read_b64_tr_b16 v[140:141], v4 offset:5120
    ds_read_b64_tr_b16 v[142:143], v25 offset:5120
    ds_read_b64_tr_b16 v[144:145], v4 offset:6144
    ds_read_b64_tr_b16 v[146:147], v25 offset:6144
    ds_read_b64_tr_b16 v[148:149], v4 offset:7168
    ds_read_b64_tr_b16 v[150:151], v25 offset:7168
    ds_read_b64_tr_b16 v[152:153], v4 offset:8192
    ds_read_b64_tr_b16 v[154:155], v25 offset:8192
    ds_read_b64_tr_b16 v[156:157], v4 offset:9216
    ds_read_b64_tr_b16 v[158:159], v25 offset:9216
    ds_read_b64_tr_b16 v[160:161], v4 offset:10240
    ds_read_b64_tr_b16 v[162:163], v25 offset:10240
    ds_read_b64_tr_b16 v[164:165], v4 offset:11264
    ds_read_b64_tr_b16 v[166:167], v25 offset:11264
    ds_read_b64_tr_b16 v[168:169], v4 offset:12288
    ds_read_b64_tr_b16 v[170:171], v25 offset:12288
    ds_read_b64_tr_b16 v[172:173], v4 offset:13312
    ds_read_b64_tr_b16 v[174:175], v25 offset:13312
    s_waitcnt lgkmcnt(15)
    v_mfma_f32_16x16x32_bf16 v[96:99], a[8:11], v[120:123], 0
    s_add_u32 s57, s58, s70
    ds_read_b64_tr_b16 a[184:185], v8 offset:24576
    v_mfma_f32_16x16x32_bf16 v[96:99], a[32:35], v[124:127], v[96:99]
    buffer_load_dwordx4 v24, s[24:27], s57 offen offset:2048 sc1 lds
    v_mfma_f32_16x16x32_bf16 v[96:99], a[56:59], v[128:131], v[96:99]
    ds_read_b64_tr_b16 a[186:187], v8 offset:25600
    ds_read_b64_tr_b16 a[188:189], v9 offset:24576
    v_mfma_f32_16x16x32_bf16 v[96:99], a[80:83], v[132:135], v[96:99]
    ds_read_b64_tr_b16 a[190:191], v9 offset:25600
    ds_read_b64_tr_b16 a[208:209], v8 offset:32768
    v_mfma_f32_16x16x32_bf16 v[96:99], a[104:107], v[136:139], v[96:99]
    s_add_u32 s57, s58, s71
    ds_read_b64_tr_b16 a[210:211], v8 offset:33792
    v_mfma_f32_16x16x32_bf16 v[96:99], a[128:131], v[140:143], v[96:99]
    buffer_load_dwordx4 v3, s[24:27], s57 offen offset:3072 sc1 lds
    s_waitcnt lgkmcnt(15)
    v_mfma_f32_16x16x32_bf16 v[96:99], a[152:155], v[144:147], v[96:99]
    ds_read_b64_tr_b16 a[212:213], v9 offset:32768
    ds_read_b64_tr_b16 a[214:215], v9 offset:33792
    v_mfma_f32_16x16x32_bf16 v[96:99], a[176:179], v[148:151], v[96:99]
    ds_read_b64_tr_b16 a[232:233], v8 offset:40960
    ds_read_b64_tr_b16 a[234:235], v8 offset:41984
    s_waitcnt lgkmcnt(15)
    v_mfma_f32_16x16x32_bf16 v[96:99], a[200:203], v[152:155], v[96:99]
    s_add_u32 m0, s90, 139264
    s_mov_b32 s57, 1120000
    ds_read_b64_tr_b16 a[236:237], v9 offset:40960
    v_mfma_f32_16x16x32_bf16 v[96:99], a[224:227], v[156:159], v[96:99]
    buffer_load_dwordx4 v2, s[8:11], s57 offen offset:0 lds
    s_waitcnt lgkmcnt(15)
    v_mfma_f32_16x16x32_bf16 v[96:99], a[248:251], v[160:163], v[96:99]
    ds_read_b64_tr_b16 a[238:239], v9 offset:41984
    v_mfma_f32_16x16x32_bf16 v[96:99], v[192:195], v[164:167], v[96:99]
    s_waitcnt lgkmcnt(12)
    v_mfma_f32_16x16x32_bf16 v[96:99], v[216:219], v[168:171], v[96:99]
    s_mov_b32 s57, 1129728
    v_mfma_f32_16x16x32_bf16 v[96:99], v[240:243], v[172:175], v[96:99]
    buffer_load_dwordx4 v2, s[8:11], s57 offen offset:1024 lds
    s_waitcnt vmcnt(12)
    s_barrier
    v_mfma_f32_16x16x32_bf16 v[100:103], a[12:15], v[120:123], 0
    ds_read_b64_tr_b16 v[120:121], v4 offset:16384
    ds_read_b64_tr_b16 v[122:123], v25 offset:16384
    v_mfma_f32_16x16x32_bf16 v[100:103], a[36:39], v[124:127], v[100:103]
    ds_read_b64_tr_b16 v[124:125], v4 offset:17408
    v_mfma_f32_16x16x32_bf16 v[100:103], a[60:63], v[128:131], v[100:103]
    ds_read_b64_tr_b16 v[126:127], v25 offset:17408
    ds_read_b64_tr_b16 v[128:129], v4 offset:18432
    s_add_u32 m0, s90, 147456
    s_mov_b32 s57, 0
    v_mfma_f32_16x16x32_bf16 v[100:103], a[84:87], v[132:135], v[100:103]
    buffer_load_dwordx4 v2, s[8:11], s57 offen offset:0 lds
    v_mfma_f32_16x16x32_bf16 v[100:103], a[108:111], v[136:139], v[100:103]
    ds_read_b64_tr_b16 v[130:131], v25 offset:18432
    ds_read_b64_tr_b16 v[132:133], v4 offset:19456
    v_mfma_f32_16x16x32_bf16 v[100:103], a[132:135], v[140:143], v[100:103]
    ds_read_b64_tr_b16 v[134:135], v25 offset:19456
    ds_read_b64_tr_b16 v[136:137], v4 offset:20480
    v_mfma_f32_16x16x32_bf16 v[100:103], a[156:159], v[144:147], v[100:103]
    ds_read_b64_tr_b16 v[138:139], v25 offset:20480
    s_mov_b32 s57, 9728
    v_mfma_f32_16x16x32_bf16 v[100:103], a[180:183], v[148:151], v[100:103]
    buffer_load_dwordx4 v2, s[8:11], s57 offen offset:1024 lds
    v_mfma_f32_16x16x32_bf16 v[100:103], a[204:207], v[152:155], v[100:103]
    ds_read_b64_tr_b16 v[140:141], v4 offset:21504
    ds_read_b64_tr_b16 v[142:143], v25 offset:21504
    v_mfma_f32_16x16x32_bf16 v[100:103], a[228:231], v[156:159], v[100:103]
    ds_read_b64_tr_b16 v[144:145], v4 offset:22528
    ds_read_b64_tr_b16 v[146:147], v25 offset:22528
    v_mfma_f32_16x16x32_bf16 v[100:103], a[252:255], v[160:163], v[100:103]
    ds_read_b64_tr_b16 v[148:149], v4 offset:23552
    ds_read_b64_tr_b16 v[150:151], v25 offset:23552
    s_add_u32 m0, s90, 155648
    s_mov_b32 s57, 86016
    v_mfma_f32_16x16x32_bf16 v[100:103], v[196:199], v[164:167], v[100:103]
    buffer_load_dwordx4 v2, s[8:11], s57 offen offset:0 lds
    v_mfma_f32_16x16x32_bf16 v[100:103], v[220:223], v[168:171], v[100:103]
    ds_read_b64_tr_b16 v[152:153], v4 offset:24576
    ds_read_b64_tr_b16 v[154:155], v25 offset:24576
    v_mfma_f32_16x16x32_bf16 v[100:103], v[244:247], v[172:175], v[100:103]
    ds_read_b64_tr_b16 v[156:157], v4 offset:25600
    ds_read_b64_tr_b16 v[158:159], v25 offset:25600
    s_waitcnt lgkmcnt(15)
    v_mfma_f32_16x16x32_bf16 v[104:107], a[8:11], v[120:123], 0
    ds_read_b64_tr_b16 v[160:161], v4 offset:26624
    s_mov_b32 s57, 95744
    v_mfma_f32_16x16x32_bf16 v[104:107], a[32:35], v[124:127], v[104:107]
    buffer_load_dwordx4 v2, s[8:11], s57 offen offset:1024 lds
    s_waitcnt lgkmcnt(13)
    v_mfma_f32_16x16x32_bf16 v[104:107], a[56:59], v[128:131], v[104:107]
    ds_read_b64_tr_b16 v[162:163], v25 offset:26624
    ds_read_b64_tr_b16 v[164:165], v4 offset:27648
    v_mfma_f32_16x16x32_bf16 v[104:107], a[80:83], v[132:135], v[104:107]
    ds_read_b64_tr_b16 v[166:167], v25 offset:27648
    ds_read_b64_tr_b16 v[168:169], v4 offset:28672
    s_waitcnt vmcnt(10)
    s_barrier
    s_waitcnt lgkmcnt(13)
    v_mfma_f32_16x16x32_bf16 v[104:107], a[104:107], v[136:139], v[104:107]
    ds_read_b64_tr_b16 v[170:171], v25 offset:28672
    ds_read_b64_tr_b16 v[172:173], v4 offset:29696
    s_add_u32 m0, s90, 65536
    s_mov_b32 s57, 172032
    v_mfma_f32_16x16x32_bf16 v[104:107], a[128:131], v[140:143], v[104:107]
    buffer_load_dwordx4 v2, s[8:11], s57 offen offset:0 lds
    s_waitcnt lgkmcnt(11)
    v_mfma_f32_16x16x32_bf16 v[104:107], a[152:155], v[144:147], v[104:107]
    ds_read_b64_tr_b16 v[174:175], v25 offset:29696
    v_cvt_pk_bf16_f32 v52, v96, v97
    v_mfma_f32_16x16x32_bf16 v[104:107], a[176:179], v[148:151], v[104:107]
    v_cvt_pk_bf16_f32 v53, v98, v99
    v_cvt_pk_bf16_f32 v54, v100, v101
    s_waitcnt lgkmcnt(8)
    v_mfma_f32_16x16x32_bf16 v[104:107], a[200:203], v[152:155], v[104:107]
    s_mov_b32 s57, 181760
    v_cvt_pk_bf16_f32 v55, v102, v103
    v_mfma_f32_16x16x32_bf16 v[104:107], a[224:227], v[156:159], v[104:107]
    buffer_load_dwordx4 v2, s[8:11], s57 offen offset:1024 lds
    s_waitcnt lgkmcnt(4)
    v_mfma_f32_16x16x32_bf16 v[104:107], a[248:251], v[160:163], v[104:107]
    v_cndmask_b32 v54, v54, 0, s[82:83]
    v_cndmask_b32 v55, v55, 0, s[82:83]
    v_mfma_f32_16x16x32_bf16 v[104:107], v[192:195], v[164:167], v[104:107]
    ds_read_b64_tr_b16 v[176:177], v12 offset:0
    ds_read_b64_tr_b16 v[178:179], v12 offset:1024
    s_waitcnt lgkmcnt(2)
    v_mfma_f32_16x16x32_bf16 v[104:107], v[216:219], v[168:171], v[104:107]
    s_add_u32 m0, s90, 73728
    s_mov_b32 s57, 258048
    ds_read_b64_tr_b16 v[180:181], v13 offset:0
    v_mfma_f32_16x16x32_bf16 v[104:107], v[240:243], v[172:175], v[104:107]
    buffer_load_dwordx4 v2, s[8:11], s57 offen offset:0 lds
    v_mfma_f32_16x16x32_bf16 v[108:111], a[12:15], v[120:123], 0
    ds_read_b64_tr_b16 v[182:183], v13 offset:1024
    ds_read_b64_tr_b16 v[200:201], v12 offset:8192
    v_mfma_f32_16x16x32_bf16 v[108:111], a[36:39], v[124:127], v[108:111]
    ds_read_b64_tr_b16 v[202:203], v12 offset:9216
    ds_read_b64_tr_b16 v[204:205], v13 offset:8192
    v_mfma_f32_16x16x32_bf16 v[108:111], a[60:63], v[128:131], v[108:111]
    s_mov_b32 s57, 267776
    ds_read_b64_tr_b16 v[206:207], v13 offset:9216
    v_mfma_f32_16x16x32_bf16 v[108:111], a[84:87], v[132:135], v[108:111]
    buffer_load_dwordx4 v2, s[8:11], s57 offen offset:1024 lds
    v_mfma_f32_16x16x32_bf16 v[108:111], a[108:111], v[136:139], v[108:111]
    ds_read_b64_tr_b16 v[224:225], v12 offset:16384
    ds_read_b64_tr_b16 v[226:227], v12 offset:17408
    v_mfma_f32_16x16x32_bf16 v[108:111], a[132:135], v[140:143], v[108:111]
    ds_read_b64_tr_b16 v[228:229], v13 offset:16384
    ds_read_b64_tr_b16 v[230:231], v13 offset:17408
    v_mfma_f32_16x16x32_bf16 v[108:111], a[156:159], v[144:147], v[108:111]
    s_add_u32 m0, s90, 81920
    s_mov_b32 s57, 344064
    v_cvt_pk_bf16_f32 v56, v104, v105
    v_mfma_f32_16x16x32_bf16 v[108:111], a[180:183], v[148:151], v[108:111]
    buffer_load_dwordx4 v2, s[8:11], s57 offen offset:0 lds
    v_mfma_f32_16x16x32_bf16 v[108:111], a[204:207], v[152:155], v[108:111]
    v_cvt_pk_bf16_f32 v57, v106, v107
    v_mfma_f32_16x16x32_bf16 v[108:111], a[228:231], v[156:159], v[108:111]
    v_mfma_f32_16x16x32_bf16 v[108:111], a[252:255], v[160:163], v[108:111]
    s_mov_b32 s57, 353792
    v_mfma_f32_16x16x32_bf16 v[108:111], v[196:199], v[164:167], v[108:111]
    buffer_load_dwordx4 v2, s[8:11], s57 offen offset:1024 lds
    v_mfma_f32_16x16x32_bf16 v[108:111], v[220:223], v[168:171], v[108:111]
    v_mfma_f32_16x16x32_bf16 v[108:111], v[244:247], v[172:175], v[108:111]
    v_mfma_f32_16x16x32_bf16 v[112:115], v[120:123], a[16:19], 0
    s_add_u32 m0, s90, 90112
    s_mov_b32 s57, 430080
    v_mfma_f32_16x16x32_bf16 v[112:115], v[124:127], a[40:43], v[112:115]
    buffer_load_dwordx4 v2, s[8:11], s57 offen offset:0 lds
    v_mfma_f32_16x16x32_bf16 v[112:115], v[128:131], a[64:67], v[112:115]
    v_mfma_f32_16x16x32_bf16 v[112:115], v[132:135], a[88:91], v[112:115]
    v_mfma_f32_16x16x32_bf16 v[112:115], v[136:139], a[112:115], v[112:115]
    s_mov_b32 s57, 439808
    v_mfma_f32_16x16x32_bf16 v[112:115], v[140:143], a[136:139], v[112:115]
    buffer_load_dwordx4 v2, s[8:11], s57 offen offset:1024 lds
    v_mfma_f32_16x16x32_bf16 v[112:115], v[144:147], a[160:163], v[112:115]
    v_cvt_pk_bf16_f32 v58, v108, v109
    v_cvt_pk_bf16_f32 v59, v110, v111
    v_mfma_f32_16x16x32_bf16 v[112:115], v[148:151], a[184:187], v[112:115]
    v_cndmask_b32 v58, v58, 0, s[82:83]
    v_cndmask_b32 v59, v59, 0, s[82:83]
    v_mfma_f32_16x16x32_bf16 v[112:115], v[152:155], a[208:211], v[112:115]
    s_add_u32 m0, s90, 98304
    s_mov_b32 s57, 516096
    buffer_load_dwordx4 v2, s[8:11], s57 offen offset:0 lds
    s_waitcnt vmcnt(9)
    s_waitcnt lgkmcnt(0)
    s_barrier
    ds_read_b64_tr_b16 v[248:249], v12 offset:24576
    ds_read_b64_tr_b16 v[250:251], v12 offset:25600
    ds_read_b64_tr_b16 v[252:253], v13 offset:24576
    ds_read_b64_tr_b16 v[254:255], v13 offset:25600
    v_mfma_f32_16x16x32_bf16 v[112:115], v[156:159], a[232:235], v[112:115]
    ds_read_b64_tr_b16 a[0:1], v10 offset:32768
    ds_read_b64_tr_b16 a[2:3], v10 offset:33792
    v_mfma_f32_16x16x32_bf16 v[112:115], v[160:163], v[176:179], v[112:115]
    ds_read_b64_tr_b16 a[4:5], v11 offset:32768
    ds_read_b64_tr_b16 a[6:7], v11 offset:33792
    v_mfma_f32_16x16x32_bf16 v[112:115], v[164:167], v[200:203], v[112:115]
    ds_read_b64_tr_b16 a[24:25], v10 offset:40960
    ds_read_b64_tr_b16 a[26:27], v10 offset:41984
    s_waitcnt lgkmcnt(6)
    v_mfma_f32_16x16x32_bf16 v[112:115], v[168:171], v[224:227], v[112:115]
    s_mov_b32 s57, 525824
    ds_read_b64_tr_b16 a[28:29], v11 offset:40960
    v_mfma_f32_16x16x32_bf16 v[112:115], v[172:175], v[248:251], v[112:115]
    buffer_load_dwordx4 v2, s[8:11], s57 offen offset:1024 lds
    v_mfma_f32_16x16x32_bf16 v[116:119], v[120:123], a[20:23], 0
    ds_read_b64_tr_b16 v[120:121], v4 offset:0
    ds_read_b64_tr_b16 v[122:123], v25 offset:0
    v_mfma_f32_16x16x32_bf16 v[116:119], v[124:127], a[44:47], v[116:119]
    ds_read_b64_tr_b16 v[124:125], v4 offset:1024
    ds_read_b64_tr_b16 a[30:31], v11 offset:41984
    v_mfma_f32_16x16x32_bf16 v[116:119], v[128:131], a[68:71], v[116:119]
    ds_read_b64_tr_b16 v[126:127], v25 offset:1024
    ds_read_b64_tr_b16 v[128:129], v4 offset:2048
    s_add_u32 m0, s90, 106496
    s_mov_b32 s57, 602112
    v_mfma_f32_16x16x32_bf16 v[116:119], v[132:135], a[92:95], v[116:119]
    buffer_load_dwordx4 v2, s[8:11], s57 offen offset:0 lds
    v_mfma_f32_16x16x32_bf16 v[116:119], v[136:139], a[116:119], v[116:119]
    ds_read_b64_tr_b16 v[130:131], v25 offset:2048
    ds_read_b64_tr_b16 v[132:133], v4 offset:3072
    v_mfma_f32_16x16x32_bf16 v[116:119], v[140:143], a[140:143], v[116:119]
    ds_read_b64_tr_b16 v[134:135], v25 offset:3072
    ds_read_b64_tr_b16 v[136:137], v4 offset:4096
    v_mfma_f32_16x16x32_bf16 v[116:119], v[144:147], a[164:167], v[116:119]
    ds_read_b64_tr_b16 v[138:139], v25 offset:4096
    s_mov_b32 s57, 611840
    v_mfma_f32_16x16x32_bf16 v[116:119], v[148:151], a[188:191], v[116:119]
    buffer_load_dwordx4 v2, s[8:11], s57 offen offset:1024 lds
    v_mfma_f32_16x16x32_bf16 v[116:119], v[152:155], a[212:215], v[116:119]
    ds_read_b64_tr_b16 v[140:141], v4 offset:5120
    ds_read_b64_tr_b16 v[142:143], v25 offset:5120
    v_mfma_f32_16x16x32_bf16 v[116:119], v[156:159], a[236:239], v[116:119]
    ds_read_b64_tr_b16 v[144:145], v4 offset:6144
    ds_read_b64_tr_b16 v[146:147], v25 offset:6144
    v_mfma_f32_16x16x32_bf16 v[116:119], v[160:163], v[180:183], v[116:119]
    ds_read_b64_tr_b16 v[148:149], v4 offset:7168
L_wa_0:
    s_cbranch_execz L_wa_ret
    ds_read_b64_tr_b16 v[150:151], v25 offset:7168
    s_add_u32 m0, s90, 114688
    s_mov_b32 s57, 688128
    v_mfma_f32_16x16x32_bf16 v[116:119], v[164:167], v[204:207], v[116:119]
    buffer_load_dwordx4 v2, s[8:11], s57 offen offset:0 lds
    v_mfma_f32_16x16x32_bf16 v[116:119], v[168:171], v[228:231], v[116:119]
    ds_read_b64_tr_b16 v[152:153], v4 offset:8192
    ds_read_b64_tr_b16 v[154:155], v25 offset:8192
    v_mfma_f32_16x16x32_bf16 v[116:119], v[172:175], v[252:255], v[116:119]
    ds_read_b64_tr_b16 v[156:157], v4 offset:9216
    ds_read_b64_tr_b16 v[158:159], v25 offset:9216
    s_waitcnt lgkmcnt(15)
    v_mfma_f32_16x16x32_bf16 v[96:99], v[120:123], a[16:19], 0
    ds_read_b64_tr_b16 v[160:161], v4 offset:10240
    s_mov_b32 s57, 697856
    v_mfma_f32_16x16x32_bf16 v[96:99], v[124:127], a[40:43], v[96:99]
    buffer_load_dwordx4 v2, s[8:11], s57 offen offset:1024 lds
    s_waitcnt lgkmcnt(13)
    v_mfma_f32_16x16x32_bf16 v[96:99], v[128:131], a[64:67], v[96:99]
    ds_read_b64_tr_b16 v[162:163], v25 offset:10240
    ds_read_b64_tr_b16 v[164:165], v4 offset:11264
    v_mfma_f32_16x16x32_bf16 v[96:99], v[132:135], a[88:91], v[96:99]
    ds_read_b64_tr_b16 v[166:167], v25 offset:11264
    ds_read_b64_tr_b16 v[168:169], v4 offset:12288
    s_waitcnt lgkmcnt(13)
    v_mfma_f32_16x16x32_bf16 v[96:99], v[136:139], a[112:115], v[96:99]
    ds_read_b64_tr_b16 v[170:171], v25 offset:12288
    ds_read_b64_tr_b16 v[172:173], v4 offset:13312
    s_add_u32 m0, s90, 122880
    s_mov_b32 s57, 774144
    v_mfma_f32_16x16x32_bf16 v[96:99], v[140:143], a[136:139], v[96:99]
    buffer_load_dwordx4 v2, s[8:11], s57 offen offset:0 lds
    s_waitcnt lgkmcnt(11)
    v_mfma_f32_16x16x32_bf16 v[96:99], v[144:147], a[160:163], v[96:99]
    ds_read_b64_tr_b16 v[174:175], v25 offset:13312
    v_cvt_pk_bf16_f32 v34, v112, v113
    v_mfma_f32_16x16x32_bf16 v[96:99], v[148:151], a[184:187], v[96:99]
    v_cvt_pk_bf16_f32 v35, v114, v115
    v_cvt_pk_bf16_f32 v44, v116, v117
    s_waitcnt lgkmcnt(8)
    v_mfma_f32_16x16x32_bf16 v[96:99], v[152:155], a[208:211], v[96:99]
    s_mov_b32 s57, 783872
    v_cvt_pk_bf16_f32 v45, v118, v119
    v_mfma_f32_16x16x32_bf16 v[96:99], v[156:159], a[232:235], v[96:99]
    buffer_load_dwordx4 v2, s[8:11], s57 offen offset:1024 lds
    s_waitcnt lgkmcnt(4)
    v_mfma_f32_16x16x32_bf16 v[96:99], v[160:163], v[176:179], v[96:99]
    v_mfma_f32_16x16x32_bf16 v[96:99], v[164:167], v[200:203], v[96:99]
    s_waitcnt vmcnt(10)
    s_barrier
    s_waitcnt lgkmcnt(0)
    v_mfma_f32_16x16x32_bf16 v[96:99], v[168:171], v[224:227], v[96:99]
    s_add_u32 m0, s90, 131072
    s_mov_b32 s57, 860160
    ds_read_b64_tr_b16 a[48:49], v6 offset:0
    v_mfma_f32_16x16x32_bf16 v[96:99], v[172:175], v[248:251], v[96:99]
    buffer_load_dwordx4 v2, s[8:11], s57 offen offset:0 lds
    v_mfma_f32_16x16x32_bf16 v[100:103], v[120:123], a[20:23], 0
    ds_read_b64_tr_b16 v[120:121], v4 offset:32768
    ds_read_b64_tr_b16 v[122:123], v25 offset:32768
    v_mfma_f32_16x16x32_bf16 v[100:103], v[124:127], a[44:47], v[100:103]
    ds_read_b64_tr_b16 v[124:125], v4 offset:33792
    ds_read_b64_tr_b16 a[50:51], v6 offset:1024
    v_mfma_f32_16x16x32_bf16 v[100:103], v[128:131], a[68:71], v[100:103]
    ds_read_b64_tr_b16 v[126:127], v25 offset:33792
    ds_read_b64_tr_b16 v[128:129], v4 offset:34816
    s_mov_b32 s57, 869888
    v_mfma_f32_16x16x32_bf16 v[100:103], v[132:135], a[92:95], v[100:103]
    buffer_load_dwordx4 v2, s[8:11], s57 offen offset:1024 lds
    v_mfma_f32_16x16x32_bf16 v[100:103], v[136:139], a[116:119], v[100:103]
    ds_read_b64_tr_b16 v[130:131], v25 offset:34816
    ds_read_b64_tr_b16 v[132:133], v4 offset:35840
    v_mfma_f32_16x16x32_bf16 v[100:103], v[140:143], a[140:143], v[100:103]
    ds_read_b64_tr_b16 v[134:135], v25 offset:35840
    ds_read_b64_tr_b16 v[136:137], v4 offset:36864
    v_mfma_f32_16x16x32_bf16 v[100:103], v[144:147], a[164:167], v[100:103]
    ds_read_b64_tr_b16 v[138:139], v25 offset:36864
    s_add_u32 m0, s90, 139264
    s_mov_b32 s57, 946176
    v_mfma_f32_16x16x32_bf16 v[100:103], v[148:151], a[188:191], v[100:103]
    buffer_load_dwordx4 v2, s[8:11], s57 offen offset:0 lds
    v_mfma_f32_16x16x32_bf16 v[100:103], v[152:155], a[212:215], v[100:103]
    ds_read_b64_tr_b16 v[140:141], v4 offset:37888
    ds_read_b64_tr_b16 v[142:143], v25 offset:37888
    v_mfma_f32_16x16x32_bf16 v[100:103], v[156:159], a[236:239], v[100:103]
    ds_read_b64_tr_b16 v[144:145], v4 offset:38912
    ds_read_b64_tr_b16 v[146:147], v25 offset:38912
    v_mfma_f32_16x16x32_bf16 v[100:103], v[160:163], v[180:183], v[100:103]
    ds_read_b64_tr_b16 v[148:149], v4 offset:39936
    ds_read_b64_tr_b16 v[150:151], v25 offset:39936
    s_mov_b32 s57, 955904
    v_mfma_f32_16x16x32_bf16 v[100:103], v[164:167], v[204:207], v[100:103]
    buffer_load_dwordx4 v2, s[8:11], s57 offen offset:1024 lds
    v_mfma_f32_16x16x32_bf16 v[100:103], v[168:171], v[228:231], v[100:103]
    ds_read_b64_tr_b16 v[152:153], v4 offset:40960
    ds_read_b64_tr_b16 v[154:155], v25 offset:40960
    v_mfma_f32_16x16x32_bf16 v[100:103], v[172:175], v[252:255], v[100:103]
    ds_read_b64_tr_b16 v[156:157], v4 offset:41984
    ds_read_b64_tr_b16 v[158:159], v25 offset:41984
    s_waitcnt lgkmcnt(15)
    v_mfma_f32_16x16x32_bf16 v[104:107], a[8:11], v[120:123], 0
    ds_read_b64_tr_b16 v[160:161], v4 offset:43008
    s_add_u32 m0, s90, 147456
    s_mov_b32 s57, 1032192
    v_mfma_f32_16x16x32_bf16 v[104:107], a[32:35], v[124:127], v[104:107]
    buffer_load_dwordx4 v2, s[8:11], s57 offen offset:0 lds
    s_waitcnt lgkmcnt(13)
    v_mfma_f32_16x16x32_bf16 v[104:107], a[56:59], v[128:131], v[104:107]
    ds_read_b64_tr_b16 v[162:163], v25 offset:43008
    ds_read_b64_tr_b16 v[164:165], v4 offset:44032
    v_mfma_f32_16x16x32_bf16 v[104:107], a[80:83], v[132:135], v[104:107]
    ds_read_b64_tr_b16 v[166:167], v25 offset:44032
    ds_read_b64_tr_b16 v[168:169], v4 offset:45056
    s_waitcnt lgkmcnt(13)
    v_mfma_f32_16x16x32_bf16 v[104:107], a[104:107], v[136:139], v[104:107]
    ds_read_b64_tr_b16 v[170:171], v25 offset:45056
    ds_read_b64_tr_b16 v[172:173], v4 offset:46080
    s_mov_b32 s57, 1041920
    v_mfma_f32_16x16x32_bf16 v[104:107], a[128:131], v[140:143], v[104:107]
    buffer_load_dwordx4 v2, s[8:11], s57 offen offset:1024 lds
    s_waitcnt lgkmcnt(11)
    v_mfma_f32_16x16x32_bf16 v[104:107], a[152:155], v[144:147], v[104:107]
    ds_read_b64_tr_b16 v[174:175], v25 offset:46080
    v_cvt_pk_bf16_f32 v32, v96, v97
    v_mfma_f32_16x16x32_bf16 v[104:107], a[176:179], v[148:151], v[104:107]
    v_cvt_pk_bf16_f32 v33, v98, v99
    v_cvt_pk_bf16_f32 v42, v100, v101
    s_waitcnt lgkmcnt(8)
    v_mfma_f32_16x16x32_bf16 v[104:107], a[200:203], v[152:155], v[104:107]
    s_add_u32 m0, s90, 155648
    s_mov_b32 s57, 1118208
    v_cvt_pk_bf16_f32 v43, v102, v103
    v_mfma_f32_16x16x32_bf16 v[104:107], a[224:227], v[156:159], v[104:107]
    buffer_load_dwordx4 v2, s[8:11], s57 offen offset:0 lds
    s_waitcnt lgkmcnt(4)
    v_mfma_f32_16x16x32_bf16 v[104:107], a[248:251], v[160:163], v[104:107]
    ds_read_b64_tr_b16 a[52:53], v7 offset:0
    ds_read_b64_tr_b16 a[54:55], v7 offset:1024
    v_mfma_f32_16x16x32_bf16 v[104:107], v[192:195], v[164:167], v[104:107]
    ds_read_b64_tr_b16 a[72:73], v6 offset:8192
    ds_read_b64_tr_b16 a[74:75], v6 offset:9216
    s_waitcnt lgkmcnt(4)
    v_mfma_f32_16x16x32_bf16 v[104:107], v[216:219], v[168:171], v[104:107]
    s_mov_b32 s57, 1127936
    ds_read_b64_tr_b16 a[76:77], v7 offset:8192
    v_mfma_f32_16x16x32_bf16 v[104:107], v[240:243], v[172:175], v[104:107]
    buffer_load_dwordx4 v2, s[8:11], s57 offen offset:1024 lds
    v_mfma_f32_16x16x32_bf16 v[108:111], a[12:15], v[120:123], 0
    ds_read_b64_tr_b16 a[78:79], v7 offset:9216
    ds_read_b64_tr_b16 a[96:97], v6 offset:16384
    v_mfma_f32_16x16x32_bf16 v[108:111], a[36:39], v[124:127], v[108:111]
    ds_read_b64_tr_b16 a[98:99], v6 offset:17408
    ds_read_b64_tr_b16 a[100:101], v7 offset:16384
    v_mfma_f32_16x16x32_bf16 v[108:111], a[60:63], v[128:131], v[108:111]
    s_add_u32 m0, s52, 49152
    s_add_u32 s58, s72, 1024
    s_add_u32 s57, s58, s68
    ds_read_b64_tr_b16 a[102:103], v7 offset:17408
    v_mfma_f32_16x16x32_bf16 v[108:111], a[84:87], v[132:135], v[108:111]
    buffer_load_dwordx4 v3, s[24:27], s57 offen offset:0 sc1 lds
    s_waitcnt vmcnt(13)
    s_waitcnt lgkmcnt(0)
    s_barrier
    v_mfma_f32_16x16x32_bf16 v[108:111], a[108:111], v[136:139], v[108:111]
    ds_read_b64_tr_b16 a[120:121], v6 offset:24576
    ds_read_b64_tr_b16 a[122:123], v6 offset:25600
    v_mfma_f32_16x16x32_bf16 v[108:111], a[132:135], v[140:143], v[108:111]
    ds_read_b64_tr_b16 a[124:125], v7 offset:24576
    ds_read_b64_tr_b16 a[126:127], v7 offset:25600
    v_mfma_f32_16x16x32_bf16 v[108:111], a[156:159], v[144:147], v[108:111]
    s_add_u32 s57, s58, s69
    v_cvt_pk_bf16_f32 v60, v104, v105
    v_mfma_f32_16x16x32_bf16 v[108:111], a[180:183], v[148:151], v[108:111]
    buffer_load_dwordx4 v3, s[24:27], s57 offen offset:1024 sc1 lds
    v_mfma_f32_16x16x32_bf16 v[108:111], a[204:207], v[152:155], v[108:111]
    v_cvt_pk_bf16_f32 v61, v106, v107
    ds_read_b64_tr_b16 a[144:145], v6 offset:32768
    v_mfma_f32_16x16x32_bf16 v[108:111], a[228:231], v[156:159], v[108:111]
    ds_read_b64_tr_b16 a[146:147], v6 offset:33792
    ds_read_b64_tr_b16 a[148:149], v7 offset:32768
    v_mfma_f32_16x16x32_bf16 v[108:111], a[252:255], v[160:163], v[108:111]
    s_add_u32 s57, s58, s70
    ds_read_b64_tr_b16 a[150:151], v7 offset:33792
    v_mfma_f32_16x16x32_bf16 v[108:111], v[196:199], v[164:167], v[108:111]
    buffer_load_dwordx4 v24, s[24:27], s57 offen offset:2048 sc1 lds
    v_mfma_f32_16x16x32_bf16 v[108:111], v[220:223], v[168:171], v[108:111]
    ds_read_b64_tr_b16 a[168:169], v6 offset:40960
    ds_read_b64_tr_b16 a[170:171], v6 offset:41984
    v_mfma_f32_16x16x32_bf16 v[108:111], v[244:247], v[172:175], v[108:111]
    ds_read_b64_tr_b16 a[172:173], v7 offset:40960
    ds_read_b64_tr_b16 a[174:175], v7 offset:41984
    v_mfma_f32_16x16x32_bf16 v[112:115], v[120:123], a[16:19], 0
    s_add_u32 s57, s58, s71
    v_mfma_f32_16x16x32_bf16 v[112:115], v[124:127], a[40:43], v[112:115]
    buffer_load_dwordx4 v3, s[24:27], s57 offen offset:3072 sc1 lds
    v_mfma_f32_16x16x32_bf16 v[112:115], v[128:131], a[64:67], v[112:115]
    v_mfma_f32_16x16x32_bf16 v[112:115], v[132:135], a[88:91], v[112:115]
    s_waitcnt vmcnt(10)
    s_waitcnt lgkmcnt(0)
    s_barrier
    v_mfma_f32_16x16x32_bf16 v[112:115], v[136:139], a[112:115], v[112:115]
    ds_read_b64_tr_b16 a[192:193], v10 offset:0
    ds_read_b64_tr_b16 a[194:195], v10 offset:1024
    v_mfma_f32_16x16x32_bf16 v[112:115], v[140:143], a[136:139], v[112:115]
    ds_read_b64_tr_b16 a[196:197], v11 offset:0
    ds_read_b64_tr_b16 a[198:199], v11 offset:1024
    v_mfma_f32_16x16x32_bf16 v[112:115], v[144:147], a[160:163], v[112:115]
    v_cvt_pk_bf16_f32 v62, v108, v109
    v_cvt_pk_bf16_f32 v63, v110, v111
    v_mfma_f32_16x16x32_bf16 v[112:115], v[148:151], a[184:187], v[112:115]
    v_cndmask_b32 v62, v62, 0, s[82:83]
    v_cndmask_b32 v63, v63, 0, s[82:83]
    v_mfma_f32_16x16x32_bf16 v[112:115], v[152:155], a[208:211], v[112:115]
    ds_read_b64_tr_b16 a[216:217], v10 offset:8192
    ds_read_b64_tr_b16 a[218:219], v10 offset:9216
    v_mfma_f32_16x16x32_bf16 v[112:115], v[156:159], a[232:235], v[112:115]
    ds_read_b64_tr_b16 a[220:221], v11 offset:8192
    ds_read_b64_tr_b16 a[222:223], v11 offset:9216
    v_mfma_f32_16x16x32_bf16 v[112:115], v[160:163], v[176:179], v[112:115]
    ds_read_b64_tr_b16 a[240:241], v10 offset:16384
    ds_read_b64_tr_b16 a[242:243], v10 offset:17408
    v_mfma_f32_16x16x32_bf16 v[112:115], v[164:167], v[200:203], v[112:115]
    ds_read_b64_tr_b16 a[244:245], v11 offset:16384
    ds_read_b64_tr_b16 a[246:247], v11 offset:17408
    v_mfma_f32_16x16x32_bf16 v[112:115], v[168:171], v[224:227], v[112:115]
    v_mfma_f32_16x16x32_bf16 v[112:115], v[172:175], v[248:251], v[112:115]
    v_mfma_f32_16x16x32_bf16 v[116:119], v[120:123], a[20:23], 0
    v_mfma_f32_16x16x32_bf16 v[116:119], v[124:127], a[44:47], v[116:119]
    v_mfma_f32_16x16x32_bf16 v[116:119], v[128:131], a[68:71], v[116:119]
    v_mfma_f32_16x16x32_bf16 v[116:119], v[132:135], a[92:95], v[116:119]
    v_mfma_f32_16x16x32_bf16 v[116:119], v[136:139], a[116:119], v[116:119]
    v_mfma_f32_16x16x32_bf16 v[116:119], v[140:143], a[140:143], v[116:119]
    v_mfma_f32_16x16x32_bf16 v[116:119], v[144:147], a[164:167], v[116:119]
    s_nop 0
    v_cvt_pk_bf16_f32 v36, v112, v113
    v_cvt_pk_bf16_f32 v37, v114, v115
    v_mfma_f32_16x16x32_bf16 v[116:119], v[148:151], a[188:191], v[116:119]
    v_mfma_f32_16x16x32_bf16 v[116:119], v[152:155], a[212:215], v[116:119]
    v_mfma_f32_16x16x32_bf16 v[116:119], v[156:159], a[236:239], v[116:119]
    v_mfma_f32_16x16x32_bf16 v[116:119], v[160:163], v[180:183], v[116:119]
    v_mfma_f32_16x16x32_bf16 v[116:119], v[164:167], v[204:207], v[116:119]
    v_mfma_f32_16x16x32_bf16 v[116:119], v[168:171], v[228:231], v[116:119]
    v_mfma_f32_16x16x32_bf16 v[116:119], v[172:175], v[252:255], v[116:119]
    s_waitcnt vmcnt(4)
    s_waitcnt lgkmcnt(0)
    s_barrier
    v_mfma_f32_16x16x32_bf16 v[96:99], a[0:3], v[120:123], 0
    ds_read_b64_tr_b16 v[184:185], v10 offset:24576
    ds_read_b64_tr_b16 v[186:187], v10 offset:25600
    v_mfma_f32_16x16x32_bf16 v[96:99], a[24:27], v[124:127], v[96:99]
    ds_read_b64_tr_b16 v[188:189], v11 offset:24576
    ds_read_b64_tr_b16 v[190:191], v11 offset:25600
    v_mfma_f32_16x16x32_bf16 v[96:99], a[48:51], v[128:131], v[96:99]
    ds_read_b64_tr_b16 v[208:209], v10 offset:32768
    ds_read_b64_tr_b16 v[210:211], v10 offset:33792
    v_mfma_f32_16x16x32_bf16 v[96:99], a[72:75], v[132:135], v[96:99]
    ds_read_b64_tr_b16 v[212:213], v11 offset:32768
    ds_read_b64_tr_b16 v[214:215], v11 offset:33792
    v_mfma_f32_16x16x32_bf16 v[96:99], a[96:99], v[136:139], v[96:99]
    ds_read_b64_tr_b16 v[232:233], v10 offset:40960
    ds_read_b64_tr_b16 v[234:235], v10 offset:41984
    v_mfma_f32_16x16x32_bf16 v[96:99], a[120:123], v[140:143], v[96:99]
    ds_read_b64_tr_b16 v[236:237], v11 offset:40960
    ds_read_b64_tr_b16 v[238:239], v11 offset:41984
    v_mfma_f32_16x16x32_bf16 v[96:99], a[144:147], v[144:147], v[96:99]
    v_cvt_pk_bf16_f32 v46, v116, v117
    v_cvt_pk_bf16_f32 v47, v118, v119
    v_mfma_f32_16x16x32_bf16 v[96:99], a[168:171], v[148:151], v[96:99]
    v_mfma_f32_16x16x32_bf16 v[96:99], a[192:195], v[152:155], v[96:99]
    v_mfma_f32_16x16x32_bf16 v[96:99], a[216:219], v[156:159], v[96:99]
    s_waitcnt lgkmcnt(8)
    v_mfma_f32_16x16x32_bf16 v[96:99], a[240:243], v[160:163], v[96:99]
    v_mfma_f32_16x16x32_bf16 v[96:99], v[184:187], v[164:167], v[96:99]
    s_waitcnt lgkmcnt(0)
    s_barrier
    v_mfma_f32_16x16x32_bf16 v[96:99], v[208:211], v[168:171], v[96:99]
    s_add_u32 m0, s52, 65536
    s_add_u32 s58, s72, 1536
    s_add_u32 s57, s58, s68
    v_mfma_f32_16x16x32_bf16 v[96:99], v[232:235], v[172:175], v[96:99]
    buffer_load_dwordx4 v3, s[24:27], s57 offen offset:0 sc1 lds
    v_mfma_f32_16x16x32_bf16 v[100:103], a[4:7], v[120:123], 0
    ds_read_b64_tr_b16 v[120:121], v4 offset:16384
    ds_read_b64_tr_b16 v[122:123], v25 offset:16384
    v_mfma_f32_16x16x32_bf16 v[100:103], a[28:31], v[124:127], v[100:103]
    ds_read_b64_tr_b16 v[124:125], v4 offset:17408
    v_mfma_f32_16x16x32_bf16 v[100:103], a[52:55], v[128:131], v[100:103]
    ds_read_b64_tr_b16 v[126:127], v25 offset:17408
    ds_read_b64_tr_b16 v[128:129], v4 offset:18432
    v_mfma_f32_16x16x32_bf16 v[100:103], a[76:79], v[132:135], v[100:103]
    ds_read_b64_tr_b16 v[130:131], v25 offset:18432
    v_mfma_f32_16x16x32_bf16 v[100:103], a[100:103], v[136:139], v[100:103]
    ds_read_b64_tr_b16 v[132:133], v4 offset:19456
    s_add_u32 s57, s58, s69
    v_mfma_f32_16x16x32_bf16 v[100:103], a[124:127], v[140:143], v[100:103]
    buffer_load_dwordx4 v3, s[24:27], s57 offen offset:1024 sc1 lds
    v_mfma_f32_16x16x32_bf16 v[100:103], a[148:151], v[144:147], v[100:103]
    ds_read_b64_tr_b16 v[134:135], v25 offset:19456
    ds_read_b64_tr_b16 v[136:137], v4 offset:20480
    v_mfma_f32_16x16x32_bf16 v[100:103], a[172:175], v[148:151], v[100:103]
    ds_read_b64_tr_b16 v[138:139], v25 offset:20480
    ds_read_b64_tr_b16 v[140:141], v4 offset:21504
    v_mfma_f32_16x16x32_bf16 v[100:103], a[196:199], v[152:155], v[100:103]
    ds_read_b64_tr_b16 v[142:143], v25 offset:21504
    ds_read_b64_tr_b16 v[144:145], v4 offset:22528
    v_mfma_f32_16x16x32_bf16 v[100:103], a[220:223], v[156:159], v[100:103]
    ds_read_b64_tr_b16 v[146:147], v25 offset:22528
    v_cvt_pk_bf16_f32 v64, v96, v97
    v_mfma_f32_16x16x32_bf16 v[100:103], a[244:247], v[160:163], v[100:103]
    ds_read_b64_tr_b16 v[148:149], v4 offset:23552
    ds_read_b64_tr_b16 v[150:151], v25 offset:23552
    s_add_u32 s57, s58, s70
    v_mfma_f32_16x16x32_bf16 v[100:103], v[188:191], v[164:167], v[100:103]
    buffer_load_dwordx4 v24, s[24:27], s57 offen offset:2048 sc1 lds
    v_mfma_f32_16x16x32_bf16 v[100:103], v[212:215], v[168:171], v[100:103]
    ds_read_b64_tr_b16 v[152:153], v4 offset:24576
    ds_read_b64_tr_b16 v[154:155], v25 offset:24576
    v_mfma_f32_16x16x32_bf16 v[100:103], v[236:239], v[172:175], v[100:103]
    ds_read_b64_tr_b16 v[156:157], v4 offset:25600
    ds_read_b64_tr_b16 v[158:159], v25 offset:25600
    s_waitcnt lgkmcnt(15)
    v_mfma_f32_16x16x32_bf16 v[104:107], a[0:3], v[120:123], 0
    ds_read_b64_tr_b16 v[160:161], v4 offset:26624
    v_cvt_pk_bf16_f32 v65, v98, v99
    v_mfma_f32_16x16x32_bf16 v[104:107], a[24:27], v[124:127], v[104:107]
    ds_read_b64_tr_b16 v[162:163], v25 offset:26624
    ds_read_b64_tr_b16 v[164:165], v4 offset:27648
    s_waitcnt lgkmcnt(15)
    v_mfma_f32_16x16x32_bf16 v[104:107], a[48:51], v[128:131], v[104:107]
    ds_read_b64_tr_b16 v[166:167], v25 offset:27648
    s_add_u32 s57, s58, s71
    v_mfma_f32_16x16x32_bf16 v[104:107], a[72:75], v[132:135], v[104:107]
    buffer_load_dwordx4 v3, s[24:27], s57 offen offset:3072 sc1 lds
    s_waitcnt lgkmcnt(12)
    v_mfma_f32_16x16x32_bf16 v[104:107], a[96:99], v[136:139], v[104:107]
    ds_read_b64_tr_b16 v[168:169], v4 offset:28672
    ds_read_b64_tr_b16 v[170:171], v25 offset:28672
    v_mfma_f32_16x16x32_bf16 v[104:107], a[120:123], v[140:143], v[104:107]
    ds_read_b64_tr_b16 v[172:173], v4 offset:29696
    ds_read_b64_tr_b16 v[174:175], v25 offset:29696
    s_waitcnt lgkmcnt(12)
    v_mfma_f32_16x16x32_bf16 v[104:107], a[144:147], v[144:147], v[104:107]
    v_cvt_pk_bf16_f32 v66, v100, v101
    v_cvt_pk_bf16_f32 v67, v102, v103
    v_mfma_f32_16x16x32_bf16 v[104:107], a[168:171], v[148:151], v[104:107]
    v_cndmask_b32 v66, v66, 0, s[82:83]
    v_cndmask_b32 v67, v67, 0, s[82:83]
    s_waitcnt lgkmcnt(8)
    v_mfma_f32_16x16x32_bf16 v[104:107], a[192:195], v[152:155], v[104:107]
    s_add_u32 m0, s52, 81920
    s_add_u32 s58, s72, 2048
    s_add_u32 s57, s58, s68
    v_mfma_f32_16x16x32_bf16 v[104:107], a[216:219], v[156:159], v[104:107]
    buffer_load_dwordx4 v3, s[24:27], s57 offen offset:0 sc1 lds
    s_waitcnt lgkmcnt(4)
    v_mfma_f32_16x16x32_bf16 v[104:107], a[240:243], v[160:163], v[104:107]
    v_mfma_f32_16x16x32_bf16 v[104:107], v[184:187], v[164:167], v[104:107]
    s_waitcnt lgkmcnt(0)
    v_mfma_f32_16x16x32_bf16 v[104:107], v[208:211], v[168:171], v[104:107]
    v_mfma_f32_16x16x32_bf16 v[104:107], v[232:235], v[172:175], v[104:107]
    s_waitcnt vmcnt(5)
    s_barrier
    v_mfma_f32_16x16x32_bf16 v[108:111], a[4:7], v[120:123], 0
    ds_read_b64_tr_b16 v[120:121], v4 offset:49152
    ds_read_b64_tr_b16 v[122:123], v25 offset:49152
    s_add_u32 s57, s58, s69
    v_mfma_f32_16x16x32_bf16 v[108:111], a[28:31], v[124:127], v[108:111]
    buffer_load_dwordx4 v3, s[24:27], s57 offen offset:1024 sc1 lds
    v_mfma_f32_16x16x32_bf16 v[108:111], a[52:55], v[128:131], v[108:111]
    ds_read_b64_tr_b16 v[124:125], v4 offset:50176
    ds_read_b64_tr_b16 v[126:127], v25 offset:50176
    v_mfma_f32_16x16x32_bf16 v[108:111], a[76:79], v[132:135], v[108:111]
    ds_read_b64_tr_b16 v[128:129], v4 offset:51200
    ds_read_b64_tr_b16 v[130:131], v25 offset:51200
    v_mfma_f32_16x16x32_bf16 v[108:111], a[100:103], v[136:139], v[108:111]
    ds_read_b64_tr_b16 v[132:133], v4 offset:52224
    v_mfma_f32_16x16x32_bf16 v[108:111], a[124:127], v[140:143], v[108:111]
    ds_read_b64_tr_b16 v[134:135], v25 offset:52224
    ds_read_b64_tr_b16 v[136:137], v4 offset:53248
    v_mfma_f32_16x16x32_bf16 v[108:111], a[148:151], v[144:147], v[108:111]
    ds_read_b64_tr_b16 v[138:139], v25 offset:53248
    s_add_u32 s57, s58, s70
    v_mfma_f32_16x16x32_bf16 v[108:111], a[172:175], v[148:151], v[108:111]
    buffer_load_dwordx4 v24, s[24:27], s57 offen offset:2048 sc1 lds
    v_mfma_f32_16x16x32_bf16 v[108:111], a[196:199], v[152:155], v[108:111]
    ds_read_b64_tr_b16 v[140:141], v4 offset:54272
    ds_read_b64_tr_b16 v[142:143], v25 offset:54272
    v_mfma_f32_16x16x32_bf16 v[108:111], a[220:223], v[156:159], v[108:111]
    ds_read_b64_tr_b16 v[144:145], v4 offset:55296
    ds_read_b64_tr_b16 v[146:147], v25 offset:55296
    v_mfma_f32_16x16x32_bf16 v[108:111], a[244:247], v[160:163], v[108:111]
    ds_read_b64_tr_b16 v[148:149], v4 offset:56320
    ds_read_b64_tr_b16 v[150:151], v25 offset:56320
    v_mfma_f32_16x16x32_bf16 v[108:111], v[188:191], v[164:167], v[108:111]
    ds_read_b64_tr_b16 v[152:153], v4 offset:57344
    v_cvt_pk_bf16_f32 v68, v104, v105
    v_mfma_f32_16x16x32_bf16 v[108:111], v[212:215], v[168:171], v[108:111]
    ds_read_b64_tr_b16 v[154:155], v25 offset:57344
    ds_read_b64_tr_b16 v[156:157], v4 offset:58368
    s_add_u32 s57, s58, s71
    v_mfma_f32_16x16x32_bf16 v[108:111], v[236:239], v[172:175], v[108:111]
    buffer_load_dwordx4 v3, s[24:27], s57 offen offset:3072 sc1 lds
    s_waitcnt lgkmcnt(15)
    v_mfma_f32_16x16x32_bf16 v[112:115], a[8:11], v[120:123], 0
    ds_read_b64_tr_b16 v[158:159], v25 offset:58368
    ds_read_b64_tr_b16 v[160:161], v4 offset:59392
    v_mfma_f32_16x16x32_bf16 v[112:115], a[32:35], v[124:127], v[112:115]
    ds_read_b64_tr_b16 v[162:163], v25 offset:59392
    ds_read_b64_tr_b16 v[164:165], v4 offset:60416
    s_waitcnt lgkmcnt(15)
    v_mfma_f32_16x16x32_bf16 v[112:115], a[56:59], v[128:131], v[112:115]
    ds_read_b64_tr_b16 v[166:167], v25 offset:60416
    v_cvt_pk_bf16_f32 v69, v106, v107
    v_mfma_f32_16x16x32_bf16 v[112:115], a[80:83], v[132:135], v[112:115]
    ds_read_b64_tr_b16 v[168:169], v4 offset:61440
    s_waitcnt lgkmcnt(13)
    v_mfma_f32_16x16x32_bf16 v[112:115], a[104:107], v[136:139], v[112:115]
    ds_read_b64_tr_b16 v[170:171], v25 offset:61440
    ds_read_b64_tr_b16 v[172:173], v4 offset:62464
    s_add_u32 m0, s52, 98304
    s_add_u32 s58, s72, 2560
    s_add_u32 s57, s58, s68
    v_mfma_f32_16x16x32_bf16 v[112:115], a[128:131], v[140:143], v[112:115]
    buffer_load_dwordx4 v3, s[24:27], s57 offen offset:0 sc1 lds
    s_waitcnt lgkmcnt(11)
    v_mfma_f32_16x16x32_bf16 v[112:115], a[152:155], v[144:147], v[112:115]
    ds_read_b64_tr_b16 v[174:175], v25 offset:62464
    v_cvt_pk_bf16_f32 v70, v108, v109
    v_mfma_f32_16x16x32_bf16 v[112:115], a[176:179], v[148:151], v[112:115]
    v_cvt_pk_bf16_f32 v71, v110, v111
    v_cndmask_b32 v70, v70, 0, s[82:83]
    s_waitcnt lgkmcnt(8)
    v_mfma_f32_16x16x32_bf16 v[112:115], a[200:203], v[152:155], v[112:115]
    v_cndmask_b32 v71, v71, 0, s[82:83]
    v_mov_b32 v8, 0
    v_mfma_f32_16x16x32_bf16 v[112:115], a[224:227], v[156:159], v[112:115]
    v_mov_b32 v9, 0
    v_mov_b32 v10, 0
    s_waitcnt lgkmcnt(4)
    v_mfma_f32_16x16x32_bf16 v[112:115], a[248:251], v[160:163], v[112:115]
    s_add_u32 s57, s58, s69
    v_mfma_f32_16x16x32_bf16 v[72:75], v[52:55], v[68:71], 0
    v_mfma_f32_16x16x32_bf16 v[112:115], v[192:195], v[164:167], v[112:115]
    buffer_load_dwordx4 v3, s[24:27], s57 offen offset:1024 sc1 lds
    s_waitcnt lgkmcnt(0)
    v_mfma_f32_16x16x32_bf16 v[112:115], v[216:219], v[168:171], v[112:115]
    v_mfma_f32_16x16x32_bf16 v[76:79], v[56:59], v[68:71], 0
    v_mfma_f32_16x16x32_bf16 v[112:115], v[240:243], v[172:175], v[112:115]
    ds_read_u16_d16_hi v8, v93 offset:0
    ds_read_u16_d16_hi v9, v94 offset:0
    v_mfma_f32_16x16x32_bf16 v[116:119], a[12:15], v[120:123], 0
    ds_read_u16_d16_hi v10, v92 offset:0
    v_mfma_f32_16x16x32_bf16 v[116:119], a[36:39], v[124:127], v[116:119]
    v_mfma_f32_16x16x32_bf16 v[116:119], a[60:63], v[128:131], v[116:119]
    s_add_u32 s57, s58, s70
    v_mfma_f32_16x16x32_bf16 v[116:119], a[84:87], v[132:135], v[116:119]
    buffer_load_dwordx4 v24, s[24:27], s57 offen offset:2048 sc1 lds
    v_mfma_f32_16x16x32_bf16 v[116:119], a[108:111], v[136:139], v[116:119]
    v_cndmask_b32 v26, v72, v73, s[76:77]
    v_cndmask_b32 v27, v74, v75, s[76:77]
    v_mfma_f32_16x16x32_bf16 v[116:119], a[132:135], v[140:143], v[116:119]
    v_cndmask_b32 v28, v76, v77, s[76:77]
    v_cndmask_b32 v29, v78, v79, s[76:77]
    v_mfma_f32_16x16x32_bf16 v[116:119], a[156:159], v[144:147], v[116:119]
    v_cvt_pk_bf16_f32 v52, v112, v113
    v_cvt_pk_bf16_f32 v53, v114, v115
    v_mfma_f32_16x16x32_bf16 v[116:119], a[180:183], v[148:151], v[116:119]
    v_cndmask_b32 v26, v26, v28, s[78:79]
    v_cndmask_b32 v27, v27, v29, s[80:81]
    v_mfma_f32_16x16x32_bf16 v[116:119], a[204:207], v[152:155], v[116:119]
    s_add_u32 s57, s58, s71
    s_waitcnt lgkmcnt(0)
    v_mfma_f32_16x16x32_bf16 v[116:119], a[228:231], v[156:159], v[116:119]
    buffer_load_dwordx4 v3, s[24:27], s57 offen offset:3072 sc1 lds
    v_mfma_f32_16x16x32_bf16 v[116:119], a[252:255], v[160:163], v[116:119]
    v_mul_f32 v26, v26, v8
    v_mul_f32 v27, v27, v9
    v_mfma_f32_16x16x32_bf16 v[116:119], v[196:199], v[164:167], v[116:119]
    v_mul_f32 v11, s91, v10
    v_cndmask_b32 v26, v26, v18, s[84:85]
    v_mfma_f32_16x16x32_bf16 v[116:119], v[220:223], v[168:171], v[116:119]
    v_cndmask_b32 v27, v27, v18, s[86:87]
    v_max_f32 v28, v26, v27
    v_mfma_f32_16x16x32_bf16 v[116:119], v[244:247], v[172:175], v[116:119]
    v_mov_b32 v29, v28
    v_mfma_f32_16x16x32_bf16 v[96:99], v[120:123], a[16:19], 0
    s_add_u32 m0, s52, 114688
    s_add_u32 s58, s72, 3072
    s_add_u32 s57, s58, s68
    v_mfma_f32_16x16x32_bf16 v[96:99], v[124:127], a[40:43], v[96:99]
    buffer_load_dwordx4 v3, s[24:27], s57 offen offset:0 sc1 lds
    v_mfma_f32_16x16x32_bf16 v[96:99], v[128:131], a[64:67], v[96:99]
    v_permlane16_swap_b32 v28, v29
    v_max_f32 v28, v28, v29
    v_mfma_f32_16x16x32_bf16 v[96:99], v[132:135], a[88:91], v[96:99]
    v_mov_b32 v29, v28
    v_mfma_f32_16x16x32_bf16 v[96:99], v[136:139], a[112:115], v[96:99]
    v_mfma_f32_16x16x32_bf16 v[96:99], v[140:143], a[136:139], v[96:99]
    v_permlane32_swap_b32 v28, v29
    v_max_f32 v28, v28, v29
    v_mfma_f32_16x16x32_bf16 v[96:99], v[144:147], a[160:163], v[96:99]
    s_add_u32 s57, s58, s69
    v_cvt_pk_bf16_f32 v54, v116, v117
    v_mfma_f32_16x16x32_bf16 v[96:99], v[148:151], a[184:187], v[96:99]
    buffer_load_dwordx4 v3, s[24:27], s57 offen offset:1024 sc1 lds
    v_mfma_f32_16x16x32_bf16 v[96:99], v[152:155], a[208:211], v[96:99]
    v_cvt_pk_bf16_f32 v55, v118, v119
    v_cndmask_b32 v54, v54, 0, s[82:83]
    v_mfma_f32_16x16x32_bf16 v[96:99], v[156:159], a[232:235], v[96:99]
    v_cndmask_b32 v55, v55, 0, s[82:83]
    v_sub_f32 v26, v26, v28
    v_mfma_f32_16x16x32_bf16 v[96:99], v[160:163], v[176:179], v[96:99]
    v_sub_f32 v27, v27, v28
    v_mul_f32 v26, v11, v26
    v_mfma_f32_16x16x32_bf16 v[96:99], v[164:167], v[200:203], v[96:99]
    v_mul_f32 v27, v11, v27
    v_exp_f32 v26, v26
    v_mfma_f32_16x16x32_bf16 v[96:99], v[168:171], v[224:227], v[96:99]
    s_add_u32 s57, s58, s70
    v_exp_f32 v27, v27
    v_mfma_f32_16x16x32_bf16 v[96:99], v[172:175], v[248:251], v[96:99]
    buffer_load_dwordx4 v24, s[24:27], s57 offen offset:2048 sc1 lds
    v_mfma_f32_16x16x32_bf16 v[100:103], v[120:123], a[20:23], 0
    v_add_f32 v28, v26, v27
    v_mov_b32 v29, v28
    v_mfma_f32_16x16x32_bf16 v[100:103], v[124:127], a[44:47], v[100:103]
    v_mfma_f32_16x16x32_bf16 v[100:103], v[128:131], a[68:71], v[100:103]
    v_permlane16_swap_b32 v28, v29
    v_add_f32 v28, v28, v29
    v_mfma_f32_16x16x32_bf16 v[100:103], v[132:135], a[92:95], v[100:103]
    v_mov_b32 v29, v28
    v_mfma_f32_16x16x32_bf16 v[100:103], v[136:139], a[116:119], v[100:103]
    s_add_u32 s57, s58, s71
    v_mfma_f32_16x16x32_bf16 v[100:103], v[140:143], a[140:143], v[100:103]
    buffer_load_dwordx4 v3, s[24:27], s57 offen offset:3072 sc1 lds
    v_mfma_f32_16x16x32_bf16 v[100:103], v[144:147], a[164:167], v[100:103]
    v_cvt_pk_bf16_f32 v38, v96, v97
    v_cvt_pk_bf16_f32 v39, v98, v99
    v_mfma_f32_16x16x32_bf16 v[100:103], v[148:151], a[188:191], v[100:103]
    v_permlane32_swap_b32 v28, v29
    v_add_f32 v28, v28, v29
    v_mfma_f32_16x16x32_bf16 v[100:103], v[152:155], a[212:215], v[100:103]
    v_rcp_f32 v28, v28
    v_mfma_f32_16x16x32_bf16 v[100:103], v[156:159], a[236:239], v[100:103]
    v_mul_f32 v26, v26, v8
    v_mul_f32 v27, v27, v9
    v_mfma_f32_16x16x32_bf16 v[100:103], v[160:163], v[180:183], v[100:103]
    s_add_u32 m0, s52, 131072
    s_add_u32 s58, s72, 3584
    s_add_u32 s57, s58, s68
    v_mul_f32 v26, v26, v28
    v_mfma_f32_16x16x32_bf16 v[100:103], v[164:167], v[204:207], v[100:103]
    buffer_load_dwordx4 v3, s[24:27], s57 offen offset:0 sc1 lds
    v_mfma_f32_16x16x32_bf16 v[100:103], v[168:171], v[228:231], v[100:103]
    v_mul_f32 v27, v27, v28
    v_cvt_pk_bf16_f32 v26, v26, v26
    v_mfma_f32_16x16x32_bf16 v[100:103], v[172:175], v[252:255], v[100:103]
    v_cvt_pk_bf16_f32 v27, v27, v27
    v_and_b32 v80, v26, v14
    v_mfma_f32_16x16x32_bf16 v[104:107], a[0:3], v[120:123], 0
    v_and_b32 v81, v27, v15
    v_and_b32 v82, v26, v16
L_wa_1:
    s_cbranch_execz L_wa_ret
    v_mfma_f32_16x16x32_bf16 v[104:107], a[24:27], v[124:127], v[104:107]
    v_and_b32 v83, v27, v17
    v_mfma_f32_16x16x32_bf16 v[104:107], a[48:51], v[128:131], v[104:107]
    s_add_u32 s57, s58, s69
    v_mfma_f32_16x16x32_bf16 v[104:107], a[72:75], v[132:135], v[104:107]
    buffer_load_dwordx4 v3, s[24:27], s57 offen offset:1024 sc1 lds
    v_mfma_f32_16x16x32_bf16 v[104:107], a[96:99], v[136:139], v[104:107]
    v_mfma_f32_16x16x32_bf16 v[72:75], v[32:35], v[80:83], 0
    v_mfma_f32_16x16x32_bf16 v[104:107], a[120:123], v[140:143], v[104:107]
    v_mfma_f32_16x16x32_bf16 v[76:79], v[42:45], v[80:83], 0
    v_mfma_f32_16x16x32_bf16 v[104:107], a[144:147], v[144:147], v[104:107]
    v_cvt_pk_bf16_f32 v48, v100, v101
    v_cvt_pk_bf16_f32 v49, v102, v103
    v_mfma_f32_16x16x32_bf16 v[104:107], a[168:171], v[148:151], v[104:107]
    s_add_u32 s53, s74, 0
    v_mfma_f32_16x16x32_bf16 v[104:107], a[192:195], v[152:155], v[104:107]
    s_add_u32 s57, s58, s70
    v_mfma_f32_16x16x32_bf16 v[104:107], a[216:219], v[156:159], v[104:107]
    buffer_load_dwordx4 v24, s[24:27], s57 offen offset:2048 sc1 lds
    v_mfma_f32_16x16x32_bf16 v[104:107], a[240:243], v[160:163], v[104:107]
    v_mfma_f32_16x16x32_bf16 v[104:107], v[184:187], v[164:167], v[104:107]
    v_mfma_f32_16x16x32_bf16 v[104:107], v[208:211], v[168:171], v[104:107]
    v_cvt_pk_bf16_f32 v84, v72, v73
    v_cvt_pk_bf16_f32 v85, v74, v75
    v_mfma_f32_16x16x32_bf16 v[104:107], v[232:235], v[172:175], v[104:107]
    v_cvt_pk_bf16_f32 v86, v76, v77
    v_cvt_pk_bf16_f32 v87, v78, v79
    s_waitcnt vmcnt(7)
    s_barrier
    v_mfma_f32_16x16x32_bf16 v[108:111], a[4:7], v[120:123], 0
    v_add_u32 v4, 65536, v4
    v_add_u32 v25, 65536, v25
    ds_read_b64_tr_b16 v[120:121], v4 offset:0
    ds_read_b64_tr_b16 v[122:123], v25 offset:0
    s_add_u32 s57, s58, s71
    v_mfma_f32_16x16x32_bf16 v[108:111], a[28:31], v[124:127], v[108:111]
    buffer_load_dwordx4 v3, s[24:27], s57 offen offset:3072 sc1 lds
    v_mfma_f32_16x16x32_bf16 v[108:111], a[52:55], v[128:131], v[108:111]
    ds_read_b64_tr_b16 v[124:125], v4 offset:1024
    ds_read_b64_tr_b16 v[126:127], v25 offset:1024
    v_mfma_f32_16x16x32_bf16 v[108:111], a[76:79], v[132:135], v[108:111]
    ds_read_b64_tr_b16 v[128:129], v4 offset:2048
    ds_read_b64_tr_b16 v[130:131], v25 offset:2048
    v_mfma_f32_16x16x32_bf16 v[108:111], a[100:103], v[136:139], v[108:111]
    ds_read_b64_tr_b16 v[132:133], v4 offset:3072
    buffer_store_dwordx4 v[84:87], v23, s[24:27], s53 offen sc1
    v_mfma_f32_16x16x32_bf16 v[108:111], a[124:127], v[140:143], v[108:111]
    ds_read_b64_tr_b16 v[134:135], v25 offset:3072
    ds_read_b64_tr_b16 v[136:137], v4 offset:4096
    v_mfma_f32_16x16x32_bf16 v[108:111], a[148:151], v[144:147], v[108:111]
    ds_read_b64_tr_b16 v[138:139], v25 offset:4096
    s_add_u32 s57, s73, 0
    v_mfma_f32_16x16x32_bf16 v[108:111], a[172:175], v[148:151], v[108:111]
    buffer_load_dword v22, v5, s[20:23], s57 offen
    v_mfma_f32_16x16x32_bf16 v[108:111], a[196:199], v[152:155], v[108:111]
    ds_read_b64_tr_b16 v[140:141], v4 offset:5120
    ds_read_b64_tr_b16 v[142:143], v25 offset:5120
    v_mfma_f32_16x16x32_bf16 v[108:111], a[220:223], v[156:159], v[108:111]
    ds_read_b64_tr_b16 v[144:145], v4 offset:6144
    ds_read_b64_tr_b16 v[146:147], v25 offset:6144
    v_mfma_f32_16x16x32_bf16 v[108:111], a[244:247], v[160:163], v[108:111]
    ds_read_b64_tr_b16 v[148:149], v4 offset:7168
    ds_read_b64_tr_b16 v[150:151], v25 offset:7168
    v_mfma_f32_16x16x32_bf16 v[108:111], v[188:191], v[164:167], v[108:111]
    ds_read_b64_tr_b16 v[152:153], v4 offset:8192
    v_cvt_pk_bf16_f32 v68, v104, v105
    v_mfma_f32_16x16x32_bf16 v[108:111], v[212:215], v[168:171], v[108:111]
    ds_read_b64_tr_b16 v[154:155], v25 offset:8192
    ds_read_b64_tr_b16 v[156:157], v4 offset:9216
    v_mfma_f32_16x16x32_bf16 v[108:111], v[236:239], v[172:175], v[108:111]
    ds_read_b64_tr_b16 v[158:159], v25 offset:9216
    v_cvt_pk_bf16_f32 v69, v106, v107
    s_waitcnt lgkmcnt(15)
    v_mfma_f32_16x16x32_bf16 v[112:115], a[8:11], v[120:123], 0
    ds_read_b64_tr_b16 v[160:161], v4 offset:10240
    v_cndmask_b32 v80, v84, v86, s[88:89]
    v_mfma_f32_16x16x32_bf16 v[112:115], a[32:35], v[124:127], v[112:115]
    ds_read_b64_tr_b16 v[162:163], v25 offset:10240
    ds_read_b64_tr_b16 v[164:165], v4 offset:11264
    s_waitcnt lgkmcnt(15)
    v_mfma_f32_16x16x32_bf16 v[112:115], a[56:59], v[128:131], v[112:115]
    ds_read_b64_tr_b16 v[166:167], v25 offset:11264
    v_cndmask_b32 v81, v85, v87, s[88:89]
    v_mfma_f32_16x16x32_bf16 v[112:115], a[80:83], v[132:135], v[112:115]
    ds_read_b64_tr_b16 v[168:169], v4 offset:12288
    ds_write_b64 v95, v[80:81] offset:0
    s_waitcnt lgkmcnt(14)
    v_mfma_f32_16x16x32_bf16 v[112:115], a[104:107], v[136:139], v[112:115]
    ds_read_b64_tr_b16 v[170:171], v25 offset:12288
    ds_read_b64_tr_b16 v[172:173], v4 offset:13312
    v_mfma_f32_16x16x32_bf16 v[112:115], a[128:131], v[140:143], v[112:115]
    ds_read_b64_tr_b16 v[174:175], v25 offset:13312
    s_waitcnt lgkmcnt(13)
    v_mfma_f32_16x16x32_bf16 v[112:115], a[152:155], v[144:147], v[112:115]
    v_cvt_pk_bf16_f32 v70, v108, v109
    v_cvt_pk_bf16_f32 v71, v110, v111
    v_mfma_f32_16x16x32_bf16 v[112:115], a[176:179], v[148:151], v[112:115]
    v_cndmask_b32 v70, v70, 0, s[82:83]
    v_cndmask_b32 v71, v71, 0, s[82:83]
    s_waitcnt lgkmcnt(9)
    v_mfma_f32_16x16x32_bf16 v[112:115], a[200:203], v[152:155], v[112:115]
    v_mfma_f32_16x16x32_bf16 v[72:75], v[56:59], v[64:67], 0
    v_mfma_f32_16x16x32_bf16 v[112:115], a[224:227], v[156:159], v[112:115]
    v_mfma_f32_16x16x32_bf16 v[76:79], v[60:63], v[64:67], 0
    s_waitcnt lgkmcnt(5)
    v_mfma_f32_16x16x32_bf16 v[112:115], a[248:251], v[160:163], v[112:115]
    ds_read_u16_d16_hi v8, v93 offset:16384
    ds_read_u16_d16_hi v9, v94 offset:16384
    v_mfma_f32_16x16x32_bf16 v[112:115], v[192:195], v[164:167], v[112:115]
    ds_read_u16_d16_hi v10, v92 offset:16384
    s_waitcnt lgkmcnt(3)
    v_mfma_f32_16x16x32_bf16 v[112:115], v[216:219], v[168:171], v[112:115]
    v_mfma_f32_16x16x32_bf16 v[112:115], v[240:243], v[172:175], v[112:115]
    v_mfma_f32_16x16x32_bf16 v[116:119], a[12:15], v[120:123], 0
    v_mfma_f32_16x16x32_bf16 v[116:119], a[36:39], v[124:127], v[116:119]
    v_cndmask_b32 v26, v72, v73, s[76:77]
    v_cndmask_b32 v27, v74, v75, s[76:77]
    v_mfma_f32_16x16x32_bf16 v[116:119], a[60:63], v[128:131], v[116:119]
    v_cndmask_b32 v28, v76, v77, s[76:77]
    v_cndmask_b32 v29, v78, v79, s[76:77]
    v_mfma_f32_16x16x32_bf16 v[116:119], a[84:87], v[132:135], v[116:119]
    v_cndmask_b32 v26, v26, v28, s[78:79]
    v_cndmask_b32 v27, v27, v29, s[80:81]
    v_mfma_f32_16x16x32_bf16 v[116:119], a[108:111], v[136:139], v[116:119]
    s_waitcnt lgkmcnt(0)
    v_mul_f32 v26, v26, v8
    v_mfma_f32_16x16x32_bf16 v[116:119], a[132:135], v[140:143], v[116:119]
    v_mul_f32 v27, v27, v9
    v_mul_f32 v11, s91, v10
    v_mfma_f32_16x16x32_bf16 v[116:119], a[156:159], v[144:147], v[116:119]
    v_cvt_pk_bf16_f32 v56, v112, v113
    v_cvt_pk_bf16_f32 v57, v114, v115
    v_mfma_f32_16x16x32_bf16 v[116:119], a[180:183], v[148:151], v[116:119]
    v_max_f32 v28, v26, v27
    v_mov_b32 v29, v28
    v_mfma_f32_16x16x32_bf16 v[116:119], a[204:207], v[152:155], v[116:119]
    v_mfma_f32_16x16x32_bf16 v[116:119], a[228:231], v[156:159], v[116:119]
    v_permlane16_swap_b32 v28, v29
    v_max_f32 v28, v28, v29
    v_mfma_f32_16x16x32_bf16 v[116:119], a[252:255], v[160:163], v[116:119]
    v_mov_b32 v29, v28
    v_mfma_f32_16x16x32_bf16 v[116:119], v[196:199], v[164:167], v[116:119]
    v_mfma_f32_16x16x32_bf16 v[116:119], v[220:223], v[168:171], v[116:119]
    v_permlane32_swap_b32 v28, v29
    v_max_f32 v28, v28, v29
    v_mfma_f32_16x16x32_bf16 v[116:119], v[244:247], v[172:175], v[116:119]
    v_sub_f32 v26, v26, v28
    v_sub_f32 v27, v27, v28
    v_mfma_f32_16x16x32_bf16 v[96:99], v[120:123], a[16:19], 0
    v_mul_f32 v26, v11, v26
    v_mul_f32 v27, v11, v27
    v_mfma_f32_16x16x32_bf16 v[96:99], v[124:127], a[40:43], v[96:99]
    v_exp_f32 v26, v26
    v_mfma_f32_16x16x32_bf16 v[96:99], v[128:131], a[64:67], v[96:99]
    v_exp_f32 v27, v27
    v_mfma_f32_16x16x32_bf16 v[96:99], v[132:135], a[88:91], v[96:99]
    v_add_f32 v28, v26, v27
    v_mov_b32 v29, v28
    v_mfma_f32_16x16x32_bf16 v[96:99], v[136:139], a[112:115], v[96:99]
    v_mfma_f32_16x16x32_bf16 v[96:99], v[140:143], a[136:139], v[96:99]
    v_permlane16_swap_b32 v28, v29
    v_add_f32 v28, v28, v29
    v_mfma_f32_16x16x32_bf16 v[96:99], v[144:147], a[160:163], v[96:99]
    v_cvt_pk_bf16_f32 v58, v116, v117
    v_cvt_pk_bf16_f32 v59, v118, v119
    v_mfma_f32_16x16x32_bf16 v[96:99], v[148:151], a[184:187], v[96:99]
    v_cndmask_b32 v58, v58, 0, s[82:83]
    v_cndmask_b32 v59, v59, 0, s[82:83]
    v_mfma_f32_16x16x32_bf16 v[96:99], v[152:155], a[208:211], v[96:99]
    v_mov_b32 v29, v28
    v_mfma_f32_16x16x32_bf16 v[96:99], v[156:159], a[232:235], v[96:99]
    v_mfma_f32_16x16x32_bf16 v[96:99], v[160:163], v[176:179], v[96:99]
    v_permlane32_swap_b32 v28, v29
    v_add_f32 v28, v28, v29
    v_mfma_f32_16x16x32_bf16 v[96:99], v[164:167], v[200:203], v[96:99]
    v_rcp_f32 v28, v28
    v_mfma_f32_16x16x32_bf16 v[96:99], v[168:171], v[224:227], v[96:99]
    v_mul_f32 v26, v26, v8
    v_mul_f32 v27, v27, v9
    v_mfma_f32_16x16x32_bf16 v[96:99], v[172:175], v[248:251], v[96:99]
    v_mul_f32 v26, v26, v28
    v_mul_f32 v27, v27, v28
    v_mfma_f32_16x16x32_bf16 v[100:103], v[120:123], a[20:23], 0
    v_cvt_pk_bf16_f32 v26, v26, v26
    v_cvt_pk_bf16_f32 v27, v27, v27
    v_mfma_f32_16x16x32_bf16 v[100:103], v[124:127], a[44:47], v[100:103]
    v_and_b32 v80, v26, v14
    v_and_b32 v81, v27, v15
    v_mfma_f32_16x16x32_bf16 v[100:103], v[128:131], a[68:71], v[100:103]
    v_and_b32 v82, v26, v16
    v_and_b32 v83, v27, v17
    v_mfma_f32_16x16x32_bf16 v[100:103], v[132:135], a[92:95], v[100:103]
    v_mfma_f32_16x16x32_bf16 v[100:103], v[136:139], a[116:119], v[100:103]
    v_mfma_f32_16x16x32_bf16 v[72:75], v[34:37], v[80:83], 0
    v_mfma_f32_16x16x32_bf16 v[100:103], v[140:143], a[140:143], v[100:103]
    v_mfma_f32_16x16x32_bf16 v[76:79], v[44:47], v[80:83], 0
    v_mfma_f32_16x16x32_bf16 v[100:103], v[144:147], a[164:167], v[100:103]
    s_add_u32 s57, s73, 524288
    v_cvt_pk_bf16_f32 v40, v96, v97
    v_mfma_f32_16x16x32_bf16 v[100:103], v[148:151], a[188:191], v[100:103]
    buffer_load_dword v22, v5, s[20:23], s57 offen
    v_mfma_f32_16x16x32_bf16 v[100:103], v[152:155], a[212:215], v[100:103]
    v_cvt_pk_bf16_f32 v41, v98, v99
    v_cvt_pk_bf16_f32 v32, v96, v97
    v_mfma_f32_16x16x32_bf16 v[100:103], v[156:159], a[236:239], v[100:103]
    v_cvt_pk_bf16_f32 v33, v98, v99
    s_add_u32 s53, s74, 16384
    v_mfma_f32_16x16x32_bf16 v[100:103], v[160:163], v[180:183], v[100:103]
    v_mfma_f32_16x16x32_bf16 v[100:103], v[164:167], v[204:207], v[100:103]
    v_mfma_f32_16x16x32_bf16 v[100:103], v[168:171], v[228:231], v[100:103]
    v_mfma_f32_16x16x32_bf16 v[100:103], v[172:175], v[252:255], v[100:103]
    v_mfma_f32_16x16x32_bf16 v[104:107], a[0:3], v[120:123], 0
    v_cvt_pk_bf16_f32 v84, v72, v73
    v_cvt_pk_bf16_f32 v85, v74, v75
    v_mfma_f32_16x16x32_bf16 v[104:107], a[24:27], v[124:127], v[104:107]
    v_cvt_pk_bf16_f32 v86, v76, v77
    v_cvt_pk_bf16_f32 v87, v78, v79
    v_mfma_f32_16x16x32_bf16 v[104:107], a[48:51], v[128:131], v[104:107]
    buffer_store_dwordx4 v[84:87], v23, s[24:27], s53 offen sc1
    v_mfma_f32_16x16x32_bf16 v[104:107], a[72:75], v[132:135], v[104:107]
    v_cndmask_b32 v80, v84, v86, s[88:89]
    v_cndmask_b32 v81, v85, v87, s[88:89]
    v_mfma_f32_16x16x32_bf16 v[104:107], a[96:99], v[136:139], v[104:107]
    ds_write_b64 v95, v[80:81] offset:256
    v_mfma_f32_16x16x32_bf16 v[104:107], a[120:123], v[140:143], v[104:107]
    v_mfma_f32_16x16x32_bf16 v[72:75], v[60:63], v[68:71], 0
    v_mfma_f32_16x16x32_bf16 v[104:107], a[144:147], v[144:147], v[104:107]
    v_cvt_pk_bf16_f32 v50, v100, v101
    v_cvt_pk_bf16_f32 v51, v102, v103
    v_mfma_f32_16x16x32_bf16 v[104:107], a[168:171], v[148:151], v[104:107]
    v_cvt_pk_bf16_f32 v42, v100, v101
    v_cvt_pk_bf16_f32 v43, v102, v103
    v_mfma_f32_16x16x32_bf16 v[104:107], a[192:195], v[152:155], v[104:107]
    v_mfma_f32_16x16x32_bf16 v[76:79], v[52:55], v[68:71], 0
    v_mfma_f32_16x16x32_bf16 v[104:107], a[216:219], v[156:159], v[104:107]
    ds_read_u16_d16_hi v8, v93 offset:32768
    ds_read_u16_d16_hi v9, v94 offset:32768
    v_mfma_f32_16x16x32_bf16 v[104:107], a[240:243], v[160:163], v[104:107]
    ds_read_u16_d16_hi v10, v92 offset:32768
    v_mfma_f32_16x16x32_bf16 v[104:107], v[184:187], v[164:167], v[104:107]
    v_mfma_f32_16x16x32_bf16 v[104:107], v[208:211], v[168:171], v[104:107]
    v_mfma_f32_16x16x32_bf16 v[104:107], v[232:235], v[172:175], v[104:107]
    v_mfma_f32_16x16x32_bf16 v[108:111], a[4:7], v[120:123], 0
    ds_read_b64_tr_b16 v[120:121], v4 offset:16384
    ds_read_b64_tr_b16 v[122:123], v25 offset:16384
    v_mfma_f32_16x16x32_bf16 v[108:111], a[28:31], v[124:127], v[108:111]
    ds_read_b64_tr_b16 v[124:125], v4 offset:17408
    v_cndmask_b32 v26, v72, v73, s[76:77]
    v_mfma_f32_16x16x32_bf16 v[108:111], a[52:55], v[128:131], v[108:111]
    ds_read_b64_tr_b16 v[126:127], v25 offset:17408
    ds_read_b64_tr_b16 v[128:129], v4 offset:18432
    v_mfma_f32_16x16x32_bf16 v[108:111], a[76:79], v[132:135], v[108:111]
    ds_read_b64_tr_b16 v[130:131], v25 offset:18432
    v_cndmask_b32 v27, v74, v75, s[76:77]
    v_mfma_f32_16x16x32_bf16 v[108:111], a[100:103], v[136:139], v[108:111]
    ds_read_b64_tr_b16 v[132:133], v4 offset:19456
    v_cndmask_b32 v28, v76, v77, s[76:77]
    v_mfma_f32_16x16x32_bf16 v[108:111], a[124:127], v[140:143], v[108:111]
    ds_read_b64_tr_b16 v[134:135], v25 offset:19456
    ds_read_b64_tr_b16 v[136:137], v4 offset:20480
    v_mfma_f32_16x16x32_bf16 v[108:111], a[148:151], v[144:147], v[108:111]
    ds_read_b64_tr_b16 v[138:139], v25 offset:20480
    v_cvt_pk_bf16_f32 v64, v104, v105
    v_mfma_f32_16x16x32_bf16 v[108:111], a[172:175], v[148:151], v[108:111]
    ds_read_b64_tr_b16 v[140:141], v4 offset:21504
    ds_read_b64_tr_b16 v[142:143], v25 offset:21504
    v_mfma_f32_16x16x32_bf16 v[108:111], a[196:199], v[152:155], v[108:111]
    ds_read_b64_tr_b16 v[144:145], v4 offset:22528
    v_cvt_pk_bf16_f32 v65, v106, v107
    v_mfma_f32_16x16x32_bf16 v[108:111], a[220:223], v[156:159], v[108:111]
    ds_read_b64_tr_b16 v[146:147], v25 offset:22528
    v_cndmask_b32 v29, v78, v79, s[76:77]
    v_mfma_f32_16x16x32_bf16 v[108:111], a[244:247], v[160:163], v[108:111]
    ds_read_b64_tr_b16 v[148:149], v4 offset:23552
    ds_read_b64_tr_b16 v[150:151], v25 offset:23552
    v_mfma_f32_16x16x32_bf16 v[108:111], v[188:191], v[164:167], v[108:111]
    ds_read_b64_tr_b16 v[152:153], v4 offset:24576
    v_cndmask_b32 v26, v26, v28, s[78:79]
    v_mfma_f32_16x16x32_bf16 v[108:111], v[212:215], v[168:171], v[108:111]
    ds_read_b64_tr_b16 v[154:155], v25 offset:24576
    ds_read_b64_tr_b16 v[156:157], v4 offset:25600
    v_mfma_f32_16x16x32_bf16 v[108:111], v[236:239], v[172:175], v[108:111]
    ds_read_b64_tr_b16 v[158:159], v25 offset:25600
    v_cndmask_b32 v27, v27, v29, s[80:81]
    s_waitcnt lgkmcnt(15)
    v_mfma_f32_16x16x32_bf16 v[112:115], a[8:11], v[120:123], 0
    ds_read_b64_tr_b16 v[160:161], v4 offset:26624
    v_mfma_f32_16x16x32_bf16 v[112:115], a[32:35], v[124:127], v[112:115]
    ds_read_b64_tr_b16 v[162:163], v25 offset:26624
    ds_read_b64_tr_b16 v[164:165], v4 offset:27648
    s_waitcnt lgkmcnt(15)
    v_mfma_f32_16x16x32_bf16 v[112:115], a[56:59], v[128:131], v[112:115]
    ds_read_b64_tr_b16 v[166:167], v25 offset:27648
    v_mul_f32 v26, v26, v8
    v_mfma_f32_16x16x32_bf16 v[112:115], a[80:83], v[132:135], v[112:115]
    ds_read_b64_tr_b16 v[168:169], v4 offset:28672
    v_mul_f32 v27, v27, v9
    s_waitcnt lgkmcnt(13)
    v_mfma_f32_16x16x32_bf16 v[112:115], a[104:107], v[136:139], v[112:115]
    ds_read_b64_tr_b16 v[170:171], v25 offset:28672
    ds_read_b64_tr_b16 v[172:173], v4 offset:29696
    v_mfma_f32_16x16x32_bf16 v[112:115], a[128:131], v[140:143], v[112:115]
    ds_read_b64_tr_b16 v[174:175], v25 offset:29696
    v_mul_f32 v11, s91, v10
    s_waitcnt lgkmcnt(12)
    v_mfma_f32_16x16x32_bf16 v[112:115], a[152:155], v[144:147], v[112:115]
    v_cvt_pk_bf16_f32 v66, v108, v109
    v_cvt_pk_bf16_f32 v67, v110, v111
    v_mfma_f32_16x16x32_bf16 v[112:115], a[176:179], v[148:151], v[112:115]
    v_cndmask_b32 v66, v66, 0, s[82:83]
    v_cndmask_b32 v67, v67, 0, s[82:83]
    s_waitcnt lgkmcnt(8)
    v_mfma_f32_16x16x32_bf16 v[112:115], a[200:203], v[152:155], v[112:115]
    v_max_f32 v28, v26, v27
    v_mov_b32 v29, v28
    v_mfma_f32_16x16x32_bf16 v[112:115], a[224:227], v[156:159], v[112:115]
    s_waitcnt lgkmcnt(4)
    v_mfma_f32_16x16x32_bf16 v[112:115], a[248:251], v[160:163], v[112:115]
    v_permlane16_swap_b32 v28, v29
    v_max_f32 v28, v28, v29
    v_mfma_f32_16x16x32_bf16 v[112:115], v[192:195], v[164:167], v[112:115]
    v_mov_b32 v29, v28
    s_waitcnt lgkmcnt(0)
    v_mfma_f32_16x16x32_bf16 v[112:115], v[216:219], v[168:171], v[112:115]
    v_mfma_f32_16x16x32_bf16 v[112:115], v[240:243], v[172:175], v[112:115]
    v_permlane32_swap_b32 v28, v29
    v_max_f32 v28, v28, v29
    v_mfma_f32_16x16x32_bf16 v[116:119], a[12:15], v[120:123], 0
    v_sub_f32 v26, v26, v28
    v_sub_f32 v27, v27, v28
    v_mfma_f32_16x16x32_bf16 v[116:119], a[36:39], v[124:127], v[116:119]
    v_mul_f32 v26, v11, v26
    v_mul_f32 v27, v11, v27
    v_mfma_f32_16x16x32_bf16 v[116:119], a[60:63], v[128:131], v[116:119]
    v_exp_f32 v26, v26
    v_mfma_f32_16x16x32_bf16 v[116:119], a[84:87], v[132:135], v[116:119]
    v_exp_f32 v27, v27
    v_mfma_f32_16x16x32_bf16 v[116:119], a[108:111], v[136:139], v[116:119]
    v_add_f32 v28, v26, v27
    v_mov_b32 v29, v28
    v_mfma_f32_16x16x32_bf16 v[116:119], a[132:135], v[140:143], v[116:119]
    v_mfma_f32_16x16x32_bf16 v[116:119], a[156:159], v[144:147], v[116:119]
    s_add_u32 s57, s75, 0
    v_cvt_pk_bf16_f32 v60, v112, v113
    v_mfma_f32_16x16x32_bf16 v[116:119], a[180:183], v[148:151], v[116:119]
    buffer_load_dword v22, v20, s[12:15], s57 offen
    v_mfma_f32_16x16x32_bf16 v[116:119], a[204:207], v[152:155], v[116:119]
    v_cvt_pk_bf16_f32 v61, v114, v115
    v_permlane16_swap_b32 v28, v29
    v_mfma_f32_16x16x32_bf16 v[116:119], a[228:231], v[156:159], v[116:119]
    v_add_f32 v28, v28, v29
    v_mov_b32 v29, v28
    v_mfma_f32_16x16x32_bf16 v[116:119], a[252:255], v[160:163], v[116:119]
    v_mfma_f32_16x16x32_bf16 v[116:119], v[196:199], v[164:167], v[116:119]
    v_permlane32_swap_b32 v28, v29
    v_add_f32 v28, v28, v29
    v_mfma_f32_16x16x32_bf16 v[116:119], v[220:223], v[168:171], v[116:119]
    v_rcp_f32 v28, v28
    v_mfma_f32_16x16x32_bf16 v[116:119], v[244:247], v[172:175], v[116:119]
    v_mul_f32 v26, v26, v8
    v_mul_f32 v27, v27, v9
    v_mfma_f32_16x16x32_bf16 v[96:99], v[120:123], a[16:19], 0
    v_mul_f32 v26, v26, v28
    v_mul_f32 v27, v27, v28
    v_mfma_f32_16x16x32_bf16 v[96:99], v[124:127], a[40:43], v[96:99]
    v_cvt_pk_bf16_f32 v26, v26, v26
    v_cvt_pk_bf16_f32 v27, v27, v27
    v_mfma_f32_16x16x32_bf16 v[96:99], v[128:131], a[64:67], v[96:99]
    v_and_b32 v80, v26, v14
    v_and_b32 v81, v27, v15
    v_mfma_f32_16x16x32_bf16 v[96:99], v[132:135], a[88:91], v[96:99]
    v_and_b32 v82, v26, v16
    v_and_b32 v83, v27, v17
    v_mfma_f32_16x16x32_bf16 v[96:99], v[136:139], a[112:115], v[96:99]
    v_mfma_f32_16x16x32_bf16 v[96:99], v[140:143], a[136:139], v[96:99]
    v_mfma_f32_16x16x32_bf16 v[72:75], v[36:39], v[80:83], 0
    v_mfma_f32_16x16x32_bf16 v[96:99], v[144:147], a[160:163], v[96:99]
    v_cvt_pk_bf16_f32 v62, v116, v117
    v_cvt_pk_bf16_f32 v63, v118, v119
    v_mfma_f32_16x16x32_bf16 v[96:99], v[148:151], a[184:187], v[96:99]
    v_cndmask_b32 v62, v62, 0, s[82:83]
    v_cndmask_b32 v63, v63, 0, s[82:83]
    v_mfma_f32_16x16x32_bf16 v[96:99], v[152:155], a[208:211], v[96:99]
    v_mfma_f32_16x16x32_bf16 v[76:79], v[46:49], v[80:83], 0
    v_mfma_f32_16x16x32_bf16 v[96:99], v[156:159], a[232:235], v[96:99]
    s_add_u32 s53, s74, 32768
    v_mfma_f32_16x16x32_bf16 v[96:99], v[160:163], v[176:179], v[96:99]
    v_mfma_f32_16x16x32_bf16 v[96:99], v[164:167], v[200:203], v[96:99]
    v_mfma_f32_16x16x32_bf16 v[96:99], v[168:171], v[224:227], v[96:99]
    v_mfma_f32_16x16x32_bf16 v[96:99], v[172:175], v[248:251], v[96:99]
    v_mfma_f32_16x16x32_bf16 v[100:103], v[120:123], a[20:23], 0
    v_cvt_pk_bf16_f32 v84, v72, v73
    v_cvt_pk_bf16_f32 v85, v74, v75
    v_mfma_f32_16x16x32_bf16 v[100:103], v[124:127], a[44:47], v[100:103]
    v_cvt_pk_bf16_f32 v86, v76, v77
    v_cvt_pk_bf16_f32 v87, v78, v79
    v_mfma_f32_16x16x32_bf16 v[100:103], v[128:131], a[68:71], v[100:103]
    buffer_store_dwordx4 v[84:87], v23, s[24:27], s53 offen sc1
    v_mfma_f32_16x16x32_bf16 v[100:103], v[132:135], a[92:95], v[100:103]
    v_cndmask_b32 v80, v84, v86, s[88:89]
    v_cndmask_b32 v81, v85, v87, s[88:89]
    v_mfma_f32_16x16x32_bf16 v[100:103], v[136:139], a[116:119], v[100:103]
    ds_write_b64 v95, v[80:81] offset:512
    v_mfma_f32_16x16x32_bf16 v[100:103], v[140:143], a[140:143], v[100:103]
    v_mfma_f32_16x16x32_bf16 v[72:75], v[52:55], v[64:67], 0
    v_mfma_f32_16x16x32_bf16 v[100:103], v[144:147], a[164:167], v[100:103]
    v_cvt_pk_bf16_f32 v34, v96, v97
    v_cvt_pk_bf16_f32 v35, v98, v99
    v_mfma_f32_16x16x32_bf16 v[100:103], v[148:151], a[188:191], v[100:103]
    v_mfma_f32_16x16x32_bf16 v[76:79], v[56:59], v[64:67], 0
    v_mfma_f32_16x16x32_bf16 v[100:103], v[152:155], a[212:215], v[100:103]
    ds_read_u16_d16_hi v8, v93 offset:49152
    ds_read_u16_d16_hi v9, v94 offset:49152
    v_mfma_f32_16x16x32_bf16 v[100:103], v[156:159], a[236:239], v[100:103]
    ds_read_u16_d16_hi v10, v92 offset:49152
    v_mfma_f32_16x16x32_bf16 v[100:103], v[160:163], v[180:183], v[100:103]
    v_mfma_f32_16x16x32_bf16 v[100:103], v[164:167], v[204:207], v[100:103]
    v_mfma_f32_16x16x32_bf16 v[100:103], v[168:171], v[228:231], v[100:103]
    v_mfma_f32_16x16x32_bf16 v[100:103], v[172:175], v[252:255], v[100:103]
    v_cndmask_b32 v26, v72, v73, s[76:77]
    v_cndmask_b32 v27, v74, v75, s[76:77]
    v_mfma_f32_16x16x32_bf16 v[104:107], a[0:3], v[120:123], 0
    v_cndmask_b32 v28, v76, v77, s[76:77]
    v_cndmask_b32 v29, v78, v79, s[76:77]
    v_mfma_f32_16x16x32_bf16 v[104:107], a[24:27], v[124:127], v[104:107]
    v_cndmask_b32 v26, v26, v28, s[78:79]
    v_cndmask_b32 v27, v27, v29, s[80:81]
    v_mfma_f32_16x16x32_bf16 v[104:107], a[48:51], v[128:131], v[104:107]
    s_waitcnt lgkmcnt(0)
    v_mul_f32 v26, v26, v8
    v_mfma_f32_16x16x32_bf16 v[104:107], a[72:75], v[132:135], v[104:107]
    v_mul_f32 v27, v27, v9
    v_mul_f32 v11, s91, v10
    v_mfma_f32_16x16x32_bf16 v[104:107], a[96:99], v[136:139], v[104:107]
    v_max_f32 v28, v26, v27
    v_mov_b32 v29, v28
    v_mfma_f32_16x16x32_bf16 v[104:107], a[120:123], v[140:143], v[104:107]
    v_mfma_f32_16x16x32_bf16 v[104:107], a[144:147], v[144:147], v[104:107]
    v_cvt_pk_bf16_f32 v44, v100, v101
    v_cvt_pk_bf16_f32 v45, v102, v103
    v_mfma_f32_16x16x32_bf16 v[104:107], a[168:171], v[148:151], v[104:107]
    v_permlane16_swap_b32 v28, v29
    v_max_f32 v28, v28, v29
    v_mfma_f32_16x16x32_bf16 v[104:107], a[192:195], v[152:155], v[104:107]
    v_mov_b32 v29, v28
    v_mfma_f32_16x16x32_bf16 v[104:107], a[216:219], v[156:159], v[104:107]
    v_mfma_f32_16x16x32_bf16 v[104:107], a[240:243], v[160:163], v[104:107]
    v_permlane32_swap_b32 v28, v29
    v_max_f32 v28, v28, v29
    v_mfma_f32_16x16x32_bf16 v[104:107], v[184:187], v[164:167], v[104:107]
    v_sub_f32 v26, v26, v28
    v_sub_f32 v27, v27, v28
    v_mfma_f32_16x16x32_bf16 v[104:107], v[208:211], v[168:171], v[104:107]
    v_mul_f32 v26, v11, v26
    v_mul_f32 v27, v11, v27
    v_mfma_f32_16x16x32_bf16 v[104:107], v[232:235], v[172:175], v[104:107]
    v_exp_f32 v26, v26
    v_mfma_f32_16x16x32_bf16 v[108:111], a[4:7], v[120:123], 0
    ds_read_b64_tr_b16 v[120:121], v4 offset:32768
    ds_read_b64_tr_b16 v[122:123], v25 offset:32768
    v_mfma_f32_16x16x32_bf16 v[108:111], a[28:31], v[124:127], v[108:111]
    ds_read_b64_tr_b16 v[124:125], v4 offset:33792
    v_exp_f32 v27, v27
    v_mfma_f32_16x16x32_bf16 v[108:111], a[52:55], v[128:131], v[108:111]
    ds_read_b64_tr_b16 v[126:127], v25 offset:33792
    ds_read_b64_tr_b16 v[128:129], v4 offset:34816
    v_mfma_f32_16x16x32_bf16 v[108:111], a[76:79], v[132:135], v[108:111]
    ds_read_b64_tr_b16 v[130:131], v25 offset:34816
    v_add_f32 v28, v26, v27
    v_mfma_f32_16x16x32_bf16 v[108:111], a[100:103], v[136:139], v[108:111]
    ds_read_b64_tr_b16 v[132:133], v4 offset:35840
    v_mov_b32 v29, v28
    v_mfma_f32_16x16x32_bf16 v[108:111], a[124:127], v[140:143], v[108:111]
    ds_read_b64_tr_b16 v[134:135], v25 offset:35840
    ds_read_b64_tr_b16 v[136:137], v4 offset:36864
    v_mfma_f32_16x16x32_bf16 v[108:111], a[148:151], v[144:147], v[108:111]
    ds_read_b64_tr_b16 v[138:139], v25 offset:36864
    s_add_u32 s57, s75, 262144
    v_mfma_f32_16x16x32_bf16 v[108:111], a[172:175], v[148:151], v[108:111]
    buffer_load_dword v22, v20, s[12:15], s57 offen
    v_mfma_f32_16x16x32_bf16 v[108:111], a[196:199], v[152:155], v[108:111]
    ds_read_b64_tr_b16 v[140:141], v4 offset:37888
    ds_read_b64_tr_b16 v[142:143], v25 offset:37888
    v_mfma_f32_16x16x32_bf16 v[108:111], a[220:223], v[156:159], v[108:111]
    ds_read_b64_tr_b16 v[144:145], v4 offset:38912
    ds_read_b64_tr_b16 v[146:147], v25 offset:38912
    v_mfma_f32_16x16x32_bf16 v[108:111], a[244:247], v[160:163], v[108:111]
    ds_read_b64_tr_b16 v[148:149], v4 offset:39936
    ds_read_b64_tr_b16 v[150:151], v25 offset:39936
    v_mfma_f32_16x16x32_bf16 v[108:111], v[188:191], v[164:167], v[108:111]
    ds_read_b64_tr_b16 v[152:153], v4 offset:40960
    v_cvt_pk_bf16_f32 v68, v104, v105
    v_mfma_f32_16x16x32_bf16 v[108:111], v[212:215], v[168:171], v[108:111]
    ds_read_b64_tr_b16 v[154:155], v25 offset:40960
    ds_read_b64_tr_b16 v[156:157], v4 offset:41984
    v_mfma_f32_16x16x32_bf16 v[108:111], v[236:239], v[172:175], v[108:111]
    ds_read_b64_tr_b16 v[158:159], v25 offset:41984
    v_cvt_pk_bf16_f32 v69, v106, v107
    s_waitcnt lgkmcnt(15)
    v_mfma_f32_16x16x32_bf16 v[112:115], a[8:11], v[120:123], 0
    ds_read_b64_tr_b16 v[160:161], v4 offset:43008
    v_permlane16_swap_b32 v28, v29
    v_mfma_f32_16x16x32_bf16 v[112:115], a[32:35], v[124:127], v[112:115]
    ds_read_b64_tr_b16 v[162:163], v25 offset:43008
    ds_read_b64_tr_b16 v[164:165], v4 offset:44032
    s_waitcnt lgkmcnt(15)
    v_mfma_f32_16x16x32_bf16 v[112:115], a[56:59], v[128:131], v[112:115]
    ds_read_b64_tr_b16 v[166:167], v25 offset:44032
    v_add_f32 v28, v28, v29
    v_mfma_f32_16x16x32_bf16 v[112:115], a[80:83], v[132:135], v[112:115]
    ds_read_b64_tr_b16 v[168:169], v4 offset:45056
    v_mov_b32 v29, v28
    s_waitcnt lgkmcnt(13)
    v_mfma_f32_16x16x32_bf16 v[112:115], a[104:107], v[136:139], v[112:115]
    ds_read_b64_tr_b16 v[170:171], v25 offset:45056
    ds_read_b64_tr_b16 v[172:173], v4 offset:46080
    v_mfma_f32_16x16x32_bf16 v[112:115], a[128:131], v[140:143], v[112:115]
    ds_read_b64_tr_b16 v[174:175], v25 offset:46080
    v_permlane32_swap_b32 v28, v29
    s_waitcnt lgkmcnt(12)
    v_mfma_f32_16x16x32_bf16 v[112:115], a[152:155], v[144:147], v[112:115]
    v_cvt_pk_bf16_f32 v70, v108, v109
    v_cvt_pk_bf16_f32 v71, v110, v111
    v_mfma_f32_16x16x32_bf16 v[112:115], a[176:179], v[148:151], v[112:115]
    v_cndmask_b32 v70, v70, 0, s[82:83]
    v_cndmask_b32 v71, v71, 0, s[82:83]
    s_waitcnt lgkmcnt(8)
    v_mfma_f32_16x16x32_bf16 v[112:115], a[200:203], v[152:155], v[112:115]
    v_add_f32 v28, v28, v29
    v_rcp_f32 v28, v28
    v_mfma_f32_16x16x32_bf16 v[112:115], a[224:227], v[156:159], v[112:115]
    v_mul_f32 v26, v26, v8
    v_mul_f32 v27, v27, v9
    s_waitcnt lgkmcnt(4)
    v_mfma_f32_16x16x32_bf16 v[112:115], a[248:251], v[160:163], v[112:115]
    v_mul_f32 v26, v26, v28
    v_mul_f32 v27, v27, v28
    v_mfma_f32_16x16x32_bf16 v[112:115], v[192:195], v[164:167], v[112:115]
    v_cvt_pk_bf16_f32 v26, v26, v26
    v_cvt_pk_bf16_f32 v27, v27, v27
    s_waitcnt lgkmcnt(0)
    v_mfma_f32_16x16x32_bf16 v[112:115], v[216:219], v[168:171], v[112:115]
    v_and_b32 v80, v26, v14
    v_and_b32 v81, v27, v15
    v_mfma_f32_16x16x32_bf16 v[112:115], v[240:243], v[172:175], v[112:115]
    v_and_b32 v82, v26, v16
    v_and_b32 v83, v27, v17
    v_mfma_f32_16x16x32_bf16 v[116:119], a[12:15], v[120:123], 0
    v_mfma_f32_16x16x32_bf16 v[116:119], a[36:39], v[124:127], v[116:119]
    v_mfma_f32_16x16x32_bf16 v[72:75], v[38:41], v[80:83], 0
    v_mfma_f32_16x16x32_bf16 v[116:119], a[60:63], v[128:131], v[116:119]
    v_mfma_f32_16x16x32_bf16 v[76:79], v[48:51], v[80:83], 0
    v_mfma_f32_16x16x32_bf16 v[116:119], a[84:87], v[132:135], v[116:119]
    s_add_u32 s53, s74, 49152
    v_mfma_f32_16x16x32_bf16 v[116:119], a[108:111], v[136:139], v[116:119]
    v_mfma_f32_16x16x32_bf16 v[116:119], a[132:135], v[140:143], v[116:119]
    v_mfma_f32_16x16x32_bf16 v[116:119], a[156:159], v[144:147], v[116:119]
    v_cvt_pk_bf16_f32 v52, v112, v113
    v_cvt_pk_bf16_f32 v53, v114, v115
    v_mfma_f32_16x16x32_bf16 v[116:119], a[180:183], v[148:151], v[116:119]
    v_mfma_f32_16x16x32_bf16 v[116:119], a[204:207], v[152:155], v[116:119]
    v_cvt_pk_bf16_f32 v84, v72, v73
    v_cvt_pk_bf16_f32 v85, v74, v75
    v_mfma_f32_16x16x32_bf16 v[116:119], a[228:231], v[156:159], v[116:119]
    v_cvt_pk_bf16_f32 v86, v76, v77
    v_cvt_pk_bf16_f32 v87, v78, v79
    v_mfma_f32_16x16x32_bf16 v[116:119], a[252:255], v[160:163], v[116:119]
    buffer_store_dwordx4 v[84:87], v23, s[24:27], s53 offen sc1
    v_mfma_f32_16x16x32_bf16 v[116:119], v[196:199], v[164:167], v[116:119]
    v_cndmask_b32 v80, v84, v86, s[88:89]
    v_cndmask_b32 v81, v85, v87, s[88:89]
    v_mfma_f32_16x16x32_bf16 v[116:119], v[220:223], v[168:171], v[116:119]
    ds_write_b64 v95, v[80:81] offset:768
    v_add_u32 v92, 65536, v92
    v_mfma_f32_16x16x32_bf16 v[116:119], v[244:247], v[172:175], v[116:119]
    v_add_u32 v93, 65536, v93
L_wa_2:
    s_cbranch_execz L_wa_ret
    v_add_u32 v94, 65536, v94
    v_mfma_f32_16x16x32_bf16 v[96:99], v[120:123], a[16:19], 0
    v_mfma_f32_16x16x32_bf16 v[72:75], v[56:59], v[68:71], 0
    v_mfma_f32_16x16x32_bf16 v[96:99], v[124:127], a[40:43], v[96:99]
    v_mfma_f32_16x16x32_bf16 v[76:79], v[60:63], v[68:71], 0
    v_mfma_f32_16x16x32_bf16 v[96:99], v[128:131], a[64:67], v[96:99]
    ds_read_u16_d16_hi v8, v93 offset:0
    ds_read_u16_d16_hi v9, v94 offset:0
    v_mfma_f32_16x16x32_bf16 v[96:99], v[132:135], a[88:91], v[96:99]
    ds_read_u16_d16_hi v10, v92 offset:0
    v_mfma_f32_16x16x32_bf16 v[96:99], v[136:139], a[112:115], v[96:99]
    v_mfma_f32_16x16x32_bf16 v[96:99], v[140:143], a[136:139], v[96:99]
    v_mfma_f32_16x16x32_bf16 v[96:99], v[144:147], a[160:163], v[96:99]
    v_cvt_pk_bf16_f32 v54, v116, v117
    v_cvt_pk_bf16_f32 v55, v118, v119
    v_mfma_f32_16x16x32_bf16 v[96:99], v[148:151], a[184:187], v[96:99]
    v_cndmask_b32 v54, v54, 0, s[82:83]
    v_cndmask_b32 v55, v55, 0, s[82:83]
    v_mfma_f32_16x16x32_bf16 v[96:99], v[152:155], a[208:211], v[96:99]
    v_cndmask_b32 v26, v72, v73, s[76:77]
    v_cndmask_b32 v27, v74, v75, s[76:77]
    v_mfma_f32_16x16x32_bf16 v[96:99], v[156:159], a[232:235], v[96:99]
    v_cndmask_b32 v28, v76, v77, s[76:77]
    v_cndmask_b32 v29, v78, v79, s[76:77]
    v_mfma_f32_16x16x32_bf16 v[96:99], v[160:163], v[176:179], v[96:99]
    v_cndmask_b32 v26, v26, v28, s[78:79]
    v_cndmask_b32 v27, v27, v29, s[80:81]
    v_mfma_f32_16x16x32_bf16 v[96:99], v[164:167], v[200:203], v[96:99]
    s_waitcnt lgkmcnt(0)
    v_mul_f32 v26, v26, v8
    v_mfma_f32_16x16x32_bf16 v[96:99], v[168:171], v[224:227], v[96:99]
    v_mul_f32 v27, v27, v9
    v_mul_f32 v11, s91, v10
    v_mfma_f32_16x16x32_bf16 v[96:99], v[172:175], v[248:251], v[96:99]
    v_max_f32 v28, v26, v27
    v_mov_b32 v29, v28
    v_mfma_f32_16x16x32_bf16 v[100:103], v[120:123], a[20:23], 0
    v_mfma_f32_16x16x32_bf16 v[100:103], v[124:127], a[44:47], v[100:103]
    v_permlane16_swap_b32 v28, v29
    v_max_f32 v28, v28, v29
    v_mfma_f32_16x16x32_bf16 v[100:103], v[128:131], a[68:71], v[100:103]
    v_mov_b32 v29, v28
    v_mfma_f32_16x16x32_bf16 v[100:103], v[132:135], a[92:95], v[100:103]
    v_mfma_f32_16x16x32_bf16 v[100:103], v[136:139], a[116:119], v[100:103]
    v_permlane32_swap_b32 v28, v29
    v_max_f32 v28, v28, v29
    v_mfma_f32_16x16x32_bf16 v[100:103], v[140:143], a[140:143], v[100:103]
    v_sub_f32 v26, v26, v28
    v_sub_f32 v27, v27, v28
    v_mfma_f32_16x16x32_bf16 v[100:103], v[144:147], a[164:167], v[100:103]
    v_cvt_pk_bf16_f32 v36, v96, v97
    v_cvt_pk_bf16_f32 v37, v98, v99
    v_mfma_f32_16x16x32_bf16 v[100:103], v[148:151], a[188:191], v[100:103]
    v_mul_f32 v26, v11, v26
    v_mul_f32 v27, v11, v27
    v_mfma_f32_16x16x32_bf16 v[100:103], v[152:155], a[212:215], v[100:103]
    v_exp_f32 v26, v26
    v_mfma_f32_16x16x32_bf16 v[100:103], v[156:159], a[236:239], v[100:103]
    v_exp_f32 v27, v27
    v_mfma_f32_16x16x32_bf16 v[100:103], v[160:163], v[180:183], v[100:103]
    v_add_f32 v28, v26, v27
    v_mov_b32 v29, v28
    v_mfma_f32_16x16x32_bf16 v[100:103], v[164:167], v[204:207], v[100:103]
    v_mfma_f32_16x16x32_bf16 v[100:103], v[168:171], v[228:231], v[100:103]
    v_permlane16_swap_b32 v28, v29
    v_add_f32 v28, v28, v29
    v_mfma_f32_16x16x32_bf16 v[100:103], v[172:175], v[252:255], v[100:103]
    v_mov_b32 v29, v28
    v_mfma_f32_16x16x32_bf16 v[104:107], a[0:3], v[120:123], 0
    v_mfma_f32_16x16x32_bf16 v[104:107], a[24:27], v[124:127], v[104:107]
    v_permlane32_swap_b32 v28, v29
    v_add_f32 v28, v28, v29
    v_mfma_f32_16x16x32_bf16 v[104:107], a[48:51], v[128:131], v[104:107]
    v_rcp_f32 v28, v28
    v_mfma_f32_16x16x32_bf16 v[104:107], a[72:75], v[132:135], v[104:107]
    v_mul_f32 v26, v26, v8
    v_mul_f32 v27, v27, v9
    v_mfma_f32_16x16x32_bf16 v[104:107], a[96:99], v[136:139], v[104:107]
    v_mul_f32 v26, v26, v28
    v_mul_f32 v27, v27, v28
    v_mfma_f32_16x16x32_bf16 v[104:107], a[120:123], v[140:143], v[104:107]
    v_cvt_pk_bf16_f32 v26, v26, v26
    v_cvt_pk_bf16_f32 v27, v27, v27
    v_mfma_f32_16x16x32_bf16 v[104:107], a[144:147], v[144:147], v[104:107]
    v_cvt_pk_bf16_f32 v46, v100, v101
    v_cvt_pk_bf16_f32 v47, v102, v103
    v_mfma_f32_16x16x32_bf16 v[104:107], a[168:171], v[148:151], v[104:107]
    v_and_b32 v80, v26, v14
    v_and_b32 v81, v27, v15
    v_mfma_f32_16x16x32_bf16 v[104:107], a[192:195], v[152:155], v[104:107]
    v_and_b32 v82, v26, v16
    v_and_b32 v83, v27, v17
    v_mfma_f32_16x16x32_bf16 v[104:107], a[216:219], v[156:159], v[104:107]
    v_mfma_f32_16x16x32_bf16 v[104:107], a[240:243], v[160:163], v[104:107]
    v_mfma_f32_16x16x32_bf16 v[72:75], v[32:35], v[80:83], 0
    v_mfma_f32_16x16x32_bf16 v[104:107], v[184:187], v[164:167], v[104:107]
    v_mfma_f32_16x16x32_bf16 v[76:79], v[42:45], v[80:83], 0
    v_mfma_f32_16x16x32_bf16 v[104:107], v[208:211], v[168:171], v[104:107]
    s_add_u32 s53, s74, 65536
    v_mfma_f32_16x16x32_bf16 v[104:107], v[232:235], v[172:175], v[104:107]
    s_waitcnt vmcnt(8)
    s_barrier
    v_mfma_f32_16x16x32_bf16 v[108:111], a[4:7], v[120:123], 0
    ds_read_b64_tr_b16 v[120:121], v4 offset:49152
    ds_read_b64_tr_b16 v[122:123], v25 offset:49152
    v_mfma_f32_16x16x32_bf16 v[108:111], a[28:31], v[124:127], v[108:111]
    ds_read_b64_tr_b16 v[124:125], v4 offset:50176
    v_mfma_f32_16x16x32_bf16 v[108:111], a[52:55], v[128:131], v[108:111]
    ds_read_b64_tr_b16 v[126:127], v25 offset:50176
    ds_read_b64_tr_b16 v[128:129], v4 offset:51200
    v_mfma_f32_16x16x32_bf16 v[108:111], a[76:79], v[132:135], v[108:111]
    ds_read_b64_tr_b16 v[130:131], v25 offset:51200
    v_cvt_pk_bf16_f32 v84, v72, v73
    v_mfma_f32_16x16x32_bf16 v[108:111], a[100:103], v[136:139], v[108:111]
    ds_read_b64_tr_b16 v[132:133], v4 offset:52224
    v_cvt_pk_bf16_f32 v85, v74, v75
    v_mfma_f32_16x16x32_bf16 v[108:111], a[124:127], v[140:143], v[108:111]
    ds_read_b64_tr_b16 v[134:135], v25 offset:52224
    ds_read_b64_tr_b16 v[136:137], v4 offset:53248
    v_mfma_f32_16x16x32_bf16 v[108:111], a[148:151], v[144:147], v[108:111]
    ds_read_b64_tr_b16 v[138:139], v25 offset:53248
    v_cvt_pk_bf16_f32 v64, v104, v105
    v_mfma_f32_16x16x32_bf16 v[108:111], a[172:175], v[148:151], v[108:111]
    ds_read_b64_tr_b16 v[140:141], v4 offset:54272
    ds_read_b64_tr_b16 v[142:143], v25 offset:54272
    v_mfma_f32_16x16x32_bf16 v[108:111], a[196:199], v[152:155], v[108:111]
    ds_read_b64_tr_b16 v[144:145], v4 offset:55296
    v_cvt_pk_bf16_f32 v65, v106, v107
    v_mfma_f32_16x16x32_bf16 v[108:111], a[220:223], v[156:159], v[108:111]
    ds_read_b64_tr_b16 v[146:147], v25 offset:55296
    v_cvt_pk_bf16_f32 v86, v76, v77
    v_mfma_f32_16x16x32_bf16 v[108:111], a[244:247], v[160:163], v[108:111]
    ds_read_b64_tr_b16 v[148:149], v4 offset:56320
    ds_read_b64_tr_b16 v[150:151], v25 offset:56320
    v_mfma_f32_16x16x32_bf16 v[108:111], v[188:191], v[164:167], v[108:111]
    ds_read_b64_tr_b16 v[152:153], v4 offset:57344
    v_cvt_pk_bf16_f32 v87, v78, v79
    v_mfma_f32_16x16x32_bf16 v[108:111], v[212:215], v[168:171], v[108:111]
    ds_read_b64_tr_b16 v[154:155], v25 offset:57344
    ds_read_b64_tr_b16 v[156:157], v4 offset:58368
    v_mfma_f32_16x16x32_bf16 v[108:111], v[236:239], v[172:175], v[108:111]
    ds_read_b64_tr_b16 v[158:159], v25 offset:58368
    buffer_store_dwordx4 v[84:87], v23, s[24:27], s53 offen sc1
    s_waitcnt lgkmcnt(15)
    v_mfma_f32_16x16x32_bf16 v[112:115], a[8:11], v[120:123], 0
    ds_read_b64_tr_b16 v[160:161], v4 offset:59392
    v_cndmask_b32 v80, v84, v86, s[88:89]
    v_mfma_f32_16x16x32_bf16 v[112:115], a[32:35], v[124:127], v[112:115]
    ds_read_b64_tr_b16 v[162:163], v25 offset:59392
    ds_read_b64_tr_b16 v[164:165], v4 offset:60416
    s_waitcnt lgkmcnt(15)
    v_mfma_f32_16x16x32_bf16 v[112:115], a[56:59], v[128:131], v[112:115]
    ds_read_b64_tr_b16 v[166:167], v25 offset:60416
    v_cndmask_b32 v81, v85, v87, s[88:89]
    v_mfma_f32_16x16x32_bf16 v[112:115], a[80:83], v[132:135], v[112:115]
    ds_read_b64_tr_b16 v[168:169], v4 offset:61440
    ds_write_b64 v95, v[80:81] offset:1024
    s_waitcnt lgkmcnt(14)
    v_mfma_f32_16x16x32_bf16 v[112:115], a[104:107], v[136:139], v[112:115]
    ds_read_b64_tr_b16 v[170:171], v25 offset:61440
    ds_read_b64_tr_b16 v[172:173], v4 offset:62464
    v_mfma_f32_16x16x32_bf16 v[112:115], a[128:131], v[140:143], v[112:115]
    ds_read_b64_tr_b16 v[174:175], v25 offset:62464
    s_waitcnt lgkmcnt(13)
    v_mfma_f32_16x16x32_bf16 v[112:115], a[152:155], v[144:147], v[112:115]
    v_cvt_pk_bf16_f32 v66, v108, v109
    v_cvt_pk_bf16_f32 v67, v110, v111
    v_mfma_f32_16x16x32_bf16 v[112:115], a[176:179], v[148:151], v[112:115]
    v_cndmask_b32 v66, v66, 0, s[82:83]
    v_cndmask_b32 v67, v67, 0, s[82:83]
    s_waitcnt lgkmcnt(9)
    v_mfma_f32_16x16x32_bf16 v[112:115], a[200:203], v[152:155], v[112:115]
    v_mfma_f32_16x16x32_bf16 v[112:115], a[224:227], v[156:159], v[112:115]
    v_mfma_f32_16x16x32_bf16 v[72:75], v[60:63], v[64:67], 0
    s_waitcnt lgkmcnt(5)
    v_mfma_f32_16x16x32_bf16 v[112:115], a[248:251], v[160:163], v[112:115]
    v_mfma_f32_16x16x32_bf16 v[76:79], v[52:55], v[64:67], 0
    v_mfma_f32_16x16x32_bf16 v[112:115], v[192:195], v[164:167], v[112:115]
    ds_read_u16_d16_hi v8, v93 offset:16384
    ds_read_u16_d16_hi v9, v94 offset:16384
    s_waitcnt lgkmcnt(2)
    v_mfma_f32_16x16x32_bf16 v[112:115], v[216:219], v[168:171], v[112:115]
    ds_read_u16_d16_hi v10, v92 offset:16384
    v_mfma_f32_16x16x32_bf16 v[112:115], v[240:243], v[172:175], v[112:115]
    v_mfma_f32_16x16x32_bf16 v[116:119], a[12:15], v[120:123], 0
    v_mfma_f32_16x16x32_bf16 v[116:119], a[36:39], v[124:127], v[116:119]
    v_mfma_f32_16x16x32_bf16 v[116:119], a[60:63], v[128:131], v[116:119]
    v_cndmask_b32 v26, v72, v73, s[76:77]
    v_cndmask_b32 v27, v74, v75, s[76:77]
    v_mfma_f32_16x16x32_bf16 v[116:119], a[84:87], v[132:135], v[116:119]
    v_cndmask_b32 v28, v76, v77, s[76:77]
    v_cndmask_b32 v29, v78, v79, s[76:77]
    v_mfma_f32_16x16x32_bf16 v[116:119], a[108:111], v[136:139], v[116:119]
    v_cndmask_b32 v26, v26, v28, s[78:79]
    v_cndmask_b32 v27, v27, v29, s[80:81]
    v_mfma_f32_16x16x32_bf16 v[116:119], a[132:135], v[140:143], v[116:119]
    s_waitcnt lgkmcnt(0)
    v_mul_f32 v26, v26, v8
    v_mfma_f32_16x16x32_bf16 v[116:119], a[156:159], v[144:147], v[116:119]
    v_cvt_pk_bf16_f32 v56, v112, v113
    v_cvt_pk_bf16_f32 v57, v114, v115
    v_mfma_f32_16x16x32_bf16 v[116:119], a[180:183], v[148:151], v[116:119]
    v_mul_f32 v27, v27, v9
    v_mul_f32 v11, s91, v10
    v_mfma_f32_16x16x32_bf16 v[116:119], a[204:207], v[152:155], v[116:119]
    v_max_f32 v28, v26, v27
    v_mov_b32 v29, v28
    v_mfma_f32_16x16x32_bf16 v[116:119], a[228:231], v[156:159], v[116:119]
    v_mfma_f32_16x16x32_bf16 v[116:119], a[252:255], v[160:163], v[116:119]
    v_permlane16_swap_b32 v28, v29
    v_max_f32 v28, v28, v29
    v_mfma_f32_16x16x32_bf16 v[116:119], v[196:199], v[164:167], v[116:119]
    v_mov_b32 v29, v28
    v_mfma_f32_16x16x32_bf16 v[116:119], v[220:223], v[168:171], v[116:119]
    v_mfma_f32_16x16x32_bf16 v[116:119], v[244:247], v[172:175], v[116:119]
    v_permlane32_swap_b32 v28, v29
    v_max_f32 v28, v28, v29
    v_mfma_f32_16x16x32_bf16 v[96:99], v[120:123], a[16:19], 0
    v_sub_f32 v26, v26, v28
    v_sub_f32 v27, v27, v28
    v_mfma_f32_16x16x32_bf16 v[96:99], v[124:127], a[40:43], v[96:99]
    v_mul_f32 v26, v11, v26
    v_mul_f32 v27, v11, v27
    v_mfma_f32_16x16x32_bf16 v[96:99], v[128:131], a[64:67], v[96:99]
    v_exp_f32 v26, v26
    v_mfma_f32_16x16x32_bf16 v[96:99], v[132:135], a[88:91], v[96:99]
    v_exp_f32 v27, v27
    v_mfma_f32_16x16x32_bf16 v[96:99], v[136:139], a[112:115], v[96:99]
    v_add_f32 v28, v26, v27
    v_mov_b32 v29, v28
    v_mfma_f32_16x16x32_bf16 v[96:99], v[140:143], a[136:139], v[96:99]
    v_mfma_f32_16x16x32_bf16 v[96:99], v[144:147], a[160:163], v[96:99]
    v_cvt_pk_bf16_f32 v58, v116, v117
    v_cvt_pk_bf16_f32 v59, v118, v119
    v_mfma_f32_16x16x32_bf16 v[96:99], v[148:151], a[184:187], v[96:99]
    v_cndmask_b32 v58, v58, 0, s[82:83]
    v_cndmask_b32 v59, v59, 0, s[82:83]
    v_mfma_f32_16x16x32_bf16 v[96:99], v[152:155], a[208:211], v[96:99]
    v_permlane16_swap_b32 v28, v29
    v_add_f32 v28, v28, v29
    v_mfma_f32_16x16x32_bf16 v[96:99], v[156:159], a[232:235], v[96:99]
    v_mov_b32 v29, v28
    v_mfma_f32_16x16x32_bf16 v[96:99], v[160:163], v[176:179], v[96:99]
    v_mfma_f32_16x16x32_bf16 v[96:99], v[164:167], v[200:203], v[96:99]
    v_permlane32_swap_b32 v28, v29
    v_add_f32 v28, v28, v29
    v_mfma_f32_16x16x32_bf16 v[96:99], v[168:171], v[224:227], v[96:99]
    v_rcp_f32 v28, v28
    v_mfma_f32_16x16x32_bf16 v[96:99], v[172:175], v[248:251], v[96:99]
    v_mul_f32 v26, v26, v8
    v_mul_f32 v27, v27, v9
    v_mfma_f32_16x16x32_bf16 v[100:103], v[120:123], a[20:23], 0
    v_mul_f32 v26, v26, v28
    v_mul_f32 v27, v27, v28
    v_mfma_f32_16x16x32_bf16 v[100:103], v[124:127], a[44:47], v[100:103]
    v_cvt_pk_bf16_f32 v26, v26, v26
    v_cvt_pk_bf16_f32 v27, v27, v27
    v_mfma_f32_16x16x32_bf16 v[100:103], v[128:131], a[68:71], v[100:103]
    v_and_b32 v80, v26, v14
    v_and_b32 v81, v27, v15
    v_mfma_f32_16x16x32_bf16 v[100:103], v[132:135], a[92:95], v[100:103]
    v_and_b32 v82, v26, v16
    v_and_b32 v83, v27, v17
    v_mfma_f32_16x16x32_bf16 v[100:103], v[136:139], a[116:119], v[100:103]
    v_mfma_f32_16x16x32_bf16 v[100:103], v[140:143], a[140:143], v[100:103]
    v_mfma_f32_16x16x32_bf16 v[72:75], v[34:37], v[80:83], 0
    v_mfma_f32_16x16x32_bf16 v[100:103], v[144:147], a[164:167], v[100:103]
    v_cvt_pk_bf16_f32 v38, v96, v97
    v_cvt_pk_bf16_f32 v39, v98, v99
    v_mfma_f32_16x16x32_bf16 v[100:103], v[148:151], a[188:191], v[100:103]
    v_mfma_f32_16x16x32_bf16 v[76:79], v[44:47], v[80:83], 0
    v_mfma_f32_16x16x32_bf16 v[100:103], v[152:155], a[212:215], v[100:103]
    s_add_u32 s53, s74, 81920
    v_mfma_f32_16x16x32_bf16 v[100:103], v[156:159], a[236:239], v[100:103]
    v_mfma_f32_16x16x32_bf16 v[100:103], v[160:163], v[180:183], v[100:103]
    v_mfma_f32_16x16x32_bf16 v[100:103], v[164:167], v[204:207], v[100:103]
    v_mfma_f32_16x16x32_bf16 v[100:103], v[168:171], v[228:231], v[100:103]
    v_mfma_f32_16x16x32_bf16 v[100:103], v[172:175], v[252:255], v[100:103]
    v_cvt_pk_bf16_f32 v84, v72, v73
    v_cvt_pk_bf16_f32 v85, v74, v75
    v_mfma_f32_16x16x32_bf16 v[104:107], a[0:3], v[120:123], 0
    v_cvt_pk_bf16_f32 v86, v76, v77
    v_cvt_pk_bf16_f32 v87, v78, v79
    v_mfma_f32_16x16x32_bf16 v[104:107], a[24:27], v[124:127], v[104:107]
    buffer_store_dwordx4 v[84:87], v23, s[24:27], s53 offen sc1
    v_mfma_f32_16x16x32_bf16 v[104:107], a[48:51], v[128:131], v[104:107]
    v_cndmask_b32 v80, v84, v86, s[88:89]
    v_cndmask_b32 v81, v85, v87, s[88:89]
    v_mfma_f32_16x16x32_bf16 v[104:107], a[72:75], v[132:135], v[104:107]
    ds_write_b64 v95, v[80:81] offset:1280
    v_mfma_f32_16x16x32_bf16 v[104:107], a[96:99], v[136:139], v[104:107]
    v_mfma_f32_16x16x32_bf16 v[104:107], a[120:123], v[140:143], v[104:107]
    v_mfma_f32_16x16x32_bf16 v[104:107], a[144:147], v[144:147], v[104:107]
    v_cvt_pk_bf16_f32 v48, v100, v101
    v_cvt_pk_bf16_f32 v49, v102, v103
    v_mfma_f32_16x16x32_bf16 v[104:107], a[168:171], v[148:151], v[104:107]
    v_mfma_f32_16x16x32_bf16 v[104:107], a[192:195], v[152:155], v[104:107]
    v_mfma_f32_16x16x32_bf16 v[104:107], a[216:219], v[156:159], v[104:107]
    v_mfma_f32_16x16x32_bf16 v[104:107], a[240:243], v[160:163], v[104:107]
    v_mfma_f32_16x16x32_bf16 v[104:107], v[184:187], v[164:167], v[104:107]
    v_mfma_f32_16x16x32_bf16 v[104:107], v[208:211], v[168:171], v[104:107]
    v_mfma_f32_16x16x32_bf16 v[104:107], v[232:235], v[172:175], v[104:107]
    v_mfma_f32_16x16x32_bf16 v[108:111], a[4:7], v[120:123], 0
    v_add_u32 v4, 65536, v4
    v_add_u32 v25, 65536, v25
    ds_read_b64_tr_b16 v[120:121], v4 offset:0
    ds_read_b64_tr_b16 v[122:123], v25 offset:0
    v_mfma_f32_16x16x32_bf16 v[108:111], a[28:31], v[124:127], v[108:111]
    ds_read_b64_tr_b16 v[124:125], v4 offset:1024
    v_mfma_f32_16x16x32_bf16 v[108:111], a[52:55], v[128:131], v[108:111]
    ds_read_b64_tr_b16 v[126:127], v25 offset:1024
    ds_read_b64_tr_b16 v[128:129], v4 offset:2048
    v_mfma_f32_16x16x32_bf16 v[108:111], a[76:79], v[132:135], v[108:111]
    ds_read_b64_tr_b16 v[130:131], v25 offset:2048
    v_mfma_f32_16x16x32_bf16 v[108:111], a[100:103], v[136:139], v[108:111]
    ds_read_b64_tr_b16 v[132:133], v4 offset:3072
    v_mfma_f32_16x16x32_bf16 v[108:111], a[124:127], v[140:143], v[108:111]
    ds_read_b64_tr_b16 v[134:135], v25 offset:3072
    ds_read_b64_tr_b16 v[136:137], v4 offset:4096
    v_mfma_f32_16x16x32_bf16 v[108:111], a[148:151], v[144:147], v[108:111]
    ds_read_b64_tr_b16 v[138:139], v25 offset:4096
    v_cvt_pk_bf16_f32 v68, v104, v105
    v_mfma_f32_16x16x32_bf16 v[108:111], a[172:175], v[148:151], v[108:111]
    ds_read_b64_tr_b16 v[140:141], v4 offset:5120
    ds_read_b64_tr_b16 v[142:143], v25 offset:5120
    v_mfma_f32_16x16x32_bf16 v[108:111], a[196:199], v[152:155], v[108:111]
    ds_read_b64_tr_b16 v[144:145], v4 offset:6144
    v_cvt_pk_bf16_f32 v69, v106, v107
    v_mfma_f32_16x16x32_bf16 v[108:111], a[220:223], v[156:159], v[108:111]
    ds_read_b64_tr_b16 v[146:147], v25 offset:6144
    v_mfma_f32_16x16x32_bf16 v[108:111], a[244:247], v[160:163], v[108:111]
    ds_read_b64_tr_b16 v[148:149], v4 offset:7168
    ds_read_b64_tr_b16 v[150:151], v25 offset:7168
    v_mfma_f32_16x16x32_bf16 v[108:111], v[188:191], v[164:167], v[108:111]
    ds_read_b64_tr_b16 v[152:153], v4 offset:8192
    v_mfma_f32_16x16x32_bf16 v[108:111], v[212:215], v[168:171], v[108:111]
    ds_read_b64_tr_b16 v[154:155], v25 offset:8192
    ds_read_b64_tr_b16 v[156:157], v4 offset:9216
    v_mfma_f32_16x16x32_bf16 v[108:111], v[236:239], v[172:175], v[108:111]
    ds_read_b64_tr_b16 v[158:159], v25 offset:9216
    s_waitcnt lgkmcnt(15)
    v_mfma_f32_16x16x32_bf16 v[112:115], a[0:3], v[120:123], 0
    ds_read_b64_tr_b16 v[160:161], v4 offset:10240
    v_mfma_f32_16x16x32_bf16 v[112:115], a[24:27], v[124:127], v[112:115]
    ds_read_b64_tr_b16 v[162:163], v25 offset:10240
    ds_read_b64_tr_b16 v[164:165], v4 offset:11264
    s_waitcnt lgkmcnt(15)
    v_mfma_f32_16x16x32_bf16 v[112:115], a[48:51], v[128:131], v[112:115]
    ds_read_b64_tr_b16 v[166:167], v25 offset:11264
    v_mfma_f32_16x16x32_bf16 v[112:115], a[72:75], v[132:135], v[112:115]
    ds_read_b64_tr_b16 v[168:169], v4 offset:12288
    s_waitcnt lgkmcnt(13)
    v_mfma_f32_16x16x32_bf16 v[112:115], a[96:99], v[136:139], v[112:115]
    ds_read_b64_tr_b16 v[170:171], v25 offset:12288
    ds_read_b64_tr_b16 v[172:173], v4 offset:13312
    v_mfma_f32_16x16x32_bf16 v[112:115], a[120:123], v[140:143], v[112:115]
    ds_read_b64_tr_b16 v[174:175], v25 offset:13312
    s_waitcnt lgkmcnt(12)
    v_mfma_f32_16x16x32_bf16 v[112:115], a[144:147], v[144:147], v[112:115]
    v_cvt_pk_bf16_f32 v70, v108, v109
    v_cvt_pk_bf16_f32 v71, v110, v111
    v_mfma_f32_16x16x32_bf16 v[112:115], a[168:171], v[148:151], v[112:115]
    v_cndmask_b32 v70, v70, 0, s[82:83]
    v_cndmask_b32 v71, v71, 0, s[82:83]
    s_waitcnt lgkmcnt(8)
    v_mfma_f32_16x16x32_bf16 v[112:115], a[192:195], v[152:155], v[112:115]
    v_mfma_f32_16x16x32_bf16 v[112:115], a[216:219], v[156:159], v[112:115]
    v_mfma_f32_16x16x32_bf16 v[72:75], v[52:55], v[68:71], 0
    s_waitcnt lgkmcnt(4)
    v_mfma_f32_16x16x32_bf16 v[112:115], a[240:243], v[160:163], v[112:115]
    v_mfma_f32_16x16x32_bf16 v[76:79], v[56:59], v[68:71], 0
    v_mfma_f32_16x16x32_bf16 v[112:115], v[184:187], v[164:167], v[112:115]
    ds_read_u16_d16_hi v8, v93 offset:32768
    ds_read_u16_d16_hi v9, v94 offset:32768
    s_waitcnt lgkmcnt(2)
    v_mfma_f32_16x16x32_bf16 v[112:115], v[208:211], v[168:171], v[112:115]
    ds_read_u16_d16_hi v10, v92 offset:32768
    v_mfma_f32_16x16x32_bf16 v[112:115], v[232:235], v[172:175], v[112:115]
    v_mfma_f32_16x16x32_bf16 v[116:119], a[4:7], v[120:123], 0
    v_mfma_f32_16x16x32_bf16 v[116:119], a[28:31], v[124:127], v[116:119]
    v_mfma_f32_16x16x32_bf16 v[116:119], a[52:55], v[128:131], v[116:119]
    v_cndmask_b32 v26, v72, v73, s[76:77]
    v_cndmask_b32 v27, v74, v75, s[76:77]
    v_mfma_f32_16x16x32_bf16 v[116:119], a[76:79], v[132:135], v[116:119]
    v_cndmask_b32 v28, v76, v77, s[76:77]
    v_cndmask_b32 v29, v78, v79, s[76:77]
    v_mfma_f32_16x16x32_bf16 v[116:119], a[100:103], v[136:139], v[116:119]
    v_cndmask_b32 v26, v26, v28, s[78:79]
    v_cndmask_b32 v27, v27, v29, s[80:81]
    v_mfma_f32_16x16x32_bf16 v[116:119], a[124:127], v[140:143], v[116:119]
    s_waitcnt lgkmcnt(0)
    v_mul_f32 v26, v26, v8
    v_mfma_f32_16x16x32_bf16 v[116:119], a[148:151], v[144:147], v[116:119]
    v_cvt_pk_bf16_f32 v64, v112, v113
    v_cvt_pk_bf16_f32 v65, v114, v115
    v_mfma_f32_16x16x32_bf16 v[116:119], a[172:175], v[148:151], v[116:119]
    v_mul_f32 v27, v27, v9
    v_mul_f32 v11, s91, v10
    v_mfma_f32_16x16x32_bf16 v[116:119], a[196:199], v[152:155], v[116:119]
    v_max_f32 v28, v26, v27
    v_mov_b32 v29, v28
    v_mfma_f32_16x16x32_bf16 v[116:119], a[220:223], v[156:159], v[116:119]
    v_mfma_f32_16x16x32_bf16 v[116:119], a[244:247], v[160:163], v[116:119]
    v_permlane16_swap_b32 v28, v29
    v_max_f32 v28, v28, v29
    v_mfma_f32_16x16x32_bf16 v[116:119], v[188:191], v[164:167], v[116:119]
    v_mov_b32 v29, v28
    v_mfma_f32_16x16x32_bf16 v[116:119], v[212:215], v[168:171], v[116:119]
    v_mfma_f32_16x16x32_bf16 v[116:119], v[236:239], v[172:175], v[116:119]
    v_permlane32_swap_b32 v28, v29
    v_max_f32 v28, v28, v29
    v_mfma_f32_16x16x32_bf16 v[96:99], a[8:11], v[120:123], 0
    v_sub_f32 v26, v26, v28
    v_sub_f32 v27, v27, v28
    v_mfma_f32_16x16x32_bf16 v[96:99], a[32:35], v[124:127], v[96:99]
    v_mul_f32 v26, v11, v26
    v_mul_f32 v27, v11, v27
    v_mfma_f32_16x16x32_bf16 v[96:99], a[56:59], v[128:131], v[96:99]
    v_exp_f32 v26, v26
    v_mfma_f32_16x16x32_bf16 v[96:99], a[80:83], v[132:135], v[96:99]
    v_exp_f32 v27, v27
    v_mfma_f32_16x16x32_bf16 v[96:99], a[104:107], v[136:139], v[96:99]
    v_add_f32 v28, v26, v27
    v_mov_b32 v29, v28
    v_mfma_f32_16x16x32_bf16 v[96:99], a[128:131], v[140:143], v[96:99]
    v_mfma_f32_16x16x32_bf16 v[96:99], a[152:155], v[144:147], v[96:99]
    v_cvt_pk_bf16_f32 v66, v116, v117
    v_cvt_pk_bf16_f32 v67, v118, v119
    v_mfma_f32_16x16x32_bf16 v[96:99], a[176:179], v[148:151], v[96:99]
    v_cndmask_b32 v66, v66, 0, s[82:83]
    v_cndmask_b32 v67, v67, 0, s[82:83]
    v_mfma_f32_16x16x32_bf16 v[96:99], a[200:203], v[152:155], v[96:99]
    v_permlane16_swap_b32 v28, v29
    v_add_f32 v28, v28, v29
    v_mfma_f32_16x16x32_bf16 v[96:99], a[224:227], v[156:159], v[96:99]
    v_mov_b32 v29, v28
    v_mfma_f32_16x16x32_bf16 v[96:99], a[248:251], v[160:163], v[96:99]
    v_mfma_f32_16x16x32_bf16 v[96:99], v[192:195], v[164:167], v[96:99]
    v_permlane32_swap_b32 v28, v29
    v_add_f32 v28, v28, v29
    v_mfma_f32_16x16x32_bf16 v[96:99], v[216:219], v[168:171], v[96:99]
    v_rcp_f32 v28, v28
    v_mfma_f32_16x16x32_bf16 v[96:99], v[240:243], v[172:175], v[96:99]
    v_mul_f32 v26, v26, v8
    v_mul_f32 v27, v27, v9
    v_mfma_f32_16x16x32_bf16 v[100:103], a[12:15], v[120:123], 0
    v_mul_f32 v26, v26, v28
    v_mul_f32 v27, v27, v28
    v_mfma_f32_16x16x32_bf16 v[100:103], a[36:39], v[124:127], v[100:103]
    v_cvt_pk_bf16_f32 v26, v26, v26
    v_cvt_pk_bf16_f32 v27, v27, v27
    v_mfma_f32_16x16x32_bf16 v[100:103], a[60:63], v[128:131], v[100:103]
    v_and_b32 v80, v26, v14
    v_and_b32 v81, v27, v15
    v_mfma_f32_16x16x32_bf16 v[100:103], a[84:87], v[132:135], v[100:103]
    v_and_b32 v82, v26, v16
    v_and_b32 v83, v27, v17
    v_mfma_f32_16x16x32_bf16 v[100:103], a[108:111], v[136:139], v[100:103]
    v_mfma_f32_16x16x32_bf16 v[100:103], a[132:135], v[140:143], v[100:103]
    v_mfma_f32_16x16x32_bf16 v[72:75], v[36:39], v[80:83], 0
    v_mfma_f32_16x16x32_bf16 v[100:103], a[156:159], v[144:147], v[100:103]
    v_cvt_pk_bf16_f32 v60, v96, v97
    v_cvt_pk_bf16_f32 v61, v98, v99
    v_mfma_f32_16x16x32_bf16 v[100:103], a[180:183], v[148:151], v[100:103]
    v_mfma_f32_16x16x32_bf16 v[76:79], v[46:49], v[80:83], 0
    v_mfma_f32_16x16x32_bf16 v[100:103], a[204:207], v[152:155], v[100:103]
    s_add_u32 s53, s74, 98304
    v_mfma_f32_16x16x32_bf16 v[100:103], a[228:231], v[156:159], v[100:103]
    v_mfma_f32_16x16x32_bf16 v[100:103], a[252:255], v[160:163], v[100:103]
    v_mfma_f32_16x16x32_bf16 v[100:103], v[196:199], v[164:167], v[100:103]
    v_mfma_f32_16x16x32_bf16 v[100:103], v[220:223], v[168:171], v[100:103]
    v_mfma_f32_16x16x32_bf16 v[100:103], v[244:247], v[172:175], v[100:103]
    v_cvt_pk_bf16_f32 v84, v72, v73
    v_cvt_pk_bf16_f32 v85, v74, v75
    v_mfma_f32_16x16x32_bf16 v[104:107], v[120:123], a[16:19], 0
    v_cvt_pk_bf16_f32 v86, v76, v77
    v_cvt_pk_bf16_f32 v87, v78, v79
    v_mfma_f32_16x16x32_bf16 v[104:107], v[124:127], a[40:43], v[104:107]
    buffer_store_dwordx4 v[84:87], v23, s[24:27], s53 offen sc1
    v_mfma_f32_16x16x32_bf16 v[104:107], v[128:131], a[64:67], v[104:107]
    v_cndmask_b32 v80, v84, v86, s[88:89]
    v_cndmask_b32 v81, v85, v87, s[88:89]
    v_mfma_f32_16x16x32_bf16 v[104:107], v[132:135], a[88:91], v[104:107]
    ds_write_b64 v95, v[80:81] offset:1536
    v_mfma_f32_16x16x32_bf16 v[104:107], v[136:139], a[112:115], v[104:107]
    v_mfma_f32_16x16x32_bf16 v[104:107], v[140:143], a[136:139], v[104:107]
    v_mfma_f32_16x16x32_bf16 v[104:107], v[144:147], a[160:163], v[104:107]
    v_cvt_pk_bf16_f32 v62, v100, v101
    v_cvt_pk_bf16_f32 v63, v102, v103
    v_mfma_f32_16x16x32_bf16 v[104:107], v[148:151], a[184:187], v[104:107]
    v_cndmask_b32 v62, v62, 0, s[82:83]
    v_cndmask_b32 v63, v63, 0, s[82:83]
    v_mfma_f32_16x16x32_bf16 v[104:107], v[152:155], a[208:211], v[104:107]
    v_mfma_f32_16x16x32_bf16 v[104:107], v[156:159], a[232:235], v[104:107]
    v_mfma_f32_16x16x32_bf16 v[72:75], v[56:59], v[64:67], 0
    v_mfma_f32_16x16x32_bf16 v[104:107], v[160:163], v[176:179], v[104:107]
    v_mfma_f32_16x16x32_bf16 v[76:79], v[60:63], v[64:67], 0
    v_mfma_f32_16x16x32_bf16 v[104:107], v[164:167], v[200:203], v[104:107]
    ds_read_u16_d16_hi v8, v93 offset:49152
    ds_read_u16_d16_hi v9, v94 offset:49152
    v_mfma_f32_16x16x32_bf16 v[104:107], v[168:171], v[224:227], v[104:107]
    ds_read_u16_d16_hi v10, v92 offset:49152
    v_mfma_f32_16x16x32_bf16 v[104:107], v[172:175], v[248:251], v[104:107]
    v_mfma_f32_16x16x32_bf16 v[108:111], v[120:123], a[20:23], 0
    v_mfma_f32_16x16x32_bf16 v[108:111], v[124:127], a[44:47], v[108:111]
    v_mfma_f32_16x16x32_bf16 v[108:111], v[128:131], a[68:71], v[108:111]
    v_cndmask_b32 v26, v72, v73, s[76:77]
    v_cndmask_b32 v27, v74, v75, s[76:77]
    v_mfma_f32_16x16x32_bf16 v[108:111], v[132:135], a[92:95], v[108:111]
    v_cndmask_b32 v28, v76, v77, s[76:77]
    v_cndmask_b32 v29, v78, v79, s[76:77]
    v_mfma_f32_16x16x32_bf16 v[108:111], v[136:139], a[116:119], v[108:111]
    v_cndmask_b32 v26, v26, v28, s[78:79]
    v_cndmask_b32 v27, v27, v29, s[80:81]
    v_mfma_f32_16x16x32_bf16 v[108:111], v[140:143], a[140:143], v[108:111]
    s_waitcnt lgkmcnt(0)
    v_mul_f32 v26, v26, v8
    v_mfma_f32_16x16x32_bf16 v[108:111], v[144:147], a[164:167], v[108:111]
    v_cvt_pk_bf16_f32 v40, v104, v105
    v_cvt_pk_bf16_f32 v41, v106, v107
    v_mfma_f32_16x16x32_bf16 v[108:111], v[148:151], a[188:191], v[108:111]
    v_mul_f32 v27, v27, v9
    v_mul_f32 v11, s91, v10
    v_mfma_f32_16x16x32_bf16 v[108:111], v[152:155], a[212:215], v[108:111]
    v_max_f32 v28, v26, v27
    v_mov_b32 v29, v28
    v_mfma_f32_16x16x32_bf16 v[108:111], v[156:159], a[236:239], v[108:111]
    v_mfma_f32_16x16x32_bf16 v[108:111], v[160:163], v[180:183], v[108:111]
    v_permlane16_swap_b32 v28, v29
    v_max_f32 v28, v28, v29
    v_mfma_f32_16x16x32_bf16 v[108:111], v[164:167], v[204:207], v[108:111]
    v_mov_b32 v29, v28
    v_mfma_f32_16x16x32_bf16 v[108:111], v[168:171], v[228:231], v[108:111]
    v_mfma_f32_16x16x32_bf16 v[108:111], v[172:175], v[252:255], v[108:111]
    v_permlane32_swap_b32 v28, v29
    v_max_f32 v28, v28, v29
    s_nop 5
    v_cvt_pk_bf16_f32 v50, v108, v109
    v_cvt_pk_bf16_f32 v51, v110, v111
    v_sub_f32 v26, v26, v28
    v_sub_f32 v27, v27, v28
    v_mul_f32 v26, v11, v26
    v_mul_f32 v27, v11, v27
    v_exp_f32 v26, v26
    v_exp_f32 v27, v27
    s_nop 0
    v_add_f32 v28, v26, v27
    v_mov_b32 v29, v28
    s_nop 1
    v_permlane16_swap_b32 v28, v29
    v_add_f32 v28, v28, v29
    v_mov_b32 v29, v28
    s_nop 1
    v_permlane32_swap_b32 v28, v29
    v_add_f32 v28, v28, v29
    v_rcp_f32 v28, v28
    v_mul_f32 v26, v26, v8
    v_mul_f32 v27, v27, v9
    v_mul_f32 v26, v26, v28
    v_mul_f32 v27, v27, v28
    v_cvt_pk_bf16_f32 v26, v26, v26
    v_cvt_pk_bf16_f32 v27, v27, v27
    v_and_b32 v80, v26, v14
    v_and_b32 v81, v27, v15
    v_and_b32 v82, v26, v16
    v_and_b32 v83, v27, v17
    s_nop 1
    v_mfma_f32_16x16x32_bf16 v[72:75], v[38:41], v[80:83], 0
    v_mfma_f32_16x16x32_bf16 v[76:79], v[48:51], v[80:83], 0
    s_add_u32 s53, s74, 114688
    s_nop 5
    v_cvt_pk_bf16_f32 v84, v72, v73
    v_cvt_pk_bf16_f32 v85, v74, v75
    v_cvt_pk_bf16_f32 v86, v76, v77
    v_cvt_pk_bf16_f32 v87, v78, v79
    buffer_store_dwordx4 v[84:87], v23, s[24:27], s53 offen sc1
    v_cndmask_b32 v80, v84, v86, s[88:89]
    v_cndmask_b32 v81, v85, v87, s[88:89]
    ds_write_b64 v95, v[80:81] offset:1792
    v_lshlrev_b32 v6, 4, v0
    v_add_u32 v6, 147456, v6
    v_lshrrev_b32 v7, 4, v1
    v_and_b32 v12, 15, v1
    v_lshlrev_b32 v7, 14, v7
    v_lshl_add_u32 v7, v12, 4, v7
    s_waitcnt lgkmcnt(0)
    s_barrier
    ds_read_b128 v[72:75], v6
    s_waitcnt lgkmcnt(0)
    buffer_store_dwordx4 v[72:75], v7, s[24:27], s95 offen sc1
    s_waitcnt vmcnt(0) lgkmcnt(0)
    s_barrier
    s_cmp_lg_u32 s44, 0
L_wa_3:
    s_cbranch_execz L_wa_ret
    s_cbranch_scc1 L_nopub21
    s_lshl_b32 s60, s48, 4
    s_add_u32 s60, s60, s49
    s_lshl_b32 s60, s60, 7
    s_add_u32 s60, s60, 12779520
    v_mov_b32 v30, s47
    s_mov_b64 exec, 1
    buffer_store_dword v30, off, s[24:27], s60 sc1
    s_mov_b64 exec, -1
L_nopub21:
    s_endpgm
L_codeend:
.section .rodata,"a"
.p2align 6
.amdhsa_kernel parallel_sum__sliding_local_dilated__mixer_token_mlp__prompt_kernel
  .amdhsa_next_free_vgpr 512
  .amdhsa_next_free_sgpr 102
  .amdhsa_accum_offset 256
  .amdhsa_group_segment_fixed_size 0
  .amdhsa_kernarg_size 88
  .amdhsa_user_sgpr_count 2
  .amdhsa_user_sgpr_kernarg_segment_ptr 1
  .amdhsa_system_sgpr_workgroup_id_x 1
  .amdhsa_float_denorm_mode_32 3
.end_amdhsa_kernel
```

```asm
; @launch grid=(256,1,1) block=(256,1,1) lds=163840
.amdgcn_target "amdgcn-amd-amdhsa--gfx950"
.text
.globl parallel_sum__sliding_local_dilated__mixer_token_mlp__prompt_kernel
.p2align 8
.type parallel_sum__sliding_local_dilated__mixer_token_mlp__prompt_kernel,@function
parallel_sum__sliding_local_dilated__mixer_token_mlp__prompt_kernel:
    s_cmp_ge_u32 s2, 256
    s_cbranch_scc1 L_end
    s_load_dwordx2 s[4:5], s[0:1], 0
    s_load_dwordx16 s[76:91], s[0:1], 0
    s_load_dwordx4 s[92:95], s[0:1], 64
    s_load_dwordx2 s[24:25], s[0:1], 80
    s_lshr_b32 s46, s2, 3
    s_getpc_b64 s[98:99]
L_pc:
    s_mul_i32 s53, s46, 1536
    v_lshrrev_b32 v26, 4, v0
    v_min_u32 v26, 11, v26
    v_lshl_add_u32 v26, v26, 7, s53
    v_lshrrev_b32 v25, 5, v0
    v_min_u32 v26, L_codeend-L_pc-4, v26
    v_mov_b32 v29, s99
    v_add_co_u32 v28, vcc, s98, v26
    s_nop 1
    v_addc_co_u32 v29, vcc, 0, v29, vcc
    global_load_dword v108, v[28:29], off
    v_and_b32 v26, 31, v0
    v_mul_u32_u24 v24, 896, v25
    v_lshl_add_u32 v24, v26, 4, v24
    s_mul_i32 s53, s2, 7168
    v_add_u32 v24, s53, v24
    v_cmp_gt_u32 vcc, 24, v26
    v_mov_b32 v27, 2130706432
    s_mov_b32 s6, 1835008
    s_mov_b32 s7, 0x20000
    v_cndmask_b32 v22, v27, v24, vcc
    v_lshrrev_b32 v27, 6, v0
    v_and_b32 v1, 63, v0
    s_waitcnt lgkmcnt(0)
    buffer_load_dwordx4 v[32:35], v24, s[4:7], 0 offen
    buffer_load_dwordx4 v[36:39], v22, s[4:7], 0 offen offset:512
    v_readfirstlane_b32 s44, v27
    s_and_b32 s45, s2, 7
    s_mov_b64 s[8:9], s[78:79]
    s_mov_b32 s10, 1204224
    s_mov_b32 s11, s7
    s_and_b32 s53, s45, 6
    s_lshr_b32 s53, 0xc9, s53
    s_and_b32 s53, s53, 3
    s_add_u32 s54, s53, 1
    s_bfe_u32 s54, s54, 0x10001
    s_add_u32 s54, s54, 1
    s_mul_i32 s53, s53, 224
    s_andn2_b32 s53, s53, 127
    s_sub_u32 s55, s46, 3
    s_cmp_lt_u32 s46, 24
    s_cselect_b32 s55, 63, s55
    s_cmp_lt_u32 s46, 21
    s_cselect_b32 s55, s46, s55
    s_mul_i32 s55, s55, 43008
    s_add_u32 s53, s53, s55
    v_and_b32 v27, 3, v0
    v_min_u32 v27, s54, v27
    v_bfe_u32 v28, v0, 2, 2
    v_med3_u32 v28, v28, 0, 2
    v_mul_u32_u24 v28, 7, v28
    v_add_u32 v27, v27, v28
    v_lshrrev_b32 v28, 4, v0
    v_min_u32 v28, 15, v28
    v_mul_u32_u24 v28, 21, v28
    v_add_lshl_u32 v27, v27, v28, 7
    buffer_load_dword v108, v27, s[8:11], s53 offen
    s_mov_b64 s[40:41], s[94:95]
    s_mov_b32 s42, 256
    s_mov_b32 s43, s7
    s_or_b32 s53, s2, s44
    s_cbranch_scc1 L_nononce
    s_memrealtime s[98:99]
    s_waitcnt lgkmcnt(0)
    s_or_b32 s98, s98, 1
    v_mov_b32 v28, s98
    s_mov_b64 exec, 1
    buffer_store_dword v28, off, s[40:43], 0 sc1
    s_mov_b64 exec, -1
L_nononce:
    s_mov_b64 s[16:17], s[84:85]
    s_mov_b32 s18, 7340032
    s_mov_b32 s19, s7
    s_mov_b32 s26, 16777216
    s_mov_b32 s27, s7
    s_mov_b64 s[20:21], s[88:89]
    s_mov_b32 s22, 7340032
    s_mov_b32 s23, s7
    s_mov_b64 s[12:13], s[80:81]
    s_mov_b32 s14, 401408
    s_mov_b32 s15, s7
    s_mov_b64 s[28:29], s[92:93]
    s_mov_b32 s30, 1835008
    s_mov_b32 s31, s7
    s_mov_b64 s[32:33], s[86:87]
    s_mov_b32 s34, 3584
    s_mov_b32 s35, s7
    s_mov_b64 s[36:37], s[90:91]
    s_mov_b32 s38, 4096
    s_mov_b32 s39, s7
    s_lshl_b32 s52, s44, 12
    v_lshlrev_b32 v23, 4, v1
    s_cmp_ge_u32 s46, 24
    s_cbranch_scc1 L_role_a
    v_lshrrev_b32 v208, 4, v1
    v_bfe_u32 v209, v1, 2, 2
    v_and_b32 v210, 3, v1
    v_and_b32 v211, 15, v1
    v_lshrrev_b32 v212, 5, v1
    s_mul_i32 s55, s45, 3
    s_max_u32 s55, s55, 1
    s_add_u32 s55, s55, s46
    s_sub_u32 s55, s55, 1
    s_sub_u32 s56, s55, 21
    s_min_u32 s55, s55, s56
    s_and_b32 s54, s45, 1
    s_mul_i32 s54, s54, 24
    s_sub_u32 s54, s46, s54
    s_cmp_ge_u32 s46, 21
    s_cselect_b32 s54, s54, s55
    s_mul_i32 s53, s45, 21
    s_add_u32 s53, s53, s54
    s_mul_i32 s50, s53, 171
    s_lshr_b32 s50, s50, 10
    s_mul_i32 s54, s50, 6
    s_sub_u32 s88, s53, s54
    s_mul_i32 s51, s50, 2
    s_add_u32 s51, s51, s88
    s_mul_i32 s54, s51, 43
    s_lshr_b32 s54, s54, 8
    s_mul_i32 s54, s54, 6
    s_sub_u32 s51, s51, s54
    s_mul_i32 s65, s51, 14
    s_add_u32 s65, s65, 2
    s_mul_i32 s65, s65, 171
    s_lshr_b32 s65, s65, 10
    v_lshl_add_u32 v213, v212, 2, v209
    v_and_b32 v215, 1, v208
    v_lshlrev_b32 v214, 4, v210
    v_lshl_add_u32 v214, v215, 6, v214
    s_mul_i32 s53, s44, 1835008
    s_lshl_b32 s54, s50, 7
    s_add_u32 s53, s53, s54
    v_mul_u32_u24 v10, 3584, v213
    v_add3_u32 v10, v10, v214, s53
    v_xor_b32 v11, 32, v10
    v_lshl_add_u32 v19, v208, 3, s54
    s_cmp_ge_u32 s46, 21
    s_cbranch_scc1 L_help
    buffer_load_dwordx2 v[224:225], v19, s[32:35], 0 offen offset:0
    buffer_load_dwordx2 v[226:227], v19, s[32:35], 0 offen offset:32
    buffer_load_dwordx2 v[228:229], v19, s[32:35], 0 offen offset:64
    buffer_load_dwordx2 v[230:231], v19, s[32:35], 0 offen offset:96
    s_add_u32 m0, s52, 49152
    s_add_u32 s57, s65, 0
    s_sub_u32 s3, s57, 14
    s_min_u32 s57, s57, s3
    s_mul_i32 s57, s57, 114688
    buffer_load_dwordx4 v10, s[16:19], s57 offen offset:0 lds
    s_add_u32 s57, s57, 27648
    buffer_load_dwordx4 v11, s[16:19], s57 offen offset:1024 lds
    v_mul_u32_u24 v109, 1088, v25
    v_lshl_add_u32 v109, v26, 4, v109
    v_mul_u32_u24 v110, 1088, v209
    v_lshl_add_u32 v110, v208, 5, v110
    v_lshl_add_u32 v110, v210, 3, v110
    s_lshl_b32 s53, s44, 7
    v_add_u32 v110, s53, v110
    v_mul_u32_u24 v111, 66816, v208
    v_lshl_add_u32 v111, v211, 4, v111
    s_mul_i32 s63, s44, 267264
    s_lshl_b32 s53, s2, 8
    s_add_u32 s63, s63, s53
    s_add_u32 s64, s63, 1069056
    v_cmp_gt_u32 vcc, 208, v0
    v_mov_b32 v100, 2130706432
    v_cmp_le_u32 s[92:93], 24, v26
    v_cndmask_b32 v22, v100, v111, vcc
    s_mov_b32 s62, 0x3f803f80
    s_mov_b32 s61, 0xffff0000
    v_mov_b32 v96, 0
    v_mov_b32 v97, 0
    v_lshlrev_b32 v216, 6, v209
    v_lshl_add_u32 v216, v210, 3, v216
    v_lshl_add_u32 v216, v215, 5, v216
    s_add_u32 s53, s52, 49152
    v_lshl_add_u32 v2, v208, 10, v216
    v_add_u32 v2, s53, v2
    v_xor_b32 v3, 32, v2
    v_add_u32 v4, 65536, v2
    v_add_u32 v5, 65536, v3
    v_lshl_add_u32 v6, v208, 9, v216
    v_add_u32 v6, s53, v6
    v_xor_b32 v7, 32, v6
    v_add_u32 v8, 65536, v6
    v_add_u32 v9, 65536, v7
    s_waitcnt vmcnt(8)
    v_dot2c_f32_bf16 v96, s62, v32
    v_dot2c_f32_bf16 v97, v32, v32
    v_lshlrev_b32 v40, 16, v32
    v_and_b32 v41, s61, v32
    v_dot2c_f32_bf16 v96, s62, v33
    v_dot2c_f32_bf16 v97, v33, v33
    v_lshlrev_b32 v42, 16, v33
    v_and_b32 v43, s61, v33
    v_dot2c_f32_bf16 v96, s62, v34
    v_dot2c_f32_bf16 v97, v34, v34
    v_lshlrev_b32 v44, 16, v34
    v_and_b32 v45, s61, v34
    v_dot2c_f32_bf16 v96, s62, v35
    v_dot2c_f32_bf16 v97, v35, v35
    v_lshlrev_b32 v46, 16, v35
    v_and_b32 v47, s61, v35
    s_waitcnt vmcnt(7)
    v_dot2c_f32_bf16 v96, s62, v36
    v_dot2c_f32_bf16 v97, v36, v36
    v_lshlrev_b32 v48, 16, v36
    v_and_b32 v49, s61, v36
    v_dot2c_f32_bf16 v96, s62, v37
    v_dot2c_f32_bf16 v97, v37, v37
    v_lshlrev_b32 v50, 16, v37
    v_and_b32 v51, s61, v37
    v_dot2c_f32_bf16 v96, s62, v38
    v_dot2c_f32_bf16 v97, v38, v38
    v_lshlrev_b32 v52, 16, v38
    v_and_b32 v53, s61, v38
    v_dot2c_f32_bf16 v96, s62, v39
    v_dot2c_f32_bf16 v97, v39, v39
    v_lshlrev_b32 v54, 16, v39
    v_and_b32 v55, s61, v39
    buffer_load_dword v29, off, s[40:43], 0 sc1
    v_add_f32_dpp v96, v96, v96 quad_perm:[1,0,3,2] row_mask:0xf bank_mask:0xf
    v_add_f32_dpp v97, v97, v97 quad_perm:[1,0,3,2] row_mask:0xf bank_mask:0xf
    s_nop 0
    v_add_f32_dpp v96, v96, v96 quad_perm:[2,3,0,1] row_mask:0xf bank_mask:0xf
    v_add_f32_dpp v97, v97, v97 quad_perm:[2,3,0,1] row_mask:0xf bank_mask:0xf
    s_nop 0
    v_add_f32_dpp v96, v96, v96 row_half_mirror row_mask:0xf bank_mask:0xf
    v_add_f32_dpp v97, v97, v97 row_half_mirror row_mask:0xf bank_mask:0xf
    s_nop 0
    v_add_f32_dpp v96, v96, v96 row_mirror row_mask:0xf bank_mask:0xf
    v_add_f32_dpp v97, v97, v97 row_mirror row_mask:0xf bank_mask:0xf
    v_mov_b32 v98, v96
    v_mov_b32 v99, v97
    s_nop 0
    v_permlane16_swap_b32 v96, v98
    v_permlane16_swap_b32 v97, v99
    v_add_f32 v96, v96, v98
    v_add_f32 v97, v97, v99
    v_mul_f32 v98, 0x3b124925, v96
    v_mul_f32 v99, 0x3b124925, v97
    v_fma_f32 v99, -v98, v98, v99
    v_max_f32 v99, 0, v99
    v_cvt_pk_bf16_f32 v100, 0, v99
    v_add_f32 v100, 0x3727c5ac, v100
    v_cvt_pk_bf16_f32 v100, 0, v100
    v_sqrt_f32 v100, v100
    s_nop 0
    v_cvt_pk_bf16_f32 v100, 0, v100
    v_rcp_f32 v100, v100
    s_nop 0
    v_mul_f32 v99, v99, v100
    v_mul_f32 v99, v99, v100
    v_cvt_pk_bf16_f32 v104, 0, v99
    v_add_f32 v104, 0x3727c5ac, v104
    v_cvt_pk_bf16_f32 v104, 0, v104
    v_sqrt_f32 v104, v104
    s_nop 0
    v_cvt_pk_bf16_f32 v102, 0, v104
    v_rcp_f32 v104, v102
    s_nop 0
    v_mul_f32 v104, v104, v100
    v_mul_f32 v106, v98, v104
    v_pk_fma_f32 v[56:57], v[40:41], v[104:105], v[106:107] op_sel_hi:[1,0,0] neg_lo:[0,0,1] neg_hi:[0,0,1]
    v_pk_fma_f32 v[58:59], v[42:43], v[104:105], v[106:107] op_sel_hi:[1,0,0] neg_lo:[0,0,1] neg_hi:[0,0,1]
    v_pk_fma_f32 v[60:61], v[44:45], v[104:105], v[106:107] op_sel_hi:[1,0,0] neg_lo:[0,0,1] neg_hi:[0,0,1]
    v_pk_fma_f32 v[62:63], v[46:47], v[104:105], v[106:107] op_sel_hi:[1,0,0] neg_lo:[0,0,1] neg_hi:[0,0,1]
    v_pk_fma_f32 v[64:65], v[48:49], v[104:105], v[106:107] op_sel_hi:[1,0,0] neg_lo:[0,0,1] neg_hi:[0,0,1]
    v_pk_fma_f32 v[66:67], v[50:51], v[104:105], v[106:107] op_sel_hi:[1,0,0] neg_lo:[0,0,1] neg_hi:[0,0,1]
    v_pk_fma_f32 v[68:69], v[52:53], v[104:105], v[106:107] op_sel_hi:[1,0,0] neg_lo:[0,0,1] neg_hi:[0,0,1]
    v_pk_fma_f32 v[70:71], v[54:55], v[104:105], v[106:107] op_sel_hi:[1,0,0] neg_lo:[0,0,1] neg_hi:[0,0,1]
    v_cvt_pk_bf16_f32 v80, v56, v57
    v_cvt_pk_bf16_f32 v81, v58, v59
    v_cvt_pk_bf16_f32 v82, v60, v61
    v_cvt_pk_bf16_f32 v83, v62, v63
    v_cvt_pk_bf16_f32 v84, v64, v65
    v_cvt_pk_bf16_f32 v85, v66, v67
    v_cvt_pk_bf16_f32 v86, v68, v69
    v_cvt_pk_bf16_f32 v87, v70, v71
    v_lshrrev_b32 v102, 16, v102
    v_cndmask_b32 v84, v84, v102, s[92:93]
    ds_write_b128 v109, v[80:83] offset:0
    ds_write_b128 v109, v[84:87] offset:512
    s_waitcnt lgkmcnt(0)
    s_barrier
    ds_read_b64_tr_b16 v[88:89], v110 offset:0
    ds_read_b64_tr_b16 v[90:91], v110 offset:4352
    ds_read_b64_tr_b16 v[92:93], v110 offset:512
    ds_read_b64_tr_b16 v[94:95], v110 offset:4864
    s_waitcnt lgkmcnt(2)
    buffer_store_dwordx4 v[88:91], v111, s[24:27], s63 offen sc1
    s_waitcnt lgkmcnt(0)
    buffer_store_dwordx4 v[92:95], v22, s[24:27], s64 offen sc1
    s_add_u32 s57, s57, 27648
    buffer_load_dwordx4 v10, s[16:19], s57 offen offset:2048 lds
    s_add_u32 s57, s57, 27648
    buffer_load_dwordx4 v11, s[16:19], s57 offen offset:3072 lds
    s_add_u32 m0, s52, 65536
    s_add_u32 s57, s65, 1
    s_sub_u32 s3, s57, 14
    s_min_u32 s57, s57, s3
    s_mul_i32 s57, s57, 114688
    buffer_load_dwordx4 v10, s[16:19], s57 offen offset:0 lds
    s_add_u32 s57, s57, 27648
    buffer_load_dwordx4 v11, s[16:19], s57 offen offset:1024 lds
    s_add_u32 s57, s57, 27648
    buffer_load_dwordx4 v10, s[16:19], s57 offen offset:2048 lds
    s_add_u32 s57, s57, 27648
    buffer_load_dwordx4 v11, s[16:19], s57 offen offset:3072 lds
    s_branch L_body
.p2align 12
L_body:
    s_mov_b32 s59, s44
    s_mov_b64 exec, 0
    s_branch L_wb_go
L_wb_ret:
    s_add_u32 s59, s59, 4
L_wb_go:
    s_cmp_eq_u32 s59, 0
    s_cbranch_scc1 L_wb_0
    s_cmp_eq_u32 s59, 1
    s_cbranch_scc1 L_wb_1
    s_cmp_eq_u32 s59, 2
    s_cbranch_scc1 L_wb_2
    s_cmp_eq_u32 s59, 3
    s_cbranch_scc1 L_wb_3
    s_cmp_eq_u32 s59, 4
    s_cbranch_scc1 L_wb_3
    s_cmp_eq_u32 s59, 5
    s_cbranch_scc1 L_wb_3
    s_mov_b64 exec, -1
    s_waitcnt vmcnt(6)
    v_cmp_eq_u32 vcc, 0, v29
    s_nop 0
    s_cbranch_vccz L_ok2
    s_mov_b32 s59, 100000
L_spin1:
    buffer_load_dword v29, off, s[40:43], 0 sc1
    s_waitcnt vmcnt(0)
    v_cmp_eq_u32 vcc, 0, v29
    s_nop 0
    s_cbranch_vccz L_ok2
    s_sub_u32 s59, s59, 1
    s_cbranch_scc0 L_spin1
L_ok2:
    v_readfirstlane_b32 s47, v29
    s_barrier
    s_cmp_lg_u32 s44, 0
    s_cbranch_scc1 L_nopub3
    s_lshl_b32 s60, s2, 5
    s_add_u32 s60, s60, 12582912
    v_mov_b32 v30, s47
    s_mov_b64 exec, 1
    buffer_store_dword v30, off, s[24:27], s60 sc1
    s_mov_b64 exec, -1
L_nopub3:
    s_lshl_b32 s53, s44, 11
    s_add_u32 s53, s53, 12582912
    v_lshl_add_u32 v18, v1, 5, s53
    s_lshl2_add_u32 s67, s51, s44
    s_add_u32 m0, s52, 81920
    s_add_u32 s57, s65, 2
    s_sub_u32 s3, s57, 14
    s_min_u32 s57, s57, s3
    s_mul_i32 s57, s57, 114688
    buffer_load_dwordx4 v10, s[16:19], s57 offen offset:0 lds
    s_mul_i32 s67, s67, 58624
    s_lshl_b32 s53, s50, 11
    s_add_u32 s67, s67, s53
    s_add_u32 s67, s67, 2097152
    s_add_u32 s57, s57, 27648
    buffer_load_dwordx4 v11, s[16:19], s57 offen offset:1024 lds
    v_mov_b32 v236, 0xbdd2d3e8
    v_mov_b32 v237, 0xc0135761
    s_or_b32 s88, s88, 0
    s_add_u32 s54, s88, 24
    s_add_u32 s57, s57, 27648
    buffer_load_dwordx4 v10, s[16:19], s57 offen offset:2048 lds
    s_mul_i32 s84, s54, 66816
    s_lshl2_add_u32 s84, s52, s84
    s_mul_i32 s83, s54, 58624
    s_add_u32 s83, s83, s53
    s_and_b32 s54, s44, 1
    s_lshl_b32 s54, s54, 10
    s_add_u32 s83, s83, s54
    s_add_u32 s83, s83, 2097152
    s_add_u32 s57, s57, 27648
    buffer_load_dwordx4 v11, s[16:19], s57 offen offset:3072 lds
    s_lshl1_add_u32 s54, s54, 49152
    v_add_u32 v243, s54, v23
    s_cmp_lt_u32 s88, 4
    s_cselect_b32 s84, s84, 2130706432
    s_cselect_b32 s83, s83, 2130706432
    s_cmp_lt_u32 s44, 2
    s_cselect_b32 s83, s83, 2130706432
    s_cmp_eq_u32 s44, 0
    s_cselect_b32 s85, 1.0, 0
    s_mul_i32 s53, s45, 7
    s_lshr_b32 s53, s53, 1
    s_sub_u32 s53, s50, s53
    s_lshl1_add_u32 s53, s53, s88
    s_sub_u32 s53, s53, 4
    s_mul_i32 s54, s44, 28
    s_add_u32 s54, s54, s53
    s_lshl_b32 s87, s54, 16
    s_lshl_b32 s54, s45, 9
    s_add_u32 s87, s87, s54
    s_cmp_ge_u32 s88, 4
    s_cselect_b32 s87, s87, 2130706432
    v_lshrrev_b32 v254, 2, v1
    v_lshlrev_b32 v254, 12, v254
    v_lshl_add_u32 v254, v210, 7, v254
    s_add_u32 m0, s52, 98304
    s_add_u32 s57, s65, 3
    s_sub_u32 s3, s57, 14
    s_min_u32 s57, s57, s3
    s_mul_i32 s57, s57, 114688
    buffer_load_dwordx4 v10, s[16:19], s57 offen offset:0 lds
    s_lshr_b32 s53, s46, 2
    s_and_b32 s89, s46, 3
    s_bfe_u32 s54, s46, 0x20001
    s_and_b32 s55, s46, 1
    s_add_u32 s55, s55, 4
    s_cmp_lt_u32 s46, 16
    s_cselect_b32 s53, s53, s54
    s_cselect_b32 s89, s89, s55
    s_mul_i32 s49, s53, 2
    s_add_u32 s49, s49, s89
    s_sub_u32 s54, s49, 6
    s_min_u32 s49, s49, s54
    s_or_b32 s89, s89, 0
    s_add_u32 s57, s57, 27648
    buffer_load_dwordx4 v11, s[16:19], s57 offen offset:1024 lds
    s_waitcnt vmcnt(10)
    ds_read_b64_tr_b16 a[0:1], v2 offset:0
    ds_read_b64_tr_b16 a[2:3], v2 offset:512
    ds_read_b64_tr_b16 a[4:5], v3 offset:0
    ds_read_b64_tr_b16 a[6:7], v3 offset:512
    s_add_u32 s57, s57, 27648
    buffer_load_dwordx4 v10, s[16:19], s57 offen offset:2048 lds
    ds_read_b64_tr_b16 a[8:9], v2 offset:256
    ds_read_b64_tr_b16 a[10:11], v2 offset:768
    ds_read_b64_tr_b16 a[12:13], v3 offset:256
    ds_read_b64_tr_b16 a[14:15], v3 offset:768
    s_add_u32 s57, s57, 27648
    buffer_load_dwordx4 v11, s[16:19], s57 offen offset:3072 lds
    s_lshl2_add_u32 s48, s45, s53
    s_mul_i32 s53, s44, 1835008
    s_lshl_b32 s74, s48, 7
    s_add_u32 s53, s53, s74
    s_lshl_b32 s56, s44, 5
    v_lshlrev_b32 v217, 5, v212
    v_xor_b32 v217, v217, v214
    v_xor_b32 v217, s56, v217
    s_add_u32 m0, s52, 114688
    s_add_u32 s57, s65, 4
    s_sub_u32 s3, s57, 14
    s_min_u32 s57, s57, s3
    s_mul_i32 s57, s57, 114688
    buffer_load_dwordx4 v10, s[16:19], s57 offen offset:0 lds
    s_add_u32 s74, s74, s56
    v_lshlrev_b32 v12, 12, v213
    v_add3_u32 v12, v12, v217, s53
    s_mul_i32 s53, s44, 28672
    s_add_u32 s57, s57, 27648
    buffer_load_dwordx4 v11, s[16:19], s57 offen offset:1024 lds
    s_waitcnt vmcnt(10)
    ds_read_b64_tr_b16 a[16:17], v2 offset:16384
    ds_read_b64_tr_b16 a[18:19], v2 offset:16896
    ds_read_b64_tr_b16 a[20:21], v3 offset:16384
    ds_read_b64_tr_b16 a[22:23], v3 offset:16896
    s_add_u32 s57, s57, 27648
    buffer_load_dwordx4 v10, s[16:19], s57 offen offset:2048 lds
    ds_read_b64_tr_b16 a[24:25], v2 offset:16640
    ds_read_b64_tr_b16 a[26:27], v2 offset:17152
    ds_read_b64_tr_b16 a[28:29], v3 offset:16640
    ds_read_b64_tr_b16 a[30:31], v3 offset:17152
    s_lshl_b32 s54, s49, 7
    s_add_u32 s55, s53, s54
    v_mul_u32_u24 v13, 896, v213
    v_add3_u32 v13, v13, v214, s55
    s_add_u32 s57, s57, 27648
    buffer_load_dwordx4 v11, s[16:19], s57 offen offset:3072 lds
    v_xor_b32 v14, 32, v13
    s_mul_i32 s55, s44, 21504
    v_subrev_u32 v239, s55, v13
    s_and_b32 s55, s56, 32
    s_add_u32 m0, s52, 131072
    s_add_u32 s57, s65, 5
    s_sub_u32 s3, s57, 14
    s_min_u32 s57, s57, s3
    s_mul_i32 s57, s57, 114688
    buffer_load_dwordx4 v10, s[16:19], s57 offen offset:0 lds
    v_xor_b32 v239, s55, v239
    s_mul_i32 s73, s48, 57344
    s_add_u32 s71, s73, s54
    s_mul_i32 s55, s44, 14336
    s_add_u32 s57, s57, 27648
    buffer_load_dwordx4 v11, s[16:19], s57 offen offset:1024 lds
    s_waitcnt vmcnt(10)
    ds_read_b64_tr_b16 a[32:33], v2 offset:32768
    ds_read_b64_tr_b16 a[34:35], v2 offset:33280
    ds_read_b64_tr_b16 a[36:37], v3 offset:32768
    ds_read_b64_tr_b16 a[38:39], v3 offset:33280
    s_add_u32 s71, s71, s55
    s_add_u32 s72, s71, 7168
    v_bfe_u32 v217, v1, 1, 2
    v_lshl_add_u32 v217, v212, 2, v217
    ds_read_b64_tr_b16 a[40:41], v2 offset:33024
    ds_read_b64_tr_b16 a[42:43], v2 offset:33536
    ds_read_b64_tr_b16 a[44:45], v3 offset:33024
    ds_read_b64_tr_b16 a[46:47], v3 offset:33536
    s_add_u32 s57, s57, 27648
    buffer_load_dwordx4 v10, s[16:19], s57 offen offset:2048 lds
    v_and_b32 v218, 24, v1
    v_add_u32 v217, v217, v218
    v_mul_u32_u24 v15, 896, v217
    v_and_b32 v217, 1, v1
    s_add_u32 s57, s57, 27648
    buffer_load_dwordx4 v11, s[16:19], s57 offen offset:3072 lds
    v_lshl_add_u32 v15, v217, 4, v15
    v_add_u32 v15, s53, v15
    s_lshl_b32 s54, s89, 5
    s_add_u32 s54, s54, 768
    s_add_u32 m0, s52, 147456
    s_add_u32 s57, s65, 6
    s_sub_u32 s3, s57, 14
    s_min_u32 s57, s57, s3
    s_mul_i32 s57, s57, 114688
    buffer_load_dwordx4 v10, s[16:19], s57 offen offset:0 lds
    s_add_u32 s68, s89, 24
    s_mul_i32 s68, s68, 58624
    s_mul_i32 s69, s44, 14336
    s_add_u32 s69, s69, 2097152
    s_add_u32 s68, s68, s69
    s_mul_i32 s55, s49, 234496
    s_add_u32 s69, s69, s55
    s_add_u32 s73, s73, s54
    s_add_u32 s57, s57, 27648
    buffer_load_dwordx4 v11, s[16:19], s57 offen offset:1024 lds
    s_waitcnt vmcnt(10)
    ds_read_b64_tr_b16 a[48:49], v2 offset:49152
    ds_read_b64_tr_b16 a[50:51], v2 offset:49664
    ds_read_b64_tr_b16 a[52:53], v3 offset:49152
    ds_read_b64_tr_b16 a[54:55], v3 offset:49664
    s_add_u32 s57, s57, 27648
    buffer_load_dwordx4 v10, s[16:19], s57 offen offset:2048 lds
    ds_read_b64_tr_b16 a[56:57], v2 offset:49408
    ds_read_b64_tr_b16 a[58:59], v2 offset:49920
    ds_read_b64_tr_b16 a[60:61], v3 offset:49408
    ds_read_b64_tr_b16 a[62:63], v3 offset:49920
    s_add_u32 s57, s57, 27648
    buffer_load_dwordx4 v11, s[16:19], s57 offen offset:3072 lds
    s_mov_b32 s76, 0
    s_add_u32 s77, s76, 2048
    s_cmp_eq_u32 s77, 14336
    s_cselect_b32 s77, 0, s77
    s_add_u32 s78, s77, 2048
    s_cmp_eq_u32 s78, 14336
    s_cselect_b32 s78, 0, s78
    s_add_u32 s79, s78, 2048
    s_cmp_eq_u32 s79, 14336
    s_cselect_b32 s79, 0, s79
    s_add_u32 s80, s79, 2048
    s_cmp_eq_u32 s80, 14336
    s_cselect_b32 s80, 0, s80
    s_add_u32 s81, s80, 2048
    s_cmp_eq_u32 s81, 14336
    s_cselect_b32 s81, 0, s81
    s_add_u32 s82, s81, 2048
    s_cmp_eq_u32 s82, 14336
    s_cselect_b32 s82, 0, s82
    s_waitcnt lgkmcnt(15)
    s_add_u32 m0, s52, 49152
    s_add_u32 s57, s65, 7
    s_sub_u32 s3, s57, 14
    s_min_u32 s57, s57, s3
    s_mul_i32 s57, s57, 114688
    buffer_load_dwordx4 v10, s[16:19], s57 offen offset:0 lds
    s_cmp_lt_u32 s89, 4
    s_cselect_b32 s75, s54, 2130706432
    s_cselect_b32 s68, s68, 2130706432
    s_cselect_b32 s73, s73, 2130706432
    s_add_u32 s57, s57, 27648
    buffer_load_dwordx4 v11, s[16:19], s57 offen offset:1024 lds
    s_waitcnt vmcnt(10)
    ds_read_b64_tr_b16 a[64:65], v4 offset:0
    ds_read_b64_tr_b16 a[66:67], v4 offset:512
    ds_read_b64_tr_b16 a[68:69], v5 offset:0
    ds_read_b64_tr_b16 a[70:71], v5 offset:512
    s_add_u32 s57, s57, 27648
    buffer_load_dwordx4 v10, s[16:19], s57 offen offset:2048 lds
    ds_read_b64_tr_b16 a[72:73], v4 offset:256
    ds_read_b64_tr_b16 a[74:75], v4 offset:768
    ds_read_b64_tr_b16 a[76:77], v5 offset:256
    ds_read_b64_tr_b16 a[78:79], v5 offset:768
    v_lshlrev_b32 v16, 3, v1
    v_add_u32 v16, 81920, v16
    v_and_b32 v217, 7, v1
    v_min_u32 v218, 6, v217
    s_add_u32 s57, s57, 27648
    buffer_load_dwordx4 v11, s[16:19], s57 offen offset:3072 lds
    s_mul_i32 s54, s44, 7
    v_add_u32 v218, s54, v218
    v_mul_u32_u24 v219, 2, v218
    v_add_u32 v219, s89, v219
    s_add_u32 m0, s52, 65536
    s_add_u32 s57, s65, 8
    s_sub_u32 s3, s57, 14
    s_min_u32 s57, s57, s3
    s_mul_i32 s57, s57, 114688
    buffer_load_dwordx4 v10, s[16:19], s57 offen offset:0 lds
    v_mul_u32_u24 v220, 43, v219
    v_lshrrev_b32 v220, 8, v220
    v_mul_u32_u24 v220, 6, v220
    v_sub_u32 v219, v219, v220
    s_add_u32 s57, s57, 27648
    buffer_load_dwordx4 v11, s[16:19], s57 offen offset:1024 lds
    s_waitcnt vmcnt(10)
    ds_read_b64_tr_b16 a[80:81], v4 offset:16384
    ds_read_b64_tr_b16 a[82:83], v4 offset:16896
    ds_read_b64_tr_b16 a[84:85], v5 offset:16384
    ds_read_b64_tr_b16 a[86:87], v5 offset:16896
    v_subrev_u32 v219, s49, v219
    v_bfe_u32 v220, v1, 3, 1
    v_mul_i32_i24 v219, v219, v220
    v_add_u32 v219, s49, v219
    ds_read_b64_tr_b16 a[88:89], v4 offset:16640
    ds_read_b64_tr_b16 a[90:91], v4 offset:17152
    ds_read_b64_tr_b16 a[92:93], v5 offset:16640
    ds_read_b64_tr_b16 a[94:95], v5 offset:17152
    s_add_u32 s57, s57, 27648
    buffer_load_dwordx4 v10, s[16:19], s57 offen offset:2048 lds
    v_lshl_add_u32 v218, v219, 5, v218
    v_lshlrev_b32 v20, 7, v218
    v_add_u32 v20, 12713984, v20
    s_lshr_b32 s53, s48, 1
    s_add_u32 s57, s57, 27648
    buffer_load_dwordx4 v11, s[16:19], s57 offen offset:3072 lds
    s_lshl_b32 s53, s53, 7
    s_add_u32 s53, s53, 12779520
    v_lshl_add_u32 v21, v210, 11, s53
    s_lshl_b32 s70, s48, 16
    s_waitcnt lgkmcnt(15)
    s_add_u32 m0, s52, 81920
    s_add_u32 s57, s65, 9
    s_sub_u32 s3, s57, 14
    s_min_u32 s57, s57, s3
    s_mul_i32 s57, s57, 114688
    buffer_load_dwordx4 v10, s[16:19], s57 offen offset:0 lds
    s_lshl2_add_u32 s70, s52, s70
    s_add_u32 s70, s70, 4194304
    v_lshrrev_b32 v218, 3, v1
    v_mul_u32_u24 v22, 896, v218
    v_lshl_add_u32 v22, v217, 4, v22
    v_lshlrev_b32 v25, 1, v211
    s_add_u32 s53, s52, 65536
    v_mul_u32_u24 v244, 176, v218
    s_add_u32 s57, s57, 27648
    buffer_load_dwordx4 v11, s[16:19], s57 offen offset:1024 lds
    s_waitcnt vmcnt(10)
    ds_read_b64_tr_b16 a[96:97], v4 offset:32768
    ds_read_b64_tr_b16 a[98:99], v4 offset:33280
    ds_read_b64_tr_b16 a[100:101], v5 offset:32768
    ds_read_b64_tr_b16 a[102:103], v5 offset:33280
    s_add_u32 s57, s57, 27648
    buffer_load_dwordx4 v10, s[16:19], s57 offen offset:2048 lds
    ds_read_b64_tr_b16 a[104:105], v4 offset:33024
    ds_read_b64_tr_b16 a[106:107], v4 offset:33536
    ds_read_b64_tr_b16 a[108:109], v5 offset:33024
    ds_read_b64_tr_b16 a[110:111], v5 offset:33536
    s_add_u32 s57, s57, 27648
    buffer_load_dwordx4 v11, s[16:19], s57 offen offset:3072 lds
    v_lshl_add_u32 v244, v217, 4, v244
    v_add_u32 v244, s53, v244
    v_mul_u32_u24 v238, 176, v211
    v_lshl_add_u32 v238, v208, 3, v238
    v_add_u32 v238, s53, v238
    v_lshrrev_b32 v218, 2, v0
    v_mul_u32_u24 v26, 896, v218
    v_lshl_add_u32 v26, v210, 3, v26
    s_add_u32 m0, s52, 98304
    s_add_u32 s57, s65, 10
    s_sub_u32 s3, s57, 14
    s_min_u32 s57, s57, s3
    s_mul_i32 s57, s57, 114688
    buffer_load_dwordx4 v10, s[16:19], s57 offen offset:0 lds
    v_lshrrev_b32 v218, 2, v1
    v_mul_u32_u24 v252, 176, v218
    v_lshl_add_u32 v252, v210, 3, v252
    v_add_u32 v252, s53, v252
    s_add_u32 s57, s57, 27648
    buffer_load_dwordx4 v11, s[16:19], s57 offen offset:1024 lds
    s_waitcnt vmcnt(10)
    ds_read_b64_tr_b16 a[112:113], v2 offset:0
    ds_read_b64_tr_b16 a[114:115], v2 offset:512
    ds_read_b64_tr_b16 a[116:117], v3 offset:0
    ds_read_b64_tr_b16 a[118:119], v3 offset:512
    s_add_u32 s57, s57, 27648
    buffer_load_dwordx4 v10, s[16:19], s57 offen offset:2048 lds
    ds_read_b64_tr_b16 a[120:121], v2 offset:256
    ds_read_b64_tr_b16 a[122:123], v2 offset:768
    ds_read_b64_tr_b16 a[124:125], v3 offset:256
    ds_read_b64_tr_b16 a[126:127], v3 offset:768
    s_sub_u32 s53, 49152, s52
    v_add_u32 v246, s53, v2
    v_add_u32 v247, s53, v3
    v_mul_u32_u24 v218, 3072, v208
    s_add_u32 s57, s57, 27648
    buffer_load_dwordx4 v11, s[16:19], s57 offen offset:3072 lds
    v_add_u32 v248, v218, v246
    v_add_u32 v249, v218, v247
    v_add_u32 v232, s52, v23
    v_xor_b32 v233, 4096, v232
    s_waitcnt lgkmcnt(15)
    s_add_u32 m0, s52, 114688
    s_add_u32 s57, s65, 11
    s_sub_u32 s3, s57, 14
    s_min_u32 s57, s57, s3
    s_mul_i32 s57, s57, 114688
    buffer_load_dwordx4 v10, s[16:19], s57 offen offset:0 lds
    v_xor_b32 v234, 8192, v232
    v_xor_b32 v235, 12288, v232
    v_lshlrev_b32 v32, 16, v224
    v_and_b32 v33, s61, v224
    v_lshlrev_b32 v34, 16, v225
    v_and_b32 v35, s61, v225
    s_add_u32 s57, s57, 27648
    buffer_load_dwordx4 v11, s[16:19], s57 offen offset:1024 lds
    s_waitcnt vmcnt(10)
    ds_read_b64_tr_b16 a[128:129], v2 offset:16384
    ds_read_b64_tr_b16 a[130:131], v2 offset:16896
    ds_read_b64_tr_b16 a[132:133], v3 offset:16384
    ds_read_b64_tr_b16 a[134:135], v3 offset:16896
    s_add_u32 s57, s57, 27648
    buffer_load_dwordx4 v10, s[16:19], s57 offen offset:2048 lds
    ds_read_b64_tr_b16 a[136:137], v2 offset:16640
    ds_read_b64_tr_b16 a[138:139], v2 offset:17152
    ds_read_b64_tr_b16 a[140:141], v3 offset:16640
    ds_read_b64_tr_b16 a[142:143], v3 offset:17152
    s_add_u32 s57, s57, 27648
    buffer_load_dwordx4 v11, s[16:19], s57 offen offset:3072 lds
    v_lshlrev_b32 v36, 16, v226
    v_and_b32 v37, s61, v226
    v_lshlrev_b32 v38, 16, v227
    v_and_b32 v39, s61, v227
    v_lshlrev_b32 v40, 16, v228
    v_and_b32 v41, s61, v228
    v_lshlrev_b32 v42, 16, v229
    v_and_b32 v43, s61, v229
    s_add_u32 m0, s52, 131072
    s_add_u32 s57, s65, 12
    s_sub_u32 s3, s57, 14
    s_min_u32 s57, s57, s3
    s_mul_i32 s57, s57, 114688
    buffer_load_dwordx4 v10, s[16:19], s57 offen offset:0 lds
    v_lshlrev_b32 v44, 16, v230
    v_and_b32 v45, s61, v230
    v_lshlrev_b32 v46, 16, v231
    v_and_b32 v47, s61, v231
    s_add_u32 s57, s57, 27648
    buffer_load_dwordx4 v11, s[16:19], s57 offen offset:1024 lds
    s_waitcnt vmcnt(10)
    ds_read_b64_tr_b16 a[144:145], v2 offset:32768
    ds_read_b64_tr_b16 a[146:147], v2 offset:33280
    ds_read_b64_tr_b16 a[148:149], v3 offset:32768
    ds_read_b64_tr_b16 a[150:151], v3 offset:33280
    s_add_u32 s57, s57, 27648
    buffer_load_dwordx4 v10, s[16:19], s57 offen offset:2048 lds
    ds_read_b64_tr_b16 a[152:153], v2 offset:33024
    ds_read_b64_tr_b16 a[154:155], v2 offset:33536
    ds_read_b64_tr_b16 a[156:157], v3 offset:33024
    ds_read_b64_tr_b16 a[158:159], v3 offset:33536
    v_mul_f32 v96, s85, v32
    v_mul_f32 v97, s85, v33
    v_mul_f32 v98, s85, v34
    v_mul_f32 v99, s85, v35
    s_add_u32 s57, s57, 27648
    buffer_load_dwordx4 v11, s[16:19], s57 offen offset:3072 lds
    v_mul_f32 v100, s85, v36
    v_mul_f32 v101, s85, v37
    v_mul_f32 v102, s85, v38
    v_mul_f32 v103, s85, v39
    buffer_load_dword v17, v18, s[24:27], 0 offen sc1
    v_mul_f32 v104, s85, v40
    v_mul_f32 v105, s85, v41
    v_mul_f32 v106, s85, v42
    v_mul_f32 v107, s85, v43
    v_mul_f32 v108, s85, v44
    v_mul_f32 v109, s85, v45
    v_mul_f32 v110, s85, v46
    v_mul_f32 v111, s85, v47
    s_waitcnt lgkmcnt(15)
    s_add_u32 m0, s52, 147456
    s_add_u32 s57, s65, 13
    s_sub_u32 s3, s57, 14
    s_min_u32 s57, s57, s3
    s_mul_i32 s57, s57, 114688
    buffer_load_dwordx4 v10, s[16:19], s57 offen offset:0 lds
    s_waitcnt vmcnt(10)
    ds_read_b64_tr_b16 a[160:161], v2 offset:49152
    ds_read_b64_tr_b16 a[162:163], v2 offset:49664
    ds_read_b64_tr_b16 a[164:165], v3 offset:49152
    ds_read_b64_tr_b16 a[166:167], v3 offset:49664
    s_add_u32 s57, s57, 27648
    buffer_load_dwordx4 v11, s[16:19], s57 offen offset:1024 lds
    ds_read_b64_tr_b16 a[168:169], v2 offset:49408
    ds_read_b64_tr_b16 a[170:171], v2 offset:49920
    ds_read_b64_tr_b16 a[172:173], v3 offset:49408
    ds_read_b64_tr_b16 a[174:175], v3 offset:49920
    s_add_u32 s57, s57, 27648
    buffer_load_dwordx4 v10, s[16:19], s57 offen offset:2048 lds
    s_add_u32 s57, s57, 27648
    buffer_load_dwordx4 v11, s[16:19], s57 offen offset:3072 lds
    s_add_u32 m0, s52, 49152
    s_mov_b32 s57, 1605632
    buffer_load_dwordx4 v10, s[16:19], s57 offen offset:0 lds
    s_waitcnt vmcnt(10)
    ds_read_b64_tr_b16 a[176:177], v4 offset:0
    ds_read_b64_tr_b16 a[178:179], v4 offset:512
    ds_read_b64_tr_b16 a[180:181], v5 offset:0
    ds_read_b64_tr_b16 a[182:183], v5 offset:512
    s_add_u32 s57, s57, 27648
    buffer_load_dwordx4 v11, s[16:19], s57 offen offset:1024 lds
    ds_read_b64_tr_b16 a[184:185], v4 offset:256
    ds_read_b64_tr_b16 a[186:187], v4 offset:768
    ds_read_b64_tr_b16 a[188:189], v5 offset:256
    ds_read_b64_tr_b16 a[190:191], v5 offset:768
    s_add_u32 s57, s57, 27648
    buffer_load_dwordx4 v10, s[16:19], s57 offen offset:2048 lds
    s_add_u32 s57, s57, 27648
    buffer_load_dwordx4 v11, s[16:19], s57 offen offset:3072 lds
    s_waitcnt lgkmcnt(15)
    s_add_u32 m0, s52, 65536
    s_mov_b32 s57, 1720320
    buffer_load_dwordx4 v10, s[16:19], s57 offen offset:0 lds
    s_waitcnt vmcnt(10)
    ds_read_b64_tr_b16 a[192:193], v4 offset:16384
    ds_read_b64_tr_b16 a[194:195], v4 offset:16896
    ds_read_b64_tr_b16 a[196:197], v5 offset:16384
    ds_read_b64_tr_b16 a[198:199], v5 offset:16896
    s_add_u32 s57, s57, 27648
    buffer_load_dwordx4 v11, s[16:19], s57 offen offset:1024 lds
    ds_read_b64_tr_b16 a[200:201], v4 offset:16640
    ds_read_b64_tr_b16 a[202:203], v4 offset:17152
    ds_read_b64_tr_b16 a[204:205], v5 offset:16640
    ds_read_b64_tr_b16 a[206:207], v5 offset:17152
    s_add_u32 s57, s57, 27648
    buffer_load_dwordx4 v10, s[16:19], s57 offen offset:2048 lds
    s_waitcnt vmcnt(11)
    v_cmp_ne_u32 vcc, s47, v17
    s_nop 0
    s_cbranch_vccz L_ok5
    s_mov_b32 s59, 100000
L_spin4:
    buffer_load_dword v17, v18, s[24:27], 0 offen sc1
    s_waitcnt vmcnt(0)
    v_cmp_ne_u32 vcc, s47, v17
    s_nop 0
    s_cbranch_vccz L_ok5
    s_sub_u32 s59, s59, 1
    s_cbranch_scc0 L_spin4
L_ok5:
    s_cmp_ge_u32 s88, 4
    s_cbranch_scc1 L_p2_alt
    s_add_u32 s57, s57, 27648
    buffer_load_dwordx4 v11, s[16:19], s57 offen offset:3072 lds
    s_mov_b32 s66, s84
    s_lshl_b32 s86, s65, 10
    s_add_u32 s58, s86, s66
    s_add_u32 s86, s66, 14336
    buffer_load_dwordx4 v[112:115], v23, s[24:27], s58 offen offset:0 sc1
    s_add_u32 s58, s58, 1024
    s_cmp_eq_u32 s58, s86
    s_cselect_b32 s58, s66, s58
    buffer_load_dwordx4 v[116:119], v23, s[24:27], s58 offen offset:0 sc1
    s_waitcnt vmcnt(10)
    ds_read_b64_tr_b16 a[208:209], v4 offset:32768
    ds_read_b64_tr_b16 a[210:211], v4 offset:33280
    ds_read_b64_tr_b16 a[212:213], v5 offset:32768
    ds_read_b64_tr_b16 a[214:215], v5 offset:33280
    s_add_u32 s58, s58, 1024
    s_cmp_eq_u32 s58, s86
    s_cselect_b32 s58, s66, s58
    buffer_load_dwordx4 v[120:123], v23, s[24:27], s58 offen offset:0 sc1
    ds_read_b64_tr_b16 a[216:217], v4 offset:33024
    ds_read_b64_tr_b16 a[218:219], v4 offset:33536
    ds_read_b64_tr_b16 a[220:221], v5 offset:33024
    ds_read_b64_tr_b16 a[222:223], v5 offset:33536
    s_add_u32 s58, s58, 1024
    s_cmp_eq_u32 s58, s86
    s_cselect_b32 s58, s66, s58
    buffer_load_dwordx4 v[124:127], v23, s[24:27], s58 offen offset:0 sc1
    s_add_u32 s58, s58, 1024
    s_cmp_eq_u32 s58, s86
    s_cselect_b32 s58, s66, s58
    buffer_load_dwordx4 v[128:131], v23, s[24:27], s58 offen offset:0 sc1
    s_add_u32 s58, s58, 1024
    s_cmp_eq_u32 s58, s86
    s_cselect_b32 s58, s66, s58
    buffer_load_dwordx4 v[132:135], v23, s[24:27], s58 offen offset:0 sc1
    s_waitcnt vmcnt(10)
    ds_read_b64_tr_b16 a[224:225], v2 offset:0
    ds_read_b64_tr_b16 a[226:227], v2 offset:512
    ds_read_b64_tr_b16 a[228:229], v3 offset:0
    ds_read_b64_tr_b16 a[230:231], v3 offset:512
    s_add_u32 s58, s58, 1024
    s_cmp_eq_u32 s58, s86
    s_cselect_b32 s58, s66, s58
    buffer_load_dwordx4 v[136:139], v23, s[24:27], s58 offen offset:0 sc1
    ds_read_b64_tr_b16 a[232:233], v2 offset:256
    ds_read_b64_tr_b16 a[234:235], v2 offset:768
    ds_read_b64_tr_b16 a[236:237], v3 offset:256
    ds_read_b64_tr_b16 a[238:239], v3 offset:768
    s_add_u32 s58, s58, 1024
    s_cmp_eq_u32 s58, s86
    s_cselect_b32 s58, s66, s58
    buffer_load_dwordx4 v[140:143], v23, s[24:27], s58 offen offset:0 sc1
    s_add_u32 s58, s58, 1024
    s_cmp_eq_u32 s58, s86
    s_cselect_b32 s58, s66, s58
    buffer_load_dwordx4 v[144:147], v23, s[24:27], s58 offen offset:0 sc1
    s_add_u32 s58, s58, 1024
    s_cmp_eq_u32 s58, s86
    s_cselect_b32 s58, s66, s58
    buffer_load_dwordx4 v[148:151], v23, s[24:27], s58 offen offset:0 sc1
    s_waitcnt vmcnt(10)
    ds_read_b64_tr_b16 a[240:241], v2 offset:16384
    ds_read_b64_tr_b16 a[242:243], v2 offset:16896
    ds_read_b64_tr_b16 a[244:245], v3 offset:16384
    ds_read_b64_tr_b16 a[246:247], v3 offset:16896
    s_add_u32 s58, s58, 1024
    s_cmp_eq_u32 s58, s86
    s_cselect_b32 s58, s66, s58
    buffer_load_dwordx4 v[152:155], v23, s[24:27], s58 offen offset:0 sc1
    ds_read_b64_tr_b16 a[248:249], v2 offset:16640
    ds_read_b64_tr_b16 a[250:251], v2 offset:17152
    ds_read_b64_tr_b16 a[252:253], v3 offset:16640
    ds_read_b64_tr_b16 a[254:255], v3 offset:17152
    s_waitcnt vmcnt(10)
    v_mfma_f32_16x16x32_bf16 v[96:99], a[0:3], v[112:115], v[96:99]
    s_add_u32 s58, s58, 1024
    s_cmp_eq_u32 s58, s86
    s_cselect_b32 s58, s66, s58
    v_mfma_f32_16x16x32_bf16 v[100:103], a[4:7], v[112:115], v[100:103]
    buffer_load_dwordx4 v[156:159], v23, s[24:27], s58 offen offset:0 sc1
    v_mfma_f32_16x16x32_bf16 v[104:107], a[8:11], v[112:115], v[104:107]
    v_mfma_f32_16x16x32_bf16 v[108:111], a[12:15], v[112:115], v[108:111]
    s_waitcnt vmcnt(10)
    v_mfma_f32_16x16x32_bf16 v[96:99], a[16:19], v[116:119], v[96:99]
    s_add_u32 s58, s58, 1024
    s_cmp_eq_u32 s58, s86
    s_cselect_b32 s58, s66, s58
    v_mfma_f32_16x16x32_bf16 v[100:103], a[20:23], v[116:119], v[100:103]
    buffer_load_dwordx4 v[112:115], v23, s[24:27], s58 offen offset:0 sc1
    v_mfma_f32_16x16x32_bf16 v[104:107], a[24:27], v[116:119], v[104:107]
    v_mfma_f32_16x16x32_bf16 v[108:111], a[28:31], v[116:119], v[108:111]
    s_waitcnt vmcnt(10)
    v_mfma_f32_16x16x32_bf16 v[96:99], a[32:35], v[120:123], v[96:99]
    s_add_u32 s58, s58, 1024
    s_cmp_eq_u32 s58, s86
    s_cselect_b32 s58, s66, s58
    v_mfma_f32_16x16x32_bf16 v[100:103], a[36:39], v[120:123], v[100:103]
    buffer_load_dwordx4 v[116:119], v23, s[24:27], s58 offen offset:0 sc1
    v_mfma_f32_16x16x32_bf16 v[104:107], a[40:43], v[120:123], v[104:107]
    v_mfma_f32_16x16x32_bf16 v[108:111], a[44:47], v[120:123], v[108:111]
    s_waitcnt vmcnt(10)
    v_mfma_f32_16x16x32_bf16 v[96:99], a[48:51], v[124:127], v[96:99]
    s_add_u32 s58, s66, 14336
L_wb_0:
    s_cbranch_execz L_wb_ret
    v_mfma_f32_16x16x32_bf16 v[100:103], a[52:55], v[124:127], v[100:103]
    buffer_load_dwordx4 v[120:123], v23, s[24:27], s58 offen offset:0 sc1
    v_mfma_f32_16x16x32_bf16 v[104:107], a[56:59], v[124:127], v[104:107]
    v_mfma_f32_16x16x32_bf16 v[108:111], a[60:63], v[124:127], v[108:111]
    s_waitcnt vmcnt(10)
    v_mfma_f32_16x16x32_bf16 v[96:99], a[64:67], v[128:131], v[96:99]
    s_add_u32 s58, s66, 15360
    v_mfma_f32_16x16x32_bf16 v[100:103], a[68:71], v[128:131], v[100:103]
    buffer_load_dwordx4 v[124:127], v23, s[24:27], s58 offen offset:0 sc1
    v_mfma_f32_16x16x32_bf16 v[104:107], a[72:75], v[128:131], v[104:107]
    v_mfma_f32_16x16x32_bf16 v[108:111], a[76:79], v[128:131], v[108:111]
    s_waitcnt vmcnt(10)
    v_mfma_f32_16x16x32_bf16 v[96:99], a[80:83], v[132:135], v[96:99]
    s_xor_b32 s66, s44, 3
    s_lshl2_add_u32 s66, s51, s66
    s_mul_i32 s66, s66, 66816
    s_lshl2_add_u32 s66, s52, s66
    s_lshl_b32 s86, s65, 10
    s_add_u32 s58, s86, s66
    s_add_u32 s86, s66, 14336
    v_mfma_f32_16x16x32_bf16 v[100:103], a[84:87], v[132:135], v[100:103]
    buffer_load_dwordx4 v[128:131], v23, s[24:27], s58 offen offset:0 sc1
    v_mfma_f32_16x16x32_bf16 v[104:107], a[88:91], v[132:135], v[104:107]
    v_mfma_f32_16x16x32_bf16 v[108:111], a[92:95], v[132:135], v[108:111]
    s_waitcnt vmcnt(10)
    v_mfma_f32_16x16x32_bf16 v[96:99], a[96:99], v[136:139], v[96:99]
    s_add_u32 s58, s58, 1024
    s_cmp_eq_u32 s58, s86
    s_cselect_b32 s58, s66, s58
    v_mfma_f32_16x16x32_bf16 v[100:103], a[100:103], v[136:139], v[100:103]
    buffer_load_dwordx4 v[132:135], v23, s[24:27], s58 offen offset:0 sc1
    v_mfma_f32_16x16x32_bf16 v[104:107], a[104:107], v[136:139], v[104:107]
    v_mfma_f32_16x16x32_bf16 v[108:111], a[108:111], v[136:139], v[108:111]
    s_waitcnt vmcnt(10)
    v_mfma_f32_16x16x32_bf16 v[96:99], a[112:115], v[140:143], v[96:99]
    s_add_u32 s58, s58, 1024
    s_cmp_eq_u32 s58, s86
    s_cselect_b32 s58, s66, s58
    v_mfma_f32_16x16x32_bf16 v[100:103], a[116:119], v[140:143], v[100:103]
    buffer_load_dwordx4 v[136:139], v23, s[24:27], s58 offen offset:0 sc1
    v_mfma_f32_16x16x32_bf16 v[104:107], a[120:123], v[140:143], v[104:107]
    v_mfma_f32_16x16x32_bf16 v[108:111], a[124:127], v[140:143], v[108:111]
    s_waitcnt vmcnt(10)
    v_mfma_f32_16x16x32_bf16 v[96:99], a[128:131], v[144:147], v[96:99]
    s_add_u32 s58, s58, 1024
    s_cmp_eq_u32 s58, s86
    s_cselect_b32 s58, s66, s58
    v_mfma_f32_16x16x32_bf16 v[100:103], a[132:135], v[144:147], v[100:103]
    buffer_load_dwordx4 v[140:143], v23, s[24:27], s58 offen offset:0 sc1
    v_mfma_f32_16x16x32_bf16 v[104:107], a[136:139], v[144:147], v[104:107]
    v_mfma_f32_16x16x32_bf16 v[108:111], a[140:143], v[144:147], v[108:111]
    s_waitcnt vmcnt(10)
    v_mfma_f32_16x16x32_bf16 v[96:99], a[144:147], v[148:151], v[96:99]
    s_add_u32 s58, s58, 1024
    s_cmp_eq_u32 s58, s86
    s_cselect_b32 s58, s66, s58
    v_mfma_f32_16x16x32_bf16 v[100:103], a[148:151], v[148:151], v[100:103]
    buffer_load_dwordx4 v[144:147], v23, s[24:27], s58 offen offset:0 sc1
    v_mfma_f32_16x16x32_bf16 v[104:107], a[152:155], v[148:151], v[104:107]
    v_mfma_f32_16x16x32_bf16 v[108:111], a[156:159], v[148:151], v[108:111]
    s_waitcnt vmcnt(10)
    s_waitcnt lgkmcnt(15)
    v_mfma_f32_16x16x32_bf16 v[96:99], a[160:163], v[152:155], v[96:99]
    s_add_u32 s58, s58, 1024
    s_cmp_eq_u32 s58, s86
    s_cselect_b32 s58, s66, s58
    v_mfma_f32_16x16x32_bf16 v[100:103], a[164:167], v[152:155], v[100:103]
    buffer_load_dwordx4 v[148:151], v23, s[24:27], s58 offen offset:0 sc1
    v_mfma_f32_16x16x32_bf16 v[104:107], a[168:171], v[152:155], v[104:107]
    v_mfma_f32_16x16x32_bf16 v[108:111], a[172:175], v[152:155], v[108:111]
    s_waitcnt vmcnt(10)
    v_mfma_f32_16x16x32_bf16 v[96:99], a[176:179], v[156:159], v[96:99]
    s_add_u32 s58, s58, 1024
    s_cmp_eq_u32 s58, s86
    s_cselect_b32 s58, s66, s58
    v_mfma_f32_16x16x32_bf16 v[100:103], a[180:183], v[156:159], v[100:103]
    buffer_load_dwordx4 v[152:155], v23, s[24:27], s58 offen offset:0 sc1
    v_mfma_f32_16x16x32_bf16 v[104:107], a[184:187], v[156:159], v[104:107]
    v_mfma_f32_16x16x32_bf16 v[108:111], a[188:191], v[156:159], v[108:111]
    s_waitcnt vmcnt(10)
    v_mfma_f32_16x16x32_bf16 v[96:99], a[192:195], v[112:115], v[96:99]
    s_add_u32 s58, s58, 1024
    s_cmp_eq_u32 s58, s86
    s_cselect_b32 s58, s66, s58
    v_mfma_f32_16x16x32_bf16 v[100:103], a[196:199], v[112:115], v[100:103]
    buffer_load_dwordx4 v[156:159], v23, s[24:27], s58 offen offset:0 sc1
    v_mfma_f32_16x16x32_bf16 v[104:107], a[200:203], v[112:115], v[104:107]
    v_mfma_f32_16x16x32_bf16 v[108:111], a[204:207], v[112:115], v[108:111]
    s_waitcnt vmcnt(10)
    v_mfma_f32_16x16x32_bf16 v[96:99], a[208:211], v[116:119], v[96:99]
    s_add_u32 s58, s58, 1024
    s_cmp_eq_u32 s58, s86
    s_cselect_b32 s58, s66, s58
    v_mfma_f32_16x16x32_bf16 v[100:103], a[212:215], v[116:119], v[100:103]
    buffer_load_dwordx4 v[112:115], v23, s[24:27], s58 offen offset:0 sc1
    v_mfma_f32_16x16x32_bf16 v[104:107], a[216:219], v[116:119], v[104:107]
    v_mfma_f32_16x16x32_bf16 v[108:111], a[220:223], v[116:119], v[108:111]
    s_waitcnt vmcnt(10)
    s_waitcnt lgkmcnt(8)
    v_mfma_f32_16x16x32_bf16 v[96:99], a[224:227], v[120:123], v[96:99]
    s_add_u32 s58, s58, 1024
    s_cmp_eq_u32 s58, s86
    s_cselect_b32 s58, s66, s58
    v_mfma_f32_16x16x32_bf16 v[100:103], a[228:231], v[120:123], v[100:103]
    buffer_load_dwordx4 v[116:119], v23, s[24:27], s58 offen offset:0 sc1
    v_mfma_f32_16x16x32_bf16 v[104:107], a[232:235], v[120:123], v[104:107]
    v_mfma_f32_16x16x32_bf16 v[108:111], a[236:239], v[120:123], v[108:111]
    s_waitcnt vmcnt(10)
    s_waitcnt lgkmcnt(0)
    v_mfma_f32_16x16x32_bf16 v[96:99], a[240:243], v[124:127], v[96:99]
    s_add_u32 s58, s58, 1024
    s_cmp_eq_u32 s58, s86
    s_cselect_b32 s58, s66, s58
    v_mfma_f32_16x16x32_bf16 v[100:103], a[244:247], v[124:127], v[100:103]
    buffer_load_dwordx4 v[120:123], v23, s[24:27], s58 offen offset:0 sc1
    v_mfma_f32_16x16x32_bf16 v[104:107], a[248:251], v[124:127], v[104:107]
    v_mfma_f32_16x16x32_bf16 v[108:111], a[252:255], v[124:127], v[108:111]
L_p2_join:
    s_waitcnt vmcnt(10)
    v_mfma_f32_16x16x32_bf16 v[80:83], a[0:3], v[128:131], 0
    s_add_u32 s58, s58, 1024
    s_cmp_eq_u32 s58, s86
    s_cselect_b32 s58, s66, s58
    v_mfma_f32_16x16x32_bf16 v[84:87], a[4:7], v[128:131], 0
    buffer_load_dwordx4 v[124:127], v23, s[24:27], s58 offen offset:0 sc1
    v_mfma_f32_16x16x32_bf16 v[88:91], a[8:11], v[128:131], 0
    v_mfma_f32_16x16x32_bf16 v[92:95], a[12:15], v[128:131], 0
    s_waitcnt vmcnt(10)
    v_mfma_f32_16x16x32_bf16 v[80:83], a[16:19], v[132:135], v[80:83]
    v_mfma_f32_16x16x32_bf16 v[84:87], a[20:23], v[132:135], v[84:87]
    buffer_load_dwordx4 v[216:219], v22, s[4:7], s71 offen
    v_mfma_f32_16x16x32_bf16 v[88:91], a[24:27], v[132:135], v[88:91]
    ds_write_b128 v232, v[96:99] offset:49152
    v_mfma_f32_16x16x32_bf16 v[92:95], a[28:31], v[132:135], v[92:95]
    s_waitcnt vmcnt(10)
    v_mfma_f32_16x16x32_bf16 v[80:83], a[32:35], v[136:139], v[80:83]
    s_add_u32 s58, s58, 1024
    s_cmp_eq_u32 s58, s86
    s_cselect_b32 s58, s66, s58
    v_mfma_f32_16x16x32_bf16 v[84:87], a[36:39], v[136:139], v[84:87]
    buffer_load_dwordx4 v[128:131], v23, s[24:27], s58 offen offset:0 sc1
    v_mfma_f32_16x16x32_bf16 v[88:91], a[40:43], v[136:139], v[88:91]
    ds_write_b128 v232, v[100:103] offset:50176
    v_mfma_f32_16x16x32_bf16 v[92:95], a[44:47], v[136:139], v[92:95]
    s_waitcnt vmcnt(10)
    v_mfma_f32_16x16x32_bf16 v[80:83], a[48:51], v[140:143], v[80:83]
    v_mfma_f32_16x16x32_bf16 v[84:87], a[52:55], v[140:143], v[84:87]
    buffer_load_dwordx4 v[220:223], v22, s[4:7], s72 offen
    v_mfma_f32_16x16x32_bf16 v[88:91], a[56:59], v[140:143], v[88:91]
    ds_write_b128 v232, v[104:107] offset:51200
    v_mfma_f32_16x16x32_bf16 v[92:95], a[60:63], v[140:143], v[92:95]
    s_waitcnt vmcnt(10)
    v_mfma_f32_16x16x32_bf16 v[80:83], a[64:67], v[144:147], v[80:83]
    s_add_u32 s58, s58, 1024
    s_cmp_eq_u32 s58, s86
    s_cselect_b32 s58, s66, s58
    v_mfma_f32_16x16x32_bf16 v[84:87], a[68:71], v[144:147], v[84:87]
    buffer_load_dwordx4 v[132:135], v23, s[24:27], s58 offen offset:0 sc1
    v_mfma_f32_16x16x32_bf16 v[88:91], a[72:75], v[144:147], v[88:91]
    ds_write_b128 v232, v[108:111] offset:52224
    v_mfma_f32_16x16x32_bf16 v[92:95], a[76:79], v[144:147], v[92:95]
    s_waitcnt vmcnt(10)
    v_mfma_f32_16x16x32_bf16 v[80:83], a[80:83], v[148:151], v[80:83]
    v_mfma_f32_16x16x32_bf16 v[84:87], a[84:87], v[148:151], v[84:87]
    buffer_load_dwordx2 v[224:225], v26, s[4:7], s73 offen
    v_mfma_f32_16x16x32_bf16 v[88:91], a[88:91], v[148:151], v[88:91]
    v_mfma_f32_16x16x32_bf16 v[92:95], a[92:95], v[148:151], v[92:95]
    s_waitcnt vmcnt(10)
    v_mfma_f32_16x16x32_bf16 v[80:83], a[96:99], v[152:155], v[80:83]
    s_add_u32 s58, s66, 14336
    v_mfma_f32_16x16x32_bf16 v[84:87], a[100:103], v[152:155], v[84:87]
    buffer_load_dwordx4 v[136:139], v23, s[24:27], s58 offen offset:0 sc1
    v_mfma_f32_16x16x32_bf16 v[88:91], a[104:107], v[152:155], v[88:91]
    v_mfma_f32_16x16x32_bf16 v[92:95], a[108:111], v[152:155], v[92:95]
    s_waitcnt vmcnt(10)
    v_mfma_f32_16x16x32_bf16 v[80:83], a[112:115], v[156:159], v[80:83]
    v_mfma_f32_16x16x32_bf16 v[84:87], a[116:119], v[156:159], v[84:87]
    buffer_load_ushort v228, v25, s[36:39], s74 offen
    v_mfma_f32_16x16x32_bf16 v[88:91], a[120:123], v[156:159], v[88:91]
    s_waitcnt lgkmcnt(0)
    s_barrier
    v_mfma_f32_16x16x32_bf16 v[92:95], a[124:127], v[156:159], v[92:95]
    s_waitcnt vmcnt(10)
    v_mfma_f32_16x16x32_bf16 v[80:83], a[128:131], v[112:115], v[80:83]
    s_add_u32 s58, s66, 15360
    v_mfma_f32_16x16x32_bf16 v[84:87], a[132:135], v[112:115], v[84:87]
    buffer_load_dwordx4 v[140:143], v23, s[24:27], s58 offen offset:0 sc1
    v_mfma_f32_16x16x32_bf16 v[88:91], a[136:139], v[112:115], v[88:91]
    ds_read_b128 v[160:163], v243 offset:0
    ds_read_b128 v[164:167], v243 offset:1024
    v_mfma_f32_16x16x32_bf16 v[92:95], a[140:143], v[112:115], v[92:95]
    ds_read_b128 v[168:171], v243 offset:4096
    s_waitcnt vmcnt(10)
    v_mfma_f32_16x16x32_bf16 v[80:83], a[144:147], v[116:119], v[80:83]
    s_xor_b32 s66, s44, 2
    s_lshl2_add_u32 s66, s51, s66
    s_mul_i32 s66, s66, 66816
    s_lshl2_add_u32 s66, s52, s66
    s_lshl_b32 s86, s65, 10
    s_add_u32 s58, s86, s66
    s_add_u32 s86, s66, 14336
    v_mfma_f32_16x16x32_bf16 v[84:87], a[148:151], v[116:119], v[84:87]
    buffer_load_dwordx4 v[144:147], v23, s[24:27], s58 offen offset:0 sc1
    v_mfma_f32_16x16x32_bf16 v[88:91], a[152:155], v[116:119], v[88:91]
    ds_read_b128 v[172:175], v243 offset:5120
    ds_read_b128 v[176:179], v243 offset:8192
    v_mfma_f32_16x16x32_bf16 v[92:95], a[156:159], v[116:119], v[92:95]
    ds_read_b128 v[180:183], v243 offset:9216
    s_waitcnt vmcnt(10)
    v_mfma_f32_16x16x32_bf16 v[80:83], a[160:163], v[120:123], v[80:83]
    s_add_u32 s58, s58, 1024
    s_cmp_eq_u32 s58, s86
    s_cselect_b32 s58, s66, s58
    v_mfma_f32_16x16x32_bf16 v[84:87], a[164:167], v[120:123], v[84:87]
    buffer_load_dwordx4 v[148:151], v23, s[24:27], s58 offen offset:0 sc1
    v_mfma_f32_16x16x32_bf16 v[88:91], a[168:171], v[120:123], v[88:91]
    ds_read_b128 v[184:187], v243 offset:12288
    v_mfma_f32_16x16x32_bf16 v[92:95], a[172:175], v[120:123], v[92:95]
    ds_read_b128 v[188:191], v243 offset:13312
    s_waitcnt vmcnt(10)
    v_mfma_f32_16x16x32_bf16 v[80:83], a[176:179], v[124:127], v[80:83]
    s_add_u32 s58, s58, 1024
    s_cmp_eq_u32 s58, s86
    s_cselect_b32 s58, s66, s58
    v_mfma_f32_16x16x32_bf16 v[84:87], a[180:183], v[124:127], v[84:87]
    buffer_load_dwordx4 v[152:155], v23, s[24:27], s58 offen offset:0 sc1
    v_mfma_f32_16x16x32_bf16 v[88:91], a[184:187], v[124:127], v[88:91]
    v_mfma_f32_16x16x32_bf16 v[92:95], a[188:191], v[124:127], v[92:95]
    s_add_u32 s58, s58, 1024
    s_cmp_eq_u32 s58, s86
    s_cselect_b32 s58, s66, s58
    buffer_load_dwordx4 v[156:159], v23, s[24:27], s58 offen offset:0 sc1
    s_waitcnt vmcnt(10)
    v_mfma_f32_16x16x32_bf16 v[80:83], a[192:195], v[128:131], v[80:83]
    s_add_u32 s58, s58, 1024
    s_cmp_eq_u32 s58, s86
    s_cselect_b32 s58, s66, s58
    v_mfma_f32_16x16x32_bf16 v[84:87], a[196:199], v[128:131], v[84:87]
    buffer_load_dwordx4 v[112:115], v23, s[24:27], s58 offen offset:0 sc1
    v_mfma_f32_16x16x32_bf16 v[88:91], a[200:203], v[128:131], v[88:91]
    s_waitcnt lgkmcnt(0)
    v_add_f32 v160, v160, v168
    v_mfma_f32_16x16x32_bf16 v[92:95], a[204:207], v[128:131], v[92:95]
    v_add_f32 v161, v161, v169
    s_add_u32 s58, s58, 1024
    s_cmp_eq_u32 s58, s86
    s_cselect_b32 s58, s66, s58
    buffer_load_dwordx4 v[116:119], v23, s[24:27], s58 offen offset:0 sc1
    s_waitcnt vmcnt(10)
    v_mfma_f32_16x16x32_bf16 v[80:83], a[208:211], v[132:135], v[80:83]
    s_add_u32 s58, s58, 1024
    s_cmp_eq_u32 s58, s86
    s_cselect_b32 s58, s66, s58
    v_mfma_f32_16x16x32_bf16 v[84:87], a[212:215], v[132:135], v[84:87]
    buffer_load_dwordx4 v[120:123], v23, s[24:27], s58 offen offset:0 sc1
    v_mfma_f32_16x16x32_bf16 v[88:91], a[216:219], v[132:135], v[88:91]
    v_add_f32 v162, v162, v170
    v_add_f32 v163, v163, v171
    v_mfma_f32_16x16x32_bf16 v[92:95], a[220:223], v[132:135], v[92:95]
    v_add_f32 v164, v164, v172
    s_add_u32 s58, s58, 1024
    s_cmp_eq_u32 s58, s86
    s_cselect_b32 s58, s66, s58
    buffer_load_dwordx4 v[124:127], v23, s[24:27], s58 offen offset:0 sc1
    s_waitcnt vmcnt(10)
    v_mfma_f32_16x16x32_bf16 v[80:83], a[224:227], v[136:139], v[80:83]
    s_add_u32 s58, s58, 1024
    s_cmp_eq_u32 s58, s86
    s_cselect_b32 s58, s66, s58
    v_mfma_f32_16x16x32_bf16 v[84:87], a[228:231], v[136:139], v[84:87]
    buffer_load_dwordx4 v[128:131], v23, s[24:27], s58 offen offset:0 sc1
    v_mfma_f32_16x16x32_bf16 v[88:91], a[232:235], v[136:139], v[88:91]
    v_add_f32 v165, v165, v173
    v_add_f32 v166, v166, v174
    v_mfma_f32_16x16x32_bf16 v[92:95], a[236:239], v[136:139], v[92:95]
    v_add_f32 v167, v167, v175
    s_add_u32 s58, s58, 1024
    s_cmp_eq_u32 s58, s86
    s_cselect_b32 s58, s66, s58
    buffer_load_dwordx4 v[132:135], v23, s[24:27], s58 offen offset:0 sc1
    s_waitcnt vmcnt(10)
    v_mfma_f32_16x16x32_bf16 v[80:83], a[240:243], v[140:143], v[80:83]
    s_add_u32 s58, s58, 1024
    s_cmp_eq_u32 s58, s86
    s_cselect_b32 s58, s66, s58
    v_mfma_f32_16x16x32_bf16 v[84:87], a[244:247], v[140:143], v[84:87]
    buffer_load_dwordx4 v[136:139], v23, s[24:27], s58 offen offset:0 sc1
    v_mfma_f32_16x16x32_bf16 v[88:91], a[248:251], v[140:143], v[88:91]
    v_add_f32 v160, v160, v176
    v_add_f32 v161, v161, v177
    v_mfma_f32_16x16x32_bf16 v[92:95], a[252:255], v[140:143], v[92:95]
    v_add_f32 v162, v162, v178
    s_waitcnt vmcnt(10)
    v_mfma_f32_16x16x32_bf16 v[64:67], a[0:3], v[144:147], 0
    s_add_u32 s58, s58, 1024
    s_cmp_eq_u32 s58, s86
    s_cselect_b32 s58, s66, s58
    v_mfma_f32_16x16x32_bf16 v[68:71], a[4:7], v[144:147], 0
    buffer_load_dwordx4 v[140:143], v23, s[24:27], s58 offen offset:0 sc1
    v_mfma_f32_16x16x32_bf16 v[72:75], a[8:11], v[144:147], 0
    v_mfma_f32_16x16x32_bf16 v[76:79], a[12:15], v[144:147], 0
    s_waitcnt vmcnt(10)
    v_mfma_f32_16x16x32_bf16 v[64:67], a[16:19], v[148:151], v[64:67]
    s_add_u32 s58, s58, 1024
    s_cmp_eq_u32 s58, s86
    s_cselect_b32 s58, s66, s58
    v_mfma_f32_16x16x32_bf16 v[68:71], a[20:23], v[148:151], v[68:71]
    buffer_load_dwordx4 v[144:147], v23, s[24:27], s58 offen offset:0 sc1
    v_mfma_f32_16x16x32_bf16 v[72:75], a[24:27], v[148:151], v[72:75]
    ds_write_b128 v232, v[80:83] offset:32768
    v_mfma_f32_16x16x32_bf16 v[76:79], a[28:31], v[148:151], v[76:79]
    s_waitcnt vmcnt(10)
    v_mfma_f32_16x16x32_bf16 v[64:67], a[32:35], v[152:155], v[64:67]
    s_add_u32 s58, s58, 1024
    s_cmp_eq_u32 s58, s86
    s_cselect_b32 s58, s66, s58
    v_mfma_f32_16x16x32_bf16 v[68:71], a[36:39], v[152:155], v[68:71]
    buffer_load_dwordx4 v[148:151], v23, s[24:27], s58 offen offset:0 sc1
    v_mfma_f32_16x16x32_bf16 v[72:75], a[40:43], v[152:155], v[72:75]
    ds_write_b128 v232, v[84:87] offset:33792
    v_mfma_f32_16x16x32_bf16 v[76:79], a[44:47], v[152:155], v[76:79]
    s_waitcnt vmcnt(10)
    v_mfma_f32_16x16x32_bf16 v[64:67], a[48:51], v[156:159], v[64:67]
    s_add_u32 s58, s66, 14336
    ds_write_b128 v232, v[88:91] offset:34816
    v_mfma_f32_16x16x32_bf16 v[68:71], a[52:55], v[156:159], v[68:71]
    buffer_load_dwordx4 v[152:155], v23, s[24:27], s58 offen offset:0 sc1
    v_mfma_f32_16x16x32_bf16 v[72:75], a[56:59], v[156:159], v[72:75]
    v_add_f32 v163, v163, v179
    v_add_f32 v164, v164, v180
    v_mfma_f32_16x16x32_bf16 v[76:79], a[60:63], v[156:159], v[76:79]
    v_add_f32 v165, v165, v181
    s_waitcnt vmcnt(10)
    v_mfma_f32_16x16x32_bf16 v[64:67], a[64:67], v[112:115], v[64:67]
    s_add_u32 s58, s66, 15360
    ds_write_b128 v232, v[92:95] offset:35840
    v_mfma_f32_16x16x32_bf16 v[68:71], a[68:71], v[112:115], v[68:71]
    buffer_load_dwordx4 v[156:159], v23, s[24:27], s58 offen offset:0 sc1
    v_mfma_f32_16x16x32_bf16 v[72:75], a[72:75], v[112:115], v[72:75]
    v_add_f32 v166, v166, v182
    v_add_f32 v167, v167, v183
    v_mfma_f32_16x16x32_bf16 v[76:79], a[76:79], v[112:115], v[76:79]
    v_add_f32 v160, v160, v184
    s_waitcnt vmcnt(10)
    v_mfma_f32_16x16x32_bf16 v[64:67], a[80:83], v[116:119], v[64:67]
    s_xor_b32 s66, s44, 1
    s_lshl2_add_u32 s66, s51, s66
    s_mul_i32 s66, s66, 66816
    s_lshl2_add_u32 s66, s52, s66
    s_lshl_b32 s86, s65, 10
    s_add_u32 s58, s86, s66
    s_add_u32 s86, s66, 14336
    v_mfma_f32_16x16x32_bf16 v[68:71], a[84:87], v[116:119], v[68:71]
    buffer_load_dwordx4 v[112:115], v23, s[24:27], s58 offen offset:0 sc1
    v_mfma_f32_16x16x32_bf16 v[72:75], a[88:91], v[116:119], v[72:75]
    v_add_f32 v161, v161, v185
    v_add_f32 v162, v162, v186
    v_mfma_f32_16x16x32_bf16 v[76:79], a[92:95], v[116:119], v[76:79]
    v_add_f32 v163, v163, v187
    s_waitcnt vmcnt(10)
    v_mfma_f32_16x16x32_bf16 v[64:67], a[96:99], v[120:123], v[64:67]
    s_add_u32 s58, s58, 1024
    s_cmp_eq_u32 s58, s86
    s_cselect_b32 s58, s66, s58
    v_mfma_f32_16x16x32_bf16 v[68:71], a[100:103], v[120:123], v[68:71]
    buffer_load_dwordx4 v[116:119], v23, s[24:27], s58 offen offset:0 sc1
    v_mfma_f32_16x16x32_bf16 v[72:75], a[104:107], v[120:123], v[72:75]
    v_add_f32 v164, v164, v188
    v_add_f32 v165, v165, v189
    v_mfma_f32_16x16x32_bf16 v[76:79], a[108:111], v[120:123], v[76:79]
    v_add_f32 v166, v166, v190
    s_waitcnt vmcnt(10)
    v_mfma_f32_16x16x32_bf16 v[64:67], a[112:115], v[124:127], v[64:67]
    s_add_u32 s58, s58, 1024
    s_cmp_eq_u32 s58, s86
    s_cselect_b32 s58, s66, s58
    v_mfma_f32_16x16x32_bf16 v[68:71], a[116:119], v[124:127], v[68:71]
    buffer_load_dwordx4 v[120:123], v23, s[24:27], s58 offen offset:0 sc1
    v_mfma_f32_16x16x32_bf16 v[72:75], a[120:123], v[124:127], v[72:75]
    v_add_f32 v167, v167, v191
    v_mul_f32 v192, v160, v160
    v_mfma_f32_16x16x32_bf16 v[76:79], a[124:127], v[124:127], v[76:79]
    v_mul_f32 v193, v161, v161
    s_waitcnt vmcnt(10)
    v_mfma_f32_16x16x32_bf16 v[64:67], a[128:131], v[128:131], v[64:67]
    s_add_u32 s58, s58, 1024
    s_cmp_eq_u32 s58, s86
    s_cselect_b32 s58, s66, s58
    v_mfma_f32_16x16x32_bf16 v[68:71], a[132:135], v[128:131], v[68:71]
    buffer_load_dwordx4 v[124:127], v23, s[24:27], s58 offen offset:0 sc1
    v_mfma_f32_16x16x32_bf16 v[72:75], a[136:139], v[128:131], v[72:75]
    v_mul_f32 v194, v162, v162
    v_mul_f32 v195, v163, v163
    v_mfma_f32_16x16x32_bf16 v[76:79], a[140:143], v[128:131], v[76:79]
    v_mul_f32 v196, v164, v164
    s_waitcnt vmcnt(10)
    v_mfma_f32_16x16x32_bf16 v[64:67], a[144:147], v[132:135], v[64:67]
    s_add_u32 s58, s58, 1024
    s_cmp_eq_u32 s58, s86
    s_cselect_b32 s58, s66, s58
    v_mfma_f32_16x16x32_bf16 v[68:71], a[148:151], v[132:135], v[68:71]
    buffer_load_dwordx4 v[128:131], v23, s[24:27], s58 offen offset:0 sc1
    v_mfma_f32_16x16x32_bf16 v[72:75], a[152:155], v[132:135], v[72:75]
    v_mul_f32 v197, v165, v165
    v_mul_f32 v198, v166, v166
    v_mfma_f32_16x16x32_bf16 v[76:79], a[156:159], v[132:135], v[76:79]
    v_mul_f32 v199, v167, v167
    ds_write_b128 v244, v[216:219]
    s_waitcnt vmcnt(10)
    v_mfma_f32_16x16x32_bf16 v[64:67], a[160:163], v[136:139], v[64:67]
    s_add_u32 s58, s58, 1024
    s_cmp_eq_u32 s58, s86
    s_cselect_b32 s58, s66, s58
    v_mfma_f32_16x16x32_bf16 v[68:71], a[164:167], v[136:139], v[68:71]
    buffer_load_dwordx4 v[132:135], v23, s[24:27], s58 offen offset:0 sc1
    v_mfma_f32_16x16x32_bf16 v[72:75], a[168:171], v[136:139], v[72:75]
    v_fma_f32 v192, v192, v236, v237
    v_fma_f32 v193, v193, v236, v237
    v_mfma_f32_16x16x32_bf16 v[76:79], a[172:175], v[136:139], v[76:79]
    v_fma_f32 v194, v194, v236, v237
    s_waitcnt vmcnt(10)
    v_mfma_f32_16x16x32_bf16 v[64:67], a[176:179], v[140:143], v[64:67]
    s_add_u32 s58, s58, 1024
    s_cmp_eq_u32 s58, s86
    s_cselect_b32 s58, s66, s58
    v_mfma_f32_16x16x32_bf16 v[68:71], a[180:183], v[140:143], v[68:71]
    buffer_load_dwordx4 v[136:139], v23, s[24:27], s58 offen offset:0 sc1
    v_mfma_f32_16x16x32_bf16 v[72:75], a[184:187], v[140:143], v[72:75]
    v_fma_f32 v195, v195, v236, v237
    v_fma_f32 v196, v196, v236, v237
    v_mfma_f32_16x16x32_bf16 v[76:79], a[188:191], v[140:143], v[76:79]
    v_fma_f32 v197, v197, v236, v237
    ds_write_b128 v244, v[220:223] offset:1408
    s_waitcnt vmcnt(10)
    v_mfma_f32_16x16x32_bf16 v[64:67], a[192:195], v[144:147], v[64:67]
    s_add_u32 s58, s58, 1024
    s_cmp_eq_u32 s58, s86
    s_cselect_b32 s58, s66, s58
    v_mfma_f32_16x16x32_bf16 v[68:71], a[196:199], v[144:147], v[68:71]
    buffer_load_dwordx4 v[140:143], v23, s[24:27], s58 offen offset:0 sc1
    v_mfma_f32_16x16x32_bf16 v[72:75], a[200:203], v[144:147], v[72:75]
    v_fma_f32 v198, v198, v236, v237
    v_fma_f32 v199, v199, v236, v237
    v_mfma_f32_16x16x32_bf16 v[76:79], a[204:207], v[144:147], v[76:79]
    v_mul_f32 v192, v192, v160
    s_waitcnt vmcnt(10)
    v_mfma_f32_16x16x32_bf16 v[64:67], a[208:211], v[148:151], v[64:67]
    s_add_u32 s58, s58, 1024
    s_cmp_eq_u32 s58, s86
    s_cselect_b32 s58, s66, s58
    v_mfma_f32_16x16x32_bf16 v[68:71], a[212:215], v[148:151], v[68:71]
    buffer_load_dwordx4 v[144:147], v23, s[24:27], s58 offen offset:0 sc1
    v_mfma_f32_16x16x32_bf16 v[72:75], a[216:219], v[148:151], v[72:75]
    v_mul_f32 v193, v193, v161
    v_mul_f32 v194, v194, v162
    v_mfma_f32_16x16x32_bf16 v[76:79], a[220:223], v[148:151], v[76:79]
    v_mul_f32 v195, v195, v163
    ds_write_b64 v252, v[224:225] offset:128
    s_waitcnt vmcnt(10)
    v_mfma_f32_16x16x32_bf16 v[64:67], a[224:227], v[152:155], v[64:67]
    s_add_u32 s58, s58, 1024
    s_cmp_eq_u32 s58, s86
    s_cselect_b32 s58, s66, s58
    v_mfma_f32_16x16x32_bf16 v[68:71], a[228:231], v[152:155], v[68:71]
    buffer_load_dwordx4 v[148:151], v23, s[24:27], s58 offen offset:0 sc1
    v_mfma_f32_16x16x32_bf16 v[72:75], a[232:235], v[152:155], v[72:75]
    v_mul_f32 v196, v196, v164
    v_mul_f32 v197, v197, v165
    v_mfma_f32_16x16x32_bf16 v[76:79], a[236:239], v[152:155], v[76:79]
    v_mul_f32 v198, v198, v166
    s_waitcnt vmcnt(10)
    v_mfma_f32_16x16x32_bf16 v[64:67], a[240:243], v[156:159], v[64:67]
    s_add_u32 s58, s58, 1024
    s_cmp_eq_u32 s58, s86
    s_cselect_b32 s58, s66, s58
    v_mfma_f32_16x16x32_bf16 v[68:71], a[244:247], v[156:159], v[68:71]
    buffer_load_dwordx4 v[152:155], v23, s[24:27], s58 offen offset:0 sc1
    v_mfma_f32_16x16x32_bf16 v[72:75], a[248:251], v[156:159], v[72:75]
    v_mul_f32 v199, v199, v167
    v_mfma_f32_16x16x32_bf16 v[76:79], a[252:255], v[156:159], v[76:79]
    ds_read_b64 v[216:217], v238 offset:0
    ds_read_b64 v[218:219], v238 offset:32
    ds_read_b64 v[220:221], v238 offset:64
    ds_read_b64 v[222:223], v238 offset:96
    ds_read_b64 v[224:225], v238 offset:128
    s_waitcnt vmcnt(10)
    v_mfma_f32_16x16x32_bf16 v[48:51], a[0:3], v[112:115], 0
    s_add_u32 s58, s58, 1024
    s_cmp_eq_u32 s58, s86
    s_cselect_b32 s58, s66, s58
    v_mfma_f32_16x16x32_bf16 v[52:55], a[4:7], v[112:115], 0
    buffer_load_dwordx4 v[156:159], v23, s[24:27], s58 offen offset:0 sc1
    v_mfma_f32_16x16x32_bf16 v[56:59], a[8:11], v[112:115], 0
    v_mfma_f32_16x16x32_bf16 v[60:63], a[12:15], v[112:115], 0
    s_waitcnt vmcnt(10)
    v_mfma_f32_16x16x32_bf16 v[48:51], a[16:19], v[116:119], v[48:51]
    s_add_u32 s58, s58, 1024
    s_cmp_eq_u32 s58, s86
    s_cselect_b32 s58, s66, s58
    v_mfma_f32_16x16x32_bf16 v[52:55], a[20:23], v[116:119], v[52:55]
    buffer_load_dwordx4 v[112:115], v23, s[24:27], s58 offen offset:0 sc1
    v_mfma_f32_16x16x32_bf16 v[56:59], a[24:27], v[116:119], v[56:59]
    ds_write_b128 v232, v[64:67] offset:16384
    v_mfma_f32_16x16x32_bf16 v[60:63], a[28:31], v[116:119], v[60:63]
    s_waitcnt vmcnt(10)
    v_mfma_f32_16x16x32_bf16 v[48:51], a[32:35], v[120:123], v[48:51]
    s_add_u32 s58, s58, 1024
    s_cmp_eq_u32 s58, s86
    s_cselect_b32 s58, s66, s58
    v_mfma_f32_16x16x32_bf16 v[52:55], a[36:39], v[120:123], v[52:55]
    buffer_load_dwordx4 v[116:119], v23, s[24:27], s58 offen offset:0 sc1
    v_mfma_f32_16x16x32_bf16 v[56:59], a[40:43], v[120:123], v[56:59]
    ds_write_b128 v232, v[68:71] offset:17408
    v_mfma_f32_16x16x32_bf16 v[60:63], a[44:47], v[120:123], v[60:63]
    s_waitcnt vmcnt(10)
    v_mfma_f32_16x16x32_bf16 v[48:51], a[48:51], v[124:127], v[48:51]
    s_add_u32 s58, s66, 14336
    ds_write_b128 v232, v[72:75] offset:18432
    v_mfma_f32_16x16x32_bf16 v[52:55], a[52:55], v[124:127], v[52:55]
    buffer_load_dwordx4 v[120:123], v23, s[24:27], s58 offen offset:0 sc1
    v_mfma_f32_16x16x32_bf16 v[56:59], a[56:59], v[124:127], v[56:59]
    v_exp_f32 v192, v192
    v_exp_f32 v193, v193
    v_mfma_f32_16x16x32_bf16 v[60:63], a[60:63], v[124:127], v[60:63]
    v_exp_f32 v194, v194
    s_waitcnt vmcnt(10)
    v_mfma_f32_16x16x32_bf16 v[48:51], a[64:67], v[128:131], v[48:51]
    s_add_u32 s58, s66, 15360
    ds_write_b128 v232, v[76:79] offset:19456
    v_mfma_f32_16x16x32_bf16 v[52:55], a[68:71], v[128:131], v[52:55]
    buffer_load_dwordx4 v[124:127], v23, s[24:27], s58 offen offset:0 sc1
    v_mfma_f32_16x16x32_bf16 v[56:59], a[72:75], v[128:131], v[56:59]
    v_exp_f32 v195, v195
    v_exp_f32 v196, v196
    v_mfma_f32_16x16x32_bf16 v[60:63], a[76:79], v[128:131], v[60:63]
    v_exp_f32 v197, v197
    s_waitcnt vmcnt(10)
    v_mfma_f32_16x16x32_bf16 v[48:51], a[80:83], v[132:135], v[48:51]
    s_xor_b32 s66, s44, 0
    s_lshl2_add_u32 s66, s51, s66
    s_mul_i32 s66, s66, 66816
    s_lshl2_add_u32 s66, s52, s66
    s_lshl_b32 s86, s65, 10
    s_add_u32 s58, s86, s66
    s_add_u32 s86, s66, 14336
    v_mfma_f32_16x16x32_bf16 v[52:55], a[84:87], v[132:135], v[52:55]
    buffer_load_dwordx4 v[128:131], v23, s[24:27], s58 offen offset:0 sc1
    v_mfma_f32_16x16x32_bf16 v[56:59], a[88:91], v[132:135], v[56:59]
    v_exp_f32 v198, v198
    v_exp_f32 v199, v199
    v_mfma_f32_16x16x32_bf16 v[60:63], a[92:95], v[132:135], v[60:63]
    v_add_f32 v192, 1.0, v192
    s_waitcnt vmcnt(10)
    v_mfma_f32_16x16x32_bf16 v[48:51], a[96:99], v[136:139], v[48:51]
    s_add_u32 s58, s58, 1024
    s_cmp_eq_u32 s58, s86
    s_cselect_b32 s58, s66, s58
    v_mfma_f32_16x16x32_bf16 v[52:55], a[100:103], v[136:139], v[52:55]
    buffer_load_dwordx4 v[132:135], v23, s[24:27], s58 offen offset:0 sc1
    v_mfma_f32_16x16x32_bf16 v[56:59], a[104:107], v[136:139], v[56:59]
    v_add_f32 v193, 1.0, v193
    v_add_f32 v194, 1.0, v194
    v_mfma_f32_16x16x32_bf16 v[60:63], a[108:111], v[136:139], v[60:63]
    v_add_f32 v195, 1.0, v195
    s_waitcnt vmcnt(10)
    v_mfma_f32_16x16x32_bf16 v[48:51], a[112:115], v[140:143], v[48:51]
    s_add_u32 s58, s58, 1024
    s_cmp_eq_u32 s58, s86
    s_cselect_b32 s58, s66, s58
    v_mfma_f32_16x16x32_bf16 v[52:55], a[116:119], v[140:143], v[52:55]
    buffer_load_dwordx4 v[136:139], v23, s[24:27], s58 offen offset:0 sc1
    v_mfma_f32_16x16x32_bf16 v[56:59], a[120:123], v[140:143], v[56:59]
    v_add_f32 v196, 1.0, v196
    v_add_f32 v197, 1.0, v197
    v_mfma_f32_16x16x32_bf16 v[60:63], a[124:127], v[140:143], v[60:63]
    v_add_f32 v198, 1.0, v198
    s_waitcnt vmcnt(10)
    v_mfma_f32_16x16x32_bf16 v[48:51], a[128:131], v[144:147], v[48:51]
    s_add_u32 s58, s58, 1024
    s_cmp_eq_u32 s58, s86
    s_cselect_b32 s58, s66, s58
    v_mfma_f32_16x16x32_bf16 v[52:55], a[132:135], v[144:147], v[52:55]
    buffer_load_dwordx4 v[140:143], v23, s[24:27], s58 offen offset:0 sc1
    v_mfma_f32_16x16x32_bf16 v[56:59], a[136:139], v[144:147], v[56:59]
    v_add_f32 v199, 1.0, v199
    v_rcp_f32 v192, v192
    v_mfma_f32_16x16x32_bf16 v[60:63], a[140:143], v[144:147], v[60:63]
    v_rcp_f32 v193, v193
    s_waitcnt vmcnt(10)
    v_mfma_f32_16x16x32_bf16 v[48:51], a[144:147], v[148:151], v[48:51]
    s_add_u32 s58, s58, 1024
    s_cmp_eq_u32 s58, s86
    s_cselect_b32 s58, s66, s58
    v_mfma_f32_16x16x32_bf16 v[52:55], a[148:151], v[148:151], v[52:55]
    buffer_load_dwordx4 v[144:147], v23, s[24:27], s58 offen offset:0 sc1
    v_mfma_f32_16x16x32_bf16 v[56:59], a[152:155], v[148:151], v[56:59]
    v_rcp_f32 v194, v194
    v_rcp_f32 v195, v195
    v_mfma_f32_16x16x32_bf16 v[60:63], a[156:159], v[148:151], v[60:63]
    v_rcp_f32 v196, v196
    s_waitcnt vmcnt(10)
    v_mfma_f32_16x16x32_bf16 v[48:51], a[160:163], v[152:155], v[48:51]
    s_add_u32 s58, s58, 1024
    s_cmp_eq_u32 s58, s86
    s_cselect_b32 s58, s66, s58
    v_mfma_f32_16x16x32_bf16 v[52:55], a[164:167], v[152:155], v[52:55]
    buffer_load_dwordx4 v[148:151], v23, s[24:27], s58 offen offset:0 sc1
    v_mfma_f32_16x16x32_bf16 v[56:59], a[168:171], v[152:155], v[56:59]
    v_rcp_f32 v197, v197
    v_rcp_f32 v198, v198
    v_mfma_f32_16x16x32_bf16 v[60:63], a[172:175], v[152:155], v[60:63]
    v_rcp_f32 v199, v199
    s_waitcnt vmcnt(10)
    v_mfma_f32_16x16x32_bf16 v[48:51], a[176:179], v[156:159], v[48:51]
    s_add_u32 s58, s58, 1024
    s_cmp_eq_u32 s58, s86
    s_cselect_b32 s58, s66, s58
    v_mfma_f32_16x16x32_bf16 v[52:55], a[180:183], v[156:159], v[52:55]
    buffer_load_dwordx4 v[152:155], v23, s[24:27], s58 offen offset:0 sc1
    v_mfma_f32_16x16x32_bf16 v[56:59], a[184:187], v[156:159], v[56:59]
    v_mul_f32 v192, v192, v160
    v_mul_f32 v193, v193, v161
    v_mfma_f32_16x16x32_bf16 v[60:63], a[188:191], v[156:159], v[60:63]
    v_mul_f32 v194, v194, v162
    s_waitcnt vmcnt(10)
    v_mfma_f32_16x16x32_bf16 v[48:51], a[192:195], v[112:115], v[48:51]
    s_add_u32 s58, s58, 1024
    s_cmp_eq_u32 s58, s86
    s_cselect_b32 s58, s66, s58
    v_mfma_f32_16x16x32_bf16 v[52:55], a[196:199], v[112:115], v[52:55]
    buffer_load_dwordx4 v[156:159], v23, s[24:27], s58 offen offset:0 sc1
    v_mfma_f32_16x16x32_bf16 v[56:59], a[200:203], v[112:115], v[56:59]
    v_mul_f32 v195, v195, v163
    v_mul_f32 v196, v196, v164
L_wb_1:
    s_cbranch_execz L_wb_ret
    v_mfma_f32_16x16x32_bf16 v[60:63], a[204:207], v[112:115], v[60:63]
    v_mul_f32 v197, v197, v165
    s_waitcnt vmcnt(10)
    v_mfma_f32_16x16x32_bf16 v[48:51], a[208:211], v[116:119], v[48:51]
    s_add_u32 s58, s58, 1024
    s_cmp_eq_u32 s58, s86
    s_cselect_b32 s58, s66, s58
    v_mfma_f32_16x16x32_bf16 v[52:55], a[212:215], v[116:119], v[52:55]
    buffer_load_dwordx4 v[112:115], v23, s[24:27], s58 offen offset:0 sc1
    v_mfma_f32_16x16x32_bf16 v[56:59], a[216:219], v[116:119], v[56:59]
    v_mul_f32 v198, v198, v166
    v_mul_f32 v199, v199, v167
    v_mfma_f32_16x16x32_bf16 v[60:63], a[220:223], v[116:119], v[60:63]
    v_cvt_pk_bf16_f32 v96, v192, v193
    s_waitcnt vmcnt(10)
    v_mfma_f32_16x16x32_bf16 v[48:51], a[224:227], v[120:123], v[48:51]
    s_add_u32 s58, s58, 1024
    s_cmp_eq_u32 s58, s86
    s_cselect_b32 s58, s66, s58
    v_mfma_f32_16x16x32_bf16 v[52:55], a[228:231], v[120:123], v[52:55]
    buffer_load_dwordx4 v[116:119], v23, s[24:27], s58 offen offset:0 sc1
    v_mfma_f32_16x16x32_bf16 v[56:59], a[232:235], v[120:123], v[56:59]
    v_cvt_pk_bf16_f32 v97, v194, v195
    v_cvt_pk_bf16_f32 v98, v196, v197
    v_mfma_f32_16x16x32_bf16 v[60:63], a[236:239], v[120:123], v[60:63]
    v_cvt_pk_bf16_f32 v99, v198, v199
    s_waitcnt vmcnt(10)
    v_mfma_f32_16x16x32_bf16 v[48:51], a[240:243], v[124:127], v[48:51]
    s_add_u32 s58, s58, 1024
    s_cmp_eq_u32 s58, s86
    s_cselect_b32 s58, s66, s58
    v_mfma_f32_16x16x32_bf16 v[52:55], a[244:247], v[124:127], v[52:55]
    buffer_load_dwordx4 v[120:123], v23, s[24:27], s58 offen offset:0 sc1
    v_mfma_f32_16x16x32_bf16 v[56:59], a[248:251], v[124:127], v[56:59]
    v_mfma_f32_16x16x32_bf16 v[60:63], a[252:255], v[124:127], v[60:63]
    s_waitcnt vmcnt(10)
    v_mfma_f32_16x16x32_bf16 v[32:35], a[0:3], v[128:131], v[32:35]
    s_add_u32 s58, s58, 1024
    s_cmp_eq_u32 s58, s86
    s_cselect_b32 s58, s66, s58
    v_mfma_f32_16x16x32_bf16 v[36:39], a[4:7], v[128:131], v[36:39]
    buffer_load_dwordx4 v[124:127], v23, s[24:27], s58 offen offset:0 sc1
    v_mfma_f32_16x16x32_bf16 v[40:43], a[8:11], v[128:131], v[40:43]
    v_mfma_f32_16x16x32_bf16 v[44:47], a[12:15], v[128:131], v[44:47]
    s_waitcnt vmcnt(10)
    v_mfma_f32_16x16x32_bf16 v[32:35], a[16:19], v[132:135], v[32:35]
    s_add_u32 s58, s58, 1024
    s_cmp_eq_u32 s58, s86
    s_cselect_b32 s58, s66, s58
    v_mfma_f32_16x16x32_bf16 v[36:39], a[20:23], v[132:135], v[36:39]
    buffer_load_dwordx4 v[128:131], v23, s[24:27], s58 offen offset:0 sc1
    v_mfma_f32_16x16x32_bf16 v[40:43], a[24:27], v[132:135], v[40:43]
    ds_write_b128 v232, v[48:51] offset:0
    v_mfma_f32_16x16x32_bf16 v[44:47], a[28:31], v[132:135], v[44:47]
    ds_write_b128 v232, v[52:55] offset:1024
    s_waitcnt vmcnt(10)
    v_mfma_f32_16x16x32_bf16 v[32:35], a[32:35], v[136:139], v[32:35]
    s_add_u32 s58, s58, 1024
    s_cmp_eq_u32 s58, s86
    s_cselect_b32 s58, s66, s58
    v_mfma_f32_16x16x32_bf16 v[36:39], a[36:39], v[136:139], v[36:39]
    buffer_load_dwordx4 v[132:135], v23, s[24:27], s58 offen offset:0 sc1
    v_mfma_f32_16x16x32_bf16 v[40:43], a[40:43], v[136:139], v[40:43]
    ds_write_b128 v232, v[56:59] offset:2048
    v_mfma_f32_16x16x32_bf16 v[44:47], a[44:47], v[136:139], v[44:47]
    ds_write_b128 v232, v[60:63] offset:3072
    s_waitcnt vmcnt(10)
    v_mfma_f32_16x16x32_bf16 v[32:35], a[48:51], v[140:143], v[32:35]
    s_add_u32 s58, s66, 14336
    v_mfma_f32_16x16x32_bf16 v[36:39], a[52:55], v[140:143], v[36:39]
    buffer_load_dwordx4 v[136:139], v23, s[24:27], s58 offen offset:0 sc1
    v_mfma_f32_16x16x32_bf16 v[40:43], a[56:59], v[140:143], v[40:43]
    v_mfma_f32_16x16x32_bf16 v[44:47], a[60:63], v[140:143], v[44:47]
    s_waitcnt vmcnt(10)
    v_mfma_f32_16x16x32_bf16 v[32:35], a[64:67], v[144:147], v[32:35]
    s_add_u32 s58, s66, 15360
    v_mfma_f32_16x16x32_bf16 v[36:39], a[68:71], v[144:147], v[36:39]
    buffer_load_dwordx4 v[140:143], v23, s[24:27], s58 offen offset:0 sc1
    v_mfma_f32_16x16x32_bf16 v[40:43], a[72:75], v[144:147], v[40:43]
    v_mfma_f32_16x16x32_bf16 v[44:47], a[76:79], v[144:147], v[44:47]
    s_waitcnt vmcnt(10)
    v_mfma_f32_16x16x32_bf16 v[32:35], a[80:83], v[148:151], v[32:35]
    s_add_u32 m0, s52, 81920
    s_lshl_b32 s57, s76, 7
    v_mfma_f32_16x16x32_bf16 v[36:39], a[84:87], v[148:151], v[36:39]
    buffer_load_dwordx4 v12, s[20:23], s57 offen offset:0 lds
    v_mfma_f32_16x16x32_bf16 v[40:43], a[88:91], v[148:151], v[40:43]
    s_waitcnt lgkmcnt(0)
    s_barrier
    v_mfma_f32_16x16x32_bf16 v[44:47], a[92:95], v[148:151], v[44:47]
    s_waitcnt vmcnt(10)
    v_mfma_f32_16x16x32_bf16 v[32:35], a[96:99], v[152:155], v[32:35]
    s_add_u32 s57, s57, 31744
    v_mfma_f32_16x16x32_bf16 v[36:39], a[100:103], v[152:155], v[36:39]
    buffer_load_dwordx4 v12, s[20:23], s57 offen offset:1024 lds
    v_mfma_f32_16x16x32_bf16 v[40:43], a[104:107], v[152:155], v[40:43]
    ds_read_b128 v[160:163], v233 offset:0
    ds_read_b128 v[176:179], v234 offset:16384
    v_mfma_f32_16x16x32_bf16 v[44:47], a[108:111], v[152:155], v[44:47]
    ds_read_b128 v[192:195], v235 offset:32768
    s_waitcnt vmcnt(10)
    v_mfma_f32_16x16x32_bf16 v[32:35], a[112:115], v[156:159], v[32:35]
    s_add_u32 s57, s57, 31744
    v_mfma_f32_16x16x32_bf16 v[36:39], a[116:119], v[156:159], v[36:39]
    buffer_load_dwordx4 v12, s[20:23], s57 offen offset:2048 lds
    v_mfma_f32_16x16x32_bf16 v[40:43], a[120:123], v[156:159], v[40:43]
    ds_read_b128 v[164:167], v233 offset:1024
    ds_read_b128 v[180:183], v234 offset:17408
    v_mfma_f32_16x16x32_bf16 v[44:47], a[124:127], v[156:159], v[44:47]
    ds_read_b128 v[196:199], v235 offset:33792
    s_waitcnt vmcnt(10)
    v_mfma_f32_16x16x32_bf16 v[32:35], a[128:131], v[112:115], v[32:35]
    s_add_u32 s57, s57, 31744
    v_mfma_f32_16x16x32_bf16 v[36:39], a[132:135], v[112:115], v[36:39]
    buffer_load_dwordx4 v12, s[20:23], s57 offen offset:3072 lds
    v_mfma_f32_16x16x32_bf16 v[40:43], a[136:139], v[112:115], v[40:43]
    ds_read_b128 v[168:171], v233 offset:2048
    ds_read_b128 v[184:187], v234 offset:18432
    v_mfma_f32_16x16x32_bf16 v[44:47], a[140:143], v[112:115], v[44:47]
    ds_read_b128 v[200:203], v235 offset:34816
    s_waitcnt vmcnt(10)
    v_mfma_f32_16x16x32_bf16 v[32:35], a[144:147], v[116:119], v[32:35]
    s_add_u32 m0, s52, 98304
    s_lshl_b32 s57, s76, 7
    s_add_u32 s57, s57, 131072
    v_mfma_f32_16x16x32_bf16 v[36:39], a[148:151], v[116:119], v[36:39]
    buffer_load_dwordx4 v12, s[20:23], s57 offen offset:0 lds
    v_mfma_f32_16x16x32_bf16 v[40:43], a[152:155], v[116:119], v[40:43]
    ds_read_b128 v[172:175], v233 offset:3072
    ds_read_b128 v[188:191], v234 offset:19456
    v_mfma_f32_16x16x32_bf16 v[44:47], a[156:159], v[116:119], v[44:47]
    ds_read_b128 v[204:207], v235 offset:35840
    s_waitcnt vmcnt(10)
    v_mfma_f32_16x16x32_bf16 v[32:35], a[160:163], v[120:123], v[32:35]
    s_add_u32 s57, s57, 31744
    v_mfma_f32_16x16x32_bf16 v[36:39], a[164:167], v[120:123], v[36:39]
    buffer_load_dwordx4 v12, s[20:23], s57 offen offset:1024 lds
    v_mfma_f32_16x16x32_bf16 v[40:43], a[168:171], v[120:123], v[40:43]
    v_mfma_f32_16x16x32_bf16 v[44:47], a[172:175], v[120:123], v[44:47]
    s_waitcnt vmcnt(10)
    v_mfma_f32_16x16x32_bf16 v[32:35], a[176:179], v[124:127], v[32:35]
    s_add_u32 s57, s57, 31744
    s_waitcnt lgkmcnt(9)
    v_mfma_f32_16x16x32_bf16 v[36:39], a[180:183], v[124:127], v[36:39]
    buffer_load_dwordx4 v12, s[20:23], s57 offen offset:2048 lds
    v_mfma_f32_16x16x32_bf16 v[40:43], a[184:187], v[124:127], v[40:43]
    v_add_f32 v160, v160, v176
    v_add_f32 v161, v161, v177
    v_mfma_f32_16x16x32_bf16 v[44:47], a[188:191], v[124:127], v[44:47]
    v_add_f32 v162, v162, v178
    s_waitcnt vmcnt(10)
    v_mfma_f32_16x16x32_bf16 v[32:35], a[192:195], v[128:131], v[32:35]
    s_add_u32 s57, s57, 31744
    v_add_f32 v163, v163, v179
    v_mfma_f32_16x16x32_bf16 v[36:39], a[196:199], v[128:131], v[36:39]
    buffer_load_dwordx4 v12, s[20:23], s57 offen offset:3072 lds
    v_mfma_f32_16x16x32_bf16 v[40:43], a[200:203], v[128:131], v[40:43]
    s_waitcnt lgkmcnt(6)
    v_add_f32 v164, v164, v180
    v_mfma_f32_16x16x32_bf16 v[44:47], a[204:207], v[128:131], v[44:47]
    v_add_f32 v165, v165, v181
    s_waitcnt vmcnt(10)
    v_mfma_f32_16x16x32_bf16 v[32:35], a[208:211], v[132:135], v[32:35]
    s_add_u32 m0, s52, 114688
    s_lshl_b32 s57, s77, 7
    v_add_f32 v166, v166, v182
    v_mfma_f32_16x16x32_bf16 v[36:39], a[212:215], v[132:135], v[36:39]
    buffer_load_dwordx4 v12, s[20:23], s57 offen offset:0 lds
    v_mfma_f32_16x16x32_bf16 v[40:43], a[216:219], v[132:135], v[40:43]
    v_add_f32 v167, v167, v183
    s_waitcnt lgkmcnt(3)
    v_mfma_f32_16x16x32_bf16 v[44:47], a[220:223], v[132:135], v[44:47]
    v_add_f32 v168, v168, v184
    s_waitcnt vmcnt(10)
    v_mfma_f32_16x16x32_bf16 v[32:35], a[224:227], v[136:139], v[32:35]
    s_add_u32 s57, s57, 31744
    v_add_f32 v169, v169, v185
    v_mfma_f32_16x16x32_bf16 v[36:39], a[228:231], v[136:139], v[36:39]
    buffer_load_dwordx4 v12, s[20:23], s57 offen offset:1024 lds
    v_mfma_f32_16x16x32_bf16 v[40:43], a[232:235], v[136:139], v[40:43]
    v_add_f32 v170, v170, v186
    v_add_f32 v171, v171, v187
    v_mfma_f32_16x16x32_bf16 v[44:47], a[236:239], v[136:139], v[44:47]
    s_waitcnt lgkmcnt(0)
    s_waitcnt vmcnt(10)
    v_mfma_f32_16x16x32_bf16 v[32:35], a[240:243], v[140:143], v[32:35]
    s_add_u32 s57, s57, 31744
    v_add_f32 v172, v172, v188
    v_mfma_f32_16x16x32_bf16 v[36:39], a[244:247], v[140:143], v[36:39]
    buffer_load_dwordx4 v12, s[20:23], s57 offen offset:2048 lds
    v_mfma_f32_16x16x32_bf16 v[40:43], a[248:251], v[140:143], v[40:43]
    v_add_f32 v173, v173, v189
    v_add_f32 v174, v174, v190
    v_mfma_f32_16x16x32_bf16 v[44:47], a[252:255], v[140:143], v[44:47]
    v_add_f32 v175, v175, v191
    v_pk_add_f32 v[160:161], v[160:161], v[192:193]
    v_pk_add_f32 v[162:163], v[162:163], v[194:195]
    v_pk_add_f32 v[164:165], v[164:165], v[196:197]
    v_pk_add_f32 v[166:167], v[166:167], v[198:199]
    v_pk_add_f32 v[168:169], v[168:169], v[200:201]
    v_pk_add_f32 v[170:171], v[170:171], v[202:203]
    v_pk_add_f32 v[172:173], v[172:173], v[204:205]
    v_pk_add_f32 v[174:175], v[174:175], v[206:207]
    buffer_store_dwordx4 v[96:99], v23, s[24:27], s83 offen sc1
    s_add_u32 s57, s57, 31744
    buffer_load_dwordx4 v12, s[20:23], s57 offen offset:3072 lds
    v_pk_add_f32 v[32:33], v[32:33], v[160:161]
    v_pk_add_f32 v[34:35], v[34:35], v[162:163]
    v_pk_add_f32 v[36:37], v[36:37], v[164:165]
    v_pk_add_f32 v[38:39], v[38:39], v[166:167]
    v_pk_mul_f32 v[48:49], v[32:33], v[32:33]
    v_pk_mul_f32 v[50:51], v[34:35], v[34:35]
    v_pk_mul_f32 v[52:53], v[36:37], v[36:37]
    v_pk_mul_f32 v[54:55], v[38:39], v[38:39]
    s_add_u32 m0, s52, 131072
    s_lshl_b32 s57, s77, 7
    s_add_u32 s57, s57, 131072
    buffer_load_dwordx4 v12, s[20:23], s57 offen offset:0 lds
    v_pk_fma_f32 v[48:49], v[48:49], v[236:237], v[236:237] op_sel:[0,0,1] op_sel_hi:[1,0,1]
    v_pk_fma_f32 v[50:51], v[50:51], v[236:237], v[236:237] op_sel:[0,0,1] op_sel_hi:[1,0,1]
    v_pk_fma_f32 v[52:53], v[52:53], v[236:237], v[236:237] op_sel:[0,0,1] op_sel_hi:[1,0,1]
    v_pk_fma_f32 v[54:55], v[54:55], v[236:237], v[236:237] op_sel:[0,0,1] op_sel_hi:[1,0,1]
    v_pk_mul_f32 v[48:49], v[48:49], v[32:33]
    v_pk_mul_f32 v[50:51], v[50:51], v[34:35]
    v_pk_mul_f32 v[52:53], v[52:53], v[36:37]
    v_pk_mul_f32 v[54:55], v[54:55], v[38:39]
    s_add_u32 s57, s57, 31744
    buffer_load_dwordx4 v12, s[20:23], s57 offen offset:1024 lds
    s_waitcnt vmcnt(11)
    ds_read_b64_tr_b16 a[0:1], v6 offset:32768
    ds_read_b64_tr_b16 a[2:3], v6 offset:34816
    ds_read_b64_tr_b16 a[4:5], v7 offset:32768
    ds_read_b64_tr_b16 a[6:7], v7 offset:34816
    v_exp_f32 v48, v48
    v_exp_f32 v49, v49
    v_exp_f32 v50, v50
    v_exp_f32 v51, v51
    ds_read_b64_tr_b16 a[8:9], v6 offset:33024
    ds_read_b64_tr_b16 a[10:11], v6 offset:35072
    ds_read_b64_tr_b16 a[12:13], v7 offset:33024
    ds_read_b64_tr_b16 a[14:15], v7 offset:35072
    s_add_u32 s57, s57, 31744
    buffer_load_dwordx4 v12, s[20:23], s57 offen offset:2048 lds
    v_exp_f32 v52, v52
    v_exp_f32 v53, v53
    v_exp_f32 v54, v54
    v_exp_f32 v55, v55
    v_pk_add_f32 v[48:49], v[48:49], 1.0 op_sel_hi:[1,0]
    v_pk_add_f32 v[50:51], v[50:51], 1.0 op_sel_hi:[1,0]
    v_pk_add_f32 v[52:53], v[52:53], 1.0 op_sel_hi:[1,0]
    v_pk_add_f32 v[54:55], v[54:55], 1.0 op_sel_hi:[1,0]
    s_add_u32 s57, s57, 31744
    buffer_load_dwordx4 v12, s[20:23], s57 offen offset:3072 lds
    v_rcp_f32 v48, v48
    v_rcp_f32 v49, v49
    v_rcp_f32 v50, v50
    v_rcp_f32 v51, v51
    v_rcp_f32 v52, v52
    v_rcp_f32 v53, v53
    v_rcp_f32 v54, v54
    v_rcp_f32 v55, v55
    v_pk_mul_f32 v[48:49], v[48:49], v[32:33]
    v_pk_mul_f32 v[50:51], v[50:51], v[34:35]
    v_pk_mul_f32 v[52:53], v[52:53], v[36:37]
    v_pk_mul_f32 v[54:55], v[54:55], v[38:39]
    s_add_u32 m0, s52, 147456
    s_lshl_b32 s57, s78, 7
    buffer_load_dwordx4 v12, s[20:23], s57 offen offset:0 lds
    v_cvt_pk_bf16_f32 v56, v48, v49
    v_cvt_pk_bf16_f32 v57, v50, v51
    v_cvt_pk_bf16_f32 v58, v52, v53
    v_cvt_pk_bf16_f32 v59, v54, v55
    buffer_store_dwordx4 v[56:59], v23, s[24:27], s67 offen offset:0 sc1
    v_pk_add_f32 v[40:41], v[40:41], v[168:169]
    v_pk_add_f32 v[42:43], v[42:43], v[170:171]
    v_pk_add_f32 v[44:45], v[44:45], v[172:173]
    v_pk_add_f32 v[46:47], v[46:47], v[174:175]
    s_add_u32 s57, s57, 31744
    buffer_load_dwordx4 v12, s[20:23], s57 offen offset:1024 lds
    s_waitcnt vmcnt(12)
    ds_read_b64_tr_b16 a[16:17], v6 offset:49152
    ds_read_b64_tr_b16 a[18:19], v6 offset:51200
    ds_read_b64_tr_b16 a[20:21], v7 offset:49152
    ds_read_b64_tr_b16 a[22:23], v7 offset:51200
    v_pk_mul_f32 v[48:49], v[40:41], v[40:41]
    v_pk_mul_f32 v[50:51], v[42:43], v[42:43]
    v_pk_mul_f32 v[52:53], v[44:45], v[44:45]
    v_pk_mul_f32 v[54:55], v[46:47], v[46:47]
    ds_read_b64_tr_b16 a[24:25], v6 offset:49408
    ds_read_b64_tr_b16 a[26:27], v6 offset:51456
    ds_read_b64_tr_b16 a[28:29], v7 offset:49408
    ds_read_b64_tr_b16 a[30:31], v7 offset:51456
    s_add_u32 s57, s57, 31744
    buffer_load_dwordx4 v12, s[20:23], s57 offen offset:2048 lds
    v_pk_fma_f32 v[48:49], v[48:49], v[236:237], v[236:237] op_sel:[0,0,1] op_sel_hi:[1,0,1]
    v_pk_fma_f32 v[50:51], v[50:51], v[236:237], v[236:237] op_sel:[0,0,1] op_sel_hi:[1,0,1]
    v_pk_fma_f32 v[52:53], v[52:53], v[236:237], v[236:237] op_sel:[0,0,1] op_sel_hi:[1,0,1]
    v_pk_fma_f32 v[54:55], v[54:55], v[236:237], v[236:237] op_sel:[0,0,1] op_sel_hi:[1,0,1]
    v_pk_mul_f32 v[48:49], v[48:49], v[40:41]
    v_pk_mul_f32 v[50:51], v[50:51], v[42:43]
    v_pk_mul_f32 v[52:53], v[52:53], v[44:45]
    v_pk_mul_f32 v[54:55], v[54:55], v[46:47]
    s_add_u32 s57, s57, 31744
    buffer_load_dwordx4 v12, s[20:23], s57 offen offset:3072 lds
    v_exp_f32 v48, v48
    v_exp_f32 v49, v49
    v_exp_f32 v50, v50
    v_exp_f32 v51, v51
    v_exp_f32 v52, v52
    v_exp_f32 v53, v53
    v_exp_f32 v54, v54
    v_exp_f32 v55, v55
    v_pk_add_f32 v[48:49], v[48:49], 1.0 op_sel_hi:[1,0]
    v_pk_add_f32 v[50:51], v[50:51], 1.0 op_sel_hi:[1,0]
    v_pk_add_f32 v[52:53], v[52:53], 1.0 op_sel_hi:[1,0]
    v_pk_add_f32 v[54:55], v[54:55], 1.0 op_sel_hi:[1,0]
    s_add_u32 m0, s52, 49152
    s_lshl_b32 s57, s78, 7
    s_add_u32 s57, s57, 131072
    buffer_load_dwordx4 v12, s[20:23], s57 offen offset:0 lds
    v_rcp_f32 v48, v48
    v_rcp_f32 v49, v49
    v_rcp_f32 v50, v50
    v_rcp_f32 v51, v51
    v_rcp_f32 v52, v52
    v_rcp_f32 v53, v53
    v_rcp_f32 v54, v54
    v_rcp_f32 v55, v55
    s_add_u32 s57, s57, 31744
    buffer_load_dwordx4 v12, s[20:23], s57 offen offset:1024 lds
    s_waitcnt vmcnt(11)
    ds_read_b64_tr_b16 a[32:33], v8 offset:0
    ds_read_b64_tr_b16 a[34:35], v8 offset:2048
    ds_read_b64_tr_b16 a[36:37], v9 offset:0
    ds_read_b64_tr_b16 a[38:39], v9 offset:2048
    v_pk_mul_f32 v[48:49], v[48:49], v[40:41]
    v_pk_mul_f32 v[50:51], v[50:51], v[42:43]
    v_pk_mul_f32 v[52:53], v[52:53], v[44:45]
    v_pk_mul_f32 v[54:55], v[54:55], v[46:47]
    ds_read_b64_tr_b16 a[40:41], v8 offset:256
    ds_read_b64_tr_b16 a[42:43], v8 offset:2304
    ds_read_b64_tr_b16 a[44:45], v9 offset:256
    ds_read_b64_tr_b16 a[46:47], v9 offset:2304
    s_add_u32 s57, s57, 31744
    buffer_load_dwordx4 v12, s[20:23], s57 offen offset:2048 lds
    v_cvt_pk_bf16_f32 v60, v48, v49
    v_cvt_pk_bf16_f32 v61, v50, v51
    v_cvt_pk_bf16_f32 v62, v52, v53
    v_cvt_pk_bf16_f32 v63, v54, v55
    buffer_store_dwordx4 v[60:63], v23, s[24:27], s67 offen offset:1024 sc1
    s_add_u32 s57, s57, 31744
    buffer_load_dwordx4 v12, s[20:23], s57 offen offset:3072 lds
    s_add_u32 m0, s52, 65536
    s_lshl_b32 s57, s79, 7
    buffer_load_dwordx4 v12, s[20:23], s57 offen offset:0 lds
    s_add_u32 s57, s57, 31744
    buffer_load_dwordx4 v12, s[20:23], s57 offen offset:1024 lds
    s_waitcnt vmcnt(12)
    ds_read_b64_tr_b16 a[48:49], v8 offset:16384
    ds_read_b64_tr_b16 a[50:51], v8 offset:18432
    ds_read_b64_tr_b16 a[52:53], v9 offset:16384
    ds_read_b64_tr_b16 a[54:55], v9 offset:18432
    s_add_u32 s57, s57, 31744
    buffer_load_dwordx4 v12, s[20:23], s57 offen offset:2048 lds
    ds_read_b64_tr_b16 a[56:57], v8 offset:16640
    ds_read_b64_tr_b16 a[58:59], v8 offset:18688
    ds_read_b64_tr_b16 a[60:61], v9 offset:16640
    ds_read_b64_tr_b16 a[62:63], v9 offset:18688
    s_add_u32 s57, s57, 31744
    buffer_load_dwordx4 v12, s[20:23], s57 offen offset:3072 lds
    s_waitcnt lgkmcnt(15)
    s_add_u32 m0, s52, 81920
    s_lshl_b32 s57, s79, 7
    s_add_u32 s57, s57, 131072
    buffer_load_dwordx4 v12, s[20:23], s57 offen offset:0 lds
    s_add_u32 s57, s57, 31744
    buffer_load_dwordx4 v12, s[20:23], s57 offen offset:1024 lds
    s_waitcnt vmcnt(11)
    ds_read_b64_tr_b16 a[64:65], v8 offset:32768
    ds_read_b64_tr_b16 a[66:67], v8 offset:34816
    ds_read_b64_tr_b16 a[68:69], v9 offset:32768
    ds_read_b64_tr_b16 a[70:71], v9 offset:34816
    s_add_u32 s57, s57, 31744
    buffer_load_dwordx4 v12, s[20:23], s57 offen offset:2048 lds
    ds_read_b64_tr_b16 a[72:73], v8 offset:33024
    ds_read_b64_tr_b16 a[74:75], v8 offset:35072
    ds_read_b64_tr_b16 a[76:77], v9 offset:33024
    ds_read_b64_tr_b16 a[78:79], v9 offset:35072
    s_add_u32 s57, s57, 31744
    buffer_load_dwordx4 v12, s[20:23], s57 offen offset:3072 lds
    s_add_u32 m0, s52, 98304
    s_lshl_b32 s57, s80, 7
    buffer_load_dwordx4 v12, s[20:23], s57 offen offset:0 lds
    s_add_u32 s57, s57, 31744
    buffer_load_dwordx4 v12, s[20:23], s57 offen offset:1024 lds
    s_waitcnt vmcnt(10)
    ds_read_b64_tr_b16 a[80:81], v6 offset:0
    ds_read_b64_tr_b16 a[82:83], v6 offset:2048
    ds_read_b64_tr_b16 a[84:85], v7 offset:0
    ds_read_b64_tr_b16 a[86:87], v7 offset:2048
    s_add_u32 s57, s57, 31744
    buffer_load_dwordx4 v12, s[20:23], s57 offen offset:2048 lds
    ds_read_b64_tr_b16 a[88:89], v6 offset:256
    ds_read_b64_tr_b16 a[90:91], v6 offset:2304
    ds_read_b64_tr_b16 a[92:93], v7 offset:256
    ds_read_b64_tr_b16 a[94:95], v7 offset:2304
    s_barrier
    s_cmp_lg_u32 s44, 0
    s_cbranch_scc1 L_nopub6
    s_lshl_b32 s60, s51, 5
    s_add_u32 s60, s60, s50
    s_lshl_b32 s60, s60, 7
    s_add_u32 s60, s60, 12713984
    v_mov_b32 v30, s47
    s_mov_b64 exec, 1
    buffer_store_dword v30, off, s[24:27], s60 sc1
    v_mov_b32 v29, 0
    s_lshl_b32 s60, s2, 8
    buffer_store_dword v29, off, s[40:43], s60 sc1
    s_mov_b64 exec, -1
L_nopub6:
L_p3join:
    s_add_u32 s57, s57, 31744
    buffer_load_dwordx4 v12, s[20:23], s57 offen offset:3072 lds
    v_lshlrev_b32 v228, 16, v228
    v_lshlrev_b32 v32, 16, v216
    v_and_b32 v33, s61, v216
    v_lshlrev_b32 v34, 16, v217
    s_waitcnt lgkmcnt(15)
    s_add_u32 m0, s52, 114688
    s_lshl_b32 s57, s80, 7
    s_add_u32 s57, s57, 131072
    buffer_load_dwordx4 v12, s[20:23], s57 offen offset:0 lds
    v_and_b32 v35, s61, v217
    v_add_f32 v32, v32, v228
    v_add_f32 v33, v33, v228
    v_add_f32 v34, v34, v228
    s_add_u32 s57, s57, 31744
    buffer_load_dwordx4 v12, s[20:23], s57 offen offset:1024 lds
    s_waitcnt vmcnt(10)
    ds_read_b64_tr_b16 a[96:97], v6 offset:16384
    ds_read_b64_tr_b16 a[98:99], v6 offset:18432
    ds_read_b64_tr_b16 a[100:101], v7 offset:16384
    ds_read_b64_tr_b16 a[102:103], v7 offset:18432
    v_add_f32 v35, v35, v228
    v_lshlrev_b32 v48, 16, v218
    v_and_b32 v49, s61, v218
    v_lshlrev_b32 v50, 16, v219
    ds_read_b64_tr_b16 a[104:105], v6 offset:16640
    ds_read_b64_tr_b16 a[106:107], v6 offset:18688
    ds_read_b64_tr_b16 a[108:109], v7 offset:16640
    ds_read_b64_tr_b16 a[110:111], v7 offset:18688
    s_add_u32 s57, s57, 31744
    buffer_load_dwordx4 v12, s[20:23], s57 offen offset:2048 lds
    v_and_b32 v51, s61, v219
    v_add_f32 v48, v48, v228
    v_add_f32 v49, v49, v228
    v_add_f32 v50, v50, v228
    s_add_u32 s57, s57, 31744
    buffer_load_dwordx4 v12, s[20:23], s57 offen offset:3072 lds
    v_add_f32 v51, v51, v228
    v_lshlrev_b32 v64, 16, v220
    v_and_b32 v65, s61, v220
    v_lshlrev_b32 v66, 16, v221
    s_add_u32 m0, s52, 131072
    s_lshl_b32 s57, s81, 7
    buffer_load_dwordx4 v12, s[20:23], s57 offen offset:0 lds
    v_and_b32 v67, s61, v221
    v_add_f32 v64, v64, v228
    v_add_f32 v65, v65, v228
    v_add_f32 v66, v66, v228
    v_add_f32 v67, v67, v228
    v_lshlrev_b32 v80, 16, v222
    v_and_b32 v81, s61, v222
    v_lshlrev_b32 v82, 16, v223
    s_add_u32 s57, s57, 31744
    buffer_load_dwordx4 v12, s[20:23], s57 offen offset:1024 lds
    s_waitcnt vmcnt(10)
    ds_read_b64_tr_b16 a[112:113], v6 offset:32768
    ds_read_b64_tr_b16 a[114:115], v6 offset:34816
    ds_read_b64_tr_b16 a[116:117], v7 offset:32768
    ds_read_b64_tr_b16 a[118:119], v7 offset:34816
    s_add_u32 s57, s57, 31744
    buffer_load_dwordx4 v12, s[20:23], s57 offen offset:2048 lds
    ds_read_b64_tr_b16 a[120:121], v6 offset:33024
    ds_read_b64_tr_b16 a[122:123], v6 offset:35072
    ds_read_b64_tr_b16 a[124:125], v7 offset:33024
    ds_read_b64_tr_b16 a[126:127], v7 offset:35072
    s_add_u32 s57, s57, 31744
    buffer_load_dwordx4 v12, s[20:23], s57 offen offset:3072 lds
    v_and_b32 v83, s61, v223
    v_add_f32 v80, v80, v228
    v_add_f32 v81, v81, v228
    v_add_f32 v82, v82, v228
    v_add_f32 v83, v83, v228
    v_lshlrev_b32 v96, 16, v224
    v_and_b32 v97, s61, v224
    v_lshlrev_b32 v98, 16, v225
    s_waitcnt lgkmcnt(15)
    s_add_u32 m0, s52, 147456
    s_lshl_b32 s57, s81, 7
    s_add_u32 s57, s57, 131072
    buffer_load_dwordx4 v12, s[20:23], s57 offen offset:0 lds
    v_and_b32 v99, s61, v225
    v_add_f32 v96, v96, v228
    v_add_f32 v97, v97, v228
    v_add_f32 v98, v98, v228
    s_add_u32 s57, s57, 31744
    buffer_load_dwordx4 v12, s[20:23], s57 offen offset:1024 lds
    s_waitcnt vmcnt(10)
    ds_read_b64_tr_b16 a[128:129], v6 offset:49152
    ds_read_b64_tr_b16 a[130:131], v6 offset:51200
    ds_read_b64_tr_b16 a[132:133], v7 offset:49152
    ds_read_b64_tr_b16 a[134:135], v7 offset:51200
    s_add_u32 s57, s57, 31744
    buffer_load_dwordx4 v12, s[20:23], s57 offen offset:2048 lds
    ds_read_b64_tr_b16 a[136:137], v6 offset:49408
    ds_read_b64_tr_b16 a[138:139], v6 offset:51456
    ds_read_b64_tr_b16 a[140:141], v7 offset:49408
    ds_read_b64_tr_b16 a[142:143], v7 offset:51456
    v_add_f32 v99, v99, v228
    s_add_u32 s57, s57, 31744
    buffer_load_dwordx4 v12, s[20:23], s57 offen offset:3072 lds
    s_add_u32 m0, s52, 49152
    s_lshl_b32 s57, s82, 7
    buffer_load_dwordx4 v12, s[20:23], s57 offen offset:0 lds
    s_add_u32 s57, s57, 31744
    buffer_load_dwordx4 v12, s[20:23], s57 offen offset:1024 lds
    s_waitcnt vmcnt(10)
    ds_read_b64_tr_b16 a[144:145], v8 offset:0
    ds_read_b64_tr_b16 a[146:147], v8 offset:2048
    ds_read_b64_tr_b16 a[148:149], v9 offset:0
    ds_read_b64_tr_b16 a[150:151], v9 offset:2048
    s_add_u32 s57, s57, 31744
    buffer_load_dwordx4 v12, s[20:23], s57 offen offset:2048 lds
    ds_read_b64_tr_b16 a[152:153], v8 offset:256
    ds_read_b64_tr_b16 a[154:155], v8 offset:2304
    ds_read_b64_tr_b16 a[156:157], v9 offset:256
    ds_read_b64_tr_b16 a[158:159], v9 offset:2304
    s_add_u32 s57, s57, 31744
    buffer_load_dwordx4 v12, s[20:23], s57 offen offset:3072 lds
    s_waitcnt lgkmcnt(15)
    s_add_u32 m0, s52, 65536
    s_lshl_b32 s57, s82, 7
    s_add_u32 s57, s57, 131072
    buffer_load_dwordx4 v12, s[20:23], s57 offen offset:0 lds
    s_add_u32 s57, s57, 31744
    buffer_load_dwordx4 v12, s[20:23], s57 offen offset:1024 lds
    s_waitcnt vmcnt(10)
    ds_read_b64_tr_b16 a[160:161], v8 offset:16384
    ds_read_b64_tr_b16 a[162:163], v8 offset:18432
    ds_read_b64_tr_b16 a[164:165], v9 offset:16384
    ds_read_b64_tr_b16 a[166:167], v9 offset:18432
    s_add_u32 s57, s57, 31744
    buffer_load_dwordx4 v12, s[20:23], s57 offen offset:2048 lds
    ds_read_b64_tr_b16 a[168:169], v8 offset:16640
    ds_read_b64_tr_b16 a[170:171], v8 offset:18688
    ds_read_b64_tr_b16 a[172:173], v9 offset:16640
    ds_read_b64_tr_b16 a[174:175], v9 offset:18688
    s_add_u32 s57, s57, 31744
    buffer_load_dwordx4 v12, s[20:23], s57 offen offset:3072 lds
    s_add_u32 m0, s52, 81920
    s_mov_b32 s57, s75
    buffer_load_dwordx4 v15, s[12:15], s57 offen offset:0 lds
    s_add_u32 s57, s57, 113664
    buffer_load_dwordx4 v15, s[12:15], s57 offen offset:1024 lds
    s_waitcnt vmcnt(10)
    ds_read_b64_tr_b16 a[176:177], v8 offset:32768
    ds_read_b64_tr_b16 a[178:179], v8 offset:34816
    ds_read_b64_tr_b16 a[180:181], v9 offset:32768
    ds_read_b64_tr_b16 a[182:183], v9 offset:34816
    s_add_u32 s57, s57, 113664
    buffer_load_dwordx4 v15, s[12:15], s57 offen offset:2048 lds
    ds_read_b64_tr_b16 a[184:185], v8 offset:33024
    ds_read_b64_tr_b16 a[186:187], v8 offset:35072
    ds_read_b64_tr_b16 a[188:189], v9 offset:33024
    ds_read_b64_tr_b16 a[190:191], v9 offset:35072
    s_add_u32 s57, s57, 113664
    buffer_load_dwordx4 v15, s[12:15], s57 offen offset:3072 lds
    s_waitcnt lgkmcnt(15)
    s_add_u32 m0, s52, 98304
    s_mov_b32 s57, 0
    buffer_load_dwordx4 v13, s[12:15], s57 offen offset:0 lds
    s_add_u32 s57, s57, 6144
    buffer_load_dwordx4 v14, s[12:15], s57 offen offset:1024 lds
    s_waitcnt vmcnt(10)
    ds_read_b64_tr_b16 a[192:193], v6 offset:0
    ds_read_b64_tr_b16 a[194:195], v6 offset:2048
    ds_read_b64_tr_b16 a[196:197], v7 offset:0
    ds_read_b64_tr_b16 a[198:199], v7 offset:2048
    s_add_u32 s57, s57, 6144
    buffer_load_dwordx4 v13, s[12:15], s57 offen offset:2048 lds
    ds_read_b64_tr_b16 a[200:201], v6 offset:256
    ds_read_b64_tr_b16 a[202:203], v6 offset:2304
    ds_read_b64_tr_b16 a[204:205], v7 offset:256
    ds_read_b64_tr_b16 a[206:207], v7 offset:2304
    s_add_u32 s57, s57, 6144
    buffer_load_dwordx4 v14, s[12:15], s57 offen offset:3072 lds
    buffer_load_dword v17, v20, s[24:27], 0 offen sc1
    s_add_u32 m0, s52, 114688
    s_mov_b32 s57, 114688
L_wb_2:
    s_cbranch_execz L_wb_ret
    buffer_load_dwordx4 v13, s[12:15], s57 offen offset:0 lds
    s_waitcnt vmcnt(10)
    ds_read_b64_tr_b16 a[208:209], v6 offset:16384
    ds_read_b64_tr_b16 a[210:211], v6 offset:18432
    ds_read_b64_tr_b16 a[212:213], v7 offset:16384
    ds_read_b64_tr_b16 a[214:215], v7 offset:18432
    s_add_u32 s57, s57, 6144
    buffer_load_dwordx4 v14, s[12:15], s57 offen offset:1024 lds
    ds_read_b64_tr_b16 a[216:217], v6 offset:16640
    ds_read_b64_tr_b16 a[218:219], v6 offset:18688
    ds_read_b64_tr_b16 a[220:221], v7 offset:16640
    ds_read_b64_tr_b16 a[222:223], v7 offset:18688
    s_add_u32 s57, s57, 6144
    buffer_load_dwordx4 v13, s[12:15], s57 offen offset:2048 lds
    s_add_u32 s57, s57, 6144
    buffer_load_dwordx4 v14, s[12:15], s57 offen offset:3072 lds
    s_waitcnt lgkmcnt(15)
    s_add_u32 m0, s52, 131072
    s_mov_b32 s57, 229376
    buffer_load_dwordx4 v13, s[12:15], s57 offen offset:0 lds
    s_add_u32 s57, s57, 6144
    buffer_load_dwordx4 v14, s[12:15], s57 offen offset:1024 lds
    s_add_u32 s57, s57, 6144
    buffer_load_dwordx4 v13, s[12:15], s57 offen offset:2048 lds
    s_add_u32 s57, s57, 6144
    buffer_load_dwordx4 v14, s[12:15], s57 offen offset:3072 lds
    s_add_u32 m0, s52, 147456
    s_mov_b32 s57, 344064
    buffer_load_dwordx4 v239, s[12:15], s57 offen offset:0 lds
    s_add_u32 s57, s57, 27648
    buffer_load_dwordx4 v239, s[12:15], s57 offen offset:1024 lds
    s_waitcnt vmcnt(10)
    v_cmp_ne_u32 vcc, s47, v17
    s_nop 0
    s_cbranch_vccz L_ok8
    s_mov_b32 s59, 100000
L_spin7:
    buffer_load_dword v17, v20, s[24:27], 0 offen sc1
    s_waitcnt vmcnt(0)
    v_cmp_ne_u32 vcc, s47, v17
    s_nop 0
    s_cbranch_vccz L_ok8
    s_sub_u32 s59, s59, 1
    s_cbranch_scc0 L_spin7
L_ok8:
    s_cmp_ge_u32 s89, 4
    s_cbranch_scc1 L_p3_alt
    s_mov_b32 s66, s68
    s_add_u32 s58, s66, s76
    buffer_load_dwordx4 v[144:147], v23, s[24:27], s58 offen offset:0 sc1
    buffer_load_dwordx4 v[148:151], v23, s[24:27], s58 offen offset:1024 sc1
    s_add_u32 s58, s66, s77
    buffer_load_dwordx4 v[152:155], v23, s[24:27], s58 offen offset:0 sc1
    buffer_load_dwordx4 v[156:159], v23, s[24:27], s58 offen offset:1024 sc1
    s_add_u32 s58, s66, s78
    buffer_load_dwordx4 v[112:115], v23, s[24:27], s58 offen offset:0 sc1
    buffer_load_dwordx4 v[116:119], v23, s[24:27], s58 offen offset:1024 sc1
    s_add_u32 s58, s66, s79
    buffer_load_dwordx4 v[120:123], v23, s[24:27], s58 offen offset:0 sc1
    buffer_load_dwordx4 v[124:127], v23, s[24:27], s58 offen offset:1024 sc1
    s_add_u32 s58, s66, s80
    buffer_load_dwordx4 v[128:131], v23, s[24:27], s58 offen offset:0 sc1
    buffer_load_dwordx4 v[132:135], v23, s[24:27], s58 offen offset:1024 sc1
    s_add_u32 s58, s66, s81
    buffer_load_dwordx4 v[136:139], v23, s[24:27], s58 offen offset:0 sc1
    s_waitcnt vmcnt(10)
    v_mfma_f32_16x16x32_bf16 v[96:99], v[144:147], a[0:3], v[96:99]
    v_mfma_f32_16x16x32_bf16 v[100:103], v[144:147], a[4:7], 0
    buffer_load_dwordx4 v[140:143], v23, s[24:27], s58 offen offset:1024 sc1
    v_mfma_f32_16x16x32_bf16 v[104:107], v[144:147], a[8:11], 0
    v_mfma_f32_16x16x32_bf16 v[108:111], v[144:147], a[12:15], 0
    s_waitcnt vmcnt(10)
    v_mfma_f32_16x16x32_bf16 v[96:99], v[148:151], a[16:19], v[96:99]
    s_add_u32 s58, s66, s82
    v_mfma_f32_16x16x32_bf16 v[100:103], v[148:151], a[20:23], v[100:103]
    buffer_load_dwordx4 v[144:147], v23, s[24:27], s58 offen offset:0 sc1
    v_mfma_f32_16x16x32_bf16 v[104:107], v[148:151], a[24:27], v[104:107]
    v_mfma_f32_16x16x32_bf16 v[108:111], v[148:151], a[28:31], v[108:111]
    s_waitcnt vmcnt(10)
    v_mfma_f32_16x16x32_bf16 v[96:99], v[152:155], a[32:35], v[96:99]
    v_mfma_f32_16x16x32_bf16 v[100:103], v[152:155], a[36:39], v[100:103]
    buffer_load_dwordx4 v[148:151], v23, s[24:27], s58 offen offset:1024 sc1
    v_mfma_f32_16x16x32_bf16 v[104:107], v[152:155], a[40:43], v[104:107]
    v_mfma_f32_16x16x32_bf16 v[108:111], v[152:155], a[44:47], v[108:111]
    s_waitcnt vmcnt(10)
    v_mfma_f32_16x16x32_bf16 v[96:99], v[156:159], a[48:51], v[96:99]
    s_add_u32 s66, s69, 175872
    s_add_u32 s58, s66, s76
    v_mfma_f32_16x16x32_bf16 v[100:103], v[156:159], a[52:55], v[100:103]
    buffer_load_dwordx4 v[152:155], v23, s[24:27], s58 offen offset:0 sc1
    v_mfma_f32_16x16x32_bf16 v[104:107], v[156:159], a[56:59], v[104:107]
    v_mfma_f32_16x16x32_bf16 v[108:111], v[156:159], a[60:63], v[108:111]
    s_waitcnt vmcnt(10)
    v_mfma_f32_16x16x32_bf16 v[96:99], v[112:115], a[64:67], v[96:99]
    v_mfma_f32_16x16x32_bf16 v[100:103], v[112:115], a[68:71], v[100:103]
    buffer_load_dwordx4 v[156:159], v23, s[24:27], s58 offen offset:1024 sc1
    v_mfma_f32_16x16x32_bf16 v[104:107], v[112:115], a[72:75], v[104:107]
    v_mfma_f32_16x16x32_bf16 v[108:111], v[112:115], a[76:79], v[108:111]
    s_waitcnt vmcnt(10)
    v_mfma_f32_16x16x32_bf16 v[96:99], v[116:119], a[80:83], v[96:99]
    s_add_u32 s58, s66, s77
    v_mfma_f32_16x16x32_bf16 v[100:103], v[116:119], a[84:87], v[100:103]
    buffer_load_dwordx4 v[112:115], v23, s[24:27], s58 offen offset:0 sc1
    v_mfma_f32_16x16x32_bf16 v[104:107], v[116:119], a[88:91], v[104:107]
    v_mfma_f32_16x16x32_bf16 v[108:111], v[116:119], a[92:95], v[108:111]
    s_waitcnt vmcnt(10)
    v_mfma_f32_16x16x32_bf16 v[96:99], v[120:123], a[96:99], v[96:99]
    v_mfma_f32_16x16x32_bf16 v[100:103], v[120:123], a[100:103], v[100:103]
    buffer_load_dwordx4 v[116:119], v23, s[24:27], s58 offen offset:1024 sc1
    v_mfma_f32_16x16x32_bf16 v[104:107], v[120:123], a[104:107], v[104:107]
    v_mfma_f32_16x16x32_bf16 v[108:111], v[120:123], a[108:111], v[108:111]
    s_waitcnt vmcnt(10)
    v_mfma_f32_16x16x32_bf16 v[96:99], v[124:127], a[112:115], v[96:99]
    s_add_u32 s58, s66, s78
    v_mfma_f32_16x16x32_bf16 v[100:103], v[124:127], a[116:119], v[100:103]
    buffer_load_dwordx4 v[120:123], v23, s[24:27], s58 offen offset:0 sc1
    v_mfma_f32_16x16x32_bf16 v[104:107], v[124:127], a[120:123], v[104:107]
    v_mfma_f32_16x16x32_bf16 v[108:111], v[124:127], a[124:127], v[108:111]
    s_waitcnt vmcnt(10)
    v_mfma_f32_16x16x32_bf16 v[96:99], v[128:131], a[128:131], v[96:99]
    v_mfma_f32_16x16x32_bf16 v[100:103], v[128:131], a[132:135], v[100:103]
    buffer_load_dwordx4 v[124:127], v23, s[24:27], s58 offen offset:1024 sc1
    v_mfma_f32_16x16x32_bf16 v[104:107], v[128:131], a[136:139], v[104:107]
    v_mfma_f32_16x16x32_bf16 v[108:111], v[128:131], a[140:143], v[108:111]
    s_waitcnt vmcnt(10)
    v_mfma_f32_16x16x32_bf16 v[96:99], v[132:135], a[144:147], v[96:99]
    s_add_u32 s58, s66, s79
    v_mfma_f32_16x16x32_bf16 v[100:103], v[132:135], a[148:151], v[100:103]
    buffer_load_dwordx4 v[128:131], v23, s[24:27], s58 offen offset:0 sc1
    v_mfma_f32_16x16x32_bf16 v[104:107], v[132:135], a[152:155], v[104:107]
    v_mfma_f32_16x16x32_bf16 v[108:111], v[132:135], a[156:159], v[108:111]
    s_waitcnt vmcnt(10)
    v_mfma_f32_16x16x32_bf16 v[96:99], v[136:139], a[160:163], v[96:99]
    v_mfma_f32_16x16x32_bf16 v[100:103], v[136:139], a[164:167], v[100:103]
    buffer_load_dwordx4 v[132:135], v23, s[24:27], s58 offen offset:1024 sc1
    v_mfma_f32_16x16x32_bf16 v[104:107], v[136:139], a[168:171], v[104:107]
    v_mfma_f32_16x16x32_bf16 v[108:111], v[136:139], a[172:175], v[108:111]
    s_waitcnt vmcnt(10)
    v_mfma_f32_16x16x32_bf16 v[96:99], v[140:143], a[176:179], v[96:99]
    s_add_u32 s58, s66, s80
    v_mfma_f32_16x16x32_bf16 v[100:103], v[140:143], a[180:183], v[100:103]
    buffer_load_dwordx4 v[136:139], v23, s[24:27], s58 offen offset:0 sc1
    v_mfma_f32_16x16x32_bf16 v[104:107], v[140:143], a[184:187], v[104:107]
    v_mfma_f32_16x16x32_bf16 v[108:111], v[140:143], a[188:191], v[108:111]
    s_waitcnt vmcnt(10)
    s_waitcnt lgkmcnt(8)
    v_mfma_f32_16x16x32_bf16 v[96:99], v[144:147], a[192:195], v[96:99]
    v_mfma_f32_16x16x32_bf16 v[100:103], v[144:147], a[196:199], v[100:103]
    buffer_load_dwordx4 v[140:143], v23, s[24:27], s58 offen offset:1024 sc1
    v_mfma_f32_16x16x32_bf16 v[104:107], v[144:147], a[200:203], v[104:107]
    v_mfma_f32_16x16x32_bf16 v[108:111], v[144:147], a[204:207], v[108:111]
    s_waitcnt vmcnt(10)
    s_waitcnt lgkmcnt(0)
    v_mfma_f32_16x16x32_bf16 v[96:99], v[148:151], a[208:211], v[96:99]
    s_add_u32 s58, s66, s81
    v_mfma_f32_16x16x32_bf16 v[100:103], v[148:151], a[212:215], v[100:103]
    buffer_load_dwordx4 v[144:147], v23, s[24:27], s58 offen offset:0 sc1
    v_mfma_f32_16x16x32_bf16 v[104:107], v[148:151], a[216:219], v[104:107]
    v_mfma_f32_16x16x32_bf16 v[108:111], v[148:151], a[220:223], v[108:111]
L_p3_join:
    s_waitcnt vmcnt(10)
    v_mfma_f32_16x16x32_bf16 v[80:83], v[152:155], a[0:3], v[80:83]
    v_mfma_f32_16x16x32_bf16 v[84:87], v[152:155], a[4:7], 0
    buffer_load_dwordx4 v[148:151], v23, s[24:27], s58 offen offset:1024 sc1
    v_mfma_f32_16x16x32_bf16 v[88:91], v[152:155], a[8:11], 0
    v_mfma_f32_16x16x32_bf16 v[92:95], v[152:155], a[12:15], 0
    s_waitcnt vmcnt(10)
    v_mfma_f32_16x16x32_bf16 v[80:83], v[156:159], a[16:19], v[80:83]
    s_add_u32 s58, s66, s82
    v_mfma_f32_16x16x32_bf16 v[84:87], v[156:159], a[20:23], v[84:87]
    buffer_load_dwordx4 v[152:155], v23, s[24:27], s58 offen offset:0 sc1
    v_mfma_f32_16x16x32_bf16 v[88:91], v[156:159], a[24:27], v[88:91]
    ds_write_b128 v232, v[100:103] offset:3072
    v_mfma_f32_16x16x32_bf16 v[92:95], v[156:159], a[28:31], v[92:95]
    s_waitcnt vmcnt(10)
    v_mfma_f32_16x16x32_bf16 v[80:83], v[112:115], a[32:35], v[80:83]
    v_mfma_f32_16x16x32_bf16 v[84:87], v[112:115], a[36:39], v[84:87]
    buffer_load_dwordx4 v[156:159], v23, s[24:27], s58 offen offset:1024 sc1
    v_mfma_f32_16x16x32_bf16 v[88:91], v[112:115], a[40:43], v[88:91]
    ds_write_b128 v232, v[104:107] offset:19456
    v_mfma_f32_16x16x32_bf16 v[92:95], v[112:115], a[44:47], v[92:95]
    s_waitcnt vmcnt(10)
    v_mfma_f32_16x16x32_bf16 v[80:83], v[116:119], a[48:51], v[80:83]
    s_add_u32 s66, s69, 117248
    s_add_u32 s58, s66, s76
    v_mfma_f32_16x16x32_bf16 v[84:87], v[116:119], a[52:55], v[84:87]
    buffer_load_dwordx4 v[112:115], v23, s[24:27], s58 offen offset:0 sc1
    v_mfma_f32_16x16x32_bf16 v[88:91], v[116:119], a[56:59], v[88:91]
    ds_write_b128 v232, v[108:111] offset:35840
    v_mfma_f32_16x16x32_bf16 v[92:95], v[116:119], a[60:63], v[92:95]
    s_waitcnt vmcnt(10)
    v_mfma_f32_16x16x32_bf16 v[80:83], v[120:123], a[64:67], v[80:83]
    v_mfma_f32_16x16x32_bf16 v[84:87], v[120:123], a[68:71], v[84:87]
    buffer_load_dwordx4 v[116:119], v23, s[24:27], s58 offen offset:1024 sc1
    v_mfma_f32_16x16x32_bf16 v[88:91], v[120:123], a[72:75], v[88:91]
    v_mfma_f32_16x16x32_bf16 v[92:95], v[120:123], a[76:79], v[92:95]
    s_waitcnt vmcnt(10)
    v_mfma_f32_16x16x32_bf16 v[80:83], v[124:127], a[80:83], v[80:83]
    s_add_u32 s58, s66, s77
    v_mfma_f32_16x16x32_bf16 v[84:87], v[124:127], a[84:87], v[84:87]
    buffer_load_dwordx4 v[120:123], v23, s[24:27], s58 offen offset:0 sc1
    v_mfma_f32_16x16x32_bf16 v[88:91], v[124:127], a[88:91], v[88:91]
    s_waitcnt lgkmcnt(0)
    s_barrier
    v_mfma_f32_16x16x32_bf16 v[92:95], v[124:127], a[92:95], v[92:95]
    s_waitcnt vmcnt(10)
    v_mfma_f32_16x16x32_bf16 v[80:83], v[128:131], a[96:99], v[80:83]
    v_mfma_f32_16x16x32_bf16 v[84:87], v[128:131], a[100:103], v[84:87]
    buffer_load_dwordx4 v[124:127], v23, s[24:27], s58 offen offset:1024 sc1
    v_mfma_f32_16x16x32_bf16 v[88:91], v[128:131], a[104:107], v[88:91]
    ds_read_b128 v[100:103], v233 offset:3072
    ds_read_b128 v[104:107], v234 offset:19456
    v_mfma_f32_16x16x32_bf16 v[92:95], v[128:131], a[108:111], v[92:95]
    ds_read_b128 v[108:111], v235 offset:35840
    s_waitcnt vmcnt(10)
    v_mfma_f32_16x16x32_bf16 v[80:83], v[132:135], a[112:115], v[80:83]
    s_add_u32 s58, s66, s78
    v_mfma_f32_16x16x32_bf16 v[84:87], v[132:135], a[116:119], v[84:87]
    buffer_load_dwordx4 v[128:131], v23, s[24:27], s58 offen offset:0 sc1
    v_mfma_f32_16x16x32_bf16 v[88:91], v[132:135], a[120:123], v[88:91]
    ds_read_b64_tr_b16 v[160:161], v16 offset:0
    v_mfma_f32_16x16x32_bf16 v[92:95], v[132:135], a[124:127], v[92:95]
    ds_read_b64_tr_b16 v[162:163], v16 offset:512
    s_waitcnt vmcnt(10)
    v_mfma_f32_16x16x32_bf16 v[80:83], v[136:139], a[128:131], v[80:83]
    s_waitcnt lgkmcnt(2)
    v_mfma_f32_16x16x32_bf16 v[84:87], v[136:139], a[132:135], v[84:87]
    buffer_load_dwordx4 v[132:135], v23, s[24:27], s58 offen offset:1024 sc1
    v_mfma_f32_16x16x32_bf16 v[88:91], v[136:139], a[136:139], v[88:91]
    v_add_f32 v96, v96, v100
    v_add_f32 v97, v97, v101
    ds_read_b64_tr_b16 v[164:165], v16 offset:4096
    v_mfma_f32_16x16x32_bf16 v[92:95], v[136:139], a[140:143], v[92:95]
    ds_read_b64_tr_b16 v[166:167], v16 offset:4608
    s_waitcnt vmcnt(10)
    v_mfma_f32_16x16x32_bf16 v[80:83], v[140:143], a[144:147], v[80:83]
    s_add_u32 s58, s66, s79
    v_add_f32 v98, v98, v102
    v_mfma_f32_16x16x32_bf16 v[84:87], v[140:143], a[148:151], v[84:87]
    buffer_load_dwordx4 v[136:139], v23, s[24:27], s58 offen offset:0 sc1
    v_mfma_f32_16x16x32_bf16 v[88:91], v[140:143], a[152:155], v[88:91]
    v_add_f32 v99, v99, v103
    v_add_f32 v96, v96, v104
    ds_read_b64_tr_b16 v[168:169], v16 offset:8192
    v_mfma_f32_16x16x32_bf16 v[92:95], v[140:143], a[156:159], v[92:95]
    ds_read_b64_tr_b16 v[170:171], v16 offset:8704
    s_waitcnt vmcnt(10)
    v_mfma_f32_16x16x32_bf16 v[80:83], v[144:147], a[160:163], v[80:83]
    v_add_f32 v97, v97, v105
    v_mfma_f32_16x16x32_bf16 v[84:87], v[144:147], a[164:167], v[84:87]
    buffer_load_dwordx4 v[140:143], v23, s[24:27], s58 offen offset:1024 sc1
    v_mfma_f32_16x16x32_bf16 v[88:91], v[144:147], a[168:171], v[88:91]
    v_add_f32 v98, v98, v106
    v_add_f32 v99, v99, v107
    ds_read_b64_tr_b16 v[172:173], v16 offset:12288
    v_mfma_f32_16x16x32_bf16 v[92:95], v[144:147], a[172:175], v[92:95]
    ds_read_b64_tr_b16 v[174:175], v16 offset:12800
    s_waitcnt vmcnt(10)
    v_mfma_f32_16x16x32_bf16 v[80:83], v[148:151], a[176:179], v[80:83]
    s_add_u32 s58, s66, s80
    v_mfma_f32_16x16x32_bf16 v[84:87], v[148:151], a[180:183], v[84:87]
    buffer_load_dwordx4 v[144:147], v23, s[24:27], s58 offen offset:0 sc1
    v_mfma_f32_16x16x32_bf16 v[88:91], v[148:151], a[184:187], v[88:91]
    v_add_f32 v96, v96, v108
    v_add_f32 v97, v97, v109
    v_mfma_f32_16x16x32_bf16 v[92:95], v[148:151], a[188:191], v[92:95]
    v_add_f32 v98, v98, v110
    s_waitcnt vmcnt(10)
    v_mfma_f32_16x16x32_bf16 v[80:83], v[152:155], a[192:195], v[80:83]
    v_mfma_f32_16x16x32_bf16 v[84:87], v[152:155], a[196:199], v[84:87]
    buffer_load_dwordx4 v[148:151], v23, s[24:27], s58 offen offset:1024 sc1
    v_mfma_f32_16x16x32_bf16 v[88:91], v[152:155], a[200:203], v[88:91]
    v_add_f32 v99, v99, v111
    v_mfma_f32_16x16x32_bf16 v[92:95], v[152:155], a[204:207], v[92:95]
    s_waitcnt vmcnt(10)
    v_mfma_f32_16x16x32_bf16 v[80:83], v[156:159], a[208:211], v[80:83]
    s_add_u32 s58, s66, s81
    v_mfma_f32_16x16x32_bf16 v[84:87], v[156:159], a[212:215], v[84:87]
    buffer_load_dwordx4 v[152:155], v23, s[24:27], s58 offen offset:0 sc1
    v_mfma_f32_16x16x32_bf16 v[88:91], v[156:159], a[216:219], v[88:91]
    v_mfma_f32_16x16x32_bf16 v[92:95], v[156:159], a[220:223], v[92:95]
    s_waitcnt vmcnt(10)
    v_mfma_f32_16x16x32_bf16 v[64:67], v[112:115], a[0:3], v[64:67]
    v_mfma_f32_16x16x32_bf16 v[68:71], v[112:115], a[4:7], 0
    buffer_load_dwordx4 v[156:159], v23, s[24:27], s58 offen offset:1024 sc1
    v_mfma_f32_16x16x32_bf16 v[72:75], v[112:115], a[8:11], 0
    ds_read_b64_tr_b16 v[192:193], v16 offset:1024
    v_mfma_f32_16x16x32_bf16 v[76:79], v[112:115], a[12:15], 0
    ds_read_b64_tr_b16 v[194:195], v16 offset:1536
    s_waitcnt vmcnt(10)
    v_mfma_f32_16x16x32_bf16 v[64:67], v[116:119], a[16:19], v[64:67]
    s_add_u32 s58, s66, s82
    v_mfma_f32_16x16x32_bf16 v[68:71], v[116:119], a[20:23], v[68:71]
    buffer_load_dwordx4 v[112:115], v23, s[24:27], s58 offen offset:0 sc1
    v_mfma_f32_16x16x32_bf16 v[72:75], v[116:119], a[24:27], v[72:75]
    ds_read_b64_tr_b16 v[196:197], v16 offset:5120
    ds_read_b64_tr_b16 v[198:199], v16 offset:5632
    v_mfma_f32_16x16x32_bf16 v[76:79], v[116:119], a[28:31], v[76:79]
    ds_write_b128 v232, v[84:87] offset:49152
    s_waitcnt vmcnt(10)
    v_mfma_f32_16x16x32_bf16 v[64:67], v[120:123], a[32:35], v[64:67]
    v_mfma_f32_16x16x32_bf16 v[68:71], v[120:123], a[36:39], v[68:71]
    buffer_load_dwordx4 v[116:119], v23, s[24:27], s58 offen offset:1024 sc1
    v_mfma_f32_16x16x32_bf16 v[72:75], v[120:123], a[40:43], v[72:75]
    ds_read_b64_tr_b16 v[200:201], v16 offset:9216
    ds_read_b64_tr_b16 v[202:203], v16 offset:9728
    v_mfma_f32_16x16x32_bf16 v[76:79], v[120:123], a[44:47], v[76:79]
    ds_write_b128 v232, v[88:91] offset:50176
    s_waitcnt vmcnt(10)
    v_mfma_f32_16x16x32_bf16 v[64:67], v[124:127], a[48:51], v[64:67]
    s_add_u32 s66, s69, 58624
    s_add_u32 s58, s66, s76
    v_mfma_f32_16x16x32_bf16 v[68:71], v[124:127], a[52:55], v[68:71]
    buffer_load_dwordx4 v[120:123], v23, s[24:27], s58 offen offset:0 sc1
    v_mfma_f32_16x16x32_bf16 v[72:75], v[124:127], a[56:59], v[72:75]
    ds_read_b64_tr_b16 v[204:205], v16 offset:13312
    ds_read_b64_tr_b16 v[206:207], v16 offset:13824
    v_mfma_f32_16x16x32_bf16 v[76:79], v[124:127], a[60:63], v[76:79]
    ds_write_b128 v232, v[92:95] offset:51200
    s_waitcnt vmcnt(10)
    v_mfma_f32_16x16x32_bf16 v[64:67], v[128:131], a[64:67], v[64:67]
    v_mfma_f32_16x16x32_bf16 v[68:71], v[128:131], a[68:71], v[68:71]
    buffer_load_dwordx4 v[124:127], v23, s[24:27], s58 offen offset:1024 sc1
    v_mfma_f32_16x16x32_bf16 v[72:75], v[128:131], a[72:75], v[72:75]
    ds_read_b64_tr_b16 v[100:101], v16 offset:2048
    v_mfma_f32_16x16x32_bf16 v[76:79], v[128:131], a[76:79], v[76:79]
    ds_read_b64_tr_b16 v[102:103], v16 offset:2560
    s_waitcnt vmcnt(10)
    v_mfma_f32_16x16x32_bf16 v[64:67], v[132:135], a[80:83], v[64:67]
    s_add_u32 s58, s66, s77
    v_mfma_f32_16x16x32_bf16 v[68:71], v[132:135], a[84:87], v[68:71]
    buffer_load_dwordx4 v[128:131], v23, s[24:27], s58 offen offset:0 sc1
    v_mfma_f32_16x16x32_bf16 v[72:75], v[132:135], a[88:91], v[72:75]
    s_waitcnt lgkmcnt(2)
    s_barrier
    v_mfma_f32_16x16x32_bf16 v[76:79], v[132:135], a[92:95], v[76:79]
    s_waitcnt vmcnt(10)
    v_mfma_f32_16x16x32_bf16 v[64:67], v[136:139], a[96:99], v[64:67]
    v_mfma_f32_16x16x32_bf16 v[68:71], v[136:139], a[100:103], v[68:71]
    buffer_load_dwordx4 v[132:135], v23, s[24:27], s58 offen offset:1024 sc1
    v_mfma_f32_16x16x32_bf16 v[72:75], v[136:139], a[104:107], v[72:75]
    ds_read_b128 v[84:87], v233 offset:49152
    ds_read_b128 v[88:91], v234 offset:50176
    v_mfma_f32_16x16x32_bf16 v[76:79], v[136:139], a[108:111], v[76:79]
    ds_read_b128 v[92:95], v235 offset:51200
    s_waitcnt vmcnt(10)
    v_mfma_f32_16x16x32_bf16 v[64:67], v[140:143], a[112:115], v[64:67]
    s_add_u32 s58, s66, s78
    v_mfma_f32_16x16x32_bf16 v[68:71], v[140:143], a[116:119], v[68:71]
    buffer_load_dwordx4 v[136:139], v23, s[24:27], s58 offen offset:0 sc1
    v_mfma_f32_16x16x32_bf16 v[72:75], v[140:143], a[120:123], v[72:75]
    ds_read_b64_tr_b16 a[224:225], v246 offset:0
    v_mfma_f32_16x16x32_bf16 v[76:79], v[140:143], a[124:127], v[76:79]
    ds_read_b64_tr_b16 a[226:227], v246 offset:512
    s_waitcnt vmcnt(10)
    v_mfma_f32_16x16x32_bf16 v[64:67], v[144:147], a[128:131], v[64:67]
    s_waitcnt lgkmcnt(2)
    v_mfma_f32_16x16x32_bf16 v[68:71], v[144:147], a[132:135], v[68:71]
    buffer_load_dwordx4 v[140:143], v23, s[24:27], s58 offen offset:1024 sc1
    v_mfma_f32_16x16x32_bf16 v[72:75], v[144:147], a[136:139], v[72:75]
    v_add_f32 v80, v80, v84
    v_add_f32 v81, v81, v85
    ds_read_b64_tr_b16 a[228:229], v247 offset:0
    v_mfma_f32_16x16x32_bf16 v[76:79], v[144:147], a[140:143], v[76:79]
    ds_read_b64_tr_b16 a[230:231], v247 offset:512
    s_waitcnt vmcnt(10)
    v_mfma_f32_16x16x32_bf16 v[64:67], v[148:151], a[144:147], v[64:67]
    s_add_u32 s58, s66, s79
    v_add_f32 v82, v82, v86
    v_mfma_f32_16x16x32_bf16 v[68:71], v[148:151], a[148:151], v[68:71]
    buffer_load_dwordx4 v[144:147], v23, s[24:27], s58 offen offset:0 sc1
    v_mfma_f32_16x16x32_bf16 v[72:75], v[148:151], a[152:155], v[72:75]
    v_add_f32 v83, v83, v87
    v_add_f32 v80, v80, v88
    ds_read_b64_tr_b16 a[232:233], v246 offset:256
    v_mfma_f32_16x16x32_bf16 v[76:79], v[148:151], a[156:159], v[76:79]
    ds_read_b64_tr_b16 a[234:235], v246 offset:768
    s_waitcnt vmcnt(10)
    v_mfma_f32_16x16x32_bf16 v[64:67], v[152:155], a[160:163], v[64:67]
    v_add_f32 v81, v81, v89
    v_mfma_f32_16x16x32_bf16 v[68:71], v[152:155], a[164:167], v[68:71]
    buffer_load_dwordx4 v[148:151], v23, s[24:27], s58 offen offset:1024 sc1
    v_mfma_f32_16x16x32_bf16 v[72:75], v[152:155], a[168:171], v[72:75]
    v_add_f32 v82, v82, v90
    v_add_f32 v83, v83, v91
    ds_read_b64_tr_b16 a[236:237], v247 offset:256
    v_mfma_f32_16x16x32_bf16 v[76:79], v[152:155], a[172:175], v[76:79]
    ds_read_b64_tr_b16 a[238:239], v247 offset:768
    s_waitcnt vmcnt(10)
    v_mfma_f32_16x16x32_bf16 v[64:67], v[156:159], a[176:179], v[64:67]
    s_add_u32 s58, s66, s80
    v_mfma_f32_16x16x32_bf16 v[68:71], v[156:159], a[180:183], v[68:71]
    buffer_load_dwordx4 v[152:155], v23, s[24:27], s58 offen offset:0 sc1
    v_mfma_f32_16x16x32_bf16 v[72:75], v[156:159], a[184:187], v[72:75]
    v_add_f32 v80, v80, v92
    v_add_f32 v81, v81, v93
    v_mfma_f32_16x16x32_bf16 v[76:79], v[156:159], a[188:191], v[76:79]
    v_add_f32 v82, v82, v94
    s_waitcnt vmcnt(10)
    v_mfma_f32_16x16x32_bf16 v[64:67], v[112:115], a[192:195], v[64:67]
    v_mfma_f32_16x16x32_bf16 v[68:71], v[112:115], a[196:199], v[68:71]
    buffer_load_dwordx4 v[156:159], v23, s[24:27], s58 offen offset:1024 sc1
    v_mfma_f32_16x16x32_bf16 v[72:75], v[112:115], a[200:203], v[72:75]
    v_add_f32 v83, v83, v95
    v_mfma_f32_16x16x32_bf16 v[76:79], v[112:115], a[204:207], v[76:79]
    s_waitcnt vmcnt(10)
    v_mfma_f32_16x16x32_bf16 v[64:67], v[116:119], a[208:211], v[64:67]
    s_add_u32 s58, s66, s81
    v_mfma_f32_16x16x32_bf16 v[68:71], v[116:119], a[212:215], v[68:71]
    buffer_load_dwordx4 v[112:115], v23, s[24:27], s58 offen offset:0 sc1
    v_mfma_f32_16x16x32_bf16 v[72:75], v[116:119], a[216:219], v[72:75]
    v_mfma_f32_16x16x32_bf16 v[76:79], v[116:119], a[220:223], v[76:79]
    s_waitcnt vmcnt(10)
    v_mfma_f32_16x16x32_bf16 v[48:51], v[120:123], a[0:3], v[48:51]
    v_mfma_f32_16x16x32_bf16 v[52:55], v[120:123], a[4:7], 0
    buffer_load_dwordx4 v[116:119], v23, s[24:27], s58 offen offset:1024 sc1
    v_mfma_f32_16x16x32_bf16 v[56:59], v[120:123], a[8:11], 0
    ds_read_b64_tr_b16 v[104:105], v16 offset:6144
    v_mfma_f32_16x16x32_bf16 v[60:63], v[120:123], a[12:15], 0
    ds_read_b64_tr_b16 v[106:107], v16 offset:6656
    s_waitcnt vmcnt(10)
    v_mfma_f32_16x16x32_bf16 v[48:51], v[124:127], a[16:19], v[48:51]
    s_add_u32 s58, s66, s82
    v_mfma_f32_16x16x32_bf16 v[52:55], v[124:127], a[20:23], v[52:55]
    buffer_load_dwordx4 v[120:123], v23, s[24:27], s58 offen offset:0 sc1
    v_mfma_f32_16x16x32_bf16 v[56:59], v[124:127], a[24:27], v[56:59]
    ds_read_b64_tr_b16 v[108:109], v16 offset:10240
    ds_read_b64_tr_b16 v[110:111], v16 offset:10752
    v_mfma_f32_16x16x32_bf16 v[60:63], v[124:127], a[28:31], v[60:63]
    ds_write_b128 v232, v[68:71] offset:32768
    s_waitcnt vmcnt(10)
    v_mfma_f32_16x16x32_bf16 v[48:51], v[128:131], a[32:35], v[48:51]
    v_mfma_f32_16x16x32_bf16 v[52:55], v[128:131], a[36:39], v[52:55]
    buffer_load_dwordx4 v[124:127], v23, s[24:27], s58 offen offset:1024 sc1
    v_mfma_f32_16x16x32_bf16 v[56:59], v[128:131], a[40:43], v[56:59]
    ds_read_b64_tr_b16 v[84:85], v16 offset:14336
    ds_read_b64_tr_b16 v[86:87], v16 offset:14848
    v_mfma_f32_16x16x32_bf16 v[60:63], v[128:131], a[44:47], v[60:63]
    ds_write_b128 v232, v[72:75] offset:33792
    s_waitcnt vmcnt(10)
    v_mfma_f32_16x16x32_bf16 v[48:51], v[132:135], a[48:51], v[48:51]
    s_add_u32 s66, s69, 0
    s_add_u32 s58, s66, s76
    v_mfma_f32_16x16x32_bf16 v[52:55], v[132:135], a[52:55], v[52:55]
    buffer_load_dwordx4 v[128:131], v23, s[24:27], s58 offen offset:0 sc1
    v_mfma_f32_16x16x32_bf16 v[56:59], v[132:135], a[56:59], v[56:59]
    ds_read_b64_tr_b16 v[88:89], v16 offset:3072
    ds_read_b64_tr_b16 v[90:91], v16 offset:3584
    v_mfma_f32_16x16x32_bf16 v[60:63], v[132:135], a[60:63], v[60:63]
    ds_write_b128 v232, v[76:79] offset:34816
    s_waitcnt vmcnt(10)
    v_mfma_f32_16x16x32_bf16 v[48:51], v[136:139], a[64:67], v[48:51]
    v_mfma_f32_16x16x32_bf16 v[52:55], v[136:139], a[68:71], v[52:55]
    buffer_load_dwordx4 v[132:135], v23, s[24:27], s58 offen offset:1024 sc1
    v_mfma_f32_16x16x32_bf16 v[56:59], v[136:139], a[72:75], v[56:59]
    ds_read_b64_tr_b16 v[92:93], v16 offset:7168
    v_mfma_f32_16x16x32_bf16 v[60:63], v[136:139], a[76:79], v[60:63]
    ds_read_b64_tr_b16 v[94:95], v16 offset:7680
    s_waitcnt vmcnt(10)
    v_mfma_f32_16x16x32_bf16 v[48:51], v[140:143], a[80:83], v[48:51]
    s_add_u32 s58, s66, s77
    v_mfma_f32_16x16x32_bf16 v[52:55], v[140:143], a[84:87], v[52:55]
    buffer_load_dwordx4 v[136:139], v23, s[24:27], s58 offen offset:0 sc1
    v_mfma_f32_16x16x32_bf16 v[56:59], v[140:143], a[88:91], v[56:59]
    s_waitcnt lgkmcnt(2)
    s_barrier
    v_mfma_f32_16x16x32_bf16 v[60:63], v[140:143], a[92:95], v[60:63]
    s_waitcnt vmcnt(10)
    v_mfma_f32_16x16x32_bf16 v[48:51], v[144:147], a[96:99], v[48:51]
    v_mfma_f32_16x16x32_bf16 v[52:55], v[144:147], a[100:103], v[52:55]
    buffer_load_dword v19, v21, s[24:27], 0 offen sc1
    v_mfma_f32_16x16x32_bf16 v[56:59], v[144:147], a[104:107], v[56:59]
    ds_read_b128 v[68:71], v233 offset:32768
    ds_read_b128 v[72:75], v234 offset:33792
    v_mfma_f32_16x16x32_bf16 v[60:63], v[144:147], a[108:111], v[60:63]
    ds_read_b128 v[76:79], v235 offset:34816
    s_waitcnt vmcnt(10)
    v_mfma_f32_16x16x32_bf16 v[48:51], v[148:151], a[112:115], v[48:51]
    v_mfma_f32_16x16x32_bf16 v[52:55], v[148:151], a[116:119], v[52:55]
    buffer_load_dwordx4 v[140:143], v23, s[24:27], s58 offen offset:1024 sc1
    v_mfma_f32_16x16x32_bf16 v[56:59], v[148:151], a[120:123], v[56:59]
    ds_read_b64_tr_b16 a[240:241], v246 offset:4096
    v_mfma_f32_16x16x32_bf16 v[60:63], v[148:151], a[124:127], v[60:63]
    ds_read_b64_tr_b16 a[242:243], v246 offset:4608
    s_waitcnt vmcnt(10)
    v_mfma_f32_16x16x32_bf16 v[48:51], v[152:155], a[128:131], v[48:51]
    s_add_u32 s58, s66, s78
    s_waitcnt lgkmcnt(2)
    v_mfma_f32_16x16x32_bf16 v[52:55], v[152:155], a[132:135], v[52:55]
    buffer_load_dwordx4 v[144:147], v23, s[24:27], s58 offen offset:0 sc1
    v_mfma_f32_16x16x32_bf16 v[56:59], v[152:155], a[136:139], v[56:59]
    v_add_f32 v64, v64, v68
    v_add_f32 v65, v65, v69
    ds_read_b64_tr_b16 a[244:245], v247 offset:4096
    v_mfma_f32_16x16x32_bf16 v[60:63], v[152:155], a[140:143], v[60:63]
    ds_read_b64_tr_b16 a[246:247], v247 offset:4608
    s_waitcnt vmcnt(10)
    v_mfma_f32_16x16x32_bf16 v[48:51], v[156:159], a[144:147], v[48:51]
    v_add_f32 v66, v66, v70
    v_mfma_f32_16x16x32_bf16 v[52:55], v[156:159], a[148:151], v[52:55]
    buffer_load_dwordx4 v[148:151], v23, s[24:27], s58 offen offset:1024 sc1
    v_mfma_f32_16x16x32_bf16 v[56:59], v[156:159], a[152:155], v[56:59]
    v_add_f32 v67, v67, v71
    v_add_f32 v64, v64, v72
    ds_read_b64_tr_b16 a[248:249], v246 offset:4352
    v_mfma_f32_16x16x32_bf16 v[60:63], v[156:159], a[156:159], v[60:63]
    ds_read_b64_tr_b16 a[250:251], v246 offset:4864
    s_waitcnt vmcnt(10)
    v_mfma_f32_16x16x32_bf16 v[48:51], v[112:115], a[160:163], v[48:51]
    s_add_u32 s58, s66, s79
    v_add_f32 v65, v65, v73
    v_mfma_f32_16x16x32_bf16 v[52:55], v[112:115], a[164:167], v[52:55]
    buffer_load_dwordx4 v[152:155], v23, s[24:27], s58 offen offset:0 sc1
    v_mfma_f32_16x16x32_bf16 v[56:59], v[112:115], a[168:171], v[56:59]
    v_add_f32 v66, v66, v74
    v_add_f32 v67, v67, v75
    ds_read_b64_tr_b16 a[252:253], v247 offset:4352
    v_mfma_f32_16x16x32_bf16 v[60:63], v[112:115], a[172:175], v[60:63]
    ds_read_b64_tr_b16 a[254:255], v247 offset:4864
    s_waitcnt vmcnt(10)
    v_mfma_f32_16x16x32_bf16 v[48:51], v[116:119], a[176:179], v[48:51]
    v_mfma_f32_16x16x32_bf16 v[52:55], v[116:119], a[180:183], v[52:55]
    buffer_load_dwordx4 v[156:159], v23, s[24:27], s58 offen offset:1024 sc1
    v_mfma_f32_16x16x32_bf16 v[56:59], v[116:119], a[184:187], v[56:59]
    v_add_f32 v64, v64, v76
    v_add_f32 v65, v65, v77
    v_mfma_f32_16x16x32_bf16 v[60:63], v[116:119], a[188:191], v[60:63]
    v_add_f32 v66, v66, v78
    s_waitcnt vmcnt(10)
    v_mfma_f32_16x16x32_bf16 v[48:51], v[120:123], a[192:195], v[48:51]
    s_add_u32 s58, s66, s80
    v_mfma_f32_16x16x32_bf16 v[52:55], v[120:123], a[196:199], v[52:55]
    buffer_load_dwordx4 v[112:115], v23, s[24:27], s58 offen offset:0 sc1
    v_mfma_f32_16x16x32_bf16 v[56:59], v[120:123], a[200:203], v[56:59]
    v_add_f32 v67, v67, v79
    v_mfma_f32_16x16x32_bf16 v[60:63], v[120:123], a[204:207], v[60:63]
    s_waitcnt vmcnt(10)
    v_mfma_f32_16x16x32_bf16 v[48:51], v[124:127], a[208:211], v[48:51]
    v_mfma_f32_16x16x32_bf16 v[52:55], v[124:127], a[212:215], v[52:55]
    buffer_load_dwordx4 v[116:119], v23, s[24:27], s58 offen offset:1024 sc1
    v_mfma_f32_16x16x32_bf16 v[56:59], v[124:127], a[216:219], v[56:59]
    v_mfma_f32_16x16x32_bf16 v[60:63], v[124:127], a[220:223], v[60:63]
    s_waitcnt vmcnt(10)
    v_mfma_f32_16x16x32_bf16 v[32:35], v[128:131], a[0:3], v[32:35]
    s_add_u32 s58, s66, s81
    v_mfma_f32_16x16x32_bf16 v[36:39], v[128:131], a[4:7], 0
    buffer_load_dwordx4 v[120:123], v23, s[24:27], s58 offen offset:0 sc1
    v_mfma_f32_16x16x32_bf16 v[40:43], v[128:131], a[8:11], 0
    v_mfma_f32_16x16x32_bf16 v[44:47], v[128:131], a[12:15], 0
    s_waitcnt vmcnt(10)
    v_mfma_f32_16x16x32_bf16 v[32:35], v[132:135], a[16:19], v[32:35]
    ds_write_b128 v232, v[52:55] offset:16384
    v_mfma_f32_16x16x32_bf16 v[36:39], v[132:135], a[20:23], v[36:39]
    buffer_load_dwordx4 v[124:127], v23, s[24:27], s58 offen offset:1024 sc1
    v_mfma_f32_16x16x32_bf16 v[40:43], v[132:135], a[24:27], v[40:43]
    ds_read_b64_tr_b16 a[0:1], v246 offset:8192
    ds_read_b64_tr_b16 a[2:3], v246 offset:8704
    ds_read_b64_tr_b16 a[4:5], v247 offset:8192
    v_mfma_f32_16x16x32_bf16 v[44:47], v[132:135], a[28:31], v[44:47]
    ds_read_b64_tr_b16 a[6:7], v247 offset:8704
    s_waitcnt vmcnt(10)
    v_mfma_f32_16x16x32_bf16 v[32:35], v[136:139], a[32:35], v[32:35]
    s_add_u32 s58, s66, s82
    ds_write_b128 v232, v[56:59] offset:17408
    v_mfma_f32_16x16x32_bf16 v[36:39], v[136:139], a[36:39], v[36:39]
    buffer_load_dwordx4 v[128:131], v23, s[24:27], s58 offen offset:0 sc1
    v_mfma_f32_16x16x32_bf16 v[40:43], v[136:139], a[40:43], v[40:43]
    ds_read_b64_tr_b16 a[8:9], v246 offset:8448
    ds_read_b64_tr_b16 a[10:11], v246 offset:8960
    ds_read_b64_tr_b16 a[12:13], v247 offset:8448
    v_mfma_f32_16x16x32_bf16 v[44:47], v[136:139], a[44:47], v[44:47]
    ds_read_b64_tr_b16 a[14:15], v247 offset:8960
    buffer_load_dwordx4 v[132:135], v23, s[24:27], s58 offen offset:1024 sc1
    s_waitcnt vmcnt(11)
    v_cmp_ne_u32 vcc, s47, v19
    s_nop 0
    s_cbranch_vccz L_ok10
    s_mov_b32 s59, 100000
L_spin9:
    buffer_load_dword v19, v21, s[24:27], 0 offen sc1
    s_waitcnt vmcnt(0)
    v_cmp_ne_u32 vcc, s47, v19
    s_nop 0
    s_cbranch_vccz L_ok10
    s_sub_u32 s59, s59, 1
    s_cbranch_scc0 L_spin9
L_ok10:
    s_waitcnt vmcnt(10)
    v_mfma_f32_16x16x32_bf16 v[32:35], v[140:143], a[48:51], v[32:35]
    s_add_u32 s58, s70, 0
    ds_write_b128 v232, v[60:63] offset:18432
    v_mfma_f32_16x16x32_bf16 v[36:39], v[140:143], a[52:55], v[36:39]
    buffer_load_dwordx4 v[136:139], v23, s[24:27], s58 offen offset:0 sc1
    v_mfma_f32_16x16x32_bf16 v[40:43], v[140:143], a[56:59], v[40:43]
    ds_read_b64_tr_b16 a[16:17], v246 offset:12288
    ds_read_b64_tr_b16 a[18:19], v246 offset:12800
    ds_read_b64_tr_b16 a[20:21], v247 offset:12288
    v_mfma_f32_16x16x32_bf16 v[44:47], v[140:143], a[60:63], v[44:47]
    ds_read_b64_tr_b16 a[22:23], v247 offset:12800
    s_waitcnt vmcnt(10)
    v_mfma_f32_16x16x32_bf16 v[32:35], v[144:147], a[64:67], v[32:35]
L_wb_3:
    s_cbranch_execz L_wb_ret
    ds_read_b64_tr_b16 a[24:25], v246 offset:12544
    v_mfma_f32_16x16x32_bf16 v[36:39], v[144:147], a[68:71], v[36:39]
    buffer_load_dwordx4 v[140:143], v23, s[24:27], s58 offen offset:1024 sc1
    v_mfma_f32_16x16x32_bf16 v[40:43], v[144:147], a[72:75], v[40:43]
    ds_read_b64_tr_b16 a[26:27], v246 offset:13056
    ds_read_b64_tr_b16 a[28:29], v247 offset:12544
    v_mfma_f32_16x16x32_bf16 v[44:47], v[144:147], a[76:79], v[44:47]
    ds_read_b64_tr_b16 a[30:31], v247 offset:13056
    s_waitcnt vmcnt(10)
    v_mfma_f32_16x16x32_bf16 v[32:35], v[148:151], a[80:83], v[32:35]
    ds_read_b64_tr_b16 a[32:33], v246 offset:16384
    v_mfma_f32_16x16x32_bf16 v[36:39], v[148:151], a[84:87], v[36:39]
    buffer_load_dwordx4 v[144:147], v23, s[24:27], s58 offen offset:2048 sc1
    v_mfma_f32_16x16x32_bf16 v[40:43], v[148:151], a[88:91], v[40:43]
    ds_read_b64_tr_b16 a[34:35], v246 offset:16896
    ds_read_b64_tr_b16 a[36:37], v247 offset:16384
    v_mfma_f32_16x16x32_bf16 v[44:47], v[148:151], a[92:95], v[44:47]
    ds_read_b64_tr_b16 a[38:39], v247 offset:16896
    s_waitcnt vmcnt(10)
    v_mfma_f32_16x16x32_bf16 v[32:35], v[152:155], a[96:99], v[32:35]
    ds_read_b64_tr_b16 a[40:41], v246 offset:16640
    v_mfma_f32_16x16x32_bf16 v[36:39], v[152:155], a[100:103], v[36:39]
    buffer_load_dwordx4 v[148:151], v23, s[24:27], s58 offen offset:3072 sc1
    v_mfma_f32_16x16x32_bf16 v[40:43], v[152:155], a[104:107], v[40:43]
    ds_read_b64_tr_b16 a[42:43], v246 offset:17152
    ds_read_b64_tr_b16 a[44:45], v247 offset:16640
    v_mfma_f32_16x16x32_bf16 v[44:47], v[152:155], a[108:111], v[44:47]
    ds_read_b64_tr_b16 a[46:47], v247 offset:17152
    s_waitcnt vmcnt(10)
    v_mfma_f32_16x16x32_bf16 v[32:35], v[156:159], a[112:115], v[32:35]
    s_add_u32 s58, s70, 4096
    ds_read_b64_tr_b16 a[48:49], v246 offset:20480
    v_mfma_f32_16x16x32_bf16 v[36:39], v[156:159], a[116:119], v[36:39]
    buffer_load_dwordx4 v[152:155], v23, s[24:27], s58 offen offset:0 sc1
    v_mfma_f32_16x16x32_bf16 v[40:43], v[156:159], a[120:123], v[40:43]
    ds_read_b64_tr_b16 a[50:51], v246 offset:20992
    ds_read_b64_tr_b16 a[52:53], v247 offset:20480
    v_mfma_f32_16x16x32_bf16 v[44:47], v[156:159], a[124:127], v[44:47]
    ds_read_b64_tr_b16 a[54:55], v247 offset:20992
    s_waitcnt vmcnt(10)
    v_mfma_f32_16x16x32_bf16 v[32:35], v[112:115], a[128:131], v[32:35]
    ds_read_b64_tr_b16 a[56:57], v246 offset:20736
    v_mfma_f32_16x16x32_bf16 v[36:39], v[112:115], a[132:135], v[36:39]
    buffer_load_dwordx4 v[156:159], v23, s[24:27], s58 offen offset:1024 sc1
    v_mfma_f32_16x16x32_bf16 v[40:43], v[112:115], a[136:139], v[40:43]
    ds_read_b64_tr_b16 a[58:59], v246 offset:21248
    ds_read_b64_tr_b16 a[60:61], v247 offset:20736
    v_mfma_f32_16x16x32_bf16 v[44:47], v[112:115], a[140:143], v[44:47]
    ds_read_b64_tr_b16 a[62:63], v247 offset:21248
    s_waitcnt vmcnt(10)
    v_mfma_f32_16x16x32_bf16 v[32:35], v[116:119], a[144:147], v[32:35]
    ds_read_b64_tr_b16 a[64:65], v246 offset:24576
    v_mfma_f32_16x16x32_bf16 v[36:39], v[116:119], a[148:151], v[36:39]
    buffer_load_dwordx4 v[112:115], v23, s[24:27], s58 offen offset:2048 sc1
    v_mfma_f32_16x16x32_bf16 v[40:43], v[116:119], a[152:155], v[40:43]
    ds_read_b64_tr_b16 a[66:67], v246 offset:25088
    ds_read_b64_tr_b16 a[68:69], v247 offset:24576
    v_mfma_f32_16x16x32_bf16 v[44:47], v[116:119], a[156:159], v[44:47]
    ds_read_b64_tr_b16 a[70:71], v247 offset:25088
    s_waitcnt vmcnt(10)
    v_mfma_f32_16x16x32_bf16 v[32:35], v[120:123], a[160:163], v[32:35]
    ds_read_b64_tr_b16 a[72:73], v246 offset:24832
    v_mfma_f32_16x16x32_bf16 v[36:39], v[120:123], a[164:167], v[36:39]
    buffer_load_dwordx4 v[116:119], v23, s[24:27], s58 offen offset:3072 sc1
    v_mfma_f32_16x16x32_bf16 v[40:43], v[120:123], a[168:171], v[40:43]
    ds_read_b64_tr_b16 a[74:75], v246 offset:25344
    ds_read_b64_tr_b16 a[76:77], v247 offset:24832
    v_mfma_f32_16x16x32_bf16 v[44:47], v[120:123], a[172:175], v[44:47]
    ds_read_b64_tr_b16 a[78:79], v247 offset:25344
    s_waitcnt vmcnt(10)
    v_mfma_f32_16x16x32_bf16 v[32:35], v[124:127], a[176:179], v[32:35]
    s_add_u32 s58, s70, 8192
    ds_read_b64_tr_b16 a[80:81], v246 offset:28672
    v_mfma_f32_16x16x32_bf16 v[36:39], v[124:127], a[180:183], v[36:39]
    buffer_load_dwordx4 v[120:123], v23, s[24:27], s58 offen offset:0 sc1
    v_mfma_f32_16x16x32_bf16 v[40:43], v[124:127], a[184:187], v[40:43]
    ds_read_b64_tr_b16 a[82:83], v246 offset:29184
    ds_read_b64_tr_b16 a[84:85], v247 offset:28672
    v_mfma_f32_16x16x32_bf16 v[44:47], v[124:127], a[188:191], v[44:47]
    ds_read_b64_tr_b16 a[86:87], v247 offset:29184
    s_waitcnt vmcnt(10)
    v_mfma_f32_16x16x32_bf16 v[32:35], v[128:131], a[192:195], v[32:35]
    ds_read_b64_tr_b16 a[88:89], v246 offset:28928
    v_mfma_f32_16x16x32_bf16 v[36:39], v[128:131], a[196:199], v[36:39]
    buffer_load_dwordx4 v[124:127], v23, s[24:27], s58 offen offset:1024 sc1
    v_mfma_f32_16x16x32_bf16 v[40:43], v[128:131], a[200:203], v[40:43]
    ds_read_b64_tr_b16 a[90:91], v246 offset:29440
    ds_read_b64_tr_b16 a[92:93], v247 offset:28928
    v_mfma_f32_16x16x32_bf16 v[44:47], v[128:131], a[204:207], v[44:47]
    ds_read_b64_tr_b16 a[94:95], v247 offset:29440
    s_waitcnt vmcnt(10)
    v_mfma_f32_16x16x32_bf16 v[32:35], v[132:135], a[208:211], v[32:35]
    ds_read_b64_tr_b16 a[96:97], v246 offset:32768
    v_mfma_f32_16x16x32_bf16 v[36:39], v[132:135], a[212:215], v[36:39]
    buffer_load_dwordx4 v[128:131], v23, s[24:27], s58 offen offset:2048 sc1
    v_mfma_f32_16x16x32_bf16 v[40:43], v[132:135], a[216:219], v[40:43]
    ds_read_b64_tr_b16 a[98:99], v246 offset:33280
    ds_read_b64_tr_b16 a[100:101], v247 offset:32768
    v_mfma_f32_16x16x32_bf16 v[44:47], v[132:135], a[220:223], v[44:47]
    ds_read_b64_tr_b16 a[102:103], v247 offset:33280
    s_waitcnt vmcnt(10)
    v_mfma_f32_16x16x32_bf16 v[32:35], a[224:227], v[136:139], v[32:35]
    v_mfma_f32_16x16x32_bf16 v[48:51], a[228:231], v[136:139], v[48:51]
    buffer_load_dwordx4 v[132:135], v23, s[24:27], s58 offen offset:3072 sc1
    v_mfma_f32_16x16x32_bf16 v[64:67], a[232:235], v[136:139], v[64:67]
    ds_read_b64_tr_b16 a[104:105], v246 offset:33024
    ds_read_b64_tr_b16 a[106:107], v246 offset:33536
    v_mfma_f32_16x16x32_bf16 v[80:83], a[236:239], v[136:139], v[80:83]
    ds_read_b64_tr_b16 a[108:109], v247 offset:33024
    ds_read_b64_tr_b16 a[110:111], v247 offset:33536
    v_mfma_f32_16x16x32_bf16 v[96:99], v[160:163], v[136:139], v[96:99]
    ds_read_b64_tr_b16 a[112:113], v246 offset:36864
    s_waitcnt lgkmcnt(15)
    s_waitcnt vmcnt(10)
    v_mfma_f32_16x16x32_bf16 v[32:35], a[240:243], v[140:143], v[32:35]
    s_add_u32 s58, s70, 12288
    v_mfma_f32_16x16x32_bf16 v[48:51], a[244:247], v[140:143], v[48:51]
    buffer_load_dwordx4 v[136:139], v23, s[24:27], s58 offen offset:0 sc1
    v_mfma_f32_16x16x32_bf16 v[64:67], a[248:251], v[140:143], v[64:67]
    ds_read_b64_tr_b16 a[114:115], v246 offset:37376
    ds_read_b64_tr_b16 a[116:117], v247 offset:36864
    v_mfma_f32_16x16x32_bf16 v[80:83], a[252:255], v[140:143], v[80:83]
    ds_read_b64_tr_b16 a[118:119], v247 offset:37376
    ds_read_b64_tr_b16 a[120:121], v246 offset:37120
    v_mfma_f32_16x16x32_bf16 v[96:99], v[164:167], v[140:143], v[96:99]
    ds_write_b128 v232, v[36:39] offset:0
    s_waitcnt vmcnt(10)
    v_mfma_f32_16x16x32_bf16 v[32:35], a[0:3], v[144:147], v[32:35]
    v_mfma_f32_16x16x32_bf16 v[48:51], a[4:7], v[144:147], v[48:51]
    buffer_load_dwordx4 v[140:143], v23, s[24:27], s58 offen offset:1024 sc1
    v_mfma_f32_16x16x32_bf16 v[64:67], a[8:11], v[144:147], v[64:67]
    ds_read_b64_tr_b16 a[122:123], v246 offset:37632
    ds_read_b64_tr_b16 a[124:125], v247 offset:37120
    v_mfma_f32_16x16x32_bf16 v[80:83], a[12:15], v[144:147], v[80:83]
    ds_read_b64_tr_b16 a[126:127], v247 offset:37632
    ds_read_b64_tr_b16 a[128:129], v246 offset:40960
    v_mfma_f32_16x16x32_bf16 v[96:99], v[168:171], v[144:147], v[96:99]
    ds_write_b128 v232, v[40:43] offset:1024
    s_waitcnt vmcnt(10)
    v_mfma_f32_16x16x32_bf16 v[32:35], a[16:19], v[148:151], v[32:35]
    ds_read_b64_tr_b16 a[130:131], v246 offset:41472
    v_mfma_f32_16x16x32_bf16 v[48:51], a[20:23], v[148:151], v[48:51]
    ds_read_b64_tr_b16 a[132:133], v247 offset:40960
    v_mfma_f32_16x16x32_bf16 v[64:67], a[24:27], v[148:151], v[64:67]
    ds_read_b64_tr_b16 a[134:135], v247 offset:41472
    v_mfma_f32_16x16x32_bf16 v[80:83], a[28:31], v[148:151], v[80:83]
    ds_read_b64_tr_b16 a[136:137], v246 offset:41216
    v_mfma_f32_16x16x32_bf16 v[96:99], v[172:175], v[148:151], v[96:99]
    ds_write_b128 v232, v[44:47] offset:2048
    s_waitcnt vmcnt(9)
    v_mfma_f32_16x16x32_bf16 v[32:35], a[32:35], v[152:155], v[32:35]
    ds_read_b64_tr_b16 a[138:139], v246 offset:41728
    v_mfma_f32_16x16x32_bf16 v[48:51], a[36:39], v[152:155], v[48:51]
    ds_read_b64_tr_b16 a[140:141], v247 offset:41216
    v_mfma_f32_16x16x32_bf16 v[64:67], a[40:43], v[152:155], v[64:67]
    ds_read_b64_tr_b16 a[142:143], v247 offset:41728
    v_mfma_f32_16x16x32_bf16 v[80:83], a[44:47], v[152:155], v[80:83]
    ds_read_b64_tr_b16 a[144:145], v246 offset:45056
    v_mfma_f32_16x16x32_bf16 v[96:99], v[192:195], v[152:155], v[96:99]
    ds_read_b64_tr_b16 a[146:147], v246 offset:45568
    s_waitcnt vmcnt(8)
    v_mfma_f32_16x16x32_bf16 v[32:35], a[48:51], v[156:159], v[32:35]
    ds_read_b64_tr_b16 a[148:149], v247 offset:45056
    v_mfma_f32_16x16x32_bf16 v[48:51], a[52:55], v[156:159], v[48:51]
    ds_read_b64_tr_b16 a[150:151], v247 offset:45568
    v_mfma_f32_16x16x32_bf16 v[64:67], a[56:59], v[156:159], v[64:67]
    ds_read_b64_tr_b16 a[152:153], v246 offset:45312
    v_mfma_f32_16x16x32_bf16 v[80:83], a[60:63], v[156:159], v[80:83]
    ds_read_b64_tr_b16 a[154:155], v246 offset:45824
    v_mfma_f32_16x16x32_bf16 v[96:99], v[196:199], v[156:159], v[96:99]
    s_waitcnt lgkmcnt(9)
    s_barrier
    s_waitcnt vmcnt(7)
    v_mfma_f32_16x16x32_bf16 v[32:35], a[64:67], v[112:115], v[32:35]
    ds_read_b64_tr_b16 a[156:157], v247 offset:45312
    ds_read_b64_tr_b16 a[158:159], v247 offset:45824
    v_mfma_f32_16x16x32_bf16 v[48:51], a[68:71], v[112:115], v[48:51]
    ds_read_b64_tr_b16 a[160:161], v248 offset:49152
    ds_read_b64_tr_b16 a[162:163], v248 offset:49664
    v_mfma_f32_16x16x32_bf16 v[64:67], a[72:75], v[112:115], v[64:67]
    ds_read_b128 v[52:55], v233 offset:16384
    v_mfma_f32_16x16x32_bf16 v[80:83], a[76:79], v[112:115], v[80:83]
    ds_read_b128 v[56:59], v234 offset:17408
    v_mfma_f32_16x16x32_bf16 v[96:99], v[200:203], v[112:115], v[96:99]
    ds_read_b128 v[60:63], v235 offset:18432
    s_waitcnt vmcnt(6)
    v_mfma_f32_16x16x32_bf16 v[32:35], a[80:83], v[116:119], v[32:35]
    ds_read_b64_tr_b16 a[164:165], v249 offset:49152
    ds_read_b64_tr_b16 a[166:167], v249 offset:49664
    v_mfma_f32_16x16x32_bf16 v[48:51], a[84:87], v[116:119], v[48:51]
    ds_read_b64_tr_b16 a[168:169], v248 offset:49408
    ds_read_b64_tr_b16 a[170:171], v248 offset:49920
    v_mfma_f32_16x16x32_bf16 v[64:67], a[88:91], v[116:119], v[64:67]
    ds_read_b128 v[36:39], v233 offset:0
    v_mfma_f32_16x16x32_bf16 v[80:83], a[92:95], v[116:119], v[80:83]
    ds_read_b128 v[40:43], v234 offset:1024
    v_mfma_f32_16x16x32_bf16 v[96:99], v[204:207], v[116:119], v[96:99]
    ds_read_b128 v[44:47], v235 offset:2048
    s_waitcnt vmcnt(5)
    v_mfma_f32_16x16x32_bf16 v[32:35], a[96:99], v[120:123], v[32:35]
    ds_read_b64_tr_b16 a[172:173], v249 offset:49408
    v_mfma_f32_16x16x32_bf16 v[48:51], a[100:103], v[120:123], v[48:51]
    ds_read_b64_tr_b16 a[174:175], v249 offset:49920
    v_mfma_f32_16x16x32_bf16 v[64:67], a[104:107], v[120:123], v[64:67]
    ds_read_b64_tr_b16 a[176:177], v248 offset:50176
    v_mfma_f32_16x16x32_bf16 v[80:83], a[108:111], v[120:123], v[80:83]
    ds_read_b64_tr_b16 a[178:179], v248 offset:50688
    v_mfma_f32_16x16x32_bf16 v[96:99], v[100:103], v[120:123], v[96:99]
    ds_read_b64_tr_b16 a[180:181], v249 offset:50176
    s_waitcnt vmcnt(4)
    v_mfma_f32_16x16x32_bf16 v[32:35], a[112:115], v[124:127], v[32:35]
    ds_read_b64_tr_b16 a[182:183], v249 offset:50688
    v_mfma_f32_16x16x32_bf16 v[48:51], a[116:119], v[124:127], v[48:51]
    ds_read_b64_tr_b16 a[184:185], v248 offset:50432
    v_mfma_f32_16x16x32_bf16 v[64:67], a[120:123], v[124:127], v[64:67]
    ds_read_b64_tr_b16 a[186:187], v248 offset:50944
    v_mfma_f32_16x16x32_bf16 v[80:83], a[124:127], v[124:127], v[80:83]
    ds_read_b64_tr_b16 a[188:189], v249 offset:50432
    v_mfma_f32_16x16x32_bf16 v[96:99], v[104:107], v[124:127], v[96:99]
    ds_read_b64_tr_b16 a[190:191], v249 offset:50944
    s_waitcnt lgkmcnt(15)
    s_waitcnt vmcnt(3)
    v_mfma_f32_16x16x32_bf16 v[32:35], a[128:131], v[128:131], v[32:35]
    v_mfma_f32_16x16x32_bf16 v[48:51], a[132:135], v[128:131], v[48:51]
    v_add_f32 v52, v52, v56
    v_mfma_f32_16x16x32_bf16 v[64:67], a[136:139], v[128:131], v[64:67]
    v_add_f32 v53, v53, v57
    v_mfma_f32_16x16x32_bf16 v[80:83], a[140:143], v[128:131], v[80:83]
    v_add_f32 v54, v54, v58
    v_mfma_f32_16x16x32_bf16 v[96:99], v[108:111], v[128:131], v[96:99]
    v_add_f32 v55, v55, v59
    s_waitcnt vmcnt(2)
    v_mfma_f32_16x16x32_bf16 v[32:35], a[144:147], v[132:135], v[32:35]
    v_add_f32 v52, v52, v60
    v_mfma_f32_16x16x32_bf16 v[48:51], a[148:151], v[132:135], v[48:51]
    v_add_f32 v53, v53, v61
    v_mfma_f32_16x16x32_bf16 v[64:67], a[152:155], v[132:135], v[64:67]
    v_add_f32 v54, v54, v62
    v_mfma_f32_16x16x32_bf16 v[80:83], a[156:159], v[132:135], v[80:83]
    v_add_f32 v55, v55, v63
    v_mfma_f32_16x16x32_bf16 v[96:99], v[84:87], v[132:135], v[96:99]
    s_waitcnt lgkmcnt(10)
    s_waitcnt lgkmcnt(8)
    s_waitcnt vmcnt(1)
    v_mfma_f32_16x16x32_bf16 v[32:35], a[160:163], v[136:139], v[32:35]
    v_add_f32 v36, v36, v40
    v_mfma_f32_16x16x32_bf16 v[48:51], a[164:167], v[136:139], v[48:51]
    v_add_f32 v37, v37, v41
    v_mfma_f32_16x16x32_bf16 v[64:67], a[168:171], v[136:139], v[64:67]
    v_add_f32 v38, v38, v42
    v_mfma_f32_16x16x32_bf16 v[80:83], a[172:175], v[136:139], v[80:83]
    v_add_f32 v39, v39, v43
    v_mfma_f32_16x16x32_bf16 v[96:99], v[88:91], v[136:139], v[96:99]
    v_add_f32 v36, v36, v44
    s_waitcnt lgkmcnt(0)
    s_waitcnt vmcnt(0)
    v_mfma_f32_16x16x32_bf16 v[32:35], a[176:179], v[140:143], v[32:35]
    v_add_f32 v37, v37, v45
    v_mfma_f32_16x16x32_bf16 v[48:51], a[180:183], v[140:143], v[48:51]
    v_add_f32 v38, v38, v46
    v_mfma_f32_16x16x32_bf16 v[64:67], a[184:187], v[140:143], v[64:67]
    v_add_f32 v39, v39, v47
    v_mfma_f32_16x16x32_bf16 v[80:83], a[188:191], v[140:143], v[80:83]
    v_mfma_f32_16x16x32_bf16 v[96:99], v[92:95], v[140:143], v[96:99]
    s_nop 0
    v_pk_add_f32 v[32:33], v[32:33], v[36:37]
    v_pk_add_f32 v[34:35], v[34:35], v[38:39]
    v_pk_add_f32 v[48:49], v[48:49], v[52:53]
    v_pk_add_f32 v[50:51], v[50:51], v[54:55]
    v_cvt_pk_bf16_f32 v176, v32, v33
    v_cvt_pk_bf16_f32 v177, v34, v35
    ds_write_b64 v238, v[176:177] offset:0
    v_cvt_pk_bf16_f32 v178, v48, v49
    v_cvt_pk_bf16_f32 v179, v50, v51
    ds_write_b64 v238, v[178:179] offset:32
    v_cvt_pk_bf16_f32 v180, v64, v65
    v_cvt_pk_bf16_f32 v181, v66, v67
    ds_write_b64 v238, v[180:181] offset:64
    v_cvt_pk_bf16_f32 v182, v80, v81
    v_cvt_pk_bf16_f32 v183, v82, v83
    ds_write_b64 v238, v[182:183] offset:96
    ds_read_b128 v[216:219], v244 offset:0
    ds_read_b128 v[220:223], v244 offset:1408
    v_cvt_pk_bf16_f32 v184, v96, v97
    v_cvt_pk_bf16_f32 v185, v98, v99
    ds_write_b64 v238, v[184:185] offset:128
    ds_read_b64 v[224:225], v252 offset:128
    s_waitcnt lgkmcnt(3)
    buffer_store_dwordx4 v[216:219], v22, s[28:31], s71 offen
    s_waitcnt lgkmcnt(2)
    buffer_store_dwordx4 v[220:223], v22, s[28:31], s72 offen
    s_waitcnt lgkmcnt(0)
    buffer_store_dwordx2 v[224:225], v26, s[28:31], s73 offen
L_end:
    s_endpgm
L_p2_alt:
    s_add_u32 s57, s57, 27648
    buffer_load_dwordx4 v11, s[16:19], s57 offen offset:3072 lds
    s_xor_b32 s66, s44, 3
    s_lshl2_add_u32 s66, s51, s66
    s_mul_i32 s66, s66, 66816
    s_lshl2_add_u32 s66, s52, s66
    s_lshl_b32 s86, s65, 10
    s_add_u32 s58, s86, s66
    s_add_u32 s86, s66, 14336
    buffer_load_dwordx4 v[128:131], v23, s[24:27], s58 offen offset:0 sc1
    s_add_u32 s58, s58, 1024
    s_cmp_eq_u32 s58, s86
    s_cselect_b32 s58, s66, s58
    buffer_load_dwordx4 v[132:135], v23, s[24:27], s58 offen offset:0 sc1
    s_add_u32 s58, s58, 1024
    s_cmp_eq_u32 s58, s86
    s_cselect_b32 s58, s66, s58
    buffer_load_dwordx4 v[136:139], v23, s[24:27], s58 offen offset:0 sc1
    s_add_u32 s58, s58, 1024
    s_cmp_eq_u32 s58, s86
    s_cselect_b32 s58, s66, s58
    buffer_load_dwordx4 v[140:143], v23, s[24:27], s58 offen offset:0 sc1
    s_add_u32 s58, s58, 1024
    s_cmp_eq_u32 s58, s86
    s_cselect_b32 s58, s66, s58
    buffer_load_dwordx4 v[144:147], v23, s[24:27], s58 offen offset:0 sc1
    s_add_u32 s58, s58, 1024
    s_cmp_eq_u32 s58, s86
    s_cselect_b32 s58, s66, s58
    buffer_load_dwordx4 v[148:151], v23, s[24:27], s58 offen offset:0 sc1
    s_add_u32 s58, s58, 1024
    s_cmp_eq_u32 s58, s86
    s_cselect_b32 s58, s66, s58
    buffer_load_dwordx4 v[152:155], v23, s[24:27], s58 offen offset:0 sc1
    s_add_u32 s58, s58, 1024
    s_cmp_eq_u32 s58, s86
    s_cselect_b32 s58, s66, s58
    buffer_load_dwordx4 v[156:159], v23, s[24:27], s58 offen offset:0 sc1
    s_add_u32 s58, s58, 1024
    s_cmp_eq_u32 s58, s86
    s_cselect_b32 s58, s66, s58
    buffer_load_dwordx4 v[112:115], v23, s[24:27], s58 offen offset:0 sc1
    s_add_u32 s58, s58, 1024
    s_cmp_eq_u32 s58, s86
    s_cselect_b32 s58, s66, s58
    buffer_load_dwordx4 v[116:119], v23, s[24:27], s58 offen offset:0 sc1
    s_add_u32 s58, s58, 1024
    s_cmp_eq_u32 s58, s86
    s_cselect_b32 s58, s66, s58
    buffer_load_dwordx4 v[120:123], v23, s[24:27], s58 offen offset:0 sc1
    s_waitcnt vmcnt(19)
    ds_read_b64_tr_b16 a[208:209], v4 offset:32768
    ds_read_b64_tr_b16 a[210:211], v4 offset:33280
    ds_read_b64_tr_b16 a[212:213], v5 offset:32768
    ds_read_b64_tr_b16 a[214:215], v5 offset:33280
    ds_read_b64_tr_b16 a[216:217], v4 offset:33024
    ds_read_b64_tr_b16 a[218:219], v4 offset:33536
    ds_read_b64_tr_b16 a[220:221], v5 offset:33024
    ds_read_b64_tr_b16 a[222:223], v5 offset:33536
    s_waitcnt vmcnt(15)
    ds_read_b64_tr_b16 a[224:225], v2 offset:0
    ds_read_b64_tr_b16 a[226:227], v2 offset:512
    ds_read_b64_tr_b16 a[228:229], v3 offset:0
    ds_read_b64_tr_b16 a[230:231], v3 offset:512
    ds_read_b64_tr_b16 a[232:233], v2 offset:256
    ds_read_b64_tr_b16 a[234:235], v2 offset:768
    ds_read_b64_tr_b16 a[236:237], v3 offset:256
    ds_read_b64_tr_b16 a[238:239], v3 offset:768
    s_waitcnt vmcnt(11)
    ds_read_b64_tr_b16 a[240:241], v2 offset:16384
    ds_read_b64_tr_b16 a[242:243], v2 offset:16896
    ds_read_b64_tr_b16 a[244:245], v3 offset:16384
    ds_read_b64_tr_b16 a[246:247], v3 offset:16896
    ds_read_b64_tr_b16 a[248:249], v2 offset:16640
    ds_read_b64_tr_b16 a[250:251], v2 offset:17152
    ds_read_b64_tr_b16 a[252:253], v3 offset:16640
    ds_read_b64_tr_b16 a[254:255], v3 offset:17152
    s_waitcnt lgkmcnt(0)
    s_branch L_p2_join
L_p3_alt:
    s_add_u32 s66, s69, 175872
    s_add_u32 s58, s66, s76
    buffer_load_dwordx4 v[152:155], v23, s[24:27], s58 offen offset:0 sc1
    buffer_load_dwordx4 v[156:159], v23, s[24:27], s58 offen offset:1024 sc1
    s_add_u32 s58, s66, s77
    buffer_load_dwordx4 v[112:115], v23, s[24:27], s58 offen offset:0 sc1
    buffer_load_dwordx4 v[116:119], v23, s[24:27], s58 offen offset:1024 sc1
    s_add_u32 s58, s66, s78
    buffer_load_dwordx4 v[120:123], v23, s[24:27], s58 offen offset:0 sc1
    buffer_load_dwordx4 v[124:127], v23, s[24:27], s58 offen offset:1024 sc1
    s_add_u32 s58, s66, s79
    buffer_load_dwordx4 v[128:131], v23, s[24:27], s58 offen offset:0 sc1
    buffer_load_dwordx4 v[132:135], v23, s[24:27], s58 offen offset:1024 sc1
    s_add_u32 s58, s66, s80
    buffer_load_dwordx4 v[136:139], v23, s[24:27], s58 offen offset:0 sc1
    buffer_load_dwordx4 v[140:143], v23, s[24:27], s58 offen offset:1024 sc1
    s_add_u32 s58, s66, s81
    buffer_load_dwordx4 v[144:147], v23, s[24:27], s58 offen offset:0 sc1
    s_waitcnt vmcnt(11) lgkmcnt(0)
    s_branch L_p3_join
L_help:
    s_sub_u32 s55, s46, 21
    v_lshlrev_b32 v217, 7, v1
    v_lshrrev_b32 v218, 2, v1
    v_lshlrev_b32 v218, 12, v218
    v_lshl_add_u32 v218, v210, 7, v218
    v_mul_u32_u24 v220, 3584, v1
    s_lshl4_add_u32 s54, s44, s65
    s_mul_i32 s54, s54, 114688
    s_lshl_b32 s56, s50, 7
    s_add_u32 s54, s54, s56
    buffer_load_dword v108, v220, s[16:19], s54 offen
    v_mul_u32_u24 v109, 1088, v25
    v_lshl_add_u32 v109, v26, 4, v109
    v_mul_u32_u24 v110, 1088, v209
    v_lshl_add_u32 v110, v208, 5, v110
    v_lshl_add_u32 v110, v210, 3, v110
    s_lshl_b32 s53, s44, 7
    v_add_u32 v110, s53, v110
    v_mul_u32_u24 v111, 66816, v208
    v_lshl_add_u32 v111, v211, 4, v111
    s_mul_i32 s63, s44, 267264
    s_lshl_b32 s53, s2, 8
    s_add_u32 s63, s63, s53
    s_add_u32 s64, s63, 1069056
    v_cmp_gt_u32 vcc, 208, v0
    v_mov_b32 v100, 2130706432
    v_cmp_le_u32 s[92:93], 24, v26
    v_cndmask_b32 v22, v100, v111, vcc
    s_mov_b32 s62, 0x3f803f80
    s_mov_b32 s61, 0xffff0000
    v_mov_b32 v96, 0
    v_mov_b32 v97, 0
    s_waitcnt vmcnt(3)
    v_dot2c_f32_bf16 v96, s62, v32
    v_dot2c_f32_bf16 v97, v32, v32
    v_lshlrev_b32 v40, 16, v32
    v_and_b32 v41, s61, v32
    v_dot2c_f32_bf16 v96, s62, v33
    v_dot2c_f32_bf16 v97, v33, v33
    v_lshlrev_b32 v42, 16, v33
    v_and_b32 v43, s61, v33
    v_dot2c_f32_bf16 v96, s62, v34
    v_dot2c_f32_bf16 v97, v34, v34
    v_lshlrev_b32 v44, 16, v34
    v_and_b32 v45, s61, v34
    v_dot2c_f32_bf16 v96, s62, v35
    v_dot2c_f32_bf16 v97, v35, v35
    v_lshlrev_b32 v46, 16, v35
    v_and_b32 v47, s61, v35
    s_waitcnt vmcnt(2)
    v_dot2c_f32_bf16 v96, s62, v36
    v_dot2c_f32_bf16 v97, v36, v36
    v_lshlrev_b32 v48, 16, v36
    v_and_b32 v49, s61, v36
    v_dot2c_f32_bf16 v96, s62, v37
    v_dot2c_f32_bf16 v97, v37, v37
    v_lshlrev_b32 v50, 16, v37
    v_and_b32 v51, s61, v37
    v_dot2c_f32_bf16 v96, s62, v38
    v_dot2c_f32_bf16 v97, v38, v38
    v_lshlrev_b32 v52, 16, v38
    v_and_b32 v53, s61, v38
    v_dot2c_f32_bf16 v96, s62, v39
    v_dot2c_f32_bf16 v97, v39, v39
    v_lshlrev_b32 v54, 16, v39
    v_and_b32 v55, s61, v39
    buffer_load_dword v29, off, s[40:43], 0 sc1
    v_add_f32_dpp v96, v96, v96 quad_perm:[1,0,3,2] row_mask:0xf bank_mask:0xf
    v_add_f32_dpp v97, v97, v97 quad_perm:[1,0,3,2] row_mask:0xf bank_mask:0xf
    s_nop 0
    v_add_f32_dpp v96, v96, v96 quad_perm:[2,3,0,1] row_mask:0xf bank_mask:0xf
    v_add_f32_dpp v97, v97, v97 quad_perm:[2,3,0,1] row_mask:0xf bank_mask:0xf
    s_nop 0
    v_add_f32_dpp v96, v96, v96 row_half_mirror row_mask:0xf bank_mask:0xf
    v_add_f32_dpp v97, v97, v97 row_half_mirror row_mask:0xf bank_mask:0xf
    s_nop 0
    v_add_f32_dpp v96, v96, v96 row_mirror row_mask:0xf bank_mask:0xf
    v_add_f32_dpp v97, v97, v97 row_mirror row_mask:0xf bank_mask:0xf
    v_mov_b32 v98, v96
    v_mov_b32 v99, v97
    s_nop 0
    v_permlane16_swap_b32 v96, v98
    v_permlane16_swap_b32 v97, v99
    v_add_f32 v96, v96, v98
    v_add_f32 v97, v97, v99
    v_mul_f32 v98, 0x3b124925, v96
    v_mul_f32 v99, 0x3b124925, v97
    v_fma_f32 v99, -v98, v98, v99
    v_max_f32 v99, 0, v99
    v_cvt_pk_bf16_f32 v100, 0, v99
    v_add_f32 v100, 0x3727c5ac, v100
    v_cvt_pk_bf16_f32 v100, 0, v100
    v_sqrt_f32 v100, v100
    s_nop 0
    v_cvt_pk_bf16_f32 v100, 0, v100
    v_rcp_f32 v100, v100
    s_nop 0
    v_mul_f32 v99, v99, v100
    v_mul_f32 v99, v99, v100
    v_cvt_pk_bf16_f32 v104, 0, v99
    v_add_f32 v104, 0x3727c5ac, v104
    v_cvt_pk_bf16_f32 v104, 0, v104
    v_sqrt_f32 v104, v104
    s_nop 0
    v_cvt_pk_bf16_f32 v102, 0, v104
    v_rcp_f32 v104, v102
    s_nop 0
    v_mul_f32 v104, v104, v100
    v_mul_f32 v106, v98, v104
    v_pk_fma_f32 v[56:57], v[40:41], v[104:105], v[106:107] op_sel_hi:[1,0,0] neg_lo:[0,0,1] neg_hi:[0,0,1]
    v_pk_fma_f32 v[58:59], v[42:43], v[104:105], v[106:107] op_sel_hi:[1,0,0] neg_lo:[0,0,1] neg_hi:[0,0,1]
    v_pk_fma_f32 v[60:61], v[44:45], v[104:105], v[106:107] op_sel_hi:[1,0,0] neg_lo:[0,0,1] neg_hi:[0,0,1]
    v_pk_fma_f32 v[62:63], v[46:47], v[104:105], v[106:107] op_sel_hi:[1,0,0] neg_lo:[0,0,1] neg_hi:[0,0,1]
    v_pk_fma_f32 v[64:65], v[48:49], v[104:105], v[106:107] op_sel_hi:[1,0,0] neg_lo:[0,0,1] neg_hi:[0,0,1]
    v_pk_fma_f32 v[66:67], v[50:51], v[104:105], v[106:107] op_sel_hi:[1,0,0] neg_lo:[0,0,1] neg_hi:[0,0,1]
    v_pk_fma_f32 v[68:69], v[52:53], v[104:105], v[106:107] op_sel_hi:[1,0,0] neg_lo:[0,0,1] neg_hi:[0,0,1]
    v_pk_fma_f32 v[70:71], v[54:55], v[104:105], v[106:107] op_sel_hi:[1,0,0] neg_lo:[0,0,1] neg_hi:[0,0,1]
    v_cvt_pk_bf16_f32 v80, v56, v57
    v_cvt_pk_bf16_f32 v81, v58, v59
    v_cvt_pk_bf16_f32 v82, v60, v61
    v_cvt_pk_bf16_f32 v83, v62, v63
    v_cvt_pk_bf16_f32 v84, v64, v65
    v_cvt_pk_bf16_f32 v85, v66, v67
    v_cvt_pk_bf16_f32 v86, v68, v69
    v_cvt_pk_bf16_f32 v87, v70, v71
    v_lshrrev_b32 v102, 16, v102
    v_cndmask_b32 v84, v84, v102, s[92:93]
    ds_write_b128 v109, v[80:83] offset:0
    ds_write_b128 v109, v[84:87] offset:512
    s_waitcnt lgkmcnt(0)
    s_barrier
    ds_read_b64_tr_b16 v[88:89], v110 offset:0
    ds_read_b64_tr_b16 v[90:91], v110 offset:4352
    ds_read_b64_tr_b16 v[92:93], v110 offset:512
    ds_read_b64_tr_b16 v[94:95], v110 offset:4864
    s_waitcnt lgkmcnt(2)
    buffer_store_dwordx4 v[88:91], v111, s[24:27], s63 offen sc1
    s_waitcnt lgkmcnt(0)
    buffer_store_dwordx4 v[92:95], v22, s[24:27], s64 offen sc1
    v_min_u32 v220, 111104, v220
    s_add_u32 s54, s54, 229376
    buffer_load_dword v108, v220, s[16:19], s54 offen
    s_waitcnt vmcnt(1)
    v_cmp_eq_u32 vcc, 0, v29
    s_nop 0
    s_cbranch_vccz L_ok12
    s_mov_b32 s59, 100000
L_spin11:
    buffer_load_dword v29, off, s[40:43], 0 sc1
    s_waitcnt vmcnt(0)
    v_cmp_eq_u32 vcc, 0, v29
    s_nop 0
    s_cbranch_vccz L_ok12
    s_sub_u32 s59, s59, 1
    s_cbranch_scc0 L_spin11
L_ok12:
    v_readfirstlane_b32 s47, v29
    s_barrier
    s_cmp_lg_u32 s44, 0
    s_cbranch_scc1 L_nopub13
    s_lshl_b32 s60, s2, 5
    s_add_u32 s60, s60, 12582912
    v_mov_b32 v30, s47
    s_mov_b64 exec, 1
    buffer_store_dword v30, off, s[24:27], s60 sc1
    s_mov_b64 exec, -1
L_nopub13:
    s_lshl_b32 s3, s45, 9
    v_min_u32 v223, 384, v217
    buffer_load_dword v108, v223, s[36:39], s3 offen
    v_lshrrev_b32 v219, 2, v1
    v_min_u32 v219, 10, v219
    v_mul_u32_u24 v219, 3584, v219
    v_lshl_add_u32 v219, v210, 7, v219
    s_mul_i32 s54, s55, 11
    s_lshl_b32 s56, s44, 9
    s_add_u32 s54, s54, s56
    s_add_u32 s54, s54, 448
    s_mul_i32 s54, s54, 3584
    s_mul_i32 s56, s45, 7
    s_lshr_b32 s56, s56, 1
    s_lshl_b32 s56, s56, 7
    s_add_u32 s54, s54, s56
    buffer_load_dword v108, v219, s[16:19], s54 offen
    s_add_u32 s54, s54, 118272
    buffer_load_dword v108, v219, s[16:19], s54 offen
    s_add_u32 s54, s54, 118272
    s_lshl_b32 s54, s44, 11
    s_add_u32 s54, s54, 12582912
    v_lshl_add_u32 v221, v1, 5, s54
    buffer_load_dword v222, v221, s[24:27], 0 offen sc1
    s_waitcnt vmcnt(0)
    v_cmp_ne_u32 vcc, s47, v222
    s_nop 0
    s_cbranch_vccz L_ok15
    s_mov_b32 s59, 100000
L_spin14:
    buffer_load_dword v222, v221, s[24:27], 0 offen sc1
    s_waitcnt vmcnt(0)
    v_cmp_ne_u32 vcc, s47, v222
    s_nop 0
    s_cbranch_vccz L_ok15
    s_sub_u32 s59, s59, 1
    s_cbranch_scc0 L_spin14
L_ok15:
    s_add_u32 s54, s55, 0
    s_lshr_b32 s56, s54, 1
    s_add_u32 s56, s56, 24
    s_mul_i32 s56, s56, 66816
    s_lshl2_add_u32 s56, s52, s56
    s_and_b32 s54, s54, 1
    s_lshl_b32 s54, s54, 13
    s_add_u32 s56, s56, s54
    buffer_load_dword v108, v217, s[24:27], s56 offen sc1
    s_add_u32 s54, s55, 3
    s_lshr_b32 s56, s54, 1
    s_add_u32 s56, s56, 24
    s_mul_i32 s56, s56, 66816
    s_lshl2_add_u32 s56, s52, s56
    s_and_b32 s54, s54, 1
    s_lshl_b32 s54, s54, 13
    s_add_u32 s56, s56, s54
    buffer_load_dword v108, v217, s[24:27], s56 offen sc1
    s_add_u32 s54, s55, 6
    s_lshr_b32 s56, s54, 1
    s_add_u32 s56, s56, 24
    s_mul_i32 s56, s56, 66816
    s_lshl2_add_u32 s56, s52, s56
    s_and_b32 s54, s54, 1
    s_lshl_b32 s54, s54, 13
    s_add_u32 s56, s56, s54
    s_cmp_lt_u32 s55, 2
    s_cselect_b32 s56, s56, 2130706432
    buffer_load_dword v108, v217, s[24:27], s56 offen sc1
    s_mul_i32 s54, s44, 28
    s_add_u32 s54, s54, s55
    s_add_u32 s54, s54, 0
    s_lshl_b32 s54, s54, 16
    s_lshl_b32 s56, s45, 9
    s_add_u32 s54, s54, s56
    buffer_load_dword v108, v218, s[20:23], s54 offen
    s_add_u32 s54, s54, 196608
    buffer_load_dword v108, v218, s[20:23], s54 offen
    s_add_u32 s54, s54, 196608
    buffer_load_dword v108, v218, s[20:23], s54 offen
    s_add_u32 s54, s54, 196608
    buffer_load_dword v108, v218, s[20:23], s54 offen
    s_add_u32 s54, s54, 196608
    s_waitcnt vmcnt(0) lgkmcnt(0)
    v_lshlrev_b32 v216, 6, v209
    v_lshl_add_u32 v216, v210, 3, v216
    v_lshl_add_u32 v216, v215, 5, v216
    s_add_u32 s53, s52, 49152
    v_lshl_add_u32 v2, v208, 10, v216
    v_add_u32 v2, s53, v2
    v_xor_b32 v3, 32, v2
    v_add_u32 v4, 65536, v2
    v_add_u32 v5, 65536, v3
    v_lshl_add_u32 v6, v208, 9, v216
    v_add_u32 v6, s53, v6
    v_xor_b32 v7, 32, v6
    v_add_u32 v8, 65536, v6
    v_add_u32 v9, 65536, v7
    s_lshr_b32 s53, s46, 2
    s_and_b32 s89, s46, 3
    s_bfe_u32 s54, s46, 0x20001
    s_and_b32 s55, s46, 1
    s_add_u32 s55, s55, 4
    s_cmp_lt_u32 s46, 16
    s_cselect_b32 s53, s53, s54
    s_cselect_b32 s89, s89, s55
    s_mul_i32 s49, s53, 2
    s_add_u32 s49, s49, s89
    s_sub_u32 s54, s49, 6
    s_min_u32 s49, s49, s54
    s_or_b32 s89, s89, 0
    s_lshl2_add_u32 s48, s45, s53
    s_mul_i32 s53, s44, 1835008
    s_lshl_b32 s74, s48, 7
    s_add_u32 s53, s53, s74
    s_lshl_b32 s56, s44, 5
    v_lshlrev_b32 v217, 5, v212
    v_xor_b32 v217, v217, v214
    v_xor_b32 v217, s56, v217
    s_add_u32 s74, s74, s56
    v_lshlrev_b32 v12, 12, v213
    v_add3_u32 v12, v12, v217, s53
    s_mul_i32 s53, s44, 28672
    s_lshl_b32 s54, s49, 7
    s_add_u32 s55, s53, s54
    v_mul_u32_u24 v13, 896, v213
    v_add3_u32 v13, v13, v214, s55
    v_xor_b32 v14, 32, v13
    s_mul_i32 s55, s44, 21504
    v_subrev_u32 v239, s55, v13
    s_and_b32 s55, s56, 32
    v_xor_b32 v239, s55, v239
    s_mul_i32 s73, s48, 57344
    s_add_u32 s71, s73, s54
    s_mul_i32 s55, s44, 14336
    s_add_u32 s71, s71, s55
    s_add_u32 s72, s71, 7168
    v_bfe_u32 v217, v1, 1, 2
    v_lshl_add_u32 v217, v212, 2, v217
    v_and_b32 v218, 24, v1
    v_add_u32 v217, v217, v218
    v_mul_u32_u24 v15, 896, v217
    v_and_b32 v217, 1, v1
    v_lshl_add_u32 v15, v217, 4, v15
    v_add_u32 v15, s53, v15
    s_lshl_b32 s54, s89, 5
    s_add_u32 s54, s54, 768
    s_add_u32 s68, s89, 24
    s_mul_i32 s68, s68, 58624
    s_mul_i32 s69, s44, 14336
    s_add_u32 s69, s69, 2097152
    s_add_u32 s68, s68, s69
    s_mul_i32 s55, s49, 234496
    s_add_u32 s69, s69, s55
    s_add_u32 s73, s73, s54
    s_mov_b32 s76, 0
    s_add_u32 s77, s76, 2048
    s_cmp_eq_u32 s77, 14336
    s_cselect_b32 s77, 0, s77
    s_add_u32 s78, s77, 2048
    s_cmp_eq_u32 s78, 14336
    s_cselect_b32 s78, 0, s78
    s_add_u32 s79, s78, 2048
    s_cmp_eq_u32 s79, 14336
    s_cselect_b32 s79, 0, s79
    s_add_u32 s80, s79, 2048
    s_cmp_eq_u32 s80, 14336
    s_cselect_b32 s80, 0, s80
    s_add_u32 s81, s80, 2048
    s_cmp_eq_u32 s81, 14336
    s_cselect_b32 s81, 0, s81
    s_add_u32 s82, s81, 2048
    s_cmp_eq_u32 s82, 14336
    s_cselect_b32 s82, 0, s82
    s_cmp_lt_u32 s89, 4
    s_cselect_b32 s75, s54, 2130706432
    s_cselect_b32 s68, s68, 2130706432
    s_cselect_b32 s73, s73, 2130706432
    v_lshlrev_b32 v16, 3, v1
    v_add_u32 v16, 81920, v16
    v_and_b32 v217, 7, v1
    v_min_u32 v218, 6, v217
    s_mul_i32 s54, s44, 7
    v_add_u32 v218, s54, v218
    v_mul_u32_u24 v219, 2, v218
    v_add_u32 v219, s89, v219
    v_mul_u32_u24 v220, 43, v219
    v_lshrrev_b32 v220, 8, v220
    v_mul_u32_u24 v220, 6, v220
    v_sub_u32 v219, v219, v220
    v_subrev_u32 v219, s49, v219
    v_bfe_u32 v220, v1, 3, 1
    v_mul_i32_i24 v219, v219, v220
    v_add_u32 v219, s49, v219
    v_lshl_add_u32 v218, v219, 5, v218
    v_lshlrev_b32 v20, 7, v218
    v_add_u32 v20, 12713984, v20
    s_lshr_b32 s53, s48, 1
    s_lshl_b32 s53, s53, 7
    s_add_u32 s53, s53, 12779520
    v_lshl_add_u32 v21, v210, 11, s53
    s_lshl_b32 s70, s48, 16
    s_lshl2_add_u32 s70, s52, s70
    s_add_u32 s70, s70, 4194304
    v_lshrrev_b32 v218, 3, v1
    v_mul_u32_u24 v22, 896, v218
    v_lshl_add_u32 v22, v217, 4, v22
    v_lshlrev_b32 v25, 1, v211
    s_add_u32 s53, s52, 65536
    v_mul_u32_u24 v244, 176, v218
    v_lshl_add_u32 v244, v217, 4, v244
    v_add_u32 v244, s53, v244
    v_mul_u32_u24 v238, 176, v211
    v_lshl_add_u32 v238, v208, 3, v238
    v_add_u32 v238, s53, v238
    v_lshrrev_b32 v218, 2, v0
    v_mul_u32_u24 v26, 896, v218
    v_lshl_add_u32 v26, v210, 3, v26
    v_lshrrev_b32 v218, 2, v1
    v_mul_u32_u24 v252, 176, v218
    v_lshl_add_u32 v252, v210, 3, v252
    v_add_u32 v252, s53, v252
    s_sub_u32 s53, 49152, s52
    v_add_u32 v246, s53, v2
    v_add_u32 v247, s53, v3
    v_mul_u32_u24 v218, 3072, v208
    v_add_u32 v248, v218, v246
    v_add_u32 v249, v218, v247
    v_add_u32 v232, s52, v23
    v_xor_b32 v233, 4096, v232
    v_xor_b32 v234, 8192, v232
    v_xor_b32 v235, 12288, v232
    buffer_load_dwordx4 v[216:219], v22, s[4:7], s71 offen
    buffer_load_dwordx4 v[220:223], v22, s[4:7], s72 offen
    buffer_load_dwordx2 v[224:225], v26, s[4:7], s73 offen
    buffer_load_ushort v228, v25, s[36:39], s74 offen
    s_waitcnt vmcnt(0)
    ds_write_b128 v244, v[216:219]
    ds_write_b128 v244, v[220:223] offset:1408
    ds_write_b64 v252, v[224:225] offset:128
    ds_read_b64 v[216:217], v238 offset:0
    ds_read_b64 v[218:219], v238 offset:32
    ds_read_b64 v[220:221], v238 offset:64
    ds_read_b64 v[222:223], v238 offset:96
    ds_read_b64 v[224:225], v238 offset:128
    s_add_u32 m0, s52, 81920
    s_lshl_b32 s57, s76, 7
    buffer_load_dwordx4 v12, s[20:23], s57 offen offset:0 lds
    s_add_u32 s57, s57, 31744
    buffer_load_dwordx4 v12, s[20:23], s57 offen offset:1024 lds
    s_add_u32 s57, s57, 31744
    buffer_load_dwordx4 v12, s[20:23], s57 offen offset:2048 lds
    s_add_u32 s57, s57, 31744
    buffer_load_dwordx4 v12, s[20:23], s57 offen offset:3072 lds
    s_add_u32 m0, s52, 98304
    s_lshl_b32 s57, s76, 7
    s_add_u32 s57, s57, 131072
    buffer_load_dwordx4 v12, s[20:23], s57 offen offset:0 lds
    s_add_u32 s57, s57, 31744
    buffer_load_dwordx4 v12, s[20:23], s57 offen offset:1024 lds
    s_add_u32 s57, s57, 31744
    buffer_load_dwordx4 v12, s[20:23], s57 offen offset:2048 lds
    s_add_u32 s57, s57, 31744
    buffer_load_dwordx4 v12, s[20:23], s57 offen offset:3072 lds
    s_add_u32 m0, s52, 114688
    s_lshl_b32 s57, s77, 7
    buffer_load_dwordx4 v12, s[20:23], s57 offen offset:0 lds
    s_add_u32 s57, s57, 31744
    buffer_load_dwordx4 v12, s[20:23], s57 offen offset:1024 lds
    s_add_u32 s57, s57, 31744
    buffer_load_dwordx4 v12, s[20:23], s57 offen offset:2048 lds
    s_add_u32 s57, s57, 31744
    buffer_load_dwordx4 v12, s[20:23], s57 offen offset:3072 lds
    s_add_u32 m0, s52, 131072
    s_lshl_b32 s57, s77, 7
    s_add_u32 s57, s57, 131072
    buffer_load_dwordx4 v12, s[20:23], s57 offen offset:0 lds
    s_add_u32 s57, s57, 31744
    buffer_load_dwordx4 v12, s[20:23], s57 offen offset:1024 lds
    s_waitcnt vmcnt(10)
    ds_read_b64_tr_b16 a[0:1], v6 offset:32768
    ds_read_b64_tr_b16 a[2:3], v6 offset:34816
    ds_read_b64_tr_b16 a[4:5], v7 offset:32768
    ds_read_b64_tr_b16 a[6:7], v7 offset:34816
    ds_read_b64_tr_b16 a[8:9], v6 offset:33024
    ds_read_b64_tr_b16 a[10:11], v6 offset:35072
    ds_read_b64_tr_b16 a[12:13], v7 offset:33024
    ds_read_b64_tr_b16 a[14:15], v7 offset:35072
    s_add_u32 s57, s57, 31744
    buffer_load_dwordx4 v12, s[20:23], s57 offen offset:2048 lds
    s_add_u32 s57, s57, 31744
    buffer_load_dwordx4 v12, s[20:23], s57 offen offset:3072 lds
    s_add_u32 m0, s52, 147456
    s_lshl_b32 s57, s78, 7
    buffer_load_dwordx4 v12, s[20:23], s57 offen offset:0 lds
    s_add_u32 s57, s57, 31744
    buffer_load_dwordx4 v12, s[20:23], s57 offen offset:1024 lds
    s_waitcnt vmcnt(10)
    ds_read_b64_tr_b16 a[16:17], v6 offset:49152
    ds_read_b64_tr_b16 a[18:19], v6 offset:51200
    ds_read_b64_tr_b16 a[20:21], v7 offset:49152
    ds_read_b64_tr_b16 a[22:23], v7 offset:51200
    ds_read_b64_tr_b16 a[24:25], v6 offset:49408
    ds_read_b64_tr_b16 a[26:27], v6 offset:51456
    ds_read_b64_tr_b16 a[28:29], v7 offset:49408
    ds_read_b64_tr_b16 a[30:31], v7 offset:51456
    s_add_u32 s57, s57, 31744
    buffer_load_dwordx4 v12, s[20:23], s57 offen offset:2048 lds
    s_add_u32 s57, s57, 31744
    buffer_load_dwordx4 v12, s[20:23], s57 offen offset:3072 lds
    s_add_u32 m0, s52, 49152
    s_lshl_b32 s57, s78, 7
    s_add_u32 s57, s57, 131072
    buffer_load_dwordx4 v12, s[20:23], s57 offen offset:0 lds
    s_add_u32 s57, s57, 31744
    buffer_load_dwordx4 v12, s[20:23], s57 offen offset:1024 lds
    s_waitcnt vmcnt(10)
    ds_read_b64_tr_b16 a[32:33], v8 offset:0
    ds_read_b64_tr_b16 a[34:35], v8 offset:2048
    ds_read_b64_tr_b16 a[36:37], v9 offset:0
    ds_read_b64_tr_b16 a[38:39], v9 offset:2048
    ds_read_b64_tr_b16 a[40:41], v8 offset:256
    ds_read_b64_tr_b16 a[42:43], v8 offset:2304
    ds_read_b64_tr_b16 a[44:45], v9 offset:256
    ds_read_b64_tr_b16 a[46:47], v9 offset:2304
    s_add_u32 s57, s57, 31744
    buffer_load_dwordx4 v12, s[20:23], s57 offen offset:2048 lds
    s_add_u32 s57, s57, 31744
    buffer_load_dwordx4 v12, s[20:23], s57 offen offset:3072 lds
    s_waitcnt lgkmcnt(15)
    s_add_u32 m0, s52, 65536
    s_lshl_b32 s57, s79, 7
    buffer_load_dwordx4 v12, s[20:23], s57 offen offset:0 lds
    s_add_u32 s57, s57, 31744
    buffer_load_dwordx4 v12, s[20:23], s57 offen offset:1024 lds
    s_waitcnt vmcnt(10)
    ds_read_b64_tr_b16 a[48:49], v8 offset:16384
    ds_read_b64_tr_b16 a[50:51], v8 offset:18432
    ds_read_b64_tr_b16 a[52:53], v9 offset:16384
    ds_read_b64_tr_b16 a[54:55], v9 offset:18432
    s_add_u32 s57, s57, 31744
    buffer_load_dwordx4 v12, s[20:23], s57 offen offset:2048 lds
    ds_read_b64_tr_b16 a[56:57], v8 offset:16640
    ds_read_b64_tr_b16 a[58:59], v8 offset:18688
    ds_read_b64_tr_b16 a[60:61], v9 offset:16640
    ds_read_b64_tr_b16 a[62:63], v9 offset:18688
    s_add_u32 s57, s57, 31744
    buffer_load_dwordx4 v12, s[20:23], s57 offen offset:3072 lds
    s_add_u32 m0, s52, 81920
    s_lshl_b32 s57, s79, 7
    s_add_u32 s57, s57, 131072
    buffer_load_dwordx4 v12, s[20:23], s57 offen offset:0 lds
    s_add_u32 s57, s57, 31744
    buffer_load_dwordx4 v12, s[20:23], s57 offen offset:1024 lds
    s_waitcnt vmcnt(10)
    ds_read_b64_tr_b16 a[64:65], v8 offset:32768
    ds_read_b64_tr_b16 a[66:67], v8 offset:34816
    ds_read_b64_tr_b16 a[68:69], v9 offset:32768
    ds_read_b64_tr_b16 a[70:71], v9 offset:34816
    s_add_u32 s57, s57, 31744
    buffer_load_dwordx4 v12, s[20:23], s57 offen offset:2048 lds
    ds_read_b64_tr_b16 a[72:73], v8 offset:33024
    ds_read_b64_tr_b16 a[74:75], v8 offset:35072
    ds_read_b64_tr_b16 a[76:77], v9 offset:33024
    ds_read_b64_tr_b16 a[78:79], v9 offset:35072
    s_add_u32 s57, s57, 31744
    buffer_load_dwordx4 v12, s[20:23], s57 offen offset:3072 lds
    s_waitcnt lgkmcnt(15)
    s_add_u32 m0, s52, 98304
    s_lshl_b32 s57, s80, 7
    buffer_load_dwordx4 v12, s[20:23], s57 offen offset:0 lds
    s_add_u32 s57, s57, 31744
    buffer_load_dwordx4 v12, s[20:23], s57 offen offset:1024 lds
    s_waitcnt vmcnt(10)
    ds_read_b64_tr_b16 a[80:81], v6 offset:0
    ds_read_b64_tr_b16 a[82:83], v6 offset:2048
    ds_read_b64_tr_b16 a[84:85], v7 offset:0
    ds_read_b64_tr_b16 a[86:87], v7 offset:2048
    s_add_u32 s57, s57, 31744
    buffer_load_dwordx4 v12, s[20:23], s57 offen offset:2048 lds
    ds_read_b64_tr_b16 a[88:89], v6 offset:256
    ds_read_b64_tr_b16 a[90:91], v6 offset:2304
    ds_read_b64_tr_b16 a[92:93], v7 offset:256
    ds_read_b64_tr_b16 a[94:95], v7 offset:2304
    s_waitcnt vmcnt(0) lgkmcnt(0)
    s_branch L_p3join
L_role_a:
    v_lshrrev_b32 v112, 4, v1
    v_bfe_u32 v113, v1, 2, 2
    v_and_b32 v114, 3, v1
    v_and_b32 v115, 15, v1
    v_lshrrev_b32 v116, 5, v1
    s_and_b32 s48, s45, 6
    s_lshr_b32 s48, 0xc9, s48
    s_and_b32 s48, s48, 3
    s_and_b32 s53, s45, 1
    s_lshl3_add_u32 s49, s53, s46
    s_sub_u32 s49, s49, 24
    s_lshl_b32 s90, s44, 11
    s_and_b32 s53, s44, 1
    s_lshl_b32 s53, s53, 1
    v_lshlrev_b32 v117, 2, v112
    v_sub_u32 v117, v115, v117
    v_and_b32 v117, 15, v117
    v_xor_b32 v117, s53, v117
    v_mul_u32_u24 v2, 2688, v112
    v_lshl_add_u32 v2, v117, 4, v2
    s_mul_i32 s53, s44, 21504
    s_mul_i32 s54, s48, 224
    s_andn2_b32 s54, s54, 63
    s_add_u32 s53, s53, s54
    v_add_u32 v2, s53, v2
    s_add_u32 m0, s90, 65536
    s_mov_b32 s57, 896
    buffer_load_dwordx4 v2, s[8:11], s57 offen offset:0 lds
    s_mov_b32 s57, 10624
    buffer_load_dwordx4 v2, s[8:11], s57 offen offset:1024 lds
    v_mul_u32_u24 v109, 1088, v25
    v_lshl_add_u32 v109, v26, 4, v109
    v_mul_u32_u24 v110, 1088, v113
    v_lshl_add_u32 v110, v112, 5, v110
    v_lshl_add_u32 v110, v114, 3, v110
    s_lshl_b32 s53, s44, 7
    v_add_u32 v110, s53, v110
    v_mul_u32_u24 v111, 66816, v112
    v_lshl_add_u32 v111, v115, 4, v111
    s_mul_i32 s63, s44, 267264
    s_lshl_b32 s53, s2, 8
    s_add_u32 s63, s63, s53
    s_add_u32 s64, s63, 1069056
    v_cmp_gt_u32 vcc, 208, v0
    v_mov_b32 v100, 2130706432
    v_cmp_le_u32 s[92:93], 24, v26
    v_cndmask_b32 v22, v100, v111, vcc
    s_mov_b32 s62, 0x3f803f80
    s_mov_b32 s61, 0xffff0000
    v_mov_b32 v96, 0
    v_mov_b32 v97, 0
    v_and_b32 v117, 1, v112
    v_lshlrev_b32 v117, 5, v117
    s_mul_i32 s53, s44, 56
    s_and_b32 s54, s48, 1
    s_lshl_b32 s54, s54, 5
    s_add_u32 s53, s53, s54
    v_lshlrev_b32 v118, 11, v112
    v_lshl_add_u32 v118, v113, 8, v118
    v_add_u32 v118, 65536, v118
    v_lshl_add_u32 v119, v114, 3, s53
    v_add_u32 v119, 0, v119
    v_xor_b32 v119, v119, v117
    v_lshl_add_u32 v119, v113, 6, v119
    v_and_b32 v119, 255, v119
    v_add_u32 v6, v118, v119
    v_add_u32 v10, 49152, v6
    v_subrev_u32 v120, 65536, v6
    v_lshl_add_u32 v119, v114, 3, s53
    v_add_u32 v119, 32, v119
    v_xor_b32 v119, v119, v117
    v_lshl_add_u32 v119, v113, 6, v119
    v_and_b32 v119, 255, v119
    v_add_u32 v7, v118, v119
    v_add_u32 v11, 49152, v7
    v_subrev_u32 v121, 65536, v7
    s_and_b32 s54, s44, 1
    s_lshl_b32 s54, s54, 3
    s_sub_u32 s53, s53, s54
    v_lshl_add_u32 v119, v114, 4, s53
    v_add_u32 v119, 0, v119
    v_xor_b32 v119, v119, v117
    v_lshl_add_u32 v119, v113, 6, v119
    v_and_b32 v119, 255, v119
    v_add_u32 v8, v118, v119
    v_add_u32 v12, 49152, v8
    v_subrev_u32 v122, 65536, v8
    v_lshl_add_u32 v119, v114, 4, s53
    v_add_u32 v119, 8, v119
    v_xor_b32 v119, v119, v117
    v_lshl_add_u32 v119, v113, 6, v119
    v_and_b32 v119, 255, v119
    v_add_u32 v9, v118, v119
    v_add_u32 v13, 49152, v9
    v_subrev_u32 v123, 65536, v9
    s_waitcnt vmcnt(4)
    v_dot2c_f32_bf16 v96, s62, v32
    v_dot2c_f32_bf16 v97, v32, v32
    v_lshlrev_b32 v40, 16, v32
    v_and_b32 v41, s61, v32
    v_dot2c_f32_bf16 v96, s62, v33
    v_dot2c_f32_bf16 v97, v33, v33
    v_lshlrev_b32 v42, 16, v33
    v_and_b32 v43, s61, v33
    v_dot2c_f32_bf16 v96, s62, v34
    v_dot2c_f32_bf16 v97, v34, v34
    v_lshlrev_b32 v44, 16, v34
    v_and_b32 v45, s61, v34
    v_dot2c_f32_bf16 v96, s62, v35
    v_dot2c_f32_bf16 v97, v35, v35
    v_lshlrev_b32 v46, 16, v35
    v_and_b32 v47, s61, v35
    s_waitcnt vmcnt(3)
    v_dot2c_f32_bf16 v96, s62, v36
    v_dot2c_f32_bf16 v97, v36, v36
    v_lshlrev_b32 v48, 16, v36
    v_and_b32 v49, s61, v36
    v_dot2c_f32_bf16 v96, s62, v37
    v_dot2c_f32_bf16 v97, v37, v37
    v_lshlrev_b32 v50, 16, v37
    v_and_b32 v51, s61, v37
    v_dot2c_f32_bf16 v96, s62, v38
    v_dot2c_f32_bf16 v97, v38, v38
    v_lshlrev_b32 v52, 16, v38
    v_and_b32 v53, s61, v38
    v_dot2c_f32_bf16 v96, s62, v39
    v_dot2c_f32_bf16 v97, v39, v39
    v_lshlrev_b32 v54, 16, v39
    v_and_b32 v55, s61, v39
    buffer_load_dword v29, off, s[40:43], 0 sc1
    v_add_f32_dpp v96, v96, v96 quad_perm:[1,0,3,2] row_mask:0xf bank_mask:0xf
    v_add_f32_dpp v97, v97, v97 quad_perm:[1,0,3,2] row_mask:0xf bank_mask:0xf
    s_nop 0
    v_add_f32_dpp v96, v96, v96 quad_perm:[2,3,0,1] row_mask:0xf bank_mask:0xf
    v_add_f32_dpp v97, v97, v97 quad_perm:[2,3,0,1] row_mask:0xf bank_mask:0xf
    s_nop 0
    v_add_f32_dpp v96, v96, v96 row_half_mirror row_mask:0xf bank_mask:0xf
    v_add_f32_dpp v97, v97, v97 row_half_mirror row_mask:0xf bank_mask:0xf
    s_nop 0
    v_add_f32_dpp v96, v96, v96 row_mirror row_mask:0xf bank_mask:0xf
    v_add_f32_dpp v97, v97, v97 row_mirror row_mask:0xf bank_mask:0xf
    v_mov_b32 v98, v96
    v_mov_b32 v99, v97
    s_nop 0
    v_permlane16_swap_b32 v96, v98
    v_permlane16_swap_b32 v97, v99
    v_add_f32 v96, v96, v98
    v_add_f32 v97, v97, v99
    v_mul_f32 v98, 0x3b124925, v96
    v_mul_f32 v99, 0x3b124925, v97
    v_fma_f32 v99, -v98, v98, v99
    v_max_f32 v99, 0, v99
    v_cvt_pk_bf16_f32 v100, 0, v99
    v_add_f32 v100, 0x3727c5ac, v100
    v_cvt_pk_bf16_f32 v100, 0, v100
    v_sqrt_f32 v100, v100
    s_nop 0
    v_cvt_pk_bf16_f32 v100, 0, v100
    v_rcp_f32 v100, v100
    s_nop 0
    v_mul_f32 v99, v99, v100
    v_mul_f32 v99, v99, v100
    v_cvt_pk_bf16_f32 v104, 0, v99
    v_add_f32 v104, 0x3727c5ac, v104
    v_cvt_pk_bf16_f32 v104, 0, v104
    v_sqrt_f32 v104, v104
    s_nop 0
    v_cvt_pk_bf16_f32 v102, 0, v104
    v_rcp_f32 v104, v102
    s_nop 0
    v_mul_f32 v104, v104, v100
    v_mul_f32 v106, v98, v104
    v_pk_fma_f32 v[56:57], v[40:41], v[104:105], v[106:107] op_sel_hi:[1,0,0] neg_lo:[0,0,1] neg_hi:[0,0,1]
    v_pk_fma_f32 v[58:59], v[42:43], v[104:105], v[106:107] op_sel_hi:[1,0,0] neg_lo:[0,0,1] neg_hi:[0,0,1]
    v_pk_fma_f32 v[60:61], v[44:45], v[104:105], v[106:107] op_sel_hi:[1,0,0] neg_lo:[0,0,1] neg_hi:[0,0,1]
    v_pk_fma_f32 v[62:63], v[46:47], v[104:105], v[106:107] op_sel_hi:[1,0,0] neg_lo:[0,0,1] neg_hi:[0,0,1]
    v_pk_fma_f32 v[64:65], v[48:49], v[104:105], v[106:107] op_sel_hi:[1,0,0] neg_lo:[0,0,1] neg_hi:[0,0,1]
    v_pk_fma_f32 v[66:67], v[50:51], v[104:105], v[106:107] op_sel_hi:[1,0,0] neg_lo:[0,0,1] neg_hi:[0,0,1]
    v_pk_fma_f32 v[68:69], v[52:53], v[104:105], v[106:107] op_sel_hi:[1,0,0] neg_lo:[0,0,1] neg_hi:[0,0,1]
    v_pk_fma_f32 v[70:71], v[54:55], v[104:105], v[106:107] op_sel_hi:[1,0,0] neg_lo:[0,0,1] neg_hi:[0,0,1]
    v_cvt_pk_bf16_f32 v80, v56, v57
    v_cvt_pk_bf16_f32 v81, v58, v59
    v_cvt_pk_bf16_f32 v82, v60, v61
    v_cvt_pk_bf16_f32 v83, v62, v63
    v_cvt_pk_bf16_f32 v84, v64, v65
    v_cvt_pk_bf16_f32 v85, v66, v67
    v_cvt_pk_bf16_f32 v86, v68, v69
    v_cvt_pk_bf16_f32 v87, v70, v71
    v_lshrrev_b32 v102, 16, v102
    v_cndmask_b32 v84, v84, v102, s[92:93]
    ds_write_b128 v109, v[80:83] offset:49152
    ds_write_b128 v109, v[84:87] offset:49664
    s_waitcnt lgkmcnt(0)
    s_barrier
    ds_read_b64_tr_b16 v[88:89], v110 offset:49152
    ds_read_b64_tr_b16 v[90:91], v110 offset:53504
    ds_read_b64_tr_b16 v[92:93], v110 offset:49664
    ds_read_b64_tr_b16 v[94:95], v110 offset:54016
    s_waitcnt lgkmcnt(2)
    buffer_store_dwordx4 v[88:91], v111, s[24:27], s63 offen sc1
    s_waitcnt lgkmcnt(0)
    buffer_store_dwordx4 v[92:95], v22, s[24:27], s64 offen sc1
    s_add_u32 m0, s90, 73728
    s_mov_b32 s57, 86912
    buffer_load_dwordx4 v2, s[8:11], s57 offen offset:0 lds
    s_movk_i32 s94, 224
    v_mul_u32_u24 v3, 66816, v116
    v_and_b32 v118, 1, v112
    v_lshlrev_b32 v119, 2, v118
    v_xor_b32 v119, v119, v115
    v_lshl_add_u32 v3, v118, 8, v3
    v_lshl_add_u32 v3, v119, 4, v3
    v_cmp_gt_u32 s[92:93], s94, v0
    v_mov_b32 v119, 2130706432
    s_mov_b32 s57, 96640
    buffer_load_dwordx4 v2, s[8:11], s57 offen offset:1024 lds
    v_lshlrev_b32 v4, 9, v116
    v_cndmask_b32 v24, v119, v3, s[92:93]
    v_lshl_add_u32 v4, v118, 7, v4
    v_lshl_add_u32 v4, v113, 4, v4
    v_lshrrev_b32 v118, 1, v114
    v_mul_u32_u24 v118, 320, v118
    v_add_u32 v4, v118, v4
    v_and_b32 v118, 1, v114
    v_lshl_add_u32 v4, v118, 3, v4
    v_xor_b32 v25, 64, v4
    s_lshl_b32 s53, s49, 4
    s_sub_u32 s53, s53, 2
    v_min_u32 v117, 17, v1
    v_add_u32 v117, s53, v117
    v_max_i32 v117, 0, v117
    v_lshlrev_b32 v19, 5, v117
    s_add_u32 m0, s90, 81920
    s_mov_b32 s57, 172928
    buffer_load_dwordx4 v2, s[8:11], s57 offen offset:0 lds
    v_add_u32 v19, 12582912, v19
    v_and_b32 v117, 1, v115
    v_cmp_eq_u32 s[76:77], 1, v117
    v_lshl_add_u32 v117, v112, 2, v117
    v_cmp_le_u32 s[78:79], v117, v115
    v_mul_u32_u24 v118, 304, v116
    v_lshl_add_u32 v93, v117, 1, v118
    v_add_u32 v117, 2, v117
    v_cmp_le_u32 s[80:81], v117, v115
    v_add_u32 v94, 4, v93
    v_mov_b32 v118, 14336
    v_mov_b32 v119, 30720
    v_cndmask_b32 v117, v118, v119, s[78:79]
    v_add_u32 v93, v117, v93
    v_cndmask_b32 v117, v118, v119, s[80:81]
    v_add_u32 v94, v117, v94
    s_mov_b32 s57, 182656
    buffer_load_dwordx4 v2, s[8:11], s57 offen offset:1024 lds
    v_lshrrev_b32 v117, 3, v115
    v_mul_u32_u24 v117, 304, v117
    v_lshl_add_u32 v92, v115, 1, v117
    v_add_u32 v92, v119, v92
    v_cmp_eq_u32 s[82:83], 3, v112
    v_mov_b32 v117, 0xffff
    v_mov_b32 v118, 0xffff0000
    v_cndmask_b32 v117, v117, v118, s[76:77]
    v_cndmask_b32 v14, v117, 0, s[78:79]
    v_cndmask_b32 v15, v117, 0, s[80:81]
    v_cndmask_b32 v16, 0, v117, s[78:79]
    v_cndmask_b32 v17, 0, v117, s[80:81]
    s_mov_b32 s91, 0x3e8b97f6
    v_mov_b32 v18, 0xf149f2ca
    s_lshl_b32 s53, s49, 3
    s_lshl_b32 s72, s53, 9
    s_add_u32 m0, s90, 90112
    s_mov_b32 s57, 258944
    buffer_load_dwordx4 v2, s[8:11], s57 offen offset:0 lds
    s_lshl_b32 s74, s53, 14
    s_lshl2_add_u32 s54, s48, s44
    s_mul_i32 s54, s54, 7
    s_lshr_b32 s54, s54, 1
    s_lshl_b32 s54, s54, 8
    s_add_u32 s74, s74, s54
    s_add_u32 s74, s74, 4194304
    s_mul_i32 s68, s44, 534528
    s_add_u32 s68, s68, 0
    s_mul_i32 s69, s44, 534528
    s_add_u32 s69, s69, 132608
    s_mul_i32 s70, s44, 534528
    s_add_u32 s70, s70, 265216
    s_mul_i32 s71, s44, 534528
    s_add_u32 s71, s71, 397824
    s_cmp_eq_u32 s44, 3
    s_cselect_b32 s71, 2130706432, s71
    s_cmp_eq_u32 s49, 0
    s_cselect_b64 s[84:85], -1, 0
    s_andn2_b64 s[86:87], s[84:85], s[80:81]
    s_andn2_b64 s[84:85], s[84:85], s[78:79]
    s_bitcmp1_b32 s44, 0
    s_cselect_b64 s[88:89], -1, 0
    s_cselect_b32 s53, 0, 3
    s_cselect_b32 s54, 8, 0
    v_cmp_eq_u32 vcc, s53, v112
    s_lshr_b32 s53, s44, 1
    s_lshl_b32 s55, s53, 11
    s_add_u32 s54, s54, s55
    s_add_u32 s54, s54, 147456
    v_lshl_add_u32 v118, v115, 4, s54
    v_add_u32 v117, 151552, v23
    v_cndmask_b32 v95, v117, v118, vcc
    v_mov_b32 v117, 2130706432
    v_cndmask_b32 v23, v23, v117, vcc
    s_lshl1_add_u32 s53, s48, s53
    s_mul_i32 s53, s53, 1792
    s_and_b32 s54, s44, 1
    s_lshl1_add_u32 s54, s49, s54
    s_lshl_b32 s54, s54, 16
    s_add_u32 s53, s53, s54
    s_add_u32 s95, s53, 4195072
    s_and_b32 s53, s46, 7
    s_mul_i32 s54, s44, 28
    s_add_u32 s54, s54, s53
    s_add_u32 s54, s54, 12
    s_lshl_b32 s73, s54, 16
    s_lshl_b32 s54, s45, 9
    s_add_u32 s73, s73, s54
    s_lshl3_add_u32 s75, s44, s53
    s_lshl_b32 s75, s75, 13
    v_lshrrev_b32 v5, 2, v1
    v_lshlrev_b32 v5, 12, v5
    v_lshl_add_u32 v5, v114, 7, v5
    v_lshlrev_b32 v20, 7, v1
    s_mov_b32 s57, 268672
    buffer_load_dwordx4 v2, s[8:11], s57 offen offset:1024 lds
    s_add_u32 m0, s90, 98304
    s_mov_b32 s57, 344960
    buffer_load_dwordx4 v2, s[8:11], s57 offen offset:0 lds
    s_mov_b32 s57, 354688
    buffer_load_dwordx4 v2, s[8:11], s57 offen offset:1024 lds
    s_mov_b32 s59, s44
    s_mov_b64 exec, 0
    s_branch L_wa_go
L_wa_ret:
    s_add_u32 s59, s59, 4
L_wa_go:
    s_cmp_eq_u32 s59, 0
    s_cbranch_scc1 L_wa_0
    s_cmp_eq_u32 s59, 1
    s_cbranch_scc1 L_wa_1
    s_cmp_eq_u32 s59, 2
    s_cbranch_scc1 L_wa_2
    s_cmp_eq_u32 s59, 3
    s_cbranch_scc1 L_wa_3
    s_cmp_eq_u32 s59, 4
    s_cbranch_scc1 L_wa_3
    s_mov_b64 exec, -1
    s_add_u32 m0, s90, 106496
    s_mov_b32 s57, 430976
    buffer_load_dwordx4 v2, s[8:11], s57 offen offset:0 lds
    s_mov_b32 s57, 440704
    buffer_load_dwordx4 v2, s[8:11], s57 offen offset:1024 lds
    s_add_u32 m0, s90, 114688
    s_mov_b32 s57, 516992
    buffer_load_dwordx4 v2, s[8:11], s57 offen offset:0 lds
    s_mov_b32 s57, 526720
    buffer_load_dwordx4 v2, s[8:11], s57 offen offset:1024 lds
    s_add_u32 m0, s90, 122880
    s_mov_b32 s57, 603008
    buffer_load_dwordx4 v2, s[8:11], s57 offen offset:0 lds
    s_mov_b32 s57, 612736
    buffer_load_dwordx4 v2, s[8:11], s57 offen offset:1024 lds
    s_add_u32 m0, s90, 131072
    s_mov_b32 s57, 689024
    buffer_load_dwordx4 v2, s[8:11], s57 offen offset:0 lds
    s_mov_b32 s57, 698752
    buffer_load_dwordx4 v2, s[8:11], s57 offen offset:1024 lds
    s_add_u32 m0, s90, 139264
    s_mov_b32 s57, 775040
    buffer_load_dwordx4 v2, s[8:11], s57 offen offset:0 lds
    s_mov_b32 s57, 784768
    buffer_load_dwordx4 v2, s[8:11], s57 offen offset:1024 lds
    s_add_u32 m0, s90, 147456
    s_mov_b32 s57, 861056
    buffer_load_dwordx4 v2, s[8:11], s57 offen offset:0 lds
    s_mov_b32 s57, 870784
    buffer_load_dwordx4 v2, s[8:11], s57 offen offset:1024 lds
    s_waitcnt vmcnt(20)
    v_cmp_eq_u32 vcc, 0, v29
    s_nop 0
    s_cbranch_vccz L_ok17
    s_mov_b32 s59, 100000
L_spin16:
    buffer_load_dword v29, off, s[40:43], 0 sc1
    s_waitcnt vmcnt(0)
    v_cmp_eq_u32 vcc, 0, v29
    s_nop 0
    s_cbranch_vccz L_ok17
    s_sub_u32 s59, s59, 1
    s_cbranch_scc0 L_spin16
L_ok17:
    v_readfirstlane_b32 s47, v29
    s_barrier
    s_cmp_lg_u32 s44, 0
    s_cbranch_scc1 L_nopub18
    s_lshl_b32 s60, s2, 5
    s_add_u32 s60, s60, 12582912
    v_mov_b32 v30, s47
    s_mov_b64 exec, 1
    buffer_store_dword v30, off, s[24:27], s60 sc1
    s_mov_b64 exec, -1
L_nopub18:
    s_waitcnt vmcnt(16)
    s_barrier
    s_add_u32 m0, s90, 155648
    s_mov_b32 s57, 947072
    buffer_load_dwordx4 v2, s[8:11], s57 offen offset:0 lds
    s_mov_b32 s57, 956800
    buffer_load_dwordx4 v2, s[8:11], s57 offen offset:1024 lds
    ds_read_b64_tr_b16 a[8:9], v6 offset:0
    ds_read_b64_tr_b16 a[10:11], v6 offset:1024
    ds_read_b64_tr_b16 a[12:13], v7 offset:0
    ds_read_b64_tr_b16 a[14:15], v7 offset:1024
    s_add_u32 m0, s90, 0
    s_mov_b32 s57, 1033088
    buffer_load_dwordx4 v2, s[8:11], s57 offen offset:0 lds
    s_mov_b32 s57, 1042816
    buffer_load_dwordx4 v2, s[8:11], s57 offen offset:1024 lds
    ds_read_b64_tr_b16 a[32:33], v6 offset:8192
    ds_read_b64_tr_b16 a[34:35], v6 offset:9216
    ds_read_b64_tr_b16 a[36:37], v7 offset:8192
    ds_read_b64_tr_b16 a[38:39], v7 offset:9216
    s_add_u32 m0, s90, 8192
    s_mov_b32 s57, 1119104
    buffer_load_dwordx4 v2, s[8:11], s57 offen offset:0 lds
    s_mov_b32 s57, 1128832
    buffer_load_dwordx4 v2, s[8:11], s57 offen offset:1024 lds
    ds_read_b64_tr_b16 a[56:57], v6 offset:16384
    ds_read_b64_tr_b16 a[58:59], v6 offset:17408
    ds_read_b64_tr_b16 a[60:61], v7 offset:16384
    ds_read_b64_tr_b16 a[62:63], v7 offset:17408
    s_waitcnt vmcnt(16)
    s_waitcnt lgkmcnt(0)
    s_barrier
    s_add_u32 m0, s90, 16384
    s_mov_b32 s57, 1792
    buffer_load_dwordx4 v2, s[8:11], s57 offen offset:0 lds
    s_mov_b32 s57, 11520
    buffer_load_dwordx4 v2, s[8:11], s57 offen offset:1024 lds
    ds_read_b64_tr_b16 a[80:81], v6 offset:24576
    ds_read_b64_tr_b16 a[82:83], v6 offset:25600
    ds_read_b64_tr_b16 a[84:85], v7 offset:24576
    ds_read_b64_tr_b16 a[86:87], v7 offset:25600
    s_add_u32 m0, s90, 24576
    s_mov_b32 s57, 87808
    buffer_load_dwordx4 v2, s[8:11], s57 offen offset:0 lds
    s_mov_b32 s57, 97536
    buffer_load_dwordx4 v2, s[8:11], s57 offen offset:1024 lds
    ds_read_b64_tr_b16 a[104:105], v6 offset:32768
    ds_read_b64_tr_b16 a[106:107], v6 offset:33792
    ds_read_b64_tr_b16 a[108:109], v7 offset:32768
    ds_read_b64_tr_b16 a[110:111], v7 offset:33792
    s_add_u32 m0, s90, 32768
    s_mov_b32 s57, 173824
    buffer_load_dwordx4 v2, s[8:11], s57 offen offset:0 lds
    s_mov_b32 s57, 183552
    buffer_load_dwordx4 v2, s[8:11], s57 offen offset:1024 lds
    ds_read_b64_tr_b16 a[128:129], v6 offset:40960
    ds_read_b64_tr_b16 a[130:131], v6 offset:41984
    ds_read_b64_tr_b16 a[132:133], v7 offset:40960
    ds_read_b64_tr_b16 a[134:135], v7 offset:41984
    s_waitcnt vmcnt(16)
    s_waitcnt lgkmcnt(0)
    s_barrier
    s_add_u32 m0, s90, 40960
    s_mov_b32 s57, 259840
    buffer_load_dwordx4 v2, s[8:11], s57 offen offset:0 lds
    s_mov_b32 s57, 269568
    buffer_load_dwordx4 v2, s[8:11], s57 offen offset:1024 lds
    ds_read_b64_tr_b16 a[152:153], v10 offset:0
    ds_read_b64_tr_b16 a[154:155], v10 offset:1024
    ds_read_b64_tr_b16 a[156:157], v11 offset:0
    ds_read_b64_tr_b16 a[158:159], v11 offset:1024
    s_add_u32 m0, s90, 65536
    s_mov_b32 s57, 345856
    buffer_load_dwordx4 v2, s[8:11], s57 offen offset:0 lds
    s_mov_b32 s57, 355584
    buffer_load_dwordx4 v2, s[8:11], s57 offen offset:1024 lds
    ds_read_b64_tr_b16 a[176:177], v10 offset:8192
    ds_read_b64_tr_b16 a[178:179], v10 offset:9216
    ds_read_b64_tr_b16 a[180:181], v11 offset:8192
    ds_read_b64_tr_b16 a[182:183], v11 offset:9216
    s_add_u32 m0, s90, 73728
    s_mov_b32 s57, 431872
    buffer_load_dwordx4 v2, s[8:11], s57 offen offset:0 lds
    s_mov_b32 s57, 441600
    buffer_load_dwordx4 v2, s[8:11], s57 offen offset:1024 lds
    ds_read_b64_tr_b16 a[200:201], v10 offset:16384
    ds_read_b64_tr_b16 a[202:203], v10 offset:17408
    ds_read_b64_tr_b16 a[204:205], v11 offset:16384
    ds_read_b64_tr_b16 a[206:207], v11 offset:17408
    s_waitcnt vmcnt(16)
    s_waitcnt lgkmcnt(0)
    s_barrier
    ds_read_b64_tr_b16 a[224:225], v10 offset:24576
    ds_read_b64_tr_b16 a[226:227], v10 offset:25600
    ds_read_b64_tr_b16 a[228:229], v11 offset:24576
    ds_read_b64_tr_b16 a[230:231], v11 offset:25600
    ds_read_b64_tr_b16 a[248:249], v10 offset:32768
    ds_read_b64_tr_b16 a[250:251], v10 offset:33792
    ds_read_b64_tr_b16 a[252:253], v11 offset:32768
    ds_read_b64_tr_b16 a[254:255], v11 offset:33792
    s_add_u32 m0, s90, 81920
    s_mov_b32 s57, 517888
    buffer_load_dwordx4 v2, s[8:11], s57 offen offset:0 lds
    ds_read_b64_tr_b16 v[192:193], v10 offset:40960
    ds_read_b64_tr_b16 v[194:195], v10 offset:41984
    ds_read_b64_tr_b16 v[196:197], v11 offset:40960
    ds_read_b64_tr_b16 v[198:199], v11 offset:41984
    s_mov_b32 s57, 527616
    buffer_load_dwordx4 v2, s[8:11], s57 offen offset:1024 lds
    s_waitcnt vmcnt(12)
    s_waitcnt lgkmcnt(0)
    s_barrier
    ds_read_b64_tr_b16 v[216:217], v120 offset:0
    ds_read_b64_tr_b16 v[218:219], v120 offset:1024
    ds_read_b64_tr_b16 v[220:221], v121 offset:0
    ds_read_b64_tr_b16 v[222:223], v121 offset:1024
    ds_read_b64_tr_b16 v[240:241], v120 offset:8192
    ds_read_b64_tr_b16 v[242:243], v120 offset:9216
    ds_read_b64_tr_b16 v[244:245], v121 offset:8192
    ds_read_b64_tr_b16 v[246:247], v121 offset:9216
    ds_read_b64_tr_b16 a[16:17], v122 offset:16384
    ds_read_b64_tr_b16 a[18:19], v122 offset:17408
    ds_read_b64_tr_b16 a[20:21], v123 offset:16384
    ds_read_b64_tr_b16 a[22:23], v123 offset:17408
    buffer_load_dword v21, v19, s[24:27], 0 offen sc1
    s_add_u32 m0, s90, 90112
    s_mov_b32 s57, 603904
    buffer_load_dwordx4 v2, s[8:11], s57 offen offset:0 lds
    s_mov_b32 s57, 613632
    buffer_load_dwordx4 v2, s[8:11], s57 offen offset:1024 lds
    s_add_u32 m0, s90, 98304
    s_mov_b32 s57, 689920
    buffer_load_dwordx4 v2, s[8:11], s57 offen offset:0 lds
    s_mov_b32 s57, 699648
    buffer_load_dwordx4 v2, s[8:11], s57 offen offset:1024 lds
    s_add_u32 m0, s90, 106496
    s_mov_b32 s57, 775936
    buffer_load_dwordx4 v2, s[8:11], s57 offen offset:0 lds
    s_waitcnt vmcnt(12)
    s_waitcnt lgkmcnt(0)
    s_barrier
    ds_read_b64_tr_b16 a[40:41], v122 offset:24576
    ds_read_b64_tr_b16 a[42:43], v122 offset:25600
    ds_read_b64_tr_b16 a[44:45], v123 offset:24576
    ds_read_b64_tr_b16 a[46:47], v123 offset:25600
    ds_read_b64_tr_b16 a[64:65], v122 offset:32768
    ds_read_b64_tr_b16 a[66:67], v122 offset:33792
    ds_read_b64_tr_b16 a[68:69], v123 offset:32768
    ds_read_b64_tr_b16 a[70:71], v123 offset:33792
    ds_read_b64_tr_b16 a[88:89], v122 offset:40960
    ds_read_b64_tr_b16 a[90:91], v122 offset:41984
    ds_read_b64_tr_b16 a[92:93], v123 offset:40960
    ds_read_b64_tr_b16 a[94:95], v123 offset:41984
    s_mov_b32 s57, 785664
    buffer_load_dwordx4 v2, s[8:11], s57 offen offset:1024 lds
    s_waitcnt vmcnt(7)
    s_waitcnt lgkmcnt(0)
    s_barrier
    ds_read_b64_tr_b16 a[112:113], v8 offset:0
    ds_read_b64_tr_b16 a[114:115], v8 offset:1024
    ds_read_b64_tr_b16 a[116:117], v9 offset:0
    ds_read_b64_tr_b16 a[118:119], v9 offset:1024
    ds_read_b64_tr_b16 a[136:137], v8 offset:8192
    ds_read_b64_tr_b16 a[138:139], v8 offset:9216
    ds_read_b64_tr_b16 a[140:141], v9 offset:8192
    ds_read_b64_tr_b16 a[142:143], v9 offset:9216
    ds_read_b64_tr_b16 a[160:161], v8 offset:16384
    ds_read_b64_tr_b16 a[162:163], v8 offset:17408
    ds_read_b64_tr_b16 a[164:165], v9 offset:16384
    ds_read_b64_tr_b16 a[166:167], v9 offset:17408
    s_waitcnt vmcnt(6)
    v_cmp_ne_u32 vcc, s47, v21
    s_nop 0
    s_cbranch_vccz L_ok20
    s_mov_b32 s59, 100000
L_spin19:
    buffer_load_dword v21, v19, s[24:27], 0 offen sc1
    s_waitcnt vmcnt(0)
    v_cmp_ne_u32 vcc, s47, v21
    s_nop 0
    s_cbranch_vccz L_ok20
    s_sub_u32 s59, s59, 1
    s_cbranch_scc0 L_spin19
L_ok20:
    s_add_u32 m0, s52, 0
    s_sub_u32 s58, s72, 512
    s_max_i32 s58, s58, 0
    s_add_u32 s57, s58, s68
    buffer_load_dwordx4 v3, s[24:27], s57 offen offset:0 sc1 lds
    s_add_u32 s57, s58, s69
    buffer_load_dwordx4 v3, s[24:27], s57 offen offset:1024 sc1 lds
    s_add_u32 s57, s58, s70
    buffer_load_dwordx4 v24, s[24:27], s57 offen offset:2048 sc1 lds
    s_add_u32 s57, s58, s71
    buffer_load_dwordx4 v3, s[24:27], s57 offen offset:3072 sc1 lds
    s_add_u32 m0, s52, 16384
    s_add_u32 s58, s72, 0
    s_add_u32 s57, s58, s68
    buffer_load_dwordx4 v3, s[24:27], s57 offen offset:0 sc1 lds
    s_add_u32 s57, s58, s69
    buffer_load_dwordx4 v3, s[24:27], s57 offen offset:1024 sc1 lds
    s_add_u32 s57, s58, s70
    buffer_load_dwordx4 v24, s[24:27], s57 offen offset:2048 sc1 lds
    s_add_u32 s57, s58, s71
    buffer_load_dwordx4 v3, s[24:27], s57 offen offset:3072 sc1 lds
    s_add_u32 m0, s90, 114688
    s_mov_b32 s57, 861952
    buffer_load_dwordx4 v2, s[8:11], s57 offen offset:0 lds
    s_mov_b32 s57, 871680
    buffer_load_dwordx4 v2, s[8:11], s57 offen offset:1024 lds
    s_add_u32 m0, s90, 122880
    s_mov_b32 s57, 947968
    buffer_load_dwordx4 v2, s[8:11], s57 offen offset:0 lds
    s_mov_b32 s57, 957696
    buffer_load_dwordx4 v2, s[8:11], s57 offen offset:1024 lds
    s_add_u32 m0, s90, 131072
    s_mov_b32 s57, 1033984
    buffer_load_dwordx4 v2, s[8:11], s57 offen offset:0 lds
    s_mov_b32 s57, 1043712
    buffer_load_dwordx4 v2, s[8:11], s57 offen offset:1024 lds
    s_add_u32 m0, s52, 32768
    s_add_u32 s58, s72, 512
    s_add_u32 s57, s58, s68
    buffer_load_dwordx4 v3, s[24:27], s57 offen offset:0 sc1 lds
    s_add_u32 s57, s58, s69
    buffer_load_dwordx4 v3, s[24:27], s57 offen offset:1024 sc1 lds
    s_waitcnt vmcnt(12)
    s_waitcnt lgkmcnt(0)
    s_barrier
    ds_read_b64_tr_b16 v[120:121], v4 offset:0
    ds_read_b64_tr_b16 v[122:123], v25 offset:0
    ds_read_b64_tr_b16 v[124:125], v4 offset:1024
    ds_read_b64_tr_b16 v[126:127], v25 offset:1024
    ds_read_b64_tr_b16 v[128:129], v4 offset:2048
    ds_read_b64_tr_b16 v[130:131], v25 offset:2048
    ds_read_b64_tr_b16 v[132:133], v4 offset:3072
    ds_read_b64_tr_b16 v[134:135], v25 offset:3072
    ds_read_b64_tr_b16 v[136:137], v4 offset:4096
    ds_read_b64_tr_b16 v[138:139], v25 offset:4096
    ds_read_b64_tr_b16 v[140:141], v4 offset:5120
    ds_read_b64_tr_b16 v[142:143], v25 offset:5120
    ds_read_b64_tr_b16 v[144:145], v4 offset:6144
    ds_read_b64_tr_b16 v[146:147], v25 offset:6144
    ds_read_b64_tr_b16 v[148:149], v4 offset:7168
    ds_read_b64_tr_b16 v[150:151], v25 offset:7168
    ds_read_b64_tr_b16 v[152:153], v4 offset:8192
    ds_read_b64_tr_b16 v[154:155], v25 offset:8192
    ds_read_b64_tr_b16 v[156:157], v4 offset:9216
    ds_read_b64_tr_b16 v[158:159], v25 offset:9216
    ds_read_b64_tr_b16 v[160:161], v4 offset:10240
    ds_read_b64_tr_b16 v[162:163], v25 offset:10240
    ds_read_b64_tr_b16 v[164:165], v4 offset:11264
    ds_read_b64_tr_b16 v[166:167], v25 offset:11264
    ds_read_b64_tr_b16 v[168:169], v4 offset:12288
    ds_read_b64_tr_b16 v[170:171], v25 offset:12288
    ds_read_b64_tr_b16 v[172:173], v4 offset:13312
    ds_read_b64_tr_b16 v[174:175], v25 offset:13312
    s_waitcnt lgkmcnt(15)
    v_mfma_f32_16x16x32_bf16 v[96:99], a[8:11], v[120:123], 0
    s_add_u32 s57, s58, s70
    ds_read_b64_tr_b16 a[184:185], v8 offset:24576
    v_mfma_f32_16x16x32_bf16 v[96:99], a[32:35], v[124:127], v[96:99]
    buffer_load_dwordx4 v24, s[24:27], s57 offen offset:2048 sc1 lds
    v_mfma_f32_16x16x32_bf16 v[96:99], a[56:59], v[128:131], v[96:99]
    ds_read_b64_tr_b16 a[186:187], v8 offset:25600
    ds_read_b64_tr_b16 a[188:189], v9 offset:24576
    v_mfma_f32_16x16x32_bf16 v[96:99], a[80:83], v[132:135], v[96:99]
    ds_read_b64_tr_b16 a[190:191], v9 offset:25600
    ds_read_b64_tr_b16 a[208:209], v8 offset:32768
    v_mfma_f32_16x16x32_bf16 v[96:99], a[104:107], v[136:139], v[96:99]
    s_add_u32 s57, s58, s71
    ds_read_b64_tr_b16 a[210:211], v8 offset:33792
    v_mfma_f32_16x16x32_bf16 v[96:99], a[128:131], v[140:143], v[96:99]
    buffer_load_dwordx4 v3, s[24:27], s57 offen offset:3072 sc1 lds
    s_waitcnt lgkmcnt(15)
    v_mfma_f32_16x16x32_bf16 v[96:99], a[152:155], v[144:147], v[96:99]
    ds_read_b64_tr_b16 a[212:213], v9 offset:32768
    ds_read_b64_tr_b16 a[214:215], v9 offset:33792
    v_mfma_f32_16x16x32_bf16 v[96:99], a[176:179], v[148:151], v[96:99]
    ds_read_b64_tr_b16 a[232:233], v8 offset:40960
    ds_read_b64_tr_b16 a[234:235], v8 offset:41984
    s_waitcnt lgkmcnt(15)
    v_mfma_f32_16x16x32_bf16 v[96:99], a[200:203], v[152:155], v[96:99]
    s_add_u32 m0, s90, 139264
    s_mov_b32 s57, 1120000
    ds_read_b64_tr_b16 a[236:237], v9 offset:40960
    v_mfma_f32_16x16x32_bf16 v[96:99], a[224:227], v[156:159], v[96:99]
    buffer_load_dwordx4 v2, s[8:11], s57 offen offset:0 lds
    s_waitcnt lgkmcnt(15)
    v_mfma_f32_16x16x32_bf16 v[96:99], a[248:251], v[160:163], v[96:99]
    ds_read_b64_tr_b16 a[238:239], v9 offset:41984
    v_mfma_f32_16x16x32_bf16 v[96:99], v[192:195], v[164:167], v[96:99]
    s_waitcnt lgkmcnt(12)
    v_mfma_f32_16x16x32_bf16 v[96:99], v[216:219], v[168:171], v[96:99]
    s_mov_b32 s57, 1129728
    v_mfma_f32_16x16x32_bf16 v[96:99], v[240:243], v[172:175], v[96:99]
    buffer_load_dwordx4 v2, s[8:11], s57 offen offset:1024 lds
    s_waitcnt vmcnt(12)
    s_barrier
    v_mfma_f32_16x16x32_bf16 v[100:103], a[12:15], v[120:123], 0
    ds_read_b64_tr_b16 v[120:121], v4 offset:16384
    ds_read_b64_tr_b16 v[122:123], v25 offset:16384
    v_mfma_f32_16x16x32_bf16 v[100:103], a[36:39], v[124:127], v[100:103]
    ds_read_b64_tr_b16 v[124:125], v4 offset:17408
    v_mfma_f32_16x16x32_bf16 v[100:103], a[60:63], v[128:131], v[100:103]
    ds_read_b64_tr_b16 v[126:127], v25 offset:17408
    ds_read_b64_tr_b16 v[128:129], v4 offset:18432
    s_add_u32 m0, s90, 147456
    s_mov_b32 s57, 0
    v_mfma_f32_16x16x32_bf16 v[100:103], a[84:87], v[132:135], v[100:103]
    buffer_load_dwordx4 v2, s[8:11], s57 offen offset:0 lds
    v_mfma_f32_16x16x32_bf16 v[100:103], a[108:111], v[136:139], v[100:103]
    ds_read_b64_tr_b16 v[130:131], v25 offset:18432
    ds_read_b64_tr_b16 v[132:133], v4 offset:19456
    v_mfma_f32_16x16x32_bf16 v[100:103], a[132:135], v[140:143], v[100:103]
    ds_read_b64_tr_b16 v[134:135], v25 offset:19456
    ds_read_b64_tr_b16 v[136:137], v4 offset:20480
    v_mfma_f32_16x16x32_bf16 v[100:103], a[156:159], v[144:147], v[100:103]
    ds_read_b64_tr_b16 v[138:139], v25 offset:20480
    s_mov_b32 s57, 9728
    v_mfma_f32_16x16x32_bf16 v[100:103], a[180:183], v[148:151], v[100:103]
    buffer_load_dwordx4 v2, s[8:11], s57 offen offset:1024 lds
    v_mfma_f32_16x16x32_bf16 v[100:103], a[204:207], v[152:155], v[100:103]
    ds_read_b64_tr_b16 v[140:141], v4 offset:21504
    ds_read_b64_tr_b16 v[142:143], v25 offset:21504
    v_mfma_f32_16x16x32_bf16 v[100:103], a[228:231], v[156:159], v[100:103]
    ds_read_b64_tr_b16 v[144:145], v4 offset:22528
    ds_read_b64_tr_b16 v[146:147], v25 offset:22528
    v_mfma_f32_16x16x32_bf16 v[100:103], a[252:255], v[160:163], v[100:103]
    ds_read_b64_tr_b16 v[148:149], v4 offset:23552
    ds_read_b64_tr_b16 v[150:151], v25 offset:23552
    s_add_u32 m0, s90, 155648
    s_mov_b32 s57, 86016
    v_mfma_f32_16x16x32_bf16 v[100:103], v[196:199], v[164:167], v[100:103]
    buffer_load_dwordx4 v2, s[8:11], s57 offen offset:0 lds
    v_mfma_f32_16x16x32_bf16 v[100:103], v[220:223], v[168:171], v[100:103]
    ds_read_b64_tr_b16 v[152:153], v4 offset:24576
    ds_read_b64_tr_b16 v[154:155], v25 offset:24576
    v_mfma_f32_16x16x32_bf16 v[100:103], v[244:247], v[172:175], v[100:103]
    ds_read_b64_tr_b16 v[156:157], v4 offset:25600
    ds_read_b64_tr_b16 v[158:159], v25 offset:25600
    s_waitcnt lgkmcnt(15)
    v_mfma_f32_16x16x32_bf16 v[104:107], a[8:11], v[120:123], 0
    ds_read_b64_tr_b16 v[160:161], v4 offset:26624
    s_mov_b32 s57, 95744
    v_mfma_f32_16x16x32_bf16 v[104:107], a[32:35], v[124:127], v[104:107]
    buffer_load_dwordx4 v2, s[8:11], s57 offen offset:1024 lds
    s_waitcnt lgkmcnt(13)
    v_mfma_f32_16x16x32_bf16 v[104:107], a[56:59], v[128:131], v[104:107]
    ds_read_b64_tr_b16 v[162:163], v25 offset:26624
    ds_read_b64_tr_b16 v[164:165], v4 offset:27648
    v_mfma_f32_16x16x32_bf16 v[104:107], a[80:83], v[132:135], v[104:107]
    ds_read_b64_tr_b16 v[166:167], v25 offset:27648
    ds_read_b64_tr_b16 v[168:169], v4 offset:28672
    s_waitcnt vmcnt(10)
    s_barrier
    s_waitcnt lgkmcnt(13)
    v_mfma_f32_16x16x32_bf16 v[104:107], a[104:107], v[136:139], v[104:107]
    ds_read_b64_tr_b16 v[170:171], v25 offset:28672
    ds_read_b64_tr_b16 v[172:173], v4 offset:29696
    s_add_u32 m0, s90, 65536
    s_mov_b32 s57, 172032
    v_mfma_f32_16x16x32_bf16 v[104:107], a[128:131], v[140:143], v[104:107]
    buffer_load_dwordx4 v2, s[8:11], s57 offen offset:0 lds
    s_waitcnt lgkmcnt(11)
    v_mfma_f32_16x16x32_bf16 v[104:107], a[152:155], v[144:147], v[104:107]
    ds_read_b64_tr_b16 v[174:175], v25 offset:29696
    v_cvt_pk_bf16_f32 v52, v96, v97
    v_mfma_f32_16x16x32_bf16 v[104:107], a[176:179], v[148:151], v[104:107]
    v_cvt_pk_bf16_f32 v53, v98, v99
    v_cvt_pk_bf16_f32 v54, v100, v101
    s_waitcnt lgkmcnt(8)
    v_mfma_f32_16x16x32_bf16 v[104:107], a[200:203], v[152:155], v[104:107]
    s_mov_b32 s57, 181760
    v_cvt_pk_bf16_f32 v55, v102, v103
    v_mfma_f32_16x16x32_bf16 v[104:107], a[224:227], v[156:159], v[104:107]
    buffer_load_dwordx4 v2, s[8:11], s57 offen offset:1024 lds
    s_waitcnt lgkmcnt(4)
    v_mfma_f32_16x16x32_bf16 v[104:107], a[248:251], v[160:163], v[104:107]
    v_cndmask_b32 v54, v54, 0, s[82:83]
    v_cndmask_b32 v55, v55, 0, s[82:83]
    v_mfma_f32_16x16x32_bf16 v[104:107], v[192:195], v[164:167], v[104:107]
    ds_read_b64_tr_b16 v[176:177], v12 offset:0
    ds_read_b64_tr_b16 v[178:179], v12 offset:1024
    s_waitcnt lgkmcnt(2)
    v_mfma_f32_16x16x32_bf16 v[104:107], v[216:219], v[168:171], v[104:107]
    s_add_u32 m0, s90, 73728
    s_mov_b32 s57, 258048
    ds_read_b64_tr_b16 v[180:181], v13 offset:0
    v_mfma_f32_16x16x32_bf16 v[104:107], v[240:243], v[172:175], v[104:107]
    buffer_load_dwordx4 v2, s[8:11], s57 offen offset:0 lds
    v_mfma_f32_16x16x32_bf16 v[108:111], a[12:15], v[120:123], 0
    ds_read_b64_tr_b16 v[182:183], v13 offset:1024
    ds_read_b64_tr_b16 v[200:201], v12 offset:8192
    v_mfma_f32_16x16x32_bf16 v[108:111], a[36:39], v[124:127], v[108:111]
    ds_read_b64_tr_b16 v[202:203], v12 offset:9216
    ds_read_b64_tr_b16 v[204:205], v13 offset:8192
    v_mfma_f32_16x16x32_bf16 v[108:111], a[60:63], v[128:131], v[108:111]
    s_mov_b32 s57, 267776
    ds_read_b64_tr_b16 v[206:207], v13 offset:9216
    v_mfma_f32_16x16x32_bf16 v[108:111], a[84:87], v[132:135], v[108:111]
    buffer_load_dwordx4 v2, s[8:11], s57 offen offset:1024 lds
    v_mfma_f32_16x16x32_bf16 v[108:111], a[108:111], v[136:139], v[108:111]
    ds_read_b64_tr_b16 v[224:225], v12 offset:16384
    ds_read_b64_tr_b16 v[226:227], v12 offset:17408
    v_mfma_f32_16x16x32_bf16 v[108:111], a[132:135], v[140:143], v[108:111]
    ds_read_b64_tr_b16 v[228:229], v13 offset:16384
    ds_read_b64_tr_b16 v[230:231], v13 offset:17408
    v_mfma_f32_16x16x32_bf16 v[108:111], a[156:159], v[144:147], v[108:111]
    s_add_u32 m0, s90, 81920
    s_mov_b32 s57, 344064
    v_cvt_pk_bf16_f32 v56, v104, v105
    v_mfma_f32_16x16x32_bf16 v[108:111], a[180:183], v[148:151], v[108:111]
    buffer_load_dwordx4 v2, s[8:11], s57 offen offset:0 lds
    v_mfma_f32_16x16x32_bf16 v[108:111], a[204:207], v[152:155], v[108:111]
    v_cvt_pk_bf16_f32 v57, v106, v107
    v_mfma_f32_16x16x32_bf16 v[108:111], a[228:231], v[156:159], v[108:111]
    v_mfma_f32_16x16x32_bf16 v[108:111], a[252:255], v[160:163], v[108:111]
    s_mov_b32 s57, 353792
    v_mfma_f32_16x16x32_bf16 v[108:111], v[196:199], v[164:167], v[108:111]
    buffer_load_dwordx4 v2, s[8:11], s57 offen offset:1024 lds
    v_mfma_f32_16x16x32_bf16 v[108:111], v[220:223], v[168:171], v[108:111]
    v_mfma_f32_16x16x32_bf16 v[108:111], v[244:247], v[172:175], v[108:111]
    v_mfma_f32_16x16x32_bf16 v[112:115], v[120:123], a[16:19], 0
    s_add_u32 m0, s90, 90112
    s_mov_b32 s57, 430080
    v_mfma_f32_16x16x32_bf16 v[112:115], v[124:127], a[40:43], v[112:115]
    buffer_load_dwordx4 v2, s[8:11], s57 offen offset:0 lds
    v_mfma_f32_16x16x32_bf16 v[112:115], v[128:131], a[64:67], v[112:115]
    v_mfma_f32_16x16x32_bf16 v[112:115], v[132:135], a[88:91], v[112:115]
    v_mfma_f32_16x16x32_bf16 v[112:115], v[136:139], a[112:115], v[112:115]
    s_mov_b32 s57, 439808
    v_mfma_f32_16x16x32_bf16 v[112:115], v[140:143], a[136:139], v[112:115]
    buffer_load_dwordx4 v2, s[8:11], s57 offen offset:1024 lds
    v_mfma_f32_16x16x32_bf16 v[112:115], v[144:147], a[160:163], v[112:115]
    v_cvt_pk_bf16_f32 v58, v108, v109
    v_cvt_pk_bf16_f32 v59, v110, v111
    v_mfma_f32_16x16x32_bf16 v[112:115], v[148:151], a[184:187], v[112:115]
    v_cndmask_b32 v58, v58, 0, s[82:83]
    v_cndmask_b32 v59, v59, 0, s[82:83]
    v_mfma_f32_16x16x32_bf16 v[112:115], v[152:155], a[208:211], v[112:115]
    s_add_u32 m0, s90, 98304
    s_mov_b32 s57, 516096
    buffer_load_dwordx4 v2, s[8:11], s57 offen offset:0 lds
    s_waitcnt vmcnt(9)
    s_waitcnt lgkmcnt(0)
    s_barrier
    ds_read_b64_tr_b16 v[248:249], v12 offset:24576
    ds_read_b64_tr_b16 v[250:251], v12 offset:25600
    ds_read_b64_tr_b16 v[252:253], v13 offset:24576
    ds_read_b64_tr_b16 v[254:255], v13 offset:25600
    v_mfma_f32_16x16x32_bf16 v[112:115], v[156:159], a[232:235], v[112:115]
    ds_read_b64_tr_b16 a[0:1], v10 offset:32768
    ds_read_b64_tr_b16 a[2:3], v10 offset:33792
    v_mfma_f32_16x16x32_bf16 v[112:115], v[160:163], v[176:179], v[112:115]
    ds_read_b64_tr_b16 a[4:5], v11 offset:32768
    ds_read_b64_tr_b16 a[6:7], v11 offset:33792
    v_mfma_f32_16x16x32_bf16 v[112:115], v[164:167], v[200:203], v[112:115]
    ds_read_b64_tr_b16 a[24:25], v10 offset:40960
    ds_read_b64_tr_b16 a[26:27], v10 offset:41984
    s_waitcnt lgkmcnt(6)
    v_mfma_f32_16x16x32_bf16 v[112:115], v[168:171], v[224:227], v[112:115]
    s_mov_b32 s57, 525824
    ds_read_b64_tr_b16 a[28:29], v11 offset:40960
    v_mfma_f32_16x16x32_bf16 v[112:115], v[172:175], v[248:251], v[112:115]
    buffer_load_dwordx4 v2, s[8:11], s57 offen offset:1024 lds
    v_mfma_f32_16x16x32_bf16 v[116:119], v[120:123], a[20:23], 0
    ds_read_b64_tr_b16 v[120:121], v4 offset:0
    ds_read_b64_tr_b16 v[122:123], v25 offset:0
    v_mfma_f32_16x16x32_bf16 v[116:119], v[124:127], a[44:47], v[116:119]
    ds_read_b64_tr_b16 v[124:125], v4 offset:1024
    ds_read_b64_tr_b16 a[30:31], v11 offset:41984
    v_mfma_f32_16x16x32_bf16 v[116:119], v[128:131], a[68:71], v[116:119]
    ds_read_b64_tr_b16 v[126:127], v25 offset:1024
    ds_read_b64_tr_b16 v[128:129], v4 offset:2048
    s_add_u32 m0, s90, 106496
    s_mov_b32 s57, 602112
    v_mfma_f32_16x16x32_bf16 v[116:119], v[132:135], a[92:95], v[116:119]
    buffer_load_dwordx4 v2, s[8:11], s57 offen offset:0 lds
    v_mfma_f32_16x16x32_bf16 v[116:119], v[136:139], a[116:119], v[116:119]
    ds_read_b64_tr_b16 v[130:131], v25 offset:2048
    ds_read_b64_tr_b16 v[132:133], v4 offset:3072
    v_mfma_f32_16x16x32_bf16 v[116:119], v[140:143], a[140:143], v[116:119]
    ds_read_b64_tr_b16 v[134:135], v25 offset:3072
    ds_read_b64_tr_b16 v[136:137], v4 offset:4096
    v_mfma_f32_16x16x32_bf16 v[116:119], v[144:147], a[164:167], v[116:119]
    ds_read_b64_tr_b16 v[138:139], v25 offset:4096
    s_mov_b32 s57, 611840
    v_mfma_f32_16x16x32_bf16 v[116:119], v[148:151], a[188:191], v[116:119]
    buffer_load_dwordx4 v2, s[8:11], s57 offen offset:1024 lds
    v_mfma_f32_16x16x32_bf16 v[116:119], v[152:155], a[212:215], v[116:119]
    ds_read_b64_tr_b16 v[140:141], v4 offset:5120
    ds_read_b64_tr_b16 v[142:143], v25 offset:5120
    v_mfma_f32_16x16x32_bf16 v[116:119], v[156:159], a[236:239], v[116:119]
    ds_read_b64_tr_b16 v[144:145], v4 offset:6144
    ds_read_b64_tr_b16 v[146:147], v25 offset:6144
    v_mfma_f32_16x16x32_bf16 v[116:119], v[160:163], v[180:183], v[116:119]
    ds_read_b64_tr_b16 v[148:149], v4 offset:7168
    ds_read_b64_tr_b16 v[150:151], v25 offset:7168
    s_add_u32 m0, s90, 114688
    s_mov_b32 s57, 688128
    v_mfma_f32_16x16x32_bf16 v[116:119], v[164:167], v[204:207], v[116:119]
    buffer_load_dwordx4 v2, s[8:11], s57 offen offset:0 lds
L_wa_0:
    s_cbranch_execz L_wa_ret
    v_mfma_f32_16x16x32_bf16 v[116:119], v[168:171], v[228:231], v[116:119]
    ds_read_b64_tr_b16 v[152:153], v4 offset:8192
    ds_read_b64_tr_b16 v[154:155], v25 offset:8192
    v_mfma_f32_16x16x32_bf16 v[116:119], v[172:175], v[252:255], v[116:119]
    ds_read_b64_tr_b16 v[156:157], v4 offset:9216
    ds_read_b64_tr_b16 v[158:159], v25 offset:9216
    s_waitcnt lgkmcnt(15)
    v_mfma_f32_16x16x32_bf16 v[96:99], v[120:123], a[16:19], 0
    ds_read_b64_tr_b16 v[160:161], v4 offset:10240
    s_mov_b32 s57, 697856
    v_mfma_f32_16x16x32_bf16 v[96:99], v[124:127], a[40:43], v[96:99]
    buffer_load_dwordx4 v2, s[8:11], s57 offen offset:1024 lds
    s_waitcnt lgkmcnt(13)
    v_mfma_f32_16x16x32_bf16 v[96:99], v[128:131], a[64:67], v[96:99]
    ds_read_b64_tr_b16 v[162:163], v25 offset:10240
    ds_read_b64_tr_b16 v[164:165], v4 offset:11264
    v_mfma_f32_16x16x32_bf16 v[96:99], v[132:135], a[88:91], v[96:99]
    ds_read_b64_tr_b16 v[166:167], v25 offset:11264
    ds_read_b64_tr_b16 v[168:169], v4 offset:12288
    s_waitcnt lgkmcnt(13)
    v_mfma_f32_16x16x32_bf16 v[96:99], v[136:139], a[112:115], v[96:99]
    ds_read_b64_tr_b16 v[170:171], v25 offset:12288
    ds_read_b64_tr_b16 v[172:173], v4 offset:13312
    s_add_u32 m0, s90, 122880
    s_mov_b32 s57, 774144
    v_mfma_f32_16x16x32_bf16 v[96:99], v[140:143], a[136:139], v[96:99]
    buffer_load_dwordx4 v2, s[8:11], s57 offen offset:0 lds
    s_waitcnt lgkmcnt(11)
    v_mfma_f32_16x16x32_bf16 v[96:99], v[144:147], a[160:163], v[96:99]
    ds_read_b64_tr_b16 v[174:175], v25 offset:13312
    v_cvt_pk_bf16_f32 v34, v112, v113
    v_mfma_f32_16x16x32_bf16 v[96:99], v[148:151], a[184:187], v[96:99]
    v_cvt_pk_bf16_f32 v35, v114, v115
    v_cvt_pk_bf16_f32 v44, v116, v117
    s_waitcnt lgkmcnt(8)
    v_mfma_f32_16x16x32_bf16 v[96:99], v[152:155], a[208:211], v[96:99]
    s_mov_b32 s57, 783872
    v_cvt_pk_bf16_f32 v45, v118, v119
    v_mfma_f32_16x16x32_bf16 v[96:99], v[156:159], a[232:235], v[96:99]
    buffer_load_dwordx4 v2, s[8:11], s57 offen offset:1024 lds
    s_waitcnt lgkmcnt(4)
    v_mfma_f32_16x16x32_bf16 v[96:99], v[160:163], v[176:179], v[96:99]
    v_mfma_f32_16x16x32_bf16 v[96:99], v[164:167], v[200:203], v[96:99]
    s_waitcnt vmcnt(10)
    s_barrier
    s_waitcnt lgkmcnt(0)
    v_mfma_f32_16x16x32_bf16 v[96:99], v[168:171], v[224:227], v[96:99]
    s_add_u32 m0, s90, 131072
    s_mov_b32 s57, 860160
    ds_read_b64_tr_b16 a[48:49], v6 offset:0
    v_mfma_f32_16x16x32_bf16 v[96:99], v[172:175], v[248:251], v[96:99]
    buffer_load_dwordx4 v2, s[8:11], s57 offen offset:0 lds
    v_mfma_f32_16x16x32_bf16 v[100:103], v[120:123], a[20:23], 0
    ds_read_b64_tr_b16 v[120:121], v4 offset:32768
    ds_read_b64_tr_b16 v[122:123], v25 offset:32768
    v_mfma_f32_16x16x32_bf16 v[100:103], v[124:127], a[44:47], v[100:103]
    ds_read_b64_tr_b16 v[124:125], v4 offset:33792
    ds_read_b64_tr_b16 a[50:51], v6 offset:1024
    v_mfma_f32_16x16x32_bf16 v[100:103], v[128:131], a[68:71], v[100:103]
    ds_read_b64_tr_b16 v[126:127], v25 offset:33792
    ds_read_b64_tr_b16 v[128:129], v4 offset:34816
    s_mov_b32 s57, 869888
    v_mfma_f32_16x16x32_bf16 v[100:103], v[132:135], a[92:95], v[100:103]
    buffer_load_dwordx4 v2, s[8:11], s57 offen offset:1024 lds
    v_mfma_f32_16x16x32_bf16 v[100:103], v[136:139], a[116:119], v[100:103]
    ds_read_b64_tr_b16 v[130:131], v25 offset:34816
    ds_read_b64_tr_b16 v[132:133], v4 offset:35840
    v_mfma_f32_16x16x32_bf16 v[100:103], v[140:143], a[140:143], v[100:103]
    ds_read_b64_tr_b16 v[134:135], v25 offset:35840
    ds_read_b64_tr_b16 v[136:137], v4 offset:36864
    v_mfma_f32_16x16x32_bf16 v[100:103], v[144:147], a[164:167], v[100:103]
    ds_read_b64_tr_b16 v[138:139], v25 offset:36864
    s_add_u32 m0, s90, 139264
    s_mov_b32 s57, 946176
    v_mfma_f32_16x16x32_bf16 v[100:103], v[148:151], a[188:191], v[100:103]
    buffer_load_dwordx4 v2, s[8:11], s57 offen offset:0 lds
    v_mfma_f32_16x16x32_bf16 v[100:103], v[152:155], a[212:215], v[100:103]
    ds_read_b64_tr_b16 v[140:141], v4 offset:37888
    ds_read_b64_tr_b16 v[142:143], v25 offset:37888
    v_mfma_f32_16x16x32_bf16 v[100:103], v[156:159], a[236:239], v[100:103]
    ds_read_b64_tr_b16 v[144:145], v4 offset:38912
    ds_read_b64_tr_b16 v[146:147], v25 offset:38912
    v_mfma_f32_16x16x32_bf16 v[100:103], v[160:163], v[180:183], v[100:103]
    ds_read_b64_tr_b16 v[148:149], v4 offset:39936
    ds_read_b64_tr_b16 v[150:151], v25 offset:39936
    s_mov_b32 s57, 955904
    v_mfma_f32_16x16x32_bf16 v[100:103], v[164:167], v[204:207], v[100:103]
    buffer_load_dwordx4 v2, s[8:11], s57 offen offset:1024 lds
    v_mfma_f32_16x16x32_bf16 v[100:103], v[168:171], v[228:231], v[100:103]
    ds_read_b64_tr_b16 v[152:153], v4 offset:40960
    ds_read_b64_tr_b16 v[154:155], v25 offset:40960
    v_mfma_f32_16x16x32_bf16 v[100:103], v[172:175], v[252:255], v[100:103]
    ds_read_b64_tr_b16 v[156:157], v4 offset:41984
    ds_read_b64_tr_b16 v[158:159], v25 offset:41984
    s_waitcnt lgkmcnt(15)
    v_mfma_f32_16x16x32_bf16 v[104:107], a[8:11], v[120:123], 0
    ds_read_b64_tr_b16 v[160:161], v4 offset:43008
    s_add_u32 m0, s90, 147456
    s_mov_b32 s57, 1032192
    v_mfma_f32_16x16x32_bf16 v[104:107], a[32:35], v[124:127], v[104:107]
    buffer_load_dwordx4 v2, s[8:11], s57 offen offset:0 lds
    s_waitcnt lgkmcnt(13)
    v_mfma_f32_16x16x32_bf16 v[104:107], a[56:59], v[128:131], v[104:107]
    ds_read_b64_tr_b16 v[162:163], v25 offset:43008
    ds_read_b64_tr_b16 v[164:165], v4 offset:44032
    v_mfma_f32_16x16x32_bf16 v[104:107], a[80:83], v[132:135], v[104:107]
    ds_read_b64_tr_b16 v[166:167], v25 offset:44032
    ds_read_b64_tr_b16 v[168:169], v4 offset:45056
    s_waitcnt lgkmcnt(13)
    v_mfma_f32_16x16x32_bf16 v[104:107], a[104:107], v[136:139], v[104:107]
    ds_read_b64_tr_b16 v[170:171], v25 offset:45056
    ds_read_b64_tr_b16 v[172:173], v4 offset:46080
    s_mov_b32 s57, 1041920
    v_mfma_f32_16x16x32_bf16 v[104:107], a[128:131], v[140:143], v[104:107]
    buffer_load_dwordx4 v2, s[8:11], s57 offen offset:1024 lds
    s_waitcnt lgkmcnt(11)
    v_mfma_f32_16x16x32_bf16 v[104:107], a[152:155], v[144:147], v[104:107]
    ds_read_b64_tr_b16 v[174:175], v25 offset:46080
    v_cvt_pk_bf16_f32 v32, v96, v97
    v_mfma_f32_16x16x32_bf16 v[104:107], a[176:179], v[148:151], v[104:107]
    v_cvt_pk_bf16_f32 v33, v98, v99
    v_cvt_pk_bf16_f32 v42, v100, v101
    s_waitcnt lgkmcnt(8)
    v_mfma_f32_16x16x32_bf16 v[104:107], a[200:203], v[152:155], v[104:107]
    s_add_u32 m0, s90, 155648
    s_mov_b32 s57, 1118208
    v_cvt_pk_bf16_f32 v43, v102, v103
    v_mfma_f32_16x16x32_bf16 v[104:107], a[224:227], v[156:159], v[104:107]
    buffer_load_dwordx4 v2, s[8:11], s57 offen offset:0 lds
    s_waitcnt lgkmcnt(4)
    v_mfma_f32_16x16x32_bf16 v[104:107], a[248:251], v[160:163], v[104:107]
    ds_read_b64_tr_b16 a[52:53], v7 offset:0
    ds_read_b64_tr_b16 a[54:55], v7 offset:1024
    v_mfma_f32_16x16x32_bf16 v[104:107], v[192:195], v[164:167], v[104:107]
    ds_read_b64_tr_b16 a[72:73], v6 offset:8192
    ds_read_b64_tr_b16 a[74:75], v6 offset:9216
    s_waitcnt lgkmcnt(4)
    v_mfma_f32_16x16x32_bf16 v[104:107], v[216:219], v[168:171], v[104:107]
    s_mov_b32 s57, 1127936
    ds_read_b64_tr_b16 a[76:77], v7 offset:8192
    v_mfma_f32_16x16x32_bf16 v[104:107], v[240:243], v[172:175], v[104:107]
    buffer_load_dwordx4 v2, s[8:11], s57 offen offset:1024 lds
    v_mfma_f32_16x16x32_bf16 v[108:111], a[12:15], v[120:123], 0
    ds_read_b64_tr_b16 a[78:79], v7 offset:9216
    ds_read_b64_tr_b16 a[96:97], v6 offset:16384
    v_mfma_f32_16x16x32_bf16 v[108:111], a[36:39], v[124:127], v[108:111]
    ds_read_b64_tr_b16 a[98:99], v6 offset:17408
    ds_read_b64_tr_b16 a[100:101], v7 offset:16384
    v_mfma_f32_16x16x32_bf16 v[108:111], a[60:63], v[128:131], v[108:111]
    s_add_u32 m0, s52, 49152
    s_add_u32 s58, s72, 1024
    s_add_u32 s57, s58, s68
    ds_read_b64_tr_b16 a[102:103], v7 offset:17408
    v_mfma_f32_16x16x32_bf16 v[108:111], a[84:87], v[132:135], v[108:111]
    buffer_load_dwordx4 v3, s[24:27], s57 offen offset:0 sc1 lds
    s_waitcnt vmcnt(13)
    s_waitcnt lgkmcnt(0)
    s_barrier
    v_mfma_f32_16x16x32_bf16 v[108:111], a[108:111], v[136:139], v[108:111]
    ds_read_b64_tr_b16 a[120:121], v6 offset:24576
    ds_read_b64_tr_b16 a[122:123], v6 offset:25600
    v_mfma_f32_16x16x32_bf16 v[108:111], a[132:135], v[140:143], v[108:111]
    ds_read_b64_tr_b16 a[124:125], v7 offset:24576
    ds_read_b64_tr_b16 a[126:127], v7 offset:25600
    v_mfma_f32_16x16x32_bf16 v[108:111], a[156:159], v[144:147], v[108:111]
    s_add_u32 s57, s58, s69
    v_cvt_pk_bf16_f32 v60, v104, v105
    v_mfma_f32_16x16x32_bf16 v[108:111], a[180:183], v[148:151], v[108:111]
    buffer_load_dwordx4 v3, s[24:27], s57 offen offset:1024 sc1 lds
    v_mfma_f32_16x16x32_bf16 v[108:111], a[204:207], v[152:155], v[108:111]
    v_cvt_pk_bf16_f32 v61, v106, v107
    ds_read_b64_tr_b16 a[144:145], v6 offset:32768
    v_mfma_f32_16x16x32_bf16 v[108:111], a[228:231], v[156:159], v[108:111]
    ds_read_b64_tr_b16 a[146:147], v6 offset:33792
    ds_read_b64_tr_b16 a[148:149], v7 offset:32768
    v_mfma_f32_16x16x32_bf16 v[108:111], a[252:255], v[160:163], v[108:111]
    s_add_u32 s57, s58, s70
    ds_read_b64_tr_b16 a[150:151], v7 offset:33792
    v_mfma_f32_16x16x32_bf16 v[108:111], v[196:199], v[164:167], v[108:111]
    buffer_load_dwordx4 v24, s[24:27], s57 offen offset:2048 sc1 lds
    v_mfma_f32_16x16x32_bf16 v[108:111], v[220:223], v[168:171], v[108:111]
    ds_read_b64_tr_b16 a[168:169], v6 offset:40960
    ds_read_b64_tr_b16 a[170:171], v6 offset:41984
    v_mfma_f32_16x16x32_bf16 v[108:111], v[244:247], v[172:175], v[108:111]
    ds_read_b64_tr_b16 a[172:173], v7 offset:40960
    ds_read_b64_tr_b16 a[174:175], v7 offset:41984
    v_mfma_f32_16x16x32_bf16 v[112:115], v[120:123], a[16:19], 0
    s_add_u32 s57, s58, s71
    v_mfma_f32_16x16x32_bf16 v[112:115], v[124:127], a[40:43], v[112:115]
    buffer_load_dwordx4 v3, s[24:27], s57 offen offset:3072 sc1 lds
    v_mfma_f32_16x16x32_bf16 v[112:115], v[128:131], a[64:67], v[112:115]
    v_mfma_f32_16x16x32_bf16 v[112:115], v[132:135], a[88:91], v[112:115]
    s_waitcnt vmcnt(10)
    s_waitcnt lgkmcnt(0)
    s_barrier
    v_mfma_f32_16x16x32_bf16 v[112:115], v[136:139], a[112:115], v[112:115]
    ds_read_b64_tr_b16 a[192:193], v10 offset:0
    ds_read_b64_tr_b16 a[194:195], v10 offset:1024
    v_mfma_f32_16x16x32_bf16 v[112:115], v[140:143], a[136:139], v[112:115]
    ds_read_b64_tr_b16 a[196:197], v11 offset:0
    ds_read_b64_tr_b16 a[198:199], v11 offset:1024
    v_mfma_f32_16x16x32_bf16 v[112:115], v[144:147], a[160:163], v[112:115]
    v_cvt_pk_bf16_f32 v62, v108, v109
    v_cvt_pk_bf16_f32 v63, v110, v111
    v_mfma_f32_16x16x32_bf16 v[112:115], v[148:151], a[184:187], v[112:115]
    v_cndmask_b32 v62, v62, 0, s[82:83]
    v_cndmask_b32 v63, v63, 0, s[82:83]
    v_mfma_f32_16x16x32_bf16 v[112:115], v[152:155], a[208:211], v[112:115]
    ds_read_b64_tr_b16 a[216:217], v10 offset:8192
    ds_read_b64_tr_b16 a[218:219], v10 offset:9216
    v_mfma_f32_16x16x32_bf16 v[112:115], v[156:159], a[232:235], v[112:115]
    ds_read_b64_tr_b16 a[220:221], v11 offset:8192
    ds_read_b64_tr_b16 a[222:223], v11 offset:9216
    v_mfma_f32_16x16x32_bf16 v[112:115], v[160:163], v[176:179], v[112:115]
    ds_read_b64_tr_b16 a[240:241], v10 offset:16384
    ds_read_b64_tr_b16 a[242:243], v10 offset:17408
    v_mfma_f32_16x16x32_bf16 v[112:115], v[164:167], v[200:203], v[112:115]
    ds_read_b64_tr_b16 a[244:245], v11 offset:16384
    ds_read_b64_tr_b16 a[246:247], v11 offset:17408
    v_mfma_f32_16x16x32_bf16 v[112:115], v[168:171], v[224:227], v[112:115]
    v_mfma_f32_16x16x32_bf16 v[112:115], v[172:175], v[248:251], v[112:115]
    v_mfma_f32_16x16x32_bf16 v[116:119], v[120:123], a[20:23], 0
    v_mfma_f32_16x16x32_bf16 v[116:119], v[124:127], a[44:47], v[116:119]
    v_mfma_f32_16x16x32_bf16 v[116:119], v[128:131], a[68:71], v[116:119]
    v_mfma_f32_16x16x32_bf16 v[116:119], v[132:135], a[92:95], v[116:119]
    v_mfma_f32_16x16x32_bf16 v[116:119], v[136:139], a[116:119], v[116:119]
    v_mfma_f32_16x16x32_bf16 v[116:119], v[140:143], a[140:143], v[116:119]
    v_mfma_f32_16x16x32_bf16 v[116:119], v[144:147], a[164:167], v[116:119]
    s_nop 0
    v_cvt_pk_bf16_f32 v36, v112, v113
    v_cvt_pk_bf16_f32 v37, v114, v115
    v_mfma_f32_16x16x32_bf16 v[116:119], v[148:151], a[188:191], v[116:119]
    v_mfma_f32_16x16x32_bf16 v[116:119], v[152:155], a[212:215], v[116:119]
    v_mfma_f32_16x16x32_bf16 v[116:119], v[156:159], a[236:239], v[116:119]
    v_mfma_f32_16x16x32_bf16 v[116:119], v[160:163], v[180:183], v[116:119]
    v_mfma_f32_16x16x32_bf16 v[116:119], v[164:167], v[204:207], v[116:119]
    v_mfma_f32_16x16x32_bf16 v[116:119], v[168:171], v[228:231], v[116:119]
    v_mfma_f32_16x16x32_bf16 v[116:119], v[172:175], v[252:255], v[116:119]
    s_waitcnt vmcnt(4)
    s_waitcnt lgkmcnt(0)
    s_barrier
    v_mfma_f32_16x16x32_bf16 v[96:99], a[0:3], v[120:123], 0
    ds_read_b64_tr_b16 v[184:185], v10 offset:24576
    ds_read_b64_tr_b16 v[186:187], v10 offset:25600
    v_mfma_f32_16x16x32_bf16 v[96:99], a[24:27], v[124:127], v[96:99]
    ds_read_b64_tr_b16 v[188:189], v11 offset:24576
    ds_read_b64_tr_b16 v[190:191], v11 offset:25600
    v_mfma_f32_16x16x32_bf16 v[96:99], a[48:51], v[128:131], v[96:99]
    ds_read_b64_tr_b16 v[208:209], v10 offset:32768
    ds_read_b64_tr_b16 v[210:211], v10 offset:33792
    v_mfma_f32_16x16x32_bf16 v[96:99], a[72:75], v[132:135], v[96:99]
    ds_read_b64_tr_b16 v[212:213], v11 offset:32768
    ds_read_b64_tr_b16 v[214:215], v11 offset:33792
    v_mfma_f32_16x16x32_bf16 v[96:99], a[96:99], v[136:139], v[96:99]
    ds_read_b64_tr_b16 v[232:233], v10 offset:40960
    ds_read_b64_tr_b16 v[234:235], v10 offset:41984
    v_mfma_f32_16x16x32_bf16 v[96:99], a[120:123], v[140:143], v[96:99]
    ds_read_b64_tr_b16 v[236:237], v11 offset:40960
    ds_read_b64_tr_b16 v[238:239], v11 offset:41984
    v_mfma_f32_16x16x32_bf16 v[96:99], a[144:147], v[144:147], v[96:99]
    v_cvt_pk_bf16_f32 v46, v116, v117
    v_cvt_pk_bf16_f32 v47, v118, v119
    v_mfma_f32_16x16x32_bf16 v[96:99], a[168:171], v[148:151], v[96:99]
    v_mfma_f32_16x16x32_bf16 v[96:99], a[192:195], v[152:155], v[96:99]
    v_mfma_f32_16x16x32_bf16 v[96:99], a[216:219], v[156:159], v[96:99]
    s_waitcnt lgkmcnt(8)
    v_mfma_f32_16x16x32_bf16 v[96:99], a[240:243], v[160:163], v[96:99]
    v_mfma_f32_16x16x32_bf16 v[96:99], v[184:187], v[164:167], v[96:99]
    s_waitcnt lgkmcnt(0)
    s_barrier
    v_mfma_f32_16x16x32_bf16 v[96:99], v[208:211], v[168:171], v[96:99]
    s_add_u32 m0, s52, 65536
    s_add_u32 s58, s72, 1536
    s_add_u32 s57, s58, s68
    v_mfma_f32_16x16x32_bf16 v[96:99], v[232:235], v[172:175], v[96:99]
    buffer_load_dwordx4 v3, s[24:27], s57 offen offset:0 sc1 lds
    v_mfma_f32_16x16x32_bf16 v[100:103], a[4:7], v[120:123], 0
    ds_read_b64_tr_b16 v[120:121], v4 offset:16384
    ds_read_b64_tr_b16 v[122:123], v25 offset:16384
    v_mfma_f32_16x16x32_bf16 v[100:103], a[28:31], v[124:127], v[100:103]
    ds_read_b64_tr_b16 v[124:125], v4 offset:17408
    v_mfma_f32_16x16x32_bf16 v[100:103], a[52:55], v[128:131], v[100:103]
    ds_read_b64_tr_b16 v[126:127], v25 offset:17408
    ds_read_b64_tr_b16 v[128:129], v4 offset:18432
    v_mfma_f32_16x16x32_bf16 v[100:103], a[76:79], v[132:135], v[100:103]
    ds_read_b64_tr_b16 v[130:131], v25 offset:18432
    v_mfma_f32_16x16x32_bf16 v[100:103], a[100:103], v[136:139], v[100:103]
    ds_read_b64_tr_b16 v[132:133], v4 offset:19456
    s_add_u32 s57, s58, s69
    v_mfma_f32_16x16x32_bf16 v[100:103], a[124:127], v[140:143], v[100:103]
    buffer_load_dwordx4 v3, s[24:27], s57 offen offset:1024 sc1 lds
    v_mfma_f32_16x16x32_bf16 v[100:103], a[148:151], v[144:147], v[100:103]
    ds_read_b64_tr_b16 v[134:135], v25 offset:19456
    ds_read_b64_tr_b16 v[136:137], v4 offset:20480
    v_mfma_f32_16x16x32_bf16 v[100:103], a[172:175], v[148:151], v[100:103]
    ds_read_b64_tr_b16 v[138:139], v25 offset:20480
    ds_read_b64_tr_b16 v[140:141], v4 offset:21504
    v_mfma_f32_16x16x32_bf16 v[100:103], a[196:199], v[152:155], v[100:103]
    ds_read_b64_tr_b16 v[142:143], v25 offset:21504
    ds_read_b64_tr_b16 v[144:145], v4 offset:22528
    v_mfma_f32_16x16x32_bf16 v[100:103], a[220:223], v[156:159], v[100:103]
    ds_read_b64_tr_b16 v[146:147], v25 offset:22528
    v_cvt_pk_bf16_f32 v64, v96, v97
    v_mfma_f32_16x16x32_bf16 v[100:103], a[244:247], v[160:163], v[100:103]
    ds_read_b64_tr_b16 v[148:149], v4 offset:23552
    ds_read_b64_tr_b16 v[150:151], v25 offset:23552
    s_add_u32 s57, s58, s70
    v_mfma_f32_16x16x32_bf16 v[100:103], v[188:191], v[164:167], v[100:103]
    buffer_load_dwordx4 v24, s[24:27], s57 offen offset:2048 sc1 lds
    v_mfma_f32_16x16x32_bf16 v[100:103], v[212:215], v[168:171], v[100:103]
    ds_read_b64_tr_b16 v[152:153], v4 offset:24576
    ds_read_b64_tr_b16 v[154:155], v25 offset:24576
    v_mfma_f32_16x16x32_bf16 v[100:103], v[236:239], v[172:175], v[100:103]
    ds_read_b64_tr_b16 v[156:157], v4 offset:25600
    ds_read_b64_tr_b16 v[158:159], v25 offset:25600
    s_waitcnt lgkmcnt(15)
    v_mfma_f32_16x16x32_bf16 v[104:107], a[0:3], v[120:123], 0
    ds_read_b64_tr_b16 v[160:161], v4 offset:26624
    v_cvt_pk_bf16_f32 v65, v98, v99
    v_mfma_f32_16x16x32_bf16 v[104:107], a[24:27], v[124:127], v[104:107]
    ds_read_b64_tr_b16 v[162:163], v25 offset:26624
    ds_read_b64_tr_b16 v[164:165], v4 offset:27648
    s_waitcnt lgkmcnt(15)
    v_mfma_f32_16x16x32_bf16 v[104:107], a[48:51], v[128:131], v[104:107]
    ds_read_b64_tr_b16 v[166:167], v25 offset:27648
    s_add_u32 s57, s58, s71
    v_mfma_f32_16x16x32_bf16 v[104:107], a[72:75], v[132:135], v[104:107]
    buffer_load_dwordx4 v3, s[24:27], s57 offen offset:3072 sc1 lds
    s_waitcnt lgkmcnt(12)
    v_mfma_f32_16x16x32_bf16 v[104:107], a[96:99], v[136:139], v[104:107]
    ds_read_b64_tr_b16 v[168:169], v4 offset:28672
    ds_read_b64_tr_b16 v[170:171], v25 offset:28672
    v_mfma_f32_16x16x32_bf16 v[104:107], a[120:123], v[140:143], v[104:107]
    ds_read_b64_tr_b16 v[172:173], v4 offset:29696
    ds_read_b64_tr_b16 v[174:175], v25 offset:29696
    s_waitcnt lgkmcnt(12)
    v_mfma_f32_16x16x32_bf16 v[104:107], a[144:147], v[144:147], v[104:107]
    v_cvt_pk_bf16_f32 v66, v100, v101
    v_cvt_pk_bf16_f32 v67, v102, v103
    v_mfma_f32_16x16x32_bf16 v[104:107], a[168:171], v[148:151], v[104:107]
    v_cndmask_b32 v66, v66, 0, s[82:83]
    v_cndmask_b32 v67, v67, 0, s[82:83]
    s_waitcnt lgkmcnt(8)
    v_mfma_f32_16x16x32_bf16 v[104:107], a[192:195], v[152:155], v[104:107]
    s_add_u32 m0, s52, 81920
    s_add_u32 s58, s72, 2048
    s_add_u32 s57, s58, s68
    v_mfma_f32_16x16x32_bf16 v[104:107], a[216:219], v[156:159], v[104:107]
    buffer_load_dwordx4 v3, s[24:27], s57 offen offset:0 sc1 lds
    s_waitcnt lgkmcnt(4)
    v_mfma_f32_16x16x32_bf16 v[104:107], a[240:243], v[160:163], v[104:107]
    v_mfma_f32_16x16x32_bf16 v[104:107], v[184:187], v[164:167], v[104:107]
    s_waitcnt lgkmcnt(0)
    v_mfma_f32_16x16x32_bf16 v[104:107], v[208:211], v[168:171], v[104:107]
    v_mfma_f32_16x16x32_bf16 v[104:107], v[232:235], v[172:175], v[104:107]
    s_waitcnt vmcnt(5)
    s_barrier
    v_mfma_f32_16x16x32_bf16 v[108:111], a[4:7], v[120:123], 0
    ds_read_b64_tr_b16 v[120:121], v4 offset:49152
    ds_read_b64_tr_b16 v[122:123], v25 offset:49152
    s_add_u32 s57, s58, s69
    v_mfma_f32_16x16x32_bf16 v[108:111], a[28:31], v[124:127], v[108:111]
    buffer_load_dwordx4 v3, s[24:27], s57 offen offset:1024 sc1 lds
    v_mfma_f32_16x16x32_bf16 v[108:111], a[52:55], v[128:131], v[108:111]
    ds_read_b64_tr_b16 v[124:125], v4 offset:50176
    ds_read_b64_tr_b16 v[126:127], v25 offset:50176
    v_mfma_f32_16x16x32_bf16 v[108:111], a[76:79], v[132:135], v[108:111]
    ds_read_b64_tr_b16 v[128:129], v4 offset:51200
    ds_read_b64_tr_b16 v[130:131], v25 offset:51200
    v_mfma_f32_16x16x32_bf16 v[108:111], a[100:103], v[136:139], v[108:111]
    ds_read_b64_tr_b16 v[132:133], v4 offset:52224
    v_mfma_f32_16x16x32_bf16 v[108:111], a[124:127], v[140:143], v[108:111]
    ds_read_b64_tr_b16 v[134:135], v25 offset:52224
    ds_read_b64_tr_b16 v[136:137], v4 offset:53248
    v_mfma_f32_16x16x32_bf16 v[108:111], a[148:151], v[144:147], v[108:111]
    ds_read_b64_tr_b16 v[138:139], v25 offset:53248
    s_add_u32 s57, s58, s70
    v_mfma_f32_16x16x32_bf16 v[108:111], a[172:175], v[148:151], v[108:111]
    buffer_load_dwordx4 v24, s[24:27], s57 offen offset:2048 sc1 lds
    v_mfma_f32_16x16x32_bf16 v[108:111], a[196:199], v[152:155], v[108:111]
    ds_read_b64_tr_b16 v[140:141], v4 offset:54272
    ds_read_b64_tr_b16 v[142:143], v25 offset:54272
    v_mfma_f32_16x16x32_bf16 v[108:111], a[220:223], v[156:159], v[108:111]
    ds_read_b64_tr_b16 v[144:145], v4 offset:55296
    ds_read_b64_tr_b16 v[146:147], v25 offset:55296
    v_mfma_f32_16x16x32_bf16 v[108:111], a[244:247], v[160:163], v[108:111]
    ds_read_b64_tr_b16 v[148:149], v4 offset:56320
    ds_read_b64_tr_b16 v[150:151], v25 offset:56320
    v_mfma_f32_16x16x32_bf16 v[108:111], v[188:191], v[164:167], v[108:111]
    ds_read_b64_tr_b16 v[152:153], v4 offset:57344
    v_cvt_pk_bf16_f32 v68, v104, v105
    v_mfma_f32_16x16x32_bf16 v[108:111], v[212:215], v[168:171], v[108:111]
    ds_read_b64_tr_b16 v[154:155], v25 offset:57344
    ds_read_b64_tr_b16 v[156:157], v4 offset:58368
    s_add_u32 s57, s58, s71
    v_mfma_f32_16x16x32_bf16 v[108:111], v[236:239], v[172:175], v[108:111]
    buffer_load_dwordx4 v3, s[24:27], s57 offen offset:3072 sc1 lds
    s_waitcnt lgkmcnt(15)
    v_mfma_f32_16x16x32_bf16 v[112:115], a[8:11], v[120:123], 0
    ds_read_b64_tr_b16 v[158:159], v25 offset:58368
    ds_read_b64_tr_b16 v[160:161], v4 offset:59392
    v_mfma_f32_16x16x32_bf16 v[112:115], a[32:35], v[124:127], v[112:115]
    ds_read_b64_tr_b16 v[162:163], v25 offset:59392
    ds_read_b64_tr_b16 v[164:165], v4 offset:60416
    s_waitcnt lgkmcnt(15)
    v_mfma_f32_16x16x32_bf16 v[112:115], a[56:59], v[128:131], v[112:115]
    ds_read_b64_tr_b16 v[166:167], v25 offset:60416
    v_cvt_pk_bf16_f32 v69, v106, v107
    v_mfma_f32_16x16x32_bf16 v[112:115], a[80:83], v[132:135], v[112:115]
    ds_read_b64_tr_b16 v[168:169], v4 offset:61440
    s_waitcnt lgkmcnt(13)
    v_mfma_f32_16x16x32_bf16 v[112:115], a[104:107], v[136:139], v[112:115]
    ds_read_b64_tr_b16 v[170:171], v25 offset:61440
    ds_read_b64_tr_b16 v[172:173], v4 offset:62464
    s_add_u32 m0, s52, 98304
    s_add_u32 s58, s72, 2560
    s_add_u32 s57, s58, s68
    v_mfma_f32_16x16x32_bf16 v[112:115], a[128:131], v[140:143], v[112:115]
    buffer_load_dwordx4 v3, s[24:27], s57 offen offset:0 sc1 lds
    s_waitcnt lgkmcnt(11)
    v_mfma_f32_16x16x32_bf16 v[112:115], a[152:155], v[144:147], v[112:115]
    ds_read_b64_tr_b16 v[174:175], v25 offset:62464
    v_cvt_pk_bf16_f32 v70, v108, v109
    v_mfma_f32_16x16x32_bf16 v[112:115], a[176:179], v[148:151], v[112:115]
    v_cvt_pk_bf16_f32 v71, v110, v111
    v_cndmask_b32 v70, v70, 0, s[82:83]
    s_waitcnt lgkmcnt(8)
    v_mfma_f32_16x16x32_bf16 v[112:115], a[200:203], v[152:155], v[112:115]
    v_cndmask_b32 v71, v71, 0, s[82:83]
    v_mov_b32 v8, 0
    v_mfma_f32_16x16x32_bf16 v[112:115], a[224:227], v[156:159], v[112:115]
    v_mov_b32 v9, 0
    v_mov_b32 v10, 0
    s_waitcnt lgkmcnt(4)
    v_mfma_f32_16x16x32_bf16 v[112:115], a[248:251], v[160:163], v[112:115]
    s_add_u32 s57, s58, s69
    v_mfma_f32_16x16x32_bf16 v[72:75], v[52:55], v[68:71], 0
    v_mfma_f32_16x16x32_bf16 v[112:115], v[192:195], v[164:167], v[112:115]
    buffer_load_dwordx4 v3, s[24:27], s57 offen offset:1024 sc1 lds
    s_waitcnt lgkmcnt(0)
    v_mfma_f32_16x16x32_bf16 v[112:115], v[216:219], v[168:171], v[112:115]
    v_mfma_f32_16x16x32_bf16 v[76:79], v[56:59], v[68:71], 0
    v_mfma_f32_16x16x32_bf16 v[112:115], v[240:243], v[172:175], v[112:115]
    ds_read_u16_d16_hi v8, v93 offset:0
    ds_read_u16_d16_hi v9, v94 offset:0
    v_mfma_f32_16x16x32_bf16 v[116:119], a[12:15], v[120:123], 0
    ds_read_u16_d16_hi v10, v92 offset:0
    v_mfma_f32_16x16x32_bf16 v[116:119], a[36:39], v[124:127], v[116:119]
    v_mfma_f32_16x16x32_bf16 v[116:119], a[60:63], v[128:131], v[116:119]
    s_add_u32 s57, s58, s70
    v_mfma_f32_16x16x32_bf16 v[116:119], a[84:87], v[132:135], v[116:119]
    buffer_load_dwordx4 v24, s[24:27], s57 offen offset:2048 sc1 lds
    v_mfma_f32_16x16x32_bf16 v[116:119], a[108:111], v[136:139], v[116:119]
    v_cndmask_b32 v26, v72, v73, s[76:77]
    v_cndmask_b32 v27, v74, v75, s[76:77]
    v_mfma_f32_16x16x32_bf16 v[116:119], a[132:135], v[140:143], v[116:119]
    v_cndmask_b32 v28, v76, v77, s[76:77]
    v_cndmask_b32 v29, v78, v79, s[76:77]
    v_mfma_f32_16x16x32_bf16 v[116:119], a[156:159], v[144:147], v[116:119]
    v_cvt_pk_bf16_f32 v52, v112, v113
    v_cvt_pk_bf16_f32 v53, v114, v115
    v_mfma_f32_16x16x32_bf16 v[116:119], a[180:183], v[148:151], v[116:119]
    v_cndmask_b32 v26, v26, v28, s[78:79]
    v_cndmask_b32 v27, v27, v29, s[80:81]
    v_mfma_f32_16x16x32_bf16 v[116:119], a[204:207], v[152:155], v[116:119]
    s_add_u32 s57, s58, s71
    s_waitcnt lgkmcnt(0)
    v_mfma_f32_16x16x32_bf16 v[116:119], a[228:231], v[156:159], v[116:119]
    buffer_load_dwordx4 v3, s[24:27], s57 offen offset:3072 sc1 lds
    v_mfma_f32_16x16x32_bf16 v[116:119], a[252:255], v[160:163], v[116:119]
    v_mul_f32 v26, v26, v8
    v_mul_f32 v27, v27, v9
    v_mfma_f32_16x16x32_bf16 v[116:119], v[196:199], v[164:167], v[116:119]
    v_mul_f32 v11, s91, v10
    v_cndmask_b32 v26, v26, v18, s[84:85]
    v_mfma_f32_16x16x32_bf16 v[116:119], v[220:223], v[168:171], v[116:119]
    v_cndmask_b32 v27, v27, v18, s[86:87]
    v_max_f32 v28, v26, v27
    v_mfma_f32_16x16x32_bf16 v[116:119], v[244:247], v[172:175], v[116:119]
    v_mov_b32 v29, v28
    v_mfma_f32_16x16x32_bf16 v[96:99], v[120:123], a[16:19], 0
    s_add_u32 m0, s52, 114688
    s_add_u32 s58, s72, 3072
    s_add_u32 s57, s58, s68
    v_mfma_f32_16x16x32_bf16 v[96:99], v[124:127], a[40:43], v[96:99]
    buffer_load_dwordx4 v3, s[24:27], s57 offen offset:0 sc1 lds
    v_mfma_f32_16x16x32_bf16 v[96:99], v[128:131], a[64:67], v[96:99]
    v_permlane16_swap_b32 v28, v29
    v_max_f32 v28, v28, v29
    v_mfma_f32_16x16x32_bf16 v[96:99], v[132:135], a[88:91], v[96:99]
    v_mov_b32 v29, v28
    v_mfma_f32_16x16x32_bf16 v[96:99], v[136:139], a[112:115], v[96:99]
    v_mfma_f32_16x16x32_bf16 v[96:99], v[140:143], a[136:139], v[96:99]
    v_permlane32_swap_b32 v28, v29
    v_max_f32 v28, v28, v29
    v_mfma_f32_16x16x32_bf16 v[96:99], v[144:147], a[160:163], v[96:99]
    s_add_u32 s57, s58, s69
    v_cvt_pk_bf16_f32 v54, v116, v117
    v_mfma_f32_16x16x32_bf16 v[96:99], v[148:151], a[184:187], v[96:99]
    buffer_load_dwordx4 v3, s[24:27], s57 offen offset:1024 sc1 lds
    v_mfma_f32_16x16x32_bf16 v[96:99], v[152:155], a[208:211], v[96:99]
    v_cvt_pk_bf16_f32 v55, v118, v119
    v_cndmask_b32 v54, v54, 0, s[82:83]
    v_mfma_f32_16x16x32_bf16 v[96:99], v[156:159], a[232:235], v[96:99]
    v_cndmask_b32 v55, v55, 0, s[82:83]
    v_sub_f32 v26, v26, v28
    v_mfma_f32_16x16x32_bf16 v[96:99], v[160:163], v[176:179], v[96:99]
    v_sub_f32 v27, v27, v28
    v_mul_f32 v26, v11, v26
    v_mfma_f32_16x16x32_bf16 v[96:99], v[164:167], v[200:203], v[96:99]
    v_mul_f32 v27, v11, v27
    v_exp_f32 v26, v26
    v_mfma_f32_16x16x32_bf16 v[96:99], v[168:171], v[224:227], v[96:99]
    s_add_u32 s57, s58, s70
    v_exp_f32 v27, v27
    v_mfma_f32_16x16x32_bf16 v[96:99], v[172:175], v[248:251], v[96:99]
    buffer_load_dwordx4 v24, s[24:27], s57 offen offset:2048 sc1 lds
    v_mfma_f32_16x16x32_bf16 v[100:103], v[120:123], a[20:23], 0
    v_add_f32 v28, v26, v27
    v_mov_b32 v29, v28
    v_mfma_f32_16x16x32_bf16 v[100:103], v[124:127], a[44:47], v[100:103]
    v_mfma_f32_16x16x32_bf16 v[100:103], v[128:131], a[68:71], v[100:103]
    v_permlane16_swap_b32 v28, v29
    v_add_f32 v28, v28, v29
    v_mfma_f32_16x16x32_bf16 v[100:103], v[132:135], a[92:95], v[100:103]
    v_mov_b32 v29, v28
    v_mfma_f32_16x16x32_bf16 v[100:103], v[136:139], a[116:119], v[100:103]
    s_add_u32 s57, s58, s71
    v_mfma_f32_16x16x32_bf16 v[100:103], v[140:143], a[140:143], v[100:103]
    buffer_load_dwordx4 v3, s[24:27], s57 offen offset:3072 sc1 lds
    v_mfma_f32_16x16x32_bf16 v[100:103], v[144:147], a[164:167], v[100:103]
    v_cvt_pk_bf16_f32 v38, v96, v97
    v_cvt_pk_bf16_f32 v39, v98, v99
    v_mfma_f32_16x16x32_bf16 v[100:103], v[148:151], a[188:191], v[100:103]
    v_permlane32_swap_b32 v28, v29
    v_add_f32 v28, v28, v29
    v_mfma_f32_16x16x32_bf16 v[100:103], v[152:155], a[212:215], v[100:103]
    v_rcp_f32 v28, v28
    v_mfma_f32_16x16x32_bf16 v[100:103], v[156:159], a[236:239], v[100:103]
    v_mul_f32 v26, v26, v8
    v_mul_f32 v27, v27, v9
    v_mfma_f32_16x16x32_bf16 v[100:103], v[160:163], v[180:183], v[100:103]
    s_add_u32 m0, s52, 131072
    s_add_u32 s58, s72, 3584
    s_add_u32 s57, s58, s68
    v_mul_f32 v26, v26, v28
    v_mfma_f32_16x16x32_bf16 v[100:103], v[164:167], v[204:207], v[100:103]
    buffer_load_dwordx4 v3, s[24:27], s57 offen offset:0 sc1 lds
    v_mfma_f32_16x16x32_bf16 v[100:103], v[168:171], v[228:231], v[100:103]
    v_mul_f32 v27, v27, v28
    v_cvt_pk_bf16_f32 v26, v26, v26
    v_mfma_f32_16x16x32_bf16 v[100:103], v[172:175], v[252:255], v[100:103]
    v_cvt_pk_bf16_f32 v27, v27, v27
    v_and_b32 v80, v26, v14
    v_mfma_f32_16x16x32_bf16 v[104:107], a[0:3], v[120:123], 0
    v_and_b32 v81, v27, v15
    v_and_b32 v82, v26, v16
    v_mfma_f32_16x16x32_bf16 v[104:107], a[24:27], v[124:127], v[104:107]
    v_and_b32 v83, v27, v17
    v_mfma_f32_16x16x32_bf16 v[104:107], a[48:51], v[128:131], v[104:107]
    s_add_u32 s57, s58, s69
    v_mfma_f32_16x16x32_bf16 v[104:107], a[72:75], v[132:135], v[104:107]
    buffer_load_dwordx4 v3, s[24:27], s57 offen offset:1024 sc1 lds
L_wa_1:
    s_cbranch_execz L_wa_ret
    v_mfma_f32_16x16x32_bf16 v[104:107], a[96:99], v[136:139], v[104:107]
    v_mfma_f32_16x16x32_bf16 v[72:75], v[32:35], v[80:83], 0
    v_mfma_f32_16x16x32_bf16 v[104:107], a[120:123], v[140:143], v[104:107]
    v_mfma_f32_16x16x32_bf16 v[76:79], v[42:45], v[80:83], 0
    v_mfma_f32_16x16x32_bf16 v[104:107], a[144:147], v[144:147], v[104:107]
    v_cvt_pk_bf16_f32 v48, v100, v101
    v_cvt_pk_bf16_f32 v49, v102, v103
    v_mfma_f32_16x16x32_bf16 v[104:107], a[168:171], v[148:151], v[104:107]
    s_add_u32 s53, s74, 0
    v_mfma_f32_16x16x32_bf16 v[104:107], a[192:195], v[152:155], v[104:107]
    s_add_u32 s57, s58, s70
    v_mfma_f32_16x16x32_bf16 v[104:107], a[216:219], v[156:159], v[104:107]
    buffer_load_dwordx4 v24, s[24:27], s57 offen offset:2048 sc1 lds
    v_mfma_f32_16x16x32_bf16 v[104:107], a[240:243], v[160:163], v[104:107]
    v_mfma_f32_16x16x32_bf16 v[104:107], v[184:187], v[164:167], v[104:107]
    v_mfma_f32_16x16x32_bf16 v[104:107], v[208:211], v[168:171], v[104:107]
    v_cvt_pk_bf16_f32 v84, v72, v73
    v_cvt_pk_bf16_f32 v85, v74, v75
    v_mfma_f32_16x16x32_bf16 v[104:107], v[232:235], v[172:175], v[104:107]
    v_cvt_pk_bf16_f32 v86, v76, v77
    v_cvt_pk_bf16_f32 v87, v78, v79
    s_waitcnt vmcnt(7)
    s_barrier
    v_mfma_f32_16x16x32_bf16 v[108:111], a[4:7], v[120:123], 0
    v_add_u32 v4, 65536, v4
    v_add_u32 v25, 65536, v25
    ds_read_b64_tr_b16 v[120:121], v4 offset:0
    ds_read_b64_tr_b16 v[122:123], v25 offset:0
    s_add_u32 s57, s58, s71
    v_mfma_f32_16x16x32_bf16 v[108:111], a[28:31], v[124:127], v[108:111]
    buffer_load_dwordx4 v3, s[24:27], s57 offen offset:3072 sc1 lds
    v_mfma_f32_16x16x32_bf16 v[108:111], a[52:55], v[128:131], v[108:111]
    ds_read_b64_tr_b16 v[124:125], v4 offset:1024
    ds_read_b64_tr_b16 v[126:127], v25 offset:1024
    v_mfma_f32_16x16x32_bf16 v[108:111], a[76:79], v[132:135], v[108:111]
    ds_read_b64_tr_b16 v[128:129], v4 offset:2048
    ds_read_b64_tr_b16 v[130:131], v25 offset:2048
    v_mfma_f32_16x16x32_bf16 v[108:111], a[100:103], v[136:139], v[108:111]
    ds_read_b64_tr_b16 v[132:133], v4 offset:3072
    buffer_store_dwordx4 v[84:87], v23, s[24:27], s53 offen sc1
    v_mfma_f32_16x16x32_bf16 v[108:111], a[124:127], v[140:143], v[108:111]
    ds_read_b64_tr_b16 v[134:135], v25 offset:3072
    ds_read_b64_tr_b16 v[136:137], v4 offset:4096
    v_mfma_f32_16x16x32_bf16 v[108:111], a[148:151], v[144:147], v[108:111]
    ds_read_b64_tr_b16 v[138:139], v25 offset:4096
    s_add_u32 s57, s73, 0
    v_mfma_f32_16x16x32_bf16 v[108:111], a[172:175], v[148:151], v[108:111]
    buffer_load_dword v22, v5, s[20:23], s57 offen
    v_mfma_f32_16x16x32_bf16 v[108:111], a[196:199], v[152:155], v[108:111]
    ds_read_b64_tr_b16 v[140:141], v4 offset:5120
    ds_read_b64_tr_b16 v[142:143], v25 offset:5120
    v_mfma_f32_16x16x32_bf16 v[108:111], a[220:223], v[156:159], v[108:111]
    ds_read_b64_tr_b16 v[144:145], v4 offset:6144
    ds_read_b64_tr_b16 v[146:147], v25 offset:6144
    v_mfma_f32_16x16x32_bf16 v[108:111], a[244:247], v[160:163], v[108:111]
    ds_read_b64_tr_b16 v[148:149], v4 offset:7168
    ds_read_b64_tr_b16 v[150:151], v25 offset:7168
    v_mfma_f32_16x16x32_bf16 v[108:111], v[188:191], v[164:167], v[108:111]
    ds_read_b64_tr_b16 v[152:153], v4 offset:8192
    v_cvt_pk_bf16_f32 v68, v104, v105
    v_mfma_f32_16x16x32_bf16 v[108:111], v[212:215], v[168:171], v[108:111]
    ds_read_b64_tr_b16 v[154:155], v25 offset:8192
    ds_read_b64_tr_b16 v[156:157], v4 offset:9216
    v_mfma_f32_16x16x32_bf16 v[108:111], v[236:239], v[172:175], v[108:111]
    ds_read_b64_tr_b16 v[158:159], v25 offset:9216
    v_cvt_pk_bf16_f32 v69, v106, v107
    s_waitcnt lgkmcnt(15)
    v_mfma_f32_16x16x32_bf16 v[112:115], a[8:11], v[120:123], 0
    ds_read_b64_tr_b16 v[160:161], v4 offset:10240
    v_cndmask_b32 v80, v84, v86, s[88:89]
    v_mfma_f32_16x16x32_bf16 v[112:115], a[32:35], v[124:127], v[112:115]
    ds_read_b64_tr_b16 v[162:163], v25 offset:10240
    ds_read_b64_tr_b16 v[164:165], v4 offset:11264
    s_waitcnt lgkmcnt(15)
    v_mfma_f32_16x16x32_bf16 v[112:115], a[56:59], v[128:131], v[112:115]
    ds_read_b64_tr_b16 v[166:167], v25 offset:11264
    v_cndmask_b32 v81, v85, v87, s[88:89]
    v_mfma_f32_16x16x32_bf16 v[112:115], a[80:83], v[132:135], v[112:115]
    ds_read_b64_tr_b16 v[168:169], v4 offset:12288
    ds_write_b64 v95, v[80:81] offset:0
    s_waitcnt lgkmcnt(14)
    v_mfma_f32_16x16x32_bf16 v[112:115], a[104:107], v[136:139], v[112:115]
    ds_read_b64_tr_b16 v[170:171], v25 offset:12288
    ds_read_b64_tr_b16 v[172:173], v4 offset:13312
    v_mfma_f32_16x16x32_bf16 v[112:115], a[128:131], v[140:143], v[112:115]
    ds_read_b64_tr_b16 v[174:175], v25 offset:13312
    s_waitcnt lgkmcnt(13)
    v_mfma_f32_16x16x32_bf16 v[112:115], a[152:155], v[144:147], v[112:115]
    v_cvt_pk_bf16_f32 v70, v108, v109
    v_cvt_pk_bf16_f32 v71, v110, v111
    v_mfma_f32_16x16x32_bf16 v[112:115], a[176:179], v[148:151], v[112:115]
    v_cndmask_b32 v70, v70, 0, s[82:83]
    v_cndmask_b32 v71, v71, 0, s[82:83]
    s_waitcnt lgkmcnt(9)
    v_mfma_f32_16x16x32_bf16 v[112:115], a[200:203], v[152:155], v[112:115]
    v_mfma_f32_16x16x32_bf16 v[72:75], v[56:59], v[64:67], 0
    v_mfma_f32_16x16x32_bf16 v[112:115], a[224:227], v[156:159], v[112:115]
    v_mfma_f32_16x16x32_bf16 v[76:79], v[60:63], v[64:67], 0
    s_waitcnt lgkmcnt(5)
    v_mfma_f32_16x16x32_bf16 v[112:115], a[248:251], v[160:163], v[112:115]
    ds_read_u16_d16_hi v8, v93 offset:16384
    ds_read_u16_d16_hi v9, v94 offset:16384
    v_mfma_f32_16x16x32_bf16 v[112:115], v[192:195], v[164:167], v[112:115]
    ds_read_u16_d16_hi v10, v92 offset:16384
    s_waitcnt lgkmcnt(3)
    v_mfma_f32_16x16x32_bf16 v[112:115], v[216:219], v[168:171], v[112:115]
    v_mfma_f32_16x16x32_bf16 v[112:115], v[240:243], v[172:175], v[112:115]
    v_mfma_f32_16x16x32_bf16 v[116:119], a[12:15], v[120:123], 0
    v_mfma_f32_16x16x32_bf16 v[116:119], a[36:39], v[124:127], v[116:119]
    v_cndmask_b32 v26, v72, v73, s[76:77]
    v_cndmask_b32 v27, v74, v75, s[76:77]
    v_mfma_f32_16x16x32_bf16 v[116:119], a[60:63], v[128:131], v[116:119]
    v_cndmask_b32 v28, v76, v77, s[76:77]
    v_cndmask_b32 v29, v78, v79, s[76:77]
    v_mfma_f32_16x16x32_bf16 v[116:119], a[84:87], v[132:135], v[116:119]
    v_cndmask_b32 v26, v26, v28, s[78:79]
    v_cndmask_b32 v27, v27, v29, s[80:81]
    v_mfma_f32_16x16x32_bf16 v[116:119], a[108:111], v[136:139], v[116:119]
    s_waitcnt lgkmcnt(0)
    v_mul_f32 v26, v26, v8
    v_mfma_f32_16x16x32_bf16 v[116:119], a[132:135], v[140:143], v[116:119]
    v_mul_f32 v27, v27, v9
    v_mul_f32 v11, s91, v10
    v_mfma_f32_16x16x32_bf16 v[116:119], a[156:159], v[144:147], v[116:119]
    v_cvt_pk_bf16_f32 v56, v112, v113
    v_cvt_pk_bf16_f32 v57, v114, v115
    v_mfma_f32_16x16x32_bf16 v[116:119], a[180:183], v[148:151], v[116:119]
    v_max_f32 v28, v26, v27
    v_mov_b32 v29, v28
    v_mfma_f32_16x16x32_bf16 v[116:119], a[204:207], v[152:155], v[116:119]
    v_mfma_f32_16x16x32_bf16 v[116:119], a[228:231], v[156:159], v[116:119]
    v_permlane16_swap_b32 v28, v29
    v_max_f32 v28, v28, v29
    v_mfma_f32_16x16x32_bf16 v[116:119], a[252:255], v[160:163], v[116:119]
    v_mov_b32 v29, v28
    v_mfma_f32_16x16x32_bf16 v[116:119], v[196:199], v[164:167], v[116:119]
    v_mfma_f32_16x16x32_bf16 v[116:119], v[220:223], v[168:171], v[116:119]
    v_permlane32_swap_b32 v28, v29
    v_max_f32 v28, v28, v29
    v_mfma_f32_16x16x32_bf16 v[116:119], v[244:247], v[172:175], v[116:119]
    v_sub_f32 v26, v26, v28
    v_sub_f32 v27, v27, v28
    v_mfma_f32_16x16x32_bf16 v[96:99], v[120:123], a[16:19], 0
    v_mul_f32 v26, v11, v26
    v_mul_f32 v27, v11, v27
    v_mfma_f32_16x16x32_bf16 v[96:99], v[124:127], a[40:43], v[96:99]
    v_exp_f32 v26, v26
    v_mfma_f32_16x16x32_bf16 v[96:99], v[128:131], a[64:67], v[96:99]
    v_exp_f32 v27, v27
    v_mfma_f32_16x16x32_bf16 v[96:99], v[132:135], a[88:91], v[96:99]
    v_add_f32 v28, v26, v27
    v_mov_b32 v29, v28
    v_mfma_f32_16x16x32_bf16 v[96:99], v[136:139], a[112:115], v[96:99]
    v_mfma_f32_16x16x32_bf16 v[96:99], v[140:143], a[136:139], v[96:99]
    v_permlane16_swap_b32 v28, v29
    v_add_f32 v28, v28, v29
    v_mfma_f32_16x16x32_bf16 v[96:99], v[144:147], a[160:163], v[96:99]
    v_cvt_pk_bf16_f32 v58, v116, v117
    v_cvt_pk_bf16_f32 v59, v118, v119
    v_mfma_f32_16x16x32_bf16 v[96:99], v[148:151], a[184:187], v[96:99]
    v_cndmask_b32 v58, v58, 0, s[82:83]
    v_cndmask_b32 v59, v59, 0, s[82:83]
    v_mfma_f32_16x16x32_bf16 v[96:99], v[152:155], a[208:211], v[96:99]
    v_mov_b32 v29, v28
    v_mfma_f32_16x16x32_bf16 v[96:99], v[156:159], a[232:235], v[96:99]
    v_mfma_f32_16x16x32_bf16 v[96:99], v[160:163], v[176:179], v[96:99]
    v_permlane32_swap_b32 v28, v29
    v_add_f32 v28, v28, v29
    v_mfma_f32_16x16x32_bf16 v[96:99], v[164:167], v[200:203], v[96:99]
    v_rcp_f32 v28, v28
    v_mfma_f32_16x16x32_bf16 v[96:99], v[168:171], v[224:227], v[96:99]
    v_mul_f32 v26, v26, v8
    v_mul_f32 v27, v27, v9
    v_mfma_f32_16x16x32_bf16 v[96:99], v[172:175], v[248:251], v[96:99]
    v_mul_f32 v26, v26, v28
    v_mul_f32 v27, v27, v28
    v_mfma_f32_16x16x32_bf16 v[100:103], v[120:123], a[20:23], 0
    v_cvt_pk_bf16_f32 v26, v26, v26
    v_cvt_pk_bf16_f32 v27, v27, v27
    v_mfma_f32_16x16x32_bf16 v[100:103], v[124:127], a[44:47], v[100:103]
    v_and_b32 v80, v26, v14
    v_and_b32 v81, v27, v15
    v_mfma_f32_16x16x32_bf16 v[100:103], v[128:131], a[68:71], v[100:103]
    v_and_b32 v82, v26, v16
    v_and_b32 v83, v27, v17
    v_mfma_f32_16x16x32_bf16 v[100:103], v[132:135], a[92:95], v[100:103]
    v_mfma_f32_16x16x32_bf16 v[100:103], v[136:139], a[116:119], v[100:103]
    v_mfma_f32_16x16x32_bf16 v[72:75], v[34:37], v[80:83], 0
    v_mfma_f32_16x16x32_bf16 v[100:103], v[140:143], a[140:143], v[100:103]
    v_mfma_f32_16x16x32_bf16 v[76:79], v[44:47], v[80:83], 0
    v_mfma_f32_16x16x32_bf16 v[100:103], v[144:147], a[164:167], v[100:103]
    s_add_u32 s57, s73, 524288
    v_cvt_pk_bf16_f32 v40, v96, v97
    v_mfma_f32_16x16x32_bf16 v[100:103], v[148:151], a[188:191], v[100:103]
    buffer_load_dword v22, v5, s[20:23], s57 offen
    v_mfma_f32_16x16x32_bf16 v[100:103], v[152:155], a[212:215], v[100:103]
    v_cvt_pk_bf16_f32 v41, v98, v99
    v_cvt_pk_bf16_f32 v32, v96, v97
    v_mfma_f32_16x16x32_bf16 v[100:103], v[156:159], a[236:239], v[100:103]
    v_cvt_pk_bf16_f32 v33, v98, v99
    s_add_u32 s53, s74, 16384
    v_mfma_f32_16x16x32_bf16 v[100:103], v[160:163], v[180:183], v[100:103]
    v_mfma_f32_16x16x32_bf16 v[100:103], v[164:167], v[204:207], v[100:103]
    v_mfma_f32_16x16x32_bf16 v[100:103], v[168:171], v[228:231], v[100:103]
    v_mfma_f32_16x16x32_bf16 v[100:103], v[172:175], v[252:255], v[100:103]
    v_mfma_f32_16x16x32_bf16 v[104:107], a[0:3], v[120:123], 0
    v_cvt_pk_bf16_f32 v84, v72, v73
    v_cvt_pk_bf16_f32 v85, v74, v75
    v_mfma_f32_16x16x32_bf16 v[104:107], a[24:27], v[124:127], v[104:107]
    v_cvt_pk_bf16_f32 v86, v76, v77
    v_cvt_pk_bf16_f32 v87, v78, v79
    v_mfma_f32_16x16x32_bf16 v[104:107], a[48:51], v[128:131], v[104:107]
    buffer_store_dwordx4 v[84:87], v23, s[24:27], s53 offen sc1
    v_mfma_f32_16x16x32_bf16 v[104:107], a[72:75], v[132:135], v[104:107]
    v_cndmask_b32 v80, v84, v86, s[88:89]
    v_cndmask_b32 v81, v85, v87, s[88:89]
    v_mfma_f32_16x16x32_bf16 v[104:107], a[96:99], v[136:139], v[104:107]
    ds_write_b64 v95, v[80:81] offset:256
    v_mfma_f32_16x16x32_bf16 v[104:107], a[120:123], v[140:143], v[104:107]
    v_mfma_f32_16x16x32_bf16 v[72:75], v[60:63], v[68:71], 0
    v_mfma_f32_16x16x32_bf16 v[104:107], a[144:147], v[144:147], v[104:107]
    v_cvt_pk_bf16_f32 v50, v100, v101
    v_cvt_pk_bf16_f32 v51, v102, v103
    v_mfma_f32_16x16x32_bf16 v[104:107], a[168:171], v[148:151], v[104:107]
    v_cvt_pk_bf16_f32 v42, v100, v101
    v_cvt_pk_bf16_f32 v43, v102, v103
    v_mfma_f32_16x16x32_bf16 v[104:107], a[192:195], v[152:155], v[104:107]
    v_mfma_f32_16x16x32_bf16 v[76:79], v[52:55], v[68:71], 0
    v_mfma_f32_16x16x32_bf16 v[104:107], a[216:219], v[156:159], v[104:107]
    ds_read_u16_d16_hi v8, v93 offset:32768
    ds_read_u16_d16_hi v9, v94 offset:32768
    v_mfma_f32_16x16x32_bf16 v[104:107], a[240:243], v[160:163], v[104:107]
    ds_read_u16_d16_hi v10, v92 offset:32768
    v_mfma_f32_16x16x32_bf16 v[104:107], v[184:187], v[164:167], v[104:107]
    v_mfma_f32_16x16x32_bf16 v[104:107], v[208:211], v[168:171], v[104:107]
    v_mfma_f32_16x16x32_bf16 v[104:107], v[232:235], v[172:175], v[104:107]
    v_mfma_f32_16x16x32_bf16 v[108:111], a[4:7], v[120:123], 0
    ds_read_b64_tr_b16 v[120:121], v4 offset:16384
    ds_read_b64_tr_b16 v[122:123], v25 offset:16384
    v_mfma_f32_16x16x32_bf16 v[108:111], a[28:31], v[124:127], v[108:111]
    ds_read_b64_tr_b16 v[124:125], v4 offset:17408
    v_cndmask_b32 v26, v72, v73, s[76:77]
    v_mfma_f32_16x16x32_bf16 v[108:111], a[52:55], v[128:131], v[108:111]
    ds_read_b64_tr_b16 v[126:127], v25 offset:17408
    ds_read_b64_tr_b16 v[128:129], v4 offset:18432
    v_mfma_f32_16x16x32_bf16 v[108:111], a[76:79], v[132:135], v[108:111]
    ds_read_b64_tr_b16 v[130:131], v25 offset:18432
    v_cndmask_b32 v27, v74, v75, s[76:77]
    v_mfma_f32_16x16x32_bf16 v[108:111], a[100:103], v[136:139], v[108:111]
    ds_read_b64_tr_b16 v[132:133], v4 offset:19456
    v_cndmask_b32 v28, v76, v77, s[76:77]
    v_mfma_f32_16x16x32_bf16 v[108:111], a[124:127], v[140:143], v[108:111]
    ds_read_b64_tr_b16 v[134:135], v25 offset:19456
    ds_read_b64_tr_b16 v[136:137], v4 offset:20480
    v_mfma_f32_16x16x32_bf16 v[108:111], a[148:151], v[144:147], v[108:111]
    ds_read_b64_tr_b16 v[138:139], v25 offset:20480
    v_cvt_pk_bf16_f32 v64, v104, v105
    v_mfma_f32_16x16x32_bf16 v[108:111], a[172:175], v[148:151], v[108:111]
    ds_read_b64_tr_b16 v[140:141], v4 offset:21504
    ds_read_b64_tr_b16 v[142:143], v25 offset:21504
    v_mfma_f32_16x16x32_bf16 v[108:111], a[196:199], v[152:155], v[108:111]
    ds_read_b64_tr_b16 v[144:145], v4 offset:22528
    v_cvt_pk_bf16_f32 v65, v106, v107
    v_mfma_f32_16x16x32_bf16 v[108:111], a[220:223], v[156:159], v[108:111]
    ds_read_b64_tr_b16 v[146:147], v25 offset:22528
    v_cndmask_b32 v29, v78, v79, s[76:77]
    v_mfma_f32_16x16x32_bf16 v[108:111], a[244:247], v[160:163], v[108:111]
    ds_read_b64_tr_b16 v[148:149], v4 offset:23552
    ds_read_b64_tr_b16 v[150:151], v25 offset:23552
    v_mfma_f32_16x16x32_bf16 v[108:111], v[188:191], v[164:167], v[108:111]
    ds_read_b64_tr_b16 v[152:153], v4 offset:24576
    v_cndmask_b32 v26, v26, v28, s[78:79]
    v_mfma_f32_16x16x32_bf16 v[108:111], v[212:215], v[168:171], v[108:111]
    ds_read_b64_tr_b16 v[154:155], v25 offset:24576
    ds_read_b64_tr_b16 v[156:157], v4 offset:25600
    v_mfma_f32_16x16x32_bf16 v[108:111], v[236:239], v[172:175], v[108:111]
    ds_read_b64_tr_b16 v[158:159], v25 offset:25600
    v_cndmask_b32 v27, v27, v29, s[80:81]
    s_waitcnt lgkmcnt(15)
    v_mfma_f32_16x16x32_bf16 v[112:115], a[8:11], v[120:123], 0
    ds_read_b64_tr_b16 v[160:161], v4 offset:26624
    v_mfma_f32_16x16x32_bf16 v[112:115], a[32:35], v[124:127], v[112:115]
    ds_read_b64_tr_b16 v[162:163], v25 offset:26624
    ds_read_b64_tr_b16 v[164:165], v4 offset:27648
    s_waitcnt lgkmcnt(15)
    v_mfma_f32_16x16x32_bf16 v[112:115], a[56:59], v[128:131], v[112:115]
    ds_read_b64_tr_b16 v[166:167], v25 offset:27648
    v_mul_f32 v26, v26, v8
    v_mfma_f32_16x16x32_bf16 v[112:115], a[80:83], v[132:135], v[112:115]
    ds_read_b64_tr_b16 v[168:169], v4 offset:28672
    v_mul_f32 v27, v27, v9
    s_waitcnt lgkmcnt(13)
    v_mfma_f32_16x16x32_bf16 v[112:115], a[104:107], v[136:139], v[112:115]
    ds_read_b64_tr_b16 v[170:171], v25 offset:28672
    ds_read_b64_tr_b16 v[172:173], v4 offset:29696
    v_mfma_f32_16x16x32_bf16 v[112:115], a[128:131], v[140:143], v[112:115]
    ds_read_b64_tr_b16 v[174:175], v25 offset:29696
    v_mul_f32 v11, s91, v10
    s_waitcnt lgkmcnt(12)
    v_mfma_f32_16x16x32_bf16 v[112:115], a[152:155], v[144:147], v[112:115]
    v_cvt_pk_bf16_f32 v66, v108, v109
    v_cvt_pk_bf16_f32 v67, v110, v111
    v_mfma_f32_16x16x32_bf16 v[112:115], a[176:179], v[148:151], v[112:115]
    v_cndmask_b32 v66, v66, 0, s[82:83]
    v_cndmask_b32 v67, v67, 0, s[82:83]
    s_waitcnt lgkmcnt(8)
    v_mfma_f32_16x16x32_bf16 v[112:115], a[200:203], v[152:155], v[112:115]
    v_max_f32 v28, v26, v27
    v_mov_b32 v29, v28
    v_mfma_f32_16x16x32_bf16 v[112:115], a[224:227], v[156:159], v[112:115]
    s_waitcnt lgkmcnt(4)
    v_mfma_f32_16x16x32_bf16 v[112:115], a[248:251], v[160:163], v[112:115]
    v_permlane16_swap_b32 v28, v29
    v_max_f32 v28, v28, v29
    v_mfma_f32_16x16x32_bf16 v[112:115], v[192:195], v[164:167], v[112:115]
    v_mov_b32 v29, v28
    s_waitcnt lgkmcnt(0)
    v_mfma_f32_16x16x32_bf16 v[112:115], v[216:219], v[168:171], v[112:115]
    v_mfma_f32_16x16x32_bf16 v[112:115], v[240:243], v[172:175], v[112:115]
    v_permlane32_swap_b32 v28, v29
    v_max_f32 v28, v28, v29
    v_mfma_f32_16x16x32_bf16 v[116:119], a[12:15], v[120:123], 0
    v_sub_f32 v26, v26, v28
    v_sub_f32 v27, v27, v28
    v_mfma_f32_16x16x32_bf16 v[116:119], a[36:39], v[124:127], v[116:119]
    v_mul_f32 v26, v11, v26
    v_mul_f32 v27, v11, v27
    v_mfma_f32_16x16x32_bf16 v[116:119], a[60:63], v[128:131], v[116:119]
    v_exp_f32 v26, v26
    v_mfma_f32_16x16x32_bf16 v[116:119], a[84:87], v[132:135], v[116:119]
    v_exp_f32 v27, v27
    v_mfma_f32_16x16x32_bf16 v[116:119], a[108:111], v[136:139], v[116:119]
    v_add_f32 v28, v26, v27
    v_mov_b32 v29, v28
    v_mfma_f32_16x16x32_bf16 v[116:119], a[132:135], v[140:143], v[116:119]
    v_mfma_f32_16x16x32_bf16 v[116:119], a[156:159], v[144:147], v[116:119]
    s_add_u32 s57, s75, 0
    v_cvt_pk_bf16_f32 v60, v112, v113
    v_mfma_f32_16x16x32_bf16 v[116:119], a[180:183], v[148:151], v[116:119]
    buffer_load_dword v22, v20, s[12:15], s57 offen
    v_mfma_f32_16x16x32_bf16 v[116:119], a[204:207], v[152:155], v[116:119]
    v_cvt_pk_bf16_f32 v61, v114, v115
    v_permlane16_swap_b32 v28, v29
    v_mfma_f32_16x16x32_bf16 v[116:119], a[228:231], v[156:159], v[116:119]
    v_add_f32 v28, v28, v29
    v_mov_b32 v29, v28
    v_mfma_f32_16x16x32_bf16 v[116:119], a[252:255], v[160:163], v[116:119]
    v_mfma_f32_16x16x32_bf16 v[116:119], v[196:199], v[164:167], v[116:119]
    v_permlane32_swap_b32 v28, v29
    v_add_f32 v28, v28, v29
    v_mfma_f32_16x16x32_bf16 v[116:119], v[220:223], v[168:171], v[116:119]
    v_rcp_f32 v28, v28
    v_mfma_f32_16x16x32_bf16 v[116:119], v[244:247], v[172:175], v[116:119]
    v_mul_f32 v26, v26, v8
    v_mul_f32 v27, v27, v9
    v_mfma_f32_16x16x32_bf16 v[96:99], v[120:123], a[16:19], 0
    v_mul_f32 v26, v26, v28
    v_mul_f32 v27, v27, v28
    v_mfma_f32_16x16x32_bf16 v[96:99], v[124:127], a[40:43], v[96:99]
    v_cvt_pk_bf16_f32 v26, v26, v26
    v_cvt_pk_bf16_f32 v27, v27, v27
    v_mfma_f32_16x16x32_bf16 v[96:99], v[128:131], a[64:67], v[96:99]
    v_and_b32 v80, v26, v14
    v_and_b32 v81, v27, v15
    v_mfma_f32_16x16x32_bf16 v[96:99], v[132:135], a[88:91], v[96:99]
    v_and_b32 v82, v26, v16
    v_and_b32 v83, v27, v17
    v_mfma_f32_16x16x32_bf16 v[96:99], v[136:139], a[112:115], v[96:99]
    v_mfma_f32_16x16x32_bf16 v[96:99], v[140:143], a[136:139], v[96:99]
    v_mfma_f32_16x16x32_bf16 v[72:75], v[36:39], v[80:83], 0
    v_mfma_f32_16x16x32_bf16 v[96:99], v[144:147], a[160:163], v[96:99]
    v_cvt_pk_bf16_f32 v62, v116, v117
    v_cvt_pk_bf16_f32 v63, v118, v119
    v_mfma_f32_16x16x32_bf16 v[96:99], v[148:151], a[184:187], v[96:99]
    v_cndmask_b32 v62, v62, 0, s[82:83]
    v_cndmask_b32 v63, v63, 0, s[82:83]
    v_mfma_f32_16x16x32_bf16 v[96:99], v[152:155], a[208:211], v[96:99]
    v_mfma_f32_16x16x32_bf16 v[76:79], v[46:49], v[80:83], 0
    v_mfma_f32_16x16x32_bf16 v[96:99], v[156:159], a[232:235], v[96:99]
    s_add_u32 s53, s74, 32768
    v_mfma_f32_16x16x32_bf16 v[96:99], v[160:163], v[176:179], v[96:99]
    v_mfma_f32_16x16x32_bf16 v[96:99], v[164:167], v[200:203], v[96:99]
    v_mfma_f32_16x16x32_bf16 v[96:99], v[168:171], v[224:227], v[96:99]
    v_mfma_f32_16x16x32_bf16 v[96:99], v[172:175], v[248:251], v[96:99]
    v_mfma_f32_16x16x32_bf16 v[100:103], v[120:123], a[20:23], 0
    v_cvt_pk_bf16_f32 v84, v72, v73
    v_cvt_pk_bf16_f32 v85, v74, v75
    v_mfma_f32_16x16x32_bf16 v[100:103], v[124:127], a[44:47], v[100:103]
    v_cvt_pk_bf16_f32 v86, v76, v77
    v_cvt_pk_bf16_f32 v87, v78, v79
    v_mfma_f32_16x16x32_bf16 v[100:103], v[128:131], a[68:71], v[100:103]
    buffer_store_dwordx4 v[84:87], v23, s[24:27], s53 offen sc1
    v_mfma_f32_16x16x32_bf16 v[100:103], v[132:135], a[92:95], v[100:103]
    v_cndmask_b32 v80, v84, v86, s[88:89]
    v_cndmask_b32 v81, v85, v87, s[88:89]
    v_mfma_f32_16x16x32_bf16 v[100:103], v[136:139], a[116:119], v[100:103]
    ds_write_b64 v95, v[80:81] offset:512
    v_mfma_f32_16x16x32_bf16 v[100:103], v[140:143], a[140:143], v[100:103]
    v_mfma_f32_16x16x32_bf16 v[72:75], v[52:55], v[64:67], 0
    v_mfma_f32_16x16x32_bf16 v[100:103], v[144:147], a[164:167], v[100:103]
    v_cvt_pk_bf16_f32 v34, v96, v97
    v_cvt_pk_bf16_f32 v35, v98, v99
    v_mfma_f32_16x16x32_bf16 v[100:103], v[148:151], a[188:191], v[100:103]
    v_mfma_f32_16x16x32_bf16 v[76:79], v[56:59], v[64:67], 0
    v_mfma_f32_16x16x32_bf16 v[100:103], v[152:155], a[212:215], v[100:103]
    ds_read_u16_d16_hi v8, v93 offset:49152
    ds_read_u16_d16_hi v9, v94 offset:49152
    v_mfma_f32_16x16x32_bf16 v[100:103], v[156:159], a[236:239], v[100:103]
    ds_read_u16_d16_hi v10, v92 offset:49152
    v_mfma_f32_16x16x32_bf16 v[100:103], v[160:163], v[180:183], v[100:103]
    v_mfma_f32_16x16x32_bf16 v[100:103], v[164:167], v[204:207], v[100:103]
    v_mfma_f32_16x16x32_bf16 v[100:103], v[168:171], v[228:231], v[100:103]
    v_mfma_f32_16x16x32_bf16 v[100:103], v[172:175], v[252:255], v[100:103]
    v_cndmask_b32 v26, v72, v73, s[76:77]
    v_cndmask_b32 v27, v74, v75, s[76:77]
    v_mfma_f32_16x16x32_bf16 v[104:107], a[0:3], v[120:123], 0
    v_cndmask_b32 v28, v76, v77, s[76:77]
    v_cndmask_b32 v29, v78, v79, s[76:77]
    v_mfma_f32_16x16x32_bf16 v[104:107], a[24:27], v[124:127], v[104:107]
    v_cndmask_b32 v26, v26, v28, s[78:79]
    v_cndmask_b32 v27, v27, v29, s[80:81]
    v_mfma_f32_16x16x32_bf16 v[104:107], a[48:51], v[128:131], v[104:107]
    s_waitcnt lgkmcnt(0)
    v_mul_f32 v26, v26, v8
    v_mfma_f32_16x16x32_bf16 v[104:107], a[72:75], v[132:135], v[104:107]
    v_mul_f32 v27, v27, v9
    v_mul_f32 v11, s91, v10
    v_mfma_f32_16x16x32_bf16 v[104:107], a[96:99], v[136:139], v[104:107]
    v_max_f32 v28, v26, v27
    v_mov_b32 v29, v28
    v_mfma_f32_16x16x32_bf16 v[104:107], a[120:123], v[140:143], v[104:107]
    v_mfma_f32_16x16x32_bf16 v[104:107], a[144:147], v[144:147], v[104:107]
    v_cvt_pk_bf16_f32 v44, v100, v101
    v_cvt_pk_bf16_f32 v45, v102, v103
    v_mfma_f32_16x16x32_bf16 v[104:107], a[168:171], v[148:151], v[104:107]
    v_permlane16_swap_b32 v28, v29
    v_max_f32 v28, v28, v29
    v_mfma_f32_16x16x32_bf16 v[104:107], a[192:195], v[152:155], v[104:107]
    v_mov_b32 v29, v28
    v_mfma_f32_16x16x32_bf16 v[104:107], a[216:219], v[156:159], v[104:107]
    v_mfma_f32_16x16x32_bf16 v[104:107], a[240:243], v[160:163], v[104:107]
    v_permlane32_swap_b32 v28, v29
    v_max_f32 v28, v28, v29
    v_mfma_f32_16x16x32_bf16 v[104:107], v[184:187], v[164:167], v[104:107]
    v_sub_f32 v26, v26, v28
    v_sub_f32 v27, v27, v28
    v_mfma_f32_16x16x32_bf16 v[104:107], v[208:211], v[168:171], v[104:107]
    v_mul_f32 v26, v11, v26
    v_mul_f32 v27, v11, v27
    v_mfma_f32_16x16x32_bf16 v[104:107], v[232:235], v[172:175], v[104:107]
    v_exp_f32 v26, v26
    v_mfma_f32_16x16x32_bf16 v[108:111], a[4:7], v[120:123], 0
    ds_read_b64_tr_b16 v[120:121], v4 offset:32768
    ds_read_b64_tr_b16 v[122:123], v25 offset:32768
    v_mfma_f32_16x16x32_bf16 v[108:111], a[28:31], v[124:127], v[108:111]
    ds_read_b64_tr_b16 v[124:125], v4 offset:33792
    v_exp_f32 v27, v27
    v_mfma_f32_16x16x32_bf16 v[108:111], a[52:55], v[128:131], v[108:111]
    ds_read_b64_tr_b16 v[126:127], v25 offset:33792
    ds_read_b64_tr_b16 v[128:129], v4 offset:34816
    v_mfma_f32_16x16x32_bf16 v[108:111], a[76:79], v[132:135], v[108:111]
    ds_read_b64_tr_b16 v[130:131], v25 offset:34816
    v_add_f32 v28, v26, v27
    v_mfma_f32_16x16x32_bf16 v[108:111], a[100:103], v[136:139], v[108:111]
    ds_read_b64_tr_b16 v[132:133], v4 offset:35840
    v_mov_b32 v29, v28
    v_mfma_f32_16x16x32_bf16 v[108:111], a[124:127], v[140:143], v[108:111]
    ds_read_b64_tr_b16 v[134:135], v25 offset:35840
    ds_read_b64_tr_b16 v[136:137], v4 offset:36864
    v_mfma_f32_16x16x32_bf16 v[108:111], a[148:151], v[144:147], v[108:111]
    ds_read_b64_tr_b16 v[138:139], v25 offset:36864
    s_add_u32 s57, s75, 262144
    v_mfma_f32_16x16x32_bf16 v[108:111], a[172:175], v[148:151], v[108:111]
    buffer_load_dword v22, v20, s[12:15], s57 offen
    v_mfma_f32_16x16x32_bf16 v[108:111], a[196:199], v[152:155], v[108:111]
    ds_read_b64_tr_b16 v[140:141], v4 offset:37888
    ds_read_b64_tr_b16 v[142:143], v25 offset:37888
    v_mfma_f32_16x16x32_bf16 v[108:111], a[220:223], v[156:159], v[108:111]
    ds_read_b64_tr_b16 v[144:145], v4 offset:38912
    ds_read_b64_tr_b16 v[146:147], v25 offset:38912
    v_mfma_f32_16x16x32_bf16 v[108:111], a[244:247], v[160:163], v[108:111]
    ds_read_b64_tr_b16 v[148:149], v4 offset:39936
    ds_read_b64_tr_b16 v[150:151], v25 offset:39936
    v_mfma_f32_16x16x32_bf16 v[108:111], v[188:191], v[164:167], v[108:111]
    ds_read_b64_tr_b16 v[152:153], v4 offset:40960
    v_cvt_pk_bf16_f32 v68, v104, v105
    v_mfma_f32_16x16x32_bf16 v[108:111], v[212:215], v[168:171], v[108:111]
    ds_read_b64_tr_b16 v[154:155], v25 offset:40960
    ds_read_b64_tr_b16 v[156:157], v4 offset:41984
    v_mfma_f32_16x16x32_bf16 v[108:111], v[236:239], v[172:175], v[108:111]
    ds_read_b64_tr_b16 v[158:159], v25 offset:41984
    v_cvt_pk_bf16_f32 v69, v106, v107
    s_waitcnt lgkmcnt(15)
    v_mfma_f32_16x16x32_bf16 v[112:115], a[8:11], v[120:123], 0
    ds_read_b64_tr_b16 v[160:161], v4 offset:43008
    v_permlane16_swap_b32 v28, v29
    v_mfma_f32_16x16x32_bf16 v[112:115], a[32:35], v[124:127], v[112:115]
    ds_read_b64_tr_b16 v[162:163], v25 offset:43008
    ds_read_b64_tr_b16 v[164:165], v4 offset:44032
    s_waitcnt lgkmcnt(15)
    v_mfma_f32_16x16x32_bf16 v[112:115], a[56:59], v[128:131], v[112:115]
    ds_read_b64_tr_b16 v[166:167], v25 offset:44032
    v_add_f32 v28, v28, v29
    v_mfma_f32_16x16x32_bf16 v[112:115], a[80:83], v[132:135], v[112:115]
    ds_read_b64_tr_b16 v[168:169], v4 offset:45056
    v_mov_b32 v29, v28
    s_waitcnt lgkmcnt(13)
    v_mfma_f32_16x16x32_bf16 v[112:115], a[104:107], v[136:139], v[112:115]
    ds_read_b64_tr_b16 v[170:171], v25 offset:45056
    ds_read_b64_tr_b16 v[172:173], v4 offset:46080
    v_mfma_f32_16x16x32_bf16 v[112:115], a[128:131], v[140:143], v[112:115]
    ds_read_b64_tr_b16 v[174:175], v25 offset:46080
    v_permlane32_swap_b32 v28, v29
    s_waitcnt lgkmcnt(12)
    v_mfma_f32_16x16x32_bf16 v[112:115], a[152:155], v[144:147], v[112:115]
    v_cvt_pk_bf16_f32 v70, v108, v109
    v_cvt_pk_bf16_f32 v71, v110, v111
    v_mfma_f32_16x16x32_bf16 v[112:115], a[176:179], v[148:151], v[112:115]
    v_cndmask_b32 v70, v70, 0, s[82:83]
    v_cndmask_b32 v71, v71, 0, s[82:83]
    s_waitcnt lgkmcnt(8)
    v_mfma_f32_16x16x32_bf16 v[112:115], a[200:203], v[152:155], v[112:115]
    v_add_f32 v28, v28, v29
    v_rcp_f32 v28, v28
    v_mfma_f32_16x16x32_bf16 v[112:115], a[224:227], v[156:159], v[112:115]
    v_mul_f32 v26, v26, v8
    v_mul_f32 v27, v27, v9
    s_waitcnt lgkmcnt(4)
    v_mfma_f32_16x16x32_bf16 v[112:115], a[248:251], v[160:163], v[112:115]
    v_mul_f32 v26, v26, v28
    v_mul_f32 v27, v27, v28
    v_mfma_f32_16x16x32_bf16 v[112:115], v[192:195], v[164:167], v[112:115]
    v_cvt_pk_bf16_f32 v26, v26, v26
    v_cvt_pk_bf16_f32 v27, v27, v27
    s_waitcnt lgkmcnt(0)
    v_mfma_f32_16x16x32_bf16 v[112:115], v[216:219], v[168:171], v[112:115]
    v_and_b32 v80, v26, v14
    v_and_b32 v81, v27, v15
    v_mfma_f32_16x16x32_bf16 v[112:115], v[240:243], v[172:175], v[112:115]
    v_and_b32 v82, v26, v16
    v_and_b32 v83, v27, v17
    v_mfma_f32_16x16x32_bf16 v[116:119], a[12:15], v[120:123], 0
    v_mfma_f32_16x16x32_bf16 v[116:119], a[36:39], v[124:127], v[116:119]
    v_mfma_f32_16x16x32_bf16 v[72:75], v[38:41], v[80:83], 0
    v_mfma_f32_16x16x32_bf16 v[116:119], a[60:63], v[128:131], v[116:119]
    v_mfma_f32_16x16x32_bf16 v[76:79], v[48:51], v[80:83], 0
    v_mfma_f32_16x16x32_bf16 v[116:119], a[84:87], v[132:135], v[116:119]
    s_add_u32 s53, s74, 49152
    v_mfma_f32_16x16x32_bf16 v[116:119], a[108:111], v[136:139], v[116:119]
    v_mfma_f32_16x16x32_bf16 v[116:119], a[132:135], v[140:143], v[116:119]
    v_mfma_f32_16x16x32_bf16 v[116:119], a[156:159], v[144:147], v[116:119]
    v_cvt_pk_bf16_f32 v52, v112, v113
    v_cvt_pk_bf16_f32 v53, v114, v115
    v_mfma_f32_16x16x32_bf16 v[116:119], a[180:183], v[148:151], v[116:119]
    v_mfma_f32_16x16x32_bf16 v[116:119], a[204:207], v[152:155], v[116:119]
    v_cvt_pk_bf16_f32 v84, v72, v73
    v_cvt_pk_bf16_f32 v85, v74, v75
    v_mfma_f32_16x16x32_bf16 v[116:119], a[228:231], v[156:159], v[116:119]
    v_cvt_pk_bf16_f32 v86, v76, v77
    v_cvt_pk_bf16_f32 v87, v78, v79
    v_mfma_f32_16x16x32_bf16 v[116:119], a[252:255], v[160:163], v[116:119]
    buffer_store_dwordx4 v[84:87], v23, s[24:27], s53 offen sc1
    v_mfma_f32_16x16x32_bf16 v[116:119], v[196:199], v[164:167], v[116:119]
    v_cndmask_b32 v80, v84, v86, s[88:89]
    v_cndmask_b32 v81, v85, v87, s[88:89]
    v_mfma_f32_16x16x32_bf16 v[116:119], v[220:223], v[168:171], v[116:119]
    ds_write_b64 v95, v[80:81] offset:768
    v_add_u32 v92, 65536, v92
    v_mfma_f32_16x16x32_bf16 v[116:119], v[244:247], v[172:175], v[116:119]
    v_add_u32 v93, 65536, v93
    v_add_u32 v94, 65536, v94
    v_mfma_f32_16x16x32_bf16 v[96:99], v[120:123], a[16:19], 0
    v_mfma_f32_16x16x32_bf16 v[72:75], v[56:59], v[68:71], 0
    v_mfma_f32_16x16x32_bf16 v[96:99], v[124:127], a[40:43], v[96:99]
    v_mfma_f32_16x16x32_bf16 v[76:79], v[60:63], v[68:71], 0
L_wa_2:
    s_cbranch_execz L_wa_ret
    v_mfma_f32_16x16x32_bf16 v[96:99], v[128:131], a[64:67], v[96:99]
    ds_read_u16_d16_hi v8, v93 offset:0
    ds_read_u16_d16_hi v9, v94 offset:0
    v_mfma_f32_16x16x32_bf16 v[96:99], v[132:135], a[88:91], v[96:99]
    ds_read_u16_d16_hi v10, v92 offset:0
    v_mfma_f32_16x16x32_bf16 v[96:99], v[136:139], a[112:115], v[96:99]
    v_mfma_f32_16x16x32_bf16 v[96:99], v[140:143], a[136:139], v[96:99]
    v_mfma_f32_16x16x32_bf16 v[96:99], v[144:147], a[160:163], v[96:99]
    v_cvt_pk_bf16_f32 v54, v116, v117
    v_cvt_pk_bf16_f32 v55, v118, v119
    v_mfma_f32_16x16x32_bf16 v[96:99], v[148:151], a[184:187], v[96:99]
    v_cndmask_b32 v54, v54, 0, s[82:83]
    v_cndmask_b32 v55, v55, 0, s[82:83]
    v_mfma_f32_16x16x32_bf16 v[96:99], v[152:155], a[208:211], v[96:99]
    v_cndmask_b32 v26, v72, v73, s[76:77]
    v_cndmask_b32 v27, v74, v75, s[76:77]
    v_mfma_f32_16x16x32_bf16 v[96:99], v[156:159], a[232:235], v[96:99]
    v_cndmask_b32 v28, v76, v77, s[76:77]
    v_cndmask_b32 v29, v78, v79, s[76:77]
    v_mfma_f32_16x16x32_bf16 v[96:99], v[160:163], v[176:179], v[96:99]
    v_cndmask_b32 v26, v26, v28, s[78:79]
    v_cndmask_b32 v27, v27, v29, s[80:81]
    v_mfma_f32_16x16x32_bf16 v[96:99], v[164:167], v[200:203], v[96:99]
    s_waitcnt lgkmcnt(0)
    v_mul_f32 v26, v26, v8
    v_mfma_f32_16x16x32_bf16 v[96:99], v[168:171], v[224:227], v[96:99]
    v_mul_f32 v27, v27, v9
    v_mul_f32 v11, s91, v10
    v_mfma_f32_16x16x32_bf16 v[96:99], v[172:175], v[248:251], v[96:99]
    v_max_f32 v28, v26, v27
    v_mov_b32 v29, v28
    v_mfma_f32_16x16x32_bf16 v[100:103], v[120:123], a[20:23], 0
    v_mfma_f32_16x16x32_bf16 v[100:103], v[124:127], a[44:47], v[100:103]
    v_permlane16_swap_b32 v28, v29
    v_max_f32 v28, v28, v29
    v_mfma_f32_16x16x32_bf16 v[100:103], v[128:131], a[68:71], v[100:103]
    v_mov_b32 v29, v28
    v_mfma_f32_16x16x32_bf16 v[100:103], v[132:135], a[92:95], v[100:103]
    v_mfma_f32_16x16x32_bf16 v[100:103], v[136:139], a[116:119], v[100:103]
    v_permlane32_swap_b32 v28, v29
    v_max_f32 v28, v28, v29
    v_mfma_f32_16x16x32_bf16 v[100:103], v[140:143], a[140:143], v[100:103]
    v_sub_f32 v26, v26, v28
    v_sub_f32 v27, v27, v28
    v_mfma_f32_16x16x32_bf16 v[100:103], v[144:147], a[164:167], v[100:103]
    v_cvt_pk_bf16_f32 v36, v96, v97
    v_cvt_pk_bf16_f32 v37, v98, v99
    v_mfma_f32_16x16x32_bf16 v[100:103], v[148:151], a[188:191], v[100:103]
    v_mul_f32 v26, v11, v26
    v_mul_f32 v27, v11, v27
    v_mfma_f32_16x16x32_bf16 v[100:103], v[152:155], a[212:215], v[100:103]
    v_exp_f32 v26, v26
    v_mfma_f32_16x16x32_bf16 v[100:103], v[156:159], a[236:239], v[100:103]
    v_exp_f32 v27, v27
    v_mfma_f32_16x16x32_bf16 v[100:103], v[160:163], v[180:183], v[100:103]
    v_add_f32 v28, v26, v27
    v_mov_b32 v29, v28
    v_mfma_f32_16x16x32_bf16 v[100:103], v[164:167], v[204:207], v[100:103]
    v_mfma_f32_16x16x32_bf16 v[100:103], v[168:171], v[228:231], v[100:103]
    v_permlane16_swap_b32 v28, v29
    v_add_f32 v28, v28, v29
    v_mfma_f32_16x16x32_bf16 v[100:103], v[172:175], v[252:255], v[100:103]
    v_mov_b32 v29, v28
    v_mfma_f32_16x16x32_bf16 v[104:107], a[0:3], v[120:123], 0
    v_mfma_f32_16x16x32_bf16 v[104:107], a[24:27], v[124:127], v[104:107]
    v_permlane32_swap_b32 v28, v29
    v_add_f32 v28, v28, v29
    v_mfma_f32_16x16x32_bf16 v[104:107], a[48:51], v[128:131], v[104:107]
    v_rcp_f32 v28, v28
    v_mfma_f32_16x16x32_bf16 v[104:107], a[72:75], v[132:135], v[104:107]
    v_mul_f32 v26, v26, v8
    v_mul_f32 v27, v27, v9
    v_mfma_f32_16x16x32_bf16 v[104:107], a[96:99], v[136:139], v[104:107]
    v_mul_f32 v26, v26, v28
    v_mul_f32 v27, v27, v28
    v_mfma_f32_16x16x32_bf16 v[104:107], a[120:123], v[140:143], v[104:107]
    v_cvt_pk_bf16_f32 v26, v26, v26
    v_cvt_pk_bf16_f32 v27, v27, v27
    v_mfma_f32_16x16x32_bf16 v[104:107], a[144:147], v[144:147], v[104:107]
    v_cvt_pk_bf16_f32 v46, v100, v101
    v_cvt_pk_bf16_f32 v47, v102, v103
    v_mfma_f32_16x16x32_bf16 v[104:107], a[168:171], v[148:151], v[104:107]
    v_and_b32 v80, v26, v14
    v_and_b32 v81, v27, v15
    v_mfma_f32_16x16x32_bf16 v[104:107], a[192:195], v[152:155], v[104:107]
    v_and_b32 v82, v26, v16
    v_and_b32 v83, v27, v17
    v_mfma_f32_16x16x32_bf16 v[104:107], a[216:219], v[156:159], v[104:107]
    v_mfma_f32_16x16x32_bf16 v[104:107], a[240:243], v[160:163], v[104:107]
    v_mfma_f32_16x16x32_bf16 v[72:75], v[32:35], v[80:83], 0
    v_mfma_f32_16x16x32_bf16 v[104:107], v[184:187], v[164:167], v[104:107]
    v_mfma_f32_16x16x32_bf16 v[76:79], v[42:45], v[80:83], 0
    v_mfma_f32_16x16x32_bf16 v[104:107], v[208:211], v[168:171], v[104:107]
    s_add_u32 s53, s74, 65536
    v_mfma_f32_16x16x32_bf16 v[104:107], v[232:235], v[172:175], v[104:107]
    s_waitcnt vmcnt(8)
    s_barrier
    v_mfma_f32_16x16x32_bf16 v[108:111], a[4:7], v[120:123], 0
    ds_read_b64_tr_b16 v[120:121], v4 offset:49152
    ds_read_b64_tr_b16 v[122:123], v25 offset:49152
    v_mfma_f32_16x16x32_bf16 v[108:111], a[28:31], v[124:127], v[108:111]
    ds_read_b64_tr_b16 v[124:125], v4 offset:50176
    v_mfma_f32_16x16x32_bf16 v[108:111], a[52:55], v[128:131], v[108:111]
    ds_read_b64_tr_b16 v[126:127], v25 offset:50176
    ds_read_b64_tr_b16 v[128:129], v4 offset:51200
    v_mfma_f32_16x16x32_bf16 v[108:111], a[76:79], v[132:135], v[108:111]
    ds_read_b64_tr_b16 v[130:131], v25 offset:51200
    v_cvt_pk_bf16_f32 v84, v72, v73
    v_mfma_f32_16x16x32_bf16 v[108:111], a[100:103], v[136:139], v[108:111]
    ds_read_b64_tr_b16 v[132:133], v4 offset:52224
    v_cvt_pk_bf16_f32 v85, v74, v75
    v_mfma_f32_16x16x32_bf16 v[108:111], a[124:127], v[140:143], v[108:111]
    ds_read_b64_tr_b16 v[134:135], v25 offset:52224
    ds_read_b64_tr_b16 v[136:137], v4 offset:53248
    v_mfma_f32_16x16x32_bf16 v[108:111], a[148:151], v[144:147], v[108:111]
    ds_read_b64_tr_b16 v[138:139], v25 offset:53248
    v_cvt_pk_bf16_f32 v64, v104, v105
    v_mfma_f32_16x16x32_bf16 v[108:111], a[172:175], v[148:151], v[108:111]
    ds_read_b64_tr_b16 v[140:141], v4 offset:54272
    ds_read_b64_tr_b16 v[142:143], v25 offset:54272
    v_mfma_f32_16x16x32_bf16 v[108:111], a[196:199], v[152:155], v[108:111]
    ds_read_b64_tr_b16 v[144:145], v4 offset:55296
    v_cvt_pk_bf16_f32 v65, v106, v107
    v_mfma_f32_16x16x32_bf16 v[108:111], a[220:223], v[156:159], v[108:111]
    ds_read_b64_tr_b16 v[146:147], v25 offset:55296
    v_cvt_pk_bf16_f32 v86, v76, v77
    v_mfma_f32_16x16x32_bf16 v[108:111], a[244:247], v[160:163], v[108:111]
    ds_read_b64_tr_b16 v[148:149], v4 offset:56320
    ds_read_b64_tr_b16 v[150:151], v25 offset:56320
    v_mfma_f32_16x16x32_bf16 v[108:111], v[188:191], v[164:167], v[108:111]
    ds_read_b64_tr_b16 v[152:153], v4 offset:57344
    v_cvt_pk_bf16_f32 v87, v78, v79
    v_mfma_f32_16x16x32_bf16 v[108:111], v[212:215], v[168:171], v[108:111]
    ds_read_b64_tr_b16 v[154:155], v25 offset:57344
    ds_read_b64_tr_b16 v[156:157], v4 offset:58368
    v_mfma_f32_16x16x32_bf16 v[108:111], v[236:239], v[172:175], v[108:111]
    ds_read_b64_tr_b16 v[158:159], v25 offset:58368
    buffer_store_dwordx4 v[84:87], v23, s[24:27], s53 offen sc1
    s_waitcnt lgkmcnt(15)
    v_mfma_f32_16x16x32_bf16 v[112:115], a[8:11], v[120:123], 0
    ds_read_b64_tr_b16 v[160:161], v4 offset:59392
    v_cndmask_b32 v80, v84, v86, s[88:89]
    v_mfma_f32_16x16x32_bf16 v[112:115], a[32:35], v[124:127], v[112:115]
    ds_read_b64_tr_b16 v[162:163], v25 offset:59392
    ds_read_b64_tr_b16 v[164:165], v4 offset:60416
    s_waitcnt lgkmcnt(15)
    v_mfma_f32_16x16x32_bf16 v[112:115], a[56:59], v[128:131], v[112:115]
    ds_read_b64_tr_b16 v[166:167], v25 offset:60416
    v_cndmask_b32 v81, v85, v87, s[88:89]
    v_mfma_f32_16x16x32_bf16 v[112:115], a[80:83], v[132:135], v[112:115]
    ds_read_b64_tr_b16 v[168:169], v4 offset:61440
    ds_write_b64 v95, v[80:81] offset:1024
    s_waitcnt lgkmcnt(14)
    v_mfma_f32_16x16x32_bf16 v[112:115], a[104:107], v[136:139], v[112:115]
    ds_read_b64_tr_b16 v[170:171], v25 offset:61440
    ds_read_b64_tr_b16 v[172:173], v4 offset:62464
    v_mfma_f32_16x16x32_bf16 v[112:115], a[128:131], v[140:143], v[112:115]
    ds_read_b64_tr_b16 v[174:175], v25 offset:62464
    s_waitcnt lgkmcnt(13)
    v_mfma_f32_16x16x32_bf16 v[112:115], a[152:155], v[144:147], v[112:115]
    v_cvt_pk_bf16_f32 v66, v108, v109
    v_cvt_pk_bf16_f32 v67, v110, v111
    v_mfma_f32_16x16x32_bf16 v[112:115], a[176:179], v[148:151], v[112:115]
    v_cndmask_b32 v66, v66, 0, s[82:83]
    v_cndmask_b32 v67, v67, 0, s[82:83]
    s_waitcnt lgkmcnt(9)
    v_mfma_f32_16x16x32_bf16 v[112:115], a[200:203], v[152:155], v[112:115]
    v_mfma_f32_16x16x32_bf16 v[112:115], a[224:227], v[156:159], v[112:115]
    v_mfma_f32_16x16x32_bf16 v[72:75], v[60:63], v[64:67], 0
    s_waitcnt lgkmcnt(5)
    v_mfma_f32_16x16x32_bf16 v[112:115], a[248:251], v[160:163], v[112:115]
    v_mfma_f32_16x16x32_bf16 v[76:79], v[52:55], v[64:67], 0
    v_mfma_f32_16x16x32_bf16 v[112:115], v[192:195], v[164:167], v[112:115]
    ds_read_u16_d16_hi v8, v93 offset:16384
    ds_read_u16_d16_hi v9, v94 offset:16384
    s_waitcnt lgkmcnt(2)
    v_mfma_f32_16x16x32_bf16 v[112:115], v[216:219], v[168:171], v[112:115]
    ds_read_u16_d16_hi v10, v92 offset:16384
    v_mfma_f32_16x16x32_bf16 v[112:115], v[240:243], v[172:175], v[112:115]
    v_mfma_f32_16x16x32_bf16 v[116:119], a[12:15], v[120:123], 0
    v_mfma_f32_16x16x32_bf16 v[116:119], a[36:39], v[124:127], v[116:119]
    v_mfma_f32_16x16x32_bf16 v[116:119], a[60:63], v[128:131], v[116:119]
    v_cndmask_b32 v26, v72, v73, s[76:77]
    v_cndmask_b32 v27, v74, v75, s[76:77]
    v_mfma_f32_16x16x32_bf16 v[116:119], a[84:87], v[132:135], v[116:119]
    v_cndmask_b32 v28, v76, v77, s[76:77]
    v_cndmask_b32 v29, v78, v79, s[76:77]
    v_mfma_f32_16x16x32_bf16 v[116:119], a[108:111], v[136:139], v[116:119]
    v_cndmask_b32 v26, v26, v28, s[78:79]
    v_cndmask_b32 v27, v27, v29, s[80:81]
    v_mfma_f32_16x16x32_bf16 v[116:119], a[132:135], v[140:143], v[116:119]
    s_waitcnt lgkmcnt(0)
    v_mul_f32 v26, v26, v8
    v_mfma_f32_16x16x32_bf16 v[116:119], a[156:159], v[144:147], v[116:119]
    v_cvt_pk_bf16_f32 v56, v112, v113
    v_cvt_pk_bf16_f32 v57, v114, v115
    v_mfma_f32_16x16x32_bf16 v[116:119], a[180:183], v[148:151], v[116:119]
    v_mul_f32 v27, v27, v9
    v_mul_f32 v11, s91, v10
    v_mfma_f32_16x16x32_bf16 v[116:119], a[204:207], v[152:155], v[116:119]
    v_max_f32 v28, v26, v27
    v_mov_b32 v29, v28
    v_mfma_f32_16x16x32_bf16 v[116:119], a[228:231], v[156:159], v[116:119]
    v_mfma_f32_16x16x32_bf16 v[116:119], a[252:255], v[160:163], v[116:119]
    v_permlane16_swap_b32 v28, v29
    v_max_f32 v28, v28, v29
    v_mfma_f32_16x16x32_bf16 v[116:119], v[196:199], v[164:167], v[116:119]
    v_mov_b32 v29, v28
    v_mfma_f32_16x16x32_bf16 v[116:119], v[220:223], v[168:171], v[116:119]
    v_mfma_f32_16x16x32_bf16 v[116:119], v[244:247], v[172:175], v[116:119]
    v_permlane32_swap_b32 v28, v29
    v_max_f32 v28, v28, v29
    v_mfma_f32_16x16x32_bf16 v[96:99], v[120:123], a[16:19], 0
    v_sub_f32 v26, v26, v28
    v_sub_f32 v27, v27, v28
    v_mfma_f32_16x16x32_bf16 v[96:99], v[124:127], a[40:43], v[96:99]
    v_mul_f32 v26, v11, v26
    v_mul_f32 v27, v11, v27
    v_mfma_f32_16x16x32_bf16 v[96:99], v[128:131], a[64:67], v[96:99]
    v_exp_f32 v26, v26
    v_mfma_f32_16x16x32_bf16 v[96:99], v[132:135], a[88:91], v[96:99]
    v_exp_f32 v27, v27
    v_mfma_f32_16x16x32_bf16 v[96:99], v[136:139], a[112:115], v[96:99]
    v_add_f32 v28, v26, v27
    v_mov_b32 v29, v28
    v_mfma_f32_16x16x32_bf16 v[96:99], v[140:143], a[136:139], v[96:99]
    v_mfma_f32_16x16x32_bf16 v[96:99], v[144:147], a[160:163], v[96:99]
    v_cvt_pk_bf16_f32 v58, v116, v117
    v_cvt_pk_bf16_f32 v59, v118, v119
    v_mfma_f32_16x16x32_bf16 v[96:99], v[148:151], a[184:187], v[96:99]
    v_cndmask_b32 v58, v58, 0, s[82:83]
    v_cndmask_b32 v59, v59, 0, s[82:83]
    v_mfma_f32_16x16x32_bf16 v[96:99], v[152:155], a[208:211], v[96:99]
    v_permlane16_swap_b32 v28, v29
    v_add_f32 v28, v28, v29
    v_mfma_f32_16x16x32_bf16 v[96:99], v[156:159], a[232:235], v[96:99]
    v_mov_b32 v29, v28
    v_mfma_f32_16x16x32_bf16 v[96:99], v[160:163], v[176:179], v[96:99]
    v_mfma_f32_16x16x32_bf16 v[96:99], v[164:167], v[200:203], v[96:99]
    v_permlane32_swap_b32 v28, v29
    v_add_f32 v28, v28, v29
    v_mfma_f32_16x16x32_bf16 v[96:99], v[168:171], v[224:227], v[96:99]
    v_rcp_f32 v28, v28
    v_mfma_f32_16x16x32_bf16 v[96:99], v[172:175], v[248:251], v[96:99]
    v_mul_f32 v26, v26, v8
    v_mul_f32 v27, v27, v9
    v_mfma_f32_16x16x32_bf16 v[100:103], v[120:123], a[20:23], 0
    v_mul_f32 v26, v26, v28
    v_mul_f32 v27, v27, v28
    v_mfma_f32_16x16x32_bf16 v[100:103], v[124:127], a[44:47], v[100:103]
    v_cvt_pk_bf16_f32 v26, v26, v26
    v_cvt_pk_bf16_f32 v27, v27, v27
    v_mfma_f32_16x16x32_bf16 v[100:103], v[128:131], a[68:71], v[100:103]
    v_and_b32 v80, v26, v14
    v_and_b32 v81, v27, v15
    v_mfma_f32_16x16x32_bf16 v[100:103], v[132:135], a[92:95], v[100:103]
    v_and_b32 v82, v26, v16
    v_and_b32 v83, v27, v17
    v_mfma_f32_16x16x32_bf16 v[100:103], v[136:139], a[116:119], v[100:103]
    v_mfma_f32_16x16x32_bf16 v[100:103], v[140:143], a[140:143], v[100:103]
    v_mfma_f32_16x16x32_bf16 v[72:75], v[34:37], v[80:83], 0
    v_mfma_f32_16x16x32_bf16 v[100:103], v[144:147], a[164:167], v[100:103]
    v_cvt_pk_bf16_f32 v38, v96, v97
    v_cvt_pk_bf16_f32 v39, v98, v99
    v_mfma_f32_16x16x32_bf16 v[100:103], v[148:151], a[188:191], v[100:103]
    v_mfma_f32_16x16x32_bf16 v[76:79], v[44:47], v[80:83], 0
    v_mfma_f32_16x16x32_bf16 v[100:103], v[152:155], a[212:215], v[100:103]
    s_add_u32 s53, s74, 81920
    v_mfma_f32_16x16x32_bf16 v[100:103], v[156:159], a[236:239], v[100:103]
    v_mfma_f32_16x16x32_bf16 v[100:103], v[160:163], v[180:183], v[100:103]
    v_mfma_f32_16x16x32_bf16 v[100:103], v[164:167], v[204:207], v[100:103]
    v_mfma_f32_16x16x32_bf16 v[100:103], v[168:171], v[228:231], v[100:103]
    v_mfma_f32_16x16x32_bf16 v[100:103], v[172:175], v[252:255], v[100:103]
    v_cvt_pk_bf16_f32 v84, v72, v73
    v_cvt_pk_bf16_f32 v85, v74, v75
    v_mfma_f32_16x16x32_bf16 v[104:107], a[0:3], v[120:123], 0
    v_cvt_pk_bf16_f32 v86, v76, v77
    v_cvt_pk_bf16_f32 v87, v78, v79
    v_mfma_f32_16x16x32_bf16 v[104:107], a[24:27], v[124:127], v[104:107]
    buffer_store_dwordx4 v[84:87], v23, s[24:27], s53 offen sc1
    v_mfma_f32_16x16x32_bf16 v[104:107], a[48:51], v[128:131], v[104:107]
    v_cndmask_b32 v80, v84, v86, s[88:89]
    v_cndmask_b32 v81, v85, v87, s[88:89]
    v_mfma_f32_16x16x32_bf16 v[104:107], a[72:75], v[132:135], v[104:107]
    ds_write_b64 v95, v[80:81] offset:1280
    v_mfma_f32_16x16x32_bf16 v[104:107], a[96:99], v[136:139], v[104:107]
    v_mfma_f32_16x16x32_bf16 v[104:107], a[120:123], v[140:143], v[104:107]
    v_mfma_f32_16x16x32_bf16 v[104:107], a[144:147], v[144:147], v[104:107]
    v_cvt_pk_bf16_f32 v48, v100, v101
    v_cvt_pk_bf16_f32 v49, v102, v103
    v_mfma_f32_16x16x32_bf16 v[104:107], a[168:171], v[148:151], v[104:107]
    v_mfma_f32_16x16x32_bf16 v[104:107], a[192:195], v[152:155], v[104:107]
    v_mfma_f32_16x16x32_bf16 v[104:107], a[216:219], v[156:159], v[104:107]
    v_mfma_f32_16x16x32_bf16 v[104:107], a[240:243], v[160:163], v[104:107]
    v_mfma_f32_16x16x32_bf16 v[104:107], v[184:187], v[164:167], v[104:107]
    v_mfma_f32_16x16x32_bf16 v[104:107], v[208:211], v[168:171], v[104:107]
    v_mfma_f32_16x16x32_bf16 v[104:107], v[232:235], v[172:175], v[104:107]
    v_mfma_f32_16x16x32_bf16 v[108:111], a[4:7], v[120:123], 0
    v_add_u32 v4, 65536, v4
    v_add_u32 v25, 65536, v25
    ds_read_b64_tr_b16 v[120:121], v4 offset:0
    ds_read_b64_tr_b16 v[122:123], v25 offset:0
    v_mfma_f32_16x16x32_bf16 v[108:111], a[28:31], v[124:127], v[108:111]
    ds_read_b64_tr_b16 v[124:125], v4 offset:1024
    v_mfma_f32_16x16x32_bf16 v[108:111], a[52:55], v[128:131], v[108:111]
    ds_read_b64_tr_b16 v[126:127], v25 offset:1024
    ds_read_b64_tr_b16 v[128:129], v4 offset:2048
    v_mfma_f32_16x16x32_bf16 v[108:111], a[76:79], v[132:135], v[108:111]
    ds_read_b64_tr_b16 v[130:131], v25 offset:2048
    v_mfma_f32_16x16x32_bf16 v[108:111], a[100:103], v[136:139], v[108:111]
    ds_read_b64_tr_b16 v[132:133], v4 offset:3072
    v_mfma_f32_16x16x32_bf16 v[108:111], a[124:127], v[140:143], v[108:111]
    ds_read_b64_tr_b16 v[134:135], v25 offset:3072
    ds_read_b64_tr_b16 v[136:137], v4 offset:4096
    v_mfma_f32_16x16x32_bf16 v[108:111], a[148:151], v[144:147], v[108:111]
    ds_read_b64_tr_b16 v[138:139], v25 offset:4096
    v_cvt_pk_bf16_f32 v68, v104, v105
    v_mfma_f32_16x16x32_bf16 v[108:111], a[172:175], v[148:151], v[108:111]
    ds_read_b64_tr_b16 v[140:141], v4 offset:5120
    ds_read_b64_tr_b16 v[142:143], v25 offset:5120
    v_mfma_f32_16x16x32_bf16 v[108:111], a[196:199], v[152:155], v[108:111]
    ds_read_b64_tr_b16 v[144:145], v4 offset:6144
    v_cvt_pk_bf16_f32 v69, v106, v107
    v_mfma_f32_16x16x32_bf16 v[108:111], a[220:223], v[156:159], v[108:111]
    ds_read_b64_tr_b16 v[146:147], v25 offset:6144
    v_mfma_f32_16x16x32_bf16 v[108:111], a[244:247], v[160:163], v[108:111]
    ds_read_b64_tr_b16 v[148:149], v4 offset:7168
    ds_read_b64_tr_b16 v[150:151], v25 offset:7168
    v_mfma_f32_16x16x32_bf16 v[108:111], v[188:191], v[164:167], v[108:111]
    ds_read_b64_tr_b16 v[152:153], v4 offset:8192
    v_mfma_f32_16x16x32_bf16 v[108:111], v[212:215], v[168:171], v[108:111]
    ds_read_b64_tr_b16 v[154:155], v25 offset:8192
    ds_read_b64_tr_b16 v[156:157], v4 offset:9216
    v_mfma_f32_16x16x32_bf16 v[108:111], v[236:239], v[172:175], v[108:111]
    ds_read_b64_tr_b16 v[158:159], v25 offset:9216
    s_waitcnt lgkmcnt(15)
    v_mfma_f32_16x16x32_bf16 v[112:115], a[0:3], v[120:123], 0
    ds_read_b64_tr_b16 v[160:161], v4 offset:10240
    v_mfma_f32_16x16x32_bf16 v[112:115], a[24:27], v[124:127], v[112:115]
    ds_read_b64_tr_b16 v[162:163], v25 offset:10240
    ds_read_b64_tr_b16 v[164:165], v4 offset:11264
    s_waitcnt lgkmcnt(15)
    v_mfma_f32_16x16x32_bf16 v[112:115], a[48:51], v[128:131], v[112:115]
    ds_read_b64_tr_b16 v[166:167], v25 offset:11264
    v_mfma_f32_16x16x32_bf16 v[112:115], a[72:75], v[132:135], v[112:115]
    ds_read_b64_tr_b16 v[168:169], v4 offset:12288
    s_waitcnt lgkmcnt(13)
    v_mfma_f32_16x16x32_bf16 v[112:115], a[96:99], v[136:139], v[112:115]
    ds_read_b64_tr_b16 v[170:171], v25 offset:12288
    ds_read_b64_tr_b16 v[172:173], v4 offset:13312
    v_mfma_f32_16x16x32_bf16 v[112:115], a[120:123], v[140:143], v[112:115]
    ds_read_b64_tr_b16 v[174:175], v25 offset:13312
    s_waitcnt lgkmcnt(12)
    v_mfma_f32_16x16x32_bf16 v[112:115], a[144:147], v[144:147], v[112:115]
    v_cvt_pk_bf16_f32 v70, v108, v109
    v_cvt_pk_bf16_f32 v71, v110, v111
    v_mfma_f32_16x16x32_bf16 v[112:115], a[168:171], v[148:151], v[112:115]
    v_cndmask_b32 v70, v70, 0, s[82:83]
    v_cndmask_b32 v71, v71, 0, s[82:83]
    s_waitcnt lgkmcnt(8)
    v_mfma_f32_16x16x32_bf16 v[112:115], a[192:195], v[152:155], v[112:115]
    v_mfma_f32_16x16x32_bf16 v[112:115], a[216:219], v[156:159], v[112:115]
    v_mfma_f32_16x16x32_bf16 v[72:75], v[52:55], v[68:71], 0
    s_waitcnt lgkmcnt(4)
    v_mfma_f32_16x16x32_bf16 v[112:115], a[240:243], v[160:163], v[112:115]
    v_mfma_f32_16x16x32_bf16 v[76:79], v[56:59], v[68:71], 0
    v_mfma_f32_16x16x32_bf16 v[112:115], v[184:187], v[164:167], v[112:115]
    ds_read_u16_d16_hi v8, v93 offset:32768
    ds_read_u16_d16_hi v9, v94 offset:32768
    s_waitcnt lgkmcnt(2)
    v_mfma_f32_16x16x32_bf16 v[112:115], v[208:211], v[168:171], v[112:115]
    ds_read_u16_d16_hi v10, v92 offset:32768
    v_mfma_f32_16x16x32_bf16 v[112:115], v[232:235], v[172:175], v[112:115]
    v_mfma_f32_16x16x32_bf16 v[116:119], a[4:7], v[120:123], 0
    v_mfma_f32_16x16x32_bf16 v[116:119], a[28:31], v[124:127], v[116:119]
    v_mfma_f32_16x16x32_bf16 v[116:119], a[52:55], v[128:131], v[116:119]
    v_cndmask_b32 v26, v72, v73, s[76:77]
    v_cndmask_b32 v27, v74, v75, s[76:77]
    v_mfma_f32_16x16x32_bf16 v[116:119], a[76:79], v[132:135], v[116:119]
    v_cndmask_b32 v28, v76, v77, s[76:77]
    v_cndmask_b32 v29, v78, v79, s[76:77]
    v_mfma_f32_16x16x32_bf16 v[116:119], a[100:103], v[136:139], v[116:119]
    v_cndmask_b32 v26, v26, v28, s[78:79]
    v_cndmask_b32 v27, v27, v29, s[80:81]
    v_mfma_f32_16x16x32_bf16 v[116:119], a[124:127], v[140:143], v[116:119]
    s_waitcnt lgkmcnt(0)
    v_mul_f32 v26, v26, v8
    v_mfma_f32_16x16x32_bf16 v[116:119], a[148:151], v[144:147], v[116:119]
    v_cvt_pk_bf16_f32 v64, v112, v113
    v_cvt_pk_bf16_f32 v65, v114, v115
    v_mfma_f32_16x16x32_bf16 v[116:119], a[172:175], v[148:151], v[116:119]
    v_mul_f32 v27, v27, v9
    v_mul_f32 v11, s91, v10
    v_mfma_f32_16x16x32_bf16 v[116:119], a[196:199], v[152:155], v[116:119]
    v_max_f32 v28, v26, v27
    v_mov_b32 v29, v28
    v_mfma_f32_16x16x32_bf16 v[116:119], a[220:223], v[156:159], v[116:119]
    v_mfma_f32_16x16x32_bf16 v[116:119], a[244:247], v[160:163], v[116:119]
    v_permlane16_swap_b32 v28, v29
    v_max_f32 v28, v28, v29
    v_mfma_f32_16x16x32_bf16 v[116:119], v[188:191], v[164:167], v[116:119]
    v_mov_b32 v29, v28
    v_mfma_f32_16x16x32_bf16 v[116:119], v[212:215], v[168:171], v[116:119]
    v_mfma_f32_16x16x32_bf16 v[116:119], v[236:239], v[172:175], v[116:119]
    v_permlane32_swap_b32 v28, v29
    v_max_f32 v28, v28, v29
    v_mfma_f32_16x16x32_bf16 v[96:99], a[8:11], v[120:123], 0
    v_sub_f32 v26, v26, v28
    v_sub_f32 v27, v27, v28
    v_mfma_f32_16x16x32_bf16 v[96:99], a[32:35], v[124:127], v[96:99]
    v_mul_f32 v26, v11, v26
    v_mul_f32 v27, v11, v27
    v_mfma_f32_16x16x32_bf16 v[96:99], a[56:59], v[128:131], v[96:99]
    v_exp_f32 v26, v26
    v_mfma_f32_16x16x32_bf16 v[96:99], a[80:83], v[132:135], v[96:99]
    v_exp_f32 v27, v27
    v_mfma_f32_16x16x32_bf16 v[96:99], a[104:107], v[136:139], v[96:99]
    v_add_f32 v28, v26, v27
    v_mov_b32 v29, v28
    v_mfma_f32_16x16x32_bf16 v[96:99], a[128:131], v[140:143], v[96:99]
    v_mfma_f32_16x16x32_bf16 v[96:99], a[152:155], v[144:147], v[96:99]
    v_cvt_pk_bf16_f32 v66, v116, v117
    v_cvt_pk_bf16_f32 v67, v118, v119
    v_mfma_f32_16x16x32_bf16 v[96:99], a[176:179], v[148:151], v[96:99]
    v_cndmask_b32 v66, v66, 0, s[82:83]
    v_cndmask_b32 v67, v67, 0, s[82:83]
    v_mfma_f32_16x16x32_bf16 v[96:99], a[200:203], v[152:155], v[96:99]
    v_permlane16_swap_b32 v28, v29
    v_add_f32 v28, v28, v29
    v_mfma_f32_16x16x32_bf16 v[96:99], a[224:227], v[156:159], v[96:99]
    v_mov_b32 v29, v28
    v_mfma_f32_16x16x32_bf16 v[96:99], a[248:251], v[160:163], v[96:99]
    v_mfma_f32_16x16x32_bf16 v[96:99], v[192:195], v[164:167], v[96:99]
    v_permlane32_swap_b32 v28, v29
    v_add_f32 v28, v28, v29
    v_mfma_f32_16x16x32_bf16 v[96:99], v[216:219], v[168:171], v[96:99]
    v_rcp_f32 v28, v28
    v_mfma_f32_16x16x32_bf16 v[96:99], v[240:243], v[172:175], v[96:99]
    v_mul_f32 v26, v26, v8
    v_mul_f32 v27, v27, v9
    v_mfma_f32_16x16x32_bf16 v[100:103], a[12:15], v[120:123], 0
    v_mul_f32 v26, v26, v28
    v_mul_f32 v27, v27, v28
    v_mfma_f32_16x16x32_bf16 v[100:103], a[36:39], v[124:127], v[100:103]
    v_cvt_pk_bf16_f32 v26, v26, v26
    v_cvt_pk_bf16_f32 v27, v27, v27
    v_mfma_f32_16x16x32_bf16 v[100:103], a[60:63], v[128:131], v[100:103]
    v_and_b32 v80, v26, v14
    v_and_b32 v81, v27, v15
    v_mfma_f32_16x16x32_bf16 v[100:103], a[84:87], v[132:135], v[100:103]
    v_and_b32 v82, v26, v16
    v_and_b32 v83, v27, v17
    v_mfma_f32_16x16x32_bf16 v[100:103], a[108:111], v[136:139], v[100:103]
    v_mfma_f32_16x16x32_bf16 v[100:103], a[132:135], v[140:143], v[100:103]
    v_mfma_f32_16x16x32_bf16 v[72:75], v[36:39], v[80:83], 0
    v_mfma_f32_16x16x32_bf16 v[100:103], a[156:159], v[144:147], v[100:103]
    v_cvt_pk_bf16_f32 v60, v96, v97
    v_cvt_pk_bf16_f32 v61, v98, v99
    v_mfma_f32_16x16x32_bf16 v[100:103], a[180:183], v[148:151], v[100:103]
    v_mfma_f32_16x16x32_bf16 v[76:79], v[46:49], v[80:83], 0
    v_mfma_f32_16x16x32_bf16 v[100:103], a[204:207], v[152:155], v[100:103]
    s_add_u32 s53, s74, 98304
    v_mfma_f32_16x16x32_bf16 v[100:103], a[228:231], v[156:159], v[100:103]
    v_mfma_f32_16x16x32_bf16 v[100:103], a[252:255], v[160:163], v[100:103]
    v_mfma_f32_16x16x32_bf16 v[100:103], v[196:199], v[164:167], v[100:103]
    v_mfma_f32_16x16x32_bf16 v[100:103], v[220:223], v[168:171], v[100:103]
    v_mfma_f32_16x16x32_bf16 v[100:103], v[244:247], v[172:175], v[100:103]
    v_cvt_pk_bf16_f32 v84, v72, v73
    v_cvt_pk_bf16_f32 v85, v74, v75
    v_mfma_f32_16x16x32_bf16 v[104:107], v[120:123], a[16:19], 0
    v_cvt_pk_bf16_f32 v86, v76, v77
    v_cvt_pk_bf16_f32 v87, v78, v79
    v_mfma_f32_16x16x32_bf16 v[104:107], v[124:127], a[40:43], v[104:107]
    buffer_store_dwordx4 v[84:87], v23, s[24:27], s53 offen sc1
    v_mfma_f32_16x16x32_bf16 v[104:107], v[128:131], a[64:67], v[104:107]
    v_cndmask_b32 v80, v84, v86, s[88:89]
    v_cndmask_b32 v81, v85, v87, s[88:89]
    v_mfma_f32_16x16x32_bf16 v[104:107], v[132:135], a[88:91], v[104:107]
    ds_write_b64 v95, v[80:81] offset:1536
    v_mfma_f32_16x16x32_bf16 v[104:107], v[136:139], a[112:115], v[104:107]
    v_mfma_f32_16x16x32_bf16 v[104:107], v[140:143], a[136:139], v[104:107]
    v_mfma_f32_16x16x32_bf16 v[104:107], v[144:147], a[160:163], v[104:107]
    v_cvt_pk_bf16_f32 v62, v100, v101
    v_cvt_pk_bf16_f32 v63, v102, v103
    v_mfma_f32_16x16x32_bf16 v[104:107], v[148:151], a[184:187], v[104:107]
    v_cndmask_b32 v62, v62, 0, s[82:83]
    v_cndmask_b32 v63, v63, 0, s[82:83]
    v_mfma_f32_16x16x32_bf16 v[104:107], v[152:155], a[208:211], v[104:107]
    v_mfma_f32_16x16x32_bf16 v[104:107], v[156:159], a[232:235], v[104:107]
    v_mfma_f32_16x16x32_bf16 v[72:75], v[56:59], v[64:67], 0
    v_mfma_f32_16x16x32_bf16 v[104:107], v[160:163], v[176:179], v[104:107]
    v_mfma_f32_16x16x32_bf16 v[76:79], v[60:63], v[64:67], 0
    v_mfma_f32_16x16x32_bf16 v[104:107], v[164:167], v[200:203], v[104:107]
    ds_read_u16_d16_hi v8, v93 offset:49152
    ds_read_u16_d16_hi v9, v94 offset:49152
    v_mfma_f32_16x16x32_bf16 v[104:107], v[168:171], v[224:227], v[104:107]
    ds_read_u16_d16_hi v10, v92 offset:49152
    v_mfma_f32_16x16x32_bf16 v[104:107], v[172:175], v[248:251], v[104:107]
    v_mfma_f32_16x16x32_bf16 v[108:111], v[120:123], a[20:23], 0
    v_mfma_f32_16x16x32_bf16 v[108:111], v[124:127], a[44:47], v[108:111]
    v_mfma_f32_16x16x32_bf16 v[108:111], v[128:131], a[68:71], v[108:111]
    v_cndmask_b32 v26, v72, v73, s[76:77]
    v_cndmask_b32 v27, v74, v75, s[76:77]
    v_mfma_f32_16x16x32_bf16 v[108:111], v[132:135], a[92:95], v[108:111]
    v_cndmask_b32 v28, v76, v77, s[76:77]
    v_cndmask_b32 v29, v78, v79, s[76:77]
    v_mfma_f32_16x16x32_bf16 v[108:111], v[136:139], a[116:119], v[108:111]
    v_cndmask_b32 v26, v26, v28, s[78:79]
    v_cndmask_b32 v27, v27, v29, s[80:81]
    v_mfma_f32_16x16x32_bf16 v[108:111], v[140:143], a[140:143], v[108:111]
    s_waitcnt lgkmcnt(0)
    v_mul_f32 v26, v26, v8
    v_mfma_f32_16x16x32_bf16 v[108:111], v[144:147], a[164:167], v[108:111]
    v_cvt_pk_bf16_f32 v40, v104, v105
    v_cvt_pk_bf16_f32 v41, v106, v107
    v_mfma_f32_16x16x32_bf16 v[108:111], v[148:151], a[188:191], v[108:111]
    v_mul_f32 v27, v27, v9
    v_mul_f32 v11, s91, v10
    v_mfma_f32_16x16x32_bf16 v[108:111], v[152:155], a[212:215], v[108:111]
    v_max_f32 v28, v26, v27
    v_mov_b32 v29, v28
    v_mfma_f32_16x16x32_bf16 v[108:111], v[156:159], a[236:239], v[108:111]
    v_mfma_f32_16x16x32_bf16 v[108:111], v[160:163], v[180:183], v[108:111]
    v_permlane16_swap_b32 v28, v29
    v_max_f32 v28, v28, v29
    v_mfma_f32_16x16x32_bf16 v[108:111], v[164:167], v[204:207], v[108:111]
    v_mov_b32 v29, v28
    v_mfma_f32_16x16x32_bf16 v[108:111], v[168:171], v[228:231], v[108:111]
    v_mfma_f32_16x16x32_bf16 v[108:111], v[172:175], v[252:255], v[108:111]
    v_permlane32_swap_b32 v28, v29
    v_max_f32 v28, v28, v29
    s_nop 5
    v_cvt_pk_bf16_f32 v50, v108, v109
    v_cvt_pk_bf16_f32 v51, v110, v111
    v_sub_f32 v26, v26, v28
    v_sub_f32 v27, v27, v28
    v_mul_f32 v26, v11, v26
    v_mul_f32 v27, v11, v27
    v_exp_f32 v26, v26
    v_exp_f32 v27, v27
    s_nop 0
    v_add_f32 v28, v26, v27
    v_mov_b32 v29, v28
    s_nop 1
    v_permlane16_swap_b32 v28, v29
    v_add_f32 v28, v28, v29
    v_mov_b32 v29, v28
    s_nop 1
    v_permlane32_swap_b32 v28, v29
    v_add_f32 v28, v28, v29
    v_rcp_f32 v28, v28
    v_mul_f32 v26, v26, v8
    v_mul_f32 v27, v27, v9
    v_mul_f32 v26, v26, v28
    v_mul_f32 v27, v27, v28
    v_cvt_pk_bf16_f32 v26, v26, v26
    v_cvt_pk_bf16_f32 v27, v27, v27
    v_and_b32 v80, v26, v14
    v_and_b32 v81, v27, v15
    v_and_b32 v82, v26, v16
    v_and_b32 v83, v27, v17
    s_nop 1
    v_mfma_f32_16x16x32_bf16 v[72:75], v[38:41], v[80:83], 0
    v_mfma_f32_16x16x32_bf16 v[76:79], v[48:51], v[80:83], 0
    s_add_u32 s53, s74, 114688
    s_nop 5
    v_cvt_pk_bf16_f32 v84, v72, v73
    v_cvt_pk_bf16_f32 v85, v74, v75
    v_cvt_pk_bf16_f32 v86, v76, v77
    v_cvt_pk_bf16_f32 v87, v78, v79
    buffer_store_dwordx4 v[84:87], v23, s[24:27], s53 offen sc1
    v_cndmask_b32 v80, v84, v86, s[88:89]
    v_cndmask_b32 v81, v85, v87, s[88:89]
    ds_write_b64 v95, v[80:81] offset:1792
    v_lshlrev_b32 v6, 4, v0
    v_add_u32 v6, 147456, v6
    v_lshrrev_b32 v7, 4, v1
    v_and_b32 v12, 15, v1
    v_lshlrev_b32 v7, 14, v7
    v_lshl_add_u32 v7, v12, 4, v7
    s_waitcnt lgkmcnt(0)
    s_barrier
    ds_read_b128 v[72:75], v6
    s_waitcnt lgkmcnt(0)
    buffer_store_dwordx4 v[72:75], v7, s[24:27], s95 offen sc1
    s_waitcnt vmcnt(0) lgkmcnt(0)
    s_barrier
    s_cmp_lg_u32 s44, 0
    s_cbranch_scc1 L_nopub21
    s_lshl_b32 s60, s48, 4
    s_add_u32 s60, s60, s49
    s_lshl_b32 s60, s60, 7
    s_add_u32 s60, s60, 12779520
    v_mov_b32 v30, s47
    s_mov_b64 exec, 1
    buffer_store_dword v30, off, s[24:27], s60 sc1
L_wa_3:
    s_cbranch_execz L_wa_ret
    s_mov_b64 exec, -1
L_nopub21:
    s_endpgm
L_codeend:
.section .rodata,"a"
.p2align 6
.amdhsa_kernel parallel_sum__sliding_local_dilated__mixer_token_mlp__prompt_kernel
  .amdhsa_next_free_vgpr 512
  .amdhsa_next_free_sgpr 102
  .amdhsa_accum_offset 256
  .amdhsa_group_segment_fixed_size 0
  .amdhsa_kernarg_size 88
  .amdhsa_user_sgpr_count 2
  .amdhsa_user_sgpr_kernarg_segment_ptr 1
  .amdhsa_system_sgpr_workgroup_id_x 1
  .amdhsa_float_denorm_mode_32 3
.end_amdhsa_kernel
```

```asm
; @launch grid=(256,1,1) block=(256,1,1) lds=163840
.amdgcn_target "amdgcn-amd-amdhsa--gfx950"
.text
.globl parallel_sum__sliding_local_dilated__mixer_token_mlp__prompt_kernel
.p2align 8
.type parallel_sum__sliding_local_dilated__mixer_token_mlp__prompt_kernel,@function
parallel_sum__sliding_local_dilated__mixer_token_mlp__prompt_kernel:
    s_cmp_ge_u32 s2, 256
    s_cbranch_scc1 L_end
    s_load_dwordx2 s[4:5], s[0:1], 0
    s_load_dwordx16 s[76:91], s[0:1], 0
    s_load_dwordx4 s[92:95], s[0:1], 64
    s_load_dwordx2 s[24:25], s[0:1], 80
    s_lshr_b32 s46, s2, 3
    s_getpc_b64 s[98:99]
L_pc:
    s_mul_i32 s53, s46, 1536
    v_lshrrev_b32 v26, 4, v0
    v_min_u32 v26, 11, v26
    v_lshl_add_u32 v26, v26, 7, s53
    v_lshrrev_b32 v25, 5, v0
    v_min_u32 v26, L_codeend-L_pc-4, v26
    v_mov_b32 v29, s99
    v_add_co_u32 v28, vcc, s98, v26
    s_nop 1
    v_addc_co_u32 v29, vcc, 0, v29, vcc
    global_load_dword v108, v[28:29], off
    v_and_b32 v26, 31, v0
    v_mul_u32_u24 v24, 896, v25
    v_lshl_add_u32 v24, v26, 4, v24
    s_mul_i32 s53, s2, 7168
    v_add_u32 v24, s53, v24
    v_cmp_gt_u32 vcc, 24, v26
    v_mov_b32 v27, 2130706432
    s_mov_b32 s6, 1835008
    s_mov_b32 s7, 0x20000
    v_cndmask_b32 v22, v27, v24, vcc
    v_lshrrev_b32 v27, 6, v0
    v_and_b32 v1, 63, v0
    s_waitcnt lgkmcnt(0)
    buffer_load_dwordx4 v[32:35], v24, s[4:7], 0 offen
    buffer_load_dwordx4 v[36:39], v22, s[4:7], 0 offen offset:512
    v_readfirstlane_b32 s44, v27
    s_and_b32 s45, s2, 7
    s_mov_b64 s[8:9], s[78:79]
    s_mov_b32 s10, 1204224
    s_mov_b32 s11, s7
    s_and_b32 s53, s45, 6
    s_lshr_b32 s53, 0xc9, s53
    s_and_b32 s53, s53, 3
    s_add_u32 s54, s53, 1
    s_bfe_u32 s54, s54, 0x10001
    s_add_u32 s54, s54, 1
    s_mul_i32 s53, s53, 224
    s_andn2_b32 s53, s53, 127
    s_sub_u32 s55, s46, 3
    s_cmp_lt_u32 s46, 24
    s_cselect_b32 s55, 63, s55
    s_cmp_lt_u32 s46, 21
    s_cselect_b32 s55, s46, s55
    s_mul_i32 s55, s55, 43008
    s_add_u32 s53, s53, s55
    v_and_b32 v27, 3, v0
    v_min_u32 v27, s54, v27
    v_bfe_u32 v28, v0, 2, 2
    v_med3_u32 v28, v28, 1, 1
    v_mul_u32_u24 v28, 7, v28
    v_add_u32 v27, v27, v28
    v_lshrrev_b32 v28, 4, v0
    v_min_u32 v28, 15, v28
    v_mul_u32_u24 v28, 21, v28
    v_add_lshl_u32 v27, v27, v28, 7
    buffer_load_dword v108, v27, s[8:11], s53 offen
    s_mov_b64 s[40:41], s[94:95]
    s_mov_b32 s42, 256
    s_mov_b32 s43, s7
    s_or_b32 s53, s2, s44
    s_cbranch_scc1 L_nononce
    s_memrealtime s[98:99]
    s_waitcnt lgkmcnt(0)
    s_or_b32 s98, s98, 1
    v_mov_b32 v28, s98
    s_mov_b64 exec, 1
    buffer_store_dword v28, off, s[40:43], 0 sc1
    s_mov_b64 exec, -1
L_nononce:
    s_mov_b64 s[16:17], s[84:85]
    s_mov_b32 s18, 7340032
    s_mov_b32 s19, s7
    s_mov_b32 s26, 16777216
    s_mov_b32 s27, s7
    s_mov_b64 s[20:21], s[88:89]
    s_mov_b32 s22, 7340032
    s_mov_b32 s23, s7
    s_mov_b64 s[12:13], s[80:81]
    s_mov_b32 s14, 401408
    s_mov_b32 s15, s7
    s_mov_b64 s[28:29], s[92:93]
    s_mov_b32 s30, 1835008
    s_mov_b32 s31, s7
    s_mov_b64 s[32:33], s[86:87]
    s_mov_b32 s34, 3584
    s_mov_b32 s35, s7
    s_mov_b64 s[36:37], s[90:91]
    s_mov_b32 s38, 4096
    s_mov_b32 s39, s7
    s_lshl_b32 s52, s44, 12
    v_lshlrev_b32 v23, 4, v1
    s_cmp_ge_u32 s46, 24
    s_cbranch_scc1 L_role_a
    v_lshrrev_b32 v208, 4, v1
    v_bfe_u32 v209, v1, 2, 2
    v_and_b32 v210, 3, v1
    v_and_b32 v211, 15, v1
    v_lshrrev_b32 v212, 5, v1
    s_mul_i32 s55, s45, 3
    s_max_u32 s55, s55, 1
    s_add_u32 s55, s55, s46
    s_sub_u32 s55, s55, 1
    s_sub_u32 s56, s55, 21
    s_min_u32 s55, s55, s56
    s_and_b32 s54, s45, 1
    s_mul_i32 s54, s54, 24
    s_sub_u32 s54, s46, s54
    s_cmp_ge_u32 s46, 21
    s_cselect_b32 s54, s54, s55
    s_mul_i32 s53, s45, 21
    s_add_u32 s53, s53, s54
    s_mul_i32 s50, s53, 171
    s_lshr_b32 s50, s50, 10
    s_mul_i32 s54, s50, 6
    s_sub_u32 s88, s53, s54
    s_mul_i32 s51, s50, 2
    s_add_u32 s51, s51, s88
    s_mul_i32 s54, s51, 43
    s_lshr_b32 s54, s54, 8
    s_mul_i32 s54, s54, 6
    s_sub_u32 s51, s51, s54
    s_mul_i32 s65, s51, 16
    s_add_u32 s65, s65, 2
    s_mul_i32 s65, s65, 171
    s_lshr_b32 s65, s65, 10
    v_lshl_add_u32 v213, v212, 2, v209
    v_and_b32 v215, 1, v208
    v_lshlrev_b32 v214, 4, v210
    v_lshl_add_u32 v214, v215, 6, v214
    s_mul_i32 s53, s44, 1835008
    s_lshl_b32 s54, s50, 7
    s_add_u32 s53, s53, s54
    v_mul_u32_u24 v10, 3584, v213
    v_add3_u32 v10, v10, v214, s53
    v_xor_b32 v11, 32, v10
    v_lshl_add_u32 v19, v208, 3, s54
    s_cmp_ge_u32 s46, 21
    s_cbranch_scc1 L_help
    buffer_load_dwordx2 v[224:225], v19, s[32:35], 0 offen offset:0
    buffer_load_dwordx2 v[226:227], v19, s[32:35], 0 offen offset:32
    buffer_load_dwordx2 v[228:229], v19, s[32:35], 0 offen offset:64
    buffer_load_dwordx2 v[230:231], v19, s[32:35], 0 offen offset:96
    s_add_u32 m0, s52, 49152
    s_add_u32 s57, s65, 0
    s_sub_u32 s3, s57, 16
    s_min_u32 s57, s57, s3
    s_mul_i32 s57, s57, 114688
    buffer_load_dwordx4 v10, s[16:19], s57 offen offset:0 lds
    s_add_u32 s57, s57, 27648
    buffer_load_dwordx4 v11, s[16:19], s57 offen offset:1024 lds
    s_add_u32 s57, s57, 27648
    buffer_load_dwordx4 v10, s[16:19], s57 offen offset:2048 lds
    s_add_u32 s57, s57, 27648
    buffer_load_dwordx4 v11, s[16:19], s57 offen offset:3072 lds
    s_add_u32 m0, s52, 65536
    s_add_u32 s57, s65, 1
    s_sub_u32 s3, s57, 16
    s_min_u32 s57, s57, s3
    s_mul_i32 s57, s57, 114688
    buffer_load_dwordx4 v10, s[16:19], s57 offen offset:0 lds
    v_mul_u32_u24 v109, 1088, v25
    v_lshl_add_u32 v109, v26, 4, v109
    v_mul_u32_u24 v110, 1088, v209
    v_lshl_add_u32 v110, v208, 5, v110
    v_lshl_add_u32 v110, v210, 3, v110
    s_lshl_b32 s53, s44, 7
    v_add_u32 v110, s53, v110
    v_mul_u32_u24 v111, 66816, v208
    v_lshl_add_u32 v111, v211, 4, v111
    s_mul_i32 s63, s44, 267264
    s_lshl_b32 s53, s2, 8
    s_add_u32 s63, s63, s53
    s_add_u32 s64, s63, 1069056
    v_cmp_gt_u32 vcc, 208, v0
    v_mov_b32 v100, 2130706432
    v_cmp_le_u32 s[92:93], 24, v26
    v_cndmask_b32 v22, v100, v111, vcc
    s_mov_b32 s62, 0x3f803f80
    s_mov_b32 s61, 0xffff0000
    v_mov_b32 v96, 0
    v_mov_b32 v97, 0
    v_lshlrev_b32 v216, 6, v209
    v_lshl_add_u32 v216, v210, 3, v216
    v_lshl_add_u32 v216, v215, 5, v216
    s_add_u32 s53, s52, 49152
    v_lshl_add_u32 v2, v208, 10, v216
    v_add_u32 v2, s53, v2
    v_xor_b32 v3, 32, v2
    v_add_u32 v4, 65536, v2
    v_add_u32 v5, 65536, v3
    v_lshl_add_u32 v6, v208, 9, v216
    v_add_u32 v6, s53, v6
    v_xor_b32 v7, 32, v6
    v_add_u32 v8, 65536, v6
    v_add_u32 v9, 65536, v7
    s_waitcnt vmcnt(11)
    v_dot2c_f32_bf16 v96, s62, v32
    v_dot2c_f32_bf16 v97, v32, v32
    v_lshlrev_b32 v40, 16, v32
    v_and_b32 v41, s61, v32
    v_dot2c_f32_bf16 v96, s62, v33
    v_dot2c_f32_bf16 v97, v33, v33
    v_lshlrev_b32 v42, 16, v33
    v_and_b32 v43, s61, v33
    v_dot2c_f32_bf16 v96, s62, v34
    v_dot2c_f32_bf16 v97, v34, v34
    v_lshlrev_b32 v44, 16, v34
    v_and_b32 v45, s61, v34
    v_dot2c_f32_bf16 v96, s62, v35
    v_dot2c_f32_bf16 v97, v35, v35
    v_lshlrev_b32 v46, 16, v35
    v_and_b32 v47, s61, v35
    s_waitcnt vmcnt(10)
    v_dot2c_f32_bf16 v96, s62, v36
    v_dot2c_f32_bf16 v97, v36, v36
    v_lshlrev_b32 v48, 16, v36
    v_and_b32 v49, s61, v36
    v_dot2c_f32_bf16 v96, s62, v37
    v_dot2c_f32_bf16 v97, v37, v37
    v_lshlrev_b32 v50, 16, v37
    v_and_b32 v51, s61, v37
    v_dot2c_f32_bf16 v96, s62, v38
    v_dot2c_f32_bf16 v97, v38, v38
    v_lshlrev_b32 v52, 16, v38
    v_and_b32 v53, s61, v38
    v_dot2c_f32_bf16 v96, s62, v39
    v_dot2c_f32_bf16 v97, v39, v39
    v_lshlrev_b32 v54, 16, v39
    v_and_b32 v55, s61, v39
    buffer_load_dword v29, off, s[40:43], 0 sc1
    v_add_f32_dpp v96, v96, v96 quad_perm:[1,0,3,2] row_mask:0xf bank_mask:0xf
    v_add_f32_dpp v97, v97, v97 quad_perm:[1,0,3,2] row_mask:0xf bank_mask:0xf
    s_nop 0
    v_add_f32_dpp v96, v96, v96 quad_perm:[2,3,0,1] row_mask:0xf bank_mask:0xf
    v_add_f32_dpp v97, v97, v97 quad_perm:[2,3,0,1] row_mask:0xf bank_mask:0xf
    s_nop 0
    v_add_f32_dpp v96, v96, v96 row_half_mirror row_mask:0xf bank_mask:0xf
    v_add_f32_dpp v97, v97, v97 row_half_mirror row_mask:0xf bank_mask:0xf
    s_nop 0
    v_add_f32_dpp v96, v96, v96 row_mirror row_mask:0xf bank_mask:0xf
    v_add_f32_dpp v97, v97, v97 row_mirror row_mask:0xf bank_mask:0xf
    v_mov_b32 v98, v96
    v_mov_b32 v99, v97
    s_nop 0
    v_permlane16_swap_b32 v96, v98
    v_permlane16_swap_b32 v97, v99
    v_add_f32 v96, v96, v98
    v_add_f32 v97, v97, v99
    v_mul_f32 v98, 0x3b124925, v96
    v_mul_f32 v99, 0x3b124925, v97
    v_fma_f32 v99, -v98, v98, v99
    v_max_f32 v99, 0, v99
    v_cvt_pk_bf16_f32 v100, 0, v99
    v_add_f32 v100, 0x3727c5ac, v100
    v_cvt_pk_bf16_f32 v100, 0, v100
    v_sqrt_f32 v100, v100
    s_nop 0
    v_cvt_pk_bf16_f32 v100, 0, v100
    v_rcp_f32 v100, v100
    s_nop 0
    v_mul_f32 v99, v99, v100
    v_mul_f32 v99, v99, v100
    v_cvt_pk_bf16_f32 v104, 0, v99
    v_add_f32 v104, 0x3727c5ac, v104
    v_cvt_pk_bf16_f32 v104, 0, v104
    v_sqrt_f32 v104, v104
    s_nop 0
    v_cvt_pk_bf16_f32 v102, 0, v104
    v_rcp_f32 v104, v102
    s_nop 0
    v_mul_f32 v104, v104, v100
    v_mul_f32 v106, v98, v104
    v_pk_fma_f32 v[56:57], v[40:41], v[104:105], v[106:107] op_sel_hi:[1,0,0] neg_lo:[0,0,1] neg_hi:[0,0,1]
    v_pk_fma_f32 v[58:59], v[42:43], v[104:105], v[106:107] op_sel_hi:[1,0,0] neg_lo:[0,0,1] neg_hi:[0,0,1]
    v_pk_fma_f32 v[60:61], v[44:45], v[104:105], v[106:107] op_sel_hi:[1,0,0] neg_lo:[0,0,1] neg_hi:[0,0,1]
    v_pk_fma_f32 v[62:63], v[46:47], v[104:105], v[106:107] op_sel_hi:[1,0,0] neg_lo:[0,0,1] neg_hi:[0,0,1]
    v_pk_fma_f32 v[64:65], v[48:49], v[104:105], v[106:107] op_sel_hi:[1,0,0] neg_lo:[0,0,1] neg_hi:[0,0,1]
    v_pk_fma_f32 v[66:67], v[50:51], v[104:105], v[106:107] op_sel_hi:[1,0,0] neg_lo:[0,0,1] neg_hi:[0,0,1]
    v_pk_fma_f32 v[68:69], v[52:53], v[104:105], v[106:107] op_sel_hi:[1,0,0] neg_lo:[0,0,1] neg_hi:[0,0,1]
    v_pk_fma_f32 v[70:71], v[54:55], v[104:105], v[106:107] op_sel_hi:[1,0,0] neg_lo:[0,0,1] neg_hi:[0,0,1]
    v_cvt_pk_bf16_f32 v80, v56, v57
    v_cvt_pk_bf16_f32 v81, v58, v59
    v_cvt_pk_bf16_f32 v82, v60, v61
    v_cvt_pk_bf16_f32 v83, v62, v63
    v_cvt_pk_bf16_f32 v84, v64, v65
    v_cvt_pk_bf16_f32 v85, v66, v67
    v_cvt_pk_bf16_f32 v86, v68, v69
    v_cvt_pk_bf16_f32 v87, v70, v71
    v_lshrrev_b32 v102, 16, v102
    v_cndmask_b32 v84, v84, v102, s[92:93]
    ds_write_b128 v109, v[80:83] offset:0
    ds_write_b128 v109, v[84:87] offset:512
    s_waitcnt lgkmcnt(0)
    s_barrier
    ds_read_b64_tr_b16 v[88:89], v110 offset:0
    ds_read_b64_tr_b16 v[90:91], v110 offset:4352
    ds_read_b64_tr_b16 v[92:93], v110 offset:512
    ds_read_b64_tr_b16 v[94:95], v110 offset:4864
    s_waitcnt lgkmcnt(2)
    buffer_store_dwordx4 v[88:91], v111, s[24:27], s63 offen sc1
    s_waitcnt lgkmcnt(0)
    buffer_store_dwordx4 v[92:95], v22, s[24:27], s64 offen sc1
    s_add_u32 s57, s57, 27648
    buffer_load_dwordx4 v11, s[16:19], s57 offen offset:1024 lds
    s_add_u32 s57, s57, 27648
    buffer_load_dwordx4 v10, s[16:19], s57 offen offset:2048 lds
    s_add_u32 s57, s57, 27648
    buffer_load_dwordx4 v11, s[16:19], s57 offen offset:3072 lds
    s_add_u32 m0, s52, 81920
    s_add_u32 s57, s65, 2
    s_sub_u32 s3, s57, 16
    s_min_u32 s57, s57, s3
    s_mul_i32 s57, s57, 114688
    buffer_load_dwordx4 v10, s[16:19], s57 offen offset:0 lds
    s_add_u32 s57, s57, 27648
    buffer_load_dwordx4 v11, s[16:19], s57 offen offset:1024 lds
    s_add_u32 s57, s57, 27648
    buffer_load_dwordx4 v10, s[16:19], s57 offen offset:2048 lds
    s_branch L_body
.p2align 12
L_body:
    s_mov_b32 s59, s44
    s_mov_b64 exec, 0
    s_branch L_wb_go
L_wb_ret:
    s_add_u32 s59, s59, 4
L_wb_go:
    s_cmp_eq_u32 s59, 0
    s_cbranch_scc1 L_wb_0
    s_cmp_eq_u32 s59, 1
    s_cbranch_scc1 L_wb_1
    s_cmp_eq_u32 s59, 2
    s_cbranch_scc1 L_wb_2
    s_cmp_eq_u32 s59, 3
    s_cbranch_scc1 L_wb_3
    s_cmp_eq_u32 s59, 4
    s_cbranch_scc1 L_wb_3
    s_cmp_eq_u32 s59, 5
    s_cbranch_scc1 L_wb_3
    s_mov_b64 exec, -1
    s_waitcnt vmcnt(6)
    v_cmp_eq_u32 vcc, 0, v29
    s_nop 0
    s_cbranch_vccz L_ok2
    s_mov_b32 s59, 100000
L_spin1:
    buffer_load_dword v29, off, s[40:43], 0 sc1
    s_waitcnt vmcnt(0)
    v_cmp_eq_u32 vcc, 0, v29
    s_nop 0
    s_cbranch_vccz L_ok2
    s_sub_u32 s59, s59, 1
    s_cbranch_scc0 L_spin1
L_ok2:
    v_readfirstlane_b32 s47, v29
    s_barrier
    s_cmp_lg_u32 s44, 0
    s_cbranch_scc1 L_nopub3
    s_lshl_b32 s60, s2, 5
    s_add_u32 s60, s60, 12582912
    v_mov_b32 v30, s47
    s_mov_b64 exec, 1
    buffer_store_dword v30, off, s[24:27], s60 sc1
    s_mov_b64 exec, -1
L_nopub3:
    s_lshl_b32 s53, s44, 11
    s_add_u32 s53, s53, 12582912
    v_lshl_add_u32 v18, v1, 5, s53
    s_lshl2_add_u32 s67, s51, s44
    s_add_u32 s57, s57, 27648
    buffer_load_dwordx4 v11, s[16:19], s57 offen offset:3072 lds
    s_mul_i32 s67, s67, 58624
    s_lshl_b32 s53, s50, 11
    s_add_u32 s67, s67, s53
    s_add_u32 s67, s67, 2097152
    s_add_u32 m0, s52, 98304
    s_add_u32 s57, s65, 3
    s_sub_u32 s3, s57, 16
    s_min_u32 s57, s57, s3
    s_mul_i32 s57, s57, 114688
    buffer_load_dwordx4 v10, s[16:19], s57 offen offset:0 lds
    v_mov_b32 v236, 0xbdd2d3e8
    v_mov_b32 v237, 0xc0135761
    s_or_b32 s88, s88, 0
    s_add_u32 s54, s88, 24
    s_add_u32 s57, s57, 27648
    buffer_load_dwordx4 v11, s[16:19], s57 offen offset:1024 lds
    ds_read_b64_tr_b16 a[0:1], v2 offset:0
    ds_read_b64_tr_b16 a[2:3], v2 offset:512
    ds_read_b64_tr_b16 a[4:5], v3 offset:0
    ds_read_b64_tr_b16 a[6:7], v3 offset:512
    s_mul_i32 s84, s54, 66816
    s_lshl2_add_u32 s84, s52, s84
    s_mul_i32 s83, s54, 58624
    s_add_u32 s83, s83, s53
    ds_read_b64_tr_b16 a[8:9], v2 offset:256
    ds_read_b64_tr_b16 a[10:11], v2 offset:768
    ds_read_b64_tr_b16 a[12:13], v3 offset:256
    ds_read_b64_tr_b16 a[14:15], v3 offset:768
    s_add_u32 s57, s57, 27648
    buffer_load_dwordx4 v10, s[16:19], s57 offen offset:2048 lds
    s_and_b32 s54, s44, 1
    s_lshl_b32 s54, s54, 10
    s_add_u32 s83, s83, s54
    s_add_u32 s83, s83, 2097152
    s_add_u32 s57, s57, 27648
    buffer_load_dwordx4 v11, s[16:19], s57 offen offset:3072 lds
    s_lshl1_add_u32 s54, s54, 49152
    v_add_u32 v243, s54, v23
    s_cmp_lt_u32 s88, 4
    s_cselect_b32 s84, s84, 2130706432
    s_cselect_b32 s83, s83, 2130706432
    s_cmp_lt_u32 s44, 2
    s_cselect_b32 s83, s83, 2130706432
    s_cmp_eq_u32 s44, 0
    s_cselect_b32 s85, 1.0, 0
    s_mul_i32 s53, s45, 7
    s_lshr_b32 s53, s53, 1
    s_sub_u32 s53, s50, s53
    s_lshl1_add_u32 s53, s53, s88
    s_sub_u32 s53, s53, 4
    s_mul_i32 s54, s44, 28
    s_add_u32 s54, s54, s53
    s_lshl_b32 s87, s54, 16
    s_lshl_b32 s54, s45, 9
    s_add_u32 s87, s87, s54
    s_cmp_ge_u32 s88, 4
    s_cselect_b32 s87, s87, 2130706432
    v_lshrrev_b32 v254, 2, v1
    v_lshlrev_b32 v254, 12, v254
    v_lshl_add_u32 v254, v210, 7, v254
    s_add_u32 m0, s52, 114688
    s_add_u32 s57, s65, 4
    s_sub_u32 s3, s57, 16
    s_min_u32 s57, s57, s3
    s_mul_i32 s57, s57, 114688
    buffer_load_dwordx4 v10, s[16:19], s57 offen offset:0 lds
    s_lshr_b32 s53, s46, 2
    s_and_b32 s89, s46, 3
    s_bfe_u32 s54, s46, 0x20001
    s_and_b32 s55, s46, 1
    s_add_u32 s55, s55, 4
    s_cmp_lt_u32 s46, 16
    s_cselect_b32 s53, s53, s54
    s_cselect_b32 s89, s89, s55
    s_mul_i32 s49, s53, 2
    s_add_u32 s49, s49, s89
    s_sub_u32 s54, s49, 6
    s_min_u32 s49, s49, s54
    s_or_b32 s89, s89, 0
    s_add_u32 s57, s57, 27648
    buffer_load_dwordx4 v11, s[16:19], s57 offen offset:1024 lds
    s_waitcnt vmcnt(10)
    ds_read_b64_tr_b16 a[16:17], v2 offset:16384
    ds_read_b64_tr_b16 a[18:19], v2 offset:16896
    ds_read_b64_tr_b16 a[20:21], v3 offset:16384
    ds_read_b64_tr_b16 a[22:23], v3 offset:16896
    s_add_u32 s57, s57, 27648
    buffer_load_dwordx4 v10, s[16:19], s57 offen offset:2048 lds
    ds_read_b64_tr_b16 a[24:25], v2 offset:16640
    ds_read_b64_tr_b16 a[26:27], v2 offset:17152
    ds_read_b64_tr_b16 a[28:29], v3 offset:16640
    ds_read_b64_tr_b16 a[30:31], v3 offset:17152
    s_add_u32 s57, s57, 27648
    buffer_load_dwordx4 v11, s[16:19], s57 offen offset:3072 lds
    s_lshl2_add_u32 s48, s45, s53
    s_mul_i32 s53, s44, 1835008
    s_lshl_b32 s74, s48, 7
    s_add_u32 s53, s53, s74
    s_lshl_b32 s56, s44, 5
    v_lshlrev_b32 v217, 5, v212
    v_xor_b32 v217, v217, v214
    v_xor_b32 v217, s56, v217
    s_add_u32 m0, s52, 131072
    s_add_u32 s57, s65, 5
    s_sub_u32 s3, s57, 16
    s_min_u32 s57, s57, s3
    s_mul_i32 s57, s57, 114688
    buffer_load_dwordx4 v10, s[16:19], s57 offen offset:0 lds
    s_add_u32 s74, s74, s56
    v_lshlrev_b32 v12, 12, v213
    v_add3_u32 v12, v12, v217, s53
    s_mul_i32 s53, s44, 28672
    s_add_u32 s57, s57, 27648
    buffer_load_dwordx4 v11, s[16:19], s57 offen offset:1024 lds
    s_waitcnt vmcnt(10)
    ds_read_b64_tr_b16 a[32:33], v2 offset:32768
    ds_read_b64_tr_b16 a[34:35], v2 offset:33280
    ds_read_b64_tr_b16 a[36:37], v3 offset:32768
    ds_read_b64_tr_b16 a[38:39], v3 offset:33280
    s_add_u32 s57, s57, 27648
    buffer_load_dwordx4 v10, s[16:19], s57 offen offset:2048 lds
    ds_read_b64_tr_b16 a[40:41], v2 offset:33024
    ds_read_b64_tr_b16 a[42:43], v2 offset:33536
    ds_read_b64_tr_b16 a[44:45], v3 offset:33024
    ds_read_b64_tr_b16 a[46:47], v3 offset:33536
    s_lshl_b32 s54, s49, 7
    s_add_u32 s55, s53, s54
    v_mul_u32_u24 v13, 896, v213
    v_add3_u32 v13, v13, v214, s55
    s_add_u32 s57, s57, 27648
    buffer_load_dwordx4 v11, s[16:19], s57 offen offset:3072 lds
    v_xor_b32 v14, 32, v13
    s_mul_i32 s55, s44, 21504
    v_subrev_u32 v239, s55, v13
    s_and_b32 s55, s56, 32
    s_add_u32 m0, s52, 147456
    s_add_u32 s57, s65, 6
    s_sub_u32 s3, s57, 16
    s_min_u32 s57, s57, s3
    s_mul_i32 s57, s57, 114688
    buffer_load_dwordx4 v10, s[16:19], s57 offen offset:0 lds
    v_xor_b32 v239, s55, v239
    s_mul_i32 s73, s48, 57344
    s_add_u32 s71, s73, s54
    s_mul_i32 s55, s44, 14336
    s_add_u32 s57, s57, 27648
    buffer_load_dwordx4 v11, s[16:19], s57 offen offset:1024 lds
    s_waitcnt vmcnt(10)
    ds_read_b64_tr_b16 a[48:49], v2 offset:49152
    ds_read_b64_tr_b16 a[50:51], v2 offset:49664
    ds_read_b64_tr_b16 a[52:53], v3 offset:49152
    ds_read_b64_tr_b16 a[54:55], v3 offset:49664
    s_add_u32 s71, s71, s55
    s_add_u32 s72, s71, 7168
    v_bfe_u32 v217, v1, 1, 2
    v_lshl_add_u32 v217, v212, 2, v217
    ds_read_b64_tr_b16 a[56:57], v2 offset:49408
    ds_read_b64_tr_b16 a[58:59], v2 offset:49920
    ds_read_b64_tr_b16 a[60:61], v3 offset:49408
    ds_read_b64_tr_b16 a[62:63], v3 offset:49920
    s_add_u32 s57, s57, 27648
    buffer_load_dwordx4 v10, s[16:19], s57 offen offset:2048 lds
    v_and_b32 v218, 24, v1
    v_add_u32 v217, v217, v218
    v_mul_u32_u24 v15, 896, v217
    v_and_b32 v217, 1, v1
    s_add_u32 s57, s57, 27648
    buffer_load_dwordx4 v11, s[16:19], s57 offen offset:3072 lds
    v_lshl_add_u32 v15, v217, 4, v15
    v_add_u32 v15, s53, v15
    s_lshl_b32 s54, s89, 5
    s_add_u32 s54, s54, 768
    s_waitcnt lgkmcnt(15)
    s_add_u32 m0, s52, 49152
    s_add_u32 s57, s65, 7
    s_sub_u32 s3, s57, 16
    s_min_u32 s57, s57, s3
    s_mul_i32 s57, s57, 114688
    buffer_load_dwordx4 v10, s[16:19], s57 offen offset:0 lds
    s_add_u32 s68, s89, 24
    s_mul_i32 s68, s68, 58624
    s_mul_i32 s69, s44, 14336
    s_add_u32 s69, s69, 2097152
    s_add_u32 s68, s68, s69
    s_mul_i32 s55, s49, 234496
    s_add_u32 s69, s69, s55
    s_add_u32 s73, s73, s54
    s_add_u32 s57, s57, 27648
    buffer_load_dwordx4 v11, s[16:19], s57 offen offset:1024 lds
    s_waitcnt vmcnt(10)
    ds_read_b64_tr_b16 a[64:65], v4 offset:0
    ds_read_b64_tr_b16 a[66:67], v4 offset:512
    ds_read_b64_tr_b16 a[68:69], v5 offset:0
    ds_read_b64_tr_b16 a[70:71], v5 offset:512
    s_add_u32 s57, s57, 27648
    buffer_load_dwordx4 v10, s[16:19], s57 offen offset:2048 lds
    ds_read_b64_tr_b16 a[72:73], v4 offset:256
    ds_read_b64_tr_b16 a[74:75], v4 offset:768
    ds_read_b64_tr_b16 a[76:77], v5 offset:256
    ds_read_b64_tr_b16 a[78:79], v5 offset:768
    s_add_u32 s57, s57, 27648
    buffer_load_dwordx4 v11, s[16:19], s57 offen offset:3072 lds
    s_mov_b32 s76, 0
    s_add_u32 s77, s76, 2048
    s_cmp_eq_u32 s77, 14336
    s_cselect_b32 s77, 0, s77
    s_add_u32 s78, s77, 2048
    s_cmp_eq_u32 s78, 14336
    s_cselect_b32 s78, 0, s78
    s_add_u32 s79, s78, 2048
    s_cmp_eq_u32 s79, 14336
    s_cselect_b32 s79, 0, s79
    s_add_u32 s80, s79, 2048
    s_cmp_eq_u32 s80, 14336
    s_cselect_b32 s80, 0, s80
    s_add_u32 s81, s80, 2048
    s_cmp_eq_u32 s81, 14336
    s_cselect_b32 s81, 0, s81
    s_add_u32 s82, s81, 2048
    s_cmp_eq_u32 s82, 14336
    s_cselect_b32 s82, 0, s82
    s_add_u32 m0, s52, 65536
    s_add_u32 s57, s65, 8
    s_sub_u32 s3, s57, 16
    s_min_u32 s57, s57, s3
    s_mul_i32 s57, s57, 114688
    buffer_load_dwordx4 v10, s[16:19], s57 offen offset:0 lds
    s_cmp_lt_u32 s89, 4
    s_cselect_b32 s75, s54, 2130706432
    s_cselect_b32 s68, s68, 2130706432
    s_cselect_b32 s73, s73, 2130706432
    s_add_u32 s57, s57, 27648
    buffer_load_dwordx4 v11, s[16:19], s57 offen offset:1024 lds
    s_waitcnt vmcnt(10)
    ds_read_b64_tr_b16 a[80:81], v4 offset:16384
    ds_read_b64_tr_b16 a[82:83], v4 offset:16896
    ds_read_b64_tr_b16 a[84:85], v5 offset:16384
    ds_read_b64_tr_b16 a[86:87], v5 offset:16896
    s_add_u32 s57, s57, 27648
    buffer_load_dwordx4 v10, s[16:19], s57 offen offset:2048 lds
    ds_read_b64_tr_b16 a[88:89], v4 offset:16640
    ds_read_b64_tr_b16 a[90:91], v4 offset:17152
    ds_read_b64_tr_b16 a[92:93], v5 offset:16640
    ds_read_b64_tr_b16 a[94:95], v5 offset:17152
    v_lshlrev_b32 v16, 3, v1
    v_add_u32 v16, 81920, v16
    v_and_b32 v217, 7, v1
    v_min_u32 v218, 6, v217
    s_add_u32 s57, s57, 27648
    buffer_load_dwordx4 v11, s[16:19], s57 offen offset:3072 lds
    s_mul_i32 s54, s44, 7
    v_add_u32 v218, s54, v218
    v_mul_u32_u24 v219, 2, v218
    v_add_u32 v219, s89, v219
    s_waitcnt lgkmcnt(15)
    s_add_u32 m0, s52, 81920
    s_add_u32 s57, s65, 9
    s_sub_u32 s3, s57, 16
    s_min_u32 s57, s57, s3
    s_mul_i32 s57, s57, 114688
    buffer_load_dwordx4 v10, s[16:19], s57 offen offset:0 lds
    v_mul_u32_u24 v220, 43, v219
    v_lshrrev_b32 v220, 8, v220
    v_mul_u32_u24 v220, 6, v220
    v_sub_u32 v219, v219, v220
    s_add_u32 s57, s57, 27648
    buffer_load_dwordx4 v11, s[16:19], s57 offen offset:1024 lds
    s_waitcnt vmcnt(10)
    ds_read_b64_tr_b16 a[96:97], v4 offset:32768
    ds_read_b64_tr_b16 a[98:99], v4 offset:33280
    ds_read_b64_tr_b16 a[100:101], v5 offset:32768
    ds_read_b64_tr_b16 a[102:103], v5 offset:33280
    v_subrev_u32 v219, s49, v219
    v_bfe_u32 v220, v1, 3, 1
    v_mul_i32_i24 v219, v219, v220
    v_add_u32 v219, s49, v219
    ds_read_b64_tr_b16 a[104:105], v4 offset:33024
    ds_read_b64_tr_b16 a[106:107], v4 offset:33536
    ds_read_b64_tr_b16 a[108:109], v5 offset:33024
    ds_read_b64_tr_b16 a[110:111], v5 offset:33536
    s_add_u32 s57, s57, 27648
    buffer_load_dwordx4 v10, s[16:19], s57 offen offset:2048 lds
    v_lshl_add_u32 v218, v219, 5, v218
    v_lshlrev_b32 v20, 7, v218
    v_add_u32 v20, 12713984, v20
    s_lshr_b32 s53, s48, 1
    s_add_u32 s57, s57, 27648
    buffer_load_dwordx4 v11, s[16:19], s57 offen offset:3072 lds
    s_lshl_b32 s53, s53, 7
    s_add_u32 s53, s53, 12779520
    v_lshl_add_u32 v21, v210, 11, s53
    s_lshl_b32 s70, s48, 16
    s_add_u32 m0, s52, 98304
    s_add_u32 s57, s65, 10
    s_sub_u32 s3, s57, 16
    s_min_u32 s57, s57, s3
    s_mul_i32 s57, s57, 114688
    buffer_load_dwordx4 v10, s[16:19], s57 offen offset:0 lds
    s_lshl2_add_u32 s70, s52, s70
    s_add_u32 s70, s70, 4194304
    v_lshrrev_b32 v218, 3, v1
    v_mul_u32_u24 v22, 896, v218
    v_lshl_add_u32 v22, v217, 4, v22
    v_lshlrev_b32 v25, 1, v211
    s_add_u32 s53, s52, 65536
    v_mul_u32_u24 v244, 176, v218
    s_add_u32 s57, s57, 27648
    buffer_load_dwordx4 v11, s[16:19], s57 offen offset:1024 lds
    s_waitcnt vmcnt(10)
    ds_read_b64_tr_b16 a[112:113], v2 offset:0
    ds_read_b64_tr_b16 a[114:115], v2 offset:512
    ds_read_b64_tr_b16 a[116:117], v3 offset:0
    ds_read_b64_tr_b16 a[118:119], v3 offset:512
    s_add_u32 s57, s57, 27648
    buffer_load_dwordx4 v10, s[16:19], s57 offen offset:2048 lds
    ds_read_b64_tr_b16 a[120:121], v2 offset:256
    ds_read_b64_tr_b16 a[122:123], v2 offset:768
    ds_read_b64_tr_b16 a[124:125], v3 offset:256
    ds_read_b64_tr_b16 a[126:127], v3 offset:768
    s_add_u32 s57, s57, 27648
    buffer_load_dwordx4 v11, s[16:19], s57 offen offset:3072 lds
    v_lshl_add_u32 v244, v217, 4, v244
    v_add_u32 v244, s53, v244
    v_mul_u32_u24 v238, 176, v211
    v_lshl_add_u32 v238, v208, 3, v238
    v_add_u32 v238, s53, v238
    v_lshrrev_b32 v218, 2, v0
    v_mul_u32_u24 v26, 896, v218
    v_lshl_add_u32 v26, v210, 3, v26
    s_waitcnt lgkmcnt(15)
    s_add_u32 m0, s52, 114688
    s_add_u32 s57, s65, 11
    s_sub_u32 s3, s57, 16
    s_min_u32 s57, s57, s3
    s_mul_i32 s57, s57, 114688
    buffer_load_dwordx4 v10, s[16:19], s57 offen offset:0 lds
    v_lshrrev_b32 v218, 2, v1
    v_mul_u32_u24 v252, 176, v218
    v_lshl_add_u32 v252, v210, 3, v252
    v_add_u32 v252, s53, v252
    s_add_u32 s57, s57, 27648
    buffer_load_dwordx4 v11, s[16:19], s57 offen offset:1024 lds
    s_waitcnt vmcnt(10)
    ds_read_b64_tr_b16 a[128:129], v2 offset:16384
    ds_read_b64_tr_b16 a[130:131], v2 offset:16896
    ds_read_b64_tr_b16 a[132:133], v3 offset:16384
    ds_read_b64_tr_b16 a[134:135], v3 offset:16896
    s_add_u32 s57, s57, 27648
    buffer_load_dwordx4 v10, s[16:19], s57 offen offset:2048 lds
    ds_read_b64_tr_b16 a[136:137], v2 offset:16640
    ds_read_b64_tr_b16 a[138:139], v2 offset:17152
    ds_read_b64_tr_b16 a[140:141], v3 offset:16640
    ds_read_b64_tr_b16 a[142:143], v3 offset:17152
    s_sub_u32 s53, 49152, s52
    v_add_u32 v246, s53, v2
    v_add_u32 v247, s53, v3
    v_mul_u32_u24 v218, 3072, v208
    s_add_u32 s57, s57, 27648
    buffer_load_dwordx4 v11, s[16:19], s57 offen offset:3072 lds
    v_add_u32 v248, v218, v246
    v_add_u32 v249, v218, v247
    v_add_u32 v232, s52, v23
    v_xor_b32 v233, 4096, v232
    s_add_u32 m0, s52, 131072
    s_add_u32 s57, s65, 12
    s_sub_u32 s3, s57, 16
    s_min_u32 s57, s57, s3
    s_mul_i32 s57, s57, 114688
    buffer_load_dwordx4 v10, s[16:19], s57 offen offset:0 lds
    v_xor_b32 v234, 8192, v232
    v_xor_b32 v235, 12288, v232
    v_lshlrev_b32 v32, 16, v224
    v_and_b32 v33, s61, v224
    v_lshlrev_b32 v34, 16, v225
    v_and_b32 v35, s61, v225
    s_add_u32 s57, s57, 27648
    buffer_load_dwordx4 v11, s[16:19], s57 offen offset:1024 lds
    s_waitcnt vmcnt(10)
    ds_read_b64_tr_b16 a[144:145], v2 offset:32768
    ds_read_b64_tr_b16 a[146:147], v2 offset:33280
    ds_read_b64_tr_b16 a[148:149], v3 offset:32768
    ds_read_b64_tr_b16 a[150:151], v3 offset:33280
    s_add_u32 s57, s57, 27648
    buffer_load_dwordx4 v10, s[16:19], s57 offen offset:2048 lds
    ds_read_b64_tr_b16 a[152:153], v2 offset:33024
    ds_read_b64_tr_b16 a[154:155], v2 offset:33536
    ds_read_b64_tr_b16 a[156:157], v3 offset:33024
    ds_read_b64_tr_b16 a[158:159], v3 offset:33536
    s_add_u32 s57, s57, 27648
    buffer_load_dwordx4 v11, s[16:19], s57 offen offset:3072 lds
    v_lshlrev_b32 v36, 16, v226
    v_and_b32 v37, s61, v226
    v_lshlrev_b32 v38, 16, v227
    v_and_b32 v39, s61, v227
    v_lshlrev_b32 v40, 16, v228
    v_and_b32 v41, s61, v228
    v_lshlrev_b32 v42, 16, v229
    v_and_b32 v43, s61, v229
    buffer_load_dword v17, v18, s[24:27], 0 offen sc1
    v_lshlrev_b32 v44, 16, v230
    v_and_b32 v45, s61, v230
    v_lshlrev_b32 v46, 16, v231
    v_and_b32 v47, s61, v231
    v_mul_f32 v96, s85, v32
    v_mul_f32 v97, s85, v33
    v_mul_f32 v98, s85, v34
    v_mul_f32 v99, s85, v35
    s_waitcnt lgkmcnt(15)
    s_add_u32 m0, s52, 147456
    s_add_u32 s57, s65, 13
    s_sub_u32 s3, s57, 16
    s_min_u32 s57, s57, s3
    s_mul_i32 s57, s57, 114688
    buffer_load_dwordx4 v10, s[16:19], s57 offen offset:0 lds
    s_waitcnt vmcnt(10)
    ds_read_b64_tr_b16 a[160:161], v2 offset:49152
    ds_read_b64_tr_b16 a[162:163], v2 offset:49664
    ds_read_b64_tr_b16 a[164:165], v3 offset:49152
    ds_read_b64_tr_b16 a[166:167], v3 offset:49664
    v_mul_f32 v100, s85, v36
    v_mul_f32 v101, s85, v37
    v_mul_f32 v102, s85, v38
    v_mul_f32 v103, s85, v39
    ds_read_b64_tr_b16 a[168:169], v2 offset:49408
    ds_read_b64_tr_b16 a[170:171], v2 offset:49920
    ds_read_b64_tr_b16 a[172:173], v3 offset:49408
    ds_read_b64_tr_b16 a[174:175], v3 offset:49920
    s_add_u32 s57, s57, 27648
    buffer_load_dwordx4 v11, s[16:19], s57 offen offset:1024 lds
    v_mul_f32 v104, s85, v40
    v_mul_f32 v105, s85, v41
    v_mul_f32 v106, s85, v42
    v_mul_f32 v107, s85, v43
    s_add_u32 s57, s57, 27648
    buffer_load_dwordx4 v10, s[16:19], s57 offen offset:2048 lds
    v_mul_f32 v108, s85, v44
    v_mul_f32 v109, s85, v45
    v_mul_f32 v110, s85, v46
    v_mul_f32 v111, s85, v47
    s_add_u32 s57, s57, 27648
    buffer_load_dwordx4 v11, s[16:19], s57 offen offset:3072 lds
    s_add_u32 m0, s52, 49152
    s_add_u32 s57, s65, 14
    s_sub_u32 s3, s57, 16
    s_min_u32 s57, s57, s3
    s_mul_i32 s57, s57, 114688
    buffer_load_dwordx4 v10, s[16:19], s57 offen offset:0 lds
    s_waitcnt vmcnt(10)
    ds_read_b64_tr_b16 a[176:177], v4 offset:0
    ds_read_b64_tr_b16 a[178:179], v4 offset:512
    ds_read_b64_tr_b16 a[180:181], v5 offset:0
    ds_read_b64_tr_b16 a[182:183], v5 offset:512
    s_add_u32 s57, s57, 27648
    buffer_load_dwordx4 v11, s[16:19], s57 offen offset:1024 lds
    ds_read_b64_tr_b16 a[184:185], v4 offset:256
    ds_read_b64_tr_b16 a[186:187], v4 offset:768
    ds_read_b64_tr_b16 a[188:189], v5 offset:256
    ds_read_b64_tr_b16 a[190:191], v5 offset:768
    s_add_u32 s57, s57, 27648
    buffer_load_dwordx4 v10, s[16:19], s57 offen offset:2048 lds
    s_add_u32 s57, s57, 27648
    buffer_load_dwordx4 v11, s[16:19], s57 offen offset:3072 lds
    s_waitcnt lgkmcnt(15)
    s_add_u32 m0, s52, 65536
    s_add_u32 s57, s65, 15
    s_sub_u32 s3, s57, 16
    s_min_u32 s57, s57, s3
    s_mul_i32 s57, s57, 114688
    buffer_load_dwordx4 v10, s[16:19], s57 offen offset:0 lds
    s_waitcnt vmcnt(10)
    ds_read_b64_tr_b16 a[192:193], v4 offset:16384
    ds_read_b64_tr_b16 a[194:195], v4 offset:16896
    ds_read_b64_tr_b16 a[196:197], v5 offset:16384
    ds_read_b64_tr_b16 a[198:199], v5 offset:16896
    s_add_u32 s57, s57, 27648
    buffer_load_dwordx4 v11, s[16:19], s57 offen offset:1024 lds
    ds_read_b64_tr_b16 a[200:201], v4 offset:16640
    ds_read_b64_tr_b16 a[202:203], v4 offset:17152
    ds_read_b64_tr_b16 a[204:205], v5 offset:16640
    ds_read_b64_tr_b16 a[206:207], v5 offset:17152
    s_add_u32 s57, s57, 27648
    buffer_load_dwordx4 v10, s[16:19], s57 offen offset:2048 lds
    s_waitcnt vmcnt(11)
    v_cmp_ne_u32 vcc, s47, v17
    s_nop 0
    s_cbranch_vccz L_ok5
    s_mov_b32 s59, 100000
L_spin4:
    buffer_load_dword v17, v18, s[24:27], 0 offen sc1
    s_waitcnt vmcnt(0)
    v_cmp_ne_u32 vcc, s47, v17
    s_nop 0
    s_cbranch_vccz L_ok5
    s_sub_u32 s59, s59, 1
    s_cbranch_scc0 L_spin4
L_ok5:
    s_cmp_ge_u32 s88, 4
    s_cbranch_scc1 L_p2_alt
    s_add_u32 s57, s57, 27648
    buffer_load_dwordx4 v11, s[16:19], s57 offen offset:3072 lds
    s_mov_b32 s66, s84
    s_lshl_b32 s86, s65, 10
    s_add_u32 s58, s86, s66
    s_add_u32 s86, s66, 16384
    buffer_load_dwordx4 v[112:115], v23, s[24:27], s58 offen offset:0 sc1
    s_add_u32 s58, s58, 1024
    s_cmp_eq_u32 s58, s86
    s_cselect_b32 s58, s66, s58
    buffer_load_dwordx4 v[116:119], v23, s[24:27], s58 offen offset:0 sc1
    s_waitcnt vmcnt(10)
    ds_read_b64_tr_b16 a[208:209], v4 offset:32768
    ds_read_b64_tr_b16 a[210:211], v4 offset:33280
    ds_read_b64_tr_b16 a[212:213], v5 offset:32768
    ds_read_b64_tr_b16 a[214:215], v5 offset:33280
    s_add_u32 s58, s58, 1024
    s_cmp_eq_u32 s58, s86
    s_cselect_b32 s58, s66, s58
    buffer_load_dwordx4 v[120:123], v23, s[24:27], s58 offen offset:0 sc1
    ds_read_b64_tr_b16 a[216:217], v4 offset:33024
    ds_read_b64_tr_b16 a[218:219], v4 offset:33536
    ds_read_b64_tr_b16 a[220:221], v5 offset:33024
    ds_read_b64_tr_b16 a[222:223], v5 offset:33536
    s_add_u32 s58, s58, 1024
    s_cmp_eq_u32 s58, s86
    s_cselect_b32 s58, s66, s58
    buffer_load_dwordx4 v[124:127], v23, s[24:27], s58 offen offset:0 sc1
    s_add_u32 s58, s58, 1024
    s_cmp_eq_u32 s58, s86
    s_cselect_b32 s58, s66, s58
    buffer_load_dwordx4 v[128:131], v23, s[24:27], s58 offen offset:0 sc1
    s_add_u32 s58, s58, 1024
    s_cmp_eq_u32 s58, s86
    s_cselect_b32 s58, s66, s58
    buffer_load_dwordx4 v[132:135], v23, s[24:27], s58 offen offset:0 sc1
    s_waitcnt vmcnt(10)
    ds_read_b64_tr_b16 a[224:225], v2 offset:0
    ds_read_b64_tr_b16 a[226:227], v2 offset:512
    ds_read_b64_tr_b16 a[228:229], v3 offset:0
    ds_read_b64_tr_b16 a[230:231], v3 offset:512
    s_add_u32 s58, s58, 1024
    s_cmp_eq_u32 s58, s86
    s_cselect_b32 s58, s66, s58
    buffer_load_dwordx4 v[136:139], v23, s[24:27], s58 offen offset:0 sc1
    ds_read_b64_tr_b16 a[232:233], v2 offset:256
    ds_read_b64_tr_b16 a[234:235], v2 offset:768
    ds_read_b64_tr_b16 a[236:237], v3 offset:256
    ds_read_b64_tr_b16 a[238:239], v3 offset:768
    s_add_u32 s58, s58, 1024
    s_cmp_eq_u32 s58, s86
    s_cselect_b32 s58, s66, s58
    buffer_load_dwordx4 v[140:143], v23, s[24:27], s58 offen offset:0 sc1
    s_add_u32 s58, s58, 1024
    s_cmp_eq_u32 s58, s86
    s_cselect_b32 s58, s66, s58
    buffer_load_dwordx4 v[144:147], v23, s[24:27], s58 offen offset:0 sc1
    s_add_u32 s58, s58, 1024
    s_cmp_eq_u32 s58, s86
    s_cselect_b32 s58, s66, s58
    buffer_load_dwordx4 v[148:151], v23, s[24:27], s58 offen offset:0 sc1
    s_waitcnt vmcnt(10)
    ds_read_b64_tr_b16 a[240:241], v2 offset:16384
    ds_read_b64_tr_b16 a[242:243], v2 offset:16896
    ds_read_b64_tr_b16 a[244:245], v3 offset:16384
    ds_read_b64_tr_b16 a[246:247], v3 offset:16896
    s_add_u32 s58, s58, 1024
    s_cmp_eq_u32 s58, s86
    s_cselect_b32 s58, s66, s58
    buffer_load_dwordx4 v[152:155], v23, s[24:27], s58 offen offset:0 sc1
    ds_read_b64_tr_b16 a[248:249], v2 offset:16640
    ds_read_b64_tr_b16 a[250:251], v2 offset:17152
    ds_read_b64_tr_b16 a[252:253], v3 offset:16640
    ds_read_b64_tr_b16 a[254:255], v3 offset:17152
    s_waitcnt vmcnt(10)
    v_mfma_f32_16x16x32_bf16 v[96:99], a[0:3], v[112:115], v[96:99]
    s_add_u32 s58, s58, 1024
    s_cmp_eq_u32 s58, s86
    s_cselect_b32 s58, s66, s58
    v_mfma_f32_16x16x32_bf16 v[100:103], a[4:7], v[112:115], v[100:103]
    buffer_load_dwordx4 v[156:159], v23, s[24:27], s58 offen offset:0 sc1
    v_mfma_f32_16x16x32_bf16 v[104:107], a[8:11], v[112:115], v[104:107]
    v_mfma_f32_16x16x32_bf16 v[108:111], a[12:15], v[112:115], v[108:111]
    s_waitcnt vmcnt(10)
    v_mfma_f32_16x16x32_bf16 v[96:99], a[16:19], v[116:119], v[96:99]
    s_add_u32 s58, s58, 1024
    s_cmp_eq_u32 s58, s86
    s_cselect_b32 s58, s66, s58
    v_mfma_f32_16x16x32_bf16 v[100:103], a[20:23], v[116:119], v[100:103]
    buffer_load_dwordx4 v[112:115], v23, s[24:27], s58 offen offset:0 sc1
    v_mfma_f32_16x16x32_bf16 v[104:107], a[24:27], v[116:119], v[104:107]
    v_mfma_f32_16x16x32_bf16 v[108:111], a[28:31], v[116:119], v[108:111]
    s_waitcnt vmcnt(10)
    v_mfma_f32_16x16x32_bf16 v[96:99], a[32:35], v[120:123], v[96:99]
    s_add_u32 s58, s58, 1024
    s_cmp_eq_u32 s58, s86
    s_cselect_b32 s58, s66, s58
    v_mfma_f32_16x16x32_bf16 v[100:103], a[36:39], v[120:123], v[100:103]
    buffer_load_dwordx4 v[116:119], v23, s[24:27], s58 offen offset:0 sc1
    v_mfma_f32_16x16x32_bf16 v[104:107], a[40:43], v[120:123], v[104:107]
    v_mfma_f32_16x16x32_bf16 v[108:111], a[44:47], v[120:123], v[108:111]
    s_waitcnt vmcnt(10)
    v_mfma_f32_16x16x32_bf16 v[96:99], a[48:51], v[124:127], v[96:99]
    s_add_u32 s58, s58, 1024
    s_cmp_eq_u32 s58, s86
    s_cselect_b32 s58, s66, s58
    v_mfma_f32_16x16x32_bf16 v[100:103], a[52:55], v[124:127], v[100:103]
    buffer_load_dwordx4 v[120:123], v23, s[24:27], s58 offen offset:0 sc1
    v_mfma_f32_16x16x32_bf16 v[104:107], a[56:59], v[124:127], v[104:107]
    v_mfma_f32_16x16x32_bf16 v[108:111], a[60:63], v[124:127], v[108:111]
    s_waitcnt vmcnt(10)
L_wb_0:
    s_cbranch_execz L_wb_ret
    v_mfma_f32_16x16x32_bf16 v[96:99], a[64:67], v[128:131], v[96:99]
    s_add_u32 s58, s58, 1024
    s_cmp_eq_u32 s58, s86
    s_cselect_b32 s58, s66, s58
    v_mfma_f32_16x16x32_bf16 v[100:103], a[68:71], v[128:131], v[100:103]
    buffer_load_dwordx4 v[124:127], v23, s[24:27], s58 offen offset:0 sc1
    v_mfma_f32_16x16x32_bf16 v[104:107], a[72:75], v[128:131], v[104:107]
    v_mfma_f32_16x16x32_bf16 v[108:111], a[76:79], v[128:131], v[108:111]
    s_waitcnt vmcnt(10)
    v_mfma_f32_16x16x32_bf16 v[96:99], a[80:83], v[132:135], v[96:99]
    s_xor_b32 s66, s44, 3
    s_lshl2_add_u32 s66, s51, s66
    s_mul_i32 s66, s66, 66816
    s_lshl2_add_u32 s66, s52, s66
    s_lshl_b32 s86, s65, 10
    s_add_u32 s58, s86, s66
    s_add_u32 s86, s66, 16384
    v_mfma_f32_16x16x32_bf16 v[100:103], a[84:87], v[132:135], v[100:103]
    buffer_load_dwordx4 v[128:131], v23, s[24:27], s58 offen offset:0 sc1
    v_mfma_f32_16x16x32_bf16 v[104:107], a[88:91], v[132:135], v[104:107]
    v_mfma_f32_16x16x32_bf16 v[108:111], a[92:95], v[132:135], v[108:111]
    s_waitcnt vmcnt(10)
    v_mfma_f32_16x16x32_bf16 v[96:99], a[96:99], v[136:139], v[96:99]
    s_add_u32 s58, s58, 1024
    s_cmp_eq_u32 s58, s86
    s_cselect_b32 s58, s66, s58
    v_mfma_f32_16x16x32_bf16 v[100:103], a[100:103], v[136:139], v[100:103]
    buffer_load_dwordx4 v[132:135], v23, s[24:27], s58 offen offset:0 sc1
    v_mfma_f32_16x16x32_bf16 v[104:107], a[104:107], v[136:139], v[104:107]
    v_mfma_f32_16x16x32_bf16 v[108:111], a[108:111], v[136:139], v[108:111]
    s_waitcnt vmcnt(10)
    v_mfma_f32_16x16x32_bf16 v[96:99], a[112:115], v[140:143], v[96:99]
    s_add_u32 s58, s58, 1024
    s_cmp_eq_u32 s58, s86
    s_cselect_b32 s58, s66, s58
    v_mfma_f32_16x16x32_bf16 v[100:103], a[116:119], v[140:143], v[100:103]
    buffer_load_dwordx4 v[136:139], v23, s[24:27], s58 offen offset:0 sc1
    v_mfma_f32_16x16x32_bf16 v[104:107], a[120:123], v[140:143], v[104:107]
    v_mfma_f32_16x16x32_bf16 v[108:111], a[124:127], v[140:143], v[108:111]
    s_waitcnt vmcnt(10)
    v_mfma_f32_16x16x32_bf16 v[96:99], a[128:131], v[144:147], v[96:99]
    s_add_u32 s58, s58, 1024
    s_cmp_eq_u32 s58, s86
    s_cselect_b32 s58, s66, s58
    v_mfma_f32_16x16x32_bf16 v[100:103], a[132:135], v[144:147], v[100:103]
    buffer_load_dwordx4 v[140:143], v23, s[24:27], s58 offen offset:0 sc1
    v_mfma_f32_16x16x32_bf16 v[104:107], a[136:139], v[144:147], v[104:107]
    v_mfma_f32_16x16x32_bf16 v[108:111], a[140:143], v[144:147], v[108:111]
    s_waitcnt vmcnt(10)
    v_mfma_f32_16x16x32_bf16 v[96:99], a[144:147], v[148:151], v[96:99]
    s_add_u32 s58, s58, 1024
    s_cmp_eq_u32 s58, s86
    s_cselect_b32 s58, s66, s58
    v_mfma_f32_16x16x32_bf16 v[100:103], a[148:151], v[148:151], v[100:103]
    buffer_load_dwordx4 v[144:147], v23, s[24:27], s58 offen offset:0 sc1
    v_mfma_f32_16x16x32_bf16 v[104:107], a[152:155], v[148:151], v[104:107]
    v_mfma_f32_16x16x32_bf16 v[108:111], a[156:159], v[148:151], v[108:111]
    s_waitcnt vmcnt(10)
    s_waitcnt lgkmcnt(15)
    v_mfma_f32_16x16x32_bf16 v[96:99], a[160:163], v[152:155], v[96:99]
    s_add_u32 s58, s58, 1024
    s_cmp_eq_u32 s58, s86
    s_cselect_b32 s58, s66, s58
    v_mfma_f32_16x16x32_bf16 v[100:103], a[164:167], v[152:155], v[100:103]
    buffer_load_dwordx4 v[148:151], v23, s[24:27], s58 offen offset:0 sc1
    v_mfma_f32_16x16x32_bf16 v[104:107], a[168:171], v[152:155], v[104:107]
    v_mfma_f32_16x16x32_bf16 v[108:111], a[172:175], v[152:155], v[108:111]
    s_waitcnt vmcnt(10)
    v_mfma_f32_16x16x32_bf16 v[96:99], a[176:179], v[156:159], v[96:99]
    s_add_u32 s58, s58, 1024
    s_cmp_eq_u32 s58, s86
    s_cselect_b32 s58, s66, s58
    v_mfma_f32_16x16x32_bf16 v[100:103], a[180:183], v[156:159], v[100:103]
    buffer_load_dwordx4 v[152:155], v23, s[24:27], s58 offen offset:0 sc1
    v_mfma_f32_16x16x32_bf16 v[104:107], a[184:187], v[156:159], v[104:107]
    v_mfma_f32_16x16x32_bf16 v[108:111], a[188:191], v[156:159], v[108:111]
    s_waitcnt vmcnt(10)
    v_mfma_f32_16x16x32_bf16 v[96:99], a[192:195], v[112:115], v[96:99]
    s_add_u32 s58, s58, 1024
    s_cmp_eq_u32 s58, s86
    s_cselect_b32 s58, s66, s58
    v_mfma_f32_16x16x32_bf16 v[100:103], a[196:199], v[112:115], v[100:103]
    buffer_load_dwordx4 v[156:159], v23, s[24:27], s58 offen offset:0 sc1
    v_mfma_f32_16x16x32_bf16 v[104:107], a[200:203], v[112:115], v[104:107]
    v_mfma_f32_16x16x32_bf16 v[108:111], a[204:207], v[112:115], v[108:111]
    s_waitcnt vmcnt(10)
    v_mfma_f32_16x16x32_bf16 v[96:99], a[208:211], v[116:119], v[96:99]
    s_add_u32 s58, s58, 1024
    s_cmp_eq_u32 s58, s86
    s_cselect_b32 s58, s66, s58
    v_mfma_f32_16x16x32_bf16 v[100:103], a[212:215], v[116:119], v[100:103]
    buffer_load_dwordx4 v[112:115], v23, s[24:27], s58 offen offset:0 sc1
    v_mfma_f32_16x16x32_bf16 v[104:107], a[216:219], v[116:119], v[104:107]
    v_mfma_f32_16x16x32_bf16 v[108:111], a[220:223], v[116:119], v[108:111]
    s_waitcnt vmcnt(10)
    s_waitcnt lgkmcnt(8)
    v_mfma_f32_16x16x32_bf16 v[96:99], a[224:227], v[120:123], v[96:99]
    s_add_u32 s58, s58, 1024
    s_cmp_eq_u32 s58, s86
    s_cselect_b32 s58, s66, s58
    v_mfma_f32_16x16x32_bf16 v[100:103], a[228:231], v[120:123], v[100:103]
    buffer_load_dwordx4 v[116:119], v23, s[24:27], s58 offen offset:0 sc1
    v_mfma_f32_16x16x32_bf16 v[104:107], a[232:235], v[120:123], v[104:107]
    v_mfma_f32_16x16x32_bf16 v[108:111], a[236:239], v[120:123], v[108:111]
    s_waitcnt vmcnt(10)
    s_waitcnt lgkmcnt(0)
    v_mfma_f32_16x16x32_bf16 v[96:99], a[240:243], v[124:127], v[96:99]
    s_add_u32 s58, s58, 1024
    s_cmp_eq_u32 s58, s86
    s_cselect_b32 s58, s66, s58
    v_mfma_f32_16x16x32_bf16 v[100:103], a[244:247], v[124:127], v[100:103]
    buffer_load_dwordx4 v[120:123], v23, s[24:27], s58 offen offset:0 sc1
    v_mfma_f32_16x16x32_bf16 v[104:107], a[248:251], v[124:127], v[104:107]
    v_mfma_f32_16x16x32_bf16 v[108:111], a[252:255], v[124:127], v[108:111]
L_p2_join:
    s_waitcnt vmcnt(10)
    v_mfma_f32_16x16x32_bf16 v[80:83], a[0:3], v[128:131], 0
    s_add_u32 s58, s58, 1024
    s_cmp_eq_u32 s58, s86
    s_cselect_b32 s58, s66, s58
    v_mfma_f32_16x16x32_bf16 v[84:87], a[4:7], v[128:131], 0
    buffer_load_dwordx4 v[124:127], v23, s[24:27], s58 offen offset:0 sc1
    v_mfma_f32_16x16x32_bf16 v[88:91], a[8:11], v[128:131], 0
    v_mfma_f32_16x16x32_bf16 v[92:95], a[12:15], v[128:131], 0
    s_waitcnt vmcnt(10)
    v_mfma_f32_16x16x32_bf16 v[80:83], a[16:19], v[132:135], v[80:83]
    v_mfma_f32_16x16x32_bf16 v[84:87], a[20:23], v[132:135], v[84:87]
    buffer_load_dwordx4 v[216:219], v22, s[4:7], s71 offen
    v_mfma_f32_16x16x32_bf16 v[88:91], a[24:27], v[132:135], v[88:91]
    ds_write_b128 v232, v[96:99] offset:49152
    v_mfma_f32_16x16x32_bf16 v[92:95], a[28:31], v[132:135], v[92:95]
    s_waitcnt vmcnt(10)
    v_mfma_f32_16x16x32_bf16 v[80:83], a[32:35], v[136:139], v[80:83]
    s_add_u32 s58, s58, 1024
    s_cmp_eq_u32 s58, s86
    s_cselect_b32 s58, s66, s58
    v_mfma_f32_16x16x32_bf16 v[84:87], a[36:39], v[136:139], v[84:87]
    buffer_load_dwordx4 v[128:131], v23, s[24:27], s58 offen offset:0 sc1
    v_mfma_f32_16x16x32_bf16 v[88:91], a[40:43], v[136:139], v[88:91]
    ds_write_b128 v232, v[100:103] offset:50176
    v_mfma_f32_16x16x32_bf16 v[92:95], a[44:47], v[136:139], v[92:95]
    s_waitcnt vmcnt(10)
    v_mfma_f32_16x16x32_bf16 v[80:83], a[48:51], v[140:143], v[80:83]
    v_mfma_f32_16x16x32_bf16 v[84:87], a[52:55], v[140:143], v[84:87]
    buffer_load_dwordx4 v[220:223], v22, s[4:7], s72 offen
    v_mfma_f32_16x16x32_bf16 v[88:91], a[56:59], v[140:143], v[88:91]
    ds_write_b128 v232, v[104:107] offset:51200
    v_mfma_f32_16x16x32_bf16 v[92:95], a[60:63], v[140:143], v[92:95]
    s_waitcnt vmcnt(10)
    v_mfma_f32_16x16x32_bf16 v[80:83], a[64:67], v[144:147], v[80:83]
    s_add_u32 s58, s58, 1024
    s_cmp_eq_u32 s58, s86
    s_cselect_b32 s58, s66, s58
    v_mfma_f32_16x16x32_bf16 v[84:87], a[68:71], v[144:147], v[84:87]
    buffer_load_dwordx4 v[132:135], v23, s[24:27], s58 offen offset:0 sc1
    v_mfma_f32_16x16x32_bf16 v[88:91], a[72:75], v[144:147], v[88:91]
    ds_write_b128 v232, v[108:111] offset:52224
    v_mfma_f32_16x16x32_bf16 v[92:95], a[76:79], v[144:147], v[92:95]
    s_waitcnt vmcnt(10)
    v_mfma_f32_16x16x32_bf16 v[80:83], a[80:83], v[148:151], v[80:83]
    v_mfma_f32_16x16x32_bf16 v[84:87], a[84:87], v[148:151], v[84:87]
    buffer_load_dwordx2 v[224:225], v26, s[4:7], s73 offen
    v_mfma_f32_16x16x32_bf16 v[88:91], a[88:91], v[148:151], v[88:91]
    v_mfma_f32_16x16x32_bf16 v[92:95], a[92:95], v[148:151], v[92:95]
    s_waitcnt vmcnt(10)
    v_mfma_f32_16x16x32_bf16 v[80:83], a[96:99], v[152:155], v[80:83]
    s_add_u32 s58, s58, 1024
    s_cmp_eq_u32 s58, s86
    s_cselect_b32 s58, s66, s58
    v_mfma_f32_16x16x32_bf16 v[84:87], a[100:103], v[152:155], v[84:87]
    buffer_load_dwordx4 v[136:139], v23, s[24:27], s58 offen offset:0 sc1
    v_mfma_f32_16x16x32_bf16 v[88:91], a[104:107], v[152:155], v[88:91]
    v_mfma_f32_16x16x32_bf16 v[92:95], a[108:111], v[152:155], v[92:95]
    s_waitcnt vmcnt(10)
    v_mfma_f32_16x16x32_bf16 v[80:83], a[112:115], v[156:159], v[80:83]
    v_mfma_f32_16x16x32_bf16 v[84:87], a[116:119], v[156:159], v[84:87]
    buffer_load_ushort v228, v25, s[36:39], s74 offen
    v_mfma_f32_16x16x32_bf16 v[88:91], a[120:123], v[156:159], v[88:91]
    s_waitcnt lgkmcnt(0)
    s_barrier
    v_mfma_f32_16x16x32_bf16 v[92:95], a[124:127], v[156:159], v[92:95]
    s_waitcnt vmcnt(10)
    v_mfma_f32_16x16x32_bf16 v[80:83], a[128:131], v[112:115], v[80:83]
    s_add_u32 s58, s58, 1024
    s_cmp_eq_u32 s58, s86
    s_cselect_b32 s58, s66, s58
    v_mfma_f32_16x16x32_bf16 v[84:87], a[132:135], v[112:115], v[84:87]
    buffer_load_dwordx4 v[140:143], v23, s[24:27], s58 offen offset:0 sc1
    v_mfma_f32_16x16x32_bf16 v[88:91], a[136:139], v[112:115], v[88:91]
    ds_read_b128 v[160:163], v243 offset:0
    ds_read_b128 v[164:167], v243 offset:1024
    v_mfma_f32_16x16x32_bf16 v[92:95], a[140:143], v[112:115], v[92:95]
    ds_read_b128 v[168:171], v243 offset:4096
    s_waitcnt vmcnt(10)
    v_mfma_f32_16x16x32_bf16 v[80:83], a[144:147], v[116:119], v[80:83]
    s_xor_b32 s66, s44, 2
    s_lshl2_add_u32 s66, s51, s66
    s_mul_i32 s66, s66, 66816
    s_lshl2_add_u32 s66, s52, s66
    s_lshl_b32 s86, s65, 10
    s_add_u32 s58, s86, s66
    s_add_u32 s86, s66, 16384
    v_mfma_f32_16x16x32_bf16 v[84:87], a[148:151], v[116:119], v[84:87]
    buffer_load_dwordx4 v[144:147], v23, s[24:27], s58 offen offset:0 sc1
    v_mfma_f32_16x16x32_bf16 v[88:91], a[152:155], v[116:119], v[88:91]
    ds_read_b128 v[172:175], v243 offset:5120
    ds_read_b128 v[176:179], v243 offset:8192
    v_mfma_f32_16x16x32_bf16 v[92:95], a[156:159], v[116:119], v[92:95]
    ds_read_b128 v[180:183], v243 offset:9216
    s_waitcnt vmcnt(10)
    v_mfma_f32_16x16x32_bf16 v[80:83], a[160:163], v[120:123], v[80:83]
    s_add_u32 s58, s58, 1024
    s_cmp_eq_u32 s58, s86
    s_cselect_b32 s58, s66, s58
    v_mfma_f32_16x16x32_bf16 v[84:87], a[164:167], v[120:123], v[84:87]
    buffer_load_dwordx4 v[148:151], v23, s[24:27], s58 offen offset:0 sc1
    v_mfma_f32_16x16x32_bf16 v[88:91], a[168:171], v[120:123], v[88:91]
    ds_read_b128 v[184:187], v243 offset:12288
    v_mfma_f32_16x16x32_bf16 v[92:95], a[172:175], v[120:123], v[92:95]
    ds_read_b128 v[188:191], v243 offset:13312
    s_waitcnt vmcnt(10)
    v_mfma_f32_16x16x32_bf16 v[80:83], a[176:179], v[124:127], v[80:83]
    s_add_u32 s58, s58, 1024
    s_cmp_eq_u32 s58, s86
    s_cselect_b32 s58, s66, s58
    v_mfma_f32_16x16x32_bf16 v[84:87], a[180:183], v[124:127], v[84:87]
    buffer_load_dwordx4 v[152:155], v23, s[24:27], s58 offen offset:0 sc1
    v_mfma_f32_16x16x32_bf16 v[88:91], a[184:187], v[124:127], v[88:91]
    v_mfma_f32_16x16x32_bf16 v[92:95], a[188:191], v[124:127], v[92:95]
    s_add_u32 s58, s58, 1024
    s_cmp_eq_u32 s58, s86
    s_cselect_b32 s58, s66, s58
    buffer_load_dwordx4 v[156:159], v23, s[24:27], s58 offen offset:0 sc1
    s_waitcnt vmcnt(10)
    v_mfma_f32_16x16x32_bf16 v[80:83], a[192:195], v[128:131], v[80:83]
    s_add_u32 s58, s58, 1024
    s_cmp_eq_u32 s58, s86
    s_cselect_b32 s58, s66, s58
    v_mfma_f32_16x16x32_bf16 v[84:87], a[196:199], v[128:131], v[84:87]
    buffer_load_dwordx4 v[112:115], v23, s[24:27], s58 offen offset:0 sc1
    v_mfma_f32_16x16x32_bf16 v[88:91], a[200:203], v[128:131], v[88:91]
    s_waitcnt lgkmcnt(0)
    v_add_f32 v160, v160, v168
    v_mfma_f32_16x16x32_bf16 v[92:95], a[204:207], v[128:131], v[92:95]
    v_add_f32 v161, v161, v169
    s_add_u32 s58, s58, 1024
    s_cmp_eq_u32 s58, s86
    s_cselect_b32 s58, s66, s58
    buffer_load_dwordx4 v[116:119], v23, s[24:27], s58 offen offset:0 sc1
    s_waitcnt vmcnt(10)
    v_mfma_f32_16x16x32_bf16 v[80:83], a[208:211], v[132:135], v[80:83]
    s_add_u32 s58, s58, 1024
    s_cmp_eq_u32 s58, s86
    s_cselect_b32 s58, s66, s58
    v_mfma_f32_16x16x32_bf16 v[84:87], a[212:215], v[132:135], v[84:87]
    buffer_load_dwordx4 v[120:123], v23, s[24:27], s58 offen offset:0 sc1
    v_mfma_f32_16x16x32_bf16 v[88:91], a[216:219], v[132:135], v[88:91]
    v_add_f32 v162, v162, v170
    v_add_f32 v163, v163, v171
    v_mfma_f32_16x16x32_bf16 v[92:95], a[220:223], v[132:135], v[92:95]
    v_add_f32 v164, v164, v172
    s_add_u32 s58, s58, 1024
    s_cmp_eq_u32 s58, s86
    s_cselect_b32 s58, s66, s58
    buffer_load_dwordx4 v[124:127], v23, s[24:27], s58 offen offset:0 sc1
    s_waitcnt vmcnt(10)
    v_mfma_f32_16x16x32_bf16 v[80:83], a[224:227], v[136:139], v[80:83]
    s_add_u32 s58, s58, 1024
    s_cmp_eq_u32 s58, s86
    s_cselect_b32 s58, s66, s58
    v_mfma_f32_16x16x32_bf16 v[84:87], a[228:231], v[136:139], v[84:87]
    buffer_load_dwordx4 v[128:131], v23, s[24:27], s58 offen offset:0 sc1
    v_mfma_f32_16x16x32_bf16 v[88:91], a[232:235], v[136:139], v[88:91]
    v_add_f32 v165, v165, v173
    v_add_f32 v166, v166, v174
    v_mfma_f32_16x16x32_bf16 v[92:95], a[236:239], v[136:139], v[92:95]
    v_add_f32 v167, v167, v175
    s_add_u32 s58, s58, 1024
    s_cmp_eq_u32 s58, s86
    s_cselect_b32 s58, s66, s58
    buffer_load_dwordx4 v[132:135], v23, s[24:27], s58 offen offset:0 sc1
    s_waitcnt vmcnt(10)
    v_mfma_f32_16x16x32_bf16 v[80:83], a[240:243], v[140:143], v[80:83]
    s_add_u32 s58, s58, 1024
    s_cmp_eq_u32 s58, s86
    s_cselect_b32 s58, s66, s58
    v_mfma_f32_16x16x32_bf16 v[84:87], a[244:247], v[140:143], v[84:87]
    buffer_load_dwordx4 v[136:139], v23, s[24:27], s58 offen offset:0 sc1
    v_mfma_f32_16x16x32_bf16 v[88:91], a[248:251], v[140:143], v[88:91]
    v_add_f32 v160, v160, v176
    v_add_f32 v161, v161, v177
    v_mfma_f32_16x16x32_bf16 v[92:95], a[252:255], v[140:143], v[92:95]
    v_add_f32 v162, v162, v178
    s_waitcnt vmcnt(10)
    v_mfma_f32_16x16x32_bf16 v[64:67], a[0:3], v[144:147], 0
    s_add_u32 s58, s58, 1024
    s_cmp_eq_u32 s58, s86
    s_cselect_b32 s58, s66, s58
    v_mfma_f32_16x16x32_bf16 v[68:71], a[4:7], v[144:147], 0
    buffer_load_dwordx4 v[140:143], v23, s[24:27], s58 offen offset:0 sc1
    v_mfma_f32_16x16x32_bf16 v[72:75], a[8:11], v[144:147], 0
    v_mfma_f32_16x16x32_bf16 v[76:79], a[12:15], v[144:147], 0
    s_waitcnt vmcnt(10)
    v_mfma_f32_16x16x32_bf16 v[64:67], a[16:19], v[148:151], v[64:67]
    s_add_u32 s58, s58, 1024
    s_cmp_eq_u32 s58, s86
    s_cselect_b32 s58, s66, s58
    v_mfma_f32_16x16x32_bf16 v[68:71], a[20:23], v[148:151], v[68:71]
    buffer_load_dwordx4 v[144:147], v23, s[24:27], s58 offen offset:0 sc1
    v_mfma_f32_16x16x32_bf16 v[72:75], a[24:27], v[148:151], v[72:75]
    ds_write_b128 v232, v[80:83] offset:32768
    v_mfma_f32_16x16x32_bf16 v[76:79], a[28:31], v[148:151], v[76:79]
    s_waitcnt vmcnt(10)
    v_mfma_f32_16x16x32_bf16 v[64:67], a[32:35], v[152:155], v[64:67]
    s_add_u32 s58, s58, 1024
    s_cmp_eq_u32 s58, s86
    s_cselect_b32 s58, s66, s58
    v_mfma_f32_16x16x32_bf16 v[68:71], a[36:39], v[152:155], v[68:71]
    buffer_load_dwordx4 v[148:151], v23, s[24:27], s58 offen offset:0 sc1
    v_mfma_f32_16x16x32_bf16 v[72:75], a[40:43], v[152:155], v[72:75]
    ds_write_b128 v232, v[84:87] offset:33792
    v_mfma_f32_16x16x32_bf16 v[76:79], a[44:47], v[152:155], v[76:79]
    s_waitcnt vmcnt(10)
    v_mfma_f32_16x16x32_bf16 v[64:67], a[48:51], v[156:159], v[64:67]
    s_add_u32 s58, s58, 1024
    s_cmp_eq_u32 s58, s86
    s_cselect_b32 s58, s66, s58
    ds_write_b128 v232, v[88:91] offset:34816
    v_mfma_f32_16x16x32_bf16 v[68:71], a[52:55], v[156:159], v[68:71]
    buffer_load_dwordx4 v[152:155], v23, s[24:27], s58 offen offset:0 sc1
    v_mfma_f32_16x16x32_bf16 v[72:75], a[56:59], v[156:159], v[72:75]
    v_add_f32 v163, v163, v179
    v_add_f32 v164, v164, v180
    v_mfma_f32_16x16x32_bf16 v[76:79], a[60:63], v[156:159], v[76:79]
    v_add_f32 v165, v165, v181
    s_waitcnt vmcnt(10)
    v_mfma_f32_16x16x32_bf16 v[64:67], a[64:67], v[112:115], v[64:67]
    s_add_u32 s58, s58, 1024
    s_cmp_eq_u32 s58, s86
    s_cselect_b32 s58, s66, s58
    ds_write_b128 v232, v[92:95] offset:35840
    v_mfma_f32_16x16x32_bf16 v[68:71], a[68:71], v[112:115], v[68:71]
    buffer_load_dwordx4 v[156:159], v23, s[24:27], s58 offen offset:0 sc1
    v_mfma_f32_16x16x32_bf16 v[72:75], a[72:75], v[112:115], v[72:75]
    v_add_f32 v166, v166, v182
    v_add_f32 v167, v167, v183
    v_mfma_f32_16x16x32_bf16 v[76:79], a[76:79], v[112:115], v[76:79]
    v_add_f32 v160, v160, v184
    s_waitcnt vmcnt(10)
    v_mfma_f32_16x16x32_bf16 v[64:67], a[80:83], v[116:119], v[64:67]
    s_xor_b32 s66, s44, 1
    s_lshl2_add_u32 s66, s51, s66
    s_mul_i32 s66, s66, 66816
    s_lshl2_add_u32 s66, s52, s66
    s_lshl_b32 s86, s65, 10
    s_add_u32 s58, s86, s66
    s_add_u32 s86, s66, 16384
    v_mfma_f32_16x16x32_bf16 v[68:71], a[84:87], v[116:119], v[68:71]
    buffer_load_dwordx4 v[112:115], v23, s[24:27], s58 offen offset:0 sc1
    v_mfma_f32_16x16x32_bf16 v[72:75], a[88:91], v[116:119], v[72:75]
    v_add_f32 v161, v161, v185
    v_add_f32 v162, v162, v186
    v_mfma_f32_16x16x32_bf16 v[76:79], a[92:95], v[116:119], v[76:79]
    v_add_f32 v163, v163, v187
    s_waitcnt vmcnt(10)
    v_mfma_f32_16x16x32_bf16 v[64:67], a[96:99], v[120:123], v[64:67]
    s_add_u32 s58, s58, 1024
    s_cmp_eq_u32 s58, s86
    s_cselect_b32 s58, s66, s58
    v_mfma_f32_16x16x32_bf16 v[68:71], a[100:103], v[120:123], v[68:71]
    buffer_load_dwordx4 v[116:119], v23, s[24:27], s58 offen offset:0 sc1
    v_mfma_f32_16x16x32_bf16 v[72:75], a[104:107], v[120:123], v[72:75]
    v_add_f32 v164, v164, v188
    v_add_f32 v165, v165, v189
    v_mfma_f32_16x16x32_bf16 v[76:79], a[108:111], v[120:123], v[76:79]
    v_add_f32 v166, v166, v190
    s_waitcnt vmcnt(10)
    v_mfma_f32_16x16x32_bf16 v[64:67], a[112:115], v[124:127], v[64:67]
    s_add_u32 s58, s58, 1024
    s_cmp_eq_u32 s58, s86
    s_cselect_b32 s58, s66, s58
    v_mfma_f32_16x16x32_bf16 v[68:71], a[116:119], v[124:127], v[68:71]
    buffer_load_dwordx4 v[120:123], v23, s[24:27], s58 offen offset:0 sc1
    v_mfma_f32_16x16x32_bf16 v[72:75], a[120:123], v[124:127], v[72:75]
    v_add_f32 v167, v167, v191
    v_mul_f32 v192, v160, v160
    v_mfma_f32_16x16x32_bf16 v[76:79], a[124:127], v[124:127], v[76:79]
    v_mul_f32 v193, v161, v161
    s_waitcnt vmcnt(10)
    v_mfma_f32_16x16x32_bf16 v[64:67], a[128:131], v[128:131], v[64:67]
    s_add_u32 s58, s58, 1024
    s_cmp_eq_u32 s58, s86
    s_cselect_b32 s58, s66, s58
    v_mfma_f32_16x16x32_bf16 v[68:71], a[132:135], v[128:131], v[68:71]
    buffer_load_dwordx4 v[124:127], v23, s[24:27], s58 offen offset:0 sc1
    v_mfma_f32_16x16x32_bf16 v[72:75], a[136:139], v[128:131], v[72:75]
    v_mul_f32 v194, v162, v162
    v_mul_f32 v195, v163, v163
    v_mfma_f32_16x16x32_bf16 v[76:79], a[140:143], v[128:131], v[76:79]
    v_mul_f32 v196, v164, v164
    s_waitcnt vmcnt(10)
    v_mfma_f32_16x16x32_bf16 v[64:67], a[144:147], v[132:135], v[64:67]
    s_add_u32 s58, s58, 1024
    s_cmp_eq_u32 s58, s86
    s_cselect_b32 s58, s66, s58
    v_mfma_f32_16x16x32_bf16 v[68:71], a[148:151], v[132:135], v[68:71]
    buffer_load_dwordx4 v[128:131], v23, s[24:27], s58 offen offset:0 sc1
    v_mfma_f32_16x16x32_bf16 v[72:75], a[152:155], v[132:135], v[72:75]
    v_mul_f32 v197, v165, v165
    v_mul_f32 v198, v166, v166
    v_mfma_f32_16x16x32_bf16 v[76:79], a[156:159], v[132:135], v[76:79]
    v_mul_f32 v199, v167, v167
    ds_write_b128 v244, v[216:219]
    s_waitcnt vmcnt(10)
    v_mfma_f32_16x16x32_bf16 v[64:67], a[160:163], v[136:139], v[64:67]
    s_add_u32 s58, s58, 1024
    s_cmp_eq_u32 s58, s86
    s_cselect_b32 s58, s66, s58
    v_mfma_f32_16x16x32_bf16 v[68:71], a[164:167], v[136:139], v[68:71]
    buffer_load_dwordx4 v[132:135], v23, s[24:27], s58 offen offset:0 sc1
    v_mfma_f32_16x16x32_bf16 v[72:75], a[168:171], v[136:139], v[72:75]
    v_fma_f32 v192, v192, v236, v237
    v_fma_f32 v193, v193, v236, v237
    v_mfma_f32_16x16x32_bf16 v[76:79], a[172:175], v[136:139], v[76:79]
    v_fma_f32 v194, v194, v236, v237
    s_waitcnt vmcnt(10)
    v_mfma_f32_16x16x32_bf16 v[64:67], a[176:179], v[140:143], v[64:67]
    s_add_u32 s58, s58, 1024
    s_cmp_eq_u32 s58, s86
    s_cselect_b32 s58, s66, s58
    v_mfma_f32_16x16x32_bf16 v[68:71], a[180:183], v[140:143], v[68:71]
    buffer_load_dwordx4 v[136:139], v23, s[24:27], s58 offen offset:0 sc1
    v_mfma_f32_16x16x32_bf16 v[72:75], a[184:187], v[140:143], v[72:75]
    v_fma_f32 v195, v195, v236, v237
    v_fma_f32 v196, v196, v236, v237
    v_mfma_f32_16x16x32_bf16 v[76:79], a[188:191], v[140:143], v[76:79]
    v_fma_f32 v197, v197, v236, v237
    ds_write_b128 v244, v[220:223] offset:1408
    s_waitcnt vmcnt(10)
    v_mfma_f32_16x16x32_bf16 v[64:67], a[192:195], v[144:147], v[64:67]
    s_add_u32 s58, s58, 1024
    s_cmp_eq_u32 s58, s86
    s_cselect_b32 s58, s66, s58
    v_mfma_f32_16x16x32_bf16 v[68:71], a[196:199], v[144:147], v[68:71]
    buffer_load_dwordx4 v[140:143], v23, s[24:27], s58 offen offset:0 sc1
    v_mfma_f32_16x16x32_bf16 v[72:75], a[200:203], v[144:147], v[72:75]
    v_fma_f32 v198, v198, v236, v237
    v_fma_f32 v199, v199, v236, v237
    v_mfma_f32_16x16x32_bf16 v[76:79], a[204:207], v[144:147], v[76:79]
    v_mul_f32 v192, v192, v160
    s_waitcnt vmcnt(10)
    v_mfma_f32_16x16x32_bf16 v[64:67], a[208:211], v[148:151], v[64:67]
    s_add_u32 s58, s58, 1024
    s_cmp_eq_u32 s58, s86
    s_cselect_b32 s58, s66, s58
    v_mfma_f32_16x16x32_bf16 v[68:71], a[212:215], v[148:151], v[68:71]
    buffer_load_dwordx4 v[144:147], v23, s[24:27], s58 offen offset:0 sc1
    v_mfma_f32_16x16x32_bf16 v[72:75], a[216:219], v[148:151], v[72:75]
    v_mul_f32 v193, v193, v161
    v_mul_f32 v194, v194, v162
    v_mfma_f32_16x16x32_bf16 v[76:79], a[220:223], v[148:151], v[76:79]
    v_mul_f32 v195, v195, v163
    ds_write_b64 v252, v[224:225] offset:128
    s_waitcnt vmcnt(10)
    v_mfma_f32_16x16x32_bf16 v[64:67], a[224:227], v[152:155], v[64:67]
    s_add_u32 s58, s58, 1024
    s_cmp_eq_u32 s58, s86
    s_cselect_b32 s58, s66, s58
    v_mfma_f32_16x16x32_bf16 v[68:71], a[228:231], v[152:155], v[68:71]
    buffer_load_dwordx4 v[148:151], v23, s[24:27], s58 offen offset:0 sc1
    v_mfma_f32_16x16x32_bf16 v[72:75], a[232:235], v[152:155], v[72:75]
    v_mul_f32 v196, v196, v164
    v_mul_f32 v197, v197, v165
    v_mfma_f32_16x16x32_bf16 v[76:79], a[236:239], v[152:155], v[76:79]
    v_mul_f32 v198, v198, v166
    s_waitcnt vmcnt(10)
    v_mfma_f32_16x16x32_bf16 v[64:67], a[240:243], v[156:159], v[64:67]
    s_add_u32 s58, s58, 1024
    s_cmp_eq_u32 s58, s86
    s_cselect_b32 s58, s66, s58
    v_mfma_f32_16x16x32_bf16 v[68:71], a[244:247], v[156:159], v[68:71]
    buffer_load_dwordx4 v[152:155], v23, s[24:27], s58 offen offset:0 sc1
    v_mfma_f32_16x16x32_bf16 v[72:75], a[248:251], v[156:159], v[72:75]
    v_mul_f32 v199, v199, v167
    v_mfma_f32_16x16x32_bf16 v[76:79], a[252:255], v[156:159], v[76:79]
    ds_read_b64 v[216:217], v238 offset:0
    ds_read_b64 v[218:219], v238 offset:32
    ds_read_b64 v[220:221], v238 offset:64
    ds_read_b64 v[222:223], v238 offset:96
    ds_read_b64 v[224:225], v238 offset:128
    s_waitcnt vmcnt(10)
    v_mfma_f32_16x16x32_bf16 v[48:51], a[0:3], v[112:115], 0
    s_add_u32 s58, s58, 1024
    s_cmp_eq_u32 s58, s86
    s_cselect_b32 s58, s66, s58
    v_mfma_f32_16x16x32_bf16 v[52:55], a[4:7], v[112:115], 0
    buffer_load_dwordx4 v[156:159], v23, s[24:27], s58 offen offset:0 sc1
    v_mfma_f32_16x16x32_bf16 v[56:59], a[8:11], v[112:115], 0
    v_mfma_f32_16x16x32_bf16 v[60:63], a[12:15], v[112:115], 0
    s_waitcnt vmcnt(10)
    v_mfma_f32_16x16x32_bf16 v[48:51], a[16:19], v[116:119], v[48:51]
    s_add_u32 s58, s58, 1024
    s_cmp_eq_u32 s58, s86
    s_cselect_b32 s58, s66, s58
    v_mfma_f32_16x16x32_bf16 v[52:55], a[20:23], v[116:119], v[52:55]
    buffer_load_dwordx4 v[112:115], v23, s[24:27], s58 offen offset:0 sc1
    v_mfma_f32_16x16x32_bf16 v[56:59], a[24:27], v[116:119], v[56:59]
    ds_write_b128 v232, v[64:67] offset:16384
    v_mfma_f32_16x16x32_bf16 v[60:63], a[28:31], v[116:119], v[60:63]
    s_waitcnt vmcnt(10)
    v_mfma_f32_16x16x32_bf16 v[48:51], a[32:35], v[120:123], v[48:51]
    s_add_u32 s58, s58, 1024
    s_cmp_eq_u32 s58, s86
    s_cselect_b32 s58, s66, s58
    v_mfma_f32_16x16x32_bf16 v[52:55], a[36:39], v[120:123], v[52:55]
    buffer_load_dwordx4 v[116:119], v23, s[24:27], s58 offen offset:0 sc1
    v_mfma_f32_16x16x32_bf16 v[56:59], a[40:43], v[120:123], v[56:59]
    ds_write_b128 v232, v[68:71] offset:17408
    v_mfma_f32_16x16x32_bf16 v[60:63], a[44:47], v[120:123], v[60:63]
    s_waitcnt vmcnt(10)
    v_mfma_f32_16x16x32_bf16 v[48:51], a[48:51], v[124:127], v[48:51]
    s_add_u32 s58, s58, 1024
    s_cmp_eq_u32 s58, s86
    s_cselect_b32 s58, s66, s58
    ds_write_b128 v232, v[72:75] offset:18432
    v_mfma_f32_16x16x32_bf16 v[52:55], a[52:55], v[124:127], v[52:55]
    buffer_load_dwordx4 v[120:123], v23, s[24:27], s58 offen offset:0 sc1
    v_mfma_f32_16x16x32_bf16 v[56:59], a[56:59], v[124:127], v[56:59]
    v_exp_f32 v192, v192
    v_exp_f32 v193, v193
    v_mfma_f32_16x16x32_bf16 v[60:63], a[60:63], v[124:127], v[60:63]
    v_exp_f32 v194, v194
    s_waitcnt vmcnt(10)
    v_mfma_f32_16x16x32_bf16 v[48:51], a[64:67], v[128:131], v[48:51]
    s_add_u32 s58, s58, 1024
    s_cmp_eq_u32 s58, s86
    s_cselect_b32 s58, s66, s58
    ds_write_b128 v232, v[76:79] offset:19456
    v_mfma_f32_16x16x32_bf16 v[52:55], a[68:71], v[128:131], v[52:55]
    buffer_load_dwordx4 v[124:127], v23, s[24:27], s58 offen offset:0 sc1
    v_mfma_f32_16x16x32_bf16 v[56:59], a[72:75], v[128:131], v[56:59]
    v_exp_f32 v195, v195
    v_exp_f32 v196, v196
    v_mfma_f32_16x16x32_bf16 v[60:63], a[76:79], v[128:131], v[60:63]
    v_exp_f32 v197, v197
    s_waitcnt vmcnt(10)
    v_mfma_f32_16x16x32_bf16 v[48:51], a[80:83], v[132:135], v[48:51]
    s_xor_b32 s66, s44, 0
    s_lshl2_add_u32 s66, s51, s66
    s_mul_i32 s66, s66, 66816
    s_lshl2_add_u32 s66, s52, s66
    s_lshl_b32 s86, s65, 10
    s_add_u32 s58, s86, s66
    s_add_u32 s86, s66, 16384
    v_mfma_f32_16x16x32_bf16 v[52:55], a[84:87], v[132:135], v[52:55]
    buffer_load_dwordx4 v[128:131], v23, s[24:27], s58 offen offset:0 sc1
    v_mfma_f32_16x16x32_bf16 v[56:59], a[88:91], v[132:135], v[56:59]
    v_exp_f32 v198, v198
    v_exp_f32 v199, v199
    v_mfma_f32_16x16x32_bf16 v[60:63], a[92:95], v[132:135], v[60:63]
    v_add_f32 v192, 1.0, v192
    s_waitcnt vmcnt(10)
    v_mfma_f32_16x16x32_bf16 v[48:51], a[96:99], v[136:139], v[48:51]
    s_add_u32 s58, s58, 1024
    s_cmp_eq_u32 s58, s86
    s_cselect_b32 s58, s66, s58
    v_mfma_f32_16x16x32_bf16 v[52:55], a[100:103], v[136:139], v[52:55]
    buffer_load_dwordx4 v[132:135], v23, s[24:27], s58 offen offset:0 sc1
    v_mfma_f32_16x16x32_bf16 v[56:59], a[104:107], v[136:139], v[56:59]
    v_add_f32 v193, 1.0, v193
    v_add_f32 v194, 1.0, v194
    v_mfma_f32_16x16x32_bf16 v[60:63], a[108:111], v[136:139], v[60:63]
    v_add_f32 v195, 1.0, v195
    s_waitcnt vmcnt(10)
    v_mfma_f32_16x16x32_bf16 v[48:51], a[112:115], v[140:143], v[48:51]
    s_add_u32 s58, s58, 1024
    s_cmp_eq_u32 s58, s86
    s_cselect_b32 s58, s66, s58
    v_mfma_f32_16x16x32_bf16 v[52:55], a[116:119], v[140:143], v[52:55]
    buffer_load_dwordx4 v[136:139], v23, s[24:27], s58 offen offset:0 sc1
    v_mfma_f32_16x16x32_bf16 v[56:59], a[120:123], v[140:143], v[56:59]
    v_add_f32 v196, 1.0, v196
    v_add_f32 v197, 1.0, v197
    v_mfma_f32_16x16x32_bf16 v[60:63], a[124:127], v[140:143], v[60:63]
    v_add_f32 v198, 1.0, v198
    s_waitcnt vmcnt(10)
    v_mfma_f32_16x16x32_bf16 v[48:51], a[128:131], v[144:147], v[48:51]
    s_add_u32 s58, s58, 1024
    s_cmp_eq_u32 s58, s86
    s_cselect_b32 s58, s66, s58
    v_mfma_f32_16x16x32_bf16 v[52:55], a[132:135], v[144:147], v[52:55]
    buffer_load_dwordx4 v[140:143], v23, s[24:27], s58 offen offset:0 sc1
    v_mfma_f32_16x16x32_bf16 v[56:59], a[136:139], v[144:147], v[56:59]
    v_add_f32 v199, 1.0, v199
    v_rcp_f32 v192, v192
    v_mfma_f32_16x16x32_bf16 v[60:63], a[140:143], v[144:147], v[60:63]
    v_rcp_f32 v193, v193
    s_waitcnt vmcnt(10)
    v_mfma_f32_16x16x32_bf16 v[48:51], a[144:147], v[148:151], v[48:51]
    s_add_u32 s58, s58, 1024
    s_cmp_eq_u32 s58, s86
    s_cselect_b32 s58, s66, s58
    v_mfma_f32_16x16x32_bf16 v[52:55], a[148:151], v[148:151], v[52:55]
    buffer_load_dwordx4 v[144:147], v23, s[24:27], s58 offen offset:0 sc1
    v_mfma_f32_16x16x32_bf16 v[56:59], a[152:155], v[148:151], v[56:59]
    v_rcp_f32 v194, v194
    v_rcp_f32 v195, v195
    v_mfma_f32_16x16x32_bf16 v[60:63], a[156:159], v[148:151], v[60:63]
    v_rcp_f32 v196, v196
    s_waitcnt vmcnt(10)
    v_mfma_f32_16x16x32_bf16 v[48:51], a[160:163], v[152:155], v[48:51]
    s_add_u32 s58, s58, 1024
    s_cmp_eq_u32 s58, s86
    s_cselect_b32 s58, s66, s58
    v_mfma_f32_16x16x32_bf16 v[52:55], a[164:167], v[152:155], v[52:55]
    buffer_load_dwordx4 v[148:151], v23, s[24:27], s58 offen offset:0 sc1
    v_mfma_f32_16x16x32_bf16 v[56:59], a[168:171], v[152:155], v[56:59]
    v_rcp_f32 v197, v197
    v_rcp_f32 v198, v198
    v_mfma_f32_16x16x32_bf16 v[60:63], a[172:175], v[152:155], v[60:63]
    v_rcp_f32 v199, v199
    s_waitcnt vmcnt(10)
    v_mfma_f32_16x16x32_bf16 v[48:51], a[176:179], v[156:159], v[48:51]
    s_add_u32 s58, s58, 1024
    s_cmp_eq_u32 s58, s86
    s_cselect_b32 s58, s66, s58
    v_mfma_f32_16x16x32_bf16 v[52:55], a[180:183], v[156:159], v[52:55]
    buffer_load_dwordx4 v[152:155], v23, s[24:27], s58 offen offset:0 sc1
    v_mfma_f32_16x16x32_bf16 v[56:59], a[184:187], v[156:159], v[56:59]
    v_mul_f32 v192, v192, v160
    v_mul_f32 v193, v193, v161
    v_mfma_f32_16x16x32_bf16 v[60:63], a[188:191], v[156:159], v[60:63]
    v_mul_f32 v194, v194, v162
    s_waitcnt vmcnt(10)
    v_mfma_f32_16x16x32_bf16 v[48:51], a[192:195], v[112:115], v[48:51]
    s_add_u32 s58, s58, 1024
    s_cmp_eq_u32 s58, s86
    s_cselect_b32 s58, s66, s58
    v_mfma_f32_16x16x32_bf16 v[52:55], a[196:199], v[112:115], v[52:55]
    buffer_load_dwordx4 v[156:159], v23, s[24:27], s58 offen offset:0 sc1
L_wb_1:
    s_cbranch_execz L_wb_ret
    v_mfma_f32_16x16x32_bf16 v[56:59], a[200:203], v[112:115], v[56:59]
    v_mul_f32 v195, v195, v163
    v_mul_f32 v196, v196, v164
    v_mfma_f32_16x16x32_bf16 v[60:63], a[204:207], v[112:115], v[60:63]
    v_mul_f32 v197, v197, v165
    s_waitcnt vmcnt(10)
    v_mfma_f32_16x16x32_bf16 v[48:51], a[208:211], v[116:119], v[48:51]
    s_add_u32 s58, s58, 1024
    s_cmp_eq_u32 s58, s86
    s_cselect_b32 s58, s66, s58
    v_mfma_f32_16x16x32_bf16 v[52:55], a[212:215], v[116:119], v[52:55]
    buffer_load_dwordx4 v[112:115], v23, s[24:27], s58 offen offset:0 sc1
    v_mfma_f32_16x16x32_bf16 v[56:59], a[216:219], v[116:119], v[56:59]
    v_mul_f32 v198, v198, v166
    v_mul_f32 v199, v199, v167
    v_mfma_f32_16x16x32_bf16 v[60:63], a[220:223], v[116:119], v[60:63]
    v_cvt_pk_bf16_f32 v96, v192, v193
    s_waitcnt vmcnt(10)
    v_mfma_f32_16x16x32_bf16 v[48:51], a[224:227], v[120:123], v[48:51]
    s_add_u32 s58, s58, 1024
    s_cmp_eq_u32 s58, s86
    s_cselect_b32 s58, s66, s58
    v_mfma_f32_16x16x32_bf16 v[52:55], a[228:231], v[120:123], v[52:55]
    buffer_load_dwordx4 v[116:119], v23, s[24:27], s58 offen offset:0 sc1
    v_mfma_f32_16x16x32_bf16 v[56:59], a[232:235], v[120:123], v[56:59]
    v_cvt_pk_bf16_f32 v97, v194, v195
    v_cvt_pk_bf16_f32 v98, v196, v197
    v_mfma_f32_16x16x32_bf16 v[60:63], a[236:239], v[120:123], v[60:63]
    v_cvt_pk_bf16_f32 v99, v198, v199
    s_waitcnt vmcnt(10)
    v_mfma_f32_16x16x32_bf16 v[48:51], a[240:243], v[124:127], v[48:51]
    s_add_u32 s58, s58, 1024
    s_cmp_eq_u32 s58, s86
    s_cselect_b32 s58, s66, s58
    v_mfma_f32_16x16x32_bf16 v[52:55], a[244:247], v[124:127], v[52:55]
    buffer_load_dwordx4 v[120:123], v23, s[24:27], s58 offen offset:0 sc1
    v_mfma_f32_16x16x32_bf16 v[56:59], a[248:251], v[124:127], v[56:59]
    v_mfma_f32_16x16x32_bf16 v[60:63], a[252:255], v[124:127], v[60:63]
    s_waitcnt vmcnt(10)
    v_mfma_f32_16x16x32_bf16 v[32:35], a[0:3], v[128:131], v[32:35]
    s_add_u32 s58, s58, 1024
    s_cmp_eq_u32 s58, s86
    s_cselect_b32 s58, s66, s58
    v_mfma_f32_16x16x32_bf16 v[36:39], a[4:7], v[128:131], v[36:39]
    buffer_load_dwordx4 v[124:127], v23, s[24:27], s58 offen offset:0 sc1
    v_mfma_f32_16x16x32_bf16 v[40:43], a[8:11], v[128:131], v[40:43]
    v_mfma_f32_16x16x32_bf16 v[44:47], a[12:15], v[128:131], v[44:47]
    s_waitcnt vmcnt(10)
    v_mfma_f32_16x16x32_bf16 v[32:35], a[16:19], v[132:135], v[32:35]
    s_add_u32 s58, s58, 1024
    s_cmp_eq_u32 s58, s86
    s_cselect_b32 s58, s66, s58
    v_mfma_f32_16x16x32_bf16 v[36:39], a[20:23], v[132:135], v[36:39]
    buffer_load_dwordx4 v[128:131], v23, s[24:27], s58 offen offset:0 sc1
    v_mfma_f32_16x16x32_bf16 v[40:43], a[24:27], v[132:135], v[40:43]
    ds_write_b128 v232, v[48:51] offset:0
    v_mfma_f32_16x16x32_bf16 v[44:47], a[28:31], v[132:135], v[44:47]
    ds_write_b128 v232, v[52:55] offset:1024
    s_waitcnt vmcnt(10)
    v_mfma_f32_16x16x32_bf16 v[32:35], a[32:35], v[136:139], v[32:35]
    s_add_u32 s58, s58, 1024
    s_cmp_eq_u32 s58, s86
    s_cselect_b32 s58, s66, s58
    v_mfma_f32_16x16x32_bf16 v[36:39], a[36:39], v[136:139], v[36:39]
    buffer_load_dwordx4 v[132:135], v23, s[24:27], s58 offen offset:0 sc1
    v_mfma_f32_16x16x32_bf16 v[40:43], a[40:43], v[136:139], v[40:43]
    ds_write_b128 v232, v[56:59] offset:2048
    v_mfma_f32_16x16x32_bf16 v[44:47], a[44:47], v[136:139], v[44:47]
    ds_write_b128 v232, v[60:63] offset:3072
    s_waitcnt vmcnt(10)
    v_mfma_f32_16x16x32_bf16 v[32:35], a[48:51], v[140:143], v[32:35]
    s_add_u32 s58, s58, 1024
    s_cmp_eq_u32 s58, s86
    s_cselect_b32 s58, s66, s58
    v_mfma_f32_16x16x32_bf16 v[36:39], a[52:55], v[140:143], v[36:39]
    buffer_load_dwordx4 v[136:139], v23, s[24:27], s58 offen offset:0 sc1
    v_mfma_f32_16x16x32_bf16 v[40:43], a[56:59], v[140:143], v[40:43]
    v_mfma_f32_16x16x32_bf16 v[44:47], a[60:63], v[140:143], v[44:47]
    s_waitcnt vmcnt(10)
    v_mfma_f32_16x16x32_bf16 v[32:35], a[64:67], v[144:147], v[32:35]
    s_add_u32 s58, s58, 1024
    s_cmp_eq_u32 s58, s86
    s_cselect_b32 s58, s66, s58
    v_mfma_f32_16x16x32_bf16 v[36:39], a[68:71], v[144:147], v[36:39]
    buffer_load_dwordx4 v[140:143], v23, s[24:27], s58 offen offset:0 sc1
    v_mfma_f32_16x16x32_bf16 v[40:43], a[72:75], v[144:147], v[40:43]
    v_mfma_f32_16x16x32_bf16 v[44:47], a[76:79], v[144:147], v[44:47]
    s_waitcnt vmcnt(10)
    v_mfma_f32_16x16x32_bf16 v[32:35], a[80:83], v[148:151], v[32:35]
    s_add_u32 m0, s52, 81920
    s_lshl_b32 s57, s76, 7
    v_mfma_f32_16x16x32_bf16 v[36:39], a[84:87], v[148:151], v[36:39]
    buffer_load_dwordx4 v12, s[20:23], s57 offen offset:0 lds
    v_mfma_f32_16x16x32_bf16 v[40:43], a[88:91], v[148:151], v[40:43]
    s_waitcnt lgkmcnt(0)
    s_barrier
    v_mfma_f32_16x16x32_bf16 v[44:47], a[92:95], v[148:151], v[44:47]
    s_waitcnt vmcnt(10)
    v_mfma_f32_16x16x32_bf16 v[32:35], a[96:99], v[152:155], v[32:35]
    s_add_u32 s57, s57, 31744
    v_mfma_f32_16x16x32_bf16 v[36:39], a[100:103], v[152:155], v[36:39]
    buffer_load_dwordx4 v12, s[20:23], s57 offen offset:1024 lds
    v_mfma_f32_16x16x32_bf16 v[40:43], a[104:107], v[152:155], v[40:43]
    ds_read_b128 v[160:163], v233 offset:0
    ds_read_b128 v[176:179], v234 offset:16384
    v_mfma_f32_16x16x32_bf16 v[44:47], a[108:111], v[152:155], v[44:47]
    ds_read_b128 v[192:195], v235 offset:32768
    s_waitcnt vmcnt(10)
    v_mfma_f32_16x16x32_bf16 v[32:35], a[112:115], v[156:159], v[32:35]
    s_add_u32 s57, s57, 31744
    v_mfma_f32_16x16x32_bf16 v[36:39], a[116:119], v[156:159], v[36:39]
    buffer_load_dwordx4 v12, s[20:23], s57 offen offset:2048 lds
    v_mfma_f32_16x16x32_bf16 v[40:43], a[120:123], v[156:159], v[40:43]
    ds_read_b128 v[164:167], v233 offset:1024
    ds_read_b128 v[180:183], v234 offset:17408
    v_mfma_f32_16x16x32_bf16 v[44:47], a[124:127], v[156:159], v[44:47]
    ds_read_b128 v[196:199], v235 offset:33792
    s_waitcnt vmcnt(10)
    v_mfma_f32_16x16x32_bf16 v[32:35], a[128:131], v[112:115], v[32:35]
    s_add_u32 s57, s57, 31744
    v_mfma_f32_16x16x32_bf16 v[36:39], a[132:135], v[112:115], v[36:39]
    buffer_load_dwordx4 v12, s[20:23], s57 offen offset:3072 lds
    v_mfma_f32_16x16x32_bf16 v[40:43], a[136:139], v[112:115], v[40:43]
    ds_read_b128 v[168:171], v233 offset:2048
    ds_read_b128 v[184:187], v234 offset:18432
    v_mfma_f32_16x16x32_bf16 v[44:47], a[140:143], v[112:115], v[44:47]
    ds_read_b128 v[200:203], v235 offset:34816
    s_waitcnt vmcnt(10)
    v_mfma_f32_16x16x32_bf16 v[32:35], a[144:147], v[116:119], v[32:35]
    s_add_u32 m0, s52, 98304
    s_lshl_b32 s57, s76, 7
    s_add_u32 s57, s57, 131072
    v_mfma_f32_16x16x32_bf16 v[36:39], a[148:151], v[116:119], v[36:39]
    buffer_load_dwordx4 v12, s[20:23], s57 offen offset:0 lds
    v_mfma_f32_16x16x32_bf16 v[40:43], a[152:155], v[116:119], v[40:43]
    ds_read_b128 v[172:175], v233 offset:3072
    ds_read_b128 v[188:191], v234 offset:19456
    v_mfma_f32_16x16x32_bf16 v[44:47], a[156:159], v[116:119], v[44:47]
    ds_read_b128 v[204:207], v235 offset:35840
    s_waitcnt vmcnt(10)
    v_mfma_f32_16x16x32_bf16 v[32:35], a[160:163], v[120:123], v[32:35]
    s_add_u32 s57, s57, 31744
    v_mfma_f32_16x16x32_bf16 v[36:39], a[164:167], v[120:123], v[36:39]
    buffer_load_dwordx4 v12, s[20:23], s57 offen offset:1024 lds
    v_mfma_f32_16x16x32_bf16 v[40:43], a[168:171], v[120:123], v[40:43]
    v_mfma_f32_16x16x32_bf16 v[44:47], a[172:175], v[120:123], v[44:47]
    s_waitcnt vmcnt(10)
    v_mfma_f32_16x16x32_bf16 v[32:35], a[176:179], v[124:127], v[32:35]
    s_add_u32 s57, s57, 31744
    s_waitcnt lgkmcnt(9)
    v_mfma_f32_16x16x32_bf16 v[36:39], a[180:183], v[124:127], v[36:39]
    buffer_load_dwordx4 v12, s[20:23], s57 offen offset:2048 lds
    v_mfma_f32_16x16x32_bf16 v[40:43], a[184:187], v[124:127], v[40:43]
    v_add_f32 v160, v160, v176
    v_add_f32 v161, v161, v177
    v_mfma_f32_16x16x32_bf16 v[44:47], a[188:191], v[124:127], v[44:47]
    v_add_f32 v162, v162, v178
    s_waitcnt vmcnt(10)
    v_mfma_f32_16x16x32_bf16 v[32:35], a[192:195], v[128:131], v[32:35]
    s_add_u32 s57, s57, 31744
    v_add_f32 v163, v163, v179
    v_mfma_f32_16x16x32_bf16 v[36:39], a[196:199], v[128:131], v[36:39]
    buffer_load_dwordx4 v12, s[20:23], s57 offen offset:3072 lds
    v_mfma_f32_16x16x32_bf16 v[40:43], a[200:203], v[128:131], v[40:43]
    s_waitcnt lgkmcnt(6)
    v_add_f32 v164, v164, v180
    v_mfma_f32_16x16x32_bf16 v[44:47], a[204:207], v[128:131], v[44:47]
    v_add_f32 v165, v165, v181
    s_waitcnt vmcnt(10)
    v_mfma_f32_16x16x32_bf16 v[32:35], a[208:211], v[132:135], v[32:35]
    s_add_u32 m0, s52, 114688
    s_lshl_b32 s57, s77, 7
    v_add_f32 v166, v166, v182
    v_mfma_f32_16x16x32_bf16 v[36:39], a[212:215], v[132:135], v[36:39]
    buffer_load_dwordx4 v12, s[20:23], s57 offen offset:0 lds
    v_mfma_f32_16x16x32_bf16 v[40:43], a[216:219], v[132:135], v[40:43]
    v_add_f32 v167, v167, v183
    s_waitcnt lgkmcnt(3)
    v_mfma_f32_16x16x32_bf16 v[44:47], a[220:223], v[132:135], v[44:47]
    v_add_f32 v168, v168, v184
    s_waitcnt vmcnt(10)
    v_mfma_f32_16x16x32_bf16 v[32:35], a[224:227], v[136:139], v[32:35]
    s_add_u32 s57, s57, 31744
    v_add_f32 v169, v169, v185
    v_mfma_f32_16x16x32_bf16 v[36:39], a[228:231], v[136:139], v[36:39]
    buffer_load_dwordx4 v12, s[20:23], s57 offen offset:1024 lds
    v_mfma_f32_16x16x32_bf16 v[40:43], a[232:235], v[136:139], v[40:43]
    v_add_f32 v170, v170, v186
    v_add_f32 v171, v171, v187
    v_mfma_f32_16x16x32_bf16 v[44:47], a[236:239], v[136:139], v[44:47]
    s_waitcnt lgkmcnt(0)
    s_waitcnt vmcnt(10)
    v_mfma_f32_16x16x32_bf16 v[32:35], a[240:243], v[140:143], v[32:35]
    s_add_u32 s57, s57, 31744
    v_add_f32 v172, v172, v188
    v_mfma_f32_16x16x32_bf16 v[36:39], a[244:247], v[140:143], v[36:39]
    buffer_load_dwordx4 v12, s[20:23], s57 offen offset:2048 lds
    v_mfma_f32_16x16x32_bf16 v[40:43], a[248:251], v[140:143], v[40:43]
    v_add_f32 v173, v173, v189
    v_add_f32 v174, v174, v190
    v_mfma_f32_16x16x32_bf16 v[44:47], a[252:255], v[140:143], v[44:47]
    v_add_f32 v175, v175, v191
    v_pk_add_f32 v[160:161], v[160:161], v[192:193]
    v_pk_add_f32 v[162:163], v[162:163], v[194:195]
    v_pk_add_f32 v[164:165], v[164:165], v[196:197]
    v_pk_add_f32 v[166:167], v[166:167], v[198:199]
    v_pk_add_f32 v[168:169], v[168:169], v[200:201]
    v_pk_add_f32 v[170:171], v[170:171], v[202:203]
    v_pk_add_f32 v[172:173], v[172:173], v[204:205]
    v_pk_add_f32 v[174:175], v[174:175], v[206:207]
    buffer_store_dwordx4 v[96:99], v23, s[24:27], s83 offen sc1
    s_add_u32 s57, s57, 31744
    buffer_load_dwordx4 v12, s[20:23], s57 offen offset:3072 lds
    v_pk_add_f32 v[32:33], v[32:33], v[160:161]
    v_pk_add_f32 v[34:35], v[34:35], v[162:163]
    v_pk_add_f32 v[36:37], v[36:37], v[164:165]
    v_pk_add_f32 v[38:39], v[38:39], v[166:167]
    v_pk_mul_f32 v[48:49], v[32:33], v[32:33]
    v_pk_mul_f32 v[50:51], v[34:35], v[34:35]
    v_pk_mul_f32 v[52:53], v[36:37], v[36:37]
    v_pk_mul_f32 v[54:55], v[38:39], v[38:39]
    s_add_u32 m0, s52, 131072
    s_lshl_b32 s57, s77, 7
    s_add_u32 s57, s57, 131072
    buffer_load_dwordx4 v12, s[20:23], s57 offen offset:0 lds
    v_pk_fma_f32 v[48:49], v[48:49], v[236:237], v[236:237] op_sel:[0,0,1] op_sel_hi:[1,0,1]
    v_pk_fma_f32 v[50:51], v[50:51], v[236:237], v[236:237] op_sel:[0,0,1] op_sel_hi:[1,0,1]
    v_pk_fma_f32 v[52:53], v[52:53], v[236:237], v[236:237] op_sel:[0,0,1] op_sel_hi:[1,0,1]
    v_pk_fma_f32 v[54:55], v[54:55], v[236:237], v[236:237] op_sel:[0,0,1] op_sel_hi:[1,0,1]
    v_pk_mul_f32 v[48:49], v[48:49], v[32:33]
    v_pk_mul_f32 v[50:51], v[50:51], v[34:35]
    v_pk_mul_f32 v[52:53], v[52:53], v[36:37]
    v_pk_mul_f32 v[54:55], v[54:55], v[38:39]
    s_add_u32 s57, s57, 31744
    buffer_load_dwordx4 v12, s[20:23], s57 offen offset:1024 lds
    s_waitcnt vmcnt(11)
    ds_read_b64_tr_b16 a[0:1], v6 offset:32768
    ds_read_b64_tr_b16 a[2:3], v6 offset:34816
    ds_read_b64_tr_b16 a[4:5], v7 offset:32768
    ds_read_b64_tr_b16 a[6:7], v7 offset:34816
    v_exp_f32 v48, v48
    v_exp_f32 v49, v49
    v_exp_f32 v50, v50
    v_exp_f32 v51, v51
    ds_read_b64_tr_b16 a[8:9], v6 offset:33024
    ds_read_b64_tr_b16 a[10:11], v6 offset:35072
    ds_read_b64_tr_b16 a[12:13], v7 offset:33024
    ds_read_b64_tr_b16 a[14:15], v7 offset:35072
    s_add_u32 s57, s57, 31744
    buffer_load_dwordx4 v12, s[20:23], s57 offen offset:2048 lds
    v_exp_f32 v52, v52
    v_exp_f32 v53, v53
    v_exp_f32 v54, v54
    v_exp_f32 v55, v55
    v_pk_add_f32 v[48:49], v[48:49], 1.0 op_sel_hi:[1,0]
    v_pk_add_f32 v[50:51], v[50:51], 1.0 op_sel_hi:[1,0]
    v_pk_add_f32 v[52:53], v[52:53], 1.0 op_sel_hi:[1,0]
    v_pk_add_f32 v[54:55], v[54:55], 1.0 op_sel_hi:[1,0]
    s_add_u32 s57, s57, 31744
    buffer_load_dwordx4 v12, s[20:23], s57 offen offset:3072 lds
    v_rcp_f32 v48, v48
    v_rcp_f32 v49, v49
    v_rcp_f32 v50, v50
    v_rcp_f32 v51, v51
    v_rcp_f32 v52, v52
    v_rcp_f32 v53, v53
    v_rcp_f32 v54, v54
    v_rcp_f32 v55, v55
    v_pk_mul_f32 v[48:49], v[48:49], v[32:33]
    v_pk_mul_f32 v[50:51], v[50:51], v[34:35]
    v_pk_mul_f32 v[52:53], v[52:53], v[36:37]
    v_pk_mul_f32 v[54:55], v[54:55], v[38:39]
    s_add_u32 m0, s52, 147456
    s_lshl_b32 s57, s78, 7
    buffer_load_dwordx4 v12, s[20:23], s57 offen offset:0 lds
    v_cvt_pk_bf16_f32 v56, v48, v49
    v_cvt_pk_bf16_f32 v57, v50, v51
    v_cvt_pk_bf16_f32 v58, v52, v53
    v_cvt_pk_bf16_f32 v59, v54, v55
    buffer_store_dwordx4 v[56:59], v23, s[24:27], s67 offen offset:0 sc1
    v_pk_add_f32 v[40:41], v[40:41], v[168:169]
    v_pk_add_f32 v[42:43], v[42:43], v[170:171]
    v_pk_add_f32 v[44:45], v[44:45], v[172:173]
    v_pk_add_f32 v[46:47], v[46:47], v[174:175]
    s_add_u32 s57, s57, 31744
    buffer_load_dwordx4 v12, s[20:23], s57 offen offset:1024 lds
    s_waitcnt vmcnt(12)
    ds_read_b64_tr_b16 a[16:17], v6 offset:49152
    ds_read_b64_tr_b16 a[18:19], v6 offset:51200
    ds_read_b64_tr_b16 a[20:21], v7 offset:49152
    ds_read_b64_tr_b16 a[22:23], v7 offset:51200
    v_pk_mul_f32 v[48:49], v[40:41], v[40:41]
    v_pk_mul_f32 v[50:51], v[42:43], v[42:43]
    v_pk_mul_f32 v[52:53], v[44:45], v[44:45]
    v_pk_mul_f32 v[54:55], v[46:47], v[46:47]
    ds_read_b64_tr_b16 a[24:25], v6 offset:49408
    ds_read_b64_tr_b16 a[26:27], v6 offset:51456
    ds_read_b64_tr_b16 a[28:29], v7 offset:49408
    ds_read_b64_tr_b16 a[30:31], v7 offset:51456
    s_add_u32 s57, s57, 31744
    buffer_load_dwordx4 v12, s[20:23], s57 offen offset:2048 lds
    v_pk_fma_f32 v[48:49], v[48:49], v[236:237], v[236:237] op_sel:[0,0,1] op_sel_hi:[1,0,1]
    v_pk_fma_f32 v[50:51], v[50:51], v[236:237], v[236:237] op_sel:[0,0,1] op_sel_hi:[1,0,1]
    v_pk_fma_f32 v[52:53], v[52:53], v[236:237], v[236:237] op_sel:[0,0,1] op_sel_hi:[1,0,1]
    v_pk_fma_f32 v[54:55], v[54:55], v[236:237], v[236:237] op_sel:[0,0,1] op_sel_hi:[1,0,1]
    v_pk_mul_f32 v[48:49], v[48:49], v[40:41]
    v_pk_mul_f32 v[50:51], v[50:51], v[42:43]
    v_pk_mul_f32 v[52:53], v[52:53], v[44:45]
    v_pk_mul_f32 v[54:55], v[54:55], v[46:47]
    s_add_u32 s57, s57, 31744
    buffer_load_dwordx4 v12, s[20:23], s57 offen offset:3072 lds
    v_exp_f32 v48, v48
    v_exp_f32 v49, v49
    v_exp_f32 v50, v50
    v_exp_f32 v51, v51
    v_exp_f32 v52, v52
    v_exp_f32 v53, v53
    v_exp_f32 v54, v54
    v_exp_f32 v55, v55
    v_pk_add_f32 v[48:49], v[48:49], 1.0 op_sel_hi:[1,0]
    v_pk_add_f32 v[50:51], v[50:51], 1.0 op_sel_hi:[1,0]
    v_pk_add_f32 v[52:53], v[52:53], 1.0 op_sel_hi:[1,0]
    v_pk_add_f32 v[54:55], v[54:55], 1.0 op_sel_hi:[1,0]
    s_add_u32 m0, s52, 49152
    s_lshl_b32 s57, s78, 7
    s_add_u32 s57, s57, 131072
    buffer_load_dwordx4 v12, s[20:23], s57 offen offset:0 lds
    v_rcp_f32 v48, v48
    v_rcp_f32 v49, v49
    v_rcp_f32 v50, v50
    v_rcp_f32 v51, v51
    v_rcp_f32 v52, v52
    v_rcp_f32 v53, v53
    v_rcp_f32 v54, v54
    v_rcp_f32 v55, v55
    s_add_u32 s57, s57, 31744
    buffer_load_dwordx4 v12, s[20:23], s57 offen offset:1024 lds
    s_waitcnt vmcnt(11)
    ds_read_b64_tr_b16 a[32:33], v8 offset:0
    ds_read_b64_tr_b16 a[34:35], v8 offset:2048
    ds_read_b64_tr_b16 a[36:37], v9 offset:0
    ds_read_b64_tr_b16 a[38:39], v9 offset:2048
    v_pk_mul_f32 v[48:49], v[48:49], v[40:41]
    v_pk_mul_f32 v[50:51], v[50:51], v[42:43]
    v_pk_mul_f32 v[52:53], v[52:53], v[44:45]
    v_pk_mul_f32 v[54:55], v[54:55], v[46:47]
    ds_read_b64_tr_b16 a[40:41], v8 offset:256
    ds_read_b64_tr_b16 a[42:43], v8 offset:2304
    ds_read_b64_tr_b16 a[44:45], v9 offset:256
    ds_read_b64_tr_b16 a[46:47], v9 offset:2304
    s_add_u32 s57, s57, 31744
    buffer_load_dwordx4 v12, s[20:23], s57 offen offset:2048 lds
    v_cvt_pk_bf16_f32 v60, v48, v49
    v_cvt_pk_bf16_f32 v61, v50, v51
    v_cvt_pk_bf16_f32 v62, v52, v53
    v_cvt_pk_bf16_f32 v63, v54, v55
    buffer_store_dwordx4 v[60:63], v23, s[24:27], s67 offen offset:1024 sc1
    s_add_u32 s57, s57, 31744
    buffer_load_dwordx4 v12, s[20:23], s57 offen offset:3072 lds
    s_add_u32 m0, s52, 65536
    s_lshl_b32 s57, s79, 7
    buffer_load_dwordx4 v12, s[20:23], s57 offen offset:0 lds
    s_add_u32 s57, s57, 31744
    buffer_load_dwordx4 v12, s[20:23], s57 offen offset:1024 lds
    s_waitcnt vmcnt(12)
    ds_read_b64_tr_b16 a[48:49], v8 offset:16384
    ds_read_b64_tr_b16 a[50:51], v8 offset:18432
    ds_read_b64_tr_b16 a[52:53], v9 offset:16384
    ds_read_b64_tr_b16 a[54:55], v9 offset:18432
    s_add_u32 s57, s57, 31744
    buffer_load_dwordx4 v12, s[20:23], s57 offen offset:2048 lds
    ds_read_b64_tr_b16 a[56:57], v8 offset:16640
    ds_read_b64_tr_b16 a[58:59], v8 offset:18688
    ds_read_b64_tr_b16 a[60:61], v9 offset:16640
    ds_read_b64_tr_b16 a[62:63], v9 offset:18688
    s_add_u32 s57, s57, 31744
    buffer_load_dwordx4 v12, s[20:23], s57 offen offset:3072 lds
    s_waitcnt lgkmcnt(15)
    s_add_u32 m0, s52, 81920
    s_lshl_b32 s57, s79, 7
    s_add_u32 s57, s57, 131072
    buffer_load_dwordx4 v12, s[20:23], s57 offen offset:0 lds
    s_add_u32 s57, s57, 31744
    buffer_load_dwordx4 v12, s[20:23], s57 offen offset:1024 lds
    s_waitcnt vmcnt(11)
    ds_read_b64_tr_b16 a[64:65], v8 offset:32768
    ds_read_b64_tr_b16 a[66:67], v8 offset:34816
    ds_read_b64_tr_b16 a[68:69], v9 offset:32768
    ds_read_b64_tr_b16 a[70:71], v9 offset:34816
    s_add_u32 s57, s57, 31744
    buffer_load_dwordx4 v12, s[20:23], s57 offen offset:2048 lds
    ds_read_b64_tr_b16 a[72:73], v8 offset:33024
    ds_read_b64_tr_b16 a[74:75], v8 offset:35072
    ds_read_b64_tr_b16 a[76:77], v9 offset:33024
    ds_read_b64_tr_b16 a[78:79], v9 offset:35072
    s_add_u32 s57, s57, 31744
    buffer_load_dwordx4 v12, s[20:23], s57 offen offset:3072 lds
    s_add_u32 m0, s52, 98304
    s_lshl_b32 s57, s80, 7
    buffer_load_dwordx4 v12, s[20:23], s57 offen offset:0 lds
    s_add_u32 s57, s57, 31744
    buffer_load_dwordx4 v12, s[20:23], s57 offen offset:1024 lds
    s_waitcnt vmcnt(10)
    ds_read_b64_tr_b16 a[80:81], v6 offset:0
    ds_read_b64_tr_b16 a[82:83], v6 offset:2048
    ds_read_b64_tr_b16 a[84:85], v7 offset:0
    ds_read_b64_tr_b16 a[86:87], v7 offset:2048
    s_add_u32 s57, s57, 31744
    buffer_load_dwordx4 v12, s[20:23], s57 offen offset:2048 lds
    ds_read_b64_tr_b16 a[88:89], v6 offset:256
    ds_read_b64_tr_b16 a[90:91], v6 offset:2304
    ds_read_b64_tr_b16 a[92:93], v7 offset:256
    ds_read_b64_tr_b16 a[94:95], v7 offset:2304
    s_barrier
    s_cmp_lg_u32 s44, 0
    s_cbranch_scc1 L_nopub6
    s_lshl_b32 s60, s51, 5
    s_add_u32 s60, s60, s50
    s_lshl_b32 s60, s60, 7
    s_add_u32 s60, s60, 12713984
    v_mov_b32 v30, s47
    s_mov_b64 exec, 1
    buffer_store_dword v30, off, s[24:27], s60 sc1
    v_mov_b32 v29, 0
    s_lshl_b32 s60, s2, 8
    buffer_store_dword v29, off, s[40:43], s60 sc1
    s_mov_b64 exec, -1
L_nopub6:
L_p3join:
    s_add_u32 s57, s57, 31744
    buffer_load_dwordx4 v12, s[20:23], s57 offen offset:3072 lds
    v_lshlrev_b32 v228, 16, v228
    v_lshlrev_b32 v32, 16, v216
    v_and_b32 v33, s61, v216
    v_lshlrev_b32 v34, 16, v217
    s_waitcnt lgkmcnt(15)
    s_add_u32 m0, s52, 114688
    s_lshl_b32 s57, s80, 7
    s_add_u32 s57, s57, 131072
    buffer_load_dwordx4 v12, s[20:23], s57 offen offset:0 lds
    v_and_b32 v35, s61, v217
    v_add_f32 v32, v32, v228
    v_add_f32 v33, v33, v228
    v_add_f32 v34, v34, v228
    s_add_u32 s57, s57, 31744
    buffer_load_dwordx4 v12, s[20:23], s57 offen offset:1024 lds
    s_waitcnt vmcnt(10)
    ds_read_b64_tr_b16 a[96:97], v6 offset:16384
    ds_read_b64_tr_b16 a[98:99], v6 offset:18432
    ds_read_b64_tr_b16 a[100:101], v7 offset:16384
    ds_read_b64_tr_b16 a[102:103], v7 offset:18432
    v_add_f32 v35, v35, v228
    v_lshlrev_b32 v48, 16, v218
    v_and_b32 v49, s61, v218
    v_lshlrev_b32 v50, 16, v219
    ds_read_b64_tr_b16 a[104:105], v6 offset:16640
    ds_read_b64_tr_b16 a[106:107], v6 offset:18688
    ds_read_b64_tr_b16 a[108:109], v7 offset:16640
    ds_read_b64_tr_b16 a[110:111], v7 offset:18688
    s_add_u32 s57, s57, 31744
    buffer_load_dwordx4 v12, s[20:23], s57 offen offset:2048 lds
    v_and_b32 v51, s61, v219
    v_add_f32 v48, v48, v228
    v_add_f32 v49, v49, v228
    v_add_f32 v50, v50, v228
    s_add_u32 s57, s57, 31744
    buffer_load_dwordx4 v12, s[20:23], s57 offen offset:3072 lds
    v_add_f32 v51, v51, v228
    v_lshlrev_b32 v64, 16, v220
    v_and_b32 v65, s61, v220
    v_lshlrev_b32 v66, 16, v221
    s_add_u32 m0, s52, 131072
    s_lshl_b32 s57, s81, 7
    buffer_load_dwordx4 v12, s[20:23], s57 offen offset:0 lds
    v_and_b32 v67, s61, v221
    v_add_f32 v64, v64, v228
    v_add_f32 v65, v65, v228
    v_add_f32 v66, v66, v228
    v_add_f32 v67, v67, v228
    v_lshlrev_b32 v80, 16, v222
    v_and_b32 v81, s61, v222
    v_lshlrev_b32 v82, 16, v223
    s_add_u32 s57, s57, 31744
    buffer_load_dwordx4 v12, s[20:23], s57 offen offset:1024 lds
    s_waitcnt vmcnt(10)
    ds_read_b64_tr_b16 a[112:113], v6 offset:32768
    ds_read_b64_tr_b16 a[114:115], v6 offset:34816
    ds_read_b64_tr_b16 a[116:117], v7 offset:32768
    ds_read_b64_tr_b16 a[118:119], v7 offset:34816
    s_add_u32 s57, s57, 31744
    buffer_load_dwordx4 v12, s[20:23], s57 offen offset:2048 lds
    ds_read_b64_tr_b16 a[120:121], v6 offset:33024
    ds_read_b64_tr_b16 a[122:123], v6 offset:35072
    ds_read_b64_tr_b16 a[124:125], v7 offset:33024
    ds_read_b64_tr_b16 a[126:127], v7 offset:35072
    s_add_u32 s57, s57, 31744
    buffer_load_dwordx4 v12, s[20:23], s57 offen offset:3072 lds
    v_and_b32 v83, s61, v223
    v_add_f32 v80, v80, v228
    v_add_f32 v81, v81, v228
    v_add_f32 v82, v82, v228
    v_add_f32 v83, v83, v228
    v_lshlrev_b32 v96, 16, v224
    v_and_b32 v97, s61, v224
    v_lshlrev_b32 v98, 16, v225
    s_waitcnt lgkmcnt(15)
    s_add_u32 m0, s52, 147456
    s_lshl_b32 s57, s81, 7
    s_add_u32 s57, s57, 131072
    buffer_load_dwordx4 v12, s[20:23], s57 offen offset:0 lds
    v_and_b32 v99, s61, v225
    v_add_f32 v96, v96, v228
    v_add_f32 v97, v97, v228
    v_add_f32 v98, v98, v228
    s_add_u32 s57, s57, 31744
    buffer_load_dwordx4 v12, s[20:23], s57 offen offset:1024 lds
    s_waitcnt vmcnt(10)
    ds_read_b64_tr_b16 a[128:129], v6 offset:49152
    ds_read_b64_tr_b16 a[130:131], v6 offset:51200
    ds_read_b64_tr_b16 a[132:133], v7 offset:49152
    ds_read_b64_tr_b16 a[134:135], v7 offset:51200
    s_add_u32 s57, s57, 31744
    buffer_load_dwordx4 v12, s[20:23], s57 offen offset:2048 lds
    ds_read_b64_tr_b16 a[136:137], v6 offset:49408
    ds_read_b64_tr_b16 a[138:139], v6 offset:51456
    ds_read_b64_tr_b16 a[140:141], v7 offset:49408
    ds_read_b64_tr_b16 a[142:143], v7 offset:51456
    v_add_f32 v99, v99, v228
    s_add_u32 s57, s57, 31744
    buffer_load_dwordx4 v12, s[20:23], s57 offen offset:3072 lds
    s_add_u32 m0, s52, 49152
    s_lshl_b32 s57, s82, 7
    buffer_load_dwordx4 v12, s[20:23], s57 offen offset:0 lds
    s_add_u32 s57, s57, 31744
    buffer_load_dwordx4 v12, s[20:23], s57 offen offset:1024 lds
    s_waitcnt vmcnt(10)
    ds_read_b64_tr_b16 a[144:145], v8 offset:0
    ds_read_b64_tr_b16 a[146:147], v8 offset:2048
    ds_read_b64_tr_b16 a[148:149], v9 offset:0
    ds_read_b64_tr_b16 a[150:151], v9 offset:2048
    s_add_u32 s57, s57, 31744
    buffer_load_dwordx4 v12, s[20:23], s57 offen offset:2048 lds
    ds_read_b64_tr_b16 a[152:153], v8 offset:256
    ds_read_b64_tr_b16 a[154:155], v8 offset:2304
    ds_read_b64_tr_b16 a[156:157], v9 offset:256
    ds_read_b64_tr_b16 a[158:159], v9 offset:2304
    s_add_u32 s57, s57, 31744
    buffer_load_dwordx4 v12, s[20:23], s57 offen offset:3072 lds
    s_waitcnt lgkmcnt(15)
    s_add_u32 m0, s52, 65536
    s_lshl_b32 s57, s82, 7
    s_add_u32 s57, s57, 131072
    buffer_load_dwordx4 v12, s[20:23], s57 offen offset:0 lds
    s_add_u32 s57, s57, 31744
    buffer_load_dwordx4 v12, s[20:23], s57 offen offset:1024 lds
    s_waitcnt vmcnt(10)
    ds_read_b64_tr_b16 a[160:161], v8 offset:16384
    ds_read_b64_tr_b16 a[162:163], v8 offset:18432
    ds_read_b64_tr_b16 a[164:165], v9 offset:16384
    ds_read_b64_tr_b16 a[166:167], v9 offset:18432
    s_add_u32 s57, s57, 31744
    buffer_load_dwordx4 v12, s[20:23], s57 offen offset:2048 lds
    ds_read_b64_tr_b16 a[168:169], v8 offset:16640
    ds_read_b64_tr_b16 a[170:171], v8 offset:18688
    ds_read_b64_tr_b16 a[172:173], v9 offset:16640
    ds_read_b64_tr_b16 a[174:175], v9 offset:18688
    s_add_u32 s57, s57, 31744
    buffer_load_dwordx4 v12, s[20:23], s57 offen offset:3072 lds
    s_add_u32 m0, s52, 81920
    s_mov_b32 s57, s75
    buffer_load_dwordx4 v15, s[12:15], s57 offen offset:0 lds
    s_add_u32 s57, s57, 113664
    buffer_load_dwordx4 v15, s[12:15], s57 offen offset:1024 lds
    s_waitcnt vmcnt(10)
    ds_read_b64_tr_b16 a[176:177], v8 offset:32768
    ds_read_b64_tr_b16 a[178:179], v8 offset:34816
    ds_read_b64_tr_b16 a[180:181], v9 offset:32768
    ds_read_b64_tr_b16 a[182:183], v9 offset:34816
    s_add_u32 s57, s57, 113664
    buffer_load_dwordx4 v15, s[12:15], s57 offen offset:2048 lds
    ds_read_b64_tr_b16 a[184:185], v8 offset:33024
    ds_read_b64_tr_b16 a[186:187], v8 offset:35072
    ds_read_b64_tr_b16 a[188:189], v9 offset:33024
    ds_read_b64_tr_b16 a[190:191], v9 offset:35072
    s_add_u32 s57, s57, 113664
    buffer_load_dwordx4 v15, s[12:15], s57 offen offset:3072 lds
    s_waitcnt lgkmcnt(15)
    s_add_u32 m0, s52, 98304
    s_mov_b32 s57, 0
    buffer_load_dwordx4 v13, s[12:15], s57 offen offset:0 lds
    s_add_u32 s57, s57, 6144
    buffer_load_dwordx4 v14, s[12:15], s57 offen offset:1024 lds
    s_waitcnt vmcnt(10)
    ds_read_b64_tr_b16 a[192:193], v6 offset:0
    ds_read_b64_tr_b16 a[194:195], v6 offset:2048
    ds_read_b64_tr_b16 a[196:197], v7 offset:0
    ds_read_b64_tr_b16 a[198:199], v7 offset:2048
    s_add_u32 s57, s57, 6144
    buffer_load_dwordx4 v13, s[12:15], s57 offen offset:2048 lds
    ds_read_b64_tr_b16 a[200:201], v6 offset:256
    ds_read_b64_tr_b16 a[202:203], v6 offset:2304
    ds_read_b64_tr_b16 a[204:205], v7 offset:256
    ds_read_b64_tr_b16 a[206:207], v7 offset:2304
    s_add_u32 s57, s57, 6144
L_wb_2:
    s_cbranch_execz L_wb_ret
    buffer_load_dwordx4 v14, s[12:15], s57 offen offset:3072 lds
    buffer_load_dword v17, v20, s[24:27], 0 offen sc1
    s_add_u32 m0, s52, 114688
    s_mov_b32 s57, 114688
    buffer_load_dwordx4 v13, s[12:15], s57 offen offset:0 lds
    s_waitcnt vmcnt(10)
    ds_read_b64_tr_b16 a[208:209], v6 offset:16384
    ds_read_b64_tr_b16 a[210:211], v6 offset:18432
    ds_read_b64_tr_b16 a[212:213], v7 offset:16384
    ds_read_b64_tr_b16 a[214:215], v7 offset:18432
    s_add_u32 s57, s57, 6144
    buffer_load_dwordx4 v14, s[12:15], s57 offen offset:1024 lds
    ds_read_b64_tr_b16 a[216:217], v6 offset:16640
    ds_read_b64_tr_b16 a[218:219], v6 offset:18688
    ds_read_b64_tr_b16 a[220:221], v7 offset:16640
    ds_read_b64_tr_b16 a[222:223], v7 offset:18688
    s_add_u32 s57, s57, 6144
    buffer_load_dwordx4 v13, s[12:15], s57 offen offset:2048 lds
    s_add_u32 s57, s57, 6144
    buffer_load_dwordx4 v14, s[12:15], s57 offen offset:3072 lds
    s_waitcnt lgkmcnt(15)
    s_add_u32 m0, s52, 131072
    s_mov_b32 s57, 229376
    buffer_load_dwordx4 v13, s[12:15], s57 offen offset:0 lds
    s_add_u32 s57, s57, 6144
    buffer_load_dwordx4 v14, s[12:15], s57 offen offset:1024 lds
    s_add_u32 s57, s57, 6144
    buffer_load_dwordx4 v13, s[12:15], s57 offen offset:2048 lds
    s_add_u32 s57, s57, 6144
    buffer_load_dwordx4 v14, s[12:15], s57 offen offset:3072 lds
    s_add_u32 m0, s52, 147456
    s_mov_b32 s57, 344064
    buffer_load_dwordx4 v239, s[12:15], s57 offen offset:0 lds
    s_add_u32 s57, s57, 27648
    buffer_load_dwordx4 v239, s[12:15], s57 offen offset:1024 lds
    s_waitcnt vmcnt(10)
    v_cmp_ne_u32 vcc, s47, v17
    s_nop 0
    s_cbranch_vccz L_ok8
    s_mov_b32 s59, 100000
L_spin7:
    buffer_load_dword v17, v20, s[24:27], 0 offen sc1
    s_waitcnt vmcnt(0)
    v_cmp_ne_u32 vcc, s47, v17
    s_nop 0
    s_cbranch_vccz L_ok8
    s_sub_u32 s59, s59, 1
    s_cbranch_scc0 L_spin7
L_ok8:
    s_cmp_ge_u32 s89, 4
    s_cbranch_scc1 L_p3_alt
    s_mov_b32 s66, s68
    s_add_u32 s58, s66, s76
    buffer_load_dwordx4 v[144:147], v23, s[24:27], s58 offen offset:0 sc1
    buffer_load_dwordx4 v[148:151], v23, s[24:27], s58 offen offset:1024 sc1
    s_add_u32 s58, s66, s77
    buffer_load_dwordx4 v[152:155], v23, s[24:27], s58 offen offset:0 sc1
    buffer_load_dwordx4 v[156:159], v23, s[24:27], s58 offen offset:1024 sc1
    s_add_u32 s58, s66, s78
    buffer_load_dwordx4 v[112:115], v23, s[24:27], s58 offen offset:0 sc1
    buffer_load_dwordx4 v[116:119], v23, s[24:27], s58 offen offset:1024 sc1
    s_add_u32 s58, s66, s79
    buffer_load_dwordx4 v[120:123], v23, s[24:27], s58 offen offset:0 sc1
    buffer_load_dwordx4 v[124:127], v23, s[24:27], s58 offen offset:1024 sc1
    s_add_u32 s58, s66, s80
    buffer_load_dwordx4 v[128:131], v23, s[24:27], s58 offen offset:0 sc1
    buffer_load_dwordx4 v[132:135], v23, s[24:27], s58 offen offset:1024 sc1
    s_add_u32 s58, s66, s81
    buffer_load_dwordx4 v[136:139], v23, s[24:27], s58 offen offset:0 sc1
    s_waitcnt vmcnt(10)
    v_mfma_f32_16x16x32_bf16 v[96:99], v[144:147], a[0:3], v[96:99]
    v_mfma_f32_16x16x32_bf16 v[100:103], v[144:147], a[4:7], 0
    buffer_load_dwordx4 v[140:143], v23, s[24:27], s58 offen offset:1024 sc1
    v_mfma_f32_16x16x32_bf16 v[104:107], v[144:147], a[8:11], 0
    v_mfma_f32_16x16x32_bf16 v[108:111], v[144:147], a[12:15], 0
    s_waitcnt vmcnt(10)
    v_mfma_f32_16x16x32_bf16 v[96:99], v[148:151], a[16:19], v[96:99]
    s_add_u32 s58, s66, s82
    v_mfma_f32_16x16x32_bf16 v[100:103], v[148:151], a[20:23], v[100:103]
    buffer_load_dwordx4 v[144:147], v23, s[24:27], s58 offen offset:0 sc1
    v_mfma_f32_16x16x32_bf16 v[104:107], v[148:151], a[24:27], v[104:107]
    v_mfma_f32_16x16x32_bf16 v[108:111], v[148:151], a[28:31], v[108:111]
    s_waitcnt vmcnt(10)
    v_mfma_f32_16x16x32_bf16 v[96:99], v[152:155], a[32:35], v[96:99]
    v_mfma_f32_16x16x32_bf16 v[100:103], v[152:155], a[36:39], v[100:103]
    buffer_load_dwordx4 v[148:151], v23, s[24:27], s58 offen offset:1024 sc1
    v_mfma_f32_16x16x32_bf16 v[104:107], v[152:155], a[40:43], v[104:107]
    v_mfma_f32_16x16x32_bf16 v[108:111], v[152:155], a[44:47], v[108:111]
    s_waitcnt vmcnt(10)
    v_mfma_f32_16x16x32_bf16 v[96:99], v[156:159], a[48:51], v[96:99]
    s_add_u32 s66, s69, 175872
    s_add_u32 s58, s66, s76
    v_mfma_f32_16x16x32_bf16 v[100:103], v[156:159], a[52:55], v[100:103]
    buffer_load_dwordx4 v[152:155], v23, s[24:27], s58 offen offset:0 sc1
    v_mfma_f32_16x16x32_bf16 v[104:107], v[156:159], a[56:59], v[104:107]
    v_mfma_f32_16x16x32_bf16 v[108:111], v[156:159], a[60:63], v[108:111]
    s_waitcnt vmcnt(10)
    v_mfma_f32_16x16x32_bf16 v[96:99], v[112:115], a[64:67], v[96:99]
    v_mfma_f32_16x16x32_bf16 v[100:103], v[112:115], a[68:71], v[100:103]
    buffer_load_dwordx4 v[156:159], v23, s[24:27], s58 offen offset:1024 sc1
    v_mfma_f32_16x16x32_bf16 v[104:107], v[112:115], a[72:75], v[104:107]
    v_mfma_f32_16x16x32_bf16 v[108:111], v[112:115], a[76:79], v[108:111]
    s_waitcnt vmcnt(10)
    v_mfma_f32_16x16x32_bf16 v[96:99], v[116:119], a[80:83], v[96:99]
    s_add_u32 s58, s66, s77
    v_mfma_f32_16x16x32_bf16 v[100:103], v[116:119], a[84:87], v[100:103]
    buffer_load_dwordx4 v[112:115], v23, s[24:27], s58 offen offset:0 sc1
    v_mfma_f32_16x16x32_bf16 v[104:107], v[116:119], a[88:91], v[104:107]
    v_mfma_f32_16x16x32_bf16 v[108:111], v[116:119], a[92:95], v[108:111]
    s_waitcnt vmcnt(10)
    v_mfma_f32_16x16x32_bf16 v[96:99], v[120:123], a[96:99], v[96:99]
    v_mfma_f32_16x16x32_bf16 v[100:103], v[120:123], a[100:103], v[100:103]
    buffer_load_dwordx4 v[116:119], v23, s[24:27], s58 offen offset:1024 sc1
    v_mfma_f32_16x16x32_bf16 v[104:107], v[120:123], a[104:107], v[104:107]
    v_mfma_f32_16x16x32_bf16 v[108:111], v[120:123], a[108:111], v[108:111]
    s_waitcnt vmcnt(10)
    v_mfma_f32_16x16x32_bf16 v[96:99], v[124:127], a[112:115], v[96:99]
    s_add_u32 s58, s66, s78
    v_mfma_f32_16x16x32_bf16 v[100:103], v[124:127], a[116:119], v[100:103]
    buffer_load_dwordx4 v[120:123], v23, s[24:27], s58 offen offset:0 sc1
    v_mfma_f32_16x16x32_bf16 v[104:107], v[124:127], a[120:123], v[104:107]
    v_mfma_f32_16x16x32_bf16 v[108:111], v[124:127], a[124:127], v[108:111]
    s_waitcnt vmcnt(10)
    v_mfma_f32_16x16x32_bf16 v[96:99], v[128:131], a[128:131], v[96:99]
    v_mfma_f32_16x16x32_bf16 v[100:103], v[128:131], a[132:135], v[100:103]
    buffer_load_dwordx4 v[124:127], v23, s[24:27], s58 offen offset:1024 sc1
    v_mfma_f32_16x16x32_bf16 v[104:107], v[128:131], a[136:139], v[104:107]
    v_mfma_f32_16x16x32_bf16 v[108:111], v[128:131], a[140:143], v[108:111]
    s_waitcnt vmcnt(10)
    v_mfma_f32_16x16x32_bf16 v[96:99], v[132:135], a[144:147], v[96:99]
    s_add_u32 s58, s66, s79
    v_mfma_f32_16x16x32_bf16 v[100:103], v[132:135], a[148:151], v[100:103]
    buffer_load_dwordx4 v[128:131], v23, s[24:27], s58 offen offset:0 sc1
    v_mfma_f32_16x16x32_bf16 v[104:107], v[132:135], a[152:155], v[104:107]
    v_mfma_f32_16x16x32_bf16 v[108:111], v[132:135], a[156:159], v[108:111]
    s_waitcnt vmcnt(10)
    v_mfma_f32_16x16x32_bf16 v[96:99], v[136:139], a[160:163], v[96:99]
    v_mfma_f32_16x16x32_bf16 v[100:103], v[136:139], a[164:167], v[100:103]
    buffer_load_dwordx4 v[132:135], v23, s[24:27], s58 offen offset:1024 sc1
    v_mfma_f32_16x16x32_bf16 v[104:107], v[136:139], a[168:171], v[104:107]
    v_mfma_f32_16x16x32_bf16 v[108:111], v[136:139], a[172:175], v[108:111]
    s_waitcnt vmcnt(10)
    v_mfma_f32_16x16x32_bf16 v[96:99], v[140:143], a[176:179], v[96:99]
    s_add_u32 s58, s66, s80
    v_mfma_f32_16x16x32_bf16 v[100:103], v[140:143], a[180:183], v[100:103]
    buffer_load_dwordx4 v[136:139], v23, s[24:27], s58 offen offset:0 sc1
    v_mfma_f32_16x16x32_bf16 v[104:107], v[140:143], a[184:187], v[104:107]
    v_mfma_f32_16x16x32_bf16 v[108:111], v[140:143], a[188:191], v[108:111]
    s_waitcnt vmcnt(10)
    s_waitcnt lgkmcnt(8)
    v_mfma_f32_16x16x32_bf16 v[96:99], v[144:147], a[192:195], v[96:99]
    v_mfma_f32_16x16x32_bf16 v[100:103], v[144:147], a[196:199], v[100:103]
    buffer_load_dwordx4 v[140:143], v23, s[24:27], s58 offen offset:1024 sc1
    v_mfma_f32_16x16x32_bf16 v[104:107], v[144:147], a[200:203], v[104:107]
    v_mfma_f32_16x16x32_bf16 v[108:111], v[144:147], a[204:207], v[108:111]
    s_waitcnt vmcnt(10)
    s_waitcnt lgkmcnt(0)
    v_mfma_f32_16x16x32_bf16 v[96:99], v[148:151], a[208:211], v[96:99]
    s_add_u32 s58, s66, s81
    v_mfma_f32_16x16x32_bf16 v[100:103], v[148:151], a[212:215], v[100:103]
    buffer_load_dwordx4 v[144:147], v23, s[24:27], s58 offen offset:0 sc1
    v_mfma_f32_16x16x32_bf16 v[104:107], v[148:151], a[216:219], v[104:107]
    v_mfma_f32_16x16x32_bf16 v[108:111], v[148:151], a[220:223], v[108:111]
L_p3_join:
    s_waitcnt vmcnt(10)
    v_mfma_f32_16x16x32_bf16 v[80:83], v[152:155], a[0:3], v[80:83]
    v_mfma_f32_16x16x32_bf16 v[84:87], v[152:155], a[4:7], 0
    buffer_load_dwordx4 v[148:151], v23, s[24:27], s58 offen offset:1024 sc1
    v_mfma_f32_16x16x32_bf16 v[88:91], v[152:155], a[8:11], 0
    v_mfma_f32_16x16x32_bf16 v[92:95], v[152:155], a[12:15], 0
    s_waitcnt vmcnt(10)
    v_mfma_f32_16x16x32_bf16 v[80:83], v[156:159], a[16:19], v[80:83]
    s_add_u32 s58, s66, s82
    v_mfma_f32_16x16x32_bf16 v[84:87], v[156:159], a[20:23], v[84:87]
    buffer_load_dwordx4 v[152:155], v23, s[24:27], s58 offen offset:0 sc1
    v_mfma_f32_16x16x32_bf16 v[88:91], v[156:159], a[24:27], v[88:91]
    ds_write_b128 v232, v[100:103] offset:3072
    v_mfma_f32_16x16x32_bf16 v[92:95], v[156:159], a[28:31], v[92:95]
    s_waitcnt vmcnt(10)
    v_mfma_f32_16x16x32_bf16 v[80:83], v[112:115], a[32:35], v[80:83]
    v_mfma_f32_16x16x32_bf16 v[84:87], v[112:115], a[36:39], v[84:87]
    buffer_load_dwordx4 v[156:159], v23, s[24:27], s58 offen offset:1024 sc1
    v_mfma_f32_16x16x32_bf16 v[88:91], v[112:115], a[40:43], v[88:91]
    ds_write_b128 v232, v[104:107] offset:19456
    v_mfma_f32_16x16x32_bf16 v[92:95], v[112:115], a[44:47], v[92:95]
    s_waitcnt vmcnt(10)
    v_mfma_f32_16x16x32_bf16 v[80:83], v[116:119], a[48:51], v[80:83]
    s_add_u32 s66, s69, 117248
    s_add_u32 s58, s66, s76
    v_mfma_f32_16x16x32_bf16 v[84:87], v[116:119], a[52:55], v[84:87]
    buffer_load_dwordx4 v[112:115], v23, s[24:27], s58 offen offset:0 sc1
    v_mfma_f32_16x16x32_bf16 v[88:91], v[116:119], a[56:59], v[88:91]
    ds_write_b128 v232, v[108:111] offset:35840
    v_mfma_f32_16x16x32_bf16 v[92:95], v[116:119], a[60:63], v[92:95]
    s_waitcnt vmcnt(10)
    v_mfma_f32_16x16x32_bf16 v[80:83], v[120:123], a[64:67], v[80:83]
    v_mfma_f32_16x16x32_bf16 v[84:87], v[120:123], a[68:71], v[84:87]
    buffer_load_dwordx4 v[116:119], v23, s[24:27], s58 offen offset:1024 sc1
    v_mfma_f32_16x16x32_bf16 v[88:91], v[120:123], a[72:75], v[88:91]
    v_mfma_f32_16x16x32_bf16 v[92:95], v[120:123], a[76:79], v[92:95]
    s_waitcnt vmcnt(10)
    v_mfma_f32_16x16x32_bf16 v[80:83], v[124:127], a[80:83], v[80:83]
    s_add_u32 s58, s66, s77
    v_mfma_f32_16x16x32_bf16 v[84:87], v[124:127], a[84:87], v[84:87]
    buffer_load_dwordx4 v[120:123], v23, s[24:27], s58 offen offset:0 sc1
    v_mfma_f32_16x16x32_bf16 v[88:91], v[124:127], a[88:91], v[88:91]
    s_waitcnt lgkmcnt(0)
    s_barrier
    v_mfma_f32_16x16x32_bf16 v[92:95], v[124:127], a[92:95], v[92:95]
    s_waitcnt vmcnt(10)
    v_mfma_f32_16x16x32_bf16 v[80:83], v[128:131], a[96:99], v[80:83]
    v_mfma_f32_16x16x32_bf16 v[84:87], v[128:131], a[100:103], v[84:87]
    buffer_load_dwordx4 v[124:127], v23, s[24:27], s58 offen offset:1024 sc1
    v_mfma_f32_16x16x32_bf16 v[88:91], v[128:131], a[104:107], v[88:91]
    ds_read_b128 v[100:103], v233 offset:3072
    ds_read_b128 v[104:107], v234 offset:19456
    v_mfma_f32_16x16x32_bf16 v[92:95], v[128:131], a[108:111], v[92:95]
    ds_read_b128 v[108:111], v235 offset:35840
    s_waitcnt vmcnt(10)
    v_mfma_f32_16x16x32_bf16 v[80:83], v[132:135], a[112:115], v[80:83]
    s_add_u32 s58, s66, s78
    v_mfma_f32_16x16x32_bf16 v[84:87], v[132:135], a[116:119], v[84:87]
    buffer_load_dwordx4 v[128:131], v23, s[24:27], s58 offen offset:0 sc1
    v_mfma_f32_16x16x32_bf16 v[88:91], v[132:135], a[120:123], v[88:91]
    ds_read_b64_tr_b16 v[160:161], v16 offset:0
    v_mfma_f32_16x16x32_bf16 v[92:95], v[132:135], a[124:127], v[92:95]
    ds_read_b64_tr_b16 v[162:163], v16 offset:512
    s_waitcnt vmcnt(10)
    v_mfma_f32_16x16x32_bf16 v[80:83], v[136:139], a[128:131], v[80:83]
    s_waitcnt lgkmcnt(2)
    v_mfma_f32_16x16x32_bf16 v[84:87], v[136:139], a[132:135], v[84:87]
    buffer_load_dwordx4 v[132:135], v23, s[24:27], s58 offen offset:1024 sc1
    v_mfma_f32_16x16x32_bf16 v[88:91], v[136:139], a[136:139], v[88:91]
    v_add_f32 v96, v96, v100
    v_add_f32 v97, v97, v101
    ds_read_b64_tr_b16 v[164:165], v16 offset:4096
    v_mfma_f32_16x16x32_bf16 v[92:95], v[136:139], a[140:143], v[92:95]
    ds_read_b64_tr_b16 v[166:167], v16 offset:4608
    s_waitcnt vmcnt(10)
    v_mfma_f32_16x16x32_bf16 v[80:83], v[140:143], a[144:147], v[80:83]
    s_add_u32 s58, s66, s79
    v_add_f32 v98, v98, v102
    v_mfma_f32_16x16x32_bf16 v[84:87], v[140:143], a[148:151], v[84:87]
    buffer_load_dwordx4 v[136:139], v23, s[24:27], s58 offen offset:0 sc1
    v_mfma_f32_16x16x32_bf16 v[88:91], v[140:143], a[152:155], v[88:91]
    v_add_f32 v99, v99, v103
    v_add_f32 v96, v96, v104
    ds_read_b64_tr_b16 v[168:169], v16 offset:8192
    v_mfma_f32_16x16x32_bf16 v[92:95], v[140:143], a[156:159], v[92:95]
    ds_read_b64_tr_b16 v[170:171], v16 offset:8704
    s_waitcnt vmcnt(10)
    v_mfma_f32_16x16x32_bf16 v[80:83], v[144:147], a[160:163], v[80:83]
    v_add_f32 v97, v97, v105
    v_mfma_f32_16x16x32_bf16 v[84:87], v[144:147], a[164:167], v[84:87]
    buffer_load_dwordx4 v[140:143], v23, s[24:27], s58 offen offset:1024 sc1
    v_mfma_f32_16x16x32_bf16 v[88:91], v[144:147], a[168:171], v[88:91]
    v_add_f32 v98, v98, v106
    v_add_f32 v99, v99, v107
    ds_read_b64_tr_b16 v[172:173], v16 offset:12288
    v_mfma_f32_16x16x32_bf16 v[92:95], v[144:147], a[172:175], v[92:95]
    ds_read_b64_tr_b16 v[174:175], v16 offset:12800
    s_waitcnt vmcnt(10)
    v_mfma_f32_16x16x32_bf16 v[80:83], v[148:151], a[176:179], v[80:83]
    s_add_u32 s58, s66, s80
    v_mfma_f32_16x16x32_bf16 v[84:87], v[148:151], a[180:183], v[84:87]
    buffer_load_dwordx4 v[144:147], v23, s[24:27], s58 offen offset:0 sc1
    v_mfma_f32_16x16x32_bf16 v[88:91], v[148:151], a[184:187], v[88:91]
    v_add_f32 v96, v96, v108
    v_add_f32 v97, v97, v109
    v_mfma_f32_16x16x32_bf16 v[92:95], v[148:151], a[188:191], v[92:95]
    v_add_f32 v98, v98, v110
    s_waitcnt vmcnt(10)
    v_mfma_f32_16x16x32_bf16 v[80:83], v[152:155], a[192:195], v[80:83]
    v_mfma_f32_16x16x32_bf16 v[84:87], v[152:155], a[196:199], v[84:87]
    buffer_load_dwordx4 v[148:151], v23, s[24:27], s58 offen offset:1024 sc1
    v_mfma_f32_16x16x32_bf16 v[88:91], v[152:155], a[200:203], v[88:91]
    v_add_f32 v99, v99, v111
    v_mfma_f32_16x16x32_bf16 v[92:95], v[152:155], a[204:207], v[92:95]
    s_waitcnt vmcnt(10)
    v_mfma_f32_16x16x32_bf16 v[80:83], v[156:159], a[208:211], v[80:83]
    s_add_u32 s58, s66, s81
    v_mfma_f32_16x16x32_bf16 v[84:87], v[156:159], a[212:215], v[84:87]
    buffer_load_dwordx4 v[152:155], v23, s[24:27], s58 offen offset:0 sc1
    v_mfma_f32_16x16x32_bf16 v[88:91], v[156:159], a[216:219], v[88:91]
    v_mfma_f32_16x16x32_bf16 v[92:95], v[156:159], a[220:223], v[92:95]
    s_waitcnt vmcnt(10)
    v_mfma_f32_16x16x32_bf16 v[64:67], v[112:115], a[0:3], v[64:67]
    v_mfma_f32_16x16x32_bf16 v[68:71], v[112:115], a[4:7], 0
    buffer_load_dwordx4 v[156:159], v23, s[24:27], s58 offen offset:1024 sc1
    v_mfma_f32_16x16x32_bf16 v[72:75], v[112:115], a[8:11], 0
    ds_read_b64_tr_b16 v[192:193], v16 offset:1024
    v_mfma_f32_16x16x32_bf16 v[76:79], v[112:115], a[12:15], 0
    ds_read_b64_tr_b16 v[194:195], v16 offset:1536
    s_waitcnt vmcnt(10)
    v_mfma_f32_16x16x32_bf16 v[64:67], v[116:119], a[16:19], v[64:67]
    s_add_u32 s58, s66, s82
    v_mfma_f32_16x16x32_bf16 v[68:71], v[116:119], a[20:23], v[68:71]
    buffer_load_dwordx4 v[112:115], v23, s[24:27], s58 offen offset:0 sc1
    v_mfma_f32_16x16x32_bf16 v[72:75], v[116:119], a[24:27], v[72:75]
    ds_read_b64_tr_b16 v[196:197], v16 offset:5120
    ds_read_b64_tr_b16 v[198:199], v16 offset:5632
    v_mfma_f32_16x16x32_bf16 v[76:79], v[116:119], a[28:31], v[76:79]
    ds_write_b128 v232, v[84:87] offset:49152
    s_waitcnt vmcnt(10)
    v_mfma_f32_16x16x32_bf16 v[64:67], v[120:123], a[32:35], v[64:67]
    v_mfma_f32_16x16x32_bf16 v[68:71], v[120:123], a[36:39], v[68:71]
    buffer_load_dwordx4 v[116:119], v23, s[24:27], s58 offen offset:1024 sc1
    v_mfma_f32_16x16x32_bf16 v[72:75], v[120:123], a[40:43], v[72:75]
    ds_read_b64_tr_b16 v[200:201], v16 offset:9216
    ds_read_b64_tr_b16 v[202:203], v16 offset:9728
    v_mfma_f32_16x16x32_bf16 v[76:79], v[120:123], a[44:47], v[76:79]
    ds_write_b128 v232, v[88:91] offset:50176
    s_waitcnt vmcnt(10)
    v_mfma_f32_16x16x32_bf16 v[64:67], v[124:127], a[48:51], v[64:67]
    s_add_u32 s66, s69, 58624
    s_add_u32 s58, s66, s76
    v_mfma_f32_16x16x32_bf16 v[68:71], v[124:127], a[52:55], v[68:71]
    buffer_load_dwordx4 v[120:123], v23, s[24:27], s58 offen offset:0 sc1
    v_mfma_f32_16x16x32_bf16 v[72:75], v[124:127], a[56:59], v[72:75]
    ds_read_b64_tr_b16 v[204:205], v16 offset:13312
    ds_read_b64_tr_b16 v[206:207], v16 offset:13824
    v_mfma_f32_16x16x32_bf16 v[76:79], v[124:127], a[60:63], v[76:79]
    ds_write_b128 v232, v[92:95] offset:51200
    s_waitcnt vmcnt(10)
    v_mfma_f32_16x16x32_bf16 v[64:67], v[128:131], a[64:67], v[64:67]
    v_mfma_f32_16x16x32_bf16 v[68:71], v[128:131], a[68:71], v[68:71]
    buffer_load_dwordx4 v[124:127], v23, s[24:27], s58 offen offset:1024 sc1
    v_mfma_f32_16x16x32_bf16 v[72:75], v[128:131], a[72:75], v[72:75]
    ds_read_b64_tr_b16 v[100:101], v16 offset:2048
    v_mfma_f32_16x16x32_bf16 v[76:79], v[128:131], a[76:79], v[76:79]
    ds_read_b64_tr_b16 v[102:103], v16 offset:2560
    s_waitcnt vmcnt(10)
    v_mfma_f32_16x16x32_bf16 v[64:67], v[132:135], a[80:83], v[64:67]
    s_add_u32 s58, s66, s77
    v_mfma_f32_16x16x32_bf16 v[68:71], v[132:135], a[84:87], v[68:71]
    buffer_load_dwordx4 v[128:131], v23, s[24:27], s58 offen offset:0 sc1
    v_mfma_f32_16x16x32_bf16 v[72:75], v[132:135], a[88:91], v[72:75]
    s_waitcnt lgkmcnt(2)
    s_barrier
    v_mfma_f32_16x16x32_bf16 v[76:79], v[132:135], a[92:95], v[76:79]
    s_waitcnt vmcnt(10)
    v_mfma_f32_16x16x32_bf16 v[64:67], v[136:139], a[96:99], v[64:67]
    v_mfma_f32_16x16x32_bf16 v[68:71], v[136:139], a[100:103], v[68:71]
    buffer_load_dwordx4 v[132:135], v23, s[24:27], s58 offen offset:1024 sc1
    v_mfma_f32_16x16x32_bf16 v[72:75], v[136:139], a[104:107], v[72:75]
    ds_read_b128 v[84:87], v233 offset:49152
    ds_read_b128 v[88:91], v234 offset:50176
    v_mfma_f32_16x16x32_bf16 v[76:79], v[136:139], a[108:111], v[76:79]
    ds_read_b128 v[92:95], v235 offset:51200
    s_waitcnt vmcnt(10)
    v_mfma_f32_16x16x32_bf16 v[64:67], v[140:143], a[112:115], v[64:67]
    s_add_u32 s58, s66, s78
    v_mfma_f32_16x16x32_bf16 v[68:71], v[140:143], a[116:119], v[68:71]
    buffer_load_dwordx4 v[136:139], v23, s[24:27], s58 offen offset:0 sc1
    v_mfma_f32_16x16x32_bf16 v[72:75], v[140:143], a[120:123], v[72:75]
    ds_read_b64_tr_b16 a[224:225], v246 offset:0
    v_mfma_f32_16x16x32_bf16 v[76:79], v[140:143], a[124:127], v[76:79]
    ds_read_b64_tr_b16 a[226:227], v246 offset:512
    s_waitcnt vmcnt(10)
    v_mfma_f32_16x16x32_bf16 v[64:67], v[144:147], a[128:131], v[64:67]
    s_waitcnt lgkmcnt(2)
    v_mfma_f32_16x16x32_bf16 v[68:71], v[144:147], a[132:135], v[68:71]
    buffer_load_dwordx4 v[140:143], v23, s[24:27], s58 offen offset:1024 sc1
    v_mfma_f32_16x16x32_bf16 v[72:75], v[144:147], a[136:139], v[72:75]
    v_add_f32 v80, v80, v84
    v_add_f32 v81, v81, v85
    ds_read_b64_tr_b16 a[228:229], v247 offset:0
    v_mfma_f32_16x16x32_bf16 v[76:79], v[144:147], a[140:143], v[76:79]
    ds_read_b64_tr_b16 a[230:231], v247 offset:512
    s_waitcnt vmcnt(10)
    v_mfma_f32_16x16x32_bf16 v[64:67], v[148:151], a[144:147], v[64:67]
    s_add_u32 s58, s66, s79
    v_add_f32 v82, v82, v86
    v_mfma_f32_16x16x32_bf16 v[68:71], v[148:151], a[148:151], v[68:71]
    buffer_load_dwordx4 v[144:147], v23, s[24:27], s58 offen offset:0 sc1
    v_mfma_f32_16x16x32_bf16 v[72:75], v[148:151], a[152:155], v[72:75]
    v_add_f32 v83, v83, v87
    v_add_f32 v80, v80, v88
    ds_read_b64_tr_b16 a[232:233], v246 offset:256
    v_mfma_f32_16x16x32_bf16 v[76:79], v[148:151], a[156:159], v[76:79]
    ds_read_b64_tr_b16 a[234:235], v246 offset:768
    s_waitcnt vmcnt(10)
    v_mfma_f32_16x16x32_bf16 v[64:67], v[152:155], a[160:163], v[64:67]
    v_add_f32 v81, v81, v89
    v_mfma_f32_16x16x32_bf16 v[68:71], v[152:155], a[164:167], v[68:71]
    buffer_load_dwordx4 v[148:151], v23, s[24:27], s58 offen offset:1024 sc1
    v_mfma_f32_16x16x32_bf16 v[72:75], v[152:155], a[168:171], v[72:75]
    v_add_f32 v82, v82, v90
    v_add_f32 v83, v83, v91
    ds_read_b64_tr_b16 a[236:237], v247 offset:256
    v_mfma_f32_16x16x32_bf16 v[76:79], v[152:155], a[172:175], v[76:79]
    ds_read_b64_tr_b16 a[238:239], v247 offset:768
    s_waitcnt vmcnt(10)
    v_mfma_f32_16x16x32_bf16 v[64:67], v[156:159], a[176:179], v[64:67]
    s_add_u32 s58, s66, s80
    v_mfma_f32_16x16x32_bf16 v[68:71], v[156:159], a[180:183], v[68:71]
    buffer_load_dwordx4 v[152:155], v23, s[24:27], s58 offen offset:0 sc1
    v_mfma_f32_16x16x32_bf16 v[72:75], v[156:159], a[184:187], v[72:75]
    v_add_f32 v80, v80, v92
    v_add_f32 v81, v81, v93
    v_mfma_f32_16x16x32_bf16 v[76:79], v[156:159], a[188:191], v[76:79]
    v_add_f32 v82, v82, v94
    s_waitcnt vmcnt(10)
    v_mfma_f32_16x16x32_bf16 v[64:67], v[112:115], a[192:195], v[64:67]
    v_mfma_f32_16x16x32_bf16 v[68:71], v[112:115], a[196:199], v[68:71]
    buffer_load_dwordx4 v[156:159], v23, s[24:27], s58 offen offset:1024 sc1
    v_mfma_f32_16x16x32_bf16 v[72:75], v[112:115], a[200:203], v[72:75]
    v_add_f32 v83, v83, v95
    v_mfma_f32_16x16x32_bf16 v[76:79], v[112:115], a[204:207], v[76:79]
    s_waitcnt vmcnt(10)
    v_mfma_f32_16x16x32_bf16 v[64:67], v[116:119], a[208:211], v[64:67]
    s_add_u32 s58, s66, s81
    v_mfma_f32_16x16x32_bf16 v[68:71], v[116:119], a[212:215], v[68:71]
    buffer_load_dwordx4 v[112:115], v23, s[24:27], s58 offen offset:0 sc1
    v_mfma_f32_16x16x32_bf16 v[72:75], v[116:119], a[216:219], v[72:75]
    v_mfma_f32_16x16x32_bf16 v[76:79], v[116:119], a[220:223], v[76:79]
    s_waitcnt vmcnt(10)
    v_mfma_f32_16x16x32_bf16 v[48:51], v[120:123], a[0:3], v[48:51]
    v_mfma_f32_16x16x32_bf16 v[52:55], v[120:123], a[4:7], 0
    buffer_load_dwordx4 v[116:119], v23, s[24:27], s58 offen offset:1024 sc1
    v_mfma_f32_16x16x32_bf16 v[56:59], v[120:123], a[8:11], 0
    ds_read_b64_tr_b16 v[104:105], v16 offset:6144
    v_mfma_f32_16x16x32_bf16 v[60:63], v[120:123], a[12:15], 0
    ds_read_b64_tr_b16 v[106:107], v16 offset:6656
    s_waitcnt vmcnt(10)
    v_mfma_f32_16x16x32_bf16 v[48:51], v[124:127], a[16:19], v[48:51]
    s_add_u32 s58, s66, s82
    v_mfma_f32_16x16x32_bf16 v[52:55], v[124:127], a[20:23], v[52:55]
    buffer_load_dwordx4 v[120:123], v23, s[24:27], s58 offen offset:0 sc1
    v_mfma_f32_16x16x32_bf16 v[56:59], v[124:127], a[24:27], v[56:59]
    ds_read_b64_tr_b16 v[108:109], v16 offset:10240
    ds_read_b64_tr_b16 v[110:111], v16 offset:10752
    v_mfma_f32_16x16x32_bf16 v[60:63], v[124:127], a[28:31], v[60:63]
    ds_write_b128 v232, v[68:71] offset:32768
    s_waitcnt vmcnt(10)
    v_mfma_f32_16x16x32_bf16 v[48:51], v[128:131], a[32:35], v[48:51]
    v_mfma_f32_16x16x32_bf16 v[52:55], v[128:131], a[36:39], v[52:55]
    buffer_load_dwordx4 v[124:127], v23, s[24:27], s58 offen offset:1024 sc1
    v_mfma_f32_16x16x32_bf16 v[56:59], v[128:131], a[40:43], v[56:59]
    ds_read_b64_tr_b16 v[84:85], v16 offset:14336
    ds_read_b64_tr_b16 v[86:87], v16 offset:14848
    v_mfma_f32_16x16x32_bf16 v[60:63], v[128:131], a[44:47], v[60:63]
    ds_write_b128 v232, v[72:75] offset:33792
    s_waitcnt vmcnt(10)
    v_mfma_f32_16x16x32_bf16 v[48:51], v[132:135], a[48:51], v[48:51]
    s_add_u32 s66, s69, 0
    s_add_u32 s58, s66, s76
    v_mfma_f32_16x16x32_bf16 v[52:55], v[132:135], a[52:55], v[52:55]
    buffer_load_dwordx4 v[128:131], v23, s[24:27], s58 offen offset:0 sc1
    v_mfma_f32_16x16x32_bf16 v[56:59], v[132:135], a[56:59], v[56:59]
    ds_read_b64_tr_b16 v[88:89], v16 offset:3072
    ds_read_b64_tr_b16 v[90:91], v16 offset:3584
    v_mfma_f32_16x16x32_bf16 v[60:63], v[132:135], a[60:63], v[60:63]
    ds_write_b128 v232, v[76:79] offset:34816
    s_waitcnt vmcnt(10)
    v_mfma_f32_16x16x32_bf16 v[48:51], v[136:139], a[64:67], v[48:51]
    v_mfma_f32_16x16x32_bf16 v[52:55], v[136:139], a[68:71], v[52:55]
    buffer_load_dwordx4 v[132:135], v23, s[24:27], s58 offen offset:1024 sc1
    v_mfma_f32_16x16x32_bf16 v[56:59], v[136:139], a[72:75], v[56:59]
    ds_read_b64_tr_b16 v[92:93], v16 offset:7168
    v_mfma_f32_16x16x32_bf16 v[60:63], v[136:139], a[76:79], v[60:63]
    ds_read_b64_tr_b16 v[94:95], v16 offset:7680
    s_waitcnt vmcnt(10)
    v_mfma_f32_16x16x32_bf16 v[48:51], v[140:143], a[80:83], v[48:51]
    s_add_u32 s58, s66, s77
    v_mfma_f32_16x16x32_bf16 v[52:55], v[140:143], a[84:87], v[52:55]
    buffer_load_dwordx4 v[136:139], v23, s[24:27], s58 offen offset:0 sc1
    v_mfma_f32_16x16x32_bf16 v[56:59], v[140:143], a[88:91], v[56:59]
    s_waitcnt lgkmcnt(2)
    s_barrier
    v_mfma_f32_16x16x32_bf16 v[60:63], v[140:143], a[92:95], v[60:63]
    s_waitcnt vmcnt(10)
    v_mfma_f32_16x16x32_bf16 v[48:51], v[144:147], a[96:99], v[48:51]
    v_mfma_f32_16x16x32_bf16 v[52:55], v[144:147], a[100:103], v[52:55]
    buffer_load_dword v19, v21, s[24:27], 0 offen sc1
    v_mfma_f32_16x16x32_bf16 v[56:59], v[144:147], a[104:107], v[56:59]
    ds_read_b128 v[68:71], v233 offset:32768
    ds_read_b128 v[72:75], v234 offset:33792
    v_mfma_f32_16x16x32_bf16 v[60:63], v[144:147], a[108:111], v[60:63]
    ds_read_b128 v[76:79], v235 offset:34816
    s_waitcnt vmcnt(10)
    v_mfma_f32_16x16x32_bf16 v[48:51], v[148:151], a[112:115], v[48:51]
    v_mfma_f32_16x16x32_bf16 v[52:55], v[148:151], a[116:119], v[52:55]
    buffer_load_dwordx4 v[140:143], v23, s[24:27], s58 offen offset:1024 sc1
    v_mfma_f32_16x16x32_bf16 v[56:59], v[148:151], a[120:123], v[56:59]
    ds_read_b64_tr_b16 a[240:241], v246 offset:4096
    v_mfma_f32_16x16x32_bf16 v[60:63], v[148:151], a[124:127], v[60:63]
    ds_read_b64_tr_b16 a[242:243], v246 offset:4608
    s_waitcnt vmcnt(10)
    v_mfma_f32_16x16x32_bf16 v[48:51], v[152:155], a[128:131], v[48:51]
    s_add_u32 s58, s66, s78
    s_waitcnt lgkmcnt(2)
    v_mfma_f32_16x16x32_bf16 v[52:55], v[152:155], a[132:135], v[52:55]
    buffer_load_dwordx4 v[144:147], v23, s[24:27], s58 offen offset:0 sc1
    v_mfma_f32_16x16x32_bf16 v[56:59], v[152:155], a[136:139], v[56:59]
    v_add_f32 v64, v64, v68
    v_add_f32 v65, v65, v69
    ds_read_b64_tr_b16 a[244:245], v247 offset:4096
    v_mfma_f32_16x16x32_bf16 v[60:63], v[152:155], a[140:143], v[60:63]
    ds_read_b64_tr_b16 a[246:247], v247 offset:4608
    s_waitcnt vmcnt(10)
    v_mfma_f32_16x16x32_bf16 v[48:51], v[156:159], a[144:147], v[48:51]
    v_add_f32 v66, v66, v70
    v_mfma_f32_16x16x32_bf16 v[52:55], v[156:159], a[148:151], v[52:55]
    buffer_load_dwordx4 v[148:151], v23, s[24:27], s58 offen offset:1024 sc1
    v_mfma_f32_16x16x32_bf16 v[56:59], v[156:159], a[152:155], v[56:59]
    v_add_f32 v67, v67, v71
    v_add_f32 v64, v64, v72
    ds_read_b64_tr_b16 a[248:249], v246 offset:4352
    v_mfma_f32_16x16x32_bf16 v[60:63], v[156:159], a[156:159], v[60:63]
    ds_read_b64_tr_b16 a[250:251], v246 offset:4864
    s_waitcnt vmcnt(10)
    v_mfma_f32_16x16x32_bf16 v[48:51], v[112:115], a[160:163], v[48:51]
    s_add_u32 s58, s66, s79
    v_add_f32 v65, v65, v73
    v_mfma_f32_16x16x32_bf16 v[52:55], v[112:115], a[164:167], v[52:55]
    buffer_load_dwordx4 v[152:155], v23, s[24:27], s58 offen offset:0 sc1
    v_mfma_f32_16x16x32_bf16 v[56:59], v[112:115], a[168:171], v[56:59]
    v_add_f32 v66, v66, v74
    v_add_f32 v67, v67, v75
    ds_read_b64_tr_b16 a[252:253], v247 offset:4352
    v_mfma_f32_16x16x32_bf16 v[60:63], v[112:115], a[172:175], v[60:63]
    ds_read_b64_tr_b16 a[254:255], v247 offset:4864
    s_waitcnt vmcnt(10)
    v_mfma_f32_16x16x32_bf16 v[48:51], v[116:119], a[176:179], v[48:51]
    v_mfma_f32_16x16x32_bf16 v[52:55], v[116:119], a[180:183], v[52:55]
    buffer_load_dwordx4 v[156:159], v23, s[24:27], s58 offen offset:1024 sc1
    v_mfma_f32_16x16x32_bf16 v[56:59], v[116:119], a[184:187], v[56:59]
    v_add_f32 v64, v64, v76
    v_add_f32 v65, v65, v77
    v_mfma_f32_16x16x32_bf16 v[60:63], v[116:119], a[188:191], v[60:63]
    v_add_f32 v66, v66, v78
    s_waitcnt vmcnt(10)
    v_mfma_f32_16x16x32_bf16 v[48:51], v[120:123], a[192:195], v[48:51]
    s_add_u32 s58, s66, s80
    v_mfma_f32_16x16x32_bf16 v[52:55], v[120:123], a[196:199], v[52:55]
    buffer_load_dwordx4 v[112:115], v23, s[24:27], s58 offen offset:0 sc1
    v_mfma_f32_16x16x32_bf16 v[56:59], v[120:123], a[200:203], v[56:59]
    v_add_f32 v67, v67, v79
    v_mfma_f32_16x16x32_bf16 v[60:63], v[120:123], a[204:207], v[60:63]
    s_waitcnt vmcnt(10)
    v_mfma_f32_16x16x32_bf16 v[48:51], v[124:127], a[208:211], v[48:51]
    v_mfma_f32_16x16x32_bf16 v[52:55], v[124:127], a[212:215], v[52:55]
    buffer_load_dwordx4 v[116:119], v23, s[24:27], s58 offen offset:1024 sc1
    v_mfma_f32_16x16x32_bf16 v[56:59], v[124:127], a[216:219], v[56:59]
    v_mfma_f32_16x16x32_bf16 v[60:63], v[124:127], a[220:223], v[60:63]
    s_waitcnt vmcnt(10)
    v_mfma_f32_16x16x32_bf16 v[32:35], v[128:131], a[0:3], v[32:35]
    s_add_u32 s58, s66, s81
    v_mfma_f32_16x16x32_bf16 v[36:39], v[128:131], a[4:7], 0
    buffer_load_dwordx4 v[120:123], v23, s[24:27], s58 offen offset:0 sc1
    v_mfma_f32_16x16x32_bf16 v[40:43], v[128:131], a[8:11], 0
    v_mfma_f32_16x16x32_bf16 v[44:47], v[128:131], a[12:15], 0
    s_waitcnt vmcnt(10)
    v_mfma_f32_16x16x32_bf16 v[32:35], v[132:135], a[16:19], v[32:35]
    ds_write_b128 v232, v[52:55] offset:16384
    v_mfma_f32_16x16x32_bf16 v[36:39], v[132:135], a[20:23], v[36:39]
    buffer_load_dwordx4 v[124:127], v23, s[24:27], s58 offen offset:1024 sc1
    v_mfma_f32_16x16x32_bf16 v[40:43], v[132:135], a[24:27], v[40:43]
    ds_read_b64_tr_b16 a[0:1], v246 offset:8192
    ds_read_b64_tr_b16 a[2:3], v246 offset:8704
    ds_read_b64_tr_b16 a[4:5], v247 offset:8192
    v_mfma_f32_16x16x32_bf16 v[44:47], v[132:135], a[28:31], v[44:47]
    ds_read_b64_tr_b16 a[6:7], v247 offset:8704
    s_waitcnt vmcnt(10)
    v_mfma_f32_16x16x32_bf16 v[32:35], v[136:139], a[32:35], v[32:35]
    s_add_u32 s58, s66, s82
    ds_write_b128 v232, v[56:59] offset:17408
    v_mfma_f32_16x16x32_bf16 v[36:39], v[136:139], a[36:39], v[36:39]
    buffer_load_dwordx4 v[128:131], v23, s[24:27], s58 offen offset:0 sc1
    v_mfma_f32_16x16x32_bf16 v[40:43], v[136:139], a[40:43], v[40:43]
    ds_read_b64_tr_b16 a[8:9], v246 offset:8448
    ds_read_b64_tr_b16 a[10:11], v246 offset:8960
    ds_read_b64_tr_b16 a[12:13], v247 offset:8448
    v_mfma_f32_16x16x32_bf16 v[44:47], v[136:139], a[44:47], v[44:47]
    ds_read_b64_tr_b16 a[14:15], v247 offset:8960
    buffer_load_dwordx4 v[132:135], v23, s[24:27], s58 offen offset:1024 sc1
    s_waitcnt vmcnt(11)
    v_cmp_ne_u32 vcc, s47, v19
    s_nop 0
    s_cbranch_vccz L_ok10
    s_mov_b32 s59, 100000
L_spin9:
    buffer_load_dword v19, v21, s[24:27], 0 offen sc1
    s_waitcnt vmcnt(0)
    v_cmp_ne_u32 vcc, s47, v19
    s_nop 0
    s_cbranch_vccz L_ok10
    s_sub_u32 s59, s59, 1
    s_cbranch_scc0 L_spin9
L_ok10:
    s_waitcnt vmcnt(10)
    v_mfma_f32_16x16x32_bf16 v[32:35], v[140:143], a[48:51], v[32:35]
    s_add_u32 s58, s70, 0
    ds_write_b128 v232, v[60:63] offset:18432
    v_mfma_f32_16x16x32_bf16 v[36:39], v[140:143], a[52:55], v[36:39]
    buffer_load_dwordx4 v[136:139], v23, s[24:27], s58 offen offset:0 sc1
    v_mfma_f32_16x16x32_bf16 v[40:43], v[140:143], a[56:59], v[40:43]
    ds_read_b64_tr_b16 a[16:17], v246 offset:12288
    ds_read_b64_tr_b16 a[18:19], v246 offset:12800
    ds_read_b64_tr_b16 a[20:21], v247 offset:12288
L_wb_3:
    s_cbranch_execz L_wb_ret
    v_mfma_f32_16x16x32_bf16 v[44:47], v[140:143], a[60:63], v[44:47]
    ds_read_b64_tr_b16 a[22:23], v247 offset:12800
    s_waitcnt vmcnt(10)
    v_mfma_f32_16x16x32_bf16 v[32:35], v[144:147], a[64:67], v[32:35]
    ds_read_b64_tr_b16 a[24:25], v246 offset:12544
    v_mfma_f32_16x16x32_bf16 v[36:39], v[144:147], a[68:71], v[36:39]
    buffer_load_dwordx4 v[140:143], v23, s[24:27], s58 offen offset:1024 sc1
    v_mfma_f32_16x16x32_bf16 v[40:43], v[144:147], a[72:75], v[40:43]
    ds_read_b64_tr_b16 a[26:27], v246 offset:13056
    ds_read_b64_tr_b16 a[28:29], v247 offset:12544
    v_mfma_f32_16x16x32_bf16 v[44:47], v[144:147], a[76:79], v[44:47]
    ds_read_b64_tr_b16 a[30:31], v247 offset:13056
    s_waitcnt vmcnt(10)
    v_mfma_f32_16x16x32_bf16 v[32:35], v[148:151], a[80:83], v[32:35]
    ds_read_b64_tr_b16 a[32:33], v246 offset:16384
    v_mfma_f32_16x16x32_bf16 v[36:39], v[148:151], a[84:87], v[36:39]
    buffer_load_dwordx4 v[144:147], v23, s[24:27], s58 offen offset:2048 sc1
    v_mfma_f32_16x16x32_bf16 v[40:43], v[148:151], a[88:91], v[40:43]
    ds_read_b64_tr_b16 a[34:35], v246 offset:16896
    ds_read_b64_tr_b16 a[36:37], v247 offset:16384
    v_mfma_f32_16x16x32_bf16 v[44:47], v[148:151], a[92:95], v[44:47]
    ds_read_b64_tr_b16 a[38:39], v247 offset:16896
    s_waitcnt vmcnt(10)
    v_mfma_f32_16x16x32_bf16 v[32:35], v[152:155], a[96:99], v[32:35]
    ds_read_b64_tr_b16 a[40:41], v246 offset:16640
    v_mfma_f32_16x16x32_bf16 v[36:39], v[152:155], a[100:103], v[36:39]
    buffer_load_dwordx4 v[148:151], v23, s[24:27], s58 offen offset:3072 sc1
    v_mfma_f32_16x16x32_bf16 v[40:43], v[152:155], a[104:107], v[40:43]
    ds_read_b64_tr_b16 a[42:43], v246 offset:17152
    ds_read_b64_tr_b16 a[44:45], v247 offset:16640
    v_mfma_f32_16x16x32_bf16 v[44:47], v[152:155], a[108:111], v[44:47]
    ds_read_b64_tr_b16 a[46:47], v247 offset:17152
    s_waitcnt vmcnt(10)
    v_mfma_f32_16x16x32_bf16 v[32:35], v[156:159], a[112:115], v[32:35]
    s_add_u32 s58, s70, 4096
    ds_read_b64_tr_b16 a[48:49], v246 offset:20480
    v_mfma_f32_16x16x32_bf16 v[36:39], v[156:159], a[116:119], v[36:39]
    buffer_load_dwordx4 v[152:155], v23, s[24:27], s58 offen offset:0 sc1
    v_mfma_f32_16x16x32_bf16 v[40:43], v[156:159], a[120:123], v[40:43]
    ds_read_b64_tr_b16 a[50:51], v246 offset:20992
    ds_read_b64_tr_b16 a[52:53], v247 offset:20480
    v_mfma_f32_16x16x32_bf16 v[44:47], v[156:159], a[124:127], v[44:47]
    ds_read_b64_tr_b16 a[54:55], v247 offset:20992
    s_waitcnt vmcnt(10)
    v_mfma_f32_16x16x32_bf16 v[32:35], v[112:115], a[128:131], v[32:35]
    ds_read_b64_tr_b16 a[56:57], v246 offset:20736
    v_mfma_f32_16x16x32_bf16 v[36:39], v[112:115], a[132:135], v[36:39]
    buffer_load_dwordx4 v[156:159], v23, s[24:27], s58 offen offset:1024 sc1
    v_mfma_f32_16x16x32_bf16 v[40:43], v[112:115], a[136:139], v[40:43]
    ds_read_b64_tr_b16 a[58:59], v246 offset:21248
    ds_read_b64_tr_b16 a[60:61], v247 offset:20736
    v_mfma_f32_16x16x32_bf16 v[44:47], v[112:115], a[140:143], v[44:47]
    ds_read_b64_tr_b16 a[62:63], v247 offset:21248
    s_waitcnt vmcnt(10)
    v_mfma_f32_16x16x32_bf16 v[32:35], v[116:119], a[144:147], v[32:35]
    ds_read_b64_tr_b16 a[64:65], v246 offset:24576
    v_mfma_f32_16x16x32_bf16 v[36:39], v[116:119], a[148:151], v[36:39]
    buffer_load_dwordx4 v[112:115], v23, s[24:27], s58 offen offset:2048 sc1
    v_mfma_f32_16x16x32_bf16 v[40:43], v[116:119], a[152:155], v[40:43]
    ds_read_b64_tr_b16 a[66:67], v246 offset:25088
    ds_read_b64_tr_b16 a[68:69], v247 offset:24576
    v_mfma_f32_16x16x32_bf16 v[44:47], v[116:119], a[156:159], v[44:47]
    ds_read_b64_tr_b16 a[70:71], v247 offset:25088
    s_waitcnt vmcnt(10)
    v_mfma_f32_16x16x32_bf16 v[32:35], v[120:123], a[160:163], v[32:35]
    ds_read_b64_tr_b16 a[72:73], v246 offset:24832
    v_mfma_f32_16x16x32_bf16 v[36:39], v[120:123], a[164:167], v[36:39]
    buffer_load_dwordx4 v[116:119], v23, s[24:27], s58 offen offset:3072 sc1
    v_mfma_f32_16x16x32_bf16 v[40:43], v[120:123], a[168:171], v[40:43]
    ds_read_b64_tr_b16 a[74:75], v246 offset:25344
    ds_read_b64_tr_b16 a[76:77], v247 offset:24832
    v_mfma_f32_16x16x32_bf16 v[44:47], v[120:123], a[172:175], v[44:47]
    ds_read_b64_tr_b16 a[78:79], v247 offset:25344
    s_waitcnt vmcnt(10)
    v_mfma_f32_16x16x32_bf16 v[32:35], v[124:127], a[176:179], v[32:35]
    s_add_u32 s58, s70, 8192
    ds_read_b64_tr_b16 a[80:81], v246 offset:28672
    v_mfma_f32_16x16x32_bf16 v[36:39], v[124:127], a[180:183], v[36:39]
    buffer_load_dwordx4 v[120:123], v23, s[24:27], s58 offen offset:0 sc1
    v_mfma_f32_16x16x32_bf16 v[40:43], v[124:127], a[184:187], v[40:43]
    ds_read_b64_tr_b16 a[82:83], v246 offset:29184
    ds_read_b64_tr_b16 a[84:85], v247 offset:28672
    v_mfma_f32_16x16x32_bf16 v[44:47], v[124:127], a[188:191], v[44:47]
    ds_read_b64_tr_b16 a[86:87], v247 offset:29184
    s_waitcnt vmcnt(10)
    v_mfma_f32_16x16x32_bf16 v[32:35], v[128:131], a[192:195], v[32:35]
    ds_read_b64_tr_b16 a[88:89], v246 offset:28928
    v_mfma_f32_16x16x32_bf16 v[36:39], v[128:131], a[196:199], v[36:39]
    buffer_load_dwordx4 v[124:127], v23, s[24:27], s58 offen offset:1024 sc1
    v_mfma_f32_16x16x32_bf16 v[40:43], v[128:131], a[200:203], v[40:43]
    ds_read_b64_tr_b16 a[90:91], v246 offset:29440
    ds_read_b64_tr_b16 a[92:93], v247 offset:28928
    v_mfma_f32_16x16x32_bf16 v[44:47], v[128:131], a[204:207], v[44:47]
    ds_read_b64_tr_b16 a[94:95], v247 offset:29440
    s_waitcnt vmcnt(10)
    v_mfma_f32_16x16x32_bf16 v[32:35], v[132:135], a[208:211], v[32:35]
    ds_read_b64_tr_b16 a[96:97], v246 offset:32768
    v_mfma_f32_16x16x32_bf16 v[36:39], v[132:135], a[212:215], v[36:39]
    buffer_load_dwordx4 v[128:131], v23, s[24:27], s58 offen offset:2048 sc1
    v_mfma_f32_16x16x32_bf16 v[40:43], v[132:135], a[216:219], v[40:43]
    ds_read_b64_tr_b16 a[98:99], v246 offset:33280
    ds_read_b64_tr_b16 a[100:101], v247 offset:32768
    v_mfma_f32_16x16x32_bf16 v[44:47], v[132:135], a[220:223], v[44:47]
    ds_read_b64_tr_b16 a[102:103], v247 offset:33280
    s_waitcnt vmcnt(10)
    v_mfma_f32_16x16x32_bf16 v[32:35], a[224:227], v[136:139], v[32:35]
    v_mfma_f32_16x16x32_bf16 v[48:51], a[228:231], v[136:139], v[48:51]
    buffer_load_dwordx4 v[132:135], v23, s[24:27], s58 offen offset:3072 sc1
    v_mfma_f32_16x16x32_bf16 v[64:67], a[232:235], v[136:139], v[64:67]
    ds_read_b64_tr_b16 a[104:105], v246 offset:33024
    ds_read_b64_tr_b16 a[106:107], v246 offset:33536
    v_mfma_f32_16x16x32_bf16 v[80:83], a[236:239], v[136:139], v[80:83]
    ds_read_b64_tr_b16 a[108:109], v247 offset:33024
    ds_read_b64_tr_b16 a[110:111], v247 offset:33536
    v_mfma_f32_16x16x32_bf16 v[96:99], v[160:163], v[136:139], v[96:99]
    ds_read_b64_tr_b16 a[112:113], v246 offset:36864
    s_waitcnt lgkmcnt(15)
    s_waitcnt vmcnt(10)
    v_mfma_f32_16x16x32_bf16 v[32:35], a[240:243], v[140:143], v[32:35]
    s_add_u32 s58, s70, 12288
    v_mfma_f32_16x16x32_bf16 v[48:51], a[244:247], v[140:143], v[48:51]
    buffer_load_dwordx4 v[136:139], v23, s[24:27], s58 offen offset:0 sc1
    v_mfma_f32_16x16x32_bf16 v[64:67], a[248:251], v[140:143], v[64:67]
    ds_read_b64_tr_b16 a[114:115], v246 offset:37376
    ds_read_b64_tr_b16 a[116:117], v247 offset:36864
    v_mfma_f32_16x16x32_bf16 v[80:83], a[252:255], v[140:143], v[80:83]
    ds_read_b64_tr_b16 a[118:119], v247 offset:37376
    ds_read_b64_tr_b16 a[120:121], v246 offset:37120
    v_mfma_f32_16x16x32_bf16 v[96:99], v[164:167], v[140:143], v[96:99]
    ds_write_b128 v232, v[36:39] offset:0
    s_waitcnt vmcnt(10)
    v_mfma_f32_16x16x32_bf16 v[32:35], a[0:3], v[144:147], v[32:35]
    v_mfma_f32_16x16x32_bf16 v[48:51], a[4:7], v[144:147], v[48:51]
    buffer_load_dwordx4 v[140:143], v23, s[24:27], s58 offen offset:1024 sc1
    v_mfma_f32_16x16x32_bf16 v[64:67], a[8:11], v[144:147], v[64:67]
    ds_read_b64_tr_b16 a[122:123], v246 offset:37632
    ds_read_b64_tr_b16 a[124:125], v247 offset:37120
    v_mfma_f32_16x16x32_bf16 v[80:83], a[12:15], v[144:147], v[80:83]
    ds_read_b64_tr_b16 a[126:127], v247 offset:37632
    ds_read_b64_tr_b16 a[128:129], v246 offset:40960
    v_mfma_f32_16x16x32_bf16 v[96:99], v[168:171], v[144:147], v[96:99]
    ds_write_b128 v232, v[40:43] offset:1024
    s_waitcnt vmcnt(10)
    v_mfma_f32_16x16x32_bf16 v[32:35], a[16:19], v[148:151], v[32:35]
    ds_read_b64_tr_b16 a[130:131], v246 offset:41472
    v_mfma_f32_16x16x32_bf16 v[48:51], a[20:23], v[148:151], v[48:51]
    ds_read_b64_tr_b16 a[132:133], v247 offset:40960
    v_mfma_f32_16x16x32_bf16 v[64:67], a[24:27], v[148:151], v[64:67]
    ds_read_b64_tr_b16 a[134:135], v247 offset:41472
    v_mfma_f32_16x16x32_bf16 v[80:83], a[28:31], v[148:151], v[80:83]
    ds_read_b64_tr_b16 a[136:137], v246 offset:41216
    v_mfma_f32_16x16x32_bf16 v[96:99], v[172:175], v[148:151], v[96:99]
    ds_write_b128 v232, v[44:47] offset:2048
    s_waitcnt vmcnt(9)
    v_mfma_f32_16x16x32_bf16 v[32:35], a[32:35], v[152:155], v[32:35]
    ds_read_b64_tr_b16 a[138:139], v246 offset:41728
    v_mfma_f32_16x16x32_bf16 v[48:51], a[36:39], v[152:155], v[48:51]
    ds_read_b64_tr_b16 a[140:141], v247 offset:41216
    v_mfma_f32_16x16x32_bf16 v[64:67], a[40:43], v[152:155], v[64:67]
    ds_read_b64_tr_b16 a[142:143], v247 offset:41728
    v_mfma_f32_16x16x32_bf16 v[80:83], a[44:47], v[152:155], v[80:83]
    ds_read_b64_tr_b16 a[144:145], v246 offset:45056
    v_mfma_f32_16x16x32_bf16 v[96:99], v[192:195], v[152:155], v[96:99]
    ds_read_b64_tr_b16 a[146:147], v246 offset:45568
    s_waitcnt vmcnt(8)
    v_mfma_f32_16x16x32_bf16 v[32:35], a[48:51], v[156:159], v[32:35]
    ds_read_b64_tr_b16 a[148:149], v247 offset:45056
    v_mfma_f32_16x16x32_bf16 v[48:51], a[52:55], v[156:159], v[48:51]
    ds_read_b64_tr_b16 a[150:151], v247 offset:45568
    v_mfma_f32_16x16x32_bf16 v[64:67], a[56:59], v[156:159], v[64:67]
    ds_read_b64_tr_b16 a[152:153], v246 offset:45312
    v_mfma_f32_16x16x32_bf16 v[80:83], a[60:63], v[156:159], v[80:83]
    ds_read_b64_tr_b16 a[154:155], v246 offset:45824
    v_mfma_f32_16x16x32_bf16 v[96:99], v[196:199], v[156:159], v[96:99]
    s_waitcnt lgkmcnt(9)
    s_barrier
    s_waitcnt vmcnt(7)
    v_mfma_f32_16x16x32_bf16 v[32:35], a[64:67], v[112:115], v[32:35]
    ds_read_b64_tr_b16 a[156:157], v247 offset:45312
    ds_read_b64_tr_b16 a[158:159], v247 offset:45824
    v_mfma_f32_16x16x32_bf16 v[48:51], a[68:71], v[112:115], v[48:51]
    ds_read_b64_tr_b16 a[160:161], v248 offset:49152
    ds_read_b64_tr_b16 a[162:163], v248 offset:49664
    v_mfma_f32_16x16x32_bf16 v[64:67], a[72:75], v[112:115], v[64:67]
    ds_read_b128 v[52:55], v233 offset:16384
    v_mfma_f32_16x16x32_bf16 v[80:83], a[76:79], v[112:115], v[80:83]
    ds_read_b128 v[56:59], v234 offset:17408
    v_mfma_f32_16x16x32_bf16 v[96:99], v[200:203], v[112:115], v[96:99]
    ds_read_b128 v[60:63], v235 offset:18432
    s_waitcnt vmcnt(6)
    v_mfma_f32_16x16x32_bf16 v[32:35], a[80:83], v[116:119], v[32:35]
    ds_read_b64_tr_b16 a[164:165], v249 offset:49152
    ds_read_b64_tr_b16 a[166:167], v249 offset:49664
    v_mfma_f32_16x16x32_bf16 v[48:51], a[84:87], v[116:119], v[48:51]
    ds_read_b64_tr_b16 a[168:169], v248 offset:49408
    ds_read_b64_tr_b16 a[170:171], v248 offset:49920
    v_mfma_f32_16x16x32_bf16 v[64:67], a[88:91], v[116:119], v[64:67]
    ds_read_b128 v[36:39], v233 offset:0
    v_mfma_f32_16x16x32_bf16 v[80:83], a[92:95], v[116:119], v[80:83]
    ds_read_b128 v[40:43], v234 offset:1024
    v_mfma_f32_16x16x32_bf16 v[96:99], v[204:207], v[116:119], v[96:99]
    ds_read_b128 v[44:47], v235 offset:2048
    s_waitcnt vmcnt(5)
    v_mfma_f32_16x16x32_bf16 v[32:35], a[96:99], v[120:123], v[32:35]
    ds_read_b64_tr_b16 a[172:173], v249 offset:49408
    v_mfma_f32_16x16x32_bf16 v[48:51], a[100:103], v[120:123], v[48:51]
    ds_read_b64_tr_b16 a[174:175], v249 offset:49920
    v_mfma_f32_16x16x32_bf16 v[64:67], a[104:107], v[120:123], v[64:67]
    ds_read_b64_tr_b16 a[176:177], v248 offset:50176
    v_mfma_f32_16x16x32_bf16 v[80:83], a[108:111], v[120:123], v[80:83]
    ds_read_b64_tr_b16 a[178:179], v248 offset:50688
    v_mfma_f32_16x16x32_bf16 v[96:99], v[100:103], v[120:123], v[96:99]
    ds_read_b64_tr_b16 a[180:181], v249 offset:50176
    s_waitcnt vmcnt(4)
    v_mfma_f32_16x16x32_bf16 v[32:35], a[112:115], v[124:127], v[32:35]
    ds_read_b64_tr_b16 a[182:183], v249 offset:50688
    v_mfma_f32_16x16x32_bf16 v[48:51], a[116:119], v[124:127], v[48:51]
    ds_read_b64_tr_b16 a[184:185], v248 offset:50432
    v_mfma_f32_16x16x32_bf16 v[64:67], a[120:123], v[124:127], v[64:67]
    ds_read_b64_tr_b16 a[186:187], v248 offset:50944
    v_mfma_f32_16x16x32_bf16 v[80:83], a[124:127], v[124:127], v[80:83]
    ds_read_b64_tr_b16 a[188:189], v249 offset:50432
    v_mfma_f32_16x16x32_bf16 v[96:99], v[104:107], v[124:127], v[96:99]
    ds_read_b64_tr_b16 a[190:191], v249 offset:50944
    s_waitcnt lgkmcnt(15)
    s_waitcnt vmcnt(3)
    v_mfma_f32_16x16x32_bf16 v[32:35], a[128:131], v[128:131], v[32:35]
    v_mfma_f32_16x16x32_bf16 v[48:51], a[132:135], v[128:131], v[48:51]
    v_add_f32 v52, v52, v56
    v_mfma_f32_16x16x32_bf16 v[64:67], a[136:139], v[128:131], v[64:67]
    v_add_f32 v53, v53, v57
    v_mfma_f32_16x16x32_bf16 v[80:83], a[140:143], v[128:131], v[80:83]
    v_add_f32 v54, v54, v58
    v_mfma_f32_16x16x32_bf16 v[96:99], v[108:111], v[128:131], v[96:99]
    v_add_f32 v55, v55, v59
    s_waitcnt vmcnt(2)
    v_mfma_f32_16x16x32_bf16 v[32:35], a[144:147], v[132:135], v[32:35]
    v_add_f32 v52, v52, v60
    v_mfma_f32_16x16x32_bf16 v[48:51], a[148:151], v[132:135], v[48:51]
    v_add_f32 v53, v53, v61
    v_mfma_f32_16x16x32_bf16 v[64:67], a[152:155], v[132:135], v[64:67]
    v_add_f32 v54, v54, v62
    v_mfma_f32_16x16x32_bf16 v[80:83], a[156:159], v[132:135], v[80:83]
    v_add_f32 v55, v55, v63
    v_mfma_f32_16x16x32_bf16 v[96:99], v[84:87], v[132:135], v[96:99]
    s_waitcnt lgkmcnt(10)
    s_waitcnt lgkmcnt(8)
    s_waitcnt vmcnt(1)
    v_mfma_f32_16x16x32_bf16 v[32:35], a[160:163], v[136:139], v[32:35]
    v_add_f32 v36, v36, v40
    v_mfma_f32_16x16x32_bf16 v[48:51], a[164:167], v[136:139], v[48:51]
    v_add_f32 v37, v37, v41
    v_mfma_f32_16x16x32_bf16 v[64:67], a[168:171], v[136:139], v[64:67]
    v_add_f32 v38, v38, v42
    v_mfma_f32_16x16x32_bf16 v[80:83], a[172:175], v[136:139], v[80:83]
    v_add_f32 v39, v39, v43
    v_mfma_f32_16x16x32_bf16 v[96:99], v[88:91], v[136:139], v[96:99]
    v_add_f32 v36, v36, v44
    s_waitcnt lgkmcnt(0)
    s_waitcnt vmcnt(0)
    v_mfma_f32_16x16x32_bf16 v[32:35], a[176:179], v[140:143], v[32:35]
    v_add_f32 v37, v37, v45
    v_mfma_f32_16x16x32_bf16 v[48:51], a[180:183], v[140:143], v[48:51]
    v_add_f32 v38, v38, v46
    v_mfma_f32_16x16x32_bf16 v[64:67], a[184:187], v[140:143], v[64:67]
    v_add_f32 v39, v39, v47
    v_mfma_f32_16x16x32_bf16 v[80:83], a[188:191], v[140:143], v[80:83]
    v_mfma_f32_16x16x32_bf16 v[96:99], v[92:95], v[140:143], v[96:99]
    s_nop 0
    v_pk_add_f32 v[32:33], v[32:33], v[36:37]
    v_pk_add_f32 v[34:35], v[34:35], v[38:39]
    v_pk_add_f32 v[48:49], v[48:49], v[52:53]
    v_pk_add_f32 v[50:51], v[50:51], v[54:55]
    v_cvt_pk_bf16_f32 v176, v32, v33
    v_cvt_pk_bf16_f32 v177, v34, v35
    ds_write_b64 v238, v[176:177] offset:0
    v_cvt_pk_bf16_f32 v178, v48, v49
    v_cvt_pk_bf16_f32 v179, v50, v51
    ds_write_b64 v238, v[178:179] offset:32
    v_cvt_pk_bf16_f32 v180, v64, v65
    v_cvt_pk_bf16_f32 v181, v66, v67
    ds_write_b64 v238, v[180:181] offset:64
    v_cvt_pk_bf16_f32 v182, v80, v81
    v_cvt_pk_bf16_f32 v183, v82, v83
    ds_write_b64 v238, v[182:183] offset:96
    ds_read_b128 v[216:219], v244 offset:0
    ds_read_b128 v[220:223], v244 offset:1408
    v_cvt_pk_bf16_f32 v184, v96, v97
    v_cvt_pk_bf16_f32 v185, v98, v99
    ds_write_b64 v238, v[184:185] offset:128
    ds_read_b64 v[224:225], v252 offset:128
    s_waitcnt lgkmcnt(3)
    buffer_store_dwordx4 v[216:219], v22, s[28:31], s71 offen
    s_waitcnt lgkmcnt(2)
    buffer_store_dwordx4 v[220:223], v22, s[28:31], s72 offen
    s_waitcnt lgkmcnt(0)
    buffer_store_dwordx2 v[224:225], v26, s[28:31], s73 offen
L_end:
    s_endpgm
L_p2_alt:
    s_add_u32 s57, s57, 27648
    buffer_load_dwordx4 v11, s[16:19], s57 offen offset:3072 lds
    s_xor_b32 s66, s44, 3
    s_lshl2_add_u32 s66, s51, s66
    s_mul_i32 s66, s66, 66816
    s_lshl2_add_u32 s66, s52, s66
    s_lshl_b32 s86, s65, 10
    s_add_u32 s58, s86, s66
    s_add_u32 s86, s66, 16384
    buffer_load_dwordx4 v[128:131], v23, s[24:27], s58 offen offset:0 sc1
    s_add_u32 s58, s58, 1024
    s_cmp_eq_u32 s58, s86
    s_cselect_b32 s58, s66, s58
    buffer_load_dwordx4 v[132:135], v23, s[24:27], s58 offen offset:0 sc1
    s_add_u32 s58, s58, 1024
    s_cmp_eq_u32 s58, s86
    s_cselect_b32 s58, s66, s58
    buffer_load_dwordx4 v[136:139], v23, s[24:27], s58 offen offset:0 sc1
    s_add_u32 s58, s58, 1024
    s_cmp_eq_u32 s58, s86
    s_cselect_b32 s58, s66, s58
    buffer_load_dwordx4 v[140:143], v23, s[24:27], s58 offen offset:0 sc1
    s_add_u32 s58, s58, 1024
    s_cmp_eq_u32 s58, s86
    s_cselect_b32 s58, s66, s58
    buffer_load_dwordx4 v[144:147], v23, s[24:27], s58 offen offset:0 sc1
    s_add_u32 s58, s58, 1024
    s_cmp_eq_u32 s58, s86
    s_cselect_b32 s58, s66, s58
    buffer_load_dwordx4 v[148:151], v23, s[24:27], s58 offen offset:0 sc1
    s_add_u32 s58, s58, 1024
    s_cmp_eq_u32 s58, s86
    s_cselect_b32 s58, s66, s58
    buffer_load_dwordx4 v[152:155], v23, s[24:27], s58 offen offset:0 sc1
    s_add_u32 s58, s58, 1024
    s_cmp_eq_u32 s58, s86
    s_cselect_b32 s58, s66, s58
    buffer_load_dwordx4 v[156:159], v23, s[24:27], s58 offen offset:0 sc1
    s_add_u32 s58, s58, 1024
    s_cmp_eq_u32 s58, s86
    s_cselect_b32 s58, s66, s58
    buffer_load_dwordx4 v[112:115], v23, s[24:27], s58 offen offset:0 sc1
    s_add_u32 s58, s58, 1024
    s_cmp_eq_u32 s58, s86
    s_cselect_b32 s58, s66, s58
    buffer_load_dwordx4 v[116:119], v23, s[24:27], s58 offen offset:0 sc1
    s_add_u32 s58, s58, 1024
    s_cmp_eq_u32 s58, s86
    s_cselect_b32 s58, s66, s58
    buffer_load_dwordx4 v[120:123], v23, s[24:27], s58 offen offset:0 sc1
    s_waitcnt vmcnt(19)
    ds_read_b64_tr_b16 a[208:209], v4 offset:32768
    ds_read_b64_tr_b16 a[210:211], v4 offset:33280
    ds_read_b64_tr_b16 a[212:213], v5 offset:32768
    ds_read_b64_tr_b16 a[214:215], v5 offset:33280
    ds_read_b64_tr_b16 a[216:217], v4 offset:33024
    ds_read_b64_tr_b16 a[218:219], v4 offset:33536
    ds_read_b64_tr_b16 a[220:221], v5 offset:33024
    ds_read_b64_tr_b16 a[222:223], v5 offset:33536
    s_waitcnt vmcnt(15)
    ds_read_b64_tr_b16 a[224:225], v2 offset:0
    ds_read_b64_tr_b16 a[226:227], v2 offset:512
    ds_read_b64_tr_b16 a[228:229], v3 offset:0
    ds_read_b64_tr_b16 a[230:231], v3 offset:512
    ds_read_b64_tr_b16 a[232:233], v2 offset:256
    ds_read_b64_tr_b16 a[234:235], v2 offset:768
    ds_read_b64_tr_b16 a[236:237], v3 offset:256
    ds_read_b64_tr_b16 a[238:239], v3 offset:768
    s_waitcnt vmcnt(11)
    ds_read_b64_tr_b16 a[240:241], v2 offset:16384
    ds_read_b64_tr_b16 a[242:243], v2 offset:16896
    ds_read_b64_tr_b16 a[244:245], v3 offset:16384
    ds_read_b64_tr_b16 a[246:247], v3 offset:16896
    ds_read_b64_tr_b16 a[248:249], v2 offset:16640
    ds_read_b64_tr_b16 a[250:251], v2 offset:17152
    ds_read_b64_tr_b16 a[252:253], v3 offset:16640
    ds_read_b64_tr_b16 a[254:255], v3 offset:17152
    s_waitcnt lgkmcnt(0)
    s_branch L_p2_join
L_p3_alt:
    s_add_u32 s66, s69, 175872
    s_add_u32 s58, s66, s76
    buffer_load_dwordx4 v[152:155], v23, s[24:27], s58 offen offset:0 sc1
    buffer_load_dwordx4 v[156:159], v23, s[24:27], s58 offen offset:1024 sc1
    s_add_u32 s58, s66, s77
    buffer_load_dwordx4 v[112:115], v23, s[24:27], s58 offen offset:0 sc1
    buffer_load_dwordx4 v[116:119], v23, s[24:27], s58 offen offset:1024 sc1
    s_add_u32 s58, s66, s78
    buffer_load_dwordx4 v[120:123], v23, s[24:27], s58 offen offset:0 sc1
    buffer_load_dwordx4 v[124:127], v23, s[24:27], s58 offen offset:1024 sc1
    s_add_u32 s58, s66, s79
    buffer_load_dwordx4 v[128:131], v23, s[24:27], s58 offen offset:0 sc1
    buffer_load_dwordx4 v[132:135], v23, s[24:27], s58 offen offset:1024 sc1
    s_add_u32 s58, s66, s80
    buffer_load_dwordx4 v[136:139], v23, s[24:27], s58 offen offset:0 sc1
    buffer_load_dwordx4 v[140:143], v23, s[24:27], s58 offen offset:1024 sc1
    s_add_u32 s58, s66, s81
    buffer_load_dwordx4 v[144:147], v23, s[24:27], s58 offen offset:0 sc1
    s_waitcnt vmcnt(11) lgkmcnt(0)
    s_branch L_p3_join
L_help:
    s_sub_u32 s55, s46, 21
    v_lshlrev_b32 v217, 7, v1
    v_lshrrev_b32 v218, 2, v1
    v_lshlrev_b32 v218, 12, v218
    v_lshl_add_u32 v218, v210, 7, v218
    v_mul_u32_u24 v220, 3584, v1
    s_lshl4_add_u32 s54, s44, s65
    s_mul_i32 s54, s54, 114688
    s_lshl_b32 s56, s50, 7
    s_add_u32 s54, s54, s56
    buffer_load_dword v108, v220, s[16:19], s54 offen
    v_mul_u32_u24 v109, 1088, v25
    v_lshl_add_u32 v109, v26, 4, v109
    v_mul_u32_u24 v110, 1088, v209
    v_lshl_add_u32 v110, v208, 5, v110
    v_lshl_add_u32 v110, v210, 3, v110
    s_lshl_b32 s53, s44, 7
    v_add_u32 v110, s53, v110
    v_mul_u32_u24 v111, 66816, v208
    v_lshl_add_u32 v111, v211, 4, v111
    s_mul_i32 s63, s44, 267264
    s_lshl_b32 s53, s2, 8
    s_add_u32 s63, s63, s53
    s_add_u32 s64, s63, 1069056
    v_cmp_gt_u32 vcc, 208, v0
    v_mov_b32 v100, 2130706432
    v_cmp_le_u32 s[92:93], 24, v26
    v_cndmask_b32 v22, v100, v111, vcc
    s_mov_b32 s62, 0x3f803f80
    s_mov_b32 s61, 0xffff0000
    v_mov_b32 v96, 0
    v_mov_b32 v97, 0
    s_waitcnt vmcnt(3)
    v_dot2c_f32_bf16 v96, s62, v32
    v_dot2c_f32_bf16 v97, v32, v32
    v_lshlrev_b32 v40, 16, v32
    v_and_b32 v41, s61, v32
    v_dot2c_f32_bf16 v96, s62, v33
    v_dot2c_f32_bf16 v97, v33, v33
    v_lshlrev_b32 v42, 16, v33
    v_and_b32 v43, s61, v33
    v_dot2c_f32_bf16 v96, s62, v34
    v_dot2c_f32_bf16 v97, v34, v34
    v_lshlrev_b32 v44, 16, v34
    v_and_b32 v45, s61, v34
    v_dot2c_f32_bf16 v96, s62, v35
    v_dot2c_f32_bf16 v97, v35, v35
    v_lshlrev_b32 v46, 16, v35
    v_and_b32 v47, s61, v35
    s_waitcnt vmcnt(2)
    v_dot2c_f32_bf16 v96, s62, v36
    v_dot2c_f32_bf16 v97, v36, v36
    v_lshlrev_b32 v48, 16, v36
    v_and_b32 v49, s61, v36
    v_dot2c_f32_bf16 v96, s62, v37
    v_dot2c_f32_bf16 v97, v37, v37
    v_lshlrev_b32 v50, 16, v37
    v_and_b32 v51, s61, v37
    v_dot2c_f32_bf16 v96, s62, v38
    v_dot2c_f32_bf16 v97, v38, v38
    v_lshlrev_b32 v52, 16, v38
    v_and_b32 v53, s61, v38
    v_dot2c_f32_bf16 v96, s62, v39
    v_dot2c_f32_bf16 v97, v39, v39
    v_lshlrev_b32 v54, 16, v39
    v_and_b32 v55, s61, v39
    buffer_load_dword v29, off, s[40:43], 0 sc1
    v_add_f32_dpp v96, v96, v96 quad_perm:[1,0,3,2] row_mask:0xf bank_mask:0xf
    v_add_f32_dpp v97, v97, v97 quad_perm:[1,0,3,2] row_mask:0xf bank_mask:0xf
    s_nop 0
    v_add_f32_dpp v96, v96, v96 quad_perm:[2,3,0,1] row_mask:0xf bank_mask:0xf
    v_add_f32_dpp v97, v97, v97 quad_perm:[2,3,0,1] row_mask:0xf bank_mask:0xf
    s_nop 0
    v_add_f32_dpp v96, v96, v96 row_half_mirror row_mask:0xf bank_mask:0xf
    v_add_f32_dpp v97, v97, v97 row_half_mirror row_mask:0xf bank_mask:0xf
    s_nop 0
    v_add_f32_dpp v96, v96, v96 row_mirror row_mask:0xf bank_mask:0xf
    v_add_f32_dpp v97, v97, v97 row_mirror row_mask:0xf bank_mask:0xf
    v_mov_b32 v98, v96
    v_mov_b32 v99, v97
    s_nop 0
    v_permlane16_swap_b32 v96, v98
    v_permlane16_swap_b32 v97, v99
    v_add_f32 v96, v96, v98
    v_add_f32 v97, v97, v99
    v_mul_f32 v98, 0x3b124925, v96
    v_mul_f32 v99, 0x3b124925, v97
    v_fma_f32 v99, -v98, v98, v99
    v_max_f32 v99, 0, v99
    v_cvt_pk_bf16_f32 v100, 0, v99
    v_add_f32 v100, 0x3727c5ac, v100
    v_cvt_pk_bf16_f32 v100, 0, v100
    v_sqrt_f32 v100, v100
    s_nop 0
    v_cvt_pk_bf16_f32 v100, 0, v100
    v_rcp_f32 v100, v100
    s_nop 0
    v_mul_f32 v99, v99, v100
    v_mul_f32 v99, v99, v100
    v_cvt_pk_bf16_f32 v104, 0, v99
    v_add_f32 v104, 0x3727c5ac, v104
    v_cvt_pk_bf16_f32 v104, 0, v104
    v_sqrt_f32 v104, v104
    s_nop 0
    v_cvt_pk_bf16_f32 v102, 0, v104
    v_rcp_f32 v104, v102
    s_nop 0
    v_mul_f32 v104, v104, v100
    v_mul_f32 v106, v98, v104
    v_pk_fma_f32 v[56:57], v[40:41], v[104:105], v[106:107] op_sel_hi:[1,0,0] neg_lo:[0,0,1] neg_hi:[0,0,1]
    v_pk_fma_f32 v[58:59], v[42:43], v[104:105], v[106:107] op_sel_hi:[1,0,0] neg_lo:[0,0,1] neg_hi:[0,0,1]
    v_pk_fma_f32 v[60:61], v[44:45], v[104:105], v[106:107] op_sel_hi:[1,0,0] neg_lo:[0,0,1] neg_hi:[0,0,1]
    v_pk_fma_f32 v[62:63], v[46:47], v[104:105], v[106:107] op_sel_hi:[1,0,0] neg_lo:[0,0,1] neg_hi:[0,0,1]
    v_pk_fma_f32 v[64:65], v[48:49], v[104:105], v[106:107] op_sel_hi:[1,0,0] neg_lo:[0,0,1] neg_hi:[0,0,1]
    v_pk_fma_f32 v[66:67], v[50:51], v[104:105], v[106:107] op_sel_hi:[1,0,0] neg_lo:[0,0,1] neg_hi:[0,0,1]
    v_pk_fma_f32 v[68:69], v[52:53], v[104:105], v[106:107] op_sel_hi:[1,0,0] neg_lo:[0,0,1] neg_hi:[0,0,1]
    v_pk_fma_f32 v[70:71], v[54:55], v[104:105], v[106:107] op_sel_hi:[1,0,0] neg_lo:[0,0,1] neg_hi:[0,0,1]
    v_cvt_pk_bf16_f32 v80, v56, v57
    v_cvt_pk_bf16_f32 v81, v58, v59
    v_cvt_pk_bf16_f32 v82, v60, v61
    v_cvt_pk_bf16_f32 v83, v62, v63
    v_cvt_pk_bf16_f32 v84, v64, v65
    v_cvt_pk_bf16_f32 v85, v66, v67
    v_cvt_pk_bf16_f32 v86, v68, v69
    v_cvt_pk_bf16_f32 v87, v70, v71
    v_lshrrev_b32 v102, 16, v102
    v_cndmask_b32 v84, v84, v102, s[92:93]
    ds_write_b128 v109, v[80:83] offset:0
    ds_write_b128 v109, v[84:87] offset:512
    s_waitcnt lgkmcnt(0)
    s_barrier
    ds_read_b64_tr_b16 v[88:89], v110 offset:0
    ds_read_b64_tr_b16 v[90:91], v110 offset:4352
    ds_read_b64_tr_b16 v[92:93], v110 offset:512
    ds_read_b64_tr_b16 v[94:95], v110 offset:4864
    s_waitcnt lgkmcnt(2)
    buffer_store_dwordx4 v[88:91], v111, s[24:27], s63 offen sc1
    s_waitcnt lgkmcnt(0)
    buffer_store_dwordx4 v[92:95], v22, s[24:27], s64 offen sc1
    v_min_u32 v220, 111104, v220
    s_add_u32 s54, s54, 229376
    buffer_load_dword v108, v220, s[16:19], s54 offen
    s_waitcnt vmcnt(1)
    v_cmp_eq_u32 vcc, 0, v29
    s_nop 0
    s_cbranch_vccz L_ok12
    s_mov_b32 s59, 100000
L_spin11:
    buffer_load_dword v29, off, s[40:43], 0 sc1
    s_waitcnt vmcnt(0)
    v_cmp_eq_u32 vcc, 0, v29
    s_nop 0
    s_cbranch_vccz L_ok12
    s_sub_u32 s59, s59, 1
    s_cbranch_scc0 L_spin11
L_ok12:
    v_readfirstlane_b32 s47, v29
    s_barrier
    s_cmp_lg_u32 s44, 0
    s_cbranch_scc1 L_nopub13
    s_lshl_b32 s60, s2, 5
    s_add_u32 s60, s60, 12582912
    v_mov_b32 v30, s47
    s_mov_b64 exec, 1
    buffer_store_dword v30, off, s[24:27], s60 sc1
    s_mov_b64 exec, -1
L_nopub13:
    s_lshl_b32 s3, s45, 9
    v_min_u32 v223, 384, v217
    buffer_load_dword v108, v223, s[36:39], s3 offen
    s_and_b32 s56, s45, 6
    s_lshr_b32 s56, 0xc9, s56
    s_and_b32 s56, s56, 3
    s_add_u32 s54, s56, 1
    s_bfe_u32 s54, s54, 0x10001
    s_add_u32 s54, s54, 1
    v_min_u32 v221, s54, v210
    v_lshrrev_b32 v222, 2, v0
    v_min_u32 v222, 49, v222
    v_mul_u32_u24 v222, 21, v222
    v_add_lshl_u32 v221, v221, v222, 7
    s_mul_i32 s56, s56, 224
    s_andn2_b32 s56, s56, 127
    s_mul_i32 s54, s55, 134400
    s_add_u32 s54, s54, s56
    buffer_load_dword v108, v221, s[8:11], s54 offen offset:1792
    s_add_u32 s54, s54, 403200
    buffer_load_dword v108, v221, s[8:11], s54 offen offset:1792
    s_add_u32 s54, s54, 403200
    buffer_load_dword v108, v221, s[8:11], s54 offen offset:1792
    s_add_u32 s54, s54, 403200
    s_and_b32 s56, s45, 6
    s_lshr_b32 s56, 0xc9, s56
    s_and_b32 s56, s56, 3
    s_add_u32 s54, s56, 1
    s_bfe_u32 s54, s54, 0x10001
    s_add_u32 s54, s54, 1
    v_min_u32 v221, s54, v210
    v_lshrrev_b32 v222, 2, v0
    v_min_u32 v222, 49, v222
    v_mul_u32_u24 v222, 21, v222
    v_add_lshl_u32 v221, v221, v222, 7
    s_mul_i32 s56, s56, 224
    s_andn2_b32 s56, s56, 127
    s_mul_i32 s54, s55, 134400
    s_add_u32 s54, s54, s56
    buffer_load_dword v108, v221, s[8:11], s54 offen offset:0
    s_add_u32 s54, s54, 403200
    buffer_load_dword v108, v221, s[8:11], s54 offen offset:0
    s_add_u32 s54, s54, 403200
    buffer_load_dword v108, v221, s[8:11], s54 offen offset:0
    s_add_u32 s54, s54, 403200
    s_mul_i32 s54, s44, 28
    s_add_u32 s54, s54, s55
    s_add_u32 s54, s54, 0
    s_lshl_b32 s54, s54, 16
    s_lshl_b32 s56, s45, 9
    s_add_u32 s54, s54, s56
    buffer_load_dword v108, v218, s[20:23], s54 offen
    s_add_u32 s54, s54, 196608
    buffer_load_dword v108, v218, s[20:23], s54 offen
    s_add_u32 s54, s54, 196608
    buffer_load_dword v108, v218, s[20:23], s54 offen
    s_add_u32 s54, s54, 196608
    buffer_load_dword v108, v218, s[20:23], s54 offen
    s_add_u32 s54, s54, 196608
    s_waitcnt vmcnt(0) lgkmcnt(0)
    v_lshlrev_b32 v216, 6, v209
    v_lshl_add_u32 v216, v210, 3, v216
    v_lshl_add_u32 v216, v215, 5, v216
    s_add_u32 s53, s52, 49152
    v_lshl_add_u32 v2, v208, 10, v216
    v_add_u32 v2, s53, v2
    v_xor_b32 v3, 32, v2
    v_add_u32 v4, 65536, v2
    v_add_u32 v5, 65536, v3
    v_lshl_add_u32 v6, v208, 9, v216
    v_add_u32 v6, s53, v6
    v_xor_b32 v7, 32, v6
    v_add_u32 v8, 65536, v6
    v_add_u32 v9, 65536, v7
    s_lshr_b32 s53, s46, 2
    s_and_b32 s89, s46, 3
    s_bfe_u32 s54, s46, 0x20001
    s_and_b32 s55, s46, 1
    s_add_u32 s55, s55, 4
    s_cmp_lt_u32 s46, 16
    s_cselect_b32 s53, s53, s54
    s_cselect_b32 s89, s89, s55
    s_mul_i32 s49, s53, 2
    s_add_u32 s49, s49, s89
    s_sub_u32 s54, s49, 6
    s_min_u32 s49, s49, s54
    s_or_b32 s89, s89, 0
    s_lshl2_add_u32 s48, s45, s53
    s_mul_i32 s53, s44, 1835008
    s_lshl_b32 s74, s48, 7
    s_add_u32 s53, s53, s74
    s_lshl_b32 s56, s44, 5
    v_lshlrev_b32 v217, 5, v212
    v_xor_b32 v217, v217, v214
    v_xor_b32 v217, s56, v217
    s_add_u32 s74, s74, s56
    v_lshlrev_b32 v12, 12, v213
    v_add3_u32 v12, v12, v217, s53
    s_mul_i32 s53, s44, 28672
    s_lshl_b32 s54, s49, 7
    s_add_u32 s55, s53, s54
    v_mul_u32_u24 v13, 896, v213
    v_add3_u32 v13, v13, v214, s55
    v_xor_b32 v14, 32, v13
    s_mul_i32 s55, s44, 21504
    v_subrev_u32 v239, s55, v13
    s_and_b32 s55, s56, 32
    v_xor_b32 v239, s55, v239
    s_mul_i32 s73, s48, 57344
    s_add_u32 s71, s73, s54
    s_mul_i32 s55, s44, 14336
    s_add_u32 s71, s71, s55
    s_add_u32 s72, s71, 7168
    v_bfe_u32 v217, v1, 1, 2
    v_lshl_add_u32 v217, v212, 2, v217
    v_and_b32 v218, 24, v1
    v_add_u32 v217, v217, v218
    v_mul_u32_u24 v15, 896, v217
    v_and_b32 v217, 1, v1
    v_lshl_add_u32 v15, v217, 4, v15
    v_add_u32 v15, s53, v15
    s_lshl_b32 s54, s89, 5
    s_add_u32 s54, s54, 768
    s_add_u32 s68, s89, 24
    s_mul_i32 s68, s68, 58624
    s_mul_i32 s69, s44, 14336
    s_add_u32 s69, s69, 2097152
    s_add_u32 s68, s68, s69
    s_mul_i32 s55, s49, 234496
    s_add_u32 s69, s69, s55
    s_add_u32 s73, s73, s54
    s_mov_b32 s76, 0
    s_add_u32 s77, s76, 2048
    s_cmp_eq_u32 s77, 14336
    s_cselect_b32 s77, 0, s77
    s_add_u32 s78, s77, 2048
    s_cmp_eq_u32 s78, 14336
    s_cselect_b32 s78, 0, s78
    s_add_u32 s79, s78, 2048
    s_cmp_eq_u32 s79, 14336
    s_cselect_b32 s79, 0, s79
    s_add_u32 s80, s79, 2048
    s_cmp_eq_u32 s80, 14336
    s_cselect_b32 s80, 0, s80
    s_add_u32 s81, s80, 2048
    s_cmp_eq_u32 s81, 14336
    s_cselect_b32 s81, 0, s81
    s_add_u32 s82, s81, 2048
    s_cmp_eq_u32 s82, 14336
    s_cselect_b32 s82, 0, s82
    s_cmp_lt_u32 s89, 4
    s_cselect_b32 s75, s54, 2130706432
    s_cselect_b32 s68, s68, 2130706432
    s_cselect_b32 s73, s73, 2130706432
    v_lshlrev_b32 v16, 3, v1
    v_add_u32 v16, 81920, v16
    v_and_b32 v217, 7, v1
    v_min_u32 v218, 6, v217
    s_mul_i32 s54, s44, 7
    v_add_u32 v218, s54, v218
    v_mul_u32_u24 v219, 2, v218
    v_add_u32 v219, s89, v219
    v_mul_u32_u24 v220, 43, v219
    v_lshrrev_b32 v220, 8, v220
    v_mul_u32_u24 v220, 6, v220
    v_sub_u32 v219, v219, v220
    v_subrev_u32 v219, s49, v219
    v_bfe_u32 v220, v1, 3, 1
    v_mul_i32_i24 v219, v219, v220
    v_add_u32 v219, s49, v219
    v_lshl_add_u32 v218, v219, 5, v218
    v_lshlrev_b32 v20, 7, v218
    v_add_u32 v20, 12713984, v20
    s_lshr_b32 s53, s48, 1
    s_lshl_b32 s53, s53, 7
    s_add_u32 s53, s53, 12779520
    v_lshl_add_u32 v21, v210, 11, s53
    s_lshl_b32 s70, s48, 16
    s_lshl2_add_u32 s70, s52, s70
    s_add_u32 s70, s70, 4194304
    v_lshrrev_b32 v218, 3, v1
    v_mul_u32_u24 v22, 896, v218
    v_lshl_add_u32 v22, v217, 4, v22
    v_lshlrev_b32 v25, 1, v211
    s_add_u32 s53, s52, 65536
    v_mul_u32_u24 v244, 176, v218
    v_lshl_add_u32 v244, v217, 4, v244
    v_add_u32 v244, s53, v244
    v_mul_u32_u24 v238, 176, v211
    v_lshl_add_u32 v238, v208, 3, v238
    v_add_u32 v238, s53, v238
    v_lshrrev_b32 v218, 2, v0
    v_mul_u32_u24 v26, 896, v218
    v_lshl_add_u32 v26, v210, 3, v26
    v_lshrrev_b32 v218, 2, v1
    v_mul_u32_u24 v252, 176, v218
    v_lshl_add_u32 v252, v210, 3, v252
    v_add_u32 v252, s53, v252
    s_sub_u32 s53, 49152, s52
    v_add_u32 v246, s53, v2
    v_add_u32 v247, s53, v3
    v_mul_u32_u24 v218, 3072, v208
    v_add_u32 v248, v218, v246
    v_add_u32 v249, v218, v247
    v_add_u32 v232, s52, v23
    v_xor_b32 v233, 4096, v232
    v_xor_b32 v234, 8192, v232
    v_xor_b32 v235, 12288, v232
    buffer_load_dwordx4 v[216:219], v22, s[4:7], s71 offen
    buffer_load_dwordx4 v[220:223], v22, s[4:7], s72 offen
    buffer_load_dwordx2 v[224:225], v26, s[4:7], s73 offen
    buffer_load_ushort v228, v25, s[36:39], s74 offen
    s_waitcnt vmcnt(0)
    ds_write_b128 v244, v[216:219]
    ds_write_b128 v244, v[220:223] offset:1408
    ds_write_b64 v252, v[224:225] offset:128
    ds_read_b64 v[216:217], v238 offset:0
    ds_read_b64 v[218:219], v238 offset:32
    ds_read_b64 v[220:221], v238 offset:64
    ds_read_b64 v[222:223], v238 offset:96
    ds_read_b64 v[224:225], v238 offset:128
    s_add_u32 m0, s52, 81920
    s_lshl_b32 s57, s76, 7
    buffer_load_dwordx4 v12, s[20:23], s57 offen offset:0 lds
    s_add_u32 s57, s57, 31744
    buffer_load_dwordx4 v12, s[20:23], s57 offen offset:1024 lds
    s_add_u32 s57, s57, 31744
    buffer_load_dwordx4 v12, s[20:23], s57 offen offset:2048 lds
    s_add_u32 s57, s57, 31744
    buffer_load_dwordx4 v12, s[20:23], s57 offen offset:3072 lds
    s_add_u32 m0, s52, 98304
    s_lshl_b32 s57, s76, 7
    s_add_u32 s57, s57, 131072
    buffer_load_dwordx4 v12, s[20:23], s57 offen offset:0 lds
    s_add_u32 s57, s57, 31744
    buffer_load_dwordx4 v12, s[20:23], s57 offen offset:1024 lds
    s_add_u32 s57, s57, 31744
    buffer_load_dwordx4 v12, s[20:23], s57 offen offset:2048 lds
    s_add_u32 s57, s57, 31744
    buffer_load_dwordx4 v12, s[20:23], s57 offen offset:3072 lds
    s_add_u32 m0, s52, 114688
    s_lshl_b32 s57, s77, 7
    buffer_load_dwordx4 v12, s[20:23], s57 offen offset:0 lds
    s_add_u32 s57, s57, 31744
    buffer_load_dwordx4 v12, s[20:23], s57 offen offset:1024 lds
    s_add_u32 s57, s57, 31744
    buffer_load_dwordx4 v12, s[20:23], s57 offen offset:2048 lds
    s_add_u32 s57, s57, 31744
    buffer_load_dwordx4 v12, s[20:23], s57 offen offset:3072 lds
    s_add_u32 m0, s52, 131072
    s_lshl_b32 s57, s77, 7
    s_add_u32 s57, s57, 131072
    buffer_load_dwordx4 v12, s[20:23], s57 offen offset:0 lds
    s_add_u32 s57, s57, 31744
    buffer_load_dwordx4 v12, s[20:23], s57 offen offset:1024 lds
    s_waitcnt vmcnt(10)
    ds_read_b64_tr_b16 a[0:1], v6 offset:32768
    ds_read_b64_tr_b16 a[2:3], v6 offset:34816
    ds_read_b64_tr_b16 a[4:5], v7 offset:32768
    ds_read_b64_tr_b16 a[6:7], v7 offset:34816
    ds_read_b64_tr_b16 a[8:9], v6 offset:33024
    ds_read_b64_tr_b16 a[10:11], v6 offset:35072
    ds_read_b64_tr_b16 a[12:13], v7 offset:33024
    ds_read_b64_tr_b16 a[14:15], v7 offset:35072
    s_add_u32 s57, s57, 31744
    buffer_load_dwordx4 v12, s[20:23], s57 offen offset:2048 lds
    s_add_u32 s57, s57, 31744
    buffer_load_dwordx4 v12, s[20:23], s57 offen offset:3072 lds
    s_add_u32 m0, s52, 147456
    s_lshl_b32 s57, s78, 7
    buffer_load_dwordx4 v12, s[20:23], s57 offen offset:0 lds
    s_add_u32 s57, s57, 31744
    buffer_load_dwordx4 v12, s[20:23], s57 offen offset:1024 lds
    s_waitcnt vmcnt(10)
    ds_read_b64_tr_b16 a[16:17], v6 offset:49152
    ds_read_b64_tr_b16 a[18:19], v6 offset:51200
    ds_read_b64_tr_b16 a[20:21], v7 offset:49152
    ds_read_b64_tr_b16 a[22:23], v7 offset:51200
    ds_read_b64_tr_b16 a[24:25], v6 offset:49408
    ds_read_b64_tr_b16 a[26:27], v6 offset:51456
    ds_read_b64_tr_b16 a[28:29], v7 offset:49408
    ds_read_b64_tr_b16 a[30:31], v7 offset:51456
    s_add_u32 s57, s57, 31744
    buffer_load_dwordx4 v12, s[20:23], s57 offen offset:2048 lds
    s_add_u32 s57, s57, 31744
    buffer_load_dwordx4 v12, s[20:23], s57 offen offset:3072 lds
    s_add_u32 m0, s52, 49152
    s_lshl_b32 s57, s78, 7
    s_add_u32 s57, s57, 131072
    buffer_load_dwordx4 v12, s[20:23], s57 offen offset:0 lds
    s_add_u32 s57, s57, 31744
    buffer_load_dwordx4 v12, s[20:23], s57 offen offset:1024 lds
    s_waitcnt vmcnt(10)
    ds_read_b64_tr_b16 a[32:33], v8 offset:0
    ds_read_b64_tr_b16 a[34:35], v8 offset:2048
    ds_read_b64_tr_b16 a[36:37], v9 offset:0
    ds_read_b64_tr_b16 a[38:39], v9 offset:2048
    ds_read_b64_tr_b16 a[40:41], v8 offset:256
    ds_read_b64_tr_b16 a[42:43], v8 offset:2304
    ds_read_b64_tr_b16 a[44:45], v9 offset:256
    ds_read_b64_tr_b16 a[46:47], v9 offset:2304
    s_add_u32 s57, s57, 31744
    buffer_load_dwordx4 v12, s[20:23], s57 offen offset:2048 lds
    s_add_u32 s57, s57, 31744
    buffer_load_dwordx4 v12, s[20:23], s57 offen offset:3072 lds
    s_waitcnt lgkmcnt(15)
    s_add_u32 m0, s52, 65536
    s_lshl_b32 s57, s79, 7
    buffer_load_dwordx4 v12, s[20:23], s57 offen offset:0 lds
    s_add_u32 s57, s57, 31744
    buffer_load_dwordx4 v12, s[20:23], s57 offen offset:1024 lds
    s_waitcnt vmcnt(10)
    ds_read_b64_tr_b16 a[48:49], v8 offset:16384
    ds_read_b64_tr_b16 a[50:51], v8 offset:18432
    ds_read_b64_tr_b16 a[52:53], v9 offset:16384
    ds_read_b64_tr_b16 a[54:55], v9 offset:18432
    s_add_u32 s57, s57, 31744
    buffer_load_dwordx4 v12, s[20:23], s57 offen offset:2048 lds
    ds_read_b64_tr_b16 a[56:57], v8 offset:16640
    ds_read_b64_tr_b16 a[58:59], v8 offset:18688
    ds_read_b64_tr_b16 a[60:61], v9 offset:16640
    ds_read_b64_tr_b16 a[62:63], v9 offset:18688
    s_add_u32 s57, s57, 31744
    buffer_load_dwordx4 v12, s[20:23], s57 offen offset:3072 lds
    s_add_u32 m0, s52, 81920
    s_lshl_b32 s57, s79, 7
    s_add_u32 s57, s57, 131072
    buffer_load_dwordx4 v12, s[20:23], s57 offen offset:0 lds
    s_add_u32 s57, s57, 31744
    buffer_load_dwordx4 v12, s[20:23], s57 offen offset:1024 lds
    s_waitcnt vmcnt(10)
    ds_read_b64_tr_b16 a[64:65], v8 offset:32768
    ds_read_b64_tr_b16 a[66:67], v8 offset:34816
    ds_read_b64_tr_b16 a[68:69], v9 offset:32768
    ds_read_b64_tr_b16 a[70:71], v9 offset:34816
    s_add_u32 s57, s57, 31744
    buffer_load_dwordx4 v12, s[20:23], s57 offen offset:2048 lds
    ds_read_b64_tr_b16 a[72:73], v8 offset:33024
    ds_read_b64_tr_b16 a[74:75], v8 offset:35072
    ds_read_b64_tr_b16 a[76:77], v9 offset:33024
    ds_read_b64_tr_b16 a[78:79], v9 offset:35072
    s_add_u32 s57, s57, 31744
    buffer_load_dwordx4 v12, s[20:23], s57 offen offset:3072 lds
    s_waitcnt lgkmcnt(15)
    s_add_u32 m0, s52, 98304
    s_lshl_b32 s57, s80, 7
    buffer_load_dwordx4 v12, s[20:23], s57 offen offset:0 lds
    s_add_u32 s57, s57, 31744
    buffer_load_dwordx4 v12, s[20:23], s57 offen offset:1024 lds
    s_waitcnt vmcnt(10)
    ds_read_b64_tr_b16 a[80:81], v6 offset:0
    ds_read_b64_tr_b16 a[82:83], v6 offset:2048
    ds_read_b64_tr_b16 a[84:85], v7 offset:0
    ds_read_b64_tr_b16 a[86:87], v7 offset:2048
    s_add_u32 s57, s57, 31744
    buffer_load_dwordx4 v12, s[20:23], s57 offen offset:2048 lds
    ds_read_b64_tr_b16 a[88:89], v6 offset:256
    ds_read_b64_tr_b16 a[90:91], v6 offset:2304
    ds_read_b64_tr_b16 a[92:93], v7 offset:256
    ds_read_b64_tr_b16 a[94:95], v7 offset:2304
    s_waitcnt vmcnt(0) lgkmcnt(0)
    s_branch L_p3join
L_role_a:
    v_lshrrev_b32 v112, 4, v1
    v_bfe_u32 v113, v1, 2, 2
    v_and_b32 v114, 3, v1
    v_and_b32 v115, 15, v1
    v_lshrrev_b32 v116, 5, v1
    s_and_b32 s48, s45, 6
    s_lshr_b32 s48, 0xc9, s48
    s_and_b32 s48, s48, 3
    s_and_b32 s53, s45, 1
    s_lshl3_add_u32 s49, s53, s46
    s_sub_u32 s49, s49, 24
    s_lshl_b32 s90, s44, 11
    s_and_b32 s53, s44, 1
    s_lshl_b32 s53, s53, 1
    v_lshlrev_b32 v117, 2, v112
    v_sub_u32 v117, v115, v117
    v_and_b32 v117, 15, v117
    v_xor_b32 v117, s53, v117
    v_mul_u32_u24 v2, 2688, v112
    v_lshl_add_u32 v2, v117, 4, v2
    s_mul_i32 s53, s44, 21504
    s_mul_i32 s54, s48, 224
    s_andn2_b32 s54, s54, 63
    s_add_u32 s53, s53, s54
    v_add_u32 v2, s53, v2
    s_add_u32 m0, s90, 65536
    s_mov_b32 s57, 896
    buffer_load_dwordx4 v2, s[8:11], s57 offen offset:0 lds
    s_mov_b32 s57, 10624
    buffer_load_dwordx4 v2, s[8:11], s57 offen offset:1024 lds
    v_mul_u32_u24 v109, 1088, v25
    v_lshl_add_u32 v109, v26, 4, v109
    v_mul_u32_u24 v110, 1088, v113
    v_lshl_add_u32 v110, v112, 5, v110
    v_lshl_add_u32 v110, v114, 3, v110
    s_lshl_b32 s53, s44, 7
    v_add_u32 v110, s53, v110
    v_mul_u32_u24 v111, 66816, v112
    v_lshl_add_u32 v111, v115, 4, v111
    s_mul_i32 s63, s44, 267264
    s_lshl_b32 s53, s2, 8
    s_add_u32 s63, s63, s53
    s_add_u32 s64, s63, 1069056
    v_cmp_gt_u32 vcc, 208, v0
    v_mov_b32 v100, 2130706432
    v_cmp_le_u32 s[92:93], 24, v26
    v_cndmask_b32 v22, v100, v111, vcc
    s_mov_b32 s62, 0x3f803f80
    s_mov_b32 s61, 0xffff0000
    v_mov_b32 v96, 0
    v_mov_b32 v97, 0
    v_and_b32 v117, 1, v112
    v_lshlrev_b32 v117, 5, v117
    s_mul_i32 s53, s44, 56
    s_and_b32 s54, s48, 1
    s_lshl_b32 s54, s54, 5
    s_add_u32 s53, s53, s54
    v_lshlrev_b32 v118, 11, v112
    v_lshl_add_u32 v118, v113, 8, v118
    v_add_u32 v118, 65536, v118
    v_lshl_add_u32 v119, v114, 3, s53
    v_add_u32 v119, 0, v119
    v_xor_b32 v119, v119, v117
    v_lshl_add_u32 v119, v113, 6, v119
    v_and_b32 v119, 255, v119
    v_add_u32 v6, v118, v119
    v_add_u32 v10, 49152, v6
    v_subrev_u32 v120, 65536, v6
    v_lshl_add_u32 v119, v114, 3, s53
    v_add_u32 v119, 32, v119
    v_xor_b32 v119, v119, v117
    v_lshl_add_u32 v119, v113, 6, v119
    v_and_b32 v119, 255, v119
    v_add_u32 v7, v118, v119
    v_add_u32 v11, 49152, v7
    v_subrev_u32 v121, 65536, v7
    s_and_b32 s54, s44, 1
    s_lshl_b32 s54, s54, 3
    s_sub_u32 s53, s53, s54
    v_lshl_add_u32 v119, v114, 4, s53
    v_add_u32 v119, 0, v119
    v_xor_b32 v119, v119, v117
    v_lshl_add_u32 v119, v113, 6, v119
    v_and_b32 v119, 255, v119
    v_add_u32 v8, v118, v119
    v_add_u32 v12, 49152, v8
    v_subrev_u32 v122, 65536, v8
    v_lshl_add_u32 v119, v114, 4, s53
    v_add_u32 v119, 8, v119
    v_xor_b32 v119, v119, v117
    v_lshl_add_u32 v119, v113, 6, v119
    v_and_b32 v119, 255, v119
    v_add_u32 v9, v118, v119
    v_add_u32 v13, 49152, v9
    v_subrev_u32 v123, 65536, v9
    s_waitcnt vmcnt(4)
    v_dot2c_f32_bf16 v96, s62, v32
    v_dot2c_f32_bf16 v97, v32, v32
    v_lshlrev_b32 v40, 16, v32
    v_and_b32 v41, s61, v32
    v_dot2c_f32_bf16 v96, s62, v33
    v_dot2c_f32_bf16 v97, v33, v33
    v_lshlrev_b32 v42, 16, v33
    v_and_b32 v43, s61, v33
    v_dot2c_f32_bf16 v96, s62, v34
    v_dot2c_f32_bf16 v97, v34, v34
    v_lshlrev_b32 v44, 16, v34
    v_and_b32 v45, s61, v34
    v_dot2c_f32_bf16 v96, s62, v35
    v_dot2c_f32_bf16 v97, v35, v35
    v_lshlrev_b32 v46, 16, v35
    v_and_b32 v47, s61, v35
    s_waitcnt vmcnt(3)
    v_dot2c_f32_bf16 v96, s62, v36
    v_dot2c_f32_bf16 v97, v36, v36
    v_lshlrev_b32 v48, 16, v36
    v_and_b32 v49, s61, v36
    v_dot2c_f32_bf16 v96, s62, v37
    v_dot2c_f32_bf16 v97, v37, v37
    v_lshlrev_b32 v50, 16, v37
    v_and_b32 v51, s61, v37
    v_dot2c_f32_bf16 v96, s62, v38
    v_dot2c_f32_bf16 v97, v38, v38
    v_lshlrev_b32 v52, 16, v38
    v_and_b32 v53, s61, v38
    v_dot2c_f32_bf16 v96, s62, v39
    v_dot2c_f32_bf16 v97, v39, v39
    v_lshlrev_b32 v54, 16, v39
    v_and_b32 v55, s61, v39
    buffer_load_dword v29, off, s[40:43], 0 sc1
    v_add_f32_dpp v96, v96, v96 quad_perm:[1,0,3,2] row_mask:0xf bank_mask:0xf
    v_add_f32_dpp v97, v97, v97 quad_perm:[1,0,3,2] row_mask:0xf bank_mask:0xf
    s_nop 0
    v_add_f32_dpp v96, v96, v96 quad_perm:[2,3,0,1] row_mask:0xf bank_mask:0xf
    v_add_f32_dpp v97, v97, v97 quad_perm:[2,3,0,1] row_mask:0xf bank_mask:0xf
    s_nop 0
    v_add_f32_dpp v96, v96, v96 row_half_mirror row_mask:0xf bank_mask:0xf
    v_add_f32_dpp v97, v97, v97 row_half_mirror row_mask:0xf bank_mask:0xf
    s_nop 0
    v_add_f32_dpp v96, v96, v96 row_mirror row_mask:0xf bank_mask:0xf
    v_add_f32_dpp v97, v97, v97 row_mirror row_mask:0xf bank_mask:0xf
    v_mov_b32 v98, v96
    v_mov_b32 v99, v97
    s_nop 0
    v_permlane16_swap_b32 v96, v98
    v_permlane16_swap_b32 v97, v99
    v_add_f32 v96, v96, v98
    v_add_f32 v97, v97, v99
    v_mul_f32 v98, 0x3b124925, v96
    v_mul_f32 v99, 0x3b124925, v97
    v_fma_f32 v99, -v98, v98, v99
    v_max_f32 v99, 0, v99
    v_cvt_pk_bf16_f32 v100, 0, v99
    v_add_f32 v100, 0x3727c5ac, v100
    v_cvt_pk_bf16_f32 v100, 0, v100
    v_sqrt_f32 v100, v100
    s_nop 0
    v_cvt_pk_bf16_f32 v100, 0, v100
    v_rcp_f32 v100, v100
    s_nop 0
    v_mul_f32 v99, v99, v100
    v_mul_f32 v99, v99, v100
    v_cvt_pk_bf16_f32 v104, 0, v99
    v_add_f32 v104, 0x3727c5ac, v104
    v_cvt_pk_bf16_f32 v104, 0, v104
    v_sqrt_f32 v104, v104
    s_nop 0
    v_cvt_pk_bf16_f32 v102, 0, v104
    v_rcp_f32 v104, v102
    s_nop 0
    v_mul_f32 v104, v104, v100
    v_mul_f32 v106, v98, v104
    v_pk_fma_f32 v[56:57], v[40:41], v[104:105], v[106:107] op_sel_hi:[1,0,0] neg_lo:[0,0,1] neg_hi:[0,0,1]
    v_pk_fma_f32 v[58:59], v[42:43], v[104:105], v[106:107] op_sel_hi:[1,0,0] neg_lo:[0,0,1] neg_hi:[0,0,1]
    v_pk_fma_f32 v[60:61], v[44:45], v[104:105], v[106:107] op_sel_hi:[1,0,0] neg_lo:[0,0,1] neg_hi:[0,0,1]
    v_pk_fma_f32 v[62:63], v[46:47], v[104:105], v[106:107] op_sel_hi:[1,0,0] neg_lo:[0,0,1] neg_hi:[0,0,1]
    v_pk_fma_f32 v[64:65], v[48:49], v[104:105], v[106:107] op_sel_hi:[1,0,0] neg_lo:[0,0,1] neg_hi:[0,0,1]
    v_pk_fma_f32 v[66:67], v[50:51], v[104:105], v[106:107] op_sel_hi:[1,0,0] neg_lo:[0,0,1] neg_hi:[0,0,1]
    v_pk_fma_f32 v[68:69], v[52:53], v[104:105], v[106:107] op_sel_hi:[1,0,0] neg_lo:[0,0,1] neg_hi:[0,0,1]
    v_pk_fma_f32 v[70:71], v[54:55], v[104:105], v[106:107] op_sel_hi:[1,0,0] neg_lo:[0,0,1] neg_hi:[0,0,1]
    v_cvt_pk_bf16_f32 v80, v56, v57
    v_cvt_pk_bf16_f32 v81, v58, v59
    v_cvt_pk_bf16_f32 v82, v60, v61
    v_cvt_pk_bf16_f32 v83, v62, v63
    v_cvt_pk_bf16_f32 v84, v64, v65
    v_cvt_pk_bf16_f32 v85, v66, v67
    v_cvt_pk_bf16_f32 v86, v68, v69
    v_cvt_pk_bf16_f32 v87, v70, v71
    v_lshrrev_b32 v102, 16, v102
    v_cndmask_b32 v84, v84, v102, s[92:93]
    ds_write_b128 v109, v[80:83] offset:49152
    ds_write_b128 v109, v[84:87] offset:49664
    s_waitcnt lgkmcnt(0)
    s_barrier
    ds_read_b64_tr_b16 v[88:89], v110 offset:49152
    ds_read_b64_tr_b16 v[90:91], v110 offset:53504
    ds_read_b64_tr_b16 v[92:93], v110 offset:49664
    ds_read_b64_tr_b16 v[94:95], v110 offset:54016
    s_waitcnt lgkmcnt(2)
    buffer_store_dwordx4 v[88:91], v111, s[24:27], s63 offen sc1
    s_waitcnt lgkmcnt(0)
    buffer_store_dwordx4 v[92:95], v22, s[24:27], s64 offen sc1
    s_add_u32 m0, s90, 73728
    s_mov_b32 s57, 86912
    buffer_load_dwordx4 v2, s[8:11], s57 offen offset:0 lds
    s_movk_i32 s94, 224
    v_mul_u32_u24 v3, 66816, v116
    v_and_b32 v118, 1, v112
    v_lshlrev_b32 v119, 2, v118
    v_xor_b32 v119, v119, v115
    v_lshl_add_u32 v3, v118, 8, v3
    v_lshl_add_u32 v3, v119, 4, v3
    v_cmp_gt_u32 s[92:93], s94, v0
    v_mov_b32 v119, 2130706432
    s_mov_b32 s57, 96640
    buffer_load_dwordx4 v2, s[8:11], s57 offen offset:1024 lds
    v_lshlrev_b32 v4, 9, v116
    v_cndmask_b32 v24, v119, v3, s[92:93]
    v_lshl_add_u32 v4, v118, 7, v4
    v_lshl_add_u32 v4, v113, 4, v4
    v_lshrrev_b32 v118, 1, v114
    v_mul_u32_u24 v118, 320, v118
    v_add_u32 v4, v118, v4
    v_and_b32 v118, 1, v114
    v_lshl_add_u32 v4, v118, 3, v4
    v_xor_b32 v25, 64, v4
    s_lshl_b32 s53, s49, 4
    s_sub_u32 s53, s53, 2
    v_min_u32 v117, 17, v1
    v_add_u32 v117, s53, v117
    v_max_i32 v117, 0, v117
    v_lshlrev_b32 v19, 5, v117
    s_add_u32 m0, s90, 81920
    s_mov_b32 s57, 172928
    buffer_load_dwordx4 v2, s[8:11], s57 offen offset:0 lds
    v_add_u32 v19, 12582912, v19
    v_and_b32 v117, 1, v115
    v_cmp_eq_u32 s[76:77], 1, v117
    v_lshl_add_u32 v117, v112, 2, v117
    v_cmp_le_u32 s[78:79], v117, v115
    v_mul_u32_u24 v118, 304, v116
    v_lshl_add_u32 v93, v117, 1, v118
    v_add_u32 v117, 2, v117
    v_cmp_le_u32 s[80:81], v117, v115
    v_add_u32 v94, 4, v93
    v_mov_b32 v118, 14336
    v_mov_b32 v119, 30720
    v_cndmask_b32 v117, v118, v119, s[78:79]
    v_add_u32 v93, v117, v93
    v_cndmask_b32 v117, v118, v119, s[80:81]
    v_add_u32 v94, v117, v94
    s_mov_b32 s57, 182656
    buffer_load_dwordx4 v2, s[8:11], s57 offen offset:1024 lds
    v_lshrrev_b32 v117, 3, v115
    v_mul_u32_u24 v117, 304, v117
    v_lshl_add_u32 v92, v115, 1, v117
    v_add_u32 v92, v119, v92
    v_cmp_eq_u32 s[82:83], 3, v112
    v_mov_b32 v117, 0xffff
    v_mov_b32 v118, 0xffff0000
    v_cndmask_b32 v117, v117, v118, s[76:77]
    v_cndmask_b32 v14, v117, 0, s[78:79]
    v_cndmask_b32 v15, v117, 0, s[80:81]
    v_cndmask_b32 v16, 0, v117, s[78:79]
    v_cndmask_b32 v17, 0, v117, s[80:81]
    s_mov_b32 s91, 0x3e8b97f6
    v_mov_b32 v18, 0xf149f2ca
    s_lshl_b32 s53, s49, 3
    s_lshl_b32 s72, s53, 9
    s_add_u32 m0, s90, 90112
    s_mov_b32 s57, 258944
    buffer_load_dwordx4 v2, s[8:11], s57 offen offset:0 lds
    s_lshl_b32 s74, s53, 14
    s_lshl2_add_u32 s54, s48, s44
    s_mul_i32 s54, s54, 7
    s_lshr_b32 s54, s54, 1
    s_lshl_b32 s54, s54, 8
    s_add_u32 s74, s74, s54
    s_add_u32 s74, s74, 4194304
    s_mul_i32 s68, s44, 534528
    s_add_u32 s68, s68, 0
    s_mul_i32 s69, s44, 534528
    s_add_u32 s69, s69, 132608
    s_mul_i32 s70, s44, 534528
    s_add_u32 s70, s70, 265216
    s_mul_i32 s71, s44, 534528
    s_add_u32 s71, s71, 397824
    s_cmp_eq_u32 s44, 3
    s_cselect_b32 s71, 2130706432, s71
    s_cmp_eq_u32 s49, 0
    s_cselect_b64 s[84:85], -1, 0
    s_andn2_b64 s[86:87], s[84:85], s[80:81]
    s_andn2_b64 s[84:85], s[84:85], s[78:79]
    s_bitcmp1_b32 s44, 0
    s_cselect_b64 s[88:89], -1, 0
    s_cselect_b32 s53, 0, 3
    s_cselect_b32 s54, 8, 0
    v_cmp_eq_u32 vcc, s53, v112
    s_lshr_b32 s53, s44, 1
    s_lshl_b32 s55, s53, 11
    s_add_u32 s54, s54, s55
    s_add_u32 s54, s54, 147456
    v_lshl_add_u32 v118, v115, 4, s54
    v_add_u32 v117, 151552, v23
    v_cndmask_b32 v95, v117, v118, vcc
    v_mov_b32 v117, 2130706432
    v_cndmask_b32 v23, v23, v117, vcc
    s_lshl1_add_u32 s53, s48, s53
    s_mul_i32 s53, s53, 1792
    s_and_b32 s54, s44, 1
    s_lshl1_add_u32 s54, s49, s54
    s_lshl_b32 s54, s54, 16
    s_add_u32 s53, s53, s54
    s_add_u32 s95, s53, 4195072
    s_and_b32 s53, s46, 7
    s_mul_i32 s54, s44, 28
    s_add_u32 s54, s54, s53
    s_add_u32 s54, s54, 12
    s_lshl_b32 s73, s54, 16
    s_lshl_b32 s54, s45, 9
    s_add_u32 s73, s73, s54
    s_lshl3_add_u32 s75, s44, s53
    s_lshl_b32 s75, s75, 13
    v_lshrrev_b32 v5, 2, v1
    v_lshlrev_b32 v5, 12, v5
    v_lshl_add_u32 v5, v114, 7, v5
    v_lshlrev_b32 v20, 7, v1
    s_mov_b32 s57, 268672
    buffer_load_dwordx4 v2, s[8:11], s57 offen offset:1024 lds
    s_add_u32 m0, s90, 98304
    s_mov_b32 s57, 344960
    buffer_load_dwordx4 v2, s[8:11], s57 offen offset:0 lds
    s_mov_b32 s57, 354688
    buffer_load_dwordx4 v2, s[8:11], s57 offen offset:1024 lds
    s_mov_b32 s59, s44
    s_mov_b64 exec, 0
    s_branch L_wa_go
L_wa_ret:
    s_add_u32 s59, s59, 4
L_wa_go:
    s_cmp_eq_u32 s59, 0
    s_cbranch_scc1 L_wa_0
    s_cmp_eq_u32 s59, 1
    s_cbranch_scc1 L_wa_1
    s_cmp_eq_u32 s59, 2
    s_cbranch_scc1 L_wa_2
    s_cmp_eq_u32 s59, 3
    s_cbranch_scc1 L_wa_3
    s_cmp_eq_u32 s59, 4
    s_cbranch_scc1 L_wa_4
    s_mov_b64 exec, -1
    s_add_u32 m0, s90, 106496
L_wa_0:
    s_cbranch_execz L_wa_ret
    s_mov_b32 s57, 430976
    buffer_load_dwordx4 v2, s[8:11], s57 offen offset:0 lds
    s_mov_b32 s57, 440704
    buffer_load_dwordx4 v2, s[8:11], s57 offen offset:1024 lds
    s_add_u32 m0, s90, 114688
    s_mov_b32 s57, 516992
    buffer_load_dwordx4 v2, s[8:11], s57 offen offset:0 lds
    s_mov_b32 s57, 526720
    buffer_load_dwordx4 v2, s[8:11], s57 offen offset:1024 lds
    s_add_u32 m0, s90, 122880
    s_mov_b32 s57, 603008
    buffer_load_dwordx4 v2, s[8:11], s57 offen offset:0 lds
    s_mov_b32 s57, 612736
    buffer_load_dwordx4 v2, s[8:11], s57 offen offset:1024 lds
    s_add_u32 m0, s90, 131072
    s_mov_b32 s57, 689024
    buffer_load_dwordx4 v2, s[8:11], s57 offen offset:0 lds
    s_mov_b32 s57, 698752
    buffer_load_dwordx4 v2, s[8:11], s57 offen offset:1024 lds
    s_add_u32 m0, s90, 139264
    s_mov_b32 s57, 775040
    buffer_load_dwordx4 v2, s[8:11], s57 offen offset:0 lds
    s_mov_b32 s57, 784768
    buffer_load_dwordx4 v2, s[8:11], s57 offen offset:1024 lds
    s_add_u32 m0, s90, 147456
    s_mov_b32 s57, 861056
    buffer_load_dwordx4 v2, s[8:11], s57 offen offset:0 lds
    s_mov_b32 s57, 870784
    buffer_load_dwordx4 v2, s[8:11], s57 offen offset:1024 lds
    s_waitcnt vmcnt(20)
    v_cmp_eq_u32 vcc, 0, v29
    s_nop 0
    s_cbranch_vccz L_ok15
    s_mov_b32 s59, 100000
L_spin14:
    buffer_load_dword v29, off, s[40:43], 0 sc1
    s_waitcnt vmcnt(0)
    v_cmp_eq_u32 vcc, 0, v29
    s_nop 0
    s_cbranch_vccz L_ok15
    s_sub_u32 s59, s59, 1
    s_cbranch_scc0 L_spin14
L_ok15:
    v_readfirstlane_b32 s47, v29
    s_barrier
    s_cmp_lg_u32 s44, 0
    s_cbranch_scc1 L_nopub16
    s_lshl_b32 s60, s2, 5
    s_add_u32 s60, s60, 12582912
    v_mov_b32 v30, s47
    s_mov_b64 exec, 1
    buffer_store_dword v30, off, s[24:27], s60 sc1
    s_mov_b64 exec, -1
L_nopub16:
    s_waitcnt vmcnt(16)
    s_barrier
    s_add_u32 m0, s90, 155648
    s_mov_b32 s57, 947072
    buffer_load_dwordx4 v2, s[8:11], s57 offen offset:0 lds
    s_mov_b32 s57, 956800
    buffer_load_dwordx4 v2, s[8:11], s57 offen offset:1024 lds
    ds_read_b64_tr_b16 a[8:9], v6 offset:0
    ds_read_b64_tr_b16 a[10:11], v6 offset:1024
    ds_read_b64_tr_b16 a[12:13], v7 offset:0
    ds_read_b64_tr_b16 a[14:15], v7 offset:1024
    s_add_u32 m0, s90, 0
    s_mov_b32 s57, 1033088
    buffer_load_dwordx4 v2, s[8:11], s57 offen offset:0 lds
    s_mov_b32 s57, 1042816
    buffer_load_dwordx4 v2, s[8:11], s57 offen offset:1024 lds
    ds_read_b64_tr_b16 a[32:33], v6 offset:8192
    ds_read_b64_tr_b16 a[34:35], v6 offset:9216
    ds_read_b64_tr_b16 a[36:37], v7 offset:8192
    ds_read_b64_tr_b16 a[38:39], v7 offset:9216
    s_add_u32 m0, s90, 8192
    s_mov_b32 s57, 1119104
    buffer_load_dwordx4 v2, s[8:11], s57 offen offset:0 lds
    s_mov_b32 s57, 1128832
    buffer_load_dwordx4 v2, s[8:11], s57 offen offset:1024 lds
    ds_read_b64_tr_b16 a[56:57], v6 offset:16384
    ds_read_b64_tr_b16 a[58:59], v6 offset:17408
    ds_read_b64_tr_b16 a[60:61], v7 offset:16384
    ds_read_b64_tr_b16 a[62:63], v7 offset:17408
    s_waitcnt vmcnt(16)
    s_waitcnt lgkmcnt(0)
    s_barrier
    s_add_u32 m0, s90, 16384
    s_mov_b32 s57, 1792
    buffer_load_dwordx4 v2, s[8:11], s57 offen offset:0 lds
    s_mov_b32 s57, 11520
    buffer_load_dwordx4 v2, s[8:11], s57 offen offset:1024 lds
    ds_read_b64_tr_b16 a[80:81], v6 offset:24576
    ds_read_b64_tr_b16 a[82:83], v6 offset:25600
    ds_read_b64_tr_b16 a[84:85], v7 offset:24576
    ds_read_b64_tr_b16 a[86:87], v7 offset:25600
    s_add_u32 m0, s90, 24576
    s_mov_b32 s57, 87808
    buffer_load_dwordx4 v2, s[8:11], s57 offen offset:0 lds
    s_mov_b32 s57, 97536
    buffer_load_dwordx4 v2, s[8:11], s57 offen offset:1024 lds
    ds_read_b64_tr_b16 a[104:105], v6 offset:32768
    ds_read_b64_tr_b16 a[106:107], v6 offset:33792
    ds_read_b64_tr_b16 a[108:109], v7 offset:32768
    ds_read_b64_tr_b16 a[110:111], v7 offset:33792
    s_add_u32 m0, s90, 32768
    s_mov_b32 s57, 173824
    buffer_load_dwordx4 v2, s[8:11], s57 offen offset:0 lds
    s_mov_b32 s57, 183552
    buffer_load_dwordx4 v2, s[8:11], s57 offen offset:1024 lds
    ds_read_b64_tr_b16 a[128:129], v6 offset:40960
    ds_read_b64_tr_b16 a[130:131], v6 offset:41984
    ds_read_b64_tr_b16 a[132:133], v7 offset:40960
    ds_read_b64_tr_b16 a[134:135], v7 offset:41984
    s_waitcnt vmcnt(16)
    s_waitcnt lgkmcnt(0)
    s_barrier
    s_add_u32 m0, s90, 40960
    s_mov_b32 s57, 259840
    buffer_load_dwordx4 v2, s[8:11], s57 offen offset:0 lds
    s_mov_b32 s57, 269568
    buffer_load_dwordx4 v2, s[8:11], s57 offen offset:1024 lds
    ds_read_b64_tr_b16 a[152:153], v10 offset:0
    ds_read_b64_tr_b16 a[154:155], v10 offset:1024
    ds_read_b64_tr_b16 a[156:157], v11 offset:0
    ds_read_b64_tr_b16 a[158:159], v11 offset:1024
    s_add_u32 m0, s90, 65536
    s_mov_b32 s57, 345856
    buffer_load_dwordx4 v2, s[8:11], s57 offen offset:0 lds
    s_mov_b32 s57, 355584
    buffer_load_dwordx4 v2, s[8:11], s57 offen offset:1024 lds
    ds_read_b64_tr_b16 a[176:177], v10 offset:8192
    ds_read_b64_tr_b16 a[178:179], v10 offset:9216
    ds_read_b64_tr_b16 a[180:181], v11 offset:8192
    ds_read_b64_tr_b16 a[182:183], v11 offset:9216
    s_add_u32 m0, s90, 73728
    s_mov_b32 s57, 431872
    buffer_load_dwordx4 v2, s[8:11], s57 offen offset:0 lds
    s_mov_b32 s57, 441600
    buffer_load_dwordx4 v2, s[8:11], s57 offen offset:1024 lds
    ds_read_b64_tr_b16 a[200:201], v10 offset:16384
    ds_read_b64_tr_b16 a[202:203], v10 offset:17408
    ds_read_b64_tr_b16 a[204:205], v11 offset:16384
    ds_read_b64_tr_b16 a[206:207], v11 offset:17408
    s_waitcnt vmcnt(16)
    s_waitcnt lgkmcnt(0)
    s_barrier
    ds_read_b64_tr_b16 a[224:225], v10 offset:24576
    ds_read_b64_tr_b16 a[226:227], v10 offset:25600
    ds_read_b64_tr_b16 a[228:229], v11 offset:24576
    ds_read_b64_tr_b16 a[230:231], v11 offset:25600
    ds_read_b64_tr_b16 a[248:249], v10 offset:32768
    ds_read_b64_tr_b16 a[250:251], v10 offset:33792
    ds_read_b64_tr_b16 a[252:253], v11 offset:32768
    ds_read_b64_tr_b16 a[254:255], v11 offset:33792
    s_add_u32 m0, s90, 81920
    s_mov_b32 s57, 517888
    buffer_load_dwordx4 v2, s[8:11], s57 offen offset:0 lds
    ds_read_b64_tr_b16 v[192:193], v10 offset:40960
    ds_read_b64_tr_b16 v[194:195], v10 offset:41984
    ds_read_b64_tr_b16 v[196:197], v11 offset:40960
    ds_read_b64_tr_b16 v[198:199], v11 offset:41984
    s_mov_b32 s57, 527616
    buffer_load_dwordx4 v2, s[8:11], s57 offen offset:1024 lds
    s_waitcnt vmcnt(12)
    s_waitcnt lgkmcnt(0)
    s_barrier
    ds_read_b64_tr_b16 v[216:217], v120 offset:0
    ds_read_b64_tr_b16 v[218:219], v120 offset:1024
    ds_read_b64_tr_b16 v[220:221], v121 offset:0
    ds_read_b64_tr_b16 v[222:223], v121 offset:1024
    ds_read_b64_tr_b16 v[240:241], v120 offset:8192
    ds_read_b64_tr_b16 v[242:243], v120 offset:9216
    ds_read_b64_tr_b16 v[244:245], v121 offset:8192
    ds_read_b64_tr_b16 v[246:247], v121 offset:9216
    ds_read_b64_tr_b16 a[16:17], v122 offset:16384
    ds_read_b64_tr_b16 a[18:19], v122 offset:17408
    ds_read_b64_tr_b16 a[20:21], v123 offset:16384
    ds_read_b64_tr_b16 a[22:23], v123 offset:17408
    buffer_load_dword v21, v19, s[24:27], 0 offen sc1
    s_add_u32 m0, s90, 90112
    s_mov_b32 s57, 603904
    buffer_load_dwordx4 v2, s[8:11], s57 offen offset:0 lds
    s_mov_b32 s57, 613632
    buffer_load_dwordx4 v2, s[8:11], s57 offen offset:1024 lds
    s_add_u32 m0, s90, 98304
    s_mov_b32 s57, 689920
    buffer_load_dwordx4 v2, s[8:11], s57 offen offset:0 lds
    s_mov_b32 s57, 699648
    buffer_load_dwordx4 v2, s[8:11], s57 offen offset:1024 lds
    s_add_u32 m0, s90, 106496
    s_mov_b32 s57, 775936
    buffer_load_dwordx4 v2, s[8:11], s57 offen offset:0 lds
    s_waitcnt vmcnt(12)
    s_waitcnt lgkmcnt(0)
    s_barrier
    ds_read_b64_tr_b16 a[40:41], v122 offset:24576
    ds_read_b64_tr_b16 a[42:43], v122 offset:25600
    ds_read_b64_tr_b16 a[44:45], v123 offset:24576
    ds_read_b64_tr_b16 a[46:47], v123 offset:25600
    ds_read_b64_tr_b16 a[64:65], v122 offset:32768
    ds_read_b64_tr_b16 a[66:67], v122 offset:33792
    ds_read_b64_tr_b16 a[68:69], v123 offset:32768
    ds_read_b64_tr_b16 a[70:71], v123 offset:33792
    ds_read_b64_tr_b16 a[88:89], v122 offset:40960
    ds_read_b64_tr_b16 a[90:91], v122 offset:41984
    ds_read_b64_tr_b16 a[92:93], v123 offset:40960
    ds_read_b64_tr_b16 a[94:95], v123 offset:41984
    s_mov_b32 s57, 785664
    buffer_load_dwordx4 v2, s[8:11], s57 offen offset:1024 lds
    s_waitcnt vmcnt(7)
    s_waitcnt lgkmcnt(0)
    s_barrier
    ds_read_b64_tr_b16 a[112:113], v8 offset:0
    ds_read_b64_tr_b16 a[114:115], v8 offset:1024
    ds_read_b64_tr_b16 a[116:117], v9 offset:0
    ds_read_b64_tr_b16 a[118:119], v9 offset:1024
    ds_read_b64_tr_b16 a[136:137], v8 offset:8192
    ds_read_b64_tr_b16 a[138:139], v8 offset:9216
    ds_read_b64_tr_b16 a[140:141], v9 offset:8192
    ds_read_b64_tr_b16 a[142:143], v9 offset:9216
    ds_read_b64_tr_b16 a[160:161], v8 offset:16384
    ds_read_b64_tr_b16 a[162:163], v8 offset:17408
    ds_read_b64_tr_b16 a[164:165], v9 offset:16384
    ds_read_b64_tr_b16 a[166:167], v9 offset:17408
    s_waitcnt vmcnt(6)
    v_cmp_ne_u32 vcc, s47, v21
    s_nop 0
    s_cbranch_vccz L_ok18
    s_mov_b32 s59, 100000
L_spin17:
    buffer_load_dword v21, v19, s[24:27], 0 offen sc1
    s_waitcnt vmcnt(0)
    v_cmp_ne_u32 vcc, s47, v21
    s_nop 0
    s_cbranch_vccz L_ok18
    s_sub_u32 s59, s59, 1
    s_cbranch_scc0 L_spin17
L_ok18:
    s_add_u32 m0, s52, 0
    s_sub_u32 s58, s72, 512
    s_max_i32 s58, s58, 0
    s_add_u32 s57, s58, s68
    buffer_load_dwordx4 v3, s[24:27], s57 offen offset:0 sc1 lds
    s_add_u32 s57, s58, s69
    buffer_load_dwordx4 v3, s[24:27], s57 offen offset:1024 sc1 lds
    s_add_u32 s57, s58, s70
    buffer_load_dwordx4 v24, s[24:27], s57 offen offset:2048 sc1 lds
    s_add_u32 s57, s58, s71
    buffer_load_dwordx4 v3, s[24:27], s57 offen offset:3072 sc1 lds
    s_add_u32 m0, s52, 16384
    s_add_u32 s58, s72, 0
    s_add_u32 s57, s58, s68
    buffer_load_dwordx4 v3, s[24:27], s57 offen offset:0 sc1 lds
    s_add_u32 s57, s58, s69
    buffer_load_dwordx4 v3, s[24:27], s57 offen offset:1024 sc1 lds
    s_add_u32 s57, s58, s70
    buffer_load_dwordx4 v24, s[24:27], s57 offen offset:2048 sc1 lds
    s_add_u32 s57, s58, s71
    buffer_load_dwordx4 v3, s[24:27], s57 offen offset:3072 sc1 lds
    s_add_u32 m0, s90, 114688
    s_mov_b32 s57, 861952
    buffer_load_dwordx4 v2, s[8:11], s57 offen offset:0 lds
    s_mov_b32 s57, 871680
    buffer_load_dwordx4 v2, s[8:11], s57 offen offset:1024 lds
    s_add_u32 m0, s90, 122880
    s_mov_b32 s57, 947968
    buffer_load_dwordx4 v2, s[8:11], s57 offen offset:0 lds
    s_mov_b32 s57, 957696
    buffer_load_dwordx4 v2, s[8:11], s57 offen offset:1024 lds
    s_add_u32 m0, s90, 131072
    s_mov_b32 s57, 1033984
    buffer_load_dwordx4 v2, s[8:11], s57 offen offset:0 lds
    s_mov_b32 s57, 1043712
    buffer_load_dwordx4 v2, s[8:11], s57 offen offset:1024 lds
    s_add_u32 m0, s52, 32768
    s_add_u32 s58, s72, 512
    s_add_u32 s57, s58, s68
    buffer_load_dwordx4 v3, s[24:27], s57 offen offset:0 sc1 lds
    s_add_u32 s57, s58, s69
    buffer_load_dwordx4 v3, s[24:27], s57 offen offset:1024 sc1 lds
    s_waitcnt vmcnt(12)
    s_waitcnt lgkmcnt(0)
    s_barrier
    ds_read_b64_tr_b16 v[120:121], v4 offset:0
    ds_read_b64_tr_b16 v[122:123], v25 offset:0
    ds_read_b64_tr_b16 v[124:125], v4 offset:1024
    ds_read_b64_tr_b16 v[126:127], v25 offset:1024
    ds_read_b64_tr_b16 v[128:129], v4 offset:2048
    ds_read_b64_tr_b16 v[130:131], v25 offset:2048
    ds_read_b64_tr_b16 v[132:133], v4 offset:3072
    ds_read_b64_tr_b16 v[134:135], v25 offset:3072
    ds_read_b64_tr_b16 v[136:137], v4 offset:4096
    ds_read_b64_tr_b16 v[138:139], v25 offset:4096
    ds_read_b64_tr_b16 v[140:141], v4 offset:5120
    ds_read_b64_tr_b16 v[142:143], v25 offset:5120
    ds_read_b64_tr_b16 v[144:145], v4 offset:6144
    ds_read_b64_tr_b16 v[146:147], v25 offset:6144
    ds_read_b64_tr_b16 v[148:149], v4 offset:7168
    ds_read_b64_tr_b16 v[150:151], v25 offset:7168
    ds_read_b64_tr_b16 v[152:153], v4 offset:8192
    ds_read_b64_tr_b16 v[154:155], v25 offset:8192
    ds_read_b64_tr_b16 v[156:157], v4 offset:9216
    ds_read_b64_tr_b16 v[158:159], v25 offset:9216
    ds_read_b64_tr_b16 v[160:161], v4 offset:10240
    ds_read_b64_tr_b16 v[162:163], v25 offset:10240
    ds_read_b64_tr_b16 v[164:165], v4 offset:11264
    ds_read_b64_tr_b16 v[166:167], v25 offset:11264
    ds_read_b64_tr_b16 v[168:169], v4 offset:12288
    ds_read_b64_tr_b16 v[170:171], v25 offset:12288
    ds_read_b64_tr_b16 v[172:173], v4 offset:13312
    ds_read_b64_tr_b16 v[174:175], v25 offset:13312
    s_waitcnt lgkmcnt(15)
    v_mfma_f32_16x16x32_bf16 v[96:99], a[8:11], v[120:123], 0
    s_add_u32 s57, s58, s70
    ds_read_b64_tr_b16 a[184:185], v8 offset:24576
    v_mfma_f32_16x16x32_bf16 v[96:99], a[32:35], v[124:127], v[96:99]
    buffer_load_dwordx4 v24, s[24:27], s57 offen offset:2048 sc1 lds
    v_mfma_f32_16x16x32_bf16 v[96:99], a[56:59], v[128:131], v[96:99]
    ds_read_b64_tr_b16 a[186:187], v8 offset:25600
    ds_read_b64_tr_b16 a[188:189], v9 offset:24576
    v_mfma_f32_16x16x32_bf16 v[96:99], a[80:83], v[132:135], v[96:99]
    ds_read_b64_tr_b16 a[190:191], v9 offset:25600
    ds_read_b64_tr_b16 a[208:209], v8 offset:32768
    v_mfma_f32_16x16x32_bf16 v[96:99], a[104:107], v[136:139], v[96:99]
    s_add_u32 s57, s58, s71
    ds_read_b64_tr_b16 a[210:211], v8 offset:33792
    v_mfma_f32_16x16x32_bf16 v[96:99], a[128:131], v[140:143], v[96:99]
    buffer_load_dwordx4 v3, s[24:27], s57 offen offset:3072 sc1 lds
    s_waitcnt lgkmcnt(15)
    v_mfma_f32_16x16x32_bf16 v[96:99], a[152:155], v[144:147], v[96:99]
    ds_read_b64_tr_b16 a[212:213], v9 offset:32768
    ds_read_b64_tr_b16 a[214:215], v9 offset:33792
    v_mfma_f32_16x16x32_bf16 v[96:99], a[176:179], v[148:151], v[96:99]
    ds_read_b64_tr_b16 a[232:233], v8 offset:40960
    ds_read_b64_tr_b16 a[234:235], v8 offset:41984
    s_waitcnt lgkmcnt(15)
    v_mfma_f32_16x16x32_bf16 v[96:99], a[200:203], v[152:155], v[96:99]
    s_add_u32 m0, s90, 139264
    s_mov_b32 s57, 1120000
    ds_read_b64_tr_b16 a[236:237], v9 offset:40960
    v_mfma_f32_16x16x32_bf16 v[96:99], a[224:227], v[156:159], v[96:99]
    buffer_load_dwordx4 v2, s[8:11], s57 offen offset:0 lds
    s_waitcnt lgkmcnt(15)
    v_mfma_f32_16x16x32_bf16 v[96:99], a[248:251], v[160:163], v[96:99]
    ds_read_b64_tr_b16 a[238:239], v9 offset:41984
    v_mfma_f32_16x16x32_bf16 v[96:99], v[192:195], v[164:167], v[96:99]
    s_waitcnt lgkmcnt(12)
    v_mfma_f32_16x16x32_bf16 v[96:99], v[216:219], v[168:171], v[96:99]
    s_mov_b32 s57, 1129728
    v_mfma_f32_16x16x32_bf16 v[96:99], v[240:243], v[172:175], v[96:99]
    buffer_load_dwordx4 v2, s[8:11], s57 offen offset:1024 lds
    s_waitcnt vmcnt(12)
    s_barrier
    v_mfma_f32_16x16x32_bf16 v[100:103], a[12:15], v[120:123], 0
    ds_read_b64_tr_b16 v[120:121], v4 offset:16384
    ds_read_b64_tr_b16 v[122:123], v25 offset:16384
    v_mfma_f32_16x16x32_bf16 v[100:103], a[36:39], v[124:127], v[100:103]
    ds_read_b64_tr_b16 v[124:125], v4 offset:17408
    v_mfma_f32_16x16x32_bf16 v[100:103], a[60:63], v[128:131], v[100:103]
    ds_read_b64_tr_b16 v[126:127], v25 offset:17408
    ds_read_b64_tr_b16 v[128:129], v4 offset:18432
    s_add_u32 m0, s90, 147456
    s_mov_b32 s57, 0
    v_mfma_f32_16x16x32_bf16 v[100:103], a[84:87], v[132:135], v[100:103]
    buffer_load_dwordx4 v2, s[8:11], s57 offen offset:0 lds
    v_mfma_f32_16x16x32_bf16 v[100:103], a[108:111], v[136:139], v[100:103]
    ds_read_b64_tr_b16 v[130:131], v25 offset:18432
    ds_read_b64_tr_b16 v[132:133], v4 offset:19456
    v_mfma_f32_16x16x32_bf16 v[100:103], a[132:135], v[140:143], v[100:103]
    ds_read_b64_tr_b16 v[134:135], v25 offset:19456
    ds_read_b64_tr_b16 v[136:137], v4 offset:20480
    v_mfma_f32_16x16x32_bf16 v[100:103], a[156:159], v[144:147], v[100:103]
    ds_read_b64_tr_b16 v[138:139], v25 offset:20480
    s_mov_b32 s57, 9728
    v_mfma_f32_16x16x32_bf16 v[100:103], a[180:183], v[148:151], v[100:103]
    buffer_load_dwordx4 v2, s[8:11], s57 offen offset:1024 lds
    v_mfma_f32_16x16x32_bf16 v[100:103], a[204:207], v[152:155], v[100:103]
    ds_read_b64_tr_b16 v[140:141], v4 offset:21504
    ds_read_b64_tr_b16 v[142:143], v25 offset:21504
    v_mfma_f32_16x16x32_bf16 v[100:103], a[228:231], v[156:159], v[100:103]
    ds_read_b64_tr_b16 v[144:145], v4 offset:22528
    ds_read_b64_tr_b16 v[146:147], v25 offset:22528
    v_mfma_f32_16x16x32_bf16 v[100:103], a[252:255], v[160:163], v[100:103]
    ds_read_b64_tr_b16 v[148:149], v4 offset:23552
    ds_read_b64_tr_b16 v[150:151], v25 offset:23552
    s_add_u32 m0, s90, 155648
    s_mov_b32 s57, 86016
    v_mfma_f32_16x16x32_bf16 v[100:103], v[196:199], v[164:167], v[100:103]
    buffer_load_dwordx4 v2, s[8:11], s57 offen offset:0 lds
    v_mfma_f32_16x16x32_bf16 v[100:103], v[220:223], v[168:171], v[100:103]
    ds_read_b64_tr_b16 v[152:153], v4 offset:24576
    ds_read_b64_tr_b16 v[154:155], v25 offset:24576
    v_mfma_f32_16x16x32_bf16 v[100:103], v[244:247], v[172:175], v[100:103]
    ds_read_b64_tr_b16 v[156:157], v4 offset:25600
    ds_read_b64_tr_b16 v[158:159], v25 offset:25600
    s_waitcnt lgkmcnt(15)
    v_mfma_f32_16x16x32_bf16 v[104:107], a[8:11], v[120:123], 0
    ds_read_b64_tr_b16 v[160:161], v4 offset:26624
    s_mov_b32 s57, 95744
    v_mfma_f32_16x16x32_bf16 v[104:107], a[32:35], v[124:127], v[104:107]
    buffer_load_dwordx4 v2, s[8:11], s57 offen offset:1024 lds
    s_waitcnt lgkmcnt(13)
    v_mfma_f32_16x16x32_bf16 v[104:107], a[56:59], v[128:131], v[104:107]
    ds_read_b64_tr_b16 v[162:163], v25 offset:26624
    ds_read_b64_tr_b16 v[164:165], v4 offset:27648
    v_mfma_f32_16x16x32_bf16 v[104:107], a[80:83], v[132:135], v[104:107]
    ds_read_b64_tr_b16 v[166:167], v25 offset:27648
    ds_read_b64_tr_b16 v[168:169], v4 offset:28672
    s_waitcnt vmcnt(10)
    s_barrier
    s_waitcnt lgkmcnt(13)
    v_mfma_f32_16x16x32_bf16 v[104:107], a[104:107], v[136:139], v[104:107]
    ds_read_b64_tr_b16 v[170:171], v25 offset:28672
    ds_read_b64_tr_b16 v[172:173], v4 offset:29696
    s_add_u32 m0, s90, 65536
    s_mov_b32 s57, 172032
    v_mfma_f32_16x16x32_bf16 v[104:107], a[128:131], v[140:143], v[104:107]
    buffer_load_dwordx4 v2, s[8:11], s57 offen offset:0 lds
    s_waitcnt lgkmcnt(11)
    v_mfma_f32_16x16x32_bf16 v[104:107], a[152:155], v[144:147], v[104:107]
    ds_read_b64_tr_b16 v[174:175], v25 offset:29696
    v_cvt_pk_bf16_f32 v52, v96, v97
    v_mfma_f32_16x16x32_bf16 v[104:107], a[176:179], v[148:151], v[104:107]
    v_cvt_pk_bf16_f32 v53, v98, v99
    v_cvt_pk_bf16_f32 v54, v100, v101
    s_waitcnt lgkmcnt(8)
    v_mfma_f32_16x16x32_bf16 v[104:107], a[200:203], v[152:155], v[104:107]
    s_mov_b32 s57, 181760
    v_cvt_pk_bf16_f32 v55, v102, v103
    v_mfma_f32_16x16x32_bf16 v[104:107], a[224:227], v[156:159], v[104:107]
    buffer_load_dwordx4 v2, s[8:11], s57 offen offset:1024 lds
    s_waitcnt lgkmcnt(4)
    v_mfma_f32_16x16x32_bf16 v[104:107], a[248:251], v[160:163], v[104:107]
    v_cndmask_b32 v54, v54, 0, s[82:83]
    v_cndmask_b32 v55, v55, 0, s[82:83]
    v_mfma_f32_16x16x32_bf16 v[104:107], v[192:195], v[164:167], v[104:107]
    ds_read_b64_tr_b16 v[176:177], v12 offset:0
    ds_read_b64_tr_b16 v[178:179], v12 offset:1024
    s_waitcnt lgkmcnt(2)
    v_mfma_f32_16x16x32_bf16 v[104:107], v[216:219], v[168:171], v[104:107]
    s_add_u32 m0, s90, 73728
    s_mov_b32 s57, 258048
    ds_read_b64_tr_b16 v[180:181], v13 offset:0
    v_mfma_f32_16x16x32_bf16 v[104:107], v[240:243], v[172:175], v[104:107]
    buffer_load_dwordx4 v2, s[8:11], s57 offen offset:0 lds
    v_mfma_f32_16x16x32_bf16 v[108:111], a[12:15], v[120:123], 0
    ds_read_b64_tr_b16 v[182:183], v13 offset:1024
    ds_read_b64_tr_b16 v[200:201], v12 offset:8192
    v_mfma_f32_16x16x32_bf16 v[108:111], a[36:39], v[124:127], v[108:111]
    ds_read_b64_tr_b16 v[202:203], v12 offset:9216
    ds_read_b64_tr_b16 v[204:205], v13 offset:8192
    v_mfma_f32_16x16x32_bf16 v[108:111], a[60:63], v[128:131], v[108:111]
    s_mov_b32 s57, 267776
    ds_read_b64_tr_b16 v[206:207], v13 offset:9216
    v_mfma_f32_16x16x32_bf16 v[108:111], a[84:87], v[132:135], v[108:111]
    buffer_load_dwordx4 v2, s[8:11], s57 offen offset:1024 lds
    v_mfma_f32_16x16x32_bf16 v[108:111], a[108:111], v[136:139], v[108:111]
    ds_read_b64_tr_b16 v[224:225], v12 offset:16384
    ds_read_b64_tr_b16 v[226:227], v12 offset:17408
    v_mfma_f32_16x16x32_bf16 v[108:111], a[132:135], v[140:143], v[108:111]
    ds_read_b64_tr_b16 v[228:229], v13 offset:16384
    ds_read_b64_tr_b16 v[230:231], v13 offset:17408
    v_mfma_f32_16x16x32_bf16 v[108:111], a[156:159], v[144:147], v[108:111]
    s_add_u32 m0, s90, 81920
    s_mov_b32 s57, 344064
    v_cvt_pk_bf16_f32 v56, v104, v105
    v_mfma_f32_16x16x32_bf16 v[108:111], a[180:183], v[148:151], v[108:111]
    buffer_load_dwordx4 v2, s[8:11], s57 offen offset:0 lds
    v_mfma_f32_16x16x32_bf16 v[108:111], a[204:207], v[152:155], v[108:111]
    v_cvt_pk_bf16_f32 v57, v106, v107
    v_mfma_f32_16x16x32_bf16 v[108:111], a[228:231], v[156:159], v[108:111]
    v_mfma_f32_16x16x32_bf16 v[108:111], a[252:255], v[160:163], v[108:111]
    s_mov_b32 s57, 353792
    v_mfma_f32_16x16x32_bf16 v[108:111], v[196:199], v[164:167], v[108:111]
    buffer_load_dwordx4 v2, s[8:11], s57 offen offset:1024 lds
    v_mfma_f32_16x16x32_bf16 v[108:111], v[220:223], v[168:171], v[108:111]
    v_mfma_f32_16x16x32_bf16 v[108:111], v[244:247], v[172:175], v[108:111]
    v_mfma_f32_16x16x32_bf16 v[112:115], v[120:123], a[16:19], 0
    s_add_u32 m0, s90, 90112
    s_mov_b32 s57, 430080
    v_mfma_f32_16x16x32_bf16 v[112:115], v[124:127], a[40:43], v[112:115]
    buffer_load_dwordx4 v2, s[8:11], s57 offen offset:0 lds
    v_mfma_f32_16x16x32_bf16 v[112:115], v[128:131], a[64:67], v[112:115]
    v_mfma_f32_16x16x32_bf16 v[112:115], v[132:135], a[88:91], v[112:115]
    v_mfma_f32_16x16x32_bf16 v[112:115], v[136:139], a[112:115], v[112:115]
    s_mov_b32 s57, 439808
    v_mfma_f32_16x16x32_bf16 v[112:115], v[140:143], a[136:139], v[112:115]
    buffer_load_dwordx4 v2, s[8:11], s57 offen offset:1024 lds
    v_mfma_f32_16x16x32_bf16 v[112:115], v[144:147], a[160:163], v[112:115]
    v_cvt_pk_bf16_f32 v58, v108, v109
    v_cvt_pk_bf16_f32 v59, v110, v111
    v_mfma_f32_16x16x32_bf16 v[112:115], v[148:151], a[184:187], v[112:115]
    v_cndmask_b32 v58, v58, 0, s[82:83]
    v_cndmask_b32 v59, v59, 0, s[82:83]
    v_mfma_f32_16x16x32_bf16 v[112:115], v[152:155], a[208:211], v[112:115]
    s_add_u32 m0, s90, 98304
    s_mov_b32 s57, 516096
    buffer_load_dwordx4 v2, s[8:11], s57 offen offset:0 lds
    s_waitcnt vmcnt(9)
    s_waitcnt lgkmcnt(0)
    s_barrier
    ds_read_b64_tr_b16 v[248:249], v12 offset:24576
    ds_read_b64_tr_b16 v[250:251], v12 offset:25600
    ds_read_b64_tr_b16 v[252:253], v13 offset:24576
    ds_read_b64_tr_b16 v[254:255], v13 offset:25600
    v_mfma_f32_16x16x32_bf16 v[112:115], v[156:159], a[232:235], v[112:115]
    ds_read_b64_tr_b16 a[0:1], v10 offset:32768
    ds_read_b64_tr_b16 a[2:3], v10 offset:33792
    v_mfma_f32_16x16x32_bf16 v[112:115], v[160:163], v[176:179], v[112:115]
    ds_read_b64_tr_b16 a[4:5], v11 offset:32768
    ds_read_b64_tr_b16 a[6:7], v11 offset:33792
    v_mfma_f32_16x16x32_bf16 v[112:115], v[164:167], v[200:203], v[112:115]
    ds_read_b64_tr_b16 a[24:25], v10 offset:40960
    ds_read_b64_tr_b16 a[26:27], v10 offset:41984
    s_waitcnt lgkmcnt(6)
    v_mfma_f32_16x16x32_bf16 v[112:115], v[168:171], v[224:227], v[112:115]
    s_mov_b32 s57, 525824
    ds_read_b64_tr_b16 a[28:29], v11 offset:40960
    v_mfma_f32_16x16x32_bf16 v[112:115], v[172:175], v[248:251], v[112:115]
    buffer_load_dwordx4 v2, s[8:11], s57 offen offset:1024 lds
    v_mfma_f32_16x16x32_bf16 v[116:119], v[120:123], a[20:23], 0
    ds_read_b64_tr_b16 v[120:121], v4 offset:0
    ds_read_b64_tr_b16 v[122:123], v25 offset:0
    v_mfma_f32_16x16x32_bf16 v[116:119], v[124:127], a[44:47], v[116:119]
    ds_read_b64_tr_b16 v[124:125], v4 offset:1024
    ds_read_b64_tr_b16 a[30:31], v11 offset:41984
    v_mfma_f32_16x16x32_bf16 v[116:119], v[128:131], a[68:71], v[116:119]
    ds_read_b64_tr_b16 v[126:127], v25 offset:1024
    ds_read_b64_tr_b16 v[128:129], v4 offset:2048
    s_add_u32 m0, s90, 106496
    s_mov_b32 s57, 602112
    v_mfma_f32_16x16x32_bf16 v[116:119], v[132:135], a[92:95], v[116:119]
    buffer_load_dwordx4 v2, s[8:11], s57 offen offset:0 lds
    v_mfma_f32_16x16x32_bf16 v[116:119], v[136:139], a[116:119], v[116:119]
    ds_read_b64_tr_b16 v[130:131], v25 offset:2048
    ds_read_b64_tr_b16 v[132:133], v4 offset:3072
    v_mfma_f32_16x16x32_bf16 v[116:119], v[140:143], a[140:143], v[116:119]
    ds_read_b64_tr_b16 v[134:135], v25 offset:3072
    ds_read_b64_tr_b16 v[136:137], v4 offset:4096
    v_mfma_f32_16x16x32_bf16 v[116:119], v[144:147], a[164:167], v[116:119]
    ds_read_b64_tr_b16 v[138:139], v25 offset:4096
    s_mov_b32 s57, 611840
    v_mfma_f32_16x16x32_bf16 v[116:119], v[148:151], a[188:191], v[116:119]
    buffer_load_dwordx4 v2, s[8:11], s57 offen offset:1024 lds
    v_mfma_f32_16x16x32_bf16 v[116:119], v[152:155], a[212:215], v[116:119]
    ds_read_b64_tr_b16 v[140:141], v4 offset:5120
    ds_read_b64_tr_b16 v[142:143], v25 offset:5120
    v_mfma_f32_16x16x32_bf16 v[116:119], v[156:159], a[236:239], v[116:119]
    ds_read_b64_tr_b16 v[144:145], v4 offset:6144
    ds_read_b64_tr_b16 v[146:147], v25 offset:6144
    v_mfma_f32_16x16x32_bf16 v[116:119], v[160:163], v[180:183], v[116:119]
    ds_read_b64_tr_b16 v[148:149], v4 offset:7168
    ds_read_b64_tr_b16 v[150:151], v25 offset:7168
    s_add_u32 m0, s90, 114688
    s_mov_b32 s57, 688128
    v_mfma_f32_16x16x32_bf16 v[116:119], v[164:167], v[204:207], v[116:119]
    buffer_load_dwordx4 v2, s[8:11], s57 offen offset:0 lds
    v_mfma_f32_16x16x32_bf16 v[116:119], v[168:171], v[228:231], v[116:119]
    ds_read_b64_tr_b16 v[152:153], v4 offset:8192
    ds_read_b64_tr_b16 v[154:155], v25 offset:8192
    v_mfma_f32_16x16x32_bf16 v[116:119], v[172:175], v[252:255], v[116:119]
L_wa_1:
    s_cbranch_execz L_wa_ret
    ds_read_b64_tr_b16 v[156:157], v4 offset:9216
    ds_read_b64_tr_b16 v[158:159], v25 offset:9216
    s_waitcnt lgkmcnt(15)
    v_mfma_f32_16x16x32_bf16 v[96:99], v[120:123], a[16:19], 0
    ds_read_b64_tr_b16 v[160:161], v4 offset:10240
    s_mov_b32 s57, 697856
    v_mfma_f32_16x16x32_bf16 v[96:99], v[124:127], a[40:43], v[96:99]
    buffer_load_dwordx4 v2, s[8:11], s57 offen offset:1024 lds
    s_waitcnt lgkmcnt(13)
    v_mfma_f32_16x16x32_bf16 v[96:99], v[128:131], a[64:67], v[96:99]
    ds_read_b64_tr_b16 v[162:163], v25 offset:10240
    ds_read_b64_tr_b16 v[164:165], v4 offset:11264
    v_mfma_f32_16x16x32_bf16 v[96:99], v[132:135], a[88:91], v[96:99]
    ds_read_b64_tr_b16 v[166:167], v25 offset:11264
    ds_read_b64_tr_b16 v[168:169], v4 offset:12288
    s_waitcnt lgkmcnt(13)
    v_mfma_f32_16x16x32_bf16 v[96:99], v[136:139], a[112:115], v[96:99]
    ds_read_b64_tr_b16 v[170:171], v25 offset:12288
    ds_read_b64_tr_b16 v[172:173], v4 offset:13312
    s_add_u32 m0, s90, 122880
    s_mov_b32 s57, 774144
    v_mfma_f32_16x16x32_bf16 v[96:99], v[140:143], a[136:139], v[96:99]
    buffer_load_dwordx4 v2, s[8:11], s57 offen offset:0 lds
    s_waitcnt lgkmcnt(11)
    v_mfma_f32_16x16x32_bf16 v[96:99], v[144:147], a[160:163], v[96:99]
    ds_read_b64_tr_b16 v[174:175], v25 offset:13312
    v_cvt_pk_bf16_f32 v34, v112, v113
    v_mfma_f32_16x16x32_bf16 v[96:99], v[148:151], a[184:187], v[96:99]
    v_cvt_pk_bf16_f32 v35, v114, v115
    v_cvt_pk_bf16_f32 v44, v116, v117
    s_waitcnt lgkmcnt(8)
    v_mfma_f32_16x16x32_bf16 v[96:99], v[152:155], a[208:211], v[96:99]
    s_mov_b32 s57, 783872
    v_cvt_pk_bf16_f32 v45, v118, v119
    v_mfma_f32_16x16x32_bf16 v[96:99], v[156:159], a[232:235], v[96:99]
    buffer_load_dwordx4 v2, s[8:11], s57 offen offset:1024 lds
    s_waitcnt lgkmcnt(4)
    v_mfma_f32_16x16x32_bf16 v[96:99], v[160:163], v[176:179], v[96:99]
    v_mfma_f32_16x16x32_bf16 v[96:99], v[164:167], v[200:203], v[96:99]
    s_waitcnt vmcnt(10)
    s_barrier
    s_waitcnt lgkmcnt(0)
    v_mfma_f32_16x16x32_bf16 v[96:99], v[168:171], v[224:227], v[96:99]
    s_add_u32 m0, s90, 131072
    s_mov_b32 s57, 860160
    ds_read_b64_tr_b16 a[48:49], v6 offset:0
    v_mfma_f32_16x16x32_bf16 v[96:99], v[172:175], v[248:251], v[96:99]
    buffer_load_dwordx4 v2, s[8:11], s57 offen offset:0 lds
    v_mfma_f32_16x16x32_bf16 v[100:103], v[120:123], a[20:23], 0
    ds_read_b64_tr_b16 v[120:121], v4 offset:32768
    ds_read_b64_tr_b16 v[122:123], v25 offset:32768
    v_mfma_f32_16x16x32_bf16 v[100:103], v[124:127], a[44:47], v[100:103]
    ds_read_b64_tr_b16 v[124:125], v4 offset:33792
    ds_read_b64_tr_b16 a[50:51], v6 offset:1024
    v_mfma_f32_16x16x32_bf16 v[100:103], v[128:131], a[68:71], v[100:103]
    ds_read_b64_tr_b16 v[126:127], v25 offset:33792
    ds_read_b64_tr_b16 v[128:129], v4 offset:34816
    s_mov_b32 s57, 869888
    v_mfma_f32_16x16x32_bf16 v[100:103], v[132:135], a[92:95], v[100:103]
    buffer_load_dwordx4 v2, s[8:11], s57 offen offset:1024 lds
    v_mfma_f32_16x16x32_bf16 v[100:103], v[136:139], a[116:119], v[100:103]
    ds_read_b64_tr_b16 v[130:131], v25 offset:34816
    ds_read_b64_tr_b16 v[132:133], v4 offset:35840
    v_mfma_f32_16x16x32_bf16 v[100:103], v[140:143], a[140:143], v[100:103]
    ds_read_b64_tr_b16 v[134:135], v25 offset:35840
    ds_read_b64_tr_b16 v[136:137], v4 offset:36864
    v_mfma_f32_16x16x32_bf16 v[100:103], v[144:147], a[164:167], v[100:103]
    ds_read_b64_tr_b16 v[138:139], v25 offset:36864
    s_add_u32 m0, s90, 139264
    s_mov_b32 s57, 946176
    v_mfma_f32_16x16x32_bf16 v[100:103], v[148:151], a[188:191], v[100:103]
    buffer_load_dwordx4 v2, s[8:11], s57 offen offset:0 lds
    v_mfma_f32_16x16x32_bf16 v[100:103], v[152:155], a[212:215], v[100:103]
    ds_read_b64_tr_b16 v[140:141], v4 offset:37888
    ds_read_b64_tr_b16 v[142:143], v25 offset:37888
    v_mfma_f32_16x16x32_bf16 v[100:103], v[156:159], a[236:239], v[100:103]
    ds_read_b64_tr_b16 v[144:145], v4 offset:38912
    ds_read_b64_tr_b16 v[146:147], v25 offset:38912
    v_mfma_f32_16x16x32_bf16 v[100:103], v[160:163], v[180:183], v[100:103]
    ds_read_b64_tr_b16 v[148:149], v4 offset:39936
    ds_read_b64_tr_b16 v[150:151], v25 offset:39936
    s_mov_b32 s57, 955904
    v_mfma_f32_16x16x32_bf16 v[100:103], v[164:167], v[204:207], v[100:103]
    buffer_load_dwordx4 v2, s[8:11], s57 offen offset:1024 lds
    v_mfma_f32_16x16x32_bf16 v[100:103], v[168:171], v[228:231], v[100:103]
    ds_read_b64_tr_b16 v[152:153], v4 offset:40960
    ds_read_b64_tr_b16 v[154:155], v25 offset:40960
    v_mfma_f32_16x16x32_bf16 v[100:103], v[172:175], v[252:255], v[100:103]
    ds_read_b64_tr_b16 v[156:157], v4 offset:41984
    ds_read_b64_tr_b16 v[158:159], v25 offset:41984
    s_waitcnt lgkmcnt(15)
    v_mfma_f32_16x16x32_bf16 v[104:107], a[8:11], v[120:123], 0
    ds_read_b64_tr_b16 v[160:161], v4 offset:43008
    s_add_u32 m0, s90, 147456
    s_mov_b32 s57, 1032192
    v_mfma_f32_16x16x32_bf16 v[104:107], a[32:35], v[124:127], v[104:107]
    buffer_load_dwordx4 v2, s[8:11], s57 offen offset:0 lds
    s_waitcnt lgkmcnt(13)
    v_mfma_f32_16x16x32_bf16 v[104:107], a[56:59], v[128:131], v[104:107]
    ds_read_b64_tr_b16 v[162:163], v25 offset:43008
    ds_read_b64_tr_b16 v[164:165], v4 offset:44032
    v_mfma_f32_16x16x32_bf16 v[104:107], a[80:83], v[132:135], v[104:107]
    ds_read_b64_tr_b16 v[166:167], v25 offset:44032
    ds_read_b64_tr_b16 v[168:169], v4 offset:45056
    s_waitcnt lgkmcnt(13)
    v_mfma_f32_16x16x32_bf16 v[104:107], a[104:107], v[136:139], v[104:107]
    ds_read_b64_tr_b16 v[170:171], v25 offset:45056
    ds_read_b64_tr_b16 v[172:173], v4 offset:46080
    s_mov_b32 s57, 1041920
    v_mfma_f32_16x16x32_bf16 v[104:107], a[128:131], v[140:143], v[104:107]
    buffer_load_dwordx4 v2, s[8:11], s57 offen offset:1024 lds
    s_waitcnt lgkmcnt(11)
    v_mfma_f32_16x16x32_bf16 v[104:107], a[152:155], v[144:147], v[104:107]
    ds_read_b64_tr_b16 v[174:175], v25 offset:46080
    v_cvt_pk_bf16_f32 v32, v96, v97
    v_mfma_f32_16x16x32_bf16 v[104:107], a[176:179], v[148:151], v[104:107]
    v_cvt_pk_bf16_f32 v33, v98, v99
    v_cvt_pk_bf16_f32 v42, v100, v101
    s_waitcnt lgkmcnt(8)
    v_mfma_f32_16x16x32_bf16 v[104:107], a[200:203], v[152:155], v[104:107]
    s_add_u32 m0, s90, 155648
    s_mov_b32 s57, 1118208
    v_cvt_pk_bf16_f32 v43, v102, v103
    v_mfma_f32_16x16x32_bf16 v[104:107], a[224:227], v[156:159], v[104:107]
    buffer_load_dwordx4 v2, s[8:11], s57 offen offset:0 lds
    s_waitcnt lgkmcnt(4)
    v_mfma_f32_16x16x32_bf16 v[104:107], a[248:251], v[160:163], v[104:107]
    ds_read_b64_tr_b16 a[52:53], v7 offset:0
    ds_read_b64_tr_b16 a[54:55], v7 offset:1024
    v_mfma_f32_16x16x32_bf16 v[104:107], v[192:195], v[164:167], v[104:107]
    ds_read_b64_tr_b16 a[72:73], v6 offset:8192
    ds_read_b64_tr_b16 a[74:75], v6 offset:9216
    s_waitcnt lgkmcnt(4)
    v_mfma_f32_16x16x32_bf16 v[104:107], v[216:219], v[168:171], v[104:107]
    s_mov_b32 s57, 1127936
    ds_read_b64_tr_b16 a[76:77], v7 offset:8192
    v_mfma_f32_16x16x32_bf16 v[104:107], v[240:243], v[172:175], v[104:107]
    buffer_load_dwordx4 v2, s[8:11], s57 offen offset:1024 lds
    v_mfma_f32_16x16x32_bf16 v[108:111], a[12:15], v[120:123], 0
    ds_read_b64_tr_b16 a[78:79], v7 offset:9216
    ds_read_b64_tr_b16 a[96:97], v6 offset:16384
    v_mfma_f32_16x16x32_bf16 v[108:111], a[36:39], v[124:127], v[108:111]
    ds_read_b64_tr_b16 a[98:99], v6 offset:17408
    ds_read_b64_tr_b16 a[100:101], v7 offset:16384
    v_mfma_f32_16x16x32_bf16 v[108:111], a[60:63], v[128:131], v[108:111]
    s_add_u32 m0, s52, 49152
    s_add_u32 s58, s72, 1024
    s_add_u32 s57, s58, s68
    ds_read_b64_tr_b16 a[102:103], v7 offset:17408
    v_mfma_f32_16x16x32_bf16 v[108:111], a[84:87], v[132:135], v[108:111]
    buffer_load_dwordx4 v3, s[24:27], s57 offen offset:0 sc1 lds
    s_waitcnt vmcnt(13)
    s_waitcnt lgkmcnt(0)
    s_barrier
    v_mfma_f32_16x16x32_bf16 v[108:111], a[108:111], v[136:139], v[108:111]
    ds_read_b64_tr_b16 a[120:121], v6 offset:24576
    ds_read_b64_tr_b16 a[122:123], v6 offset:25600
    v_mfma_f32_16x16x32_bf16 v[108:111], a[132:135], v[140:143], v[108:111]
    ds_read_b64_tr_b16 a[124:125], v7 offset:24576
    ds_read_b64_tr_b16 a[126:127], v7 offset:25600
    v_mfma_f32_16x16x32_bf16 v[108:111], a[156:159], v[144:147], v[108:111]
    s_add_u32 s57, s58, s69
    v_cvt_pk_bf16_f32 v60, v104, v105
    v_mfma_f32_16x16x32_bf16 v[108:111], a[180:183], v[148:151], v[108:111]
    buffer_load_dwordx4 v3, s[24:27], s57 offen offset:1024 sc1 lds
    v_mfma_f32_16x16x32_bf16 v[108:111], a[204:207], v[152:155], v[108:111]
    v_cvt_pk_bf16_f32 v61, v106, v107
    ds_read_b64_tr_b16 a[144:145], v6 offset:32768
    v_mfma_f32_16x16x32_bf16 v[108:111], a[228:231], v[156:159], v[108:111]
    ds_read_b64_tr_b16 a[146:147], v6 offset:33792
    ds_read_b64_tr_b16 a[148:149], v7 offset:32768
    v_mfma_f32_16x16x32_bf16 v[108:111], a[252:255], v[160:163], v[108:111]
    s_add_u32 s57, s58, s70
    ds_read_b64_tr_b16 a[150:151], v7 offset:33792
    v_mfma_f32_16x16x32_bf16 v[108:111], v[196:199], v[164:167], v[108:111]
    buffer_load_dwordx4 v24, s[24:27], s57 offen offset:2048 sc1 lds
    v_mfma_f32_16x16x32_bf16 v[108:111], v[220:223], v[168:171], v[108:111]
    ds_read_b64_tr_b16 a[168:169], v6 offset:40960
    ds_read_b64_tr_b16 a[170:171], v6 offset:41984
    v_mfma_f32_16x16x32_bf16 v[108:111], v[244:247], v[172:175], v[108:111]
    ds_read_b64_tr_b16 a[172:173], v7 offset:40960
    ds_read_b64_tr_b16 a[174:175], v7 offset:41984
    v_mfma_f32_16x16x32_bf16 v[112:115], v[120:123], a[16:19], 0
    s_add_u32 s57, s58, s71
    v_mfma_f32_16x16x32_bf16 v[112:115], v[124:127], a[40:43], v[112:115]
    buffer_load_dwordx4 v3, s[24:27], s57 offen offset:3072 sc1 lds
    v_mfma_f32_16x16x32_bf16 v[112:115], v[128:131], a[64:67], v[112:115]
    v_mfma_f32_16x16x32_bf16 v[112:115], v[132:135], a[88:91], v[112:115]
    s_waitcnt vmcnt(10)
    s_waitcnt lgkmcnt(0)
    s_barrier
    v_mfma_f32_16x16x32_bf16 v[112:115], v[136:139], a[112:115], v[112:115]
    ds_read_b64_tr_b16 a[192:193], v10 offset:0
    ds_read_b64_tr_b16 a[194:195], v10 offset:1024
    v_mfma_f32_16x16x32_bf16 v[112:115], v[140:143], a[136:139], v[112:115]
    ds_read_b64_tr_b16 a[196:197], v11 offset:0
    ds_read_b64_tr_b16 a[198:199], v11 offset:1024
    v_mfma_f32_16x16x32_bf16 v[112:115], v[144:147], a[160:163], v[112:115]
    v_cvt_pk_bf16_f32 v62, v108, v109
    v_cvt_pk_bf16_f32 v63, v110, v111
    v_mfma_f32_16x16x32_bf16 v[112:115], v[148:151], a[184:187], v[112:115]
    v_cndmask_b32 v62, v62, 0, s[82:83]
    v_cndmask_b32 v63, v63, 0, s[82:83]
    v_mfma_f32_16x16x32_bf16 v[112:115], v[152:155], a[208:211], v[112:115]
    ds_read_b64_tr_b16 a[216:217], v10 offset:8192
    ds_read_b64_tr_b16 a[218:219], v10 offset:9216
    v_mfma_f32_16x16x32_bf16 v[112:115], v[156:159], a[232:235], v[112:115]
    ds_read_b64_tr_b16 a[220:221], v11 offset:8192
    ds_read_b64_tr_b16 a[222:223], v11 offset:9216
    v_mfma_f32_16x16x32_bf16 v[112:115], v[160:163], v[176:179], v[112:115]
    ds_read_b64_tr_b16 a[240:241], v10 offset:16384
    ds_read_b64_tr_b16 a[242:243], v10 offset:17408
    v_mfma_f32_16x16x32_bf16 v[112:115], v[164:167], v[200:203], v[112:115]
    ds_read_b64_tr_b16 a[244:245], v11 offset:16384
    ds_read_b64_tr_b16 a[246:247], v11 offset:17408
    v_mfma_f32_16x16x32_bf16 v[112:115], v[168:171], v[224:227], v[112:115]
    v_mfma_f32_16x16x32_bf16 v[112:115], v[172:175], v[248:251], v[112:115]
    v_mfma_f32_16x16x32_bf16 v[116:119], v[120:123], a[20:23], 0
    v_mfma_f32_16x16x32_bf16 v[116:119], v[124:127], a[44:47], v[116:119]
    v_mfma_f32_16x16x32_bf16 v[116:119], v[128:131], a[68:71], v[116:119]
    v_mfma_f32_16x16x32_bf16 v[116:119], v[132:135], a[92:95], v[116:119]
    v_mfma_f32_16x16x32_bf16 v[116:119], v[136:139], a[116:119], v[116:119]
    v_mfma_f32_16x16x32_bf16 v[116:119], v[140:143], a[140:143], v[116:119]
    v_mfma_f32_16x16x32_bf16 v[116:119], v[144:147], a[164:167], v[116:119]
    s_nop 0
    v_cvt_pk_bf16_f32 v36, v112, v113
    v_cvt_pk_bf16_f32 v37, v114, v115
    v_mfma_f32_16x16x32_bf16 v[116:119], v[148:151], a[188:191], v[116:119]
    v_mfma_f32_16x16x32_bf16 v[116:119], v[152:155], a[212:215], v[116:119]
    v_mfma_f32_16x16x32_bf16 v[116:119], v[156:159], a[236:239], v[116:119]
    v_mfma_f32_16x16x32_bf16 v[116:119], v[160:163], v[180:183], v[116:119]
    v_mfma_f32_16x16x32_bf16 v[116:119], v[164:167], v[204:207], v[116:119]
    v_mfma_f32_16x16x32_bf16 v[116:119], v[168:171], v[228:231], v[116:119]
    v_mfma_f32_16x16x32_bf16 v[116:119], v[172:175], v[252:255], v[116:119]
    s_waitcnt vmcnt(4)
    s_waitcnt lgkmcnt(0)
    s_barrier
    v_mfma_f32_16x16x32_bf16 v[96:99], a[0:3], v[120:123], 0
    ds_read_b64_tr_b16 v[184:185], v10 offset:24576
    ds_read_b64_tr_b16 v[186:187], v10 offset:25600
    v_mfma_f32_16x16x32_bf16 v[96:99], a[24:27], v[124:127], v[96:99]
    ds_read_b64_tr_b16 v[188:189], v11 offset:24576
    ds_read_b64_tr_b16 v[190:191], v11 offset:25600
    v_mfma_f32_16x16x32_bf16 v[96:99], a[48:51], v[128:131], v[96:99]
    ds_read_b64_tr_b16 v[208:209], v10 offset:32768
    ds_read_b64_tr_b16 v[210:211], v10 offset:33792
    v_mfma_f32_16x16x32_bf16 v[96:99], a[72:75], v[132:135], v[96:99]
    ds_read_b64_tr_b16 v[212:213], v11 offset:32768
    ds_read_b64_tr_b16 v[214:215], v11 offset:33792
    v_mfma_f32_16x16x32_bf16 v[96:99], a[96:99], v[136:139], v[96:99]
    ds_read_b64_tr_b16 v[232:233], v10 offset:40960
    ds_read_b64_tr_b16 v[234:235], v10 offset:41984
    v_mfma_f32_16x16x32_bf16 v[96:99], a[120:123], v[140:143], v[96:99]
    ds_read_b64_tr_b16 v[236:237], v11 offset:40960
    ds_read_b64_tr_b16 v[238:239], v11 offset:41984
    v_mfma_f32_16x16x32_bf16 v[96:99], a[144:147], v[144:147], v[96:99]
    v_cvt_pk_bf16_f32 v46, v116, v117
    v_cvt_pk_bf16_f32 v47, v118, v119
    v_mfma_f32_16x16x32_bf16 v[96:99], a[168:171], v[148:151], v[96:99]
    v_mfma_f32_16x16x32_bf16 v[96:99], a[192:195], v[152:155], v[96:99]
    v_mfma_f32_16x16x32_bf16 v[96:99], a[216:219], v[156:159], v[96:99]
    s_waitcnt lgkmcnt(8)
    v_mfma_f32_16x16x32_bf16 v[96:99], a[240:243], v[160:163], v[96:99]
    v_mfma_f32_16x16x32_bf16 v[96:99], v[184:187], v[164:167], v[96:99]
    s_waitcnt lgkmcnt(0)
    s_barrier
    v_mfma_f32_16x16x32_bf16 v[96:99], v[208:211], v[168:171], v[96:99]
    s_add_u32 m0, s52, 65536
    s_add_u32 s58, s72, 1536
    s_add_u32 s57, s58, s68
    v_mfma_f32_16x16x32_bf16 v[96:99], v[232:235], v[172:175], v[96:99]
    buffer_load_dwordx4 v3, s[24:27], s57 offen offset:0 sc1 lds
    v_mfma_f32_16x16x32_bf16 v[100:103], a[4:7], v[120:123], 0
    ds_read_b64_tr_b16 v[120:121], v4 offset:16384
    ds_read_b64_tr_b16 v[122:123], v25 offset:16384
    v_mfma_f32_16x16x32_bf16 v[100:103], a[28:31], v[124:127], v[100:103]
    ds_read_b64_tr_b16 v[124:125], v4 offset:17408
    v_mfma_f32_16x16x32_bf16 v[100:103], a[52:55], v[128:131], v[100:103]
    ds_read_b64_tr_b16 v[126:127], v25 offset:17408
    ds_read_b64_tr_b16 v[128:129], v4 offset:18432
    v_mfma_f32_16x16x32_bf16 v[100:103], a[76:79], v[132:135], v[100:103]
    ds_read_b64_tr_b16 v[130:131], v25 offset:18432
    v_mfma_f32_16x16x32_bf16 v[100:103], a[100:103], v[136:139], v[100:103]
    ds_read_b64_tr_b16 v[132:133], v4 offset:19456
    s_add_u32 s57, s58, s69
    v_mfma_f32_16x16x32_bf16 v[100:103], a[124:127], v[140:143], v[100:103]
    buffer_load_dwordx4 v3, s[24:27], s57 offen offset:1024 sc1 lds
    v_mfma_f32_16x16x32_bf16 v[100:103], a[148:151], v[144:147], v[100:103]
    ds_read_b64_tr_b16 v[134:135], v25 offset:19456
    ds_read_b64_tr_b16 v[136:137], v4 offset:20480
    v_mfma_f32_16x16x32_bf16 v[100:103], a[172:175], v[148:151], v[100:103]
    ds_read_b64_tr_b16 v[138:139], v25 offset:20480
    ds_read_b64_tr_b16 v[140:141], v4 offset:21504
    v_mfma_f32_16x16x32_bf16 v[100:103], a[196:199], v[152:155], v[100:103]
    ds_read_b64_tr_b16 v[142:143], v25 offset:21504
    ds_read_b64_tr_b16 v[144:145], v4 offset:22528
    v_mfma_f32_16x16x32_bf16 v[100:103], a[220:223], v[156:159], v[100:103]
    ds_read_b64_tr_b16 v[146:147], v25 offset:22528
    v_cvt_pk_bf16_f32 v64, v96, v97
    v_mfma_f32_16x16x32_bf16 v[100:103], a[244:247], v[160:163], v[100:103]
    ds_read_b64_tr_b16 v[148:149], v4 offset:23552
    ds_read_b64_tr_b16 v[150:151], v25 offset:23552
    s_add_u32 s57, s58, s70
    v_mfma_f32_16x16x32_bf16 v[100:103], v[188:191], v[164:167], v[100:103]
    buffer_load_dwordx4 v24, s[24:27], s57 offen offset:2048 sc1 lds
    v_mfma_f32_16x16x32_bf16 v[100:103], v[212:215], v[168:171], v[100:103]
    ds_read_b64_tr_b16 v[152:153], v4 offset:24576
    ds_read_b64_tr_b16 v[154:155], v25 offset:24576
    v_mfma_f32_16x16x32_bf16 v[100:103], v[236:239], v[172:175], v[100:103]
    ds_read_b64_tr_b16 v[156:157], v4 offset:25600
    ds_read_b64_tr_b16 v[158:159], v25 offset:25600
    s_waitcnt lgkmcnt(15)
    v_mfma_f32_16x16x32_bf16 v[104:107], a[0:3], v[120:123], 0
    ds_read_b64_tr_b16 v[160:161], v4 offset:26624
    v_cvt_pk_bf16_f32 v65, v98, v99
    v_mfma_f32_16x16x32_bf16 v[104:107], a[24:27], v[124:127], v[104:107]
    ds_read_b64_tr_b16 v[162:163], v25 offset:26624
    ds_read_b64_tr_b16 v[164:165], v4 offset:27648
    s_waitcnt lgkmcnt(15)
    v_mfma_f32_16x16x32_bf16 v[104:107], a[48:51], v[128:131], v[104:107]
    ds_read_b64_tr_b16 v[166:167], v25 offset:27648
    s_add_u32 s57, s58, s71
    v_mfma_f32_16x16x32_bf16 v[104:107], a[72:75], v[132:135], v[104:107]
    buffer_load_dwordx4 v3, s[24:27], s57 offen offset:3072 sc1 lds
    s_waitcnt lgkmcnt(12)
    v_mfma_f32_16x16x32_bf16 v[104:107], a[96:99], v[136:139], v[104:107]
    ds_read_b64_tr_b16 v[168:169], v4 offset:28672
    ds_read_b64_tr_b16 v[170:171], v25 offset:28672
    v_mfma_f32_16x16x32_bf16 v[104:107], a[120:123], v[140:143], v[104:107]
    ds_read_b64_tr_b16 v[172:173], v4 offset:29696
    ds_read_b64_tr_b16 v[174:175], v25 offset:29696
    s_waitcnt lgkmcnt(12)
    v_mfma_f32_16x16x32_bf16 v[104:107], a[144:147], v[144:147], v[104:107]
    v_cvt_pk_bf16_f32 v66, v100, v101
    v_cvt_pk_bf16_f32 v67, v102, v103
    v_mfma_f32_16x16x32_bf16 v[104:107], a[168:171], v[148:151], v[104:107]
    v_cndmask_b32 v66, v66, 0, s[82:83]
    v_cndmask_b32 v67, v67, 0, s[82:83]
    s_waitcnt lgkmcnt(8)
    v_mfma_f32_16x16x32_bf16 v[104:107], a[192:195], v[152:155], v[104:107]
    s_add_u32 m0, s52, 81920
    s_add_u32 s58, s72, 2048
    s_add_u32 s57, s58, s68
    v_mfma_f32_16x16x32_bf16 v[104:107], a[216:219], v[156:159], v[104:107]
    buffer_load_dwordx4 v3, s[24:27], s57 offen offset:0 sc1 lds
    s_waitcnt lgkmcnt(4)
    v_mfma_f32_16x16x32_bf16 v[104:107], a[240:243], v[160:163], v[104:107]
    v_mfma_f32_16x16x32_bf16 v[104:107], v[184:187], v[164:167], v[104:107]
    s_waitcnt lgkmcnt(0)
    v_mfma_f32_16x16x32_bf16 v[104:107], v[208:211], v[168:171], v[104:107]
    v_mfma_f32_16x16x32_bf16 v[104:107], v[232:235], v[172:175], v[104:107]
    s_waitcnt vmcnt(5)
    s_barrier
    v_mfma_f32_16x16x32_bf16 v[108:111], a[4:7], v[120:123], 0
    ds_read_b64_tr_b16 v[120:121], v4 offset:49152
    ds_read_b64_tr_b16 v[122:123], v25 offset:49152
    s_add_u32 s57, s58, s69
    v_mfma_f32_16x16x32_bf16 v[108:111], a[28:31], v[124:127], v[108:111]
    buffer_load_dwordx4 v3, s[24:27], s57 offen offset:1024 sc1 lds
    v_mfma_f32_16x16x32_bf16 v[108:111], a[52:55], v[128:131], v[108:111]
    ds_read_b64_tr_b16 v[124:125], v4 offset:50176
    ds_read_b64_tr_b16 v[126:127], v25 offset:50176
    v_mfma_f32_16x16x32_bf16 v[108:111], a[76:79], v[132:135], v[108:111]
    ds_read_b64_tr_b16 v[128:129], v4 offset:51200
    ds_read_b64_tr_b16 v[130:131], v25 offset:51200
    v_mfma_f32_16x16x32_bf16 v[108:111], a[100:103], v[136:139], v[108:111]
    ds_read_b64_tr_b16 v[132:133], v4 offset:52224
    v_mfma_f32_16x16x32_bf16 v[108:111], a[124:127], v[140:143], v[108:111]
    ds_read_b64_tr_b16 v[134:135], v25 offset:52224
    ds_read_b64_tr_b16 v[136:137], v4 offset:53248
    v_mfma_f32_16x16x32_bf16 v[108:111], a[148:151], v[144:147], v[108:111]
    ds_read_b64_tr_b16 v[138:139], v25 offset:53248
    s_add_u32 s57, s58, s70
    v_mfma_f32_16x16x32_bf16 v[108:111], a[172:175], v[148:151], v[108:111]
    buffer_load_dwordx4 v24, s[24:27], s57 offen offset:2048 sc1 lds
    v_mfma_f32_16x16x32_bf16 v[108:111], a[196:199], v[152:155], v[108:111]
    ds_read_b64_tr_b16 v[140:141], v4 offset:54272
    ds_read_b64_tr_b16 v[142:143], v25 offset:54272
    v_mfma_f32_16x16x32_bf16 v[108:111], a[220:223], v[156:159], v[108:111]
    ds_read_b64_tr_b16 v[144:145], v4 offset:55296
    ds_read_b64_tr_b16 v[146:147], v25 offset:55296
    v_mfma_f32_16x16x32_bf16 v[108:111], a[244:247], v[160:163], v[108:111]
    ds_read_b64_tr_b16 v[148:149], v4 offset:56320
    ds_read_b64_tr_b16 v[150:151], v25 offset:56320
    v_mfma_f32_16x16x32_bf16 v[108:111], v[188:191], v[164:167], v[108:111]
    ds_read_b64_tr_b16 v[152:153], v4 offset:57344
    v_cvt_pk_bf16_f32 v68, v104, v105
    v_mfma_f32_16x16x32_bf16 v[108:111], v[212:215], v[168:171], v[108:111]
    ds_read_b64_tr_b16 v[154:155], v25 offset:57344
    ds_read_b64_tr_b16 v[156:157], v4 offset:58368
    s_add_u32 s57, s58, s71
    v_mfma_f32_16x16x32_bf16 v[108:111], v[236:239], v[172:175], v[108:111]
    buffer_load_dwordx4 v3, s[24:27], s57 offen offset:3072 sc1 lds
    s_waitcnt lgkmcnt(15)
    v_mfma_f32_16x16x32_bf16 v[112:115], a[8:11], v[120:123], 0
    ds_read_b64_tr_b16 v[158:159], v25 offset:58368
    ds_read_b64_tr_b16 v[160:161], v4 offset:59392
    v_mfma_f32_16x16x32_bf16 v[112:115], a[32:35], v[124:127], v[112:115]
    ds_read_b64_tr_b16 v[162:163], v25 offset:59392
    ds_read_b64_tr_b16 v[164:165], v4 offset:60416
    s_waitcnt lgkmcnt(15)
    v_mfma_f32_16x16x32_bf16 v[112:115], a[56:59], v[128:131], v[112:115]
    ds_read_b64_tr_b16 v[166:167], v25 offset:60416
    v_cvt_pk_bf16_f32 v69, v106, v107
    v_mfma_f32_16x16x32_bf16 v[112:115], a[80:83], v[132:135], v[112:115]
    ds_read_b64_tr_b16 v[168:169], v4 offset:61440
    s_waitcnt lgkmcnt(13)
    v_mfma_f32_16x16x32_bf16 v[112:115], a[104:107], v[136:139], v[112:115]
    ds_read_b64_tr_b16 v[170:171], v25 offset:61440
    ds_read_b64_tr_b16 v[172:173], v4 offset:62464
    s_add_u32 m0, s52, 98304
    s_add_u32 s58, s72, 2560
    s_add_u32 s57, s58, s68
    v_mfma_f32_16x16x32_bf16 v[112:115], a[128:131], v[140:143], v[112:115]
    buffer_load_dwordx4 v3, s[24:27], s57 offen offset:0 sc1 lds
    s_waitcnt lgkmcnt(11)
    v_mfma_f32_16x16x32_bf16 v[112:115], a[152:155], v[144:147], v[112:115]
    ds_read_b64_tr_b16 v[174:175], v25 offset:62464
    v_cvt_pk_bf16_f32 v70, v108, v109
    v_mfma_f32_16x16x32_bf16 v[112:115], a[176:179], v[148:151], v[112:115]
    v_cvt_pk_bf16_f32 v71, v110, v111
    v_cndmask_b32 v70, v70, 0, s[82:83]
    s_waitcnt lgkmcnt(8)
    v_mfma_f32_16x16x32_bf16 v[112:115], a[200:203], v[152:155], v[112:115]
    v_cndmask_b32 v71, v71, 0, s[82:83]
    v_mov_b32 v8, 0
    v_mfma_f32_16x16x32_bf16 v[112:115], a[224:227], v[156:159], v[112:115]
    v_mov_b32 v9, 0
    v_mov_b32 v10, 0
    s_waitcnt lgkmcnt(4)
    v_mfma_f32_16x16x32_bf16 v[112:115], a[248:251], v[160:163], v[112:115]
    s_add_u32 s57, s58, s69
    v_mfma_f32_16x16x32_bf16 v[72:75], v[52:55], v[68:71], 0
    v_mfma_f32_16x16x32_bf16 v[112:115], v[192:195], v[164:167], v[112:115]
    buffer_load_dwordx4 v3, s[24:27], s57 offen offset:1024 sc1 lds
    s_waitcnt lgkmcnt(0)
    v_mfma_f32_16x16x32_bf16 v[112:115], v[216:219], v[168:171], v[112:115]
    v_mfma_f32_16x16x32_bf16 v[76:79], v[56:59], v[68:71], 0
    v_mfma_f32_16x16x32_bf16 v[112:115], v[240:243], v[172:175], v[112:115]
    ds_read_u16_d16_hi v8, v93 offset:0
    ds_read_u16_d16_hi v9, v94 offset:0
    v_mfma_f32_16x16x32_bf16 v[116:119], a[12:15], v[120:123], 0
    ds_read_u16_d16_hi v10, v92 offset:0
    v_mfma_f32_16x16x32_bf16 v[116:119], a[36:39], v[124:127], v[116:119]
    v_mfma_f32_16x16x32_bf16 v[116:119], a[60:63], v[128:131], v[116:119]
    s_add_u32 s57, s58, s70
    v_mfma_f32_16x16x32_bf16 v[116:119], a[84:87], v[132:135], v[116:119]
    buffer_load_dwordx4 v24, s[24:27], s57 offen offset:2048 sc1 lds
    v_mfma_f32_16x16x32_bf16 v[116:119], a[108:111], v[136:139], v[116:119]
    v_cndmask_b32 v26, v72, v73, s[76:77]
    v_cndmask_b32 v27, v74, v75, s[76:77]
    v_mfma_f32_16x16x32_bf16 v[116:119], a[132:135], v[140:143], v[116:119]
    v_cndmask_b32 v28, v76, v77, s[76:77]
    v_cndmask_b32 v29, v78, v79, s[76:77]
    v_mfma_f32_16x16x32_bf16 v[116:119], a[156:159], v[144:147], v[116:119]
    v_cvt_pk_bf16_f32 v52, v112, v113
    v_cvt_pk_bf16_f32 v53, v114, v115
    v_mfma_f32_16x16x32_bf16 v[116:119], a[180:183], v[148:151], v[116:119]
    v_cndmask_b32 v26, v26, v28, s[78:79]
    v_cndmask_b32 v27, v27, v29, s[80:81]
    v_mfma_f32_16x16x32_bf16 v[116:119], a[204:207], v[152:155], v[116:119]
    s_add_u32 s57, s58, s71
    s_waitcnt lgkmcnt(0)
    v_mfma_f32_16x16x32_bf16 v[116:119], a[228:231], v[156:159], v[116:119]
    buffer_load_dwordx4 v3, s[24:27], s57 offen offset:3072 sc1 lds
    v_mfma_f32_16x16x32_bf16 v[116:119], a[252:255], v[160:163], v[116:119]
    v_mul_f32 v26, v26, v8
    v_mul_f32 v27, v27, v9
    v_mfma_f32_16x16x32_bf16 v[116:119], v[196:199], v[164:167], v[116:119]
    v_mul_f32 v11, s91, v10
    v_cndmask_b32 v26, v26, v18, s[84:85]
    v_mfma_f32_16x16x32_bf16 v[116:119], v[220:223], v[168:171], v[116:119]
    v_cndmask_b32 v27, v27, v18, s[86:87]
    v_max_f32 v28, v26, v27
    v_mfma_f32_16x16x32_bf16 v[116:119], v[244:247], v[172:175], v[116:119]
    v_mov_b32 v29, v28
    v_mfma_f32_16x16x32_bf16 v[96:99], v[120:123], a[16:19], 0
    s_add_u32 m0, s52, 114688
    s_add_u32 s58, s72, 3072
    s_add_u32 s57, s58, s68
    v_mfma_f32_16x16x32_bf16 v[96:99], v[124:127], a[40:43], v[96:99]
    buffer_load_dwordx4 v3, s[24:27], s57 offen offset:0 sc1 lds
    v_mfma_f32_16x16x32_bf16 v[96:99], v[128:131], a[64:67], v[96:99]
    v_permlane16_swap_b32 v28, v29
    v_max_f32 v28, v28, v29
    v_mfma_f32_16x16x32_bf16 v[96:99], v[132:135], a[88:91], v[96:99]
    v_mov_b32 v29, v28
    v_mfma_f32_16x16x32_bf16 v[96:99], v[136:139], a[112:115], v[96:99]
    v_mfma_f32_16x16x32_bf16 v[96:99], v[140:143], a[136:139], v[96:99]
    v_permlane32_swap_b32 v28, v29
    v_max_f32 v28, v28, v29
    v_mfma_f32_16x16x32_bf16 v[96:99], v[144:147], a[160:163], v[96:99]
    s_add_u32 s57, s58, s69
    v_cvt_pk_bf16_f32 v54, v116, v117
    v_mfma_f32_16x16x32_bf16 v[96:99], v[148:151], a[184:187], v[96:99]
    buffer_load_dwordx4 v3, s[24:27], s57 offen offset:1024 sc1 lds
    v_mfma_f32_16x16x32_bf16 v[96:99], v[152:155], a[208:211], v[96:99]
    v_cvt_pk_bf16_f32 v55, v118, v119
    v_cndmask_b32 v54, v54, 0, s[82:83]
    v_mfma_f32_16x16x32_bf16 v[96:99], v[156:159], a[232:235], v[96:99]
    v_cndmask_b32 v55, v55, 0, s[82:83]
    v_sub_f32 v26, v26, v28
    v_mfma_f32_16x16x32_bf16 v[96:99], v[160:163], v[176:179], v[96:99]
    v_sub_f32 v27, v27, v28
    v_mul_f32 v26, v11, v26
    v_mfma_f32_16x16x32_bf16 v[96:99], v[164:167], v[200:203], v[96:99]
    v_mul_f32 v27, v11, v27
    v_exp_f32 v26, v26
    v_mfma_f32_16x16x32_bf16 v[96:99], v[168:171], v[224:227], v[96:99]
    s_add_u32 s57, s58, s70
    v_exp_f32 v27, v27
    v_mfma_f32_16x16x32_bf16 v[96:99], v[172:175], v[248:251], v[96:99]
    buffer_load_dwordx4 v24, s[24:27], s57 offen offset:2048 sc1 lds
    v_mfma_f32_16x16x32_bf16 v[100:103], v[120:123], a[20:23], 0
    v_add_f32 v28, v26, v27
    v_mov_b32 v29, v28
    v_mfma_f32_16x16x32_bf16 v[100:103], v[124:127], a[44:47], v[100:103]
    v_mfma_f32_16x16x32_bf16 v[100:103], v[128:131], a[68:71], v[100:103]
    v_permlane16_swap_b32 v28, v29
    v_add_f32 v28, v28, v29
    v_mfma_f32_16x16x32_bf16 v[100:103], v[132:135], a[92:95], v[100:103]
    v_mov_b32 v29, v28
    v_mfma_f32_16x16x32_bf16 v[100:103], v[136:139], a[116:119], v[100:103]
    s_add_u32 s57, s58, s71
    v_mfma_f32_16x16x32_bf16 v[100:103], v[140:143], a[140:143], v[100:103]
    buffer_load_dwordx4 v3, s[24:27], s57 offen offset:3072 sc1 lds
    v_mfma_f32_16x16x32_bf16 v[100:103], v[144:147], a[164:167], v[100:103]
    v_cvt_pk_bf16_f32 v38, v96, v97
    v_cvt_pk_bf16_f32 v39, v98, v99
    v_mfma_f32_16x16x32_bf16 v[100:103], v[148:151], a[188:191], v[100:103]
    v_permlane32_swap_b32 v28, v29
    v_add_f32 v28, v28, v29
    v_mfma_f32_16x16x32_bf16 v[100:103], v[152:155], a[212:215], v[100:103]
    v_rcp_f32 v28, v28
    v_mfma_f32_16x16x32_bf16 v[100:103], v[156:159], a[236:239], v[100:103]
    v_mul_f32 v26, v26, v8
    v_mul_f32 v27, v27, v9
    v_mfma_f32_16x16x32_bf16 v[100:103], v[160:163], v[180:183], v[100:103]
    s_add_u32 m0, s52, 131072
    s_add_u32 s58, s72, 3584
    s_add_u32 s57, s58, s68
    v_mul_f32 v26, v26, v28
    v_mfma_f32_16x16x32_bf16 v[100:103], v[164:167], v[204:207], v[100:103]
    buffer_load_dwordx4 v3, s[24:27], s57 offen offset:0 sc1 lds
    v_mfma_f32_16x16x32_bf16 v[100:103], v[168:171], v[228:231], v[100:103]
    v_mul_f32 v27, v27, v28
    v_cvt_pk_bf16_f32 v26, v26, v26
    v_mfma_f32_16x16x32_bf16 v[100:103], v[172:175], v[252:255], v[100:103]
    v_cvt_pk_bf16_f32 v27, v27, v27
    v_and_b32 v80, v26, v14
    v_mfma_f32_16x16x32_bf16 v[104:107], a[0:3], v[120:123], 0
    v_and_b32 v81, v27, v15
    v_and_b32 v82, v26, v16
    v_mfma_f32_16x16x32_bf16 v[104:107], a[24:27], v[124:127], v[104:107]
    v_and_b32 v83, v27, v17
    v_mfma_f32_16x16x32_bf16 v[104:107], a[48:51], v[128:131], v[104:107]
    s_add_u32 s57, s58, s69
    v_mfma_f32_16x16x32_bf16 v[104:107], a[72:75], v[132:135], v[104:107]
    buffer_load_dwordx4 v3, s[24:27], s57 offen offset:1024 sc1 lds
    v_mfma_f32_16x16x32_bf16 v[104:107], a[96:99], v[136:139], v[104:107]
    v_mfma_f32_16x16x32_bf16 v[72:75], v[32:35], v[80:83], 0
    v_mfma_f32_16x16x32_bf16 v[104:107], a[120:123], v[140:143], v[104:107]
    v_mfma_f32_16x16x32_bf16 v[76:79], v[42:45], v[80:83], 0
L_wa_2:
    s_cbranch_execz L_wa_ret
    v_mfma_f32_16x16x32_bf16 v[104:107], a[144:147], v[144:147], v[104:107]
    v_cvt_pk_bf16_f32 v48, v100, v101
    v_cvt_pk_bf16_f32 v49, v102, v103
    v_mfma_f32_16x16x32_bf16 v[104:107], a[168:171], v[148:151], v[104:107]
    s_add_u32 s53, s74, 0
    v_mfma_f32_16x16x32_bf16 v[104:107], a[192:195], v[152:155], v[104:107]
    s_add_u32 s57, s58, s70
    v_mfma_f32_16x16x32_bf16 v[104:107], a[216:219], v[156:159], v[104:107]
    buffer_load_dwordx4 v24, s[24:27], s57 offen offset:2048 sc1 lds
    v_mfma_f32_16x16x32_bf16 v[104:107], a[240:243], v[160:163], v[104:107]
    v_mfma_f32_16x16x32_bf16 v[104:107], v[184:187], v[164:167], v[104:107]
    v_mfma_f32_16x16x32_bf16 v[104:107], v[208:211], v[168:171], v[104:107]
    v_cvt_pk_bf16_f32 v84, v72, v73
    v_cvt_pk_bf16_f32 v85, v74, v75
    v_mfma_f32_16x16x32_bf16 v[104:107], v[232:235], v[172:175], v[104:107]
    v_cvt_pk_bf16_f32 v86, v76, v77
    v_cvt_pk_bf16_f32 v87, v78, v79
    s_waitcnt vmcnt(7)
    s_barrier
    v_mfma_f32_16x16x32_bf16 v[108:111], a[4:7], v[120:123], 0
    v_add_u32 v4, 65536, v4
    v_add_u32 v25, 65536, v25
    ds_read_b64_tr_b16 v[120:121], v4 offset:0
    ds_read_b64_tr_b16 v[122:123], v25 offset:0
    s_add_u32 s57, s58, s71
    v_mfma_f32_16x16x32_bf16 v[108:111], a[28:31], v[124:127], v[108:111]
    buffer_load_dwordx4 v3, s[24:27], s57 offen offset:3072 sc1 lds
    v_mfma_f32_16x16x32_bf16 v[108:111], a[52:55], v[128:131], v[108:111]
    ds_read_b64_tr_b16 v[124:125], v4 offset:1024
    ds_read_b64_tr_b16 v[126:127], v25 offset:1024
    v_mfma_f32_16x16x32_bf16 v[108:111], a[76:79], v[132:135], v[108:111]
    ds_read_b64_tr_b16 v[128:129], v4 offset:2048
    ds_read_b64_tr_b16 v[130:131], v25 offset:2048
    v_mfma_f32_16x16x32_bf16 v[108:111], a[100:103], v[136:139], v[108:111]
    ds_read_b64_tr_b16 v[132:133], v4 offset:3072
    v_lshlrev_b32 v13, 4, v1
    v_mfma_f32_16x16x32_bf16 v[108:111], a[124:127], v[140:143], v[108:111]
    ds_read_b64_tr_b16 v[134:135], v25 offset:3072
    ds_read_b64_tr_b16 v[136:137], v4 offset:4096
    v_mfma_f32_16x16x32_bf16 v[108:111], a[148:151], v[144:147], v[108:111]
    ds_read_b64_tr_b16 v[138:139], v25 offset:4096
    s_add_u32 s57, s73, 0
    v_mfma_f32_16x16x32_bf16 v[108:111], a[172:175], v[148:151], v[108:111]
    buffer_load_dword v22, v5, s[20:23], s57 offen
    v_mfma_f32_16x16x32_bf16 v[108:111], a[196:199], v[152:155], v[108:111]
    ds_read_b64_tr_b16 v[140:141], v4 offset:5120
    ds_read_b64_tr_b16 v[142:143], v25 offset:5120
    v_mfma_f32_16x16x32_bf16 v[108:111], a[220:223], v[156:159], v[108:111]
    ds_read_b64_tr_b16 v[144:145], v4 offset:6144
    ds_read_b64_tr_b16 v[146:147], v25 offset:6144
    v_mfma_f32_16x16x32_bf16 v[108:111], a[244:247], v[160:163], v[108:111]
    ds_read_b64_tr_b16 v[148:149], v4 offset:7168
    ds_read_b64_tr_b16 v[150:151], v25 offset:7168
    v_mfma_f32_16x16x32_bf16 v[108:111], v[188:191], v[164:167], v[108:111]
    ds_read_b64_tr_b16 v[152:153], v4 offset:8192
    v_cvt_pk_bf16_f32 v68, v104, v105
    v_mfma_f32_16x16x32_bf16 v[108:111], v[212:215], v[168:171], v[108:111]
    ds_read_b64_tr_b16 v[154:155], v25 offset:8192
    ds_read_b64_tr_b16 v[156:157], v4 offset:9216
    s_add_u32 s57, s73, 524288
    v_mfma_f32_16x16x32_bf16 v[108:111], v[236:239], v[172:175], v[108:111]
    buffer_load_dword v22, v5, s[20:23], s57 offen
    s_waitcnt lgkmcnt(15)
    v_mfma_f32_16x16x32_bf16 v[112:115], a[8:11], v[120:123], 0
    ds_read_b64_tr_b16 v[158:159], v25 offset:9216
    ds_read_b64_tr_b16 v[160:161], v4 offset:10240
    v_mfma_f32_16x16x32_bf16 v[112:115], a[32:35], v[124:127], v[112:115]
    ds_read_b64_tr_b16 v[162:163], v25 offset:10240
    ds_read_b64_tr_b16 v[164:165], v4 offset:11264
    s_waitcnt lgkmcnt(15)
    v_mfma_f32_16x16x32_bf16 v[112:115], a[56:59], v[128:131], v[112:115]
    ds_read_b64_tr_b16 v[166:167], v25 offset:11264
    v_cvt_pk_bf16_f32 v69, v106, v107
    v_mfma_f32_16x16x32_bf16 v[112:115], a[80:83], v[132:135], v[112:115]
    ds_read_b64_tr_b16 v[168:169], v4 offset:12288
    v_add_u32 v12, s90, v13
    s_waitcnt lgkmcnt(13)
    v_mfma_f32_16x16x32_bf16 v[112:115], a[104:107], v[136:139], v[112:115]
    ds_read_b64_tr_b16 v[170:171], v25 offset:12288
    ds_read_b64_tr_b16 v[172:173], v4 offset:13312
    s_add_u32 s57, s75, 0
    v_mfma_f32_16x16x32_bf16 v[112:115], a[128:131], v[140:143], v[112:115]
    buffer_load_dword v22, v20, s[12:15], s57 offen
    s_waitcnt lgkmcnt(11)
    v_mfma_f32_16x16x32_bf16 v[112:115], a[152:155], v[144:147], v[112:115]
    ds_read_b64_tr_b16 v[174:175], v25 offset:13312
    v_cvt_pk_bf16_f32 v70, v108, v109
    v_mfma_f32_16x16x32_bf16 v[112:115], a[176:179], v[148:151], v[112:115]
    v_cvt_pk_bf16_f32 v71, v110, v111
    v_cndmask_b32 v70, v70, 0, s[82:83]
    s_waitcnt lgkmcnt(8)
    v_mfma_f32_16x16x32_bf16 v[112:115], a[200:203], v[152:155], v[112:115]
    v_cndmask_b32 v71, v71, 0, s[82:83]
    v_add_u32 v12, 155648, v12
    v_mfma_f32_16x16x32_bf16 v[112:115], a[224:227], v[156:159], v[112:115]
    v_add_u32 v13, s52, v13
    ds_write_b128 v12, v[84:87] offset:0
    s_waitcnt lgkmcnt(5)
    v_mfma_f32_16x16x32_bf16 v[112:115], a[248:251], v[160:163], v[112:115]
    s_add_u32 s57, s75, 262144
    v_cndmask_b32 v80, v84, v86, s[88:89]
    v_mfma_f32_16x16x32_bf16 v[112:115], v[192:195], v[164:167], v[112:115]
    buffer_load_dword v22, v20, s[12:15], s57 offen
    s_waitcnt lgkmcnt(1)
    v_mfma_f32_16x16x32_bf16 v[112:115], v[216:219], v[168:171], v[112:115]
    v_cndmask_b32 v81, v85, v87, s[88:89]
    ds_write_b64 v95, v[80:81] offset:0
    v_mfma_f32_16x16x32_bf16 v[112:115], v[240:243], v[172:175], v[112:115]
    v_mfma_f32_16x16x32_bf16 v[116:119], a[12:15], v[120:123], 0
    v_mfma_f32_16x16x32_bf16 v[72:75], v[56:59], v[64:67], 0
    v_mfma_f32_16x16x32_bf16 v[116:119], a[36:39], v[124:127], v[116:119]
    v_mfma_f32_16x16x32_bf16 v[76:79], v[60:63], v[64:67], 0
    v_mfma_f32_16x16x32_bf16 v[116:119], a[60:63], v[128:131], v[116:119]
    ds_read_u16_d16_hi v8, v93 offset:16384
    ds_read_u16_d16_hi v9, v94 offset:16384
    v_mfma_f32_16x16x32_bf16 v[116:119], a[84:87], v[132:135], v[116:119]
    ds_read_u16_d16_hi v10, v92 offset:16384
    v_mfma_f32_16x16x32_bf16 v[116:119], a[108:111], v[136:139], v[116:119]
    v_mfma_f32_16x16x32_bf16 v[116:119], a[132:135], v[140:143], v[116:119]
    v_mfma_f32_16x16x32_bf16 v[116:119], a[156:159], v[144:147], v[116:119]
    v_cvt_pk_bf16_f32 v56, v112, v113
    v_cvt_pk_bf16_f32 v57, v114, v115
    v_mfma_f32_16x16x32_bf16 v[116:119], a[180:183], v[148:151], v[116:119]
    v_cndmask_b32 v26, v72, v73, s[76:77]
    v_cndmask_b32 v27, v74, v75, s[76:77]
    v_mfma_f32_16x16x32_bf16 v[116:119], a[204:207], v[152:155], v[116:119]
    v_cndmask_b32 v28, v76, v77, s[76:77]
    v_cndmask_b32 v29, v78, v79, s[76:77]
    v_mfma_f32_16x16x32_bf16 v[116:119], a[228:231], v[156:159], v[116:119]
    v_cndmask_b32 v26, v26, v28, s[78:79]
    v_cndmask_b32 v27, v27, v29, s[80:81]
    v_mfma_f32_16x16x32_bf16 v[116:119], a[252:255], v[160:163], v[116:119]
    s_waitcnt lgkmcnt(0)
    v_mul_f32 v26, v26, v8
    v_mfma_f32_16x16x32_bf16 v[116:119], v[196:199], v[164:167], v[116:119]
    v_mul_f32 v27, v27, v9
    v_mul_f32 v11, s91, v10
    v_mfma_f32_16x16x32_bf16 v[116:119], v[220:223], v[168:171], v[116:119]
    v_max_f32 v28, v26, v27
    v_mov_b32 v29, v28
    v_mfma_f32_16x16x32_bf16 v[116:119], v[244:247], v[172:175], v[116:119]
    v_mfma_f32_16x16x32_bf16 v[96:99], v[120:123], a[16:19], 0
    v_permlane16_swap_b32 v28, v29
    v_max_f32 v28, v28, v29
    v_mfma_f32_16x16x32_bf16 v[96:99], v[124:127], a[40:43], v[96:99]
    v_mov_b32 v29, v28
    v_mfma_f32_16x16x32_bf16 v[96:99], v[128:131], a[64:67], v[96:99]
    v_mfma_f32_16x16x32_bf16 v[96:99], v[132:135], a[88:91], v[96:99]
    v_permlane32_swap_b32 v28, v29
    v_max_f32 v28, v28, v29
    v_mfma_f32_16x16x32_bf16 v[96:99], v[136:139], a[112:115], v[96:99]
    v_sub_f32 v26, v26, v28
    v_sub_f32 v27, v27, v28
    v_mfma_f32_16x16x32_bf16 v[96:99], v[140:143], a[136:139], v[96:99]
    v_mul_f32 v26, v11, v26
    v_mul_f32 v27, v11, v27
    v_mfma_f32_16x16x32_bf16 v[96:99], v[144:147], a[160:163], v[96:99]
    v_cvt_pk_bf16_f32 v58, v116, v117
    v_cvt_pk_bf16_f32 v59, v118, v119
    v_mfma_f32_16x16x32_bf16 v[96:99], v[148:151], a[184:187], v[96:99]
    v_cndmask_b32 v58, v58, 0, s[82:83]
    v_cndmask_b32 v59, v59, 0, s[82:83]
    v_mfma_f32_16x16x32_bf16 v[96:99], v[152:155], a[208:211], v[96:99]
    v_exp_f32 v26, v26
    v_mfma_f32_16x16x32_bf16 v[96:99], v[156:159], a[232:235], v[96:99]
    v_exp_f32 v27, v27
    v_mfma_f32_16x16x32_bf16 v[96:99], v[160:163], v[176:179], v[96:99]
    v_add_f32 v28, v26, v27
    v_mov_b32 v29, v28
    v_mfma_f32_16x16x32_bf16 v[96:99], v[164:167], v[200:203], v[96:99]
    v_mfma_f32_16x16x32_bf16 v[96:99], v[168:171], v[224:227], v[96:99]
    v_permlane16_swap_b32 v28, v29
    v_add_f32 v28, v28, v29
    v_mfma_f32_16x16x32_bf16 v[96:99], v[172:175], v[248:251], v[96:99]
    v_mov_b32 v29, v28
    v_mfma_f32_16x16x32_bf16 v[100:103], v[120:123], a[20:23], 0
    v_mfma_f32_16x16x32_bf16 v[100:103], v[124:127], a[44:47], v[100:103]
    v_permlane32_swap_b32 v28, v29
    v_add_f32 v28, v28, v29
    v_mfma_f32_16x16x32_bf16 v[100:103], v[128:131], a[68:71], v[100:103]
    v_rcp_f32 v28, v28
    v_mfma_f32_16x16x32_bf16 v[100:103], v[132:135], a[92:95], v[100:103]
    v_mul_f32 v26, v26, v8
    v_mul_f32 v27, v27, v9
    v_mfma_f32_16x16x32_bf16 v[100:103], v[136:139], a[116:119], v[100:103]
    v_mul_f32 v26, v26, v28
    v_mul_f32 v27, v27, v28
    v_mfma_f32_16x16x32_bf16 v[100:103], v[140:143], a[140:143], v[100:103]
    v_cvt_pk_bf16_f32 v26, v26, v26
    v_cvt_pk_bf16_f32 v27, v27, v27
    v_mfma_f32_16x16x32_bf16 v[100:103], v[144:147], a[164:167], v[100:103]
    v_cvt_pk_bf16_f32 v40, v96, v97
    v_cvt_pk_bf16_f32 v41, v98, v99
    v_mfma_f32_16x16x32_bf16 v[100:103], v[148:151], a[188:191], v[100:103]
    v_cvt_pk_bf16_f32 v32, v96, v97
    v_cvt_pk_bf16_f32 v33, v98, v99
    v_mfma_f32_16x16x32_bf16 v[100:103], v[152:155], a[212:215], v[100:103]
    v_and_b32 v80, v26, v14
    v_and_b32 v81, v27, v15
    v_mfma_f32_16x16x32_bf16 v[100:103], v[156:159], a[236:239], v[100:103]
    v_and_b32 v82, v26, v16
    v_and_b32 v83, v27, v17
    v_mfma_f32_16x16x32_bf16 v[100:103], v[160:163], v[180:183], v[100:103]
    v_mfma_f32_16x16x32_bf16 v[100:103], v[164:167], v[204:207], v[100:103]
    v_mfma_f32_16x16x32_bf16 v[72:75], v[34:37], v[80:83], 0
    v_mfma_f32_16x16x32_bf16 v[100:103], v[168:171], v[228:231], v[100:103]
    v_mfma_f32_16x16x32_bf16 v[76:79], v[44:47], v[80:83], 0
    v_mfma_f32_16x16x32_bf16 v[100:103], v[172:175], v[252:255], v[100:103]
    s_add_u32 s53, s74, 16384
    v_mfma_f32_16x16x32_bf16 v[104:107], a[0:3], v[120:123], 0
    v_mfma_f32_16x16x32_bf16 v[104:107], a[24:27], v[124:127], v[104:107]
    v_mfma_f32_16x16x32_bf16 v[104:107], a[48:51], v[128:131], v[104:107]
    v_mfma_f32_16x16x32_bf16 v[104:107], a[72:75], v[132:135], v[104:107]
    v_mfma_f32_16x16x32_bf16 v[104:107], a[96:99], v[136:139], v[104:107]
    v_cvt_pk_bf16_f32 v84, v72, v73
    v_cvt_pk_bf16_f32 v85, v74, v75
    v_mfma_f32_16x16x32_bf16 v[104:107], a[120:123], v[140:143], v[104:107]
    v_cvt_pk_bf16_f32 v86, v76, v77
    v_cvt_pk_bf16_f32 v87, v78, v79
    v_mfma_f32_16x16x32_bf16 v[104:107], a[144:147], v[144:147], v[104:107]
    v_cvt_pk_bf16_f32 v50, v100, v101
    v_cvt_pk_bf16_f32 v51, v102, v103
    v_mfma_f32_16x16x32_bf16 v[104:107], a[168:171], v[148:151], v[104:107]
    v_cvt_pk_bf16_f32 v42, v100, v101
    v_cvt_pk_bf16_f32 v43, v102, v103
    v_mfma_f32_16x16x32_bf16 v[104:107], a[192:195], v[152:155], v[104:107]
    ds_write_b128 v12, v[84:87] offset:1024
    v_cndmask_b32 v80, v84, v86, s[88:89]
    v_mfma_f32_16x16x32_bf16 v[104:107], a[216:219], v[156:159], v[104:107]
    v_cndmask_b32 v81, v85, v87, s[88:89]
    ds_write_b64 v95, v[80:81] offset:256
    v_mfma_f32_16x16x32_bf16 v[104:107], a[240:243], v[160:163], v[104:107]
    v_mfma_f32_16x16x32_bf16 v[104:107], v[184:187], v[164:167], v[104:107]
    v_mfma_f32_16x16x32_bf16 v[72:75], v[60:63], v[68:71], 0
    v_mfma_f32_16x16x32_bf16 v[104:107], v[208:211], v[168:171], v[104:107]
    v_mfma_f32_16x16x32_bf16 v[76:79], v[52:55], v[68:71], 0
    v_mfma_f32_16x16x32_bf16 v[104:107], v[232:235], v[172:175], v[104:107]
    ds_read_u16_d16_hi v8, v93 offset:32768
    ds_read_u16_d16_hi v9, v94 offset:32768
    v_mfma_f32_16x16x32_bf16 v[108:111], a[4:7], v[120:123], 0
    ds_read_b64_tr_b16 v[120:121], v4 offset:16384
    ds_read_b64_tr_b16 v[122:123], v25 offset:16384
    v_mfma_f32_16x16x32_bf16 v[108:111], a[28:31], v[124:127], v[108:111]
    ds_read_b64_tr_b16 v[124:125], v4 offset:17408
    ds_read_u16_d16_hi v10, v92 offset:32768
    v_mfma_f32_16x16x32_bf16 v[108:111], a[52:55], v[128:131], v[108:111]
    ds_read_b64_tr_b16 v[126:127], v25 offset:17408
    ds_read_b64_tr_b16 v[128:129], v4 offset:18432
    v_mfma_f32_16x16x32_bf16 v[108:111], a[76:79], v[132:135], v[108:111]
    ds_read_b64_tr_b16 v[130:131], v25 offset:18432
    v_mfma_f32_16x16x32_bf16 v[108:111], a[100:103], v[136:139], v[108:111]
    ds_read_b64_tr_b16 v[132:133], v4 offset:19456
    v_mfma_f32_16x16x32_bf16 v[108:111], a[124:127], v[140:143], v[108:111]
    ds_read_b64_tr_b16 v[134:135], v25 offset:19456
    ds_read_b64_tr_b16 v[136:137], v4 offset:20480
    v_mfma_f32_16x16x32_bf16 v[108:111], a[148:151], v[144:147], v[108:111]
    ds_read_b64_tr_b16 v[138:139], v25 offset:20480
    v_cvt_pk_bf16_f32 v64, v104, v105
    v_mfma_f32_16x16x32_bf16 v[108:111], a[172:175], v[148:151], v[108:111]
    ds_read_b64_tr_b16 v[140:141], v4 offset:21504
    ds_read_b64_tr_b16 v[142:143], v25 offset:21504
    v_mfma_f32_16x16x32_bf16 v[108:111], a[196:199], v[152:155], v[108:111]
    ds_read_b64_tr_b16 v[144:145], v4 offset:22528
    v_cvt_pk_bf16_f32 v65, v106, v107
    v_mfma_f32_16x16x32_bf16 v[108:111], a[220:223], v[156:159], v[108:111]
    ds_read_b64_tr_b16 v[146:147], v25 offset:22528
    v_cndmask_b32 v26, v72, v73, s[76:77]
    v_mfma_f32_16x16x32_bf16 v[108:111], a[244:247], v[160:163], v[108:111]
    ds_read_b64_tr_b16 v[148:149], v4 offset:23552
    ds_read_b64_tr_b16 v[150:151], v25 offset:23552
    v_mfma_f32_16x16x32_bf16 v[108:111], v[188:191], v[164:167], v[108:111]
    ds_read_b64_tr_b16 v[152:153], v4 offset:24576
    v_cndmask_b32 v27, v74, v75, s[76:77]
    v_mfma_f32_16x16x32_bf16 v[108:111], v[212:215], v[168:171], v[108:111]
    ds_read_b64_tr_b16 v[154:155], v25 offset:24576
    ds_read_b64_tr_b16 v[156:157], v4 offset:25600
    v_mfma_f32_16x16x32_bf16 v[108:111], v[236:239], v[172:175], v[108:111]
    ds_read_b64_tr_b16 v[158:159], v25 offset:25600
    v_cndmask_b32 v28, v76, v77, s[76:77]
    s_waitcnt lgkmcnt(15)
    v_mfma_f32_16x16x32_bf16 v[112:115], a[8:11], v[120:123], 0
    ds_read_b64_tr_b16 v[160:161], v4 offset:26624
    v_cndmask_b32 v29, v78, v79, s[76:77]
    v_mfma_f32_16x16x32_bf16 v[112:115], a[32:35], v[124:127], v[112:115]
    ds_read_b64_tr_b16 v[162:163], v25 offset:26624
    ds_read_b64_tr_b16 v[164:165], v4 offset:27648
    s_waitcnt lgkmcnt(15)
    v_mfma_f32_16x16x32_bf16 v[112:115], a[56:59], v[128:131], v[112:115]
    ds_read_b64_tr_b16 v[166:167], v25 offset:27648
    v_cndmask_b32 v26, v26, v28, s[78:79]
    v_mfma_f32_16x16x32_bf16 v[112:115], a[80:83], v[132:135], v[112:115]
    ds_read_b64_tr_b16 v[168:169], v4 offset:28672
    v_cndmask_b32 v27, v27, v29, s[80:81]
    s_waitcnt lgkmcnt(13)
    v_mfma_f32_16x16x32_bf16 v[112:115], a[104:107], v[136:139], v[112:115]
    ds_read_b64_tr_b16 v[170:171], v25 offset:28672
    ds_read_b64_tr_b16 v[172:173], v4 offset:29696
    v_mfma_f32_16x16x32_bf16 v[112:115], a[128:131], v[140:143], v[112:115]
    ds_read_b64_tr_b16 v[174:175], v25 offset:29696
    s_waitcnt lgkmcnt(12)
    v_mfma_f32_16x16x32_bf16 v[112:115], a[152:155], v[144:147], v[112:115]
    v_cvt_pk_bf16_f32 v66, v108, v109
    v_cvt_pk_bf16_f32 v67, v110, v111
    v_mfma_f32_16x16x32_bf16 v[112:115], a[176:179], v[148:151], v[112:115]
    v_cndmask_b32 v66, v66, 0, s[82:83]
    v_cndmask_b32 v67, v67, 0, s[82:83]
    s_waitcnt lgkmcnt(8)
    v_mfma_f32_16x16x32_bf16 v[112:115], a[200:203], v[152:155], v[112:115]
    v_mul_f32 v26, v26, v8
    v_mul_f32 v27, v27, v9
    v_mfma_f32_16x16x32_bf16 v[112:115], a[224:227], v[156:159], v[112:115]
    v_mul_f32 v11, s91, v10
    v_max_f32 v28, v26, v27
    s_waitcnt lgkmcnt(4)
    v_mfma_f32_16x16x32_bf16 v[112:115], a[248:251], v[160:163], v[112:115]
    v_mov_b32 v29, v28
    v_mfma_f32_16x16x32_bf16 v[112:115], v[192:195], v[164:167], v[112:115]
    s_waitcnt lgkmcnt(0)
    v_mfma_f32_16x16x32_bf16 v[112:115], v[216:219], v[168:171], v[112:115]
    v_permlane16_swap_b32 v28, v29
    v_max_f32 v28, v28, v29
    v_mfma_f32_16x16x32_bf16 v[112:115], v[240:243], v[172:175], v[112:115]
    v_mov_b32 v29, v28
    v_mfma_f32_16x16x32_bf16 v[116:119], a[12:15], v[120:123], 0
    v_mfma_f32_16x16x32_bf16 v[116:119], a[36:39], v[124:127], v[116:119]
    v_permlane32_swap_b32 v28, v29
    v_max_f32 v28, v28, v29
    v_mfma_f32_16x16x32_bf16 v[116:119], a[60:63], v[128:131], v[116:119]
    v_sub_f32 v26, v26, v28
    v_sub_f32 v27, v27, v28
    v_mfma_f32_16x16x32_bf16 v[116:119], a[84:87], v[132:135], v[116:119]
    v_mul_f32 v26, v11, v26
    v_mul_f32 v27, v11, v27
    v_mfma_f32_16x16x32_bf16 v[116:119], a[108:111], v[136:139], v[116:119]
    v_exp_f32 v26, v26
    v_mfma_f32_16x16x32_bf16 v[116:119], a[132:135], v[140:143], v[116:119]
    v_exp_f32 v27, v27
    v_mfma_f32_16x16x32_bf16 v[116:119], a[156:159], v[144:147], v[116:119]
    v_cvt_pk_bf16_f32 v60, v112, v113
    v_cvt_pk_bf16_f32 v61, v114, v115
    v_mfma_f32_16x16x32_bf16 v[116:119], a[180:183], v[148:151], v[116:119]
    v_add_f32 v28, v26, v27
    v_mov_b32 v29, v28
    v_mfma_f32_16x16x32_bf16 v[116:119], a[204:207], v[152:155], v[116:119]
    v_mfma_f32_16x16x32_bf16 v[116:119], a[228:231], v[156:159], v[116:119]
    v_permlane16_swap_b32 v28, v29
    v_add_f32 v28, v28, v29
    v_mfma_f32_16x16x32_bf16 v[116:119], a[252:255], v[160:163], v[116:119]
    v_mov_b32 v29, v28
    v_mfma_f32_16x16x32_bf16 v[116:119], v[196:199], v[164:167], v[116:119]
    v_mfma_f32_16x16x32_bf16 v[116:119], v[220:223], v[168:171], v[116:119]
    v_permlane32_swap_b32 v28, v29
    v_add_f32 v28, v28, v29
    v_mfma_f32_16x16x32_bf16 v[116:119], v[244:247], v[172:175], v[116:119]
    v_rcp_f32 v28, v28
    v_mfma_f32_16x16x32_bf16 v[96:99], v[120:123], a[16:19], 0
    v_mul_f32 v26, v26, v8
    v_mul_f32 v27, v27, v9
    v_mfma_f32_16x16x32_bf16 v[96:99], v[124:127], a[40:43], v[96:99]
    v_mul_f32 v26, v26, v28
    v_mul_f32 v27, v27, v28
    v_mfma_f32_16x16x32_bf16 v[96:99], v[128:131], a[64:67], v[96:99]
    v_cvt_pk_bf16_f32 v26, v26, v26
    v_cvt_pk_bf16_f32 v27, v27, v27
    v_mfma_f32_16x16x32_bf16 v[96:99], v[132:135], a[88:91], v[96:99]
    v_and_b32 v80, v26, v14
    v_and_b32 v81, v27, v15
    v_mfma_f32_16x16x32_bf16 v[96:99], v[136:139], a[112:115], v[96:99]
    v_and_b32 v82, v26, v16
    v_and_b32 v83, v27, v17
    v_mfma_f32_16x16x32_bf16 v[96:99], v[140:143], a[136:139], v[96:99]
    v_mfma_f32_16x16x32_bf16 v[96:99], v[144:147], a[160:163], v[96:99]
    v_cvt_pk_bf16_f32 v62, v116, v117
    v_cvt_pk_bf16_f32 v63, v118, v119
    v_mfma_f32_16x16x32_bf16 v[96:99], v[148:151], a[184:187], v[96:99]
    v_cndmask_b32 v62, v62, 0, s[82:83]
    v_cndmask_b32 v63, v63, 0, s[82:83]
    v_mfma_f32_16x16x32_bf16 v[96:99], v[152:155], a[208:211], v[96:99]
    v_mfma_f32_16x16x32_bf16 v[72:75], v[36:39], v[80:83], 0
    v_mfma_f32_16x16x32_bf16 v[96:99], v[156:159], a[232:235], v[96:99]
    v_mfma_f32_16x16x32_bf16 v[76:79], v[46:49], v[80:83], 0
    v_mfma_f32_16x16x32_bf16 v[96:99], v[160:163], v[176:179], v[96:99]
    s_add_u32 s53, s74, 32768
    v_mfma_f32_16x16x32_bf16 v[96:99], v[164:167], v[200:203], v[96:99]
    v_mfma_f32_16x16x32_bf16 v[96:99], v[168:171], v[224:227], v[96:99]
    v_mfma_f32_16x16x32_bf16 v[96:99], v[172:175], v[248:251], v[96:99]
    v_mfma_f32_16x16x32_bf16 v[100:103], v[120:123], a[20:23], 0
    v_mfma_f32_16x16x32_bf16 v[100:103], v[124:127], a[44:47], v[100:103]
    v_cvt_pk_bf16_f32 v84, v72, v73
    v_cvt_pk_bf16_f32 v85, v74, v75
    v_mfma_f32_16x16x32_bf16 v[100:103], v[128:131], a[68:71], v[100:103]
    v_cvt_pk_bf16_f32 v86, v76, v77
    v_cvt_pk_bf16_f32 v87, v78, v79
    v_mfma_f32_16x16x32_bf16 v[100:103], v[132:135], a[92:95], v[100:103]
    buffer_store_dwordx4 v[84:87], v23, s[24:27], s53 offen sc1
    v_mfma_f32_16x16x32_bf16 v[100:103], v[136:139], a[116:119], v[100:103]
    v_cndmask_b32 v80, v84, v86, s[88:89]
    v_cndmask_b32 v81, v85, v87, s[88:89]
    v_mfma_f32_16x16x32_bf16 v[100:103], v[140:143], a[140:143], v[100:103]
    ds_write_b64 v95, v[80:81] offset:512
    ds_read_b128 v[72:75], v12 offset:0
    v_mfma_f32_16x16x32_bf16 v[100:103], v[144:147], a[164:167], v[100:103]
    v_cvt_pk_bf16_f32 v34, v96, v97
    v_cvt_pk_bf16_f32 v35, v98, v99
    v_mfma_f32_16x16x32_bf16 v[100:103], v[148:151], a[188:191], v[100:103]
    s_add_u32 s53, s74, 0
    v_mfma_f32_16x16x32_bf16 v[100:103], v[152:155], a[212:215], v[100:103]
    v_mfma_f32_16x16x32_bf16 v[100:103], v[156:159], a[236:239], v[100:103]
    v_mfma_f32_16x16x32_bf16 v[100:103], v[160:163], v[180:183], v[100:103]
    v_mfma_f32_16x16x32_bf16 v[100:103], v[164:167], v[204:207], v[100:103]
    s_waitcnt lgkmcnt(0)
    buffer_store_dwordx4 v[72:75], v23, s[24:27], s53 offen sc1
    v_mfma_f32_16x16x32_bf16 v[100:103], v[168:171], v[228:231], v[100:103]
    v_mfma_f32_16x16x32_bf16 v[100:103], v[172:175], v[252:255], v[100:103]
    v_mfma_f32_16x16x32_bf16 v[72:75], v[52:55], v[64:67], 0
    v_mfma_f32_16x16x32_bf16 v[104:107], a[0:3], v[120:123], 0
    v_mfma_f32_16x16x32_bf16 v[76:79], v[56:59], v[64:67], 0
    v_mfma_f32_16x16x32_bf16 v[104:107], a[24:27], v[124:127], v[104:107]
    ds_read_u16_d16_hi v8, v93 offset:49152
    ds_read_u16_d16_hi v9, v94 offset:49152
    v_mfma_f32_16x16x32_bf16 v[104:107], a[48:51], v[128:131], v[104:107]
    ds_read_u16_d16_hi v10, v92 offset:49152
    v_mfma_f32_16x16x32_bf16 v[104:107], a[72:75], v[132:135], v[104:107]
    v_mfma_f32_16x16x32_bf16 v[104:107], a[96:99], v[136:139], v[104:107]
    v_mfma_f32_16x16x32_bf16 v[104:107], a[120:123], v[140:143], v[104:107]
    v_mfma_f32_16x16x32_bf16 v[104:107], a[144:147], v[144:147], v[104:107]
    v_cvt_pk_bf16_f32 v44, v100, v101
    v_cvt_pk_bf16_f32 v45, v102, v103
    v_mfma_f32_16x16x32_bf16 v[104:107], a[168:171], v[148:151], v[104:107]
    v_cndmask_b32 v26, v72, v73, s[76:77]
    v_cndmask_b32 v27, v74, v75, s[76:77]
    v_mfma_f32_16x16x32_bf16 v[104:107], a[192:195], v[152:155], v[104:107]
    v_cndmask_b32 v28, v76, v77, s[76:77]
    v_cndmask_b32 v29, v78, v79, s[76:77]
    v_mfma_f32_16x16x32_bf16 v[104:107], a[216:219], v[156:159], v[104:107]
    v_cndmask_b32 v26, v26, v28, s[78:79]
    v_cndmask_b32 v27, v27, v29, s[80:81]
    v_mfma_f32_16x16x32_bf16 v[104:107], a[240:243], v[160:163], v[104:107]
    s_waitcnt lgkmcnt(0)
    v_mul_f32 v26, v26, v8
    v_mfma_f32_16x16x32_bf16 v[104:107], v[184:187], v[164:167], v[104:107]
    v_mul_f32 v27, v27, v9
    v_mul_f32 v11, s91, v10
    v_mfma_f32_16x16x32_bf16 v[104:107], v[208:211], v[168:171], v[104:107]
    v_max_f32 v28, v26, v27
    v_mov_b32 v29, v28
    v_mfma_f32_16x16x32_bf16 v[104:107], v[232:235], v[172:175], v[104:107]
    v_mfma_f32_16x16x32_bf16 v[108:111], a[4:7], v[120:123], 0
    ds_read_b64_tr_b16 v[120:121], v4 offset:32768
    ds_read_b64_tr_b16 v[122:123], v25 offset:32768
    v_mfma_f32_16x16x32_bf16 v[108:111], a[28:31], v[124:127], v[108:111]
    ds_read_b64_tr_b16 v[124:125], v4 offset:33792
    v_permlane16_swap_b32 v28, v29
    v_mfma_f32_16x16x32_bf16 v[108:111], a[52:55], v[128:131], v[108:111]
    ds_read_b64_tr_b16 v[126:127], v25 offset:33792
    ds_read_b64_tr_b16 v[128:129], v4 offset:34816
    v_mfma_f32_16x16x32_bf16 v[108:111], a[76:79], v[132:135], v[108:111]
    ds_read_b64_tr_b16 v[130:131], v25 offset:34816
    v_max_f32 v28, v28, v29
    v_mfma_f32_16x16x32_bf16 v[108:111], a[100:103], v[136:139], v[108:111]
    ds_read_b64_tr_b16 v[132:133], v4 offset:35840
    v_mov_b32 v29, v28
    v_mfma_f32_16x16x32_bf16 v[108:111], a[124:127], v[140:143], v[108:111]
    ds_read_b64_tr_b16 v[134:135], v25 offset:35840
    ds_read_b64_tr_b16 v[136:137], v4 offset:36864
    v_mfma_f32_16x16x32_bf16 v[108:111], a[148:151], v[144:147], v[108:111]
    ds_read_b64_tr_b16 v[138:139], v25 offset:36864
    v_cvt_pk_bf16_f32 v68, v104, v105
    v_mfma_f32_16x16x32_bf16 v[108:111], a[172:175], v[148:151], v[108:111]
    ds_read_b64_tr_b16 v[140:141], v4 offset:37888
    ds_read_b64_tr_b16 v[142:143], v25 offset:37888
    v_mfma_f32_16x16x32_bf16 v[108:111], a[196:199], v[152:155], v[108:111]
    ds_read_b64_tr_b16 v[144:145], v4 offset:38912
    v_cvt_pk_bf16_f32 v69, v106, v107
    v_mfma_f32_16x16x32_bf16 v[108:111], a[220:223], v[156:159], v[108:111]
    ds_read_b64_tr_b16 v[146:147], v25 offset:38912
    v_permlane32_swap_b32 v28, v29
    v_mfma_f32_16x16x32_bf16 v[108:111], a[244:247], v[160:163], v[108:111]
    ds_read_b64_tr_b16 v[148:149], v4 offset:39936
    ds_read_b64_tr_b16 v[150:151], v25 offset:39936
    v_mfma_f32_16x16x32_bf16 v[108:111], v[188:191], v[164:167], v[108:111]
    ds_read_b64_tr_b16 v[152:153], v4 offset:40960
    v_max_f32 v28, v28, v29
    v_mfma_f32_16x16x32_bf16 v[108:111], v[212:215], v[168:171], v[108:111]
    ds_read_b64_tr_b16 v[154:155], v25 offset:40960
    ds_read_b64_tr_b16 v[156:157], v4 offset:41984
    v_mfma_f32_16x16x32_bf16 v[108:111], v[236:239], v[172:175], v[108:111]
    ds_read_b64_tr_b16 v[158:159], v25 offset:41984
    v_sub_f32 v26, v26, v28
    s_waitcnt lgkmcnt(15)
    v_mfma_f32_16x16x32_bf16 v[112:115], a[8:11], v[120:123], 0
    ds_read_b64_tr_b16 v[160:161], v4 offset:43008
    v_sub_f32 v27, v27, v28
    v_mfma_f32_16x16x32_bf16 v[112:115], a[32:35], v[124:127], v[112:115]
    ds_read_b64_tr_b16 v[162:163], v25 offset:43008
    ds_read_b64_tr_b16 v[164:165], v4 offset:44032
    s_waitcnt lgkmcnt(15)
    v_mfma_f32_16x16x32_bf16 v[112:115], a[56:59], v[128:131], v[112:115]
    ds_read_b64_tr_b16 v[166:167], v25 offset:44032
    v_mul_f32 v26, v11, v26
    v_mfma_f32_16x16x32_bf16 v[112:115], a[80:83], v[132:135], v[112:115]
    ds_read_b64_tr_b16 v[168:169], v4 offset:45056
    v_mul_f32 v27, v11, v27
    s_waitcnt lgkmcnt(13)
    v_mfma_f32_16x16x32_bf16 v[112:115], a[104:107], v[136:139], v[112:115]
    ds_read_b64_tr_b16 v[170:171], v25 offset:45056
    ds_read_b64_tr_b16 v[172:173], v4 offset:46080
    v_mfma_f32_16x16x32_bf16 v[112:115], a[128:131], v[140:143], v[112:115]
    ds_read_b64_tr_b16 v[174:175], v25 offset:46080
    v_exp_f32 v26, v26
    s_waitcnt lgkmcnt(12)
    v_mfma_f32_16x16x32_bf16 v[112:115], a[152:155], v[144:147], v[112:115]
    v_cvt_pk_bf16_f32 v70, v108, v109
    v_cvt_pk_bf16_f32 v71, v110, v111
    v_mfma_f32_16x16x32_bf16 v[112:115], a[176:179], v[148:151], v[112:115]
    v_cndmask_b32 v70, v70, 0, s[82:83]
    v_cndmask_b32 v71, v71, 0, s[82:83]
    s_waitcnt lgkmcnt(8)
    v_mfma_f32_16x16x32_bf16 v[112:115], a[200:203], v[152:155], v[112:115]
    v_exp_f32 v27, v27
    v_mfma_f32_16x16x32_bf16 v[112:115], a[224:227], v[156:159], v[112:115]
    v_add_f32 v28, v26, v27
    v_mov_b32 v29, v28
    s_waitcnt lgkmcnt(4)
    v_mfma_f32_16x16x32_bf16 v[112:115], a[248:251], v[160:163], v[112:115]
    v_mfma_f32_16x16x32_bf16 v[112:115], v[192:195], v[164:167], v[112:115]
    v_permlane16_swap_b32 v28, v29
    v_add_f32 v28, v28, v29
    s_waitcnt lgkmcnt(0)
    v_mfma_f32_16x16x32_bf16 v[112:115], v[216:219], v[168:171], v[112:115]
    v_mov_b32 v29, v28
    v_mfma_f32_16x16x32_bf16 v[112:115], v[240:243], v[172:175], v[112:115]
    v_mfma_f32_16x16x32_bf16 v[116:119], a[12:15], v[120:123], 0
    v_permlane32_swap_b32 v28, v29
    v_add_f32 v28, v28, v29
    v_mfma_f32_16x16x32_bf16 v[116:119], a[36:39], v[124:127], v[116:119]
    v_rcp_f32 v28, v28
    v_mfma_f32_16x16x32_bf16 v[116:119], a[60:63], v[128:131], v[116:119]
    v_mul_f32 v26, v26, v8
    v_mul_f32 v27, v27, v9
    v_mfma_f32_16x16x32_bf16 v[116:119], a[84:87], v[132:135], v[116:119]
    v_mul_f32 v26, v26, v28
    v_mul_f32 v27, v27, v28
    v_mfma_f32_16x16x32_bf16 v[116:119], a[108:111], v[136:139], v[116:119]
    v_cvt_pk_bf16_f32 v26, v26, v26
    v_cvt_pk_bf16_f32 v27, v27, v27
    v_mfma_f32_16x16x32_bf16 v[116:119], a[132:135], v[140:143], v[116:119]
    v_and_b32 v80, v26, v14
    v_and_b32 v81, v27, v15
    v_mfma_f32_16x16x32_bf16 v[116:119], a[156:159], v[144:147], v[116:119]
    v_cvt_pk_bf16_f32 v52, v112, v113
    v_cvt_pk_bf16_f32 v53, v114, v115
    v_mfma_f32_16x16x32_bf16 v[116:119], a[180:183], v[148:151], v[116:119]
    v_and_b32 v82, v26, v16
    v_and_b32 v83, v27, v17
    v_mfma_f32_16x16x32_bf16 v[116:119], a[204:207], v[152:155], v[116:119]
    v_mfma_f32_16x16x32_bf16 v[116:119], a[228:231], v[156:159], v[116:119]
    v_mfma_f32_16x16x32_bf16 v[72:75], v[38:41], v[80:83], 0
    v_mfma_f32_16x16x32_bf16 v[116:119], a[252:255], v[160:163], v[116:119]
    v_mfma_f32_16x16x32_bf16 v[76:79], v[48:51], v[80:83], 0
    v_mfma_f32_16x16x32_bf16 v[116:119], v[196:199], v[164:167], v[116:119]
    s_add_u32 s53, s74, 49152
    v_mfma_f32_16x16x32_bf16 v[116:119], v[220:223], v[168:171], v[116:119]
    v_mfma_f32_16x16x32_bf16 v[116:119], v[244:247], v[172:175], v[116:119]
    v_mfma_f32_16x16x32_bf16 v[96:99], v[120:123], a[16:19], 0
    v_mfma_f32_16x16x32_bf16 v[96:99], v[124:127], a[40:43], v[96:99]
    v_mfma_f32_16x16x32_bf16 v[96:99], v[128:131], a[64:67], v[96:99]
    v_cvt_pk_bf16_f32 v84, v72, v73
    v_cvt_pk_bf16_f32 v85, v74, v75
    v_mfma_f32_16x16x32_bf16 v[96:99], v[132:135], a[88:91], v[96:99]
    v_cvt_pk_bf16_f32 v86, v76, v77
    v_cvt_pk_bf16_f32 v87, v78, v79
    v_mfma_f32_16x16x32_bf16 v[96:99], v[136:139], a[112:115], v[96:99]
    buffer_store_dwordx4 v[84:87], v23, s[24:27], s53 offen sc1
    v_mfma_f32_16x16x32_bf16 v[96:99], v[140:143], a[136:139], v[96:99]
    v_cndmask_b32 v80, v84, v86, s[88:89]
    v_cndmask_b32 v81, v85, v87, s[88:89]
L_wa_3:
    s_cbranch_execz L_wa_ret
    v_mfma_f32_16x16x32_bf16 v[96:99], v[144:147], a[160:163], v[96:99]
    v_cvt_pk_bf16_f32 v54, v116, v117
    v_cvt_pk_bf16_f32 v55, v118, v119
    v_mfma_f32_16x16x32_bf16 v[96:99], v[148:151], a[184:187], v[96:99]
    v_cndmask_b32 v54, v54, 0, s[82:83]
    v_cndmask_b32 v55, v55, 0, s[82:83]
    v_mfma_f32_16x16x32_bf16 v[96:99], v[152:155], a[208:211], v[96:99]
    ds_write_b64 v95, v[80:81] offset:768
    ds_read_b128 v[72:75], v12 offset:1024
    v_mfma_f32_16x16x32_bf16 v[96:99], v[156:159], a[232:235], v[96:99]
    s_add_u32 s53, s74, 16384
    v_mfma_f32_16x16x32_bf16 v[96:99], v[160:163], v[176:179], v[96:99]
    v_mfma_f32_16x16x32_bf16 v[96:99], v[164:167], v[200:203], v[96:99]
    v_mfma_f32_16x16x32_bf16 v[96:99], v[168:171], v[224:227], v[96:99]
    v_mfma_f32_16x16x32_bf16 v[96:99], v[172:175], v[248:251], v[96:99]
    s_waitcnt lgkmcnt(0)
    buffer_store_dwordx4 v[72:75], v23, s[24:27], s53 offen sc1
    v_mfma_f32_16x16x32_bf16 v[100:103], v[120:123], a[20:23], 0
    v_add_u32 v92, 65536, v92
    v_add_u32 v93, 65536, v93
    v_mfma_f32_16x16x32_bf16 v[100:103], v[124:127], a[44:47], v[100:103]
    v_add_u32 v94, 65536, v94
    v_mfma_f32_16x16x32_bf16 v[100:103], v[128:131], a[68:71], v[100:103]
    v_mfma_f32_16x16x32_bf16 v[72:75], v[56:59], v[68:71], 0
    v_mfma_f32_16x16x32_bf16 v[100:103], v[132:135], a[92:95], v[100:103]
    v_mfma_f32_16x16x32_bf16 v[76:79], v[60:63], v[68:71], 0
    v_mfma_f32_16x16x32_bf16 v[100:103], v[136:139], a[116:119], v[100:103]
    ds_read_u16_d16_hi v8, v93 offset:0
    ds_read_u16_d16_hi v9, v94 offset:0
    v_mfma_f32_16x16x32_bf16 v[100:103], v[140:143], a[140:143], v[100:103]
    ds_read_u16_d16_hi v10, v92 offset:0
    v_mfma_f32_16x16x32_bf16 v[100:103], v[144:147], a[164:167], v[100:103]
    v_cvt_pk_bf16_f32 v36, v96, v97
    v_cvt_pk_bf16_f32 v37, v98, v99
    v_mfma_f32_16x16x32_bf16 v[100:103], v[148:151], a[188:191], v[100:103]
    v_mfma_f32_16x16x32_bf16 v[100:103], v[152:155], a[212:215], v[100:103]
    v_mfma_f32_16x16x32_bf16 v[100:103], v[156:159], a[236:239], v[100:103]
    v_cndmask_b32 v26, v72, v73, s[76:77]
    v_cndmask_b32 v27, v74, v75, s[76:77]
    v_mfma_f32_16x16x32_bf16 v[100:103], v[160:163], v[180:183], v[100:103]
    v_cndmask_b32 v28, v76, v77, s[76:77]
    v_cndmask_b32 v29, v78, v79, s[76:77]
    v_mfma_f32_16x16x32_bf16 v[100:103], v[164:167], v[204:207], v[100:103]
    v_cndmask_b32 v26, v26, v28, s[78:79]
    v_cndmask_b32 v27, v27, v29, s[80:81]
    v_mfma_f32_16x16x32_bf16 v[100:103], v[168:171], v[228:231], v[100:103]
    s_waitcnt lgkmcnt(0)
    v_mul_f32 v26, v26, v8
    v_mfma_f32_16x16x32_bf16 v[100:103], v[172:175], v[252:255], v[100:103]
    v_mul_f32 v27, v27, v9
    v_mul_f32 v11, s91, v10
    v_mfma_f32_16x16x32_bf16 v[104:107], a[0:3], v[120:123], 0
    v_max_f32 v28, v26, v27
    v_mov_b32 v29, v28
    v_mfma_f32_16x16x32_bf16 v[104:107], a[24:27], v[124:127], v[104:107]
    v_mfma_f32_16x16x32_bf16 v[104:107], a[48:51], v[128:131], v[104:107]
    v_permlane16_swap_b32 v28, v29
    v_max_f32 v28, v28, v29
    v_mfma_f32_16x16x32_bf16 v[104:107], a[72:75], v[132:135], v[104:107]
    v_mov_b32 v29, v28
    v_mfma_f32_16x16x32_bf16 v[104:107], a[96:99], v[136:139], v[104:107]
    v_mfma_f32_16x16x32_bf16 v[104:107], a[120:123], v[140:143], v[104:107]
    v_permlane32_swap_b32 v28, v29
    v_max_f32 v28, v28, v29
    v_mfma_f32_16x16x32_bf16 v[104:107], a[144:147], v[144:147], v[104:107]
    v_cvt_pk_bf16_f32 v46, v100, v101
    v_cvt_pk_bf16_f32 v47, v102, v103
    v_mfma_f32_16x16x32_bf16 v[104:107], a[168:171], v[148:151], v[104:107]
    v_sub_f32 v26, v26, v28
    v_sub_f32 v27, v27, v28
    v_mfma_f32_16x16x32_bf16 v[104:107], a[192:195], v[152:155], v[104:107]
    v_mul_f32 v26, v11, v26
    v_mul_f32 v27, v11, v27
    v_mfma_f32_16x16x32_bf16 v[104:107], a[216:219], v[156:159], v[104:107]
    v_exp_f32 v26, v26
    v_mfma_f32_16x16x32_bf16 v[104:107], a[240:243], v[160:163], v[104:107]
    v_exp_f32 v27, v27
    v_mfma_f32_16x16x32_bf16 v[104:107], v[184:187], v[164:167], v[104:107]
    v_add_f32 v28, v26, v27
    v_mov_b32 v29, v28
    v_mfma_f32_16x16x32_bf16 v[104:107], v[208:211], v[168:171], v[104:107]
    v_mfma_f32_16x16x32_bf16 v[104:107], v[232:235], v[172:175], v[104:107]
    v_permlane16_swap_b32 v28, v29
    v_add_f32 v28, v28, v29
    s_waitcnt vmcnt(8)
    s_barrier
    v_mfma_f32_16x16x32_bf16 v[108:111], a[4:7], v[120:123], 0
    ds_read_b64_tr_b16 v[120:121], v4 offset:49152
    ds_read_b64_tr_b16 v[122:123], v25 offset:49152
    v_mfma_f32_16x16x32_bf16 v[108:111], a[28:31], v[124:127], v[108:111]
    ds_read_b64_tr_b16 v[124:125], v4 offset:50176
    v_mov_b32 v29, v28
    v_mfma_f32_16x16x32_bf16 v[108:111], a[52:55], v[128:131], v[108:111]
    ds_read_b64_tr_b16 v[126:127], v25 offset:50176
    ds_read_b64_tr_b16 v[128:129], v4 offset:51200
    v_mfma_f32_16x16x32_bf16 v[108:111], a[76:79], v[132:135], v[108:111]
    ds_read_b64_tr_b16 v[130:131], v25 offset:51200
    v_permlane32_swap_b32 v28, v29
    v_mfma_f32_16x16x32_bf16 v[108:111], a[100:103], v[136:139], v[108:111]
    ds_read_b64_tr_b16 v[132:133], v4 offset:52224
    v_add_f32 v28, v28, v29
    v_mfma_f32_16x16x32_bf16 v[108:111], a[124:127], v[140:143], v[108:111]
    ds_read_b64_tr_b16 v[134:135], v25 offset:52224
    ds_read_b64_tr_b16 v[136:137], v4 offset:53248
    v_mfma_f32_16x16x32_bf16 v[108:111], a[148:151], v[144:147], v[108:111]
    ds_read_b64_tr_b16 v[138:139], v25 offset:53248
    v_cvt_pk_bf16_f32 v64, v104, v105
    v_mfma_f32_16x16x32_bf16 v[108:111], a[172:175], v[148:151], v[108:111]
    ds_read_b64_tr_b16 v[140:141], v4 offset:54272
    ds_read_b64_tr_b16 v[142:143], v25 offset:54272
    v_mfma_f32_16x16x32_bf16 v[108:111], a[196:199], v[152:155], v[108:111]
    ds_read_b64_tr_b16 v[144:145], v4 offset:55296
    v_cvt_pk_bf16_f32 v65, v106, v107
    v_mfma_f32_16x16x32_bf16 v[108:111], a[220:223], v[156:159], v[108:111]
    ds_read_b64_tr_b16 v[146:147], v25 offset:55296
    v_rcp_f32 v28, v28
    v_mfma_f32_16x16x32_bf16 v[108:111], a[244:247], v[160:163], v[108:111]
    ds_read_b64_tr_b16 v[148:149], v4 offset:56320
    ds_read_b64_tr_b16 v[150:151], v25 offset:56320
    v_mfma_f32_16x16x32_bf16 v[108:111], v[188:191], v[164:167], v[108:111]
    ds_read_b64_tr_b16 v[152:153], v4 offset:57344
    v_mul_f32 v26, v26, v8
    v_mfma_f32_16x16x32_bf16 v[108:111], v[212:215], v[168:171], v[108:111]
    ds_read_b64_tr_b16 v[154:155], v25 offset:57344
    ds_read_b64_tr_b16 v[156:157], v4 offset:58368
    v_mfma_f32_16x16x32_bf16 v[108:111], v[236:239], v[172:175], v[108:111]
    ds_read_b64_tr_b16 v[158:159], v25 offset:58368
    v_mul_f32 v27, v27, v9
    s_waitcnt lgkmcnt(15)
    v_mfma_f32_16x16x32_bf16 v[112:115], a[8:11], v[120:123], 0
    ds_read_b64_tr_b16 v[160:161], v4 offset:59392
    v_mul_f32 v26, v26, v28
    v_mfma_f32_16x16x32_bf16 v[112:115], a[32:35], v[124:127], v[112:115]
    ds_read_b64_tr_b16 v[162:163], v25 offset:59392
    ds_read_b64_tr_b16 v[164:165], v4 offset:60416
    s_waitcnt lgkmcnt(15)
    v_mfma_f32_16x16x32_bf16 v[112:115], a[56:59], v[128:131], v[112:115]
    ds_read_b64_tr_b16 v[166:167], v25 offset:60416
    v_mul_f32 v27, v27, v28
    v_mfma_f32_16x16x32_bf16 v[112:115], a[80:83], v[132:135], v[112:115]
    ds_read_b64_tr_b16 v[168:169], v4 offset:61440
    v_cvt_pk_bf16_f32 v26, v26, v26
    s_waitcnt lgkmcnt(13)
    v_mfma_f32_16x16x32_bf16 v[112:115], a[104:107], v[136:139], v[112:115]
    ds_read_b64_tr_b16 v[170:171], v25 offset:61440
    ds_read_b64_tr_b16 v[172:173], v4 offset:62464
    v_mfma_f32_16x16x32_bf16 v[112:115], a[128:131], v[140:143], v[112:115]
    ds_read_b64_tr_b16 v[174:175], v25 offset:62464
    v_cvt_pk_bf16_f32 v27, v27, v27
    s_waitcnt lgkmcnt(12)
    v_mfma_f32_16x16x32_bf16 v[112:115], a[152:155], v[144:147], v[112:115]
    v_cvt_pk_bf16_f32 v66, v108, v109
    v_cvt_pk_bf16_f32 v67, v110, v111
    v_mfma_f32_16x16x32_bf16 v[112:115], a[176:179], v[148:151], v[112:115]
    v_cndmask_b32 v66, v66, 0, s[82:83]
    v_cndmask_b32 v67, v67, 0, s[82:83]
    s_waitcnt lgkmcnt(8)
    v_mfma_f32_16x16x32_bf16 v[112:115], a[200:203], v[152:155], v[112:115]
    v_and_b32 v80, v26, v14
    v_and_b32 v81, v27, v15
    v_mfma_f32_16x16x32_bf16 v[112:115], a[224:227], v[156:159], v[112:115]
    v_and_b32 v82, v26, v16
    v_and_b32 v83, v27, v17
    s_waitcnt lgkmcnt(4)
    v_mfma_f32_16x16x32_bf16 v[112:115], a[248:251], v[160:163], v[112:115]
    v_mfma_f32_16x16x32_bf16 v[112:115], v[192:195], v[164:167], v[112:115]
    v_mfma_f32_16x16x32_bf16 v[72:75], v[32:35], v[80:83], 0
    s_waitcnt lgkmcnt(0)
    v_mfma_f32_16x16x32_bf16 v[112:115], v[216:219], v[168:171], v[112:115]
    v_mfma_f32_16x16x32_bf16 v[76:79], v[42:45], v[80:83], 0
    v_mfma_f32_16x16x32_bf16 v[112:115], v[240:243], v[172:175], v[112:115]
    s_add_u32 s53, s74, 65536
    v_mfma_f32_16x16x32_bf16 v[116:119], a[12:15], v[120:123], 0
    v_mfma_f32_16x16x32_bf16 v[116:119], a[36:39], v[124:127], v[116:119]
    v_mfma_f32_16x16x32_bf16 v[116:119], a[60:63], v[128:131], v[116:119]
    v_mfma_f32_16x16x32_bf16 v[116:119], a[84:87], v[132:135], v[116:119]
    v_mfma_f32_16x16x32_bf16 v[116:119], a[108:111], v[136:139], v[116:119]
    v_cvt_pk_bf16_f32 v84, v72, v73
    v_cvt_pk_bf16_f32 v85, v74, v75
    v_mfma_f32_16x16x32_bf16 v[116:119], a[132:135], v[140:143], v[116:119]
    v_cvt_pk_bf16_f32 v86, v76, v77
    v_cvt_pk_bf16_f32 v87, v78, v79
    v_mfma_f32_16x16x32_bf16 v[116:119], a[156:159], v[144:147], v[116:119]
    v_cvt_pk_bf16_f32 v56, v112, v113
    v_cvt_pk_bf16_f32 v57, v114, v115
    v_mfma_f32_16x16x32_bf16 v[116:119], a[180:183], v[148:151], v[116:119]
    buffer_store_dwordx4 v[84:87], v23, s[24:27], s53 offen sc1
    v_mfma_f32_16x16x32_bf16 v[116:119], a[204:207], v[152:155], v[116:119]
    v_cndmask_b32 v80, v84, v86, s[88:89]
    v_cndmask_b32 v81, v85, v87, s[88:89]
    v_mfma_f32_16x16x32_bf16 v[116:119], a[228:231], v[156:159], v[116:119]
    ds_write_b64 v95, v[80:81] offset:1024
    v_mfma_f32_16x16x32_bf16 v[116:119], a[252:255], v[160:163], v[116:119]
    v_mfma_f32_16x16x32_bf16 v[72:75], v[60:63], v[64:67], 0
    v_mfma_f32_16x16x32_bf16 v[116:119], v[196:199], v[164:167], v[116:119]
    v_mfma_f32_16x16x32_bf16 v[76:79], v[52:55], v[64:67], 0
    v_mfma_f32_16x16x32_bf16 v[116:119], v[220:223], v[168:171], v[116:119]
    ds_read_u16_d16_hi v8, v93 offset:16384
    ds_read_u16_d16_hi v9, v94 offset:16384
    v_mfma_f32_16x16x32_bf16 v[116:119], v[244:247], v[172:175], v[116:119]
    ds_read_u16_d16_hi v10, v92 offset:16384
    v_mfma_f32_16x16x32_bf16 v[96:99], v[120:123], a[16:19], 0
    v_mfma_f32_16x16x32_bf16 v[96:99], v[124:127], a[40:43], v[96:99]
    v_mfma_f32_16x16x32_bf16 v[96:99], v[128:131], a[64:67], v[96:99]
    v_mfma_f32_16x16x32_bf16 v[96:99], v[132:135], a[88:91], v[96:99]
    v_cndmask_b32 v26, v72, v73, s[76:77]
    v_cndmask_b32 v27, v74, v75, s[76:77]
    v_mfma_f32_16x16x32_bf16 v[96:99], v[136:139], a[112:115], v[96:99]
    v_cndmask_b32 v28, v76, v77, s[76:77]
    v_cndmask_b32 v29, v78, v79, s[76:77]
    v_mfma_f32_16x16x32_bf16 v[96:99], v[140:143], a[136:139], v[96:99]
    v_cndmask_b32 v26, v26, v28, s[78:79]
    v_cndmask_b32 v27, v27, v29, s[80:81]
    v_mfma_f32_16x16x32_bf16 v[96:99], v[144:147], a[160:163], v[96:99]
    v_cvt_pk_bf16_f32 v58, v116, v117
    v_cvt_pk_bf16_f32 v59, v118, v119
    v_mfma_f32_16x16x32_bf16 v[96:99], v[148:151], a[184:187], v[96:99]
    v_cndmask_b32 v58, v58, 0, s[82:83]
    v_cndmask_b32 v59, v59, 0, s[82:83]
    v_mfma_f32_16x16x32_bf16 v[96:99], v[152:155], a[208:211], v[96:99]
    s_waitcnt lgkmcnt(0)
    v_mul_f32 v26, v26, v8
    v_mfma_f32_16x16x32_bf16 v[96:99], v[156:159], a[232:235], v[96:99]
    v_mul_f32 v27, v27, v9
    v_mul_f32 v11, s91, v10
    v_mfma_f32_16x16x32_bf16 v[96:99], v[160:163], v[176:179], v[96:99]
    v_max_f32 v28, v26, v27
    v_mov_b32 v29, v28
    v_mfma_f32_16x16x32_bf16 v[96:99], v[164:167], v[200:203], v[96:99]
    v_mfma_f32_16x16x32_bf16 v[96:99], v[168:171], v[224:227], v[96:99]
    v_permlane16_swap_b32 v28, v29
    v_max_f32 v28, v28, v29
    v_mfma_f32_16x16x32_bf16 v[96:99], v[172:175], v[248:251], v[96:99]
    v_mov_b32 v29, v28
    v_mfma_f32_16x16x32_bf16 v[100:103], v[120:123], a[20:23], 0
    v_mfma_f32_16x16x32_bf16 v[100:103], v[124:127], a[44:47], v[100:103]
    v_permlane32_swap_b32 v28, v29
    v_max_f32 v28, v28, v29
    v_mfma_f32_16x16x32_bf16 v[100:103], v[128:131], a[68:71], v[100:103]
    v_sub_f32 v26, v26, v28
    v_sub_f32 v27, v27, v28
    v_mfma_f32_16x16x32_bf16 v[100:103], v[132:135], a[92:95], v[100:103]
    v_mul_f32 v26, v11, v26
    v_mul_f32 v27, v11, v27
    v_mfma_f32_16x16x32_bf16 v[100:103], v[136:139], a[116:119], v[100:103]
    v_exp_f32 v26, v26
    v_mfma_f32_16x16x32_bf16 v[100:103], v[140:143], a[140:143], v[100:103]
    v_exp_f32 v27, v27
    v_mfma_f32_16x16x32_bf16 v[100:103], v[144:147], a[164:167], v[100:103]
    v_cvt_pk_bf16_f32 v38, v96, v97
    v_cvt_pk_bf16_f32 v39, v98, v99
    v_mfma_f32_16x16x32_bf16 v[100:103], v[148:151], a[188:191], v[100:103]
    v_add_f32 v28, v26, v27
    v_mov_b32 v29, v28
    v_mfma_f32_16x16x32_bf16 v[100:103], v[152:155], a[212:215], v[100:103]
    v_mfma_f32_16x16x32_bf16 v[100:103], v[156:159], a[236:239], v[100:103]
    v_permlane16_swap_b32 v28, v29
    v_add_f32 v28, v28, v29
    v_mfma_f32_16x16x32_bf16 v[100:103], v[160:163], v[180:183], v[100:103]
    v_mov_b32 v29, v28
    v_mfma_f32_16x16x32_bf16 v[100:103], v[164:167], v[204:207], v[100:103]
    v_mfma_f32_16x16x32_bf16 v[100:103], v[168:171], v[228:231], v[100:103]
    v_permlane32_swap_b32 v28, v29
    v_add_f32 v28, v28, v29
    v_mfma_f32_16x16x32_bf16 v[100:103], v[172:175], v[252:255], v[100:103]
    v_rcp_f32 v28, v28
    v_mfma_f32_16x16x32_bf16 v[104:107], a[0:3], v[120:123], 0
    v_mul_f32 v26, v26, v8
    v_mul_f32 v27, v27, v9
    v_mfma_f32_16x16x32_bf16 v[104:107], a[24:27], v[124:127], v[104:107]
    v_mul_f32 v26, v26, v28
    v_mul_f32 v27, v27, v28
    v_mfma_f32_16x16x32_bf16 v[104:107], a[48:51], v[128:131], v[104:107]
    v_cvt_pk_bf16_f32 v26, v26, v26
    v_cvt_pk_bf16_f32 v27, v27, v27
    v_mfma_f32_16x16x32_bf16 v[104:107], a[72:75], v[132:135], v[104:107]
    v_and_b32 v80, v26, v14
    v_and_b32 v81, v27, v15
    v_mfma_f32_16x16x32_bf16 v[104:107], a[96:99], v[136:139], v[104:107]
    v_and_b32 v82, v26, v16
    v_and_b32 v83, v27, v17
    v_mfma_f32_16x16x32_bf16 v[104:107], a[120:123], v[140:143], v[104:107]
    v_mfma_f32_16x16x32_bf16 v[104:107], a[144:147], v[144:147], v[104:107]
    v_cvt_pk_bf16_f32 v48, v100, v101
    v_cvt_pk_bf16_f32 v49, v102, v103
    v_mfma_f32_16x16x32_bf16 v[104:107], a[168:171], v[148:151], v[104:107]
    v_mfma_f32_16x16x32_bf16 v[72:75], v[34:37], v[80:83], 0
    v_mfma_f32_16x16x32_bf16 v[104:107], a[192:195], v[152:155], v[104:107]
    v_mfma_f32_16x16x32_bf16 v[76:79], v[44:47], v[80:83], 0
    v_mfma_f32_16x16x32_bf16 v[104:107], a[216:219], v[156:159], v[104:107]
    s_add_u32 s53, s74, 81920
    v_mfma_f32_16x16x32_bf16 v[104:107], a[240:243], v[160:163], v[104:107]
    v_mfma_f32_16x16x32_bf16 v[104:107], v[184:187], v[164:167], v[104:107]
    v_mfma_f32_16x16x32_bf16 v[104:107], v[208:211], v[168:171], v[104:107]
    v_mfma_f32_16x16x32_bf16 v[104:107], v[232:235], v[172:175], v[104:107]
    v_mfma_f32_16x16x32_bf16 v[108:111], a[4:7], v[120:123], 0
    v_add_u32 v4, 65536, v4
    v_add_u32 v25, 65536, v25
    ds_read_b64_tr_b16 v[120:121], v4 offset:0
    ds_read_b64_tr_b16 v[122:123], v25 offset:0
    v_mfma_f32_16x16x32_bf16 v[108:111], a[28:31], v[124:127], v[108:111]
    ds_read_b64_tr_b16 v[124:125], v4 offset:1024
    v_cvt_pk_bf16_f32 v84, v72, v73
    v_mfma_f32_16x16x32_bf16 v[108:111], a[52:55], v[128:131], v[108:111]
    ds_read_b64_tr_b16 v[126:127], v25 offset:1024
    ds_read_b64_tr_b16 v[128:129], v4 offset:2048
    v_mfma_f32_16x16x32_bf16 v[108:111], a[76:79], v[132:135], v[108:111]
    ds_read_b64_tr_b16 v[130:131], v25 offset:2048
    v_cvt_pk_bf16_f32 v85, v74, v75
    v_mfma_f32_16x16x32_bf16 v[108:111], a[100:103], v[136:139], v[108:111]
    ds_read_b64_tr_b16 v[132:133], v4 offset:3072
    v_cvt_pk_bf16_f32 v86, v76, v77
    v_mfma_f32_16x16x32_bf16 v[108:111], a[124:127], v[140:143], v[108:111]
    ds_read_b64_tr_b16 v[134:135], v25 offset:3072
    ds_read_b64_tr_b16 v[136:137], v4 offset:4096
    v_mfma_f32_16x16x32_bf16 v[108:111], a[148:151], v[144:147], v[108:111]
    ds_read_b64_tr_b16 v[138:139], v25 offset:4096
    v_cvt_pk_bf16_f32 v68, v104, v105
    v_mfma_f32_16x16x32_bf16 v[108:111], a[172:175], v[148:151], v[108:111]
    ds_read_b64_tr_b16 v[140:141], v4 offset:5120
    ds_read_b64_tr_b16 v[142:143], v25 offset:5120
    v_mfma_f32_16x16x32_bf16 v[108:111], a[196:199], v[152:155], v[108:111]
    ds_read_b64_tr_b16 v[144:145], v4 offset:6144
    v_cvt_pk_bf16_f32 v69, v106, v107
    v_mfma_f32_16x16x32_bf16 v[108:111], a[220:223], v[156:159], v[108:111]
    ds_read_b64_tr_b16 v[146:147], v25 offset:6144
    v_cvt_pk_bf16_f32 v87, v78, v79
    v_mfma_f32_16x16x32_bf16 v[108:111], a[244:247], v[160:163], v[108:111]
    ds_read_b64_tr_b16 v[148:149], v4 offset:7168
    ds_read_b64_tr_b16 v[150:151], v25 offset:7168
    v_mfma_f32_16x16x32_bf16 v[108:111], v[188:191], v[164:167], v[108:111]
    ds_read_b64_tr_b16 v[152:153], v4 offset:8192
    buffer_store_dwordx4 v[84:87], v23, s[24:27], s53 offen sc1
    v_mfma_f32_16x16x32_bf16 v[108:111], v[212:215], v[168:171], v[108:111]
    ds_read_b64_tr_b16 v[154:155], v25 offset:8192
    ds_read_b64_tr_b16 v[156:157], v4 offset:9216
    v_mfma_f32_16x16x32_bf16 v[108:111], v[236:239], v[172:175], v[108:111]
    ds_read_b64_tr_b16 v[158:159], v25 offset:9216
    v_cndmask_b32 v80, v84, v86, s[88:89]
    s_waitcnt lgkmcnt(15)
    v_mfma_f32_16x16x32_bf16 v[112:115], a[0:3], v[120:123], 0
    ds_read_b64_tr_b16 v[160:161], v4 offset:10240
    v_cndmask_b32 v81, v85, v87, s[88:89]
    v_mfma_f32_16x16x32_bf16 v[112:115], a[24:27], v[124:127], v[112:115]
    ds_read_b64_tr_b16 v[162:163], v25 offset:10240
    ds_read_b64_tr_b16 v[164:165], v4 offset:11264
    s_waitcnt lgkmcnt(15)
    v_mfma_f32_16x16x32_bf16 v[112:115], a[48:51], v[128:131], v[112:115]
    ds_read_b64_tr_b16 v[166:167], v25 offset:11264
    ds_write_b64 v95, v[80:81] offset:1280
    v_mfma_f32_16x16x32_bf16 v[112:115], a[72:75], v[132:135], v[112:115]
    ds_read_b64_tr_b16 v[168:169], v4 offset:12288
    s_waitcnt lgkmcnt(14)
    v_mfma_f32_16x16x32_bf16 v[112:115], a[96:99], v[136:139], v[112:115]
    ds_read_b64_tr_b16 v[170:171], v25 offset:12288
    ds_read_b64_tr_b16 v[172:173], v4 offset:13312
    v_mfma_f32_16x16x32_bf16 v[112:115], a[120:123], v[140:143], v[112:115]
    ds_read_b64_tr_b16 v[174:175], v25 offset:13312
    s_waitcnt lgkmcnt(13)
    v_mfma_f32_16x16x32_bf16 v[112:115], a[144:147], v[144:147], v[112:115]
    v_cvt_pk_bf16_f32 v70, v108, v109
    v_cvt_pk_bf16_f32 v71, v110, v111
    v_mfma_f32_16x16x32_bf16 v[112:115], a[168:171], v[148:151], v[112:115]
    v_cndmask_b32 v70, v70, 0, s[82:83]
    v_cndmask_b32 v71, v71, 0, s[82:83]
    s_waitcnt lgkmcnt(9)
    v_mfma_f32_16x16x32_bf16 v[112:115], a[192:195], v[152:155], v[112:115]
    v_mfma_f32_16x16x32_bf16 v[112:115], a[216:219], v[156:159], v[112:115]
    v_mfma_f32_16x16x32_bf16 v[72:75], v[52:55], v[68:71], 0
    s_waitcnt lgkmcnt(5)
    v_mfma_f32_16x16x32_bf16 v[112:115], a[240:243], v[160:163], v[112:115]
    v_mfma_f32_16x16x32_bf16 v[76:79], v[56:59], v[68:71], 0
    v_mfma_f32_16x16x32_bf16 v[112:115], v[184:187], v[164:167], v[112:115]
    ds_read_u16_d16_hi v8, v93 offset:32768
    ds_read_u16_d16_hi v9, v94 offset:32768
    s_waitcnt lgkmcnt(2)
    v_mfma_f32_16x16x32_bf16 v[112:115], v[208:211], v[168:171], v[112:115]
    ds_read_u16_d16_hi v10, v92 offset:32768
    v_mfma_f32_16x16x32_bf16 v[112:115], v[232:235], v[172:175], v[112:115]
    v_mfma_f32_16x16x32_bf16 v[116:119], a[4:7], v[120:123], 0
    v_mfma_f32_16x16x32_bf16 v[116:119], a[28:31], v[124:127], v[116:119]
    v_mfma_f32_16x16x32_bf16 v[116:119], a[52:55], v[128:131], v[116:119]
    v_cndmask_b32 v26, v72, v73, s[76:77]
    v_cndmask_b32 v27, v74, v75, s[76:77]
    v_mfma_f32_16x16x32_bf16 v[116:119], a[76:79], v[132:135], v[116:119]
    v_cndmask_b32 v28, v76, v77, s[76:77]
    v_cndmask_b32 v29, v78, v79, s[76:77]
    v_mfma_f32_16x16x32_bf16 v[116:119], a[100:103], v[136:139], v[116:119]
    v_cndmask_b32 v26, v26, v28, s[78:79]
    v_cndmask_b32 v27, v27, v29, s[80:81]
    v_mfma_f32_16x16x32_bf16 v[116:119], a[124:127], v[140:143], v[116:119]
    s_waitcnt lgkmcnt(0)
    v_mul_f32 v26, v26, v8
    v_mfma_f32_16x16x32_bf16 v[116:119], a[148:151], v[144:147], v[116:119]
    v_cvt_pk_bf16_f32 v64, v112, v113
    v_cvt_pk_bf16_f32 v65, v114, v115
    v_mfma_f32_16x16x32_bf16 v[116:119], a[172:175], v[148:151], v[116:119]
    v_mul_f32 v27, v27, v9
    v_mul_f32 v11, s91, v10
    v_mfma_f32_16x16x32_bf16 v[116:119], a[196:199], v[152:155], v[116:119]
    v_max_f32 v28, v26, v27
    v_mov_b32 v29, v28
    v_mfma_f32_16x16x32_bf16 v[116:119], a[220:223], v[156:159], v[116:119]
    v_mfma_f32_16x16x32_bf16 v[116:119], a[244:247], v[160:163], v[116:119]
    v_permlane16_swap_b32 v28, v29
    v_max_f32 v28, v28, v29
    v_mfma_f32_16x16x32_bf16 v[116:119], v[188:191], v[164:167], v[116:119]
    v_mov_b32 v29, v28
    v_mfma_f32_16x16x32_bf16 v[116:119], v[212:215], v[168:171], v[116:119]
    v_mfma_f32_16x16x32_bf16 v[116:119], v[236:239], v[172:175], v[116:119]
    v_permlane32_swap_b32 v28, v29
    v_max_f32 v28, v28, v29
    v_mfma_f32_16x16x32_bf16 v[96:99], a[8:11], v[120:123], 0
    v_sub_f32 v26, v26, v28
    v_sub_f32 v27, v27, v28
    v_mfma_f32_16x16x32_bf16 v[96:99], a[32:35], v[124:127], v[96:99]
    v_mul_f32 v26, v11, v26
    v_mul_f32 v27, v11, v27
    v_mfma_f32_16x16x32_bf16 v[96:99], a[56:59], v[128:131], v[96:99]
    v_exp_f32 v26, v26
    v_mfma_f32_16x16x32_bf16 v[96:99], a[80:83], v[132:135], v[96:99]
    v_exp_f32 v27, v27
    v_mfma_f32_16x16x32_bf16 v[96:99], a[104:107], v[136:139], v[96:99]
    v_add_f32 v28, v26, v27
    v_mov_b32 v29, v28
    v_mfma_f32_16x16x32_bf16 v[96:99], a[128:131], v[140:143], v[96:99]
    v_mfma_f32_16x16x32_bf16 v[96:99], a[152:155], v[144:147], v[96:99]
    v_cvt_pk_bf16_f32 v66, v116, v117
    v_cvt_pk_bf16_f32 v67, v118, v119
    v_mfma_f32_16x16x32_bf16 v[96:99], a[176:179], v[148:151], v[96:99]
    v_cndmask_b32 v66, v66, 0, s[82:83]
    v_cndmask_b32 v67, v67, 0, s[82:83]
    v_mfma_f32_16x16x32_bf16 v[96:99], a[200:203], v[152:155], v[96:99]
    v_permlane16_swap_b32 v28, v29
    v_add_f32 v28, v28, v29
    v_mfma_f32_16x16x32_bf16 v[96:99], a[224:227], v[156:159], v[96:99]
    v_mov_b32 v29, v28
    v_mfma_f32_16x16x32_bf16 v[96:99], a[248:251], v[160:163], v[96:99]
    v_mfma_f32_16x16x32_bf16 v[96:99], v[192:195], v[164:167], v[96:99]
    v_permlane32_swap_b32 v28, v29
    v_add_f32 v28, v28, v29
    v_mfma_f32_16x16x32_bf16 v[96:99], v[216:219], v[168:171], v[96:99]
    v_rcp_f32 v28, v28
    v_mfma_f32_16x16x32_bf16 v[96:99], v[240:243], v[172:175], v[96:99]
    v_mul_f32 v26, v26, v8
    v_mul_f32 v27, v27, v9
    v_mfma_f32_16x16x32_bf16 v[100:103], a[12:15], v[120:123], 0
    v_mul_f32 v26, v26, v28
    v_mul_f32 v27, v27, v28
    v_mfma_f32_16x16x32_bf16 v[100:103], a[36:39], v[124:127], v[100:103]
    v_cvt_pk_bf16_f32 v26, v26, v26
    v_cvt_pk_bf16_f32 v27, v27, v27
    v_mfma_f32_16x16x32_bf16 v[100:103], a[60:63], v[128:131], v[100:103]
    v_and_b32 v80, v26, v14
    v_and_b32 v81, v27, v15
    v_mfma_f32_16x16x32_bf16 v[100:103], a[84:87], v[132:135], v[100:103]
    v_and_b32 v82, v26, v16
    v_and_b32 v83, v27, v17
    v_mfma_f32_16x16x32_bf16 v[100:103], a[108:111], v[136:139], v[100:103]
    v_mfma_f32_16x16x32_bf16 v[100:103], a[132:135], v[140:143], v[100:103]
    v_mfma_f32_16x16x32_bf16 v[72:75], v[36:39], v[80:83], 0
    v_mfma_f32_16x16x32_bf16 v[100:103], a[156:159], v[144:147], v[100:103]
    v_cvt_pk_bf16_f32 v60, v96, v97
    v_cvt_pk_bf16_f32 v61, v98, v99
    v_mfma_f32_16x16x32_bf16 v[100:103], a[180:183], v[148:151], v[100:103]
    v_mfma_f32_16x16x32_bf16 v[76:79], v[46:49], v[80:83], 0
    v_mfma_f32_16x16x32_bf16 v[100:103], a[204:207], v[152:155], v[100:103]
    s_add_u32 s53, s74, 98304
    v_mfma_f32_16x16x32_bf16 v[100:103], a[228:231], v[156:159], v[100:103]
    v_mfma_f32_16x16x32_bf16 v[100:103], a[252:255], v[160:163], v[100:103]
    v_mfma_f32_16x16x32_bf16 v[100:103], v[196:199], v[164:167], v[100:103]
    v_mfma_f32_16x16x32_bf16 v[100:103], v[220:223], v[168:171], v[100:103]
    v_mfma_f32_16x16x32_bf16 v[100:103], v[244:247], v[172:175], v[100:103]
    v_cvt_pk_bf16_f32 v84, v72, v73
    v_cvt_pk_bf16_f32 v85, v74, v75
    v_mfma_f32_16x16x32_bf16 v[104:107], v[120:123], a[16:19], 0
    v_cvt_pk_bf16_f32 v86, v76, v77
    v_cvt_pk_bf16_f32 v87, v78, v79
    v_mfma_f32_16x16x32_bf16 v[104:107], v[124:127], a[40:43], v[104:107]
    buffer_store_dwordx4 v[84:87], v23, s[24:27], s53 offen sc1
    v_mfma_f32_16x16x32_bf16 v[104:107], v[128:131], a[64:67], v[104:107]
    v_cndmask_b32 v80, v84, v86, s[88:89]
    v_cndmask_b32 v81, v85, v87, s[88:89]
    v_mfma_f32_16x16x32_bf16 v[104:107], v[132:135], a[88:91], v[104:107]
    ds_write_b64 v95, v[80:81] offset:1536
    v_mfma_f32_16x16x32_bf16 v[104:107], v[136:139], a[112:115], v[104:107]
    v_mfma_f32_16x16x32_bf16 v[104:107], v[140:143], a[136:139], v[104:107]
    v_mfma_f32_16x16x32_bf16 v[104:107], v[144:147], a[160:163], v[104:107]
    v_cvt_pk_bf16_f32 v62, v100, v101
    v_cvt_pk_bf16_f32 v63, v102, v103
    v_mfma_f32_16x16x32_bf16 v[104:107], v[148:151], a[184:187], v[104:107]
    v_cndmask_b32 v62, v62, 0, s[82:83]
    v_cndmask_b32 v63, v63, 0, s[82:83]
    v_mfma_f32_16x16x32_bf16 v[104:107], v[152:155], a[208:211], v[104:107]
    v_mfma_f32_16x16x32_bf16 v[104:107], v[156:159], a[232:235], v[104:107]
    v_mfma_f32_16x16x32_bf16 v[72:75], v[56:59], v[64:67], 0
    v_mfma_f32_16x16x32_bf16 v[104:107], v[160:163], v[176:179], v[104:107]
    v_mfma_f32_16x16x32_bf16 v[76:79], v[60:63], v[64:67], 0
    v_mfma_f32_16x16x32_bf16 v[104:107], v[164:167], v[200:203], v[104:107]
    ds_read_u16_d16_hi v8, v93 offset:49152
    ds_read_u16_d16_hi v9, v94 offset:49152
    v_mfma_f32_16x16x32_bf16 v[104:107], v[168:171], v[224:227], v[104:107]
    ds_read_u16_d16_hi v10, v92 offset:49152
    v_mfma_f32_16x16x32_bf16 v[104:107], v[172:175], v[248:251], v[104:107]
    v_mfma_f32_16x16x32_bf16 v[108:111], v[120:123], a[20:23], 0
    v_mfma_f32_16x16x32_bf16 v[108:111], v[124:127], a[44:47], v[108:111]
    v_mfma_f32_16x16x32_bf16 v[108:111], v[128:131], a[68:71], v[108:111]
    v_cndmask_b32 v26, v72, v73, s[76:77]
    v_cndmask_b32 v27, v74, v75, s[76:77]
    v_mfma_f32_16x16x32_bf16 v[108:111], v[132:135], a[92:95], v[108:111]
    v_cndmask_b32 v28, v76, v77, s[76:77]
    v_cndmask_b32 v29, v78, v79, s[76:77]
    v_mfma_f32_16x16x32_bf16 v[108:111], v[136:139], a[116:119], v[108:111]
    v_cndmask_b32 v26, v26, v28, s[78:79]
    v_cndmask_b32 v27, v27, v29, s[80:81]
    v_mfma_f32_16x16x32_bf16 v[108:111], v[140:143], a[140:143], v[108:111]
    s_waitcnt lgkmcnt(0)
    v_mul_f32 v26, v26, v8
    v_mfma_f32_16x16x32_bf16 v[108:111], v[144:147], a[164:167], v[108:111]
    v_cvt_pk_bf16_f32 v40, v104, v105
    v_cvt_pk_bf16_f32 v41, v106, v107
    v_mfma_f32_16x16x32_bf16 v[108:111], v[148:151], a[188:191], v[108:111]
    v_mul_f32 v27, v27, v9
    v_mul_f32 v11, s91, v10
    v_mfma_f32_16x16x32_bf16 v[108:111], v[152:155], a[212:215], v[108:111]
    v_max_f32 v28, v26, v27
    v_mov_b32 v29, v28
    v_mfma_f32_16x16x32_bf16 v[108:111], v[156:159], a[236:239], v[108:111]
    v_mfma_f32_16x16x32_bf16 v[108:111], v[160:163], v[180:183], v[108:111]
    v_permlane16_swap_b32 v28, v29
    v_max_f32 v28, v28, v29
    v_mfma_f32_16x16x32_bf16 v[108:111], v[164:167], v[204:207], v[108:111]
    v_mov_b32 v29, v28
    v_mfma_f32_16x16x32_bf16 v[108:111], v[168:171], v[228:231], v[108:111]
    v_mfma_f32_16x16x32_bf16 v[108:111], v[172:175], v[252:255], v[108:111]
    v_permlane32_swap_b32 v28, v29
    v_max_f32 v28, v28, v29
    s_nop 5
    v_cvt_pk_bf16_f32 v50, v108, v109
    v_cvt_pk_bf16_f32 v51, v110, v111
    v_sub_f32 v26, v26, v28
    v_sub_f32 v27, v27, v28
    v_mul_f32 v26, v11, v26
    v_mul_f32 v27, v11, v27
    v_exp_f32 v26, v26
    v_exp_f32 v27, v27
    s_nop 0
    v_add_f32 v28, v26, v27
    v_mov_b32 v29, v28
    s_nop 1
    v_permlane16_swap_b32 v28, v29
    v_add_f32 v28, v28, v29
    v_mov_b32 v29, v28
    s_nop 1
    v_permlane32_swap_b32 v28, v29
    v_add_f32 v28, v28, v29
    v_rcp_f32 v28, v28
    v_mul_f32 v26, v26, v8
    v_mul_f32 v27, v27, v9
    v_mul_f32 v26, v26, v28
    v_mul_f32 v27, v27, v28
    v_cvt_pk_bf16_f32 v26, v26, v26
    v_cvt_pk_bf16_f32 v27, v27, v27
    v_and_b32 v80, v26, v14
    v_and_b32 v81, v27, v15
    v_and_b32 v82, v26, v16
    v_and_b32 v83, v27, v17
    s_nop 1
    v_mfma_f32_16x16x32_bf16 v[72:75], v[38:41], v[80:83], 0
    v_mfma_f32_16x16x32_bf16 v[76:79], v[48:51], v[80:83], 0
    s_add_u32 s53, s74, 114688
    s_nop 5
    v_cvt_pk_bf16_f32 v84, v72, v73
    v_cvt_pk_bf16_f32 v85, v74, v75
    v_cvt_pk_bf16_f32 v86, v76, v77
    v_cvt_pk_bf16_f32 v87, v78, v79
    buffer_store_dwordx4 v[84:87], v23, s[24:27], s53 offen sc1
    v_cndmask_b32 v80, v84, v86, s[88:89]
    v_cndmask_b32 v81, v85, v87, s[88:89]
    ds_write_b64 v95, v[80:81] offset:1792
    v_lshlrev_b32 v6, 4, v0
    v_add_u32 v6, 147456, v6
    v_lshrrev_b32 v7, 4, v1
    v_and_b32 v12, 15, v1
    v_lshlrev_b32 v7, 14, v7
    v_lshl_add_u32 v7, v12, 4, v7
    s_waitcnt lgkmcnt(0)
    s_barrier
    ds_read_b128 v[72:75], v6
    s_waitcnt lgkmcnt(0)
    buffer_store_dwordx4 v[72:75], v7, s[24:27], s95 offen sc1
    s_waitcnt vmcnt(0) lgkmcnt(0)
    s_barrier
L_wa_4:
    s_cbranch_execz L_wa_ret
    s_cmp_lg_u32 s44, 0
    s_cbranch_scc1 L_nopub19
    s_lshl_b32 s60, s48, 4
    s_add_u32 s60, s60, s49
    s_lshl_b32 s60, s60, 7
    s_add_u32 s60, s60, 12779520
    v_mov_b32 v30, s47
    s_mov_b64 exec, 1
    buffer_store_dword v30, off, s[24:27], s60 sc1
    s_mov_b64 exec, -1
L_nopub19:
    s_endpgm
L_codeend:
.section .rodata,"a"
.p2align 6
.amdhsa_kernel parallel_sum__sliding_local_dilated__mixer_token_mlp__prompt_kernel
  .amdhsa_next_free_vgpr 512
  .amdhsa_next_free_sgpr 102
  .amdhsa_accum_offset 256
  .amdhsa_group_segment_fixed_size 0
  .amdhsa_kernarg_size 88
  .amdhsa_user_sgpr_count 2
  .amdhsa_user_sgpr_kernarg_segment_ptr 1
  .amdhsa_system_sgpr_workgroup_id_x 1
  .amdhsa_float_denorm_mode_32 3
.end_amdhsa_kernel
```

```asm
; @launch grid=(256,1,1) block=(256,1,1) lds=163840
.amdgcn_target "amdgcn-amd-amdhsa--gfx950"
.text
.globl parallel_sum__sliding_local_dilated__mixer_token_mlp__prompt_kernel
.p2align 8
.type parallel_sum__sliding_local_dilated__mixer_token_mlp__prompt_kernel,@function
parallel_sum__sliding_local_dilated__mixer_token_mlp__prompt_kernel:
    s_cmp_ge_u32 s2, 256
    s_cbranch_scc1 L_end
    s_load_dwordx2 s[4:5], s[0:1], 0
    s_load_dwordx16 s[76:91], s[0:1], 0
    s_load_dwordx4 s[92:95], s[0:1], 64
    s_load_dwordx2 s[24:25], s[0:1], 80
    s_lshr_b32 s46, s2, 3
    s_getpc_b64 s[98:99]
L_pc:
    s_mul_i32 s53, s46, 1536
    v_lshrrev_b32 v26, 4, v0
    v_min_u32 v26, 11, v26
    v_lshl_add_u32 v26, v26, 7, s53
    v_lshrrev_b32 v25, 5, v0
    v_min_u32 v26, L_codeend-L_pc-4, v26
    v_mov_b32 v29, s99
    v_add_co_u32 v28, vcc, s98, v26
    s_nop 1
    v_addc_co_u32 v29, vcc, 0, v29, vcc
    global_load_dword v108, v[28:29], off
    v_and_b32 v26, 31, v0
    v_mul_u32_u24 v24, 896, v25
    v_lshl_add_u32 v24, v26, 4, v24
    s_mul_i32 s53, s2, 7168
    v_add_u32 v24, s53, v24
    v_cmp_gt_u32 vcc, 24, v26
    v_mov_b32 v27, 2130706432
    s_mov_b32 s6, 1835008
    s_mov_b32 s7, 0x20000
    v_cndmask_b32 v22, v27, v24, vcc
    v_lshrrev_b32 v27, 6, v0
    v_and_b32 v1, 63, v0
    s_waitcnt lgkmcnt(0)
    buffer_load_dwordx4 v[32:35], v24, s[4:7], 0 offen
    buffer_load_dwordx4 v[36:39], v22, s[4:7], 0 offen offset:512
    v_readfirstlane_b32 s44, v27
    s_and_b32 s45, s2, 7
    s_mov_b64 s[8:9], s[78:79]
    s_mov_b32 s10, 1204224
    s_mov_b32 s11, s7
    s_and_b32 s53, s45, 6
    s_lshr_b32 s53, 0xc9, s53
    s_and_b32 s53, s53, 3
    s_add_u32 s54, s53, 1
    s_bfe_u32 s54, s54, 0x10001
    s_add_u32 s54, s54, 1
    s_mul_i32 s53, s53, 224
    s_andn2_b32 s53, s53, 127
    s_sub_u32 s55, s46, 3
    s_cmp_lt_u32 s46, 24
    s_cselect_b32 s55, 63, s55
    s_cmp_lt_u32 s46, 21
    s_cselect_b32 s55, s46, s55
    s_mul_i32 s55, s55, 43008
    s_add_u32 s53, s53, s55
    v_and_b32 v27, 3, v0
    v_min_u32 v27, s54, v27
    v_bfe_u32 v28, v0, 2, 2
    v_med3_u32 v28, v28, 1, 1
    v_mul_u32_u24 v28, 7, v28
    v_add_u32 v27, v27, v28
    v_lshrrev_b32 v28, 4, v0
    v_min_u32 v28, 15, v28
    v_mul_u32_u24 v28, 21, v28
    v_add_lshl_u32 v27, v27, v28, 7
    buffer_load_dword v108, v27, s[8:11], s53 offen
    s_mov_b64 s[40:41], s[94:95]
    s_mov_b32 s42, 256
    s_mov_b32 s43, s7
    s_or_b32 s53, s2, s44
    s_cbranch_scc1 L_nononce
    s_memrealtime s[98:99]
    s_waitcnt lgkmcnt(0)
    s_or_b32 s98, s98, 1
    v_mov_b32 v28, s98
    s_mov_b64 exec, 1
    buffer_store_dword v28, off, s[40:43], 0 sc1
    s_mov_b64 exec, -1
L_nononce:
    s_mov_b64 s[16:17], s[84:85]
    s_mov_b32 s18, 7340032
    s_mov_b32 s19, s7
    s_mov_b32 s26, 16777216
    s_mov_b32 s27, s7
    s_mov_b64 s[20:21], s[88:89]
    s_mov_b32 s22, 7340032
    s_mov_b32 s23, s7
    s_mov_b64 s[12:13], s[80:81]
    s_mov_b32 s14, 401408
    s_mov_b32 s15, s7
    s_mov_b64 s[28:29], s[92:93]
    s_mov_b32 s30, 1835008
    s_mov_b32 s31, s7
    s_mov_b64 s[32:33], s[86:87]
    s_mov_b32 s34, 3584
    s_mov_b32 s35, s7
    s_mov_b64 s[36:37], s[90:91]
    s_mov_b32 s38, 4096
    s_mov_b32 s39, s7
    s_lshl_b32 s52, s44, 12
    v_lshlrev_b32 v23, 4, v1
    s_cmp_ge_u32 s46, 24
    s_cbranch_scc1 L_role_a
    v_lshrrev_b32 v208, 4, v1
    v_bfe_u32 v209, v1, 2, 2
    v_and_b32 v210, 3, v1
    v_and_b32 v211, 15, v1
    v_lshrrev_b32 v212, 5, v1
    s_mul_i32 s55, s45, 3
    s_max_u32 s55, s55, 1
    s_add_u32 s55, s55, s46
    s_sub_u32 s55, s55, 1
    s_sub_u32 s56, s55, 21
    s_min_u32 s55, s55, s56
    s_and_b32 s54, s45, 1
    s_mul_i32 s54, s54, 24
    s_sub_u32 s54, s46, s54
    s_cmp_ge_u32 s46, 21
    s_cselect_b32 s54, s54, s55
    s_mul_i32 s53, s45, 21
    s_add_u32 s53, s53, s54
    s_mul_i32 s50, s53, 171
    s_lshr_b32 s50, s50, 10
    s_mul_i32 s54, s50, 6
    s_sub_u32 s88, s53, s54
    s_mul_i32 s51, s50, 2
    s_add_u32 s51, s51, s88
    s_mul_i32 s54, s51, 43
    s_lshr_b32 s54, s54, 8
    s_mul_i32 s54, s54, 6
    s_sub_u32 s51, s51, s54
    s_mul_i32 s65, s51, 16
    s_add_u32 s65, s65, 2
    s_mul_i32 s65, s65, 171
    s_lshr_b32 s65, s65, 10
    v_lshl_add_u32 v213, v212, 2, v209
    v_and_b32 v215, 1, v208
    v_lshlrev_b32 v214, 4, v210
    v_lshl_add_u32 v214, v215, 6, v214
    s_mul_i32 s53, s44, 1835008
    s_lshl_b32 s54, s50, 7
    s_add_u32 s53, s53, s54
    v_mul_u32_u24 v10, 3584, v213
    v_add3_u32 v10, v10, v214, s53
    v_xor_b32 v11, 32, v10
    v_lshl_add_u32 v19, v208, 3, s54
    s_cmp_ge_u32 s46, 21
    s_cbranch_scc1 L_help
    buffer_load_dwordx2 v[224:225], v19, s[32:35], 0 offen offset:0
    buffer_load_dwordx2 v[226:227], v19, s[32:35], 0 offen offset:32
    buffer_load_dwordx2 v[228:229], v19, s[32:35], 0 offen offset:64
    buffer_load_dwordx2 v[230:231], v19, s[32:35], 0 offen offset:96
    s_add_u32 m0, s52, 49152
    s_add_u32 s57, s65, 0
    s_sub_u32 s3, s57, 16
    s_min_u32 s57, s57, s3
    s_mul_i32 s57, s57, 114688
    buffer_load_dwordx4 v10, s[16:19], s57 offen offset:0 lds
    s_add_u32 s57, s57, 27648
    buffer_load_dwordx4 v11, s[16:19], s57 offen offset:1024 lds
    s_add_u32 s57, s57, 27648
    buffer_load_dwordx4 v10, s[16:19], s57 offen offset:2048 lds
    s_add_u32 s57, s57, 27648
    buffer_load_dwordx4 v11, s[16:19], s57 offen offset:3072 lds
    s_add_u32 m0, s52, 65536
    s_add_u32 s57, s65, 1
    s_sub_u32 s3, s57, 16
    s_min_u32 s57, s57, s3
    s_mul_i32 s57, s57, 114688
    buffer_load_dwordx4 v10, s[16:19], s57 offen offset:0 lds
    v_mul_u32_u24 v109, 1088, v25
    v_lshl_add_u32 v109, v26, 4, v109
    v_mul_u32_u24 v110, 1088, v209
    v_lshl_add_u32 v110, v208, 5, v110
    v_lshl_add_u32 v110, v210, 3, v110
    s_lshl_b32 s53, s44, 7
    v_add_u32 v110, s53, v110
    v_mul_u32_u24 v111, 66816, v208
    v_lshl_add_u32 v111, v211, 4, v111
    s_mul_i32 s63, s44, 267264
    s_lshl_b32 s53, s2, 8
    s_add_u32 s63, s63, s53
    s_add_u32 s64, s63, 1069056
    v_cmp_gt_u32 vcc, 208, v0
    v_mov_b32 v100, 2130706432
    v_cmp_le_u32 s[92:93], 24, v26
    v_cndmask_b32 v22, v100, v111, vcc
    s_mov_b32 s62, 0x3f803f80
    s_mov_b32 s61, 0xffff0000
    v_mov_b32 v96, 0
    v_mov_b32 v97, 0
    v_lshlrev_b32 v216, 6, v209
    v_lshl_add_u32 v216, v210, 3, v216
    v_lshl_add_u32 v216, v215, 5, v216
    s_add_u32 s53, s52, 49152
    v_lshl_add_u32 v2, v208, 10, v216
    v_add_u32 v2, s53, v2
    v_xor_b32 v3, 32, v2
    v_add_u32 v4, 65536, v2
    v_add_u32 v5, 65536, v3
    v_lshl_add_u32 v6, v208, 9, v216
    v_add_u32 v6, s53, v6
    v_xor_b32 v7, 32, v6
    v_add_u32 v8, 65536, v6
    v_add_u32 v9, 65536, v7
    s_waitcnt vmcnt(11)
    v_dot2c_f32_bf16 v96, s62, v32
    v_dot2c_f32_bf16 v97, v32, v32
    v_lshlrev_b32 v40, 16, v32
    v_and_b32 v41, s61, v32
    v_dot2c_f32_bf16 v96, s62, v33
    v_dot2c_f32_bf16 v97, v33, v33
    v_lshlrev_b32 v42, 16, v33
    v_and_b32 v43, s61, v33
    v_dot2c_f32_bf16 v96, s62, v34
    v_dot2c_f32_bf16 v97, v34, v34
    v_lshlrev_b32 v44, 16, v34
    v_and_b32 v45, s61, v34
    v_dot2c_f32_bf16 v96, s62, v35
    v_dot2c_f32_bf16 v97, v35, v35
    v_lshlrev_b32 v46, 16, v35
    v_and_b32 v47, s61, v35
    s_waitcnt vmcnt(10)
    v_dot2c_f32_bf16 v96, s62, v36
    v_dot2c_f32_bf16 v97, v36, v36
    v_lshlrev_b32 v48, 16, v36
    v_and_b32 v49, s61, v36
    v_dot2c_f32_bf16 v96, s62, v37
    v_dot2c_f32_bf16 v97, v37, v37
    v_lshlrev_b32 v50, 16, v37
    v_and_b32 v51, s61, v37
    v_dot2c_f32_bf16 v96, s62, v38
    v_dot2c_f32_bf16 v97, v38, v38
    v_lshlrev_b32 v52, 16, v38
    v_and_b32 v53, s61, v38
    v_dot2c_f32_bf16 v96, s62, v39
    v_dot2c_f32_bf16 v97, v39, v39
    v_lshlrev_b32 v54, 16, v39
    v_and_b32 v55, s61, v39
    buffer_load_dword v29, off, s[40:43], 0 sc1
    v_add_f32_dpp v96, v96, v96 quad_perm:[1,0,3,2] row_mask:0xf bank_mask:0xf
    v_add_f32_dpp v97, v97, v97 quad_perm:[1,0,3,2] row_mask:0xf bank_mask:0xf
    s_nop 0
    v_add_f32_dpp v96, v96, v96 quad_perm:[2,3,0,1] row_mask:0xf bank_mask:0xf
    v_add_f32_dpp v97, v97, v97 quad_perm:[2,3,0,1] row_mask:0xf bank_mask:0xf
    s_nop 0
    v_add_f32_dpp v96, v96, v96 row_half_mirror row_mask:0xf bank_mask:0xf
    v_add_f32_dpp v97, v97, v97 row_half_mirror row_mask:0xf bank_mask:0xf
    s_nop 0
    v_add_f32_dpp v96, v96, v96 row_mirror row_mask:0xf bank_mask:0xf
    v_add_f32_dpp v97, v97, v97 row_mirror row_mask:0xf bank_mask:0xf
    v_mov_b32 v98, v96
    v_mov_b32 v99, v97
    s_nop 0
    v_permlane16_swap_b32 v96, v98
    v_permlane16_swap_b32 v97, v99
    v_add_f32 v96, v96, v98
    v_add_f32 v97, v97, v99
    v_mul_f32 v98, 0x3b124925, v96
    v_mul_f32 v99, 0x3b124925, v97
    v_fma_f32 v99, -v98, v98, v99
    v_max_f32 v99, 0, v99
    v_cvt_pk_bf16_f32 v100, 0, v99
    v_add_f32 v100, 0x3727c5ac, v100
    v_cvt_pk_bf16_f32 v100, 0, v100
    v_sqrt_f32 v100, v100
    s_nop 0
    v_cvt_pk_bf16_f32 v100, 0, v100
    v_rcp_f32 v100, v100
    s_nop 0
    v_mul_f32 v99, v99, v100
    v_mul_f32 v99, v99, v100
    v_cvt_pk_bf16_f32 v104, 0, v99
    v_add_f32 v104, 0x3727c5ac, v104
    v_cvt_pk_bf16_f32 v104, 0, v104
    v_sqrt_f32 v104, v104
    s_nop 0
    v_cvt_pk_bf16_f32 v102, 0, v104
    v_rcp_f32 v104, v102
    s_nop 0
    v_mul_f32 v104, v104, v100
    v_mul_f32 v106, v98, v104
    v_pk_fma_f32 v[56:57], v[40:41], v[104:105], v[106:107] op_sel_hi:[1,0,0] neg_lo:[0,0,1] neg_hi:[0,0,1]
    v_pk_fma_f32 v[58:59], v[42:43], v[104:105], v[106:107] op_sel_hi:[1,0,0] neg_lo:[0,0,1] neg_hi:[0,0,1]
    v_pk_fma_f32 v[60:61], v[44:45], v[104:105], v[106:107] op_sel_hi:[1,0,0] neg_lo:[0,0,1] neg_hi:[0,0,1]
    v_pk_fma_f32 v[62:63], v[46:47], v[104:105], v[106:107] op_sel_hi:[1,0,0] neg_lo:[0,0,1] neg_hi:[0,0,1]
    v_pk_fma_f32 v[64:65], v[48:49], v[104:105], v[106:107] op_sel_hi:[1,0,0] neg_lo:[0,0,1] neg_hi:[0,0,1]
    v_pk_fma_f32 v[66:67], v[50:51], v[104:105], v[106:107] op_sel_hi:[1,0,0] neg_lo:[0,0,1] neg_hi:[0,0,1]
    v_pk_fma_f32 v[68:69], v[52:53], v[104:105], v[106:107] op_sel_hi:[1,0,0] neg_lo:[0,0,1] neg_hi:[0,0,1]
    v_pk_fma_f32 v[70:71], v[54:55], v[104:105], v[106:107] op_sel_hi:[1,0,0] neg_lo:[0,0,1] neg_hi:[0,0,1]
    v_cvt_pk_bf16_f32 v80, v56, v57
    v_cvt_pk_bf16_f32 v81, v58, v59
    v_cvt_pk_bf16_f32 v82, v60, v61
    v_cvt_pk_bf16_f32 v83, v62, v63
    v_cvt_pk_bf16_f32 v84, v64, v65
    v_cvt_pk_bf16_f32 v85, v66, v67
    v_cvt_pk_bf16_f32 v86, v68, v69
    v_cvt_pk_bf16_f32 v87, v70, v71
    v_lshrrev_b32 v102, 16, v102
    v_cndmask_b32 v84, v84, v102, s[92:93]
    ds_write_b128 v109, v[80:83] offset:0
    ds_write_b128 v109, v[84:87] offset:512
    s_waitcnt lgkmcnt(0)
    s_barrier
    ds_read_b64_tr_b16 v[88:89], v110 offset:0
    ds_read_b64_tr_b16 v[90:91], v110 offset:4352
    ds_read_b64_tr_b16 v[92:93], v110 offset:512
    ds_read_b64_tr_b16 v[94:95], v110 offset:4864
    s_waitcnt lgkmcnt(2)
    buffer_store_dwordx4 v[88:91], v111, s[24:27], s63 offen sc1
    s_waitcnt lgkmcnt(0)
    buffer_store_dwordx4 v[92:95], v22, s[24:27], s64 offen sc1
    s_add_u32 s57, s57, 27648
    buffer_load_dwordx4 v11, s[16:19], s57 offen offset:1024 lds
    s_add_u32 s57, s57, 27648
    buffer_load_dwordx4 v10, s[16:19], s57 offen offset:2048 lds
    s_add_u32 s57, s57, 27648
    buffer_load_dwordx4 v11, s[16:19], s57 offen offset:3072 lds
    s_add_u32 m0, s52, 81920
    s_add_u32 s57, s65, 2
    s_sub_u32 s3, s57, 16
    s_min_u32 s57, s57, s3
    s_mul_i32 s57, s57, 114688
    buffer_load_dwordx4 v10, s[16:19], s57 offen offset:0 lds
    s_add_u32 s57, s57, 27648
    buffer_load_dwordx4 v11, s[16:19], s57 offen offset:1024 lds
    s_add_u32 s57, s57, 27648
    buffer_load_dwordx4 v10, s[16:19], s57 offen offset:2048 lds
    s_branch L_body
.p2align 12
L_body:
    s_mov_b32 s59, s44
    s_mov_b64 exec, 0
    s_branch L_wb_go
L_wb_ret:
    s_add_u32 s59, s59, 4
L_wb_go:
    s_cmp_eq_u32 s59, 0
    s_cbranch_scc1 L_wb_0
    s_cmp_eq_u32 s59, 1
    s_cbranch_scc1 L_wb_1
    s_cmp_eq_u32 s59, 2
    s_cbranch_scc1 L_wb_2
    s_cmp_eq_u32 s59, 3
    s_cbranch_scc1 L_wb_3
    s_cmp_eq_u32 s59, 4
    s_cbranch_scc1 L_wb_3
    s_cmp_eq_u32 s59, 5
    s_cbranch_scc1 L_wb_3
    s_mov_b64 exec, -1
    s_waitcnt vmcnt(6)
    v_cmp_eq_u32 vcc, 0, v29
    s_nop 0
    s_cbranch_vccz L_ok2
    s_mov_b32 s59, 100000
L_spin1:
    buffer_load_dword v29, off, s[40:43], 0 sc1
    s_waitcnt vmcnt(0)
    v_cmp_eq_u32 vcc, 0, v29
    s_nop 0
    s_cbranch_vccz L_ok2
    s_sub_u32 s59, s59, 1
    s_cbranch_scc0 L_spin1
L_ok2:
    v_readfirstlane_b32 s47, v29
    s_barrier
    s_cmp_lg_u32 s44, 0
    s_cbranch_scc1 L_nopub3
    s_lshl_b32 s60, s2, 5
    s_add_u32 s60, s60, 12582912
    v_mov_b32 v30, s47
    s_mov_b64 exec, 1
    buffer_store_dword v30, off, s[24:27], s60 sc1
    s_mov_b64 exec, -1
L_nopub3:
    s_lshl_b32 s53, s44, 11
    s_add_u32 s53, s53, 12582912
    v_lshl_add_u32 v18, v1, 5, s53
    s_lshl2_add_u32 s67, s51, s44
    s_add_u32 s57, s57, 27648
    buffer_load_dwordx4 v11, s[16:19], s57 offen offset:3072 lds
    s_mul_i32 s67, s67, 58624
    s_lshl_b32 s53, s50, 11
    s_add_u32 s67, s67, s53
    s_add_u32 s67, s67, 2097152
    s_add_u32 m0, s52, 98304
    s_add_u32 s57, s65, 3
    s_sub_u32 s3, s57, 16
    s_min_u32 s57, s57, s3
    s_mul_i32 s57, s57, 114688
    buffer_load_dwordx4 v10, s[16:19], s57 offen offset:0 lds
    v_mov_b32 v236, 0xbdd2d3e8
    v_mov_b32 v237, 0xc0135761
    s_or_b32 s88, s88, 0
    s_add_u32 s54, s88, 24
    s_add_u32 s57, s57, 27648
    buffer_load_dwordx4 v11, s[16:19], s57 offen offset:1024 lds
    ds_read_b64_tr_b16 a[0:1], v2 offset:0
    ds_read_b64_tr_b16 a[2:3], v2 offset:512
    ds_read_b64_tr_b16 a[4:5], v3 offset:0
    ds_read_b64_tr_b16 a[6:7], v3 offset:512
    s_mul_i32 s84, s54, 66816
    s_lshl2_add_u32 s84, s52, s84
    s_mul_i32 s83, s54, 58624
    s_add_u32 s83, s83, s53
    ds_read_b64_tr_b16 a[8:9], v2 offset:256
    ds_read_b64_tr_b16 a[10:11], v2 offset:768
    ds_read_b64_tr_b16 a[12:13], v3 offset:256
    ds_read_b64_tr_b16 a[14:15], v3 offset:768
    s_add_u32 s57, s57, 27648
    buffer_load_dwordx4 v10, s[16:19], s57 offen offset:2048 lds
    s_and_b32 s54, s44, 1
    s_lshl_b32 s54, s54, 10
    s_add_u32 s83, s83, s54
    s_add_u32 s83, s83, 2097152
    s_add_u32 s57, s57, 27648
    buffer_load_dwordx4 v11, s[16:19], s57 offen offset:3072 lds
    s_lshl1_add_u32 s54, s54, 49152
    v_add_u32 v243, s54, v23
    s_cmp_lt_u32 s88, 4
    s_cselect_b32 s84, s84, 2130706432
    s_cselect_b32 s83, s83, 2130706432
    s_cmp_lt_u32 s44, 2
    s_cselect_b32 s83, s83, 2130706432
    s_cmp_eq_u32 s44, 0
    s_cselect_b32 s85, 1.0, 0
    s_mul_i32 s53, s45, 7
    s_lshr_b32 s53, s53, 1
    s_sub_u32 s53, s50, s53
    s_lshl1_add_u32 s53, s53, s88
    s_sub_u32 s53, s53, 4
    s_mul_i32 s54, s44, 28
    s_add_u32 s54, s54, s53
    s_lshl_b32 s87, s54, 16
    s_lshl_b32 s54, s45, 9
    s_add_u32 s87, s87, s54
    s_cmp_ge_u32 s88, 4
    s_cselect_b32 s87, s87, 2130706432
    v_lshrrev_b32 v254, 2, v1
    v_lshlrev_b32 v254, 12, v254
    v_lshl_add_u32 v254, v210, 7, v254
    s_add_u32 m0, s52, 114688
    s_add_u32 s57, s65, 4
    s_sub_u32 s3, s57, 16
    s_min_u32 s57, s57, s3
    s_mul_i32 s57, s57, 114688
    buffer_load_dwordx4 v10, s[16:19], s57 offen offset:0 lds
    s_lshr_b32 s53, s46, 2
    s_and_b32 s89, s46, 3
    s_bfe_u32 s54, s46, 0x20001
    s_and_b32 s55, s46, 1
    s_add_u32 s55, s55, 4
    s_cmp_lt_u32 s46, 16
    s_cselect_b32 s53, s53, s54
    s_cselect_b32 s89, s89, s55
    s_mul_i32 s49, s53, 2
    s_add_u32 s49, s49, s89
    s_sub_u32 s54, s49, 6
    s_min_u32 s49, s49, s54
    s_or_b32 s89, s89, 0
    s_add_u32 s57, s57, 27648
    buffer_load_dwordx4 v11, s[16:19], s57 offen offset:1024 lds
    s_waitcnt vmcnt(10)
    ds_read_b64_tr_b16 a[16:17], v2 offset:16384
    ds_read_b64_tr_b16 a[18:19], v2 offset:16896
    ds_read_b64_tr_b16 a[20:21], v3 offset:16384
    ds_read_b64_tr_b16 a[22:23], v3 offset:16896
    s_add_u32 s57, s57, 27648
    buffer_load_dwordx4 v10, s[16:19], s57 offen offset:2048 lds
    ds_read_b64_tr_b16 a[24:25], v2 offset:16640
    ds_read_b64_tr_b16 a[26:27], v2 offset:17152
    ds_read_b64_tr_b16 a[28:29], v3 offset:16640
    ds_read_b64_tr_b16 a[30:31], v3 offset:17152
    s_add_u32 s57, s57, 27648
    buffer_load_dwordx4 v11, s[16:19], s57 offen offset:3072 lds
    s_lshl2_add_u32 s48, s45, s53
    s_mul_i32 s53, s44, 1835008
    s_lshl_b32 s74, s48, 7
    s_add_u32 s53, s53, s74
    s_lshl_b32 s56, s44, 5
    v_lshlrev_b32 v217, 5, v212
    v_xor_b32 v217, v217, v214
    v_xor_b32 v217, s56, v217
    s_add_u32 m0, s52, 131072
    s_add_u32 s57, s65, 5
    s_sub_u32 s3, s57, 16
    s_min_u32 s57, s57, s3
    s_mul_i32 s57, s57, 114688
    buffer_load_dwordx4 v10, s[16:19], s57 offen offset:0 lds
    s_add_u32 s74, s74, s56
    v_lshlrev_b32 v12, 12, v213
    v_add3_u32 v12, v12, v217, s53
    s_mul_i32 s53, s44, 28672
    s_add_u32 s57, s57, 27648
    buffer_load_dwordx4 v11, s[16:19], s57 offen offset:1024 lds
    s_waitcnt vmcnt(10)
    ds_read_b64_tr_b16 a[32:33], v2 offset:32768
    ds_read_b64_tr_b16 a[34:35], v2 offset:33280
    ds_read_b64_tr_b16 a[36:37], v3 offset:32768
    ds_read_b64_tr_b16 a[38:39], v3 offset:33280
    s_add_u32 s57, s57, 27648
    buffer_load_dwordx4 v10, s[16:19], s57 offen offset:2048 lds
    ds_read_b64_tr_b16 a[40:41], v2 offset:33024
    ds_read_b64_tr_b16 a[42:43], v2 offset:33536
    ds_read_b64_tr_b16 a[44:45], v3 offset:33024
    ds_read_b64_tr_b16 a[46:47], v3 offset:33536
    s_lshl_b32 s54, s49, 7
    s_add_u32 s55, s53, s54
    v_mul_u32_u24 v13, 896, v213
    v_add3_u32 v13, v13, v214, s55
    s_add_u32 s57, s57, 27648
    buffer_load_dwordx4 v11, s[16:19], s57 offen offset:3072 lds
    v_xor_b32 v14, 32, v13
    s_mul_i32 s55, s44, 21504
    v_subrev_u32 v239, s55, v13
    s_and_b32 s55, s56, 32
    s_add_u32 m0, s52, 147456
    s_add_u32 s57, s65, 6
    s_sub_u32 s3, s57, 16
    s_min_u32 s57, s57, s3
    s_mul_i32 s57, s57, 114688
    buffer_load_dwordx4 v10, s[16:19], s57 offen offset:0 lds
    v_xor_b32 v239, s55, v239
    s_mul_i32 s73, s48, 57344
    s_add_u32 s71, s73, s54
    s_mul_i32 s55, s44, 14336
    s_add_u32 s57, s57, 27648
    buffer_load_dwordx4 v11, s[16:19], s57 offen offset:1024 lds
    s_waitcnt vmcnt(10)
    ds_read_b64_tr_b16 a[48:49], v2 offset:49152
    ds_read_b64_tr_b16 a[50:51], v2 offset:49664
    ds_read_b64_tr_b16 a[52:53], v3 offset:49152
    ds_read_b64_tr_b16 a[54:55], v3 offset:49664
    s_add_u32 s71, s71, s55
    s_add_u32 s72, s71, 7168
    v_bfe_u32 v217, v1, 1, 2
    v_lshl_add_u32 v217, v212, 2, v217
    ds_read_b64_tr_b16 a[56:57], v2 offset:49408
    ds_read_b64_tr_b16 a[58:59], v2 offset:49920
    ds_read_b64_tr_b16 a[60:61], v3 offset:49408
    ds_read_b64_tr_b16 a[62:63], v3 offset:49920
    s_add_u32 s57, s57, 27648
    buffer_load_dwordx4 v10, s[16:19], s57 offen offset:2048 lds
    v_and_b32 v218, 24, v1
    v_add_u32 v217, v217, v218
    v_mul_u32_u24 v15, 896, v217
    v_and_b32 v217, 1, v1
    s_add_u32 s57, s57, 27648
    buffer_load_dwordx4 v11, s[16:19], s57 offen offset:3072 lds
    v_lshl_add_u32 v15, v217, 4, v15
    v_add_u32 v15, s53, v15
    s_lshl_b32 s54, s89, 5
    s_add_u32 s54, s54, 768
    s_waitcnt lgkmcnt(15)
    s_add_u32 m0, s52, 49152
    s_add_u32 s57, s65, 7
    s_sub_u32 s3, s57, 16
    s_min_u32 s57, s57, s3
    s_mul_i32 s57, s57, 114688
    buffer_load_dwordx4 v10, s[16:19], s57 offen offset:0 lds
    s_add_u32 s68, s89, 24
    s_mul_i32 s68, s68, 58624
    s_mul_i32 s69, s44, 14336
    s_add_u32 s69, s69, 2097152
    s_add_u32 s68, s68, s69
    s_mul_i32 s55, s49, 234496
    s_add_u32 s69, s69, s55
    s_add_u32 s73, s73, s54
    s_add_u32 s57, s57, 27648
    buffer_load_dwordx4 v11, s[16:19], s57 offen offset:1024 lds
    s_waitcnt vmcnt(10)
    ds_read_b64_tr_b16 a[64:65], v4 offset:0
    ds_read_b64_tr_b16 a[66:67], v4 offset:512
    ds_read_b64_tr_b16 a[68:69], v5 offset:0
    ds_read_b64_tr_b16 a[70:71], v5 offset:512
    s_add_u32 s57, s57, 27648
    buffer_load_dwordx4 v10, s[16:19], s57 offen offset:2048 lds
    ds_read_b64_tr_b16 a[72:73], v4 offset:256
    ds_read_b64_tr_b16 a[74:75], v4 offset:768
    ds_read_b64_tr_b16 a[76:77], v5 offset:256
    ds_read_b64_tr_b16 a[78:79], v5 offset:768
    s_add_u32 s57, s57, 27648
    buffer_load_dwordx4 v11, s[16:19], s57 offen offset:3072 lds
    s_mov_b32 s76, 0
    s_add_u32 s77, s76, 2048
    s_cmp_eq_u32 s77, 14336
    s_cselect_b32 s77, 0, s77
    s_add_u32 s78, s77, 2048
    s_cmp_eq_u32 s78, 14336
    s_cselect_b32 s78, 0, s78
    s_add_u32 s79, s78, 2048
    s_cmp_eq_u32 s79, 14336
    s_cselect_b32 s79, 0, s79
    s_add_u32 s80, s79, 2048
    s_cmp_eq_u32 s80, 14336
    s_cselect_b32 s80, 0, s80
    s_add_u32 s81, s80, 2048
    s_cmp_eq_u32 s81, 14336
    s_cselect_b32 s81, 0, s81
    s_add_u32 s82, s81, 2048
    s_cmp_eq_u32 s82, 14336
    s_cselect_b32 s82, 0, s82
    s_add_u32 m0, s52, 65536
    s_add_u32 s57, s65, 8
    s_sub_u32 s3, s57, 16
    s_min_u32 s57, s57, s3
    s_mul_i32 s57, s57, 114688
    buffer_load_dwordx4 v10, s[16:19], s57 offen offset:0 lds
    s_cmp_lt_u32 s89, 4
    s_cselect_b32 s75, s54, 2130706432
    s_cselect_b32 s68, s68, 2130706432
    s_cselect_b32 s73, s73, 2130706432
    s_add_u32 s57, s57, 27648
    buffer_load_dwordx4 v11, s[16:19], s57 offen offset:1024 lds
    s_waitcnt vmcnt(10)
    ds_read_b64_tr_b16 a[80:81], v4 offset:16384
    ds_read_b64_tr_b16 a[82:83], v4 offset:16896
    ds_read_b64_tr_b16 a[84:85], v5 offset:16384
    ds_read_b64_tr_b16 a[86:87], v5 offset:16896
    s_add_u32 s57, s57, 27648
    buffer_load_dwordx4 v10, s[16:19], s57 offen offset:2048 lds
    ds_read_b64_tr_b16 a[88:89], v4 offset:16640
    ds_read_b64_tr_b16 a[90:91], v4 offset:17152
    ds_read_b64_tr_b16 a[92:93], v5 offset:16640
    ds_read_b64_tr_b16 a[94:95], v5 offset:17152
    v_lshlrev_b32 v16, 3, v1
    v_add_u32 v16, 81920, v16
    v_and_b32 v217, 7, v1
    v_min_u32 v218, 6, v217
    s_add_u32 s57, s57, 27648
    buffer_load_dwordx4 v11, s[16:19], s57 offen offset:3072 lds
    s_mul_i32 s54, s44, 7
    v_add_u32 v218, s54, v218
    v_mul_u32_u24 v219, 2, v218
    v_add_u32 v219, s89, v219
    s_waitcnt lgkmcnt(15)
    s_add_u32 m0, s52, 81920
    s_add_u32 s57, s65, 9
    s_sub_u32 s3, s57, 16
    s_min_u32 s57, s57, s3
    s_mul_i32 s57, s57, 114688
    buffer_load_dwordx4 v10, s[16:19], s57 offen offset:0 lds
    v_mul_u32_u24 v220, 43, v219
    v_lshrrev_b32 v220, 8, v220
    v_mul_u32_u24 v220, 6, v220
    v_sub_u32 v219, v219, v220
    s_add_u32 s57, s57, 27648
    buffer_load_dwordx4 v11, s[16:19], s57 offen offset:1024 lds
    s_waitcnt vmcnt(10)
    ds_read_b64_tr_b16 a[96:97], v4 offset:32768
    ds_read_b64_tr_b16 a[98:99], v4 offset:33280
    ds_read_b64_tr_b16 a[100:101], v5 offset:32768
    ds_read_b64_tr_b16 a[102:103], v5 offset:33280
    v_subrev_u32 v219, s49, v219
    v_bfe_u32 v220, v1, 3, 1
    v_mul_i32_i24 v219, v219, v220
    v_add_u32 v219, s49, v219
    ds_read_b64_tr_b16 a[104:105], v4 offset:33024
    ds_read_b64_tr_b16 a[106:107], v4 offset:33536
    ds_read_b64_tr_b16 a[108:109], v5 offset:33024
    ds_read_b64_tr_b16 a[110:111], v5 offset:33536
    s_add_u32 s57, s57, 27648
    buffer_load_dwordx4 v10, s[16:19], s57 offen offset:2048 lds
    v_lshl_add_u32 v218, v219, 5, v218
    v_lshlrev_b32 v20, 7, v218
    v_add_u32 v20, 12713984, v20
    s_lshr_b32 s53, s48, 1
    s_add_u32 s57, s57, 27648
    buffer_load_dwordx4 v11, s[16:19], s57 offen offset:3072 lds
    s_lshl_b32 s53, s53, 7
    s_add_u32 s53, s53, 12779520
    v_lshl_add_u32 v21, v210, 11, s53
    s_lshl_b32 s70, s48, 16
    s_add_u32 m0, s52, 98304
    s_add_u32 s57, s65, 10
    s_sub_u32 s3, s57, 16
    s_min_u32 s57, s57, s3
    s_mul_i32 s57, s57, 114688
    buffer_load_dwordx4 v10, s[16:19], s57 offen offset:0 lds
    s_lshl2_add_u32 s70, s52, s70
    s_add_u32 s70, s70, 4194304
    v_lshrrev_b32 v218, 3, v1
    v_mul_u32_u24 v22, 896, v218
    v_lshl_add_u32 v22, v217, 4, v22
    v_lshlrev_b32 v25, 1, v211
    s_add_u32 s53, s52, 65536
    v_mul_u32_u24 v244, 176, v218
    s_add_u32 s57, s57, 27648
    buffer_load_dwordx4 v11, s[16:19], s57 offen offset:1024 lds
    s_waitcnt vmcnt(10)
    ds_read_b64_tr_b16 a[112:113], v2 offset:0
    ds_read_b64_tr_b16 a[114:115], v2 offset:512
    ds_read_b64_tr_b16 a[116:117], v3 offset:0
    ds_read_b64_tr_b16 a[118:119], v3 offset:512
    s_add_u32 s57, s57, 27648
    buffer_load_dwordx4 v10, s[16:19], s57 offen offset:2048 lds
    ds_read_b64_tr_b16 a[120:121], v2 offset:256
    ds_read_b64_tr_b16 a[122:123], v2 offset:768
    ds_read_b64_tr_b16 a[124:125], v3 offset:256
    ds_read_b64_tr_b16 a[126:127], v3 offset:768
    s_add_u32 s57, s57, 27648
    buffer_load_dwordx4 v11, s[16:19], s57 offen offset:3072 lds
    v_lshl_add_u32 v244, v217, 4, v244
    v_add_u32 v244, s53, v244
    v_mul_u32_u24 v238, 176, v211
    v_lshl_add_u32 v238, v208, 3, v238
    v_add_u32 v238, s53, v238
    v_lshrrev_b32 v218, 2, v0
    v_mul_u32_u24 v26, 896, v218
    v_lshl_add_u32 v26, v210, 3, v26
    s_waitcnt lgkmcnt(15)
    s_add_u32 m0, s52, 114688
    s_add_u32 s57, s65, 11
    s_sub_u32 s3, s57, 16
    s_min_u32 s57, s57, s3
    s_mul_i32 s57, s57, 114688
    buffer_load_dwordx4 v10, s[16:19], s57 offen offset:0 lds
    v_lshrrev_b32 v218, 2, v1
    v_mul_u32_u24 v252, 176, v218
    v_lshl_add_u32 v252, v210, 3, v252
    v_add_u32 v252, s53, v252
    s_add_u32 s57, s57, 27648
    buffer_load_dwordx4 v11, s[16:19], s57 offen offset:1024 lds
    s_waitcnt vmcnt(10)
    ds_read_b64_tr_b16 a[128:129], v2 offset:16384
    ds_read_b64_tr_b16 a[130:131], v2 offset:16896
    ds_read_b64_tr_b16 a[132:133], v3 offset:16384
    ds_read_b64_tr_b16 a[134:135], v3 offset:16896
    s_add_u32 s57, s57, 27648
    buffer_load_dwordx4 v10, s[16:19], s57 offen offset:2048 lds
    ds_read_b64_tr_b16 a[136:137], v2 offset:16640
    ds_read_b64_tr_b16 a[138:139], v2 offset:17152
    ds_read_b64_tr_b16 a[140:141], v3 offset:16640
    ds_read_b64_tr_b16 a[142:143], v3 offset:17152
    s_sub_u32 s53, 49152, s52
    v_add_u32 v246, s53, v2
    v_add_u32 v247, s53, v3
    v_mul_u32_u24 v218, 3072, v208
    s_add_u32 s57, s57, 27648
    buffer_load_dwordx4 v11, s[16:19], s57 offen offset:3072 lds
    v_add_u32 v248, v218, v246
    v_add_u32 v249, v218, v247
    v_add_u32 v232, s52, v23
    v_xor_b32 v233, 4096, v232
    s_add_u32 m0, s52, 131072
    s_add_u32 s57, s65, 12
    s_sub_u32 s3, s57, 16
    s_min_u32 s57, s57, s3
    s_mul_i32 s57, s57, 114688
    buffer_load_dwordx4 v10, s[16:19], s57 offen offset:0 lds
    v_xor_b32 v234, 8192, v232
    v_xor_b32 v235, 12288, v232
    v_lshlrev_b32 v32, 16, v224
    v_and_b32 v33, s61, v224
    v_lshlrev_b32 v34, 16, v225
    v_and_b32 v35, s61, v225
    s_add_u32 s57, s57, 27648
    buffer_load_dwordx4 v11, s[16:19], s57 offen offset:1024 lds
    s_waitcnt vmcnt(10)
    ds_read_b64_tr_b16 a[144:145], v2 offset:32768
    ds_read_b64_tr_b16 a[146:147], v2 offset:33280
    ds_read_b64_tr_b16 a[148:149], v3 offset:32768
    ds_read_b64_tr_b16 a[150:151], v3 offset:33280
    s_add_u32 s57, s57, 27648
    buffer_load_dwordx4 v10, s[16:19], s57 offen offset:2048 lds
    ds_read_b64_tr_b16 a[152:153], v2 offset:33024
    ds_read_b64_tr_b16 a[154:155], v2 offset:33536
    ds_read_b64_tr_b16 a[156:157], v3 offset:33024
    ds_read_b64_tr_b16 a[158:159], v3 offset:33536
    s_add_u32 s57, s57, 27648
    buffer_load_dwordx4 v11, s[16:19], s57 offen offset:3072 lds
    v_lshlrev_b32 v36, 16, v226
    v_and_b32 v37, s61, v226
    v_lshlrev_b32 v38, 16, v227
    v_and_b32 v39, s61, v227
    v_lshlrev_b32 v40, 16, v228
    v_and_b32 v41, s61, v228
    v_lshlrev_b32 v42, 16, v229
    v_and_b32 v43, s61, v229
    buffer_load_dword v17, v18, s[24:27], 0 offen sc1
    v_lshlrev_b32 v44, 16, v230
    v_and_b32 v45, s61, v230
    v_lshlrev_b32 v46, 16, v231
    v_and_b32 v47, s61, v231
    v_mul_f32 v96, s85, v32
    v_mul_f32 v97, s85, v33
    v_mul_f32 v98, s85, v34
    v_mul_f32 v99, s85, v35
    s_waitcnt lgkmcnt(15)
    s_add_u32 m0, s52, 147456
    s_add_u32 s57, s65, 13
    s_sub_u32 s3, s57, 16
    s_min_u32 s57, s57, s3
    s_mul_i32 s57, s57, 114688
    buffer_load_dwordx4 v10, s[16:19], s57 offen offset:0 lds
    s_waitcnt vmcnt(10)
    ds_read_b64_tr_b16 a[160:161], v2 offset:49152
    ds_read_b64_tr_b16 a[162:163], v2 offset:49664
    ds_read_b64_tr_b16 a[164:165], v3 offset:49152
    ds_read_b64_tr_b16 a[166:167], v3 offset:49664
    v_mul_f32 v100, s85, v36
    v_mul_f32 v101, s85, v37
    v_mul_f32 v102, s85, v38
    v_mul_f32 v103, s85, v39
    ds_read_b64_tr_b16 a[168:169], v2 offset:49408
    ds_read_b64_tr_b16 a[170:171], v2 offset:49920
    ds_read_b64_tr_b16 a[172:173], v3 offset:49408
    ds_read_b64_tr_b16 a[174:175], v3 offset:49920
    s_add_u32 s57, s57, 27648
    buffer_load_dwordx4 v11, s[16:19], s57 offen offset:1024 lds
    v_mul_f32 v104, s85, v40
    v_mul_f32 v105, s85, v41
    v_mul_f32 v106, s85, v42
    v_mul_f32 v107, s85, v43
    s_add_u32 s57, s57, 27648
    buffer_load_dwordx4 v10, s[16:19], s57 offen offset:2048 lds
    v_mul_f32 v108, s85, v44
    v_mul_f32 v109, s85, v45
    v_mul_f32 v110, s85, v46
    v_mul_f32 v111, s85, v47
    s_add_u32 s57, s57, 27648
    buffer_load_dwordx4 v11, s[16:19], s57 offen offset:3072 lds
    s_add_u32 m0, s52, 49152
    s_add_u32 s57, s65, 14
    s_sub_u32 s3, s57, 16
    s_min_u32 s57, s57, s3
    s_mul_i32 s57, s57, 114688
    buffer_load_dwordx4 v10, s[16:19], s57 offen offset:0 lds
    s_waitcnt vmcnt(10)
    ds_read_b64_tr_b16 a[176:177], v4 offset:0
    ds_read_b64_tr_b16 a[178:179], v4 offset:512
    ds_read_b64_tr_b16 a[180:181], v5 offset:0
    ds_read_b64_tr_b16 a[182:183], v5 offset:512
    s_add_u32 s57, s57, 27648
    buffer_load_dwordx4 v11, s[16:19], s57 offen offset:1024 lds
    ds_read_b64_tr_b16 a[184:185], v4 offset:256
    ds_read_b64_tr_b16 a[186:187], v4 offset:768
    ds_read_b64_tr_b16 a[188:189], v5 offset:256
    ds_read_b64_tr_b16 a[190:191], v5 offset:768
    s_add_u32 s57, s57, 27648
    buffer_load_dwordx4 v10, s[16:19], s57 offen offset:2048 lds
    s_add_u32 s57, s57, 27648
    buffer_load_dwordx4 v11, s[16:19], s57 offen offset:3072 lds
    s_waitcnt lgkmcnt(15)
    s_add_u32 m0, s52, 65536
    s_add_u32 s57, s65, 15
    s_sub_u32 s3, s57, 16
    s_min_u32 s57, s57, s3
    s_mul_i32 s57, s57, 114688
    buffer_load_dwordx4 v10, s[16:19], s57 offen offset:0 lds
    s_waitcnt vmcnt(10)
    ds_read_b64_tr_b16 a[192:193], v4 offset:16384
    ds_read_b64_tr_b16 a[194:195], v4 offset:16896
    ds_read_b64_tr_b16 a[196:197], v5 offset:16384
    ds_read_b64_tr_b16 a[198:199], v5 offset:16896
    s_add_u32 s57, s57, 27648
    buffer_load_dwordx4 v11, s[16:19], s57 offen offset:1024 lds
    ds_read_b64_tr_b16 a[200:201], v4 offset:16640
    ds_read_b64_tr_b16 a[202:203], v4 offset:17152
    ds_read_b64_tr_b16 a[204:205], v5 offset:16640
    ds_read_b64_tr_b16 a[206:207], v5 offset:17152
    s_add_u32 s57, s57, 27648
    buffer_load_dwordx4 v10, s[16:19], s57 offen offset:2048 lds
    s_waitcnt vmcnt(11)
    v_cmp_ne_u32 vcc, s47, v17
    s_nop 0
    s_cbranch_vccz L_ok5
    s_mov_b32 s59, 100000
L_spin4:
    buffer_load_dword v17, v18, s[24:27], 0 offen sc1
    s_waitcnt vmcnt(0)
    v_cmp_ne_u32 vcc, s47, v17
    s_nop 0
    s_cbranch_vccz L_ok5
    s_sub_u32 s59, s59, 1
    s_cbranch_scc0 L_spin4
L_ok5:
    s_cmp_ge_u32 s88, 4
    s_cbranch_scc1 L_p2_alt
    s_add_u32 s57, s57, 27648
    buffer_load_dwordx4 v11, s[16:19], s57 offen offset:3072 lds
    s_mov_b32 s66, s84
    s_lshl_b32 s86, s65, 10
    s_add_u32 s58, s86, s66
    s_add_u32 s86, s66, 16384
    buffer_load_dwordx4 v[112:115], v23, s[24:27], s58 offen offset:0 sc1
    s_add_u32 s58, s58, 1024
    s_cmp_eq_u32 s58, s86
    s_cselect_b32 s58, s66, s58
    buffer_load_dwordx4 v[116:119], v23, s[24:27], s58 offen offset:0 sc1
    s_waitcnt vmcnt(10)
    ds_read_b64_tr_b16 a[208:209], v4 offset:32768
    ds_read_b64_tr_b16 a[210:211], v4 offset:33280
    ds_read_b64_tr_b16 a[212:213], v5 offset:32768
    ds_read_b64_tr_b16 a[214:215], v5 offset:33280
    s_add_u32 s58, s58, 1024
    s_cmp_eq_u32 s58, s86
    s_cselect_b32 s58, s66, s58
    buffer_load_dwordx4 v[120:123], v23, s[24:27], s58 offen offset:0 sc1
    ds_read_b64_tr_b16 a[216:217], v4 offset:33024
    ds_read_b64_tr_b16 a[218:219], v4 offset:33536
    ds_read_b64_tr_b16 a[220:221], v5 offset:33024
    ds_read_b64_tr_b16 a[222:223], v5 offset:33536
    s_add_u32 s58, s58, 1024
    s_cmp_eq_u32 s58, s86
    s_cselect_b32 s58, s66, s58
    buffer_load_dwordx4 v[124:127], v23, s[24:27], s58 offen offset:0 sc1
    s_add_u32 s58, s58, 1024
    s_cmp_eq_u32 s58, s86
    s_cselect_b32 s58, s66, s58
    buffer_load_dwordx4 v[128:131], v23, s[24:27], s58 offen offset:0 sc1
    s_add_u32 s58, s58, 1024
    s_cmp_eq_u32 s58, s86
    s_cselect_b32 s58, s66, s58
    buffer_load_dwordx4 v[132:135], v23, s[24:27], s58 offen offset:0 sc1
    s_waitcnt vmcnt(10)
    ds_read_b64_tr_b16 a[224:225], v2 offset:0
    ds_read_b64_tr_b16 a[226:227], v2 offset:512
    ds_read_b64_tr_b16 a[228:229], v3 offset:0
    ds_read_b64_tr_b16 a[230:231], v3 offset:512
    s_add_u32 s58, s58, 1024
    s_cmp_eq_u32 s58, s86
    s_cselect_b32 s58, s66, s58
    buffer_load_dwordx4 v[136:139], v23, s[24:27], s58 offen offset:0 sc1
    ds_read_b64_tr_b16 a[232:233], v2 offset:256
    ds_read_b64_tr_b16 a[234:235], v2 offset:768
    ds_read_b64_tr_b16 a[236:237], v3 offset:256
    ds_read_b64_tr_b16 a[238:239], v3 offset:768
    s_add_u32 s58, s58, 1024
    s_cmp_eq_u32 s58, s86
    s_cselect_b32 s58, s66, s58
    buffer_load_dwordx4 v[140:143], v23, s[24:27], s58 offen offset:0 sc1
    s_add_u32 s58, s58, 1024
    s_cmp_eq_u32 s58, s86
    s_cselect_b32 s58, s66, s58
    buffer_load_dwordx4 v[144:147], v23, s[24:27], s58 offen offset:0 sc1
    s_add_u32 s58, s58, 1024
    s_cmp_eq_u32 s58, s86
    s_cselect_b32 s58, s66, s58
    buffer_load_dwordx4 v[148:151], v23, s[24:27], s58 offen offset:0 sc1
    s_waitcnt vmcnt(10)
    ds_read_b64_tr_b16 a[240:241], v2 offset:16384
    ds_read_b64_tr_b16 a[242:243], v2 offset:16896
    ds_read_b64_tr_b16 a[244:245], v3 offset:16384
    ds_read_b64_tr_b16 a[246:247], v3 offset:16896
    s_add_u32 s58, s58, 1024
    s_cmp_eq_u32 s58, s86
    s_cselect_b32 s58, s66, s58
    buffer_load_dwordx4 v[152:155], v23, s[24:27], s58 offen offset:0 sc1
    ds_read_b64_tr_b16 a[248:249], v2 offset:16640
    ds_read_b64_tr_b16 a[250:251], v2 offset:17152
    ds_read_b64_tr_b16 a[252:253], v3 offset:16640
    ds_read_b64_tr_b16 a[254:255], v3 offset:17152
    s_waitcnt vmcnt(10)
    v_mfma_f32_16x16x32_bf16 v[96:99], a[0:3], v[112:115], v[96:99]
    s_add_u32 s58, s58, 1024
    s_cmp_eq_u32 s58, s86
    s_cselect_b32 s58, s66, s58
    v_mfma_f32_16x16x32_bf16 v[100:103], a[4:7], v[112:115], v[100:103]
    buffer_load_dwordx4 v[156:159], v23, s[24:27], s58 offen offset:0 sc1
    v_mfma_f32_16x16x32_bf16 v[104:107], a[8:11], v[112:115], v[104:107]
    v_mfma_f32_16x16x32_bf16 v[108:111], a[12:15], v[112:115], v[108:111]
    s_waitcnt vmcnt(10)
    v_mfma_f32_16x16x32_bf16 v[96:99], a[16:19], v[116:119], v[96:99]
    s_add_u32 s58, s58, 1024
    s_cmp_eq_u32 s58, s86
    s_cselect_b32 s58, s66, s58
    v_mfma_f32_16x16x32_bf16 v[100:103], a[20:23], v[116:119], v[100:103]
    buffer_load_dwordx4 v[112:115], v23, s[24:27], s58 offen offset:0 sc1
    v_mfma_f32_16x16x32_bf16 v[104:107], a[24:27], v[116:119], v[104:107]
    v_mfma_f32_16x16x32_bf16 v[108:111], a[28:31], v[116:119], v[108:111]
    s_waitcnt vmcnt(10)
    v_mfma_f32_16x16x32_bf16 v[96:99], a[32:35], v[120:123], v[96:99]
    s_add_u32 s58, s58, 1024
    s_cmp_eq_u32 s58, s86
    s_cselect_b32 s58, s66, s58
    v_mfma_f32_16x16x32_bf16 v[100:103], a[36:39], v[120:123], v[100:103]
    buffer_load_dwordx4 v[116:119], v23, s[24:27], s58 offen offset:0 sc1
    v_mfma_f32_16x16x32_bf16 v[104:107], a[40:43], v[120:123], v[104:107]
    v_mfma_f32_16x16x32_bf16 v[108:111], a[44:47], v[120:123], v[108:111]
    s_waitcnt vmcnt(10)
    v_mfma_f32_16x16x32_bf16 v[96:99], a[48:51], v[124:127], v[96:99]
    s_add_u32 s58, s58, 1024
    s_cmp_eq_u32 s58, s86
    s_cselect_b32 s58, s66, s58
    v_mfma_f32_16x16x32_bf16 v[100:103], a[52:55], v[124:127], v[100:103]
    buffer_load_dwordx4 v[120:123], v23, s[24:27], s58 offen offset:0 sc1
    v_mfma_f32_16x16x32_bf16 v[104:107], a[56:59], v[124:127], v[104:107]
    v_mfma_f32_16x16x32_bf16 v[108:111], a[60:63], v[124:127], v[108:111]
    s_waitcnt vmcnt(10)
L_wb_0:
    s_cbranch_execz L_wb_ret
    v_mfma_f32_16x16x32_bf16 v[96:99], a[64:67], v[128:131], v[96:99]
    s_add_u32 s58, s58, 1024
    s_cmp_eq_u32 s58, s86
    s_cselect_b32 s58, s66, s58
    v_mfma_f32_16x16x32_bf16 v[100:103], a[68:71], v[128:131], v[100:103]
    buffer_load_dwordx4 v[124:127], v23, s[24:27], s58 offen offset:0 sc1
    v_mfma_f32_16x16x32_bf16 v[104:107], a[72:75], v[128:131], v[104:107]
    v_mfma_f32_16x16x32_bf16 v[108:111], a[76:79], v[128:131], v[108:111]
    s_waitcnt vmcnt(10)
    v_mfma_f32_16x16x32_bf16 v[96:99], a[80:83], v[132:135], v[96:99]
    s_xor_b32 s66, s44, 3
    s_lshl2_add_u32 s66, s51, s66
    s_mul_i32 s66, s66, 66816
    s_lshl2_add_u32 s66, s52, s66
    s_lshl_b32 s86, s65, 10
    s_add_u32 s58, s86, s66
    s_add_u32 s86, s66, 16384
    v_mfma_f32_16x16x32_bf16 v[100:103], a[84:87], v[132:135], v[100:103]
    buffer_load_dwordx4 v[128:131], v23, s[24:27], s58 offen offset:0 sc1
    v_mfma_f32_16x16x32_bf16 v[104:107], a[88:91], v[132:135], v[104:107]
    v_mfma_f32_16x16x32_bf16 v[108:111], a[92:95], v[132:135], v[108:111]
    s_waitcnt vmcnt(10)
    v_mfma_f32_16x16x32_bf16 v[96:99], a[96:99], v[136:139], v[96:99]
    s_add_u32 s58, s58, 1024
    s_cmp_eq_u32 s58, s86
    s_cselect_b32 s58, s66, s58
    v_mfma_f32_16x16x32_bf16 v[100:103], a[100:103], v[136:139], v[100:103]
    buffer_load_dwordx4 v[132:135], v23, s[24:27], s58 offen offset:0 sc1
    v_mfma_f32_16x16x32_bf16 v[104:107], a[104:107], v[136:139], v[104:107]
    v_mfma_f32_16x16x32_bf16 v[108:111], a[108:111], v[136:139], v[108:111]
    s_waitcnt vmcnt(10)
    v_mfma_f32_16x16x32_bf16 v[96:99], a[112:115], v[140:143], v[96:99]
    s_add_u32 s58, s58, 1024
    s_cmp_eq_u32 s58, s86
    s_cselect_b32 s58, s66, s58
    v_mfma_f32_16x16x32_bf16 v[100:103], a[116:119], v[140:143], v[100:103]
    buffer_load_dwordx4 v[136:139], v23, s[24:27], s58 offen offset:0 sc1
    v_mfma_f32_16x16x32_bf16 v[104:107], a[120:123], v[140:143], v[104:107]
    v_mfma_f32_16x16x32_bf16 v[108:111], a[124:127], v[140:143], v[108:111]
    s_waitcnt vmcnt(10)
    v_mfma_f32_16x16x32_bf16 v[96:99], a[128:131], v[144:147], v[96:99]
    s_add_u32 s58, s58, 1024
    s_cmp_eq_u32 s58, s86
    s_cselect_b32 s58, s66, s58
    v_mfma_f32_16x16x32_bf16 v[100:103], a[132:135], v[144:147], v[100:103]
    buffer_load_dwordx4 v[140:143], v23, s[24:27], s58 offen offset:0 sc1
    v_mfma_f32_16x16x32_bf16 v[104:107], a[136:139], v[144:147], v[104:107]
    v_mfma_f32_16x16x32_bf16 v[108:111], a[140:143], v[144:147], v[108:111]
    s_waitcnt vmcnt(10)
    v_mfma_f32_16x16x32_bf16 v[96:99], a[144:147], v[148:151], v[96:99]
    s_add_u32 s58, s58, 1024
    s_cmp_eq_u32 s58, s86
    s_cselect_b32 s58, s66, s58
    v_mfma_f32_16x16x32_bf16 v[100:103], a[148:151], v[148:151], v[100:103]
    buffer_load_dwordx4 v[144:147], v23, s[24:27], s58 offen offset:0 sc1
    v_mfma_f32_16x16x32_bf16 v[104:107], a[152:155], v[148:151], v[104:107]
    v_mfma_f32_16x16x32_bf16 v[108:111], a[156:159], v[148:151], v[108:111]
    s_waitcnt vmcnt(10)
    s_waitcnt lgkmcnt(15)
    v_mfma_f32_16x16x32_bf16 v[96:99], a[160:163], v[152:155], v[96:99]
    s_add_u32 s58, s58, 1024
    s_cmp_eq_u32 s58, s86
    s_cselect_b32 s58, s66, s58
    v_mfma_f32_16x16x32_bf16 v[100:103], a[164:167], v[152:155], v[100:103]
    buffer_load_dwordx4 v[148:151], v23, s[24:27], s58 offen offset:0 sc1
    v_mfma_f32_16x16x32_bf16 v[104:107], a[168:171], v[152:155], v[104:107]
    v_mfma_f32_16x16x32_bf16 v[108:111], a[172:175], v[152:155], v[108:111]
    s_waitcnt vmcnt(10)
    v_mfma_f32_16x16x32_bf16 v[96:99], a[176:179], v[156:159], v[96:99]
    s_add_u32 s58, s58, 1024
    s_cmp_eq_u32 s58, s86
    s_cselect_b32 s58, s66, s58
    v_mfma_f32_16x16x32_bf16 v[100:103], a[180:183], v[156:159], v[100:103]
    buffer_load_dwordx4 v[152:155], v23, s[24:27], s58 offen offset:0 sc1
    v_mfma_f32_16x16x32_bf16 v[104:107], a[184:187], v[156:159], v[104:107]
    v_mfma_f32_16x16x32_bf16 v[108:111], a[188:191], v[156:159], v[108:111]
    s_waitcnt vmcnt(10)
    v_mfma_f32_16x16x32_bf16 v[96:99], a[192:195], v[112:115], v[96:99]
    s_add_u32 s58, s58, 1024
    s_cmp_eq_u32 s58, s86
    s_cselect_b32 s58, s66, s58
    v_mfma_f32_16x16x32_bf16 v[100:103], a[196:199], v[112:115], v[100:103]
    buffer_load_dwordx4 v[156:159], v23, s[24:27], s58 offen offset:0 sc1
    v_mfma_f32_16x16x32_bf16 v[104:107], a[200:203], v[112:115], v[104:107]
    v_mfma_f32_16x16x32_bf16 v[108:111], a[204:207], v[112:115], v[108:111]
    s_waitcnt vmcnt(10)
    v_mfma_f32_16x16x32_bf16 v[96:99], a[208:211], v[116:119], v[96:99]
    s_add_u32 s58, s58, 1024
    s_cmp_eq_u32 s58, s86
    s_cselect_b32 s58, s66, s58
    v_mfma_f32_16x16x32_bf16 v[100:103], a[212:215], v[116:119], v[100:103]
    buffer_load_dwordx4 v[112:115], v23, s[24:27], s58 offen offset:0 sc1
    v_mfma_f32_16x16x32_bf16 v[104:107], a[216:219], v[116:119], v[104:107]
    v_mfma_f32_16x16x32_bf16 v[108:111], a[220:223], v[116:119], v[108:111]
    s_waitcnt vmcnt(10)
    s_waitcnt lgkmcnt(8)
    v_mfma_f32_16x16x32_bf16 v[96:99], a[224:227], v[120:123], v[96:99]
    s_add_u32 s58, s58, 1024
    s_cmp_eq_u32 s58, s86
    s_cselect_b32 s58, s66, s58
    v_mfma_f32_16x16x32_bf16 v[100:103], a[228:231], v[120:123], v[100:103]
    buffer_load_dwordx4 v[116:119], v23, s[24:27], s58 offen offset:0 sc1
    v_mfma_f32_16x16x32_bf16 v[104:107], a[232:235], v[120:123], v[104:107]
    v_mfma_f32_16x16x32_bf16 v[108:111], a[236:239], v[120:123], v[108:111]
    s_waitcnt vmcnt(10)
    s_waitcnt lgkmcnt(0)
    v_mfma_f32_16x16x32_bf16 v[96:99], a[240:243], v[124:127], v[96:99]
    s_add_u32 s58, s58, 1024
    s_cmp_eq_u32 s58, s86
    s_cselect_b32 s58, s66, s58
    v_mfma_f32_16x16x32_bf16 v[100:103], a[244:247], v[124:127], v[100:103]
    buffer_load_dwordx4 v[120:123], v23, s[24:27], s58 offen offset:0 sc1
    v_mfma_f32_16x16x32_bf16 v[104:107], a[248:251], v[124:127], v[104:107]
    v_mfma_f32_16x16x32_bf16 v[108:111], a[252:255], v[124:127], v[108:111]
L_p2_join:
    s_waitcnt vmcnt(10)
    v_mfma_f32_16x16x32_bf16 v[80:83], a[0:3], v[128:131], 0
    s_add_u32 s58, s58, 1024
    s_cmp_eq_u32 s58, s86
    s_cselect_b32 s58, s66, s58
    v_mfma_f32_16x16x32_bf16 v[84:87], a[4:7], v[128:131], 0
    buffer_load_dwordx4 v[124:127], v23, s[24:27], s58 offen offset:0 sc1
    v_mfma_f32_16x16x32_bf16 v[88:91], a[8:11], v[128:131], 0
    v_mfma_f32_16x16x32_bf16 v[92:95], a[12:15], v[128:131], 0
    s_waitcnt vmcnt(10)
    v_mfma_f32_16x16x32_bf16 v[80:83], a[16:19], v[132:135], v[80:83]
    v_mfma_f32_16x16x32_bf16 v[84:87], a[20:23], v[132:135], v[84:87]
    buffer_load_dwordx4 v[216:219], v22, s[4:7], s71 offen
    v_mfma_f32_16x16x32_bf16 v[88:91], a[24:27], v[132:135], v[88:91]
    ds_write_b128 v232, v[96:99] offset:49152
    v_mfma_f32_16x16x32_bf16 v[92:95], a[28:31], v[132:135], v[92:95]
    s_waitcnt vmcnt(10)
    v_mfma_f32_16x16x32_bf16 v[80:83], a[32:35], v[136:139], v[80:83]
    s_add_u32 s58, s58, 1024
    s_cmp_eq_u32 s58, s86
    s_cselect_b32 s58, s66, s58
    v_mfma_f32_16x16x32_bf16 v[84:87], a[36:39], v[136:139], v[84:87]
    buffer_load_dwordx4 v[128:131], v23, s[24:27], s58 offen offset:0 sc1
    v_mfma_f32_16x16x32_bf16 v[88:91], a[40:43], v[136:139], v[88:91]
    ds_write_b128 v232, v[100:103] offset:50176
    v_mfma_f32_16x16x32_bf16 v[92:95], a[44:47], v[136:139], v[92:95]
    s_waitcnt vmcnt(10)
    v_mfma_f32_16x16x32_bf16 v[80:83], a[48:51], v[140:143], v[80:83]
    v_mfma_f32_16x16x32_bf16 v[84:87], a[52:55], v[140:143], v[84:87]
    buffer_load_dwordx4 v[220:223], v22, s[4:7], s72 offen
    v_mfma_f32_16x16x32_bf16 v[88:91], a[56:59], v[140:143], v[88:91]
    ds_write_b128 v232, v[104:107] offset:51200
    v_mfma_f32_16x16x32_bf16 v[92:95], a[60:63], v[140:143], v[92:95]
    s_waitcnt vmcnt(10)
    v_mfma_f32_16x16x32_bf16 v[80:83], a[64:67], v[144:147], v[80:83]
    s_add_u32 s58, s58, 1024
    s_cmp_eq_u32 s58, s86
    s_cselect_b32 s58, s66, s58
    v_mfma_f32_16x16x32_bf16 v[84:87], a[68:71], v[144:147], v[84:87]
    buffer_load_dwordx4 v[132:135], v23, s[24:27], s58 offen offset:0 sc1
    v_mfma_f32_16x16x32_bf16 v[88:91], a[72:75], v[144:147], v[88:91]
    ds_write_b128 v232, v[108:111] offset:52224
    v_mfma_f32_16x16x32_bf16 v[92:95], a[76:79], v[144:147], v[92:95]
    s_waitcnt vmcnt(10)
    v_mfma_f32_16x16x32_bf16 v[80:83], a[80:83], v[148:151], v[80:83]
    v_mfma_f32_16x16x32_bf16 v[84:87], a[84:87], v[148:151], v[84:87]
    buffer_load_dwordx2 v[224:225], v26, s[4:7], s73 offen
    v_mfma_f32_16x16x32_bf16 v[88:91], a[88:91], v[148:151], v[88:91]
    v_mfma_f32_16x16x32_bf16 v[92:95], a[92:95], v[148:151], v[92:95]
    s_waitcnt vmcnt(10)
    v_mfma_f32_16x16x32_bf16 v[80:83], a[96:99], v[152:155], v[80:83]
    s_add_u32 s58, s58, 1024
    s_cmp_eq_u32 s58, s86
    s_cselect_b32 s58, s66, s58
    v_mfma_f32_16x16x32_bf16 v[84:87], a[100:103], v[152:155], v[84:87]
    buffer_load_dwordx4 v[136:139], v23, s[24:27], s58 offen offset:0 sc1
    v_mfma_f32_16x16x32_bf16 v[88:91], a[104:107], v[152:155], v[88:91]
    v_mfma_f32_16x16x32_bf16 v[92:95], a[108:111], v[152:155], v[92:95]
    s_waitcnt vmcnt(10)
    v_mfma_f32_16x16x32_bf16 v[80:83], a[112:115], v[156:159], v[80:83]
    v_mfma_f32_16x16x32_bf16 v[84:87], a[116:119], v[156:159], v[84:87]
    buffer_load_ushort v228, v25, s[36:39], s74 offen
    v_mfma_f32_16x16x32_bf16 v[88:91], a[120:123], v[156:159], v[88:91]
    s_waitcnt lgkmcnt(0)
    s_barrier
    v_mfma_f32_16x16x32_bf16 v[92:95], a[124:127], v[156:159], v[92:95]
    s_waitcnt vmcnt(10)
    v_mfma_f32_16x16x32_bf16 v[80:83], a[128:131], v[112:115], v[80:83]
    s_add_u32 s58, s58, 1024
    s_cmp_eq_u32 s58, s86
    s_cselect_b32 s58, s66, s58
    v_mfma_f32_16x16x32_bf16 v[84:87], a[132:135], v[112:115], v[84:87]
    buffer_load_dwordx4 v[140:143], v23, s[24:27], s58 offen offset:0 sc1
    v_mfma_f32_16x16x32_bf16 v[88:91], a[136:139], v[112:115], v[88:91]
    ds_read_b128 v[160:163], v243 offset:0
    ds_read_b128 v[164:167], v243 offset:1024
    v_mfma_f32_16x16x32_bf16 v[92:95], a[140:143], v[112:115], v[92:95]
    ds_read_b128 v[168:171], v243 offset:4096
    s_waitcnt vmcnt(10)
    v_mfma_f32_16x16x32_bf16 v[80:83], a[144:147], v[116:119], v[80:83]
    s_xor_b32 s66, s44, 2
    s_lshl2_add_u32 s66, s51, s66
    s_mul_i32 s66, s66, 66816
    s_lshl2_add_u32 s66, s52, s66
    s_lshl_b32 s86, s65, 10
    s_add_u32 s58, s86, s66
    s_add_u32 s86, s66, 16384
    v_mfma_f32_16x16x32_bf16 v[84:87], a[148:151], v[116:119], v[84:87]
    buffer_load_dwordx4 v[144:147], v23, s[24:27], s58 offen offset:0 sc1
    v_mfma_f32_16x16x32_bf16 v[88:91], a[152:155], v[116:119], v[88:91]
    ds_read_b128 v[172:175], v243 offset:5120
    ds_read_b128 v[176:179], v243 offset:8192
    v_mfma_f32_16x16x32_bf16 v[92:95], a[156:159], v[116:119], v[92:95]
    ds_read_b128 v[180:183], v243 offset:9216
    s_waitcnt vmcnt(10)
    v_mfma_f32_16x16x32_bf16 v[80:83], a[160:163], v[120:123], v[80:83]
    s_add_u32 s58, s58, 1024
    s_cmp_eq_u32 s58, s86
    s_cselect_b32 s58, s66, s58
    v_mfma_f32_16x16x32_bf16 v[84:87], a[164:167], v[120:123], v[84:87]
    buffer_load_dwordx4 v[148:151], v23, s[24:27], s58 offen offset:0 sc1
    v_mfma_f32_16x16x32_bf16 v[88:91], a[168:171], v[120:123], v[88:91]
    ds_read_b128 v[184:187], v243 offset:12288
    v_mfma_f32_16x16x32_bf16 v[92:95], a[172:175], v[120:123], v[92:95]
    ds_read_b128 v[188:191], v243 offset:13312
    s_waitcnt vmcnt(10)
    v_mfma_f32_16x16x32_bf16 v[80:83], a[176:179], v[124:127], v[80:83]
    s_add_u32 s58, s58, 1024
    s_cmp_eq_u32 s58, s86
    s_cselect_b32 s58, s66, s58
    v_mfma_f32_16x16x32_bf16 v[84:87], a[180:183], v[124:127], v[84:87]
    buffer_load_dwordx4 v[152:155], v23, s[24:27], s58 offen offset:0 sc1
    v_mfma_f32_16x16x32_bf16 v[88:91], a[184:187], v[124:127], v[88:91]
    v_mfma_f32_16x16x32_bf16 v[92:95], a[188:191], v[124:127], v[92:95]
    s_add_u32 s58, s58, 1024
    s_cmp_eq_u32 s58, s86
    s_cselect_b32 s58, s66, s58
    buffer_load_dwordx4 v[156:159], v23, s[24:27], s58 offen offset:0 sc1
    s_waitcnt vmcnt(10)
    v_mfma_f32_16x16x32_bf16 v[80:83], a[192:195], v[128:131], v[80:83]
    s_add_u32 s58, s58, 1024
    s_cmp_eq_u32 s58, s86
    s_cselect_b32 s58, s66, s58
    v_mfma_f32_16x16x32_bf16 v[84:87], a[196:199], v[128:131], v[84:87]
    buffer_load_dwordx4 v[112:115], v23, s[24:27], s58 offen offset:0 sc1
    v_mfma_f32_16x16x32_bf16 v[88:91], a[200:203], v[128:131], v[88:91]
    s_waitcnt lgkmcnt(0)
    v_add_f32 v160, v160, v168
    v_mfma_f32_16x16x32_bf16 v[92:95], a[204:207], v[128:131], v[92:95]
    v_add_f32 v161, v161, v169
    s_add_u32 s58, s58, 1024
    s_cmp_eq_u32 s58, s86
    s_cselect_b32 s58, s66, s58
    buffer_load_dwordx4 v[116:119], v23, s[24:27], s58 offen offset:0 sc1
    s_waitcnt vmcnt(10)
    v_mfma_f32_16x16x32_bf16 v[80:83], a[208:211], v[132:135], v[80:83]
    s_add_u32 s58, s58, 1024
    s_cmp_eq_u32 s58, s86
    s_cselect_b32 s58, s66, s58
    v_mfma_f32_16x16x32_bf16 v[84:87], a[212:215], v[132:135], v[84:87]
    buffer_load_dwordx4 v[120:123], v23, s[24:27], s58 offen offset:0 sc1
    v_mfma_f32_16x16x32_bf16 v[88:91], a[216:219], v[132:135], v[88:91]
    v_add_f32 v162, v162, v170
    v_add_f32 v163, v163, v171
    v_mfma_f32_16x16x32_bf16 v[92:95], a[220:223], v[132:135], v[92:95]
    v_add_f32 v164, v164, v172
    s_add_u32 s58, s58, 1024
    s_cmp_eq_u32 s58, s86
    s_cselect_b32 s58, s66, s58
    buffer_load_dwordx4 v[124:127], v23, s[24:27], s58 offen offset:0 sc1
    s_waitcnt vmcnt(10)
    v_mfma_f32_16x16x32_bf16 v[80:83], a[224:227], v[136:139], v[80:83]
    s_add_u32 s58, s58, 1024
    s_cmp_eq_u32 s58, s86
    s_cselect_b32 s58, s66, s58
    v_mfma_f32_16x16x32_bf16 v[84:87], a[228:231], v[136:139], v[84:87]
    buffer_load_dwordx4 v[128:131], v23, s[24:27], s58 offen offset:0 sc1
    v_mfma_f32_16x16x32_bf16 v[88:91], a[232:235], v[136:139], v[88:91]
    v_add_f32 v165, v165, v173
    v_add_f32 v166, v166, v174
    v_mfma_f32_16x16x32_bf16 v[92:95], a[236:239], v[136:139], v[92:95]
    v_add_f32 v167, v167, v175
    s_add_u32 s58, s58, 1024
    s_cmp_eq_u32 s58, s86
    s_cselect_b32 s58, s66, s58
    buffer_load_dwordx4 v[132:135], v23, s[24:27], s58 offen offset:0 sc1
    s_waitcnt vmcnt(10)
    v_mfma_f32_16x16x32_bf16 v[80:83], a[240:243], v[140:143], v[80:83]
    s_add_u32 s58, s58, 1024
    s_cmp_eq_u32 s58, s86
    s_cselect_b32 s58, s66, s58
    v_mfma_f32_16x16x32_bf16 v[84:87], a[244:247], v[140:143], v[84:87]
    buffer_load_dwordx4 v[136:139], v23, s[24:27], s58 offen offset:0 sc1
    v_mfma_f32_16x16x32_bf16 v[88:91], a[248:251], v[140:143], v[88:91]
    v_add_f32 v160, v160, v176
    v_add_f32 v161, v161, v177
    v_mfma_f32_16x16x32_bf16 v[92:95], a[252:255], v[140:143], v[92:95]
    v_add_f32 v162, v162, v178
    s_waitcnt vmcnt(10)
    v_mfma_f32_16x16x32_bf16 v[64:67], a[0:3], v[144:147], 0
    s_add_u32 s58, s58, 1024
    s_cmp_eq_u32 s58, s86
    s_cselect_b32 s58, s66, s58
    v_mfma_f32_16x16x32_bf16 v[68:71], a[4:7], v[144:147], 0
    buffer_load_dwordx4 v[140:143], v23, s[24:27], s58 offen offset:0 sc1
    v_mfma_f32_16x16x32_bf16 v[72:75], a[8:11], v[144:147], 0
    v_mfma_f32_16x16x32_bf16 v[76:79], a[12:15], v[144:147], 0
    s_waitcnt vmcnt(10)
    v_mfma_f32_16x16x32_bf16 v[64:67], a[16:19], v[148:151], v[64:67]
    s_add_u32 s58, s58, 1024
    s_cmp_eq_u32 s58, s86
    s_cselect_b32 s58, s66, s58
    v_mfma_f32_16x16x32_bf16 v[68:71], a[20:23], v[148:151], v[68:71]
    buffer_load_dwordx4 v[144:147], v23, s[24:27], s58 offen offset:0 sc1
    v_mfma_f32_16x16x32_bf16 v[72:75], a[24:27], v[148:151], v[72:75]
    ds_write_b128 v232, v[80:83] offset:32768
    v_mfma_f32_16x16x32_bf16 v[76:79], a[28:31], v[148:151], v[76:79]
    s_waitcnt vmcnt(10)
    v_mfma_f32_16x16x32_bf16 v[64:67], a[32:35], v[152:155], v[64:67]
    s_add_u32 s58, s58, 1024
    s_cmp_eq_u32 s58, s86
    s_cselect_b32 s58, s66, s58
    v_mfma_f32_16x16x32_bf16 v[68:71], a[36:39], v[152:155], v[68:71]
    buffer_load_dwordx4 v[148:151], v23, s[24:27], s58 offen offset:0 sc1
    v_mfma_f32_16x16x32_bf16 v[72:75], a[40:43], v[152:155], v[72:75]
    ds_write_b128 v232, v[84:87] offset:33792
    v_mfma_f32_16x16x32_bf16 v[76:79], a[44:47], v[152:155], v[76:79]
    s_waitcnt vmcnt(10)
    v_mfma_f32_16x16x32_bf16 v[64:67], a[48:51], v[156:159], v[64:67]
    s_add_u32 s58, s58, 1024
    s_cmp_eq_u32 s58, s86
    s_cselect_b32 s58, s66, s58
    ds_write_b128 v232, v[88:91] offset:34816
    v_mfma_f32_16x16x32_bf16 v[68:71], a[52:55], v[156:159], v[68:71]
    buffer_load_dwordx4 v[152:155], v23, s[24:27], s58 offen offset:0 sc1
    v_mfma_f32_16x16x32_bf16 v[72:75], a[56:59], v[156:159], v[72:75]
    v_add_f32 v163, v163, v179
    v_add_f32 v164, v164, v180
    v_mfma_f32_16x16x32_bf16 v[76:79], a[60:63], v[156:159], v[76:79]
    v_add_f32 v165, v165, v181
    s_waitcnt vmcnt(10)
    v_mfma_f32_16x16x32_bf16 v[64:67], a[64:67], v[112:115], v[64:67]
    s_add_u32 s58, s58, 1024
    s_cmp_eq_u32 s58, s86
    s_cselect_b32 s58, s66, s58
    ds_write_b128 v232, v[92:95] offset:35840
    v_mfma_f32_16x16x32_bf16 v[68:71], a[68:71], v[112:115], v[68:71]
    buffer_load_dwordx4 v[156:159], v23, s[24:27], s58 offen offset:0 sc1
    v_mfma_f32_16x16x32_bf16 v[72:75], a[72:75], v[112:115], v[72:75]
    v_add_f32 v166, v166, v182
    v_add_f32 v167, v167, v183
    v_mfma_f32_16x16x32_bf16 v[76:79], a[76:79], v[112:115], v[76:79]
    v_add_f32 v160, v160, v184
    s_waitcnt vmcnt(10)
    v_mfma_f32_16x16x32_bf16 v[64:67], a[80:83], v[116:119], v[64:67]
    s_xor_b32 s66, s44, 1
    s_lshl2_add_u32 s66, s51, s66
    s_mul_i32 s66, s66, 66816
    s_lshl2_add_u32 s66, s52, s66
    s_lshl_b32 s86, s65, 10
    s_add_u32 s58, s86, s66
    s_add_u32 s86, s66, 16384
    v_mfma_f32_16x16x32_bf16 v[68:71], a[84:87], v[116:119], v[68:71]
    buffer_load_dwordx4 v[112:115], v23, s[24:27], s58 offen offset:0 sc1
    v_mfma_f32_16x16x32_bf16 v[72:75], a[88:91], v[116:119], v[72:75]
    v_add_f32 v161, v161, v185
    v_add_f32 v162, v162, v186
    v_mfma_f32_16x16x32_bf16 v[76:79], a[92:95], v[116:119], v[76:79]
    v_add_f32 v163, v163, v187
    s_waitcnt vmcnt(10)
    v_mfma_f32_16x16x32_bf16 v[64:67], a[96:99], v[120:123], v[64:67]
    s_add_u32 s58, s58, 1024
    s_cmp_eq_u32 s58, s86
    s_cselect_b32 s58, s66, s58
    v_mfma_f32_16x16x32_bf16 v[68:71], a[100:103], v[120:123], v[68:71]
    buffer_load_dwordx4 v[116:119], v23, s[24:27], s58 offen offset:0 sc1
    v_mfma_f32_16x16x32_bf16 v[72:75], a[104:107], v[120:123], v[72:75]
    v_add_f32 v164, v164, v188
    v_add_f32 v165, v165, v189
    v_mfma_f32_16x16x32_bf16 v[76:79], a[108:111], v[120:123], v[76:79]
    v_add_f32 v166, v166, v190
    s_waitcnt vmcnt(10)
    v_mfma_f32_16x16x32_bf16 v[64:67], a[112:115], v[124:127], v[64:67]
    s_add_u32 s58, s58, 1024
    s_cmp_eq_u32 s58, s86
    s_cselect_b32 s58, s66, s58
    v_mfma_f32_16x16x32_bf16 v[68:71], a[116:119], v[124:127], v[68:71]
    buffer_load_dwordx4 v[120:123], v23, s[24:27], s58 offen offset:0 sc1
    v_mfma_f32_16x16x32_bf16 v[72:75], a[120:123], v[124:127], v[72:75]
    v_add_f32 v167, v167, v191
    v_mul_f32 v192, v160, v160
    v_mfma_f32_16x16x32_bf16 v[76:79], a[124:127], v[124:127], v[76:79]
    v_mul_f32 v193, v161, v161
    s_waitcnt vmcnt(10)
    v_mfma_f32_16x16x32_bf16 v[64:67], a[128:131], v[128:131], v[64:67]
    s_add_u32 s58, s58, 1024
    s_cmp_eq_u32 s58, s86
    s_cselect_b32 s58, s66, s58
    v_mfma_f32_16x16x32_bf16 v[68:71], a[132:135], v[128:131], v[68:71]
    buffer_load_dwordx4 v[124:127], v23, s[24:27], s58 offen offset:0 sc1
    v_mfma_f32_16x16x32_bf16 v[72:75], a[136:139], v[128:131], v[72:75]
    v_mul_f32 v194, v162, v162
    v_mul_f32 v195, v163, v163
    v_mfma_f32_16x16x32_bf16 v[76:79], a[140:143], v[128:131], v[76:79]
    v_mul_f32 v196, v164, v164
    s_waitcnt vmcnt(10)
    v_mfma_f32_16x16x32_bf16 v[64:67], a[144:147], v[132:135], v[64:67]
    s_add_u32 s58, s58, 1024
    s_cmp_eq_u32 s58, s86
    s_cselect_b32 s58, s66, s58
    v_mfma_f32_16x16x32_bf16 v[68:71], a[148:151], v[132:135], v[68:71]
    buffer_load_dwordx4 v[128:131], v23, s[24:27], s58 offen offset:0 sc1
    v_mfma_f32_16x16x32_bf16 v[72:75], a[152:155], v[132:135], v[72:75]
    v_mul_f32 v197, v165, v165
    v_mul_f32 v198, v166, v166
    v_mfma_f32_16x16x32_bf16 v[76:79], a[156:159], v[132:135], v[76:79]
    v_mul_f32 v199, v167, v167
    ds_write_b128 v244, v[216:219]
    s_waitcnt vmcnt(10)
    v_mfma_f32_16x16x32_bf16 v[64:67], a[160:163], v[136:139], v[64:67]
    s_add_u32 s58, s58, 1024
    s_cmp_eq_u32 s58, s86
    s_cselect_b32 s58, s66, s58
    v_mfma_f32_16x16x32_bf16 v[68:71], a[164:167], v[136:139], v[68:71]
    buffer_load_dwordx4 v[132:135], v23, s[24:27], s58 offen offset:0 sc1
    v_mfma_f32_16x16x32_bf16 v[72:75], a[168:171], v[136:139], v[72:75]
    v_fma_f32 v192, v192, v236, v237
    v_fma_f32 v193, v193, v236, v237
    v_mfma_f32_16x16x32_bf16 v[76:79], a[172:175], v[136:139], v[76:79]
    v_fma_f32 v194, v194, v236, v237
    s_waitcnt vmcnt(10)
    v_mfma_f32_16x16x32_bf16 v[64:67], a[176:179], v[140:143], v[64:67]
    s_add_u32 s58, s58, 1024
    s_cmp_eq_u32 s58, s86
    s_cselect_b32 s58, s66, s58
    v_mfma_f32_16x16x32_bf16 v[68:71], a[180:183], v[140:143], v[68:71]
    buffer_load_dwordx4 v[136:139], v23, s[24:27], s58 offen offset:0 sc1
    v_mfma_f32_16x16x32_bf16 v[72:75], a[184:187], v[140:143], v[72:75]
    v_fma_f32 v195, v195, v236, v237
    v_fma_f32 v196, v196, v236, v237
    v_mfma_f32_16x16x32_bf16 v[76:79], a[188:191], v[140:143], v[76:79]
    v_fma_f32 v197, v197, v236, v237
    ds_write_b128 v244, v[220:223] offset:1408
    s_waitcnt vmcnt(10)
    v_mfma_f32_16x16x32_bf16 v[64:67], a[192:195], v[144:147], v[64:67]
    s_add_u32 s58, s58, 1024
    s_cmp_eq_u32 s58, s86
    s_cselect_b32 s58, s66, s58
    v_mfma_f32_16x16x32_bf16 v[68:71], a[196:199], v[144:147], v[68:71]
    buffer_load_dwordx4 v[140:143], v23, s[24:27], s58 offen offset:0 sc1
    v_mfma_f32_16x16x32_bf16 v[72:75], a[200:203], v[144:147], v[72:75]
    v_fma_f32 v198, v198, v236, v237
    v_fma_f32 v199, v199, v236, v237
    v_mfma_f32_16x16x32_bf16 v[76:79], a[204:207], v[144:147], v[76:79]
    v_mul_f32 v192, v192, v160
    s_waitcnt vmcnt(10)
    v_mfma_f32_16x16x32_bf16 v[64:67], a[208:211], v[148:151], v[64:67]
    s_add_u32 s58, s58, 1024
    s_cmp_eq_u32 s58, s86
    s_cselect_b32 s58, s66, s58
    v_mfma_f32_16x16x32_bf16 v[68:71], a[212:215], v[148:151], v[68:71]
    buffer_load_dwordx4 v[144:147], v23, s[24:27], s58 offen offset:0 sc1
    v_mfma_f32_16x16x32_bf16 v[72:75], a[216:219], v[148:151], v[72:75]
    v_mul_f32 v193, v193, v161
    v_mul_f32 v194, v194, v162
    v_mfma_f32_16x16x32_bf16 v[76:79], a[220:223], v[148:151], v[76:79]
    v_mul_f32 v195, v195, v163
    ds_write_b64 v252, v[224:225] offset:128
    s_waitcnt vmcnt(10)
    v_mfma_f32_16x16x32_bf16 v[64:67], a[224:227], v[152:155], v[64:67]
    s_add_u32 s58, s58, 1024
    s_cmp_eq_u32 s58, s86
    s_cselect_b32 s58, s66, s58
    v_mfma_f32_16x16x32_bf16 v[68:71], a[228:231], v[152:155], v[68:71]
    buffer_load_dwordx4 v[148:151], v23, s[24:27], s58 offen offset:0 sc1
    v_mfma_f32_16x16x32_bf16 v[72:75], a[232:235], v[152:155], v[72:75]
    v_mul_f32 v196, v196, v164
    v_mul_f32 v197, v197, v165
    v_mfma_f32_16x16x32_bf16 v[76:79], a[236:239], v[152:155], v[76:79]
    v_mul_f32 v198, v198, v166
    s_waitcnt vmcnt(10)
    v_mfma_f32_16x16x32_bf16 v[64:67], a[240:243], v[156:159], v[64:67]
    s_add_u32 s58, s58, 1024
    s_cmp_eq_u32 s58, s86
    s_cselect_b32 s58, s66, s58
    v_mfma_f32_16x16x32_bf16 v[68:71], a[244:247], v[156:159], v[68:71]
    buffer_load_dwordx4 v[152:155], v23, s[24:27], s58 offen offset:0 sc1
    v_mfma_f32_16x16x32_bf16 v[72:75], a[248:251], v[156:159], v[72:75]
    v_mul_f32 v199, v199, v167
    v_mfma_f32_16x16x32_bf16 v[76:79], a[252:255], v[156:159], v[76:79]
    ds_read_b64 v[216:217], v238 offset:0
    ds_read_b64 v[218:219], v238 offset:32
    ds_read_b64 v[220:221], v238 offset:64
    ds_read_b64 v[222:223], v238 offset:96
    ds_read_b64 v[224:225], v238 offset:128
    s_waitcnt vmcnt(10)
    v_mfma_f32_16x16x32_bf16 v[48:51], a[0:3], v[112:115], 0
    s_add_u32 s58, s58, 1024
    s_cmp_eq_u32 s58, s86
    s_cselect_b32 s58, s66, s58
    v_mfma_f32_16x16x32_bf16 v[52:55], a[4:7], v[112:115], 0
    buffer_load_dwordx4 v[156:159], v23, s[24:27], s58 offen offset:0 sc1
    v_mfma_f32_16x16x32_bf16 v[56:59], a[8:11], v[112:115], 0
    v_mfma_f32_16x16x32_bf16 v[60:63], a[12:15], v[112:115], 0
    s_waitcnt vmcnt(10)
    v_mfma_f32_16x16x32_bf16 v[48:51], a[16:19], v[116:119], v[48:51]
    s_add_u32 s58, s58, 1024
    s_cmp_eq_u32 s58, s86
    s_cselect_b32 s58, s66, s58
    v_mfma_f32_16x16x32_bf16 v[52:55], a[20:23], v[116:119], v[52:55]
    buffer_load_dwordx4 v[112:115], v23, s[24:27], s58 offen offset:0 sc1
    v_mfma_f32_16x16x32_bf16 v[56:59], a[24:27], v[116:119], v[56:59]
    ds_write_b128 v232, v[64:67] offset:16384
    v_mfma_f32_16x16x32_bf16 v[60:63], a[28:31], v[116:119], v[60:63]
    s_waitcnt vmcnt(10)
    v_mfma_f32_16x16x32_bf16 v[48:51], a[32:35], v[120:123], v[48:51]
    s_add_u32 s58, s58, 1024
    s_cmp_eq_u32 s58, s86
    s_cselect_b32 s58, s66, s58
    v_mfma_f32_16x16x32_bf16 v[52:55], a[36:39], v[120:123], v[52:55]
    buffer_load_dwordx4 v[116:119], v23, s[24:27], s58 offen offset:0 sc1
    v_mfma_f32_16x16x32_bf16 v[56:59], a[40:43], v[120:123], v[56:59]
    ds_write_b128 v232, v[68:71] offset:17408
    v_mfma_f32_16x16x32_bf16 v[60:63], a[44:47], v[120:123], v[60:63]
    s_waitcnt vmcnt(10)
    v_mfma_f32_16x16x32_bf16 v[48:51], a[48:51], v[124:127], v[48:51]
    s_add_u32 s58, s58, 1024
    s_cmp_eq_u32 s58, s86
    s_cselect_b32 s58, s66, s58
    ds_write_b128 v232, v[72:75] offset:18432
    v_mfma_f32_16x16x32_bf16 v[52:55], a[52:55], v[124:127], v[52:55]
    buffer_load_dwordx4 v[120:123], v23, s[24:27], s58 offen offset:0 sc1
    v_mfma_f32_16x16x32_bf16 v[56:59], a[56:59], v[124:127], v[56:59]
    v_exp_f32 v192, v192
    v_exp_f32 v193, v193
    v_mfma_f32_16x16x32_bf16 v[60:63], a[60:63], v[124:127], v[60:63]
    v_exp_f32 v194, v194
    s_waitcnt vmcnt(10)
    v_mfma_f32_16x16x32_bf16 v[48:51], a[64:67], v[128:131], v[48:51]
    s_add_u32 s58, s58, 1024
    s_cmp_eq_u32 s58, s86
    s_cselect_b32 s58, s66, s58
    ds_write_b128 v232, v[76:79] offset:19456
    v_mfma_f32_16x16x32_bf16 v[52:55], a[68:71], v[128:131], v[52:55]
    buffer_load_dwordx4 v[124:127], v23, s[24:27], s58 offen offset:0 sc1
    v_mfma_f32_16x16x32_bf16 v[56:59], a[72:75], v[128:131], v[56:59]
    v_exp_f32 v195, v195
    v_exp_f32 v196, v196
    v_mfma_f32_16x16x32_bf16 v[60:63], a[76:79], v[128:131], v[60:63]
    v_exp_f32 v197, v197
    s_waitcnt vmcnt(10)
    v_mfma_f32_16x16x32_bf16 v[48:51], a[80:83], v[132:135], v[48:51]
    s_xor_b32 s66, s44, 0
    s_lshl2_add_u32 s66, s51, s66
    s_mul_i32 s66, s66, 66816
    s_lshl2_add_u32 s66, s52, s66
    s_lshl_b32 s86, s65, 10
    s_add_u32 s58, s86, s66
    s_add_u32 s86, s66, 16384
    v_mfma_f32_16x16x32_bf16 v[52:55], a[84:87], v[132:135], v[52:55]
    buffer_load_dwordx4 v[128:131], v23, s[24:27], s58 offen offset:0 sc1
    v_mfma_f32_16x16x32_bf16 v[56:59], a[88:91], v[132:135], v[56:59]
    v_exp_f32 v198, v198
    v_exp_f32 v199, v199
    v_mfma_f32_16x16x32_bf16 v[60:63], a[92:95], v[132:135], v[60:63]
    v_add_f32 v192, 1.0, v192
    s_waitcnt vmcnt(10)
    v_mfma_f32_16x16x32_bf16 v[48:51], a[96:99], v[136:139], v[48:51]
    s_add_u32 s58, s58, 1024
    s_cmp_eq_u32 s58, s86
    s_cselect_b32 s58, s66, s58
    v_mfma_f32_16x16x32_bf16 v[52:55], a[100:103], v[136:139], v[52:55]
    buffer_load_dwordx4 v[132:135], v23, s[24:27], s58 offen offset:0 sc1
    v_mfma_f32_16x16x32_bf16 v[56:59], a[104:107], v[136:139], v[56:59]
    v_add_f32 v193, 1.0, v193
    v_add_f32 v194, 1.0, v194
    v_mfma_f32_16x16x32_bf16 v[60:63], a[108:111], v[136:139], v[60:63]
    v_add_f32 v195, 1.0, v195
    s_waitcnt vmcnt(10)
    v_mfma_f32_16x16x32_bf16 v[48:51], a[112:115], v[140:143], v[48:51]
    s_add_u32 s58, s58, 1024
    s_cmp_eq_u32 s58, s86
    s_cselect_b32 s58, s66, s58
    v_mfma_f32_16x16x32_bf16 v[52:55], a[116:119], v[140:143], v[52:55]
    buffer_load_dwordx4 v[136:139], v23, s[24:27], s58 offen offset:0 sc1
    v_mfma_f32_16x16x32_bf16 v[56:59], a[120:123], v[140:143], v[56:59]
    v_add_f32 v196, 1.0, v196
    v_add_f32 v197, 1.0, v197
    v_mfma_f32_16x16x32_bf16 v[60:63], a[124:127], v[140:143], v[60:63]
    v_add_f32 v198, 1.0, v198
    s_waitcnt vmcnt(10)
    v_mfma_f32_16x16x32_bf16 v[48:51], a[128:131], v[144:147], v[48:51]
    s_add_u32 s58, s58, 1024
    s_cmp_eq_u32 s58, s86
    s_cselect_b32 s58, s66, s58
    v_mfma_f32_16x16x32_bf16 v[52:55], a[132:135], v[144:147], v[52:55]
    buffer_load_dwordx4 v[140:143], v23, s[24:27], s58 offen offset:0 sc1
    v_mfma_f32_16x16x32_bf16 v[56:59], a[136:139], v[144:147], v[56:59]
    v_add_f32 v199, 1.0, v199
    v_rcp_f32 v192, v192
    v_mfma_f32_16x16x32_bf16 v[60:63], a[140:143], v[144:147], v[60:63]
    v_rcp_f32 v193, v193
    s_waitcnt vmcnt(10)
    v_mfma_f32_16x16x32_bf16 v[48:51], a[144:147], v[148:151], v[48:51]
    s_add_u32 s58, s58, 1024
    s_cmp_eq_u32 s58, s86
    s_cselect_b32 s58, s66, s58
    v_mfma_f32_16x16x32_bf16 v[52:55], a[148:151], v[148:151], v[52:55]
    buffer_load_dwordx4 v[144:147], v23, s[24:27], s58 offen offset:0 sc1
    v_mfma_f32_16x16x32_bf16 v[56:59], a[152:155], v[148:151], v[56:59]
    v_rcp_f32 v194, v194
    v_rcp_f32 v195, v195
    v_mfma_f32_16x16x32_bf16 v[60:63], a[156:159], v[148:151], v[60:63]
    v_rcp_f32 v196, v196
    s_waitcnt vmcnt(10)
    v_mfma_f32_16x16x32_bf16 v[48:51], a[160:163], v[152:155], v[48:51]
    s_add_u32 s58, s58, 1024
    s_cmp_eq_u32 s58, s86
    s_cselect_b32 s58, s66, s58
    v_mfma_f32_16x16x32_bf16 v[52:55], a[164:167], v[152:155], v[52:55]
    buffer_load_dwordx4 v[148:151], v23, s[24:27], s58 offen offset:0 sc1
    v_mfma_f32_16x16x32_bf16 v[56:59], a[168:171], v[152:155], v[56:59]
    v_rcp_f32 v197, v197
    v_rcp_f32 v198, v198
    v_mfma_f32_16x16x32_bf16 v[60:63], a[172:175], v[152:155], v[60:63]
    v_rcp_f32 v199, v199
    s_waitcnt vmcnt(10)
    v_mfma_f32_16x16x32_bf16 v[48:51], a[176:179], v[156:159], v[48:51]
    s_add_u32 s58, s58, 1024
    s_cmp_eq_u32 s58, s86
    s_cselect_b32 s58, s66, s58
    v_mfma_f32_16x16x32_bf16 v[52:55], a[180:183], v[156:159], v[52:55]
    buffer_load_dwordx4 v[152:155], v23, s[24:27], s58 offen offset:0 sc1
    v_mfma_f32_16x16x32_bf16 v[56:59], a[184:187], v[156:159], v[56:59]
    v_mul_f32 v192, v192, v160
    v_mul_f32 v193, v193, v161
    v_mfma_f32_16x16x32_bf16 v[60:63], a[188:191], v[156:159], v[60:63]
    v_mul_f32 v194, v194, v162
    s_waitcnt vmcnt(10)
    v_mfma_f32_16x16x32_bf16 v[48:51], a[192:195], v[112:115], v[48:51]
    s_add_u32 s58, s58, 1024
    s_cmp_eq_u32 s58, s86
    s_cselect_b32 s58, s66, s58
    v_mfma_f32_16x16x32_bf16 v[52:55], a[196:199], v[112:115], v[52:55]
    buffer_load_dwordx4 v[156:159], v23, s[24:27], s58 offen offset:0 sc1
L_wb_1:
    s_cbranch_execz L_wb_ret
    v_mfma_f32_16x16x32_bf16 v[56:59], a[200:203], v[112:115], v[56:59]
    v_mul_f32 v195, v195, v163
    v_mul_f32 v196, v196, v164
    v_mfma_f32_16x16x32_bf16 v[60:63], a[204:207], v[112:115], v[60:63]
    v_mul_f32 v197, v197, v165
    s_waitcnt vmcnt(10)
    v_mfma_f32_16x16x32_bf16 v[48:51], a[208:211], v[116:119], v[48:51]
    s_add_u32 s58, s58, 1024
    s_cmp_eq_u32 s58, s86
    s_cselect_b32 s58, s66, s58
    v_mfma_f32_16x16x32_bf16 v[52:55], a[212:215], v[116:119], v[52:55]
    buffer_load_dwordx4 v[112:115], v23, s[24:27], s58 offen offset:0 sc1
    v_mfma_f32_16x16x32_bf16 v[56:59], a[216:219], v[116:119], v[56:59]
    v_mul_f32 v198, v198, v166
    v_mul_f32 v199, v199, v167
    v_mfma_f32_16x16x32_bf16 v[60:63], a[220:223], v[116:119], v[60:63]
    v_cvt_pk_bf16_f32 v96, v192, v193
    s_waitcnt vmcnt(10)
    v_mfma_f32_16x16x32_bf16 v[48:51], a[224:227], v[120:123], v[48:51]
    s_add_u32 s58, s58, 1024
    s_cmp_eq_u32 s58, s86
    s_cselect_b32 s58, s66, s58
    v_mfma_f32_16x16x32_bf16 v[52:55], a[228:231], v[120:123], v[52:55]
    buffer_load_dwordx4 v[116:119], v23, s[24:27], s58 offen offset:0 sc1
    v_mfma_f32_16x16x32_bf16 v[56:59], a[232:235], v[120:123], v[56:59]
    v_cvt_pk_bf16_f32 v97, v194, v195
    v_cvt_pk_bf16_f32 v98, v196, v197
    v_mfma_f32_16x16x32_bf16 v[60:63], a[236:239], v[120:123], v[60:63]
    v_cvt_pk_bf16_f32 v99, v198, v199
    s_waitcnt vmcnt(10)
    v_mfma_f32_16x16x32_bf16 v[48:51], a[240:243], v[124:127], v[48:51]
    s_add_u32 s58, s58, 1024
    s_cmp_eq_u32 s58, s86
    s_cselect_b32 s58, s66, s58
    v_mfma_f32_16x16x32_bf16 v[52:55], a[244:247], v[124:127], v[52:55]
    buffer_load_dwordx4 v[120:123], v23, s[24:27], s58 offen offset:0 sc1
    v_mfma_f32_16x16x32_bf16 v[56:59], a[248:251], v[124:127], v[56:59]
    v_mfma_f32_16x16x32_bf16 v[60:63], a[252:255], v[124:127], v[60:63]
    s_waitcnt vmcnt(10)
    v_mfma_f32_16x16x32_bf16 v[32:35], a[0:3], v[128:131], v[32:35]
    s_add_u32 s58, s58, 1024
    s_cmp_eq_u32 s58, s86
    s_cselect_b32 s58, s66, s58
    v_mfma_f32_16x16x32_bf16 v[36:39], a[4:7], v[128:131], v[36:39]
    buffer_load_dwordx4 v[124:127], v23, s[24:27], s58 offen offset:0 sc1
    v_mfma_f32_16x16x32_bf16 v[40:43], a[8:11], v[128:131], v[40:43]
    v_mfma_f32_16x16x32_bf16 v[44:47], a[12:15], v[128:131], v[44:47]
    s_waitcnt vmcnt(10)
    v_mfma_f32_16x16x32_bf16 v[32:35], a[16:19], v[132:135], v[32:35]
    s_add_u32 s58, s58, 1024
    s_cmp_eq_u32 s58, s86
    s_cselect_b32 s58, s66, s58
    v_mfma_f32_16x16x32_bf16 v[36:39], a[20:23], v[132:135], v[36:39]
    buffer_load_dwordx4 v[128:131], v23, s[24:27], s58 offen offset:0 sc1
    v_mfma_f32_16x16x32_bf16 v[40:43], a[24:27], v[132:135], v[40:43]
    ds_write_b128 v232, v[48:51] offset:0
    v_mfma_f32_16x16x32_bf16 v[44:47], a[28:31], v[132:135], v[44:47]
    ds_write_b128 v232, v[52:55] offset:1024
    s_waitcnt vmcnt(10)
    v_mfma_f32_16x16x32_bf16 v[32:35], a[32:35], v[136:139], v[32:35]
    s_add_u32 s58, s58, 1024
    s_cmp_eq_u32 s58, s86
    s_cselect_b32 s58, s66, s58
    v_mfma_f32_16x16x32_bf16 v[36:39], a[36:39], v[136:139], v[36:39]
    buffer_load_dwordx4 v[132:135], v23, s[24:27], s58 offen offset:0 sc1
    v_mfma_f32_16x16x32_bf16 v[40:43], a[40:43], v[136:139], v[40:43]
    ds_write_b128 v232, v[56:59] offset:2048
    v_mfma_f32_16x16x32_bf16 v[44:47], a[44:47], v[136:139], v[44:47]
    ds_write_b128 v232, v[60:63] offset:3072
    s_waitcnt vmcnt(10)
    v_mfma_f32_16x16x32_bf16 v[32:35], a[48:51], v[140:143], v[32:35]
    s_add_u32 s58, s58, 1024
    s_cmp_eq_u32 s58, s86
    s_cselect_b32 s58, s66, s58
    v_mfma_f32_16x16x32_bf16 v[36:39], a[52:55], v[140:143], v[36:39]
    buffer_load_dwordx4 v[136:139], v23, s[24:27], s58 offen offset:0 sc1
    v_mfma_f32_16x16x32_bf16 v[40:43], a[56:59], v[140:143], v[40:43]
    v_mfma_f32_16x16x32_bf16 v[44:47], a[60:63], v[140:143], v[44:47]
    s_waitcnt vmcnt(10)
    v_mfma_f32_16x16x32_bf16 v[32:35], a[64:67], v[144:147], v[32:35]
    s_add_u32 s58, s58, 1024
    s_cmp_eq_u32 s58, s86
    s_cselect_b32 s58, s66, s58
    v_mfma_f32_16x16x32_bf16 v[36:39], a[68:71], v[144:147], v[36:39]
    buffer_load_dwordx4 v[140:143], v23, s[24:27], s58 offen offset:0 sc1
    v_mfma_f32_16x16x32_bf16 v[40:43], a[72:75], v[144:147], v[40:43]
    v_mfma_f32_16x16x32_bf16 v[44:47], a[76:79], v[144:147], v[44:47]
    s_waitcnt vmcnt(10)
    v_mfma_f32_16x16x32_bf16 v[32:35], a[80:83], v[148:151], v[32:35]
    s_add_u32 m0, s52, 81920
    s_lshl_b32 s57, s76, 7
    v_mfma_f32_16x16x32_bf16 v[36:39], a[84:87], v[148:151], v[36:39]
    buffer_load_dwordx4 v12, s[20:23], s57 offen offset:0 lds
    v_mfma_f32_16x16x32_bf16 v[40:43], a[88:91], v[148:151], v[40:43]
    s_waitcnt lgkmcnt(0)
    s_barrier
    v_mfma_f32_16x16x32_bf16 v[44:47], a[92:95], v[148:151], v[44:47]
    s_waitcnt vmcnt(10)
    v_mfma_f32_16x16x32_bf16 v[32:35], a[96:99], v[152:155], v[32:35]
    s_add_u32 s57, s57, 31744
    v_mfma_f32_16x16x32_bf16 v[36:39], a[100:103], v[152:155], v[36:39]
    buffer_load_dwordx4 v12, s[20:23], s57 offen offset:1024 lds
    v_mfma_f32_16x16x32_bf16 v[40:43], a[104:107], v[152:155], v[40:43]
    ds_read_b128 v[160:163], v233 offset:0
    ds_read_b128 v[176:179], v234 offset:16384
    v_mfma_f32_16x16x32_bf16 v[44:47], a[108:111], v[152:155], v[44:47]
    ds_read_b128 v[192:195], v235 offset:32768
    s_waitcnt vmcnt(10)
    v_mfma_f32_16x16x32_bf16 v[32:35], a[112:115], v[156:159], v[32:35]
    s_add_u32 s57, s57, 31744
    v_mfma_f32_16x16x32_bf16 v[36:39], a[116:119], v[156:159], v[36:39]
    buffer_load_dwordx4 v12, s[20:23], s57 offen offset:2048 lds
    v_mfma_f32_16x16x32_bf16 v[40:43], a[120:123], v[156:159], v[40:43]
    ds_read_b128 v[164:167], v233 offset:1024
    ds_read_b128 v[180:183], v234 offset:17408
    v_mfma_f32_16x16x32_bf16 v[44:47], a[124:127], v[156:159], v[44:47]
    ds_read_b128 v[196:199], v235 offset:33792
    s_waitcnt vmcnt(10)
    v_mfma_f32_16x16x32_bf16 v[32:35], a[128:131], v[112:115], v[32:35]
    s_add_u32 s57, s57, 31744
    v_mfma_f32_16x16x32_bf16 v[36:39], a[132:135], v[112:115], v[36:39]
    buffer_load_dwordx4 v12, s[20:23], s57 offen offset:3072 lds
    v_mfma_f32_16x16x32_bf16 v[40:43], a[136:139], v[112:115], v[40:43]
    ds_read_b128 v[168:171], v233 offset:2048
    ds_read_b128 v[184:187], v234 offset:18432
    v_mfma_f32_16x16x32_bf16 v[44:47], a[140:143], v[112:115], v[44:47]
    ds_read_b128 v[200:203], v235 offset:34816
    s_waitcnt vmcnt(10)
    v_mfma_f32_16x16x32_bf16 v[32:35], a[144:147], v[116:119], v[32:35]
    s_add_u32 m0, s52, 98304
    s_lshl_b32 s57, s76, 7
    s_add_u32 s57, s57, 131072
    v_mfma_f32_16x16x32_bf16 v[36:39], a[148:151], v[116:119], v[36:39]
    buffer_load_dwordx4 v12, s[20:23], s57 offen offset:0 lds
    v_mfma_f32_16x16x32_bf16 v[40:43], a[152:155], v[116:119], v[40:43]
    ds_read_b128 v[172:175], v233 offset:3072
    ds_read_b128 v[188:191], v234 offset:19456
    v_mfma_f32_16x16x32_bf16 v[44:47], a[156:159], v[116:119], v[44:47]
    ds_read_b128 v[204:207], v235 offset:35840
    s_waitcnt vmcnt(10)
    v_mfma_f32_16x16x32_bf16 v[32:35], a[160:163], v[120:123], v[32:35]
    s_add_u32 s57, s57, 31744
    v_mfma_f32_16x16x32_bf16 v[36:39], a[164:167], v[120:123], v[36:39]
    buffer_load_dwordx4 v12, s[20:23], s57 offen offset:1024 lds
    v_mfma_f32_16x16x32_bf16 v[40:43], a[168:171], v[120:123], v[40:43]
    v_mfma_f32_16x16x32_bf16 v[44:47], a[172:175], v[120:123], v[44:47]
    s_waitcnt vmcnt(10)
    v_mfma_f32_16x16x32_bf16 v[32:35], a[176:179], v[124:127], v[32:35]
    s_add_u32 s57, s57, 31744
    s_waitcnt lgkmcnt(9)
    v_mfma_f32_16x16x32_bf16 v[36:39], a[180:183], v[124:127], v[36:39]
    buffer_load_dwordx4 v12, s[20:23], s57 offen offset:2048 lds
    v_mfma_f32_16x16x32_bf16 v[40:43], a[184:187], v[124:127], v[40:43]
    v_add_f32 v160, v160, v176
    v_add_f32 v161, v161, v177
    v_mfma_f32_16x16x32_bf16 v[44:47], a[188:191], v[124:127], v[44:47]
    v_add_f32 v162, v162, v178
    s_waitcnt vmcnt(10)
    v_mfma_f32_16x16x32_bf16 v[32:35], a[192:195], v[128:131], v[32:35]
    s_add_u32 s57, s57, 31744
    v_add_f32 v163, v163, v179
    v_mfma_f32_16x16x32_bf16 v[36:39], a[196:199], v[128:131], v[36:39]
    buffer_load_dwordx4 v12, s[20:23], s57 offen offset:3072 lds
    v_mfma_f32_16x16x32_bf16 v[40:43], a[200:203], v[128:131], v[40:43]
    s_waitcnt lgkmcnt(6)
    v_add_f32 v164, v164, v180
    v_mfma_f32_16x16x32_bf16 v[44:47], a[204:207], v[128:131], v[44:47]
    v_add_f32 v165, v165, v181
    s_waitcnt vmcnt(10)
    v_mfma_f32_16x16x32_bf16 v[32:35], a[208:211], v[132:135], v[32:35]
    s_add_u32 m0, s52, 114688
    s_lshl_b32 s57, s77, 7
    v_add_f32 v166, v166, v182
    v_mfma_f32_16x16x32_bf16 v[36:39], a[212:215], v[132:135], v[36:39]
    buffer_load_dwordx4 v12, s[20:23], s57 offen offset:0 lds
    v_mfma_f32_16x16x32_bf16 v[40:43], a[216:219], v[132:135], v[40:43]
    v_add_f32 v167, v167, v183
    s_waitcnt lgkmcnt(3)
    v_mfma_f32_16x16x32_bf16 v[44:47], a[220:223], v[132:135], v[44:47]
    v_add_f32 v168, v168, v184
    s_waitcnt vmcnt(10)
    v_mfma_f32_16x16x32_bf16 v[32:35], a[224:227], v[136:139], v[32:35]
    s_add_u32 s57, s57, 31744
    v_add_f32 v169, v169, v185
    v_mfma_f32_16x16x32_bf16 v[36:39], a[228:231], v[136:139], v[36:39]
    buffer_load_dwordx4 v12, s[20:23], s57 offen offset:1024 lds
    v_mfma_f32_16x16x32_bf16 v[40:43], a[232:235], v[136:139], v[40:43]
    v_add_f32 v170, v170, v186
    v_add_f32 v171, v171, v187
    v_mfma_f32_16x16x32_bf16 v[44:47], a[236:239], v[136:139], v[44:47]
    s_waitcnt lgkmcnt(0)
    s_waitcnt vmcnt(10)
    v_mfma_f32_16x16x32_bf16 v[32:35], a[240:243], v[140:143], v[32:35]
    s_add_u32 s57, s57, 31744
    v_add_f32 v172, v172, v188
    v_mfma_f32_16x16x32_bf16 v[36:39], a[244:247], v[140:143], v[36:39]
    buffer_load_dwordx4 v12, s[20:23], s57 offen offset:2048 lds
    v_mfma_f32_16x16x32_bf16 v[40:43], a[248:251], v[140:143], v[40:43]
    v_add_f32 v173, v173, v189
    v_add_f32 v174, v174, v190
    v_mfma_f32_16x16x32_bf16 v[44:47], a[252:255], v[140:143], v[44:47]
    v_add_f32 v175, v175, v191
    v_pk_add_f32 v[160:161], v[160:161], v[192:193]
    v_pk_add_f32 v[162:163], v[162:163], v[194:195]
    v_pk_add_f32 v[164:165], v[164:165], v[196:197]
    v_pk_add_f32 v[166:167], v[166:167], v[198:199]
    v_pk_add_f32 v[168:169], v[168:169], v[200:201]
    v_pk_add_f32 v[170:171], v[170:171], v[202:203]
    v_pk_add_f32 v[172:173], v[172:173], v[204:205]
    v_pk_add_f32 v[174:175], v[174:175], v[206:207]
    buffer_store_dwordx4 v[96:99], v23, s[24:27], s83 offen sc1
    s_add_u32 s57, s57, 31744
    buffer_load_dwordx4 v12, s[20:23], s57 offen offset:3072 lds
    v_pk_add_f32 v[32:33], v[32:33], v[160:161]
    v_pk_add_f32 v[34:35], v[34:35], v[162:163]
    v_pk_add_f32 v[36:37], v[36:37], v[164:165]
    v_pk_add_f32 v[38:39], v[38:39], v[166:167]
    v_pk_mul_f32 v[48:49], v[32:33], v[32:33]
    v_pk_mul_f32 v[50:51], v[34:35], v[34:35]
    v_pk_mul_f32 v[52:53], v[36:37], v[36:37]
    v_pk_mul_f32 v[54:55], v[38:39], v[38:39]
    s_add_u32 m0, s52, 131072
    s_lshl_b32 s57, s77, 7
    s_add_u32 s57, s57, 131072
    buffer_load_dwordx4 v12, s[20:23], s57 offen offset:0 lds
    v_pk_fma_f32 v[48:49], v[48:49], v[236:237], v[236:237] op_sel:[0,0,1] op_sel_hi:[1,0,1]
    v_pk_fma_f32 v[50:51], v[50:51], v[236:237], v[236:237] op_sel:[0,0,1] op_sel_hi:[1,0,1]
    v_pk_fma_f32 v[52:53], v[52:53], v[236:237], v[236:237] op_sel:[0,0,1] op_sel_hi:[1,0,1]
    v_pk_fma_f32 v[54:55], v[54:55], v[236:237], v[236:237] op_sel:[0,0,1] op_sel_hi:[1,0,1]
    v_pk_mul_f32 v[48:49], v[48:49], v[32:33]
    v_pk_mul_f32 v[50:51], v[50:51], v[34:35]
    v_pk_mul_f32 v[52:53], v[52:53], v[36:37]
    v_pk_mul_f32 v[54:55], v[54:55], v[38:39]
    s_add_u32 s57, s57, 31744
    buffer_load_dwordx4 v12, s[20:23], s57 offen offset:1024 lds
    s_waitcnt vmcnt(11)
    ds_read_b64_tr_b16 a[0:1], v6 offset:32768
    ds_read_b64_tr_b16 a[2:3], v6 offset:34816
    ds_read_b64_tr_b16 a[4:5], v7 offset:32768
    ds_read_b64_tr_b16 a[6:7], v7 offset:34816
    v_exp_f32 v48, v48
    v_exp_f32 v49, v49
    v_exp_f32 v50, v50
    v_exp_f32 v51, v51
    ds_read_b64_tr_b16 a[8:9], v6 offset:33024
    ds_read_b64_tr_b16 a[10:11], v6 offset:35072
    ds_read_b64_tr_b16 a[12:13], v7 offset:33024
    ds_read_b64_tr_b16 a[14:15], v7 offset:35072
    s_add_u32 s57, s57, 31744
    buffer_load_dwordx4 v12, s[20:23], s57 offen offset:2048 lds
    v_exp_f32 v52, v52
    v_exp_f32 v53, v53
    v_exp_f32 v54, v54
    v_exp_f32 v55, v55
    v_pk_add_f32 v[48:49], v[48:49], 1.0 op_sel_hi:[1,0]
    v_pk_add_f32 v[50:51], v[50:51], 1.0 op_sel_hi:[1,0]
    v_pk_add_f32 v[52:53], v[52:53], 1.0 op_sel_hi:[1,0]
    v_pk_add_f32 v[54:55], v[54:55], 1.0 op_sel_hi:[1,0]
    s_add_u32 s57, s57, 31744
    buffer_load_dwordx4 v12, s[20:23], s57 offen offset:3072 lds
    v_rcp_f32 v48, v48
    v_rcp_f32 v49, v49
    v_rcp_f32 v50, v50
    v_rcp_f32 v51, v51
    v_rcp_f32 v52, v52
    v_rcp_f32 v53, v53
    v_rcp_f32 v54, v54
    v_rcp_f32 v55, v55
    v_pk_mul_f32 v[48:49], v[48:49], v[32:33]
    v_pk_mul_f32 v[50:51], v[50:51], v[34:35]
    v_pk_mul_f32 v[52:53], v[52:53], v[36:37]
    v_pk_mul_f32 v[54:55], v[54:55], v[38:39]
    s_add_u32 m0, s52, 147456
    s_lshl_b32 s57, s78, 7
    buffer_load_dwordx4 v12, s[20:23], s57 offen offset:0 lds
    v_cvt_pk_bf16_f32 v56, v48, v49
    v_cvt_pk_bf16_f32 v57, v50, v51
    v_cvt_pk_bf16_f32 v58, v52, v53
    v_cvt_pk_bf16_f32 v59, v54, v55
    buffer_store_dwordx4 v[56:59], v23, s[24:27], s67 offen offset:0 sc1
    v_pk_add_f32 v[40:41], v[40:41], v[168:169]
    v_pk_add_f32 v[42:43], v[42:43], v[170:171]
    v_pk_add_f32 v[44:45], v[44:45], v[172:173]
    v_pk_add_f32 v[46:47], v[46:47], v[174:175]
    s_add_u32 s57, s57, 31744
    buffer_load_dwordx4 v12, s[20:23], s57 offen offset:1024 lds
    s_waitcnt vmcnt(12)
    ds_read_b64_tr_b16 a[16:17], v6 offset:49152
    ds_read_b64_tr_b16 a[18:19], v6 offset:51200
    ds_read_b64_tr_b16 a[20:21], v7 offset:49152
    ds_read_b64_tr_b16 a[22:23], v7 offset:51200
    v_pk_mul_f32 v[48:49], v[40:41], v[40:41]
    v_pk_mul_f32 v[50:51], v[42:43], v[42:43]
    v_pk_mul_f32 v[52:53], v[44:45], v[44:45]
    v_pk_mul_f32 v[54:55], v[46:47], v[46:47]
    ds_read_b64_tr_b16 a[24:25], v6 offset:49408
    ds_read_b64_tr_b16 a[26:27], v6 offset:51456
    ds_read_b64_tr_b16 a[28:29], v7 offset:49408
    ds_read_b64_tr_b16 a[30:31], v7 offset:51456
    s_add_u32 s57, s57, 31744
    buffer_load_dwordx4 v12, s[20:23], s57 offen offset:2048 lds
    v_pk_fma_f32 v[48:49], v[48:49], v[236:237], v[236:237] op_sel:[0,0,1] op_sel_hi:[1,0,1]
    v_pk_fma_f32 v[50:51], v[50:51], v[236:237], v[236:237] op_sel:[0,0,1] op_sel_hi:[1,0,1]
    v_pk_fma_f32 v[52:53], v[52:53], v[236:237], v[236:237] op_sel:[0,0,1] op_sel_hi:[1,0,1]
    v_pk_fma_f32 v[54:55], v[54:55], v[236:237], v[236:237] op_sel:[0,0,1] op_sel_hi:[1,0,1]
    v_pk_mul_f32 v[48:49], v[48:49], v[40:41]
    v_pk_mul_f32 v[50:51], v[50:51], v[42:43]
    v_pk_mul_f32 v[52:53], v[52:53], v[44:45]
    v_pk_mul_f32 v[54:55], v[54:55], v[46:47]
    s_add_u32 s57, s57, 31744
    buffer_load_dwordx4 v12, s[20:23], s57 offen offset:3072 lds
    v_exp_f32 v48, v48
    v_exp_f32 v49, v49
    v_exp_f32 v50, v50
    v_exp_f32 v51, v51
    v_exp_f32 v52, v52
    v_exp_f32 v53, v53
    v_exp_f32 v54, v54
    v_exp_f32 v55, v55
    v_pk_add_f32 v[48:49], v[48:49], 1.0 op_sel_hi:[1,0]
    v_pk_add_f32 v[50:51], v[50:51], 1.0 op_sel_hi:[1,0]
    v_pk_add_f32 v[52:53], v[52:53], 1.0 op_sel_hi:[1,0]
    v_pk_add_f32 v[54:55], v[54:55], 1.0 op_sel_hi:[1,0]
    s_add_u32 m0, s52, 49152
    s_lshl_b32 s57, s78, 7
    s_add_u32 s57, s57, 131072
    buffer_load_dwordx4 v12, s[20:23], s57 offen offset:0 lds
    v_rcp_f32 v48, v48
    v_rcp_f32 v49, v49
    v_rcp_f32 v50, v50
    v_rcp_f32 v51, v51
    v_rcp_f32 v52, v52
    v_rcp_f32 v53, v53
    v_rcp_f32 v54, v54
    v_rcp_f32 v55, v55
    s_add_u32 s57, s57, 31744
    buffer_load_dwordx4 v12, s[20:23], s57 offen offset:1024 lds
    s_waitcnt vmcnt(11)
    ds_read_b64_tr_b16 a[32:33], v8 offset:0
    ds_read_b64_tr_b16 a[34:35], v8 offset:2048
    ds_read_b64_tr_b16 a[36:37], v9 offset:0
    ds_read_b64_tr_b16 a[38:39], v9 offset:2048
    v_pk_mul_f32 v[48:49], v[48:49], v[40:41]
    v_pk_mul_f32 v[50:51], v[50:51], v[42:43]
    v_pk_mul_f32 v[52:53], v[52:53], v[44:45]
    v_pk_mul_f32 v[54:55], v[54:55], v[46:47]
    ds_read_b64_tr_b16 a[40:41], v8 offset:256
    ds_read_b64_tr_b16 a[42:43], v8 offset:2304
    ds_read_b64_tr_b16 a[44:45], v9 offset:256
    ds_read_b64_tr_b16 a[46:47], v9 offset:2304
    s_add_u32 s57, s57, 31744
    buffer_load_dwordx4 v12, s[20:23], s57 offen offset:2048 lds
    v_cvt_pk_bf16_f32 v60, v48, v49
    v_cvt_pk_bf16_f32 v61, v50, v51
    v_cvt_pk_bf16_f32 v62, v52, v53
    v_cvt_pk_bf16_f32 v63, v54, v55
    buffer_store_dwordx4 v[60:63], v23, s[24:27], s67 offen offset:1024 sc1
    s_add_u32 s57, s57, 31744
    buffer_load_dwordx4 v12, s[20:23], s57 offen offset:3072 lds
    s_add_u32 m0, s52, 65536
    s_lshl_b32 s57, s79, 7
    buffer_load_dwordx4 v12, s[20:23], s57 offen offset:0 lds
    s_add_u32 s57, s57, 31744
    buffer_load_dwordx4 v12, s[20:23], s57 offen offset:1024 lds
    s_waitcnt vmcnt(12)
    ds_read_b64_tr_b16 a[48:49], v8 offset:16384
    ds_read_b64_tr_b16 a[50:51], v8 offset:18432
    ds_read_b64_tr_b16 a[52:53], v9 offset:16384
    ds_read_b64_tr_b16 a[54:55], v9 offset:18432
    s_add_u32 s57, s57, 31744
    buffer_load_dwordx4 v12, s[20:23], s57 offen offset:2048 lds
    ds_read_b64_tr_b16 a[56:57], v8 offset:16640
    ds_read_b64_tr_b16 a[58:59], v8 offset:18688
    ds_read_b64_tr_b16 a[60:61], v9 offset:16640
    ds_read_b64_tr_b16 a[62:63], v9 offset:18688
    s_add_u32 s57, s57, 31744
    buffer_load_dwordx4 v12, s[20:23], s57 offen offset:3072 lds
    s_waitcnt lgkmcnt(15)
    s_add_u32 m0, s52, 81920
    s_lshl_b32 s57, s79, 7
    s_add_u32 s57, s57, 131072
    buffer_load_dwordx4 v12, s[20:23], s57 offen offset:0 lds
    s_add_u32 s57, s57, 31744
    buffer_load_dwordx4 v12, s[20:23], s57 offen offset:1024 lds
    s_waitcnt vmcnt(11)
    ds_read_b64_tr_b16 a[64:65], v8 offset:32768
    ds_read_b64_tr_b16 a[66:67], v8 offset:34816
    ds_read_b64_tr_b16 a[68:69], v9 offset:32768
    ds_read_b64_tr_b16 a[70:71], v9 offset:34816
    s_add_u32 s57, s57, 31744
    buffer_load_dwordx4 v12, s[20:23], s57 offen offset:2048 lds
    ds_read_b64_tr_b16 a[72:73], v8 offset:33024
    ds_read_b64_tr_b16 a[74:75], v8 offset:35072
    ds_read_b64_tr_b16 a[76:77], v9 offset:33024
    ds_read_b64_tr_b16 a[78:79], v9 offset:35072
    s_add_u32 s57, s57, 31744
    buffer_load_dwordx4 v12, s[20:23], s57 offen offset:3072 lds
    s_add_u32 m0, s52, 98304
    s_lshl_b32 s57, s80, 7
    buffer_load_dwordx4 v12, s[20:23], s57 offen offset:0 lds
    s_add_u32 s57, s57, 31744
    buffer_load_dwordx4 v12, s[20:23], s57 offen offset:1024 lds
    s_waitcnt vmcnt(10)
    ds_read_b64_tr_b16 a[80:81], v6 offset:0
    ds_read_b64_tr_b16 a[82:83], v6 offset:2048
    ds_read_b64_tr_b16 a[84:85], v7 offset:0
    ds_read_b64_tr_b16 a[86:87], v7 offset:2048
    s_add_u32 s57, s57, 31744
    buffer_load_dwordx4 v12, s[20:23], s57 offen offset:2048 lds
    ds_read_b64_tr_b16 a[88:89], v6 offset:256
    ds_read_b64_tr_b16 a[90:91], v6 offset:2304
    ds_read_b64_tr_b16 a[92:93], v7 offset:256
    ds_read_b64_tr_b16 a[94:95], v7 offset:2304
    s_barrier
    s_cmp_lg_u32 s44, 0
    s_cbranch_scc1 L_nopub6
    s_lshl_b32 s60, s51, 5
    s_add_u32 s60, s60, s50
    s_lshl_b32 s60, s60, 7
    s_add_u32 s60, s60, 12713984
    v_mov_b32 v30, s47
    s_mov_b64 exec, 1
    buffer_store_dword v30, off, s[24:27], s60 sc1
    v_mov_b32 v29, 0
    s_lshl_b32 s60, s2, 8
    buffer_store_dword v29, off, s[40:43], s60 sc1
    s_mov_b64 exec, -1
L_nopub6:
L_p3join:
    s_add_u32 s57, s57, 31744
    buffer_load_dwordx4 v12, s[20:23], s57 offen offset:3072 lds
    v_lshlrev_b32 v228, 16, v228
    v_lshlrev_b32 v32, 16, v216
    v_and_b32 v33, s61, v216
    v_lshlrev_b32 v34, 16, v217
    s_waitcnt lgkmcnt(15)
    s_add_u32 m0, s52, 114688
    s_lshl_b32 s57, s80, 7
    s_add_u32 s57, s57, 131072
    buffer_load_dwordx4 v12, s[20:23], s57 offen offset:0 lds
    v_and_b32 v35, s61, v217
    v_add_f32 v32, v32, v228
    v_add_f32 v33, v33, v228
    v_add_f32 v34, v34, v228
    s_add_u32 s57, s57, 31744
    buffer_load_dwordx4 v12, s[20:23], s57 offen offset:1024 lds
    s_waitcnt vmcnt(10)
    ds_read_b64_tr_b16 a[96:97], v6 offset:16384
    ds_read_b64_tr_b16 a[98:99], v6 offset:18432
    ds_read_b64_tr_b16 a[100:101], v7 offset:16384
    ds_read_b64_tr_b16 a[102:103], v7 offset:18432
    v_add_f32 v35, v35, v228
    v_lshlrev_b32 v48, 16, v218
    v_and_b32 v49, s61, v218
    v_lshlrev_b32 v50, 16, v219
    ds_read_b64_tr_b16 a[104:105], v6 offset:16640
    ds_read_b64_tr_b16 a[106:107], v6 offset:18688
    ds_read_b64_tr_b16 a[108:109], v7 offset:16640
    ds_read_b64_tr_b16 a[110:111], v7 offset:18688
    s_add_u32 s57, s57, 31744
    buffer_load_dwordx4 v12, s[20:23], s57 offen offset:2048 lds
    v_and_b32 v51, s61, v219
    v_add_f32 v48, v48, v228
    v_add_f32 v49, v49, v228
    v_add_f32 v50, v50, v228
    s_add_u32 s57, s57, 31744
    buffer_load_dwordx4 v12, s[20:23], s57 offen offset:3072 lds
    v_add_f32 v51, v51, v228
    v_lshlrev_b32 v64, 16, v220
    v_and_b32 v65, s61, v220
    v_lshlrev_b32 v66, 16, v221
    s_add_u32 m0, s52, 131072
    s_lshl_b32 s57, s81, 7
    buffer_load_dwordx4 v12, s[20:23], s57 offen offset:0 lds
    v_and_b32 v67, s61, v221
    v_add_f32 v64, v64, v228
    v_add_f32 v65, v65, v228
    v_add_f32 v66, v66, v228
    v_add_f32 v67, v67, v228
    v_lshlrev_b32 v80, 16, v222
    v_and_b32 v81, s61, v222
    v_lshlrev_b32 v82, 16, v223
    s_add_u32 s57, s57, 31744
    buffer_load_dwordx4 v12, s[20:23], s57 offen offset:1024 lds
    s_waitcnt vmcnt(10)
    ds_read_b64_tr_b16 a[112:113], v6 offset:32768
    ds_read_b64_tr_b16 a[114:115], v6 offset:34816
    ds_read_b64_tr_b16 a[116:117], v7 offset:32768
    ds_read_b64_tr_b16 a[118:119], v7 offset:34816
    s_add_u32 s57, s57, 31744
    buffer_load_dwordx4 v12, s[20:23], s57 offen offset:2048 lds
    ds_read_b64_tr_b16 a[120:121], v6 offset:33024
    ds_read_b64_tr_b16 a[122:123], v6 offset:35072
    ds_read_b64_tr_b16 a[124:125], v7 offset:33024
    ds_read_b64_tr_b16 a[126:127], v7 offset:35072
    s_add_u32 s57, s57, 31744
    buffer_load_dwordx4 v12, s[20:23], s57 offen offset:3072 lds
    v_and_b32 v83, s61, v223
    v_add_f32 v80, v80, v228
    v_add_f32 v81, v81, v228
    v_add_f32 v82, v82, v228
    v_add_f32 v83, v83, v228
    v_lshlrev_b32 v96, 16, v224
    v_and_b32 v97, s61, v224
    v_lshlrev_b32 v98, 16, v225
    s_waitcnt lgkmcnt(15)
    s_add_u32 m0, s52, 147456
    s_lshl_b32 s57, s81, 7
    s_add_u32 s57, s57, 131072
    buffer_load_dwordx4 v12, s[20:23], s57 offen offset:0 lds
    v_and_b32 v99, s61, v225
    v_add_f32 v96, v96, v228
    v_add_f32 v97, v97, v228
    v_add_f32 v98, v98, v228
    s_add_u32 s57, s57, 31744
    buffer_load_dwordx4 v12, s[20:23], s57 offen offset:1024 lds
    s_waitcnt vmcnt(10)
    ds_read_b64_tr_b16 a[128:129], v6 offset:49152
    ds_read_b64_tr_b16 a[130:131], v6 offset:51200
    ds_read_b64_tr_b16 a[132:133], v7 offset:49152
    ds_read_b64_tr_b16 a[134:135], v7 offset:51200
    s_add_u32 s57, s57, 31744
    buffer_load_dwordx4 v12, s[20:23], s57 offen offset:2048 lds
    ds_read_b64_tr_b16 a[136:137], v6 offset:49408
    ds_read_b64_tr_b16 a[138:139], v6 offset:51456
    ds_read_b64_tr_b16 a[140:141], v7 offset:49408
    ds_read_b64_tr_b16 a[142:143], v7 offset:51456
    v_add_f32 v99, v99, v228
    s_add_u32 s57, s57, 31744
    buffer_load_dwordx4 v12, s[20:23], s57 offen offset:3072 lds
    s_add_u32 m0, s52, 49152
    s_lshl_b32 s57, s82, 7
    buffer_load_dwordx4 v12, s[20:23], s57 offen offset:0 lds
    s_add_u32 s57, s57, 31744
    buffer_load_dwordx4 v12, s[20:23], s57 offen offset:1024 lds
    s_waitcnt vmcnt(10)
    ds_read_b64_tr_b16 a[144:145], v8 offset:0
    ds_read_b64_tr_b16 a[146:147], v8 offset:2048
    ds_read_b64_tr_b16 a[148:149], v9 offset:0
    ds_read_b64_tr_b16 a[150:151], v9 offset:2048
    s_add_u32 s57, s57, 31744
    buffer_load_dwordx4 v12, s[20:23], s57 offen offset:2048 lds
    ds_read_b64_tr_b16 a[152:153], v8 offset:256
    ds_read_b64_tr_b16 a[154:155], v8 offset:2304
    ds_read_b64_tr_b16 a[156:157], v9 offset:256
    ds_read_b64_tr_b16 a[158:159], v9 offset:2304
    s_add_u32 s57, s57, 31744
    buffer_load_dwordx4 v12, s[20:23], s57 offen offset:3072 lds
    s_waitcnt lgkmcnt(15)
    s_add_u32 m0, s52, 65536
    s_lshl_b32 s57, s82, 7
    s_add_u32 s57, s57, 131072
    buffer_load_dwordx4 v12, s[20:23], s57 offen offset:0 lds
    s_add_u32 s57, s57, 31744
    buffer_load_dwordx4 v12, s[20:23], s57 offen offset:1024 lds
    s_waitcnt vmcnt(10)
    ds_read_b64_tr_b16 a[160:161], v8 offset:16384
    ds_read_b64_tr_b16 a[162:163], v8 offset:18432
    ds_read_b64_tr_b16 a[164:165], v9 offset:16384
    ds_read_b64_tr_b16 a[166:167], v9 offset:18432
    s_add_u32 s57, s57, 31744
    buffer_load_dwordx4 v12, s[20:23], s57 offen offset:2048 lds
    ds_read_b64_tr_b16 a[168:169], v8 offset:16640
    ds_read_b64_tr_b16 a[170:171], v8 offset:18688
    ds_read_b64_tr_b16 a[172:173], v9 offset:16640
    ds_read_b64_tr_b16 a[174:175], v9 offset:18688
    s_add_u32 s57, s57, 31744
    buffer_load_dwordx4 v12, s[20:23], s57 offen offset:3072 lds
    s_add_u32 m0, s52, 81920
    s_mov_b32 s57, s75
    buffer_load_dwordx4 v15, s[12:15], s57 offen offset:0 lds
    s_add_u32 s57, s57, 113664
    buffer_load_dwordx4 v15, s[12:15], s57 offen offset:1024 lds
    s_waitcnt vmcnt(10)
    ds_read_b64_tr_b16 a[176:177], v8 offset:32768
    ds_read_b64_tr_b16 a[178:179], v8 offset:34816
    ds_read_b64_tr_b16 a[180:181], v9 offset:32768
    ds_read_b64_tr_b16 a[182:183], v9 offset:34816
    s_add_u32 s57, s57, 113664
    buffer_load_dwordx4 v15, s[12:15], s57 offen offset:2048 lds
    ds_read_b64_tr_b16 a[184:185], v8 offset:33024
    ds_read_b64_tr_b16 a[186:187], v8 offset:35072
    ds_read_b64_tr_b16 a[188:189], v9 offset:33024
    ds_read_b64_tr_b16 a[190:191], v9 offset:35072
    s_add_u32 s57, s57, 113664
    buffer_load_dwordx4 v15, s[12:15], s57 offen offset:3072 lds
    s_waitcnt lgkmcnt(15)
    s_add_u32 m0, s52, 98304
    s_mov_b32 s57, 0
    buffer_load_dwordx4 v13, s[12:15], s57 offen offset:0 lds
    s_add_u32 s57, s57, 6144
    buffer_load_dwordx4 v14, s[12:15], s57 offen offset:1024 lds
    s_waitcnt vmcnt(10)
    ds_read_b64_tr_b16 a[192:193], v6 offset:0
    ds_read_b64_tr_b16 a[194:195], v6 offset:2048
    ds_read_b64_tr_b16 a[196:197], v7 offset:0
    ds_read_b64_tr_b16 a[198:199], v7 offset:2048
    s_add_u32 s57, s57, 6144
    buffer_load_dwordx4 v13, s[12:15], s57 offen offset:2048 lds
    ds_read_b64_tr_b16 a[200:201], v6 offset:256
    ds_read_b64_tr_b16 a[202:203], v6 offset:2304
    ds_read_b64_tr_b16 a[204:205], v7 offset:256
    ds_read_b64_tr_b16 a[206:207], v7 offset:2304
    s_add_u32 s57, s57, 6144
L_wb_2:
    s_cbranch_execz L_wb_ret
    buffer_load_dwordx4 v14, s[12:15], s57 offen offset:3072 lds
    buffer_load_dword v17, v20, s[24:27], 0 offen sc1
    s_add_u32 m0, s52, 114688
    s_mov_b32 s57, 114688
    buffer_load_dwordx4 v13, s[12:15], s57 offen offset:0 lds
    s_waitcnt vmcnt(10)
    ds_read_b64_tr_b16 a[208:209], v6 offset:16384
    ds_read_b64_tr_b16 a[210:211], v6 offset:18432
    ds_read_b64_tr_b16 a[212:213], v7 offset:16384
    ds_read_b64_tr_b16 a[214:215], v7 offset:18432
    s_add_u32 s57, s57, 6144
    buffer_load_dwordx4 v14, s[12:15], s57 offen offset:1024 lds
    ds_read_b64_tr_b16 a[216:217], v6 offset:16640
    ds_read_b64_tr_b16 a[218:219], v6 offset:18688
    ds_read_b64_tr_b16 a[220:221], v7 offset:16640
    ds_read_b64_tr_b16 a[222:223], v7 offset:18688
    s_add_u32 s57, s57, 6144
    buffer_load_dwordx4 v13, s[12:15], s57 offen offset:2048 lds
    s_add_u32 s57, s57, 6144
    buffer_load_dwordx4 v14, s[12:15], s57 offen offset:3072 lds
    s_waitcnt lgkmcnt(15)
    s_add_u32 m0, s52, 131072
    s_mov_b32 s57, 229376
    buffer_load_dwordx4 v13, s[12:15], s57 offen offset:0 lds
    s_add_u32 s57, s57, 6144
    buffer_load_dwordx4 v14, s[12:15], s57 offen offset:1024 lds
    s_add_u32 s57, s57, 6144
    buffer_load_dwordx4 v13, s[12:15], s57 offen offset:2048 lds
    s_add_u32 s57, s57, 6144
    buffer_load_dwordx4 v14, s[12:15], s57 offen offset:3072 lds
    s_add_u32 m0, s52, 147456
    s_mov_b32 s57, 344064
    buffer_load_dwordx4 v239, s[12:15], s57 offen offset:0 lds
    s_add_u32 s57, s57, 27648
    buffer_load_dwordx4 v239, s[12:15], s57 offen offset:1024 lds
    s_waitcnt vmcnt(10)
    v_cmp_ne_u32 vcc, s47, v17
    s_nop 0
    s_cbranch_vccz L_ok8
    s_mov_b32 s59, 100000
L_spin7:
    buffer_load_dword v17, v20, s[24:27], 0 offen sc1
    s_waitcnt vmcnt(0)
    v_cmp_ne_u32 vcc, s47, v17
    s_nop 0
    s_cbranch_vccz L_ok8
    s_sub_u32 s59, s59, 1
    s_cbranch_scc0 L_spin7
L_ok8:
    s_cmp_ge_u32 s89, 4
    s_cbranch_scc1 L_p3_alt
    s_mov_b32 s66, s68
    s_add_u32 s58, s66, s76
    buffer_load_dwordx4 v[144:147], v23, s[24:27], s58 offen offset:0 sc1
    buffer_load_dwordx4 v[148:151], v23, s[24:27], s58 offen offset:1024 sc1
    s_add_u32 s58, s66, s77
    buffer_load_dwordx4 v[152:155], v23, s[24:27], s58 offen offset:0 sc1
    buffer_load_dwordx4 v[156:159], v23, s[24:27], s58 offen offset:1024 sc1
    s_add_u32 s58, s66, s78
    buffer_load_dwordx4 v[112:115], v23, s[24:27], s58 offen offset:0 sc1
    buffer_load_dwordx4 v[116:119], v23, s[24:27], s58 offen offset:1024 sc1
    s_add_u32 s58, s66, s79
    buffer_load_dwordx4 v[120:123], v23, s[24:27], s58 offen offset:0 sc1
    buffer_load_dwordx4 v[124:127], v23, s[24:27], s58 offen offset:1024 sc1
    s_add_u32 s58, s66, s80
    buffer_load_dwordx4 v[128:131], v23, s[24:27], s58 offen offset:0 sc1
    buffer_load_dwordx4 v[132:135], v23, s[24:27], s58 offen offset:1024 sc1
    s_add_u32 s58, s66, s81
    buffer_load_dwordx4 v[136:139], v23, s[24:27], s58 offen offset:0 sc1
    s_waitcnt vmcnt(10)
    v_mfma_f32_16x16x32_bf16 v[96:99], v[144:147], a[0:3], v[96:99]
    v_mfma_f32_16x16x32_bf16 v[100:103], v[144:147], a[4:7], 0
    buffer_load_dwordx4 v[140:143], v23, s[24:27], s58 offen offset:1024 sc1
    v_mfma_f32_16x16x32_bf16 v[104:107], v[144:147], a[8:11], 0
    v_mfma_f32_16x16x32_bf16 v[108:111], v[144:147], a[12:15], 0
    s_waitcnt vmcnt(10)
    v_mfma_f32_16x16x32_bf16 v[96:99], v[148:151], a[16:19], v[96:99]
    s_add_u32 s58, s66, s82
    v_mfma_f32_16x16x32_bf16 v[100:103], v[148:151], a[20:23], v[100:103]
    buffer_load_dwordx4 v[144:147], v23, s[24:27], s58 offen offset:0 sc1
    v_mfma_f32_16x16x32_bf16 v[104:107], v[148:151], a[24:27], v[104:107]
    v_mfma_f32_16x16x32_bf16 v[108:111], v[148:151], a[28:31], v[108:111]
    s_waitcnt vmcnt(10)
    v_mfma_f32_16x16x32_bf16 v[96:99], v[152:155], a[32:35], v[96:99]
    v_mfma_f32_16x16x32_bf16 v[100:103], v[152:155], a[36:39], v[100:103]
    buffer_load_dwordx4 v[148:151], v23, s[24:27], s58 offen offset:1024 sc1
    v_mfma_f32_16x16x32_bf16 v[104:107], v[152:155], a[40:43], v[104:107]
    v_mfma_f32_16x16x32_bf16 v[108:111], v[152:155], a[44:47], v[108:111]
    s_waitcnt vmcnt(10)
    v_mfma_f32_16x16x32_bf16 v[96:99], v[156:159], a[48:51], v[96:99]
    s_add_u32 s66, s69, 175872
    s_add_u32 s58, s66, s76
    v_mfma_f32_16x16x32_bf16 v[100:103], v[156:159], a[52:55], v[100:103]
    buffer_load_dwordx4 v[152:155], v23, s[24:27], s58 offen offset:0 sc1
    v_mfma_f32_16x16x32_bf16 v[104:107], v[156:159], a[56:59], v[104:107]
    v_mfma_f32_16x16x32_bf16 v[108:111], v[156:159], a[60:63], v[108:111]
    s_waitcnt vmcnt(10)
    v_mfma_f32_16x16x32_bf16 v[96:99], v[112:115], a[64:67], v[96:99]
    v_mfma_f32_16x16x32_bf16 v[100:103], v[112:115], a[68:71], v[100:103]
    buffer_load_dwordx4 v[156:159], v23, s[24:27], s58 offen offset:1024 sc1
    v_mfma_f32_16x16x32_bf16 v[104:107], v[112:115], a[72:75], v[104:107]
    v_mfma_f32_16x16x32_bf16 v[108:111], v[112:115], a[76:79], v[108:111]
    s_waitcnt vmcnt(10)
    v_mfma_f32_16x16x32_bf16 v[96:99], v[116:119], a[80:83], v[96:99]
    s_add_u32 s58, s66, s77
    v_mfma_f32_16x16x32_bf16 v[100:103], v[116:119], a[84:87], v[100:103]
    buffer_load_dwordx4 v[112:115], v23, s[24:27], s58 offen offset:0 sc1
    v_mfma_f32_16x16x32_bf16 v[104:107], v[116:119], a[88:91], v[104:107]
    v_mfma_f32_16x16x32_bf16 v[108:111], v[116:119], a[92:95], v[108:111]
    s_waitcnt vmcnt(10)
    v_mfma_f32_16x16x32_bf16 v[96:99], v[120:123], a[96:99], v[96:99]
    v_mfma_f32_16x16x32_bf16 v[100:103], v[120:123], a[100:103], v[100:103]
    buffer_load_dwordx4 v[116:119], v23, s[24:27], s58 offen offset:1024 sc1
    v_mfma_f32_16x16x32_bf16 v[104:107], v[120:123], a[104:107], v[104:107]
    v_mfma_f32_16x16x32_bf16 v[108:111], v[120:123], a[108:111], v[108:111]
    s_waitcnt vmcnt(10)
    v_mfma_f32_16x16x32_bf16 v[96:99], v[124:127], a[112:115], v[96:99]
    s_add_u32 s58, s66, s78
    v_mfma_f32_16x16x32_bf16 v[100:103], v[124:127], a[116:119], v[100:103]
    buffer_load_dwordx4 v[120:123], v23, s[24:27], s58 offen offset:0 sc1
    v_mfma_f32_16x16x32_bf16 v[104:107], v[124:127], a[120:123], v[104:107]
    v_mfma_f32_16x16x32_bf16 v[108:111], v[124:127], a[124:127], v[108:111]
    s_waitcnt vmcnt(10)
    v_mfma_f32_16x16x32_bf16 v[96:99], v[128:131], a[128:131], v[96:99]
    v_mfma_f32_16x16x32_bf16 v[100:103], v[128:131], a[132:135], v[100:103]
    buffer_load_dwordx4 v[124:127], v23, s[24:27], s58 offen offset:1024 sc1
    v_mfma_f32_16x16x32_bf16 v[104:107], v[128:131], a[136:139], v[104:107]
    v_mfma_f32_16x16x32_bf16 v[108:111], v[128:131], a[140:143], v[108:111]
    s_waitcnt vmcnt(10)
    v_mfma_f32_16x16x32_bf16 v[96:99], v[132:135], a[144:147], v[96:99]
    s_add_u32 s58, s66, s79
    v_mfma_f32_16x16x32_bf16 v[100:103], v[132:135], a[148:151], v[100:103]
    buffer_load_dwordx4 v[128:131], v23, s[24:27], s58 offen offset:0 sc1
    v_mfma_f32_16x16x32_bf16 v[104:107], v[132:135], a[152:155], v[104:107]
    v_mfma_f32_16x16x32_bf16 v[108:111], v[132:135], a[156:159], v[108:111]
    s_waitcnt vmcnt(10)
    v_mfma_f32_16x16x32_bf16 v[96:99], v[136:139], a[160:163], v[96:99]
    v_mfma_f32_16x16x32_bf16 v[100:103], v[136:139], a[164:167], v[100:103]
    buffer_load_dwordx4 v[132:135], v23, s[24:27], s58 offen offset:1024 sc1
    v_mfma_f32_16x16x32_bf16 v[104:107], v[136:139], a[168:171], v[104:107]
    v_mfma_f32_16x16x32_bf16 v[108:111], v[136:139], a[172:175], v[108:111]
    s_waitcnt vmcnt(10)
    v_mfma_f32_16x16x32_bf16 v[96:99], v[140:143], a[176:179], v[96:99]
    s_add_u32 s58, s66, s80
    v_mfma_f32_16x16x32_bf16 v[100:103], v[140:143], a[180:183], v[100:103]
    buffer_load_dwordx4 v[136:139], v23, s[24:27], s58 offen offset:0 sc1
    v_mfma_f32_16x16x32_bf16 v[104:107], v[140:143], a[184:187], v[104:107]
    v_mfma_f32_16x16x32_bf16 v[108:111], v[140:143], a[188:191], v[108:111]
    s_waitcnt vmcnt(10)
    s_waitcnt lgkmcnt(8)
    v_mfma_f32_16x16x32_bf16 v[96:99], v[144:147], a[192:195], v[96:99]
    v_mfma_f32_16x16x32_bf16 v[100:103], v[144:147], a[196:199], v[100:103]
    buffer_load_dwordx4 v[140:143], v23, s[24:27], s58 offen offset:1024 sc1
    v_mfma_f32_16x16x32_bf16 v[104:107], v[144:147], a[200:203], v[104:107]
    v_mfma_f32_16x16x32_bf16 v[108:111], v[144:147], a[204:207], v[108:111]
    s_waitcnt vmcnt(10)
    s_waitcnt lgkmcnt(0)
    v_mfma_f32_16x16x32_bf16 v[96:99], v[148:151], a[208:211], v[96:99]
    s_add_u32 s58, s66, s81
    v_mfma_f32_16x16x32_bf16 v[100:103], v[148:151], a[212:215], v[100:103]
    buffer_load_dwordx4 v[144:147], v23, s[24:27], s58 offen offset:0 sc1
    v_mfma_f32_16x16x32_bf16 v[104:107], v[148:151], a[216:219], v[104:107]
    v_mfma_f32_16x16x32_bf16 v[108:111], v[148:151], a[220:223], v[108:111]
L_p3_join:
    s_waitcnt vmcnt(10)
    v_mfma_f32_16x16x32_bf16 v[80:83], v[152:155], a[0:3], v[80:83]
    v_mfma_f32_16x16x32_bf16 v[84:87], v[152:155], a[4:7], 0
    buffer_load_dwordx4 v[148:151], v23, s[24:27], s58 offen offset:1024 sc1
    v_mfma_f32_16x16x32_bf16 v[88:91], v[152:155], a[8:11], 0
    v_mfma_f32_16x16x32_bf16 v[92:95], v[152:155], a[12:15], 0
    s_waitcnt vmcnt(10)
    v_mfma_f32_16x16x32_bf16 v[80:83], v[156:159], a[16:19], v[80:83]
    s_add_u32 s58, s66, s82
    v_mfma_f32_16x16x32_bf16 v[84:87], v[156:159], a[20:23], v[84:87]
    buffer_load_dwordx4 v[152:155], v23, s[24:27], s58 offen offset:0 sc1
    v_mfma_f32_16x16x32_bf16 v[88:91], v[156:159], a[24:27], v[88:91]
    ds_write_b128 v232, v[100:103] offset:3072
    v_mfma_f32_16x16x32_bf16 v[92:95], v[156:159], a[28:31], v[92:95]
    s_waitcnt vmcnt(10)
    v_mfma_f32_16x16x32_bf16 v[80:83], v[112:115], a[32:35], v[80:83]
    v_mfma_f32_16x16x32_bf16 v[84:87], v[112:115], a[36:39], v[84:87]
    buffer_load_dwordx4 v[156:159], v23, s[24:27], s58 offen offset:1024 sc1
    v_mfma_f32_16x16x32_bf16 v[88:91], v[112:115], a[40:43], v[88:91]
    ds_write_b128 v232, v[104:107] offset:19456
    v_mfma_f32_16x16x32_bf16 v[92:95], v[112:115], a[44:47], v[92:95]
    s_waitcnt vmcnt(10)
    v_mfma_f32_16x16x32_bf16 v[80:83], v[116:119], a[48:51], v[80:83]
    s_add_u32 s66, s69, 117248
    s_add_u32 s58, s66, s76
    v_mfma_f32_16x16x32_bf16 v[84:87], v[116:119], a[52:55], v[84:87]
    buffer_load_dwordx4 v[112:115], v23, s[24:27], s58 offen offset:0 sc1
    v_mfma_f32_16x16x32_bf16 v[88:91], v[116:119], a[56:59], v[88:91]
    ds_write_b128 v232, v[108:111] offset:35840
    v_mfma_f32_16x16x32_bf16 v[92:95], v[116:119], a[60:63], v[92:95]
    s_waitcnt vmcnt(10)
    v_mfma_f32_16x16x32_bf16 v[80:83], v[120:123], a[64:67], v[80:83]
    v_mfma_f32_16x16x32_bf16 v[84:87], v[120:123], a[68:71], v[84:87]
    buffer_load_dwordx4 v[116:119], v23, s[24:27], s58 offen offset:1024 sc1
    v_mfma_f32_16x16x32_bf16 v[88:91], v[120:123], a[72:75], v[88:91]
    v_mfma_f32_16x16x32_bf16 v[92:95], v[120:123], a[76:79], v[92:95]
    s_waitcnt vmcnt(10)
    v_mfma_f32_16x16x32_bf16 v[80:83], v[124:127], a[80:83], v[80:83]
    s_add_u32 s58, s66, s77
    v_mfma_f32_16x16x32_bf16 v[84:87], v[124:127], a[84:87], v[84:87]
    buffer_load_dwordx4 v[120:123], v23, s[24:27], s58 offen offset:0 sc1
    v_mfma_f32_16x16x32_bf16 v[88:91], v[124:127], a[88:91], v[88:91]
    s_waitcnt lgkmcnt(0)
    s_barrier
    v_mfma_f32_16x16x32_bf16 v[92:95], v[124:127], a[92:95], v[92:95]
    s_waitcnt vmcnt(10)
    v_mfma_f32_16x16x32_bf16 v[80:83], v[128:131], a[96:99], v[80:83]
    v_mfma_f32_16x16x32_bf16 v[84:87], v[128:131], a[100:103], v[84:87]
    buffer_load_dwordx4 v[124:127], v23, s[24:27], s58 offen offset:1024 sc1
    v_mfma_f32_16x16x32_bf16 v[88:91], v[128:131], a[104:107], v[88:91]
    ds_read_b128 v[100:103], v233 offset:3072
    ds_read_b128 v[104:107], v234 offset:19456
    v_mfma_f32_16x16x32_bf16 v[92:95], v[128:131], a[108:111], v[92:95]
    ds_read_b128 v[108:111], v235 offset:35840
    s_waitcnt vmcnt(10)
    v_mfma_f32_16x16x32_bf16 v[80:83], v[132:135], a[112:115], v[80:83]
    s_add_u32 s58, s66, s78
    v_mfma_f32_16x16x32_bf16 v[84:87], v[132:135], a[116:119], v[84:87]
    buffer_load_dwordx4 v[128:131], v23, s[24:27], s58 offen offset:0 sc1
    v_mfma_f32_16x16x32_bf16 v[88:91], v[132:135], a[120:123], v[88:91]
    ds_read_b64_tr_b16 v[160:161], v16 offset:0
    v_mfma_f32_16x16x32_bf16 v[92:95], v[132:135], a[124:127], v[92:95]
    ds_read_b64_tr_b16 v[162:163], v16 offset:512
    s_waitcnt vmcnt(10)
    v_mfma_f32_16x16x32_bf16 v[80:83], v[136:139], a[128:131], v[80:83]
    s_waitcnt lgkmcnt(2)
    v_mfma_f32_16x16x32_bf16 v[84:87], v[136:139], a[132:135], v[84:87]
    buffer_load_dwordx4 v[132:135], v23, s[24:27], s58 offen offset:1024 sc1
    v_mfma_f32_16x16x32_bf16 v[88:91], v[136:139], a[136:139], v[88:91]
    v_add_f32 v96, v96, v100
    v_add_f32 v97, v97, v101
    ds_read_b64_tr_b16 v[164:165], v16 offset:4096
    v_mfma_f32_16x16x32_bf16 v[92:95], v[136:139], a[140:143], v[92:95]
    ds_read_b64_tr_b16 v[166:167], v16 offset:4608
    s_waitcnt vmcnt(10)
    v_mfma_f32_16x16x32_bf16 v[80:83], v[140:143], a[144:147], v[80:83]
    s_add_u32 s58, s66, s79
    v_add_f32 v98, v98, v102
    v_mfma_f32_16x16x32_bf16 v[84:87], v[140:143], a[148:151], v[84:87]
    buffer_load_dwordx4 v[136:139], v23, s[24:27], s58 offen offset:0 sc1
    v_mfma_f32_16x16x32_bf16 v[88:91], v[140:143], a[152:155], v[88:91]
    v_add_f32 v99, v99, v103
    v_add_f32 v96, v96, v104
    ds_read_b64_tr_b16 v[168:169], v16 offset:8192
    v_mfma_f32_16x16x32_bf16 v[92:95], v[140:143], a[156:159], v[92:95]
    ds_read_b64_tr_b16 v[170:171], v16 offset:8704
    s_waitcnt vmcnt(10)
    v_mfma_f32_16x16x32_bf16 v[80:83], v[144:147], a[160:163], v[80:83]
    v_add_f32 v97, v97, v105
    v_mfma_f32_16x16x32_bf16 v[84:87], v[144:147], a[164:167], v[84:87]
    buffer_load_dwordx4 v[140:143], v23, s[24:27], s58 offen offset:1024 sc1
    v_mfma_f32_16x16x32_bf16 v[88:91], v[144:147], a[168:171], v[88:91]
    v_add_f32 v98, v98, v106
    v_add_f32 v99, v99, v107
    ds_read_b64_tr_b16 v[172:173], v16 offset:12288
    v_mfma_f32_16x16x32_bf16 v[92:95], v[144:147], a[172:175], v[92:95]
    ds_read_b64_tr_b16 v[174:175], v16 offset:12800
    s_waitcnt vmcnt(10)
    v_mfma_f32_16x16x32_bf16 v[80:83], v[148:151], a[176:179], v[80:83]
    s_add_u32 s58, s66, s80
    v_mfma_f32_16x16x32_bf16 v[84:87], v[148:151], a[180:183], v[84:87]
    buffer_load_dwordx4 v[144:147], v23, s[24:27], s58 offen offset:0 sc1
    v_mfma_f32_16x16x32_bf16 v[88:91], v[148:151], a[184:187], v[88:91]
    v_add_f32 v96, v96, v108
    v_add_f32 v97, v97, v109
    v_mfma_f32_16x16x32_bf16 v[92:95], v[148:151], a[188:191], v[92:95]
    v_add_f32 v98, v98, v110
    s_waitcnt vmcnt(10)
    v_mfma_f32_16x16x32_bf16 v[80:83], v[152:155], a[192:195], v[80:83]
    v_mfma_f32_16x16x32_bf16 v[84:87], v[152:155], a[196:199], v[84:87]
    buffer_load_dwordx4 v[148:151], v23, s[24:27], s58 offen offset:1024 sc1
    v_mfma_f32_16x16x32_bf16 v[88:91], v[152:155], a[200:203], v[88:91]
    v_add_f32 v99, v99, v111
    v_mfma_f32_16x16x32_bf16 v[92:95], v[152:155], a[204:207], v[92:95]
    s_waitcnt vmcnt(10)
    v_mfma_f32_16x16x32_bf16 v[80:83], v[156:159], a[208:211], v[80:83]
    s_add_u32 s58, s66, s81
    v_mfma_f32_16x16x32_bf16 v[84:87], v[156:159], a[212:215], v[84:87]
    buffer_load_dwordx4 v[152:155], v23, s[24:27], s58 offen offset:0 sc1
    v_mfma_f32_16x16x32_bf16 v[88:91], v[156:159], a[216:219], v[88:91]
    v_mfma_f32_16x16x32_bf16 v[92:95], v[156:159], a[220:223], v[92:95]
    s_waitcnt vmcnt(10)
    v_mfma_f32_16x16x32_bf16 v[64:67], v[112:115], a[0:3], v[64:67]
    v_mfma_f32_16x16x32_bf16 v[68:71], v[112:115], a[4:7], 0
    buffer_load_dwordx4 v[156:159], v23, s[24:27], s58 offen offset:1024 sc1
    v_mfma_f32_16x16x32_bf16 v[72:75], v[112:115], a[8:11], 0
    ds_read_b64_tr_b16 v[192:193], v16 offset:1024
    v_mfma_f32_16x16x32_bf16 v[76:79], v[112:115], a[12:15], 0
    ds_read_b64_tr_b16 v[194:195], v16 offset:1536
    s_waitcnt vmcnt(10)
    v_mfma_f32_16x16x32_bf16 v[64:67], v[116:119], a[16:19], v[64:67]
    s_add_u32 s58, s66, s82
    v_mfma_f32_16x16x32_bf16 v[68:71], v[116:119], a[20:23], v[68:71]
    buffer_load_dwordx4 v[112:115], v23, s[24:27], s58 offen offset:0 sc1
    v_mfma_f32_16x16x32_bf16 v[72:75], v[116:119], a[24:27], v[72:75]
    ds_read_b64_tr_b16 v[196:197], v16 offset:5120
    ds_read_b64_tr_b16 v[198:199], v16 offset:5632
    v_mfma_f32_16x16x32_bf16 v[76:79], v[116:119], a[28:31], v[76:79]
    ds_write_b128 v232, v[84:87] offset:49152
    s_waitcnt vmcnt(10)
    v_mfma_f32_16x16x32_bf16 v[64:67], v[120:123], a[32:35], v[64:67]
    v_mfma_f32_16x16x32_bf16 v[68:71], v[120:123], a[36:39], v[68:71]
    buffer_load_dwordx4 v[116:119], v23, s[24:27], s58 offen offset:1024 sc1
    v_mfma_f32_16x16x32_bf16 v[72:75], v[120:123], a[40:43], v[72:75]
    ds_read_b64_tr_b16 v[200:201], v16 offset:9216
    ds_read_b64_tr_b16 v[202:203], v16 offset:9728
    v_mfma_f32_16x16x32_bf16 v[76:79], v[120:123], a[44:47], v[76:79]
    ds_write_b128 v232, v[88:91] offset:50176
    s_waitcnt vmcnt(10)
    v_mfma_f32_16x16x32_bf16 v[64:67], v[124:127], a[48:51], v[64:67]
    s_add_u32 s66, s69, 58624
    s_add_u32 s58, s66, s76
    v_mfma_f32_16x16x32_bf16 v[68:71], v[124:127], a[52:55], v[68:71]
    buffer_load_dwordx4 v[120:123], v23, s[24:27], s58 offen offset:0 sc1
    v_mfma_f32_16x16x32_bf16 v[72:75], v[124:127], a[56:59], v[72:75]
    ds_read_b64_tr_b16 v[204:205], v16 offset:13312
    ds_read_b64_tr_b16 v[206:207], v16 offset:13824
    v_mfma_f32_16x16x32_bf16 v[76:79], v[124:127], a[60:63], v[76:79]
    ds_write_b128 v232, v[92:95] offset:51200
    s_waitcnt vmcnt(10)
    v_mfma_f32_16x16x32_bf16 v[64:67], v[128:131], a[64:67], v[64:67]
    v_mfma_f32_16x16x32_bf16 v[68:71], v[128:131], a[68:71], v[68:71]
    buffer_load_dwordx4 v[124:127], v23, s[24:27], s58 offen offset:1024 sc1
    v_mfma_f32_16x16x32_bf16 v[72:75], v[128:131], a[72:75], v[72:75]
    ds_read_b64_tr_b16 v[100:101], v16 offset:2048
    v_mfma_f32_16x16x32_bf16 v[76:79], v[128:131], a[76:79], v[76:79]
    ds_read_b64_tr_b16 v[102:103], v16 offset:2560
    s_waitcnt vmcnt(10)
    v_mfma_f32_16x16x32_bf16 v[64:67], v[132:135], a[80:83], v[64:67]
    s_add_u32 s58, s66, s77
    v_mfma_f32_16x16x32_bf16 v[68:71], v[132:135], a[84:87], v[68:71]
    buffer_load_dwordx4 v[128:131], v23, s[24:27], s58 offen offset:0 sc1
    v_mfma_f32_16x16x32_bf16 v[72:75], v[132:135], a[88:91], v[72:75]
    s_waitcnt lgkmcnt(2)
    s_barrier
    v_mfma_f32_16x16x32_bf16 v[76:79], v[132:135], a[92:95], v[76:79]
    s_waitcnt vmcnt(10)
    v_mfma_f32_16x16x32_bf16 v[64:67], v[136:139], a[96:99], v[64:67]
    v_mfma_f32_16x16x32_bf16 v[68:71], v[136:139], a[100:103], v[68:71]
    buffer_load_dwordx4 v[132:135], v23, s[24:27], s58 offen offset:1024 sc1
    v_mfma_f32_16x16x32_bf16 v[72:75], v[136:139], a[104:107], v[72:75]
    ds_read_b128 v[84:87], v233 offset:49152
    ds_read_b128 v[88:91], v234 offset:50176
    v_mfma_f32_16x16x32_bf16 v[76:79], v[136:139], a[108:111], v[76:79]
    ds_read_b128 v[92:95], v235 offset:51200
    s_waitcnt vmcnt(10)
    v_mfma_f32_16x16x32_bf16 v[64:67], v[140:143], a[112:115], v[64:67]
    s_add_u32 s58, s66, s78
    v_mfma_f32_16x16x32_bf16 v[68:71], v[140:143], a[116:119], v[68:71]
    buffer_load_dwordx4 v[136:139], v23, s[24:27], s58 offen offset:0 sc1
    v_mfma_f32_16x16x32_bf16 v[72:75], v[140:143], a[120:123], v[72:75]
    ds_read_b64_tr_b16 a[224:225], v246 offset:0
    v_mfma_f32_16x16x32_bf16 v[76:79], v[140:143], a[124:127], v[76:79]
    ds_read_b64_tr_b16 a[226:227], v246 offset:512
    s_waitcnt vmcnt(10)
    v_mfma_f32_16x16x32_bf16 v[64:67], v[144:147], a[128:131], v[64:67]
    s_waitcnt lgkmcnt(2)
    v_mfma_f32_16x16x32_bf16 v[68:71], v[144:147], a[132:135], v[68:71]
    buffer_load_dwordx4 v[140:143], v23, s[24:27], s58 offen offset:1024 sc1
    v_mfma_f32_16x16x32_bf16 v[72:75], v[144:147], a[136:139], v[72:75]
    v_add_f32 v80, v80, v84
    v_add_f32 v81, v81, v85
    ds_read_b64_tr_b16 a[228:229], v247 offset:0
    v_mfma_f32_16x16x32_bf16 v[76:79], v[144:147], a[140:143], v[76:79]
    ds_read_b64_tr_b16 a[230:231], v247 offset:512
    s_waitcnt vmcnt(10)
    v_mfma_f32_16x16x32_bf16 v[64:67], v[148:151], a[144:147], v[64:67]
    s_add_u32 s58, s66, s79
    v_add_f32 v82, v82, v86
    v_mfma_f32_16x16x32_bf16 v[68:71], v[148:151], a[148:151], v[68:71]
    buffer_load_dwordx4 v[144:147], v23, s[24:27], s58 offen offset:0 sc1
    v_mfma_f32_16x16x32_bf16 v[72:75], v[148:151], a[152:155], v[72:75]
    v_add_f32 v83, v83, v87
    v_add_f32 v80, v80, v88
    ds_read_b64_tr_b16 a[232:233], v246 offset:256
    v_mfma_f32_16x16x32_bf16 v[76:79], v[148:151], a[156:159], v[76:79]
    ds_read_b64_tr_b16 a[234:235], v246 offset:768
    s_waitcnt vmcnt(10)
    v_mfma_f32_16x16x32_bf16 v[64:67], v[152:155], a[160:163], v[64:67]
    v_add_f32 v81, v81, v89
    v_mfma_f32_16x16x32_bf16 v[68:71], v[152:155], a[164:167], v[68:71]
    buffer_load_dwordx4 v[148:151], v23, s[24:27], s58 offen offset:1024 sc1
    v_mfma_f32_16x16x32_bf16 v[72:75], v[152:155], a[168:171], v[72:75]
    v_add_f32 v82, v82, v90
    v_add_f32 v83, v83, v91
    ds_read_b64_tr_b16 a[236:237], v247 offset:256
    v_mfma_f32_16x16x32_bf16 v[76:79], v[152:155], a[172:175], v[76:79]
    ds_read_b64_tr_b16 a[238:239], v247 offset:768
    s_waitcnt vmcnt(10)
    v_mfma_f32_16x16x32_bf16 v[64:67], v[156:159], a[176:179], v[64:67]
    s_add_u32 s58, s66, s80
    v_mfma_f32_16x16x32_bf16 v[68:71], v[156:159], a[180:183], v[68:71]
    buffer_load_dwordx4 v[152:155], v23, s[24:27], s58 offen offset:0 sc1
    v_mfma_f32_16x16x32_bf16 v[72:75], v[156:159], a[184:187], v[72:75]
    v_add_f32 v80, v80, v92
    v_add_f32 v81, v81, v93
    v_mfma_f32_16x16x32_bf16 v[76:79], v[156:159], a[188:191], v[76:79]
    v_add_f32 v82, v82, v94
    s_waitcnt vmcnt(10)
    v_mfma_f32_16x16x32_bf16 v[64:67], v[112:115], a[192:195], v[64:67]
    v_mfma_f32_16x16x32_bf16 v[68:71], v[112:115], a[196:199], v[68:71]
    buffer_load_dwordx4 v[156:159], v23, s[24:27], s58 offen offset:1024 sc1
    v_mfma_f32_16x16x32_bf16 v[72:75], v[112:115], a[200:203], v[72:75]
    v_add_f32 v83, v83, v95
    v_mfma_f32_16x16x32_bf16 v[76:79], v[112:115], a[204:207], v[76:79]
    s_waitcnt vmcnt(10)
    v_mfma_f32_16x16x32_bf16 v[64:67], v[116:119], a[208:211], v[64:67]
    s_add_u32 s58, s66, s81
    v_mfma_f32_16x16x32_bf16 v[68:71], v[116:119], a[212:215], v[68:71]
    buffer_load_dwordx4 v[112:115], v23, s[24:27], s58 offen offset:0 sc1
    v_mfma_f32_16x16x32_bf16 v[72:75], v[116:119], a[216:219], v[72:75]
    v_mfma_f32_16x16x32_bf16 v[76:79], v[116:119], a[220:223], v[76:79]
    s_waitcnt vmcnt(10)
    v_mfma_f32_16x16x32_bf16 v[48:51], v[120:123], a[0:3], v[48:51]
    v_mfma_f32_16x16x32_bf16 v[52:55], v[120:123], a[4:7], 0
    buffer_load_dwordx4 v[116:119], v23, s[24:27], s58 offen offset:1024 sc1
    v_mfma_f32_16x16x32_bf16 v[56:59], v[120:123], a[8:11], 0
    ds_read_b64_tr_b16 v[104:105], v16 offset:6144
    v_mfma_f32_16x16x32_bf16 v[60:63], v[120:123], a[12:15], 0
    ds_read_b64_tr_b16 v[106:107], v16 offset:6656
    s_waitcnt vmcnt(10)
    v_mfma_f32_16x16x32_bf16 v[48:51], v[124:127], a[16:19], v[48:51]
    s_add_u32 s58, s66, s82
    v_mfma_f32_16x16x32_bf16 v[52:55], v[124:127], a[20:23], v[52:55]
    buffer_load_dwordx4 v[120:123], v23, s[24:27], s58 offen offset:0 sc1
    v_mfma_f32_16x16x32_bf16 v[56:59], v[124:127], a[24:27], v[56:59]
    ds_read_b64_tr_b16 v[108:109], v16 offset:10240
    ds_read_b64_tr_b16 v[110:111], v16 offset:10752
    v_mfma_f32_16x16x32_bf16 v[60:63], v[124:127], a[28:31], v[60:63]
    ds_write_b128 v232, v[68:71] offset:32768
    s_waitcnt vmcnt(10)
    v_mfma_f32_16x16x32_bf16 v[48:51], v[128:131], a[32:35], v[48:51]
    v_mfma_f32_16x16x32_bf16 v[52:55], v[128:131], a[36:39], v[52:55]
    buffer_load_dwordx4 v[124:127], v23, s[24:27], s58 offen offset:1024 sc1
    v_mfma_f32_16x16x32_bf16 v[56:59], v[128:131], a[40:43], v[56:59]
    ds_read_b64_tr_b16 v[84:85], v16 offset:14336
    ds_read_b64_tr_b16 v[86:87], v16 offset:14848
    v_mfma_f32_16x16x32_bf16 v[60:63], v[128:131], a[44:47], v[60:63]
    ds_write_b128 v232, v[72:75] offset:33792
    s_waitcnt vmcnt(10)
    v_mfma_f32_16x16x32_bf16 v[48:51], v[132:135], a[48:51], v[48:51]
    s_add_u32 s66, s69, 0
    s_add_u32 s58, s66, s76
    v_mfma_f32_16x16x32_bf16 v[52:55], v[132:135], a[52:55], v[52:55]
    buffer_load_dwordx4 v[128:131], v23, s[24:27], s58 offen offset:0 sc1
    v_mfma_f32_16x16x32_bf16 v[56:59], v[132:135], a[56:59], v[56:59]
    ds_read_b64_tr_b16 v[88:89], v16 offset:3072
    ds_read_b64_tr_b16 v[90:91], v16 offset:3584
    v_mfma_f32_16x16x32_bf16 v[60:63], v[132:135], a[60:63], v[60:63]
    ds_write_b128 v232, v[76:79] offset:34816
    s_waitcnt vmcnt(10)
    v_mfma_f32_16x16x32_bf16 v[48:51], v[136:139], a[64:67], v[48:51]
    v_mfma_f32_16x16x32_bf16 v[52:55], v[136:139], a[68:71], v[52:55]
    buffer_load_dwordx4 v[132:135], v23, s[24:27], s58 offen offset:1024 sc1
    v_mfma_f32_16x16x32_bf16 v[56:59], v[136:139], a[72:75], v[56:59]
    ds_read_b64_tr_b16 v[92:93], v16 offset:7168
    v_mfma_f32_16x16x32_bf16 v[60:63], v[136:139], a[76:79], v[60:63]
    ds_read_b64_tr_b16 v[94:95], v16 offset:7680
    s_waitcnt vmcnt(10)
    v_mfma_f32_16x16x32_bf16 v[48:51], v[140:143], a[80:83], v[48:51]
    s_add_u32 s58, s66, s77
    v_mfma_f32_16x16x32_bf16 v[52:55], v[140:143], a[84:87], v[52:55]
    buffer_load_dwordx4 v[136:139], v23, s[24:27], s58 offen offset:0 sc1
    v_mfma_f32_16x16x32_bf16 v[56:59], v[140:143], a[88:91], v[56:59]
    s_waitcnt lgkmcnt(2)
    s_barrier
    v_mfma_f32_16x16x32_bf16 v[60:63], v[140:143], a[92:95], v[60:63]
    s_waitcnt vmcnt(10)
    v_mfma_f32_16x16x32_bf16 v[48:51], v[144:147], a[96:99], v[48:51]
    v_mfma_f32_16x16x32_bf16 v[52:55], v[144:147], a[100:103], v[52:55]
    buffer_load_dword v19, v21, s[24:27], 0 offen sc1
    v_mfma_f32_16x16x32_bf16 v[56:59], v[144:147], a[104:107], v[56:59]
    ds_read_b128 v[68:71], v233 offset:32768
    ds_read_b128 v[72:75], v234 offset:33792
    v_mfma_f32_16x16x32_bf16 v[60:63], v[144:147], a[108:111], v[60:63]
    ds_read_b128 v[76:79], v235 offset:34816
    s_waitcnt vmcnt(10)
    v_mfma_f32_16x16x32_bf16 v[48:51], v[148:151], a[112:115], v[48:51]
    v_mfma_f32_16x16x32_bf16 v[52:55], v[148:151], a[116:119], v[52:55]
    buffer_load_dwordx4 v[140:143], v23, s[24:27], s58 offen offset:1024 sc1
    v_mfma_f32_16x16x32_bf16 v[56:59], v[148:151], a[120:123], v[56:59]
    ds_read_b64_tr_b16 a[240:241], v246 offset:4096
    v_mfma_f32_16x16x32_bf16 v[60:63], v[148:151], a[124:127], v[60:63]
    ds_read_b64_tr_b16 a[242:243], v246 offset:4608
    s_waitcnt vmcnt(10)
    v_mfma_f32_16x16x32_bf16 v[48:51], v[152:155], a[128:131], v[48:51]
    s_add_u32 s58, s66, s78
    s_waitcnt lgkmcnt(2)
    v_mfma_f32_16x16x32_bf16 v[52:55], v[152:155], a[132:135], v[52:55]
    buffer_load_dwordx4 v[144:147], v23, s[24:27], s58 offen offset:0 sc1
    v_mfma_f32_16x16x32_bf16 v[56:59], v[152:155], a[136:139], v[56:59]
    v_add_f32 v64, v64, v68
    v_add_f32 v65, v65, v69
    ds_read_b64_tr_b16 a[244:245], v247 offset:4096
    v_mfma_f32_16x16x32_bf16 v[60:63], v[152:155], a[140:143], v[60:63]
    ds_read_b64_tr_b16 a[246:247], v247 offset:4608
    s_waitcnt vmcnt(10)
    v_mfma_f32_16x16x32_bf16 v[48:51], v[156:159], a[144:147], v[48:51]
    v_add_f32 v66, v66, v70
    v_mfma_f32_16x16x32_bf16 v[52:55], v[156:159], a[148:151], v[52:55]
    buffer_load_dwordx4 v[148:151], v23, s[24:27], s58 offen offset:1024 sc1
    v_mfma_f32_16x16x32_bf16 v[56:59], v[156:159], a[152:155], v[56:59]
    v_add_f32 v67, v67, v71
    v_add_f32 v64, v64, v72
    ds_read_b64_tr_b16 a[248:249], v246 offset:4352
    v_mfma_f32_16x16x32_bf16 v[60:63], v[156:159], a[156:159], v[60:63]
    ds_read_b64_tr_b16 a[250:251], v246 offset:4864
    s_waitcnt vmcnt(10)
    v_mfma_f32_16x16x32_bf16 v[48:51], v[112:115], a[160:163], v[48:51]
    s_add_u32 s58, s66, s79
    v_add_f32 v65, v65, v73
    v_mfma_f32_16x16x32_bf16 v[52:55], v[112:115], a[164:167], v[52:55]
    buffer_load_dwordx4 v[152:155], v23, s[24:27], s58 offen offset:0 sc1
    v_mfma_f32_16x16x32_bf16 v[56:59], v[112:115], a[168:171], v[56:59]
    v_add_f32 v66, v66, v74
    v_add_f32 v67, v67, v75
    ds_read_b64_tr_b16 a[252:253], v247 offset:4352
    v_mfma_f32_16x16x32_bf16 v[60:63], v[112:115], a[172:175], v[60:63]
    ds_read_b64_tr_b16 a[254:255], v247 offset:4864
    s_waitcnt vmcnt(10)
    v_mfma_f32_16x16x32_bf16 v[48:51], v[116:119], a[176:179], v[48:51]
    v_mfma_f32_16x16x32_bf16 v[52:55], v[116:119], a[180:183], v[52:55]
    buffer_load_dwordx4 v[156:159], v23, s[24:27], s58 offen offset:1024 sc1
    v_mfma_f32_16x16x32_bf16 v[56:59], v[116:119], a[184:187], v[56:59]
    v_add_f32 v64, v64, v76
    v_add_f32 v65, v65, v77
    v_mfma_f32_16x16x32_bf16 v[60:63], v[116:119], a[188:191], v[60:63]
    v_add_f32 v66, v66, v78
    s_waitcnt vmcnt(10)
    v_mfma_f32_16x16x32_bf16 v[48:51], v[120:123], a[192:195], v[48:51]
    s_add_u32 s58, s66, s80
    v_mfma_f32_16x16x32_bf16 v[52:55], v[120:123], a[196:199], v[52:55]
    buffer_load_dwordx4 v[112:115], v23, s[24:27], s58 offen offset:0 sc1
    v_mfma_f32_16x16x32_bf16 v[56:59], v[120:123], a[200:203], v[56:59]
    v_add_f32 v67, v67, v79
    v_mfma_f32_16x16x32_bf16 v[60:63], v[120:123], a[204:207], v[60:63]
    s_waitcnt vmcnt(10)
    v_mfma_f32_16x16x32_bf16 v[48:51], v[124:127], a[208:211], v[48:51]
    v_mfma_f32_16x16x32_bf16 v[52:55], v[124:127], a[212:215], v[52:55]
    buffer_load_dwordx4 v[116:119], v23, s[24:27], s58 offen offset:1024 sc1
    v_mfma_f32_16x16x32_bf16 v[56:59], v[124:127], a[216:219], v[56:59]
    v_mfma_f32_16x16x32_bf16 v[60:63], v[124:127], a[220:223], v[60:63]
    s_waitcnt vmcnt(10)
    v_mfma_f32_16x16x32_bf16 v[32:35], v[128:131], a[0:3], v[32:35]
    s_add_u32 s58, s66, s81
    v_mfma_f32_16x16x32_bf16 v[36:39], v[128:131], a[4:7], 0
    buffer_load_dwordx4 v[120:123], v23, s[24:27], s58 offen offset:0 sc1
    v_mfma_f32_16x16x32_bf16 v[40:43], v[128:131], a[8:11], 0
    v_mfma_f32_16x16x32_bf16 v[44:47], v[128:131], a[12:15], 0
    s_waitcnt vmcnt(10)
    v_mfma_f32_16x16x32_bf16 v[32:35], v[132:135], a[16:19], v[32:35]
    ds_write_b128 v232, v[52:55] offset:16384
    v_mfma_f32_16x16x32_bf16 v[36:39], v[132:135], a[20:23], v[36:39]
    buffer_load_dwordx4 v[124:127], v23, s[24:27], s58 offen offset:1024 sc1
    v_mfma_f32_16x16x32_bf16 v[40:43], v[132:135], a[24:27], v[40:43]
    ds_read_b64_tr_b16 a[0:1], v246 offset:8192
    ds_read_b64_tr_b16 a[2:3], v246 offset:8704
    ds_read_b64_tr_b16 a[4:5], v247 offset:8192
    v_mfma_f32_16x16x32_bf16 v[44:47], v[132:135], a[28:31], v[44:47]
    ds_read_b64_tr_b16 a[6:7], v247 offset:8704
    s_waitcnt vmcnt(10)
    v_mfma_f32_16x16x32_bf16 v[32:35], v[136:139], a[32:35], v[32:35]
    s_add_u32 s58, s66, s82
    ds_write_b128 v232, v[56:59] offset:17408
    v_mfma_f32_16x16x32_bf16 v[36:39], v[136:139], a[36:39], v[36:39]
    buffer_load_dwordx4 v[128:131], v23, s[24:27], s58 offen offset:0 sc1
    v_mfma_f32_16x16x32_bf16 v[40:43], v[136:139], a[40:43], v[40:43]
    ds_read_b64_tr_b16 a[8:9], v246 offset:8448
    ds_read_b64_tr_b16 a[10:11], v246 offset:8960
    ds_read_b64_tr_b16 a[12:13], v247 offset:8448
    v_mfma_f32_16x16x32_bf16 v[44:47], v[136:139], a[44:47], v[44:47]
    ds_read_b64_tr_b16 a[14:15], v247 offset:8960
    buffer_load_dwordx4 v[132:135], v23, s[24:27], s58 offen offset:1024 sc1
    s_waitcnt vmcnt(11)
    v_cmp_ne_u32 vcc, s47, v19
    s_nop 0
    s_cbranch_vccz L_ok10
    s_mov_b32 s59, 100000
L_spin9:
    buffer_load_dword v19, v21, s[24:27], 0 offen sc1
    s_waitcnt vmcnt(0)
    v_cmp_ne_u32 vcc, s47, v19
    s_nop 0
    s_cbranch_vccz L_ok10
    s_sub_u32 s59, s59, 1
    s_cbranch_scc0 L_spin9
L_ok10:
    s_waitcnt vmcnt(10)
    v_mfma_f32_16x16x32_bf16 v[32:35], v[140:143], a[48:51], v[32:35]
    s_add_u32 s58, s70, 0
    ds_write_b128 v232, v[60:63] offset:18432
    v_mfma_f32_16x16x32_bf16 v[36:39], v[140:143], a[52:55], v[36:39]
    buffer_load_dwordx4 v[136:139], v23, s[24:27], s58 offen offset:0 sc1
    v_mfma_f32_16x16x32_bf16 v[40:43], v[140:143], a[56:59], v[40:43]
    ds_read_b64_tr_b16 a[16:17], v246 offset:12288
    ds_read_b64_tr_b16 a[18:19], v246 offset:12800
    ds_read_b64_tr_b16 a[20:21], v247 offset:12288
L_wb_3:
    s_cbranch_execz L_wb_ret
    v_mfma_f32_16x16x32_bf16 v[44:47], v[140:143], a[60:63], v[44:47]
    ds_read_b64_tr_b16 a[22:23], v247 offset:12800
    s_waitcnt vmcnt(10)
    v_mfma_f32_16x16x32_bf16 v[32:35], v[144:147], a[64:67], v[32:35]
    ds_read_b64_tr_b16 a[24:25], v246 offset:12544
    v_mfma_f32_16x16x32_bf16 v[36:39], v[144:147], a[68:71], v[36:39]
    buffer_load_dwordx4 v[140:143], v23, s[24:27], s58 offen offset:1024 sc1
    v_mfma_f32_16x16x32_bf16 v[40:43], v[144:147], a[72:75], v[40:43]
    ds_read_b64_tr_b16 a[26:27], v246 offset:13056
    ds_read_b64_tr_b16 a[28:29], v247 offset:12544
    v_mfma_f32_16x16x32_bf16 v[44:47], v[144:147], a[76:79], v[44:47]
    ds_read_b64_tr_b16 a[30:31], v247 offset:13056
    s_waitcnt vmcnt(10)
    v_mfma_f32_16x16x32_bf16 v[32:35], v[148:151], a[80:83], v[32:35]
    ds_read_b64_tr_b16 a[32:33], v246 offset:16384
    v_mfma_f32_16x16x32_bf16 v[36:39], v[148:151], a[84:87], v[36:39]
    buffer_load_dwordx4 v[144:147], v23, s[24:27], s58 offen offset:2048 sc1
    v_mfma_f32_16x16x32_bf16 v[40:43], v[148:151], a[88:91], v[40:43]
    ds_read_b64_tr_b16 a[34:35], v246 offset:16896
    ds_read_b64_tr_b16 a[36:37], v247 offset:16384
    v_mfma_f32_16x16x32_bf16 v[44:47], v[148:151], a[92:95], v[44:47]
    ds_read_b64_tr_b16 a[38:39], v247 offset:16896
    s_waitcnt vmcnt(10)
    v_mfma_f32_16x16x32_bf16 v[32:35], v[152:155], a[96:99], v[32:35]
    ds_read_b64_tr_b16 a[40:41], v246 offset:16640
    v_mfma_f32_16x16x32_bf16 v[36:39], v[152:155], a[100:103], v[36:39]
    buffer_load_dwordx4 v[148:151], v23, s[24:27], s58 offen offset:3072 sc1
    v_mfma_f32_16x16x32_bf16 v[40:43], v[152:155], a[104:107], v[40:43]
    ds_read_b64_tr_b16 a[42:43], v246 offset:17152
    ds_read_b64_tr_b16 a[44:45], v247 offset:16640
    v_mfma_f32_16x16x32_bf16 v[44:47], v[152:155], a[108:111], v[44:47]
    ds_read_b64_tr_b16 a[46:47], v247 offset:17152
    s_waitcnt vmcnt(10)
    v_mfma_f32_16x16x32_bf16 v[32:35], v[156:159], a[112:115], v[32:35]
    s_add_u32 s58, s70, 4096
    ds_read_b64_tr_b16 a[48:49], v246 offset:20480
    v_mfma_f32_16x16x32_bf16 v[36:39], v[156:159], a[116:119], v[36:39]
    buffer_load_dwordx4 v[152:155], v23, s[24:27], s58 offen offset:0 sc1
    v_mfma_f32_16x16x32_bf16 v[40:43], v[156:159], a[120:123], v[40:43]
    ds_read_b64_tr_b16 a[50:51], v246 offset:20992
    ds_read_b64_tr_b16 a[52:53], v247 offset:20480
    v_mfma_f32_16x16x32_bf16 v[44:47], v[156:159], a[124:127], v[44:47]
    ds_read_b64_tr_b16 a[54:55], v247 offset:20992
    s_waitcnt vmcnt(10)
    v_mfma_f32_16x16x32_bf16 v[32:35], v[112:115], a[128:131], v[32:35]
    ds_read_b64_tr_b16 a[56:57], v246 offset:20736
    v_mfma_f32_16x16x32_bf16 v[36:39], v[112:115], a[132:135], v[36:39]
    buffer_load_dwordx4 v[156:159], v23, s[24:27], s58 offen offset:1024 sc1
    v_mfma_f32_16x16x32_bf16 v[40:43], v[112:115], a[136:139], v[40:43]
    ds_read_b64_tr_b16 a[58:59], v246 offset:21248
    ds_read_b64_tr_b16 a[60:61], v247 offset:20736
    v_mfma_f32_16x16x32_bf16 v[44:47], v[112:115], a[140:143], v[44:47]
    ds_read_b64_tr_b16 a[62:63], v247 offset:21248
    s_waitcnt vmcnt(10)
    v_mfma_f32_16x16x32_bf16 v[32:35], v[116:119], a[144:147], v[32:35]
    ds_read_b64_tr_b16 a[64:65], v246 offset:24576
    v_mfma_f32_16x16x32_bf16 v[36:39], v[116:119], a[148:151], v[36:39]
    buffer_load_dwordx4 v[112:115], v23, s[24:27], s58 offen offset:2048 sc1
    v_mfma_f32_16x16x32_bf16 v[40:43], v[116:119], a[152:155], v[40:43]
    ds_read_b64_tr_b16 a[66:67], v246 offset:25088
    ds_read_b64_tr_b16 a[68:69], v247 offset:24576
    v_mfma_f32_16x16x32_bf16 v[44:47], v[116:119], a[156:159], v[44:47]
    ds_read_b64_tr_b16 a[70:71], v247 offset:25088
    s_waitcnt vmcnt(10)
    v_mfma_f32_16x16x32_bf16 v[32:35], v[120:123], a[160:163], v[32:35]
    ds_read_b64_tr_b16 a[72:73], v246 offset:24832
    v_mfma_f32_16x16x32_bf16 v[36:39], v[120:123], a[164:167], v[36:39]
    buffer_load_dwordx4 v[116:119], v23, s[24:27], s58 offen offset:3072 sc1
    v_mfma_f32_16x16x32_bf16 v[40:43], v[120:123], a[168:171], v[40:43]
    ds_read_b64_tr_b16 a[74:75], v246 offset:25344
    ds_read_b64_tr_b16 a[76:77], v247 offset:24832
    v_mfma_f32_16x16x32_bf16 v[44:47], v[120:123], a[172:175], v[44:47]
    ds_read_b64_tr_b16 a[78:79], v247 offset:25344
    s_waitcnt vmcnt(10)
    v_mfma_f32_16x16x32_bf16 v[32:35], v[124:127], a[176:179], v[32:35]
    s_add_u32 s58, s70, 8192
    ds_read_b64_tr_b16 a[80:81], v246 offset:28672
    v_mfma_f32_16x16x32_bf16 v[36:39], v[124:127], a[180:183], v[36:39]
    buffer_load_dwordx4 v[120:123], v23, s[24:27], s58 offen offset:0 sc1
    v_mfma_f32_16x16x32_bf16 v[40:43], v[124:127], a[184:187], v[40:43]
    ds_read_b64_tr_b16 a[82:83], v246 offset:29184
    ds_read_b64_tr_b16 a[84:85], v247 offset:28672
    v_mfma_f32_16x16x32_bf16 v[44:47], v[124:127], a[188:191], v[44:47]
    ds_read_b64_tr_b16 a[86:87], v247 offset:29184
    s_waitcnt vmcnt(10)
    v_mfma_f32_16x16x32_bf16 v[32:35], v[128:131], a[192:195], v[32:35]
    ds_read_b64_tr_b16 a[88:89], v246 offset:28928
    v_mfma_f32_16x16x32_bf16 v[36:39], v[128:131], a[196:199], v[36:39]
    buffer_load_dwordx4 v[124:127], v23, s[24:27], s58 offen offset:1024 sc1
    v_mfma_f32_16x16x32_bf16 v[40:43], v[128:131], a[200:203], v[40:43]
    ds_read_b64_tr_b16 a[90:91], v246 offset:29440
    ds_read_b64_tr_b16 a[92:93], v247 offset:28928
    v_mfma_f32_16x16x32_bf16 v[44:47], v[128:131], a[204:207], v[44:47]
    ds_read_b64_tr_b16 a[94:95], v247 offset:29440
    s_waitcnt vmcnt(10)
    v_mfma_f32_16x16x32_bf16 v[32:35], v[132:135], a[208:211], v[32:35]
    ds_read_b64_tr_b16 a[96:97], v246 offset:32768
    v_mfma_f32_16x16x32_bf16 v[36:39], v[132:135], a[212:215], v[36:39]
    buffer_load_dwordx4 v[128:131], v23, s[24:27], s58 offen offset:2048 sc1
    v_mfma_f32_16x16x32_bf16 v[40:43], v[132:135], a[216:219], v[40:43]
    ds_read_b64_tr_b16 a[98:99], v246 offset:33280
    ds_read_b64_tr_b16 a[100:101], v247 offset:32768
    v_mfma_f32_16x16x32_bf16 v[44:47], v[132:135], a[220:223], v[44:47]
    ds_read_b64_tr_b16 a[102:103], v247 offset:33280
    s_waitcnt vmcnt(10)
    v_mfma_f32_16x16x32_bf16 v[32:35], a[224:227], v[136:139], v[32:35]
    v_mfma_f32_16x16x32_bf16 v[48:51], a[228:231], v[136:139], v[48:51]
    buffer_load_dwordx4 v[132:135], v23, s[24:27], s58 offen offset:3072 sc1
    v_mfma_f32_16x16x32_bf16 v[64:67], a[232:235], v[136:139], v[64:67]
    ds_read_b64_tr_b16 a[104:105], v246 offset:33024
    ds_read_b64_tr_b16 a[106:107], v246 offset:33536
    v_mfma_f32_16x16x32_bf16 v[80:83], a[236:239], v[136:139], v[80:83]
    ds_read_b64_tr_b16 a[108:109], v247 offset:33024
    ds_read_b64_tr_b16 a[110:111], v247 offset:33536
    v_mfma_f32_16x16x32_bf16 v[96:99], v[160:163], v[136:139], v[96:99]
    ds_read_b64_tr_b16 a[112:113], v246 offset:36864
    s_waitcnt lgkmcnt(15)
    s_waitcnt vmcnt(10)
    v_mfma_f32_16x16x32_bf16 v[32:35], a[240:243], v[140:143], v[32:35]
    s_add_u32 s58, s70, 12288
    v_mfma_f32_16x16x32_bf16 v[48:51], a[244:247], v[140:143], v[48:51]
    buffer_load_dwordx4 v[136:139], v23, s[24:27], s58 offen offset:0 sc1
    v_mfma_f32_16x16x32_bf16 v[64:67], a[248:251], v[140:143], v[64:67]
    ds_read_b64_tr_b16 a[114:115], v246 offset:37376
    ds_read_b64_tr_b16 a[116:117], v247 offset:36864
    v_mfma_f32_16x16x32_bf16 v[80:83], a[252:255], v[140:143], v[80:83]
    ds_read_b64_tr_b16 a[118:119], v247 offset:37376
    ds_read_b64_tr_b16 a[120:121], v246 offset:37120
    v_mfma_f32_16x16x32_bf16 v[96:99], v[164:167], v[140:143], v[96:99]
    ds_write_b128 v232, v[36:39] offset:0
    s_waitcnt vmcnt(10)
    v_mfma_f32_16x16x32_bf16 v[32:35], a[0:3], v[144:147], v[32:35]
    v_mfma_f32_16x16x32_bf16 v[48:51], a[4:7], v[144:147], v[48:51]
    buffer_load_dwordx4 v[140:143], v23, s[24:27], s58 offen offset:1024 sc1
    v_mfma_f32_16x16x32_bf16 v[64:67], a[8:11], v[144:147], v[64:67]
    ds_read_b64_tr_b16 a[122:123], v246 offset:37632
    ds_read_b64_tr_b16 a[124:125], v247 offset:37120
    v_mfma_f32_16x16x32_bf16 v[80:83], a[12:15], v[144:147], v[80:83]
    ds_read_b64_tr_b16 a[126:127], v247 offset:37632
    ds_read_b64_tr_b16 a[128:129], v246 offset:40960
    v_mfma_f32_16x16x32_bf16 v[96:99], v[168:171], v[144:147], v[96:99]
    ds_write_b128 v232, v[40:43] offset:1024
    s_waitcnt vmcnt(10)
    v_mfma_f32_16x16x32_bf16 v[32:35], a[16:19], v[148:151], v[32:35]
    ds_read_b64_tr_b16 a[130:131], v246 offset:41472
    v_mfma_f32_16x16x32_bf16 v[48:51], a[20:23], v[148:151], v[48:51]
    ds_read_b64_tr_b16 a[132:133], v247 offset:40960
    v_mfma_f32_16x16x32_bf16 v[64:67], a[24:27], v[148:151], v[64:67]
    ds_read_b64_tr_b16 a[134:135], v247 offset:41472
    v_mfma_f32_16x16x32_bf16 v[80:83], a[28:31], v[148:151], v[80:83]
    ds_read_b64_tr_b16 a[136:137], v246 offset:41216
    v_mfma_f32_16x16x32_bf16 v[96:99], v[172:175], v[148:151], v[96:99]
    ds_write_b128 v232, v[44:47] offset:2048
    s_waitcnt vmcnt(9)
    v_mfma_f32_16x16x32_bf16 v[32:35], a[32:35], v[152:155], v[32:35]
    ds_read_b64_tr_b16 a[138:139], v246 offset:41728
    v_mfma_f32_16x16x32_bf16 v[48:51], a[36:39], v[152:155], v[48:51]
    ds_read_b64_tr_b16 a[140:141], v247 offset:41216
    v_mfma_f32_16x16x32_bf16 v[64:67], a[40:43], v[152:155], v[64:67]
    ds_read_b64_tr_b16 a[142:143], v247 offset:41728
    v_mfma_f32_16x16x32_bf16 v[80:83], a[44:47], v[152:155], v[80:83]
    ds_read_b64_tr_b16 a[144:145], v246 offset:45056
    v_mfma_f32_16x16x32_bf16 v[96:99], v[192:195], v[152:155], v[96:99]
    ds_read_b64_tr_b16 a[146:147], v246 offset:45568
    s_waitcnt vmcnt(8)
    v_mfma_f32_16x16x32_bf16 v[32:35], a[48:51], v[156:159], v[32:35]
    ds_read_b64_tr_b16 a[148:149], v247 offset:45056
    v_mfma_f32_16x16x32_bf16 v[48:51], a[52:55], v[156:159], v[48:51]
    ds_read_b64_tr_b16 a[150:151], v247 offset:45568
    v_mfma_f32_16x16x32_bf16 v[64:67], a[56:59], v[156:159], v[64:67]
    ds_read_b64_tr_b16 a[152:153], v246 offset:45312
    v_mfma_f32_16x16x32_bf16 v[80:83], a[60:63], v[156:159], v[80:83]
    ds_read_b64_tr_b16 a[154:155], v246 offset:45824
    v_mfma_f32_16x16x32_bf16 v[96:99], v[196:199], v[156:159], v[96:99]
    s_waitcnt lgkmcnt(9)
    s_barrier
    s_waitcnt vmcnt(7)
    v_mfma_f32_16x16x32_bf16 v[32:35], a[64:67], v[112:115], v[32:35]
    ds_read_b64_tr_b16 a[156:157], v247 offset:45312
    ds_read_b64_tr_b16 a[158:159], v247 offset:45824
    v_mfma_f32_16x16x32_bf16 v[48:51], a[68:71], v[112:115], v[48:51]
    ds_read_b64_tr_b16 a[160:161], v248 offset:49152
    ds_read_b64_tr_b16 a[162:163], v248 offset:49664
    v_mfma_f32_16x16x32_bf16 v[64:67], a[72:75], v[112:115], v[64:67]
    ds_read_b128 v[52:55], v233 offset:16384
    v_mfma_f32_16x16x32_bf16 v[80:83], a[76:79], v[112:115], v[80:83]
    ds_read_b128 v[56:59], v234 offset:17408
    v_mfma_f32_16x16x32_bf16 v[96:99], v[200:203], v[112:115], v[96:99]
    ds_read_b128 v[60:63], v235 offset:18432
    s_waitcnt vmcnt(6)
    v_mfma_f32_16x16x32_bf16 v[32:35], a[80:83], v[116:119], v[32:35]
    ds_read_b64_tr_b16 a[164:165], v249 offset:49152
    ds_read_b64_tr_b16 a[166:167], v249 offset:49664
    v_mfma_f32_16x16x32_bf16 v[48:51], a[84:87], v[116:119], v[48:51]
    ds_read_b64_tr_b16 a[168:169], v248 offset:49408
    ds_read_b64_tr_b16 a[170:171], v248 offset:49920
    v_mfma_f32_16x16x32_bf16 v[64:67], a[88:91], v[116:119], v[64:67]
    ds_read_b128 v[36:39], v233 offset:0
    v_mfma_f32_16x16x32_bf16 v[80:83], a[92:95], v[116:119], v[80:83]
    ds_read_b128 v[40:43], v234 offset:1024
    v_mfma_f32_16x16x32_bf16 v[96:99], v[204:207], v[116:119], v[96:99]
    ds_read_b128 v[44:47], v235 offset:2048
    s_waitcnt vmcnt(5)
    v_mfma_f32_16x16x32_bf16 v[32:35], a[96:99], v[120:123], v[32:35]
    ds_read_b64_tr_b16 a[172:173], v249 offset:49408
    v_mfma_f32_16x16x32_bf16 v[48:51], a[100:103], v[120:123], v[48:51]
    ds_read_b64_tr_b16 a[174:175], v249 offset:49920
    v_mfma_f32_16x16x32_bf16 v[64:67], a[104:107], v[120:123], v[64:67]
    ds_read_b64_tr_b16 a[176:177], v248 offset:50176
    v_mfma_f32_16x16x32_bf16 v[80:83], a[108:111], v[120:123], v[80:83]
    ds_read_b64_tr_b16 a[178:179], v248 offset:50688
    v_mfma_f32_16x16x32_bf16 v[96:99], v[100:103], v[120:123], v[96:99]
    ds_read_b64_tr_b16 a[180:181], v249 offset:50176
    s_waitcnt vmcnt(4)
    v_mfma_f32_16x16x32_bf16 v[32:35], a[112:115], v[124:127], v[32:35]
    ds_read_b64_tr_b16 a[182:183], v249 offset:50688
    v_mfma_f32_16x16x32_bf16 v[48:51], a[116:119], v[124:127], v[48:51]
    ds_read_b64_tr_b16 a[184:185], v248 offset:50432
    v_mfma_f32_16x16x32_bf16 v[64:67], a[120:123], v[124:127], v[64:67]
    ds_read_b64_tr_b16 a[186:187], v248 offset:50944
    v_mfma_f32_16x16x32_bf16 v[80:83], a[124:127], v[124:127], v[80:83]
    ds_read_b64_tr_b16 a[188:189], v249 offset:50432
    v_mfma_f32_16x16x32_bf16 v[96:99], v[104:107], v[124:127], v[96:99]
    ds_read_b64_tr_b16 a[190:191], v249 offset:50944
    s_waitcnt lgkmcnt(15)
    s_waitcnt vmcnt(3)
    v_mfma_f32_16x16x32_bf16 v[32:35], a[128:131], v[128:131], v[32:35]
    v_mfma_f32_16x16x32_bf16 v[48:51], a[132:135], v[128:131], v[48:51]
    v_add_f32 v52, v52, v56
    v_mfma_f32_16x16x32_bf16 v[64:67], a[136:139], v[128:131], v[64:67]
    v_add_f32 v53, v53, v57
    v_mfma_f32_16x16x32_bf16 v[80:83], a[140:143], v[128:131], v[80:83]
    v_add_f32 v54, v54, v58
    v_mfma_f32_16x16x32_bf16 v[96:99], v[108:111], v[128:131], v[96:99]
    v_add_f32 v55, v55, v59
    s_waitcnt vmcnt(2)
    v_mfma_f32_16x16x32_bf16 v[32:35], a[144:147], v[132:135], v[32:35]
    v_add_f32 v52, v52, v60
    v_mfma_f32_16x16x32_bf16 v[48:51], a[148:151], v[132:135], v[48:51]
    v_add_f32 v53, v53, v61
    v_mfma_f32_16x16x32_bf16 v[64:67], a[152:155], v[132:135], v[64:67]
    v_add_f32 v54, v54, v62
    v_mfma_f32_16x16x32_bf16 v[80:83], a[156:159], v[132:135], v[80:83]
    v_add_f32 v55, v55, v63
    v_mfma_f32_16x16x32_bf16 v[96:99], v[84:87], v[132:135], v[96:99]
    s_waitcnt lgkmcnt(10)
    s_waitcnt lgkmcnt(8)
    s_waitcnt vmcnt(1)
    v_mfma_f32_16x16x32_bf16 v[32:35], a[160:163], v[136:139], v[32:35]
    v_add_f32 v36, v36, v40
    v_mfma_f32_16x16x32_bf16 v[48:51], a[164:167], v[136:139], v[48:51]
    v_add_f32 v37, v37, v41
    v_mfma_f32_16x16x32_bf16 v[64:67], a[168:171], v[136:139], v[64:67]
    v_add_f32 v38, v38, v42
    v_mfma_f32_16x16x32_bf16 v[80:83], a[172:175], v[136:139], v[80:83]
    v_add_f32 v39, v39, v43
    v_mfma_f32_16x16x32_bf16 v[96:99], v[88:91], v[136:139], v[96:99]
    v_add_f32 v36, v36, v44
    s_waitcnt lgkmcnt(0)
    s_waitcnt vmcnt(0)
    v_mfma_f32_16x16x32_bf16 v[32:35], a[176:179], v[140:143], v[32:35]
    v_add_f32 v37, v37, v45
    v_mfma_f32_16x16x32_bf16 v[48:51], a[180:183], v[140:143], v[48:51]
    v_add_f32 v38, v38, v46
    v_mfma_f32_16x16x32_bf16 v[64:67], a[184:187], v[140:143], v[64:67]
    v_add_f32 v39, v39, v47
    v_mfma_f32_16x16x32_bf16 v[80:83], a[188:191], v[140:143], v[80:83]
    v_mfma_f32_16x16x32_bf16 v[96:99], v[92:95], v[140:143], v[96:99]
    s_nop 0
    v_pk_add_f32 v[32:33], v[32:33], v[36:37]
    v_pk_add_f32 v[34:35], v[34:35], v[38:39]
    v_pk_add_f32 v[48:49], v[48:49], v[52:53]
    v_pk_add_f32 v[50:51], v[50:51], v[54:55]
    v_cvt_pk_bf16_f32 v176, v32, v33
    v_cvt_pk_bf16_f32 v177, v34, v35
    ds_write_b64 v238, v[176:177] offset:0
    v_cvt_pk_bf16_f32 v178, v48, v49
    v_cvt_pk_bf16_f32 v179, v50, v51
    ds_write_b64 v238, v[178:179] offset:32
    v_cvt_pk_bf16_f32 v180, v64, v65
    v_cvt_pk_bf16_f32 v181, v66, v67
    ds_write_b64 v238, v[180:181] offset:64
    v_cvt_pk_bf16_f32 v182, v80, v81
    v_cvt_pk_bf16_f32 v183, v82, v83
    ds_write_b64 v238, v[182:183] offset:96
    ds_read_b128 v[216:219], v244 offset:0
    ds_read_b128 v[220:223], v244 offset:1408
    v_cvt_pk_bf16_f32 v184, v96, v97
    v_cvt_pk_bf16_f32 v185, v98, v99
    ds_write_b64 v238, v[184:185] offset:128
    ds_read_b64 v[224:225], v252 offset:128
    s_waitcnt lgkmcnt(3)
    buffer_store_dwordx4 v[216:219], v22, s[28:31], s71 offen
    s_waitcnt lgkmcnt(2)
    buffer_store_dwordx4 v[220:223], v22, s[28:31], s72 offen
    s_waitcnt lgkmcnt(0)
    buffer_store_dwordx2 v[224:225], v26, s[28:31], s73 offen
L_end:
    s_endpgm
L_p2_alt:
    s_add_u32 s57, s57, 27648
    buffer_load_dwordx4 v11, s[16:19], s57 offen offset:3072 lds
    s_xor_b32 s66, s44, 3
    s_lshl2_add_u32 s66, s51, s66
    s_mul_i32 s66, s66, 66816
    s_lshl2_add_u32 s66, s52, s66
    s_lshl_b32 s86, s65, 10
    s_add_u32 s58, s86, s66
    s_add_u32 s86, s66, 16384
    buffer_load_dwordx4 v[128:131], v23, s[24:27], s58 offen offset:0 sc1
    s_add_u32 s58, s58, 1024
    s_cmp_eq_u32 s58, s86
    s_cselect_b32 s58, s66, s58
    buffer_load_dwordx4 v[132:135], v23, s[24:27], s58 offen offset:0 sc1
    s_add_u32 s58, s58, 1024
    s_cmp_eq_u32 s58, s86
    s_cselect_b32 s58, s66, s58
    buffer_load_dwordx4 v[136:139], v23, s[24:27], s58 offen offset:0 sc1
    s_add_u32 s58, s58, 1024
    s_cmp_eq_u32 s58, s86
    s_cselect_b32 s58, s66, s58
    buffer_load_dwordx4 v[140:143], v23, s[24:27], s58 offen offset:0 sc1
    s_add_u32 s58, s58, 1024
    s_cmp_eq_u32 s58, s86
    s_cselect_b32 s58, s66, s58
    buffer_load_dwordx4 v[144:147], v23, s[24:27], s58 offen offset:0 sc1
    s_add_u32 s58, s58, 1024
    s_cmp_eq_u32 s58, s86
    s_cselect_b32 s58, s66, s58
    buffer_load_dwordx4 v[148:151], v23, s[24:27], s58 offen offset:0 sc1
    s_add_u32 s58, s58, 1024
    s_cmp_eq_u32 s58, s86
    s_cselect_b32 s58, s66, s58
    buffer_load_dwordx4 v[152:155], v23, s[24:27], s58 offen offset:0 sc1
    s_add_u32 s58, s58, 1024
    s_cmp_eq_u32 s58, s86
    s_cselect_b32 s58, s66, s58
    buffer_load_dwordx4 v[156:159], v23, s[24:27], s58 offen offset:0 sc1
    s_add_u32 s58, s58, 1024
    s_cmp_eq_u32 s58, s86
    s_cselect_b32 s58, s66, s58
    buffer_load_dwordx4 v[112:115], v23, s[24:27], s58 offen offset:0 sc1
    s_add_u32 s58, s58, 1024
    s_cmp_eq_u32 s58, s86
    s_cselect_b32 s58, s66, s58
    buffer_load_dwordx4 v[116:119], v23, s[24:27], s58 offen offset:0 sc1
    s_add_u32 s58, s58, 1024
    s_cmp_eq_u32 s58, s86
    s_cselect_b32 s58, s66, s58
    buffer_load_dwordx4 v[120:123], v23, s[24:27], s58 offen offset:0 sc1
    s_waitcnt vmcnt(19)
    ds_read_b64_tr_b16 a[208:209], v4 offset:32768
    ds_read_b64_tr_b16 a[210:211], v4 offset:33280
    ds_read_b64_tr_b16 a[212:213], v5 offset:32768
    ds_read_b64_tr_b16 a[214:215], v5 offset:33280
    ds_read_b64_tr_b16 a[216:217], v4 offset:33024
    ds_read_b64_tr_b16 a[218:219], v4 offset:33536
    ds_read_b64_tr_b16 a[220:221], v5 offset:33024
    ds_read_b64_tr_b16 a[222:223], v5 offset:33536
    s_waitcnt vmcnt(15)
    ds_read_b64_tr_b16 a[224:225], v2 offset:0
    ds_read_b64_tr_b16 a[226:227], v2 offset:512
    ds_read_b64_tr_b16 a[228:229], v3 offset:0
    ds_read_b64_tr_b16 a[230:231], v3 offset:512
    ds_read_b64_tr_b16 a[232:233], v2 offset:256
    ds_read_b64_tr_b16 a[234:235], v2 offset:768
    ds_read_b64_tr_b16 a[236:237], v3 offset:256
    ds_read_b64_tr_b16 a[238:239], v3 offset:768
    s_waitcnt vmcnt(11)
    ds_read_b64_tr_b16 a[240:241], v2 offset:16384
    ds_read_b64_tr_b16 a[242:243], v2 offset:16896
    ds_read_b64_tr_b16 a[244:245], v3 offset:16384
    ds_read_b64_tr_b16 a[246:247], v3 offset:16896
    ds_read_b64_tr_b16 a[248:249], v2 offset:16640
    ds_read_b64_tr_b16 a[250:251], v2 offset:17152
    ds_read_b64_tr_b16 a[252:253], v3 offset:16640
    ds_read_b64_tr_b16 a[254:255], v3 offset:17152
    s_waitcnt lgkmcnt(0)
    s_branch L_p2_join
L_p3_alt:
    s_add_u32 s66, s69, 175872
    s_add_u32 s58, s66, s76
    buffer_load_dwordx4 v[152:155], v23, s[24:27], s58 offen offset:0 sc1
    buffer_load_dwordx4 v[156:159], v23, s[24:27], s58 offen offset:1024 sc1
    s_add_u32 s58, s66, s77
    buffer_load_dwordx4 v[112:115], v23, s[24:27], s58 offen offset:0 sc1
    buffer_load_dwordx4 v[116:119], v23, s[24:27], s58 offen offset:1024 sc1
    s_add_u32 s58, s66, s78
    buffer_load_dwordx4 v[120:123], v23, s[24:27], s58 offen offset:0 sc1
    buffer_load_dwordx4 v[124:127], v23, s[24:27], s58 offen offset:1024 sc1
    s_add_u32 s58, s66, s79
    buffer_load_dwordx4 v[128:131], v23, s[24:27], s58 offen offset:0 sc1
    buffer_load_dwordx4 v[132:135], v23, s[24:27], s58 offen offset:1024 sc1
    s_add_u32 s58, s66, s80
    buffer_load_dwordx4 v[136:139], v23, s[24:27], s58 offen offset:0 sc1
    buffer_load_dwordx4 v[140:143], v23, s[24:27], s58 offen offset:1024 sc1
    s_add_u32 s58, s66, s81
    buffer_load_dwordx4 v[144:147], v23, s[24:27], s58 offen offset:0 sc1
    s_waitcnt vmcnt(11) lgkmcnt(0)
    s_branch L_p3_join
L_help:
    s_sub_u32 s55, s46, 21
    v_lshlrev_b32 v217, 7, v1
    v_lshrrev_b32 v218, 2, v1
    v_lshlrev_b32 v218, 12, v218
    v_lshl_add_u32 v218, v210, 7, v218
    v_mul_u32_u24 v220, 3584, v1
    s_lshl4_add_u32 s54, s44, s65
    s_mul_i32 s54, s54, 114688
    s_lshl_b32 s56, s50, 7
    s_add_u32 s54, s54, s56
    buffer_load_dword v108, v220, s[16:19], s54 offen
    v_mul_u32_u24 v109, 1088, v25
    v_lshl_add_u32 v109, v26, 4, v109
    v_mul_u32_u24 v110, 1088, v209
    v_lshl_add_u32 v110, v208, 5, v110
    v_lshl_add_u32 v110, v210, 3, v110
    s_lshl_b32 s53, s44, 7
    v_add_u32 v110, s53, v110
    v_mul_u32_u24 v111, 66816, v208
    v_lshl_add_u32 v111, v211, 4, v111
    s_mul_i32 s63, s44, 267264
    s_lshl_b32 s53, s2, 8
    s_add_u32 s63, s63, s53
    s_add_u32 s64, s63, 1069056
    v_cmp_gt_u32 vcc, 208, v0
    v_mov_b32 v100, 2130706432
    v_cmp_le_u32 s[92:93], 24, v26
    v_cndmask_b32 v22, v100, v111, vcc
    s_mov_b32 s62, 0x3f803f80
    s_mov_b32 s61, 0xffff0000
    v_mov_b32 v96, 0
    v_mov_b32 v97, 0
    s_waitcnt vmcnt(3)
    v_dot2c_f32_bf16 v96, s62, v32
    v_dot2c_f32_bf16 v97, v32, v32
    v_lshlrev_b32 v40, 16, v32
    v_and_b32 v41, s61, v32
    v_dot2c_f32_bf16 v96, s62, v33
    v_dot2c_f32_bf16 v97, v33, v33
    v_lshlrev_b32 v42, 16, v33
    v_and_b32 v43, s61, v33
    v_dot2c_f32_bf16 v96, s62, v34
    v_dot2c_f32_bf16 v97, v34, v34
    v_lshlrev_b32 v44, 16, v34
    v_and_b32 v45, s61, v34
    v_dot2c_f32_bf16 v96, s62, v35
    v_dot2c_f32_bf16 v97, v35, v35
    v_lshlrev_b32 v46, 16, v35
    v_and_b32 v47, s61, v35
    s_waitcnt vmcnt(2)
    v_dot2c_f32_bf16 v96, s62, v36
    v_dot2c_f32_bf16 v97, v36, v36
    v_lshlrev_b32 v48, 16, v36
    v_and_b32 v49, s61, v36
    v_dot2c_f32_bf16 v96, s62, v37
    v_dot2c_f32_bf16 v97, v37, v37
    v_lshlrev_b32 v50, 16, v37
    v_and_b32 v51, s61, v37
    v_dot2c_f32_bf16 v96, s62, v38
    v_dot2c_f32_bf16 v97, v38, v38
    v_lshlrev_b32 v52, 16, v38
    v_and_b32 v53, s61, v38
    v_dot2c_f32_bf16 v96, s62, v39
    v_dot2c_f32_bf16 v97, v39, v39
    v_lshlrev_b32 v54, 16, v39
    v_and_b32 v55, s61, v39
    buffer_load_dword v29, off, s[40:43], 0 sc1
    v_add_f32_dpp v96, v96, v96 quad_perm:[1,0,3,2] row_mask:0xf bank_mask:0xf
    v_add_f32_dpp v97, v97, v97 quad_perm:[1,0,3,2] row_mask:0xf bank_mask:0xf
    s_nop 0
    v_add_f32_dpp v96, v96, v96 quad_perm:[2,3,0,1] row_mask:0xf bank_mask:0xf
    v_add_f32_dpp v97, v97, v97 quad_perm:[2,3,0,1] row_mask:0xf bank_mask:0xf
    s_nop 0
    v_add_f32_dpp v96, v96, v96 row_half_mirror row_mask:0xf bank_mask:0xf
    v_add_f32_dpp v97, v97, v97 row_half_mirror row_mask:0xf bank_mask:0xf
    s_nop 0
    v_add_f32_dpp v96, v96, v96 row_mirror row_mask:0xf bank_mask:0xf
    v_add_f32_dpp v97, v97, v97 row_mirror row_mask:0xf bank_mask:0xf
    v_mov_b32 v98, v96
    v_mov_b32 v99, v97
    s_nop 0
    v_permlane16_swap_b32 v96, v98
    v_permlane16_swap_b32 v97, v99
    v_add_f32 v96, v96, v98
    v_add_f32 v97, v97, v99
    v_mul_f32 v98, 0x3b124925, v96
    v_mul_f32 v99, 0x3b124925, v97
    v_fma_f32 v99, -v98, v98, v99
    v_max_f32 v99, 0, v99
    v_cvt_pk_bf16_f32 v100, 0, v99
    v_add_f32 v100, 0x3727c5ac, v100
    v_cvt_pk_bf16_f32 v100, 0, v100
    v_sqrt_f32 v100, v100
    s_nop 0
    v_cvt_pk_bf16_f32 v100, 0, v100
    v_rcp_f32 v100, v100
    s_nop 0
    v_mul_f32 v99, v99, v100
    v_mul_f32 v99, v99, v100
    v_cvt_pk_bf16_f32 v104, 0, v99
    v_add_f32 v104, 0x3727c5ac, v104
    v_cvt_pk_bf16_f32 v104, 0, v104
    v_sqrt_f32 v104, v104
    s_nop 0
    v_cvt_pk_bf16_f32 v102, 0, v104
    v_rcp_f32 v104, v102
    s_nop 0
    v_mul_f32 v104, v104, v100
    v_mul_f32 v106, v98, v104
    v_pk_fma_f32 v[56:57], v[40:41], v[104:105], v[106:107] op_sel_hi:[1,0,0] neg_lo:[0,0,1] neg_hi:[0,0,1]
    v_pk_fma_f32 v[58:59], v[42:43], v[104:105], v[106:107] op_sel_hi:[1,0,0] neg_lo:[0,0,1] neg_hi:[0,0,1]
    v_pk_fma_f32 v[60:61], v[44:45], v[104:105], v[106:107] op_sel_hi:[1,0,0] neg_lo:[0,0,1] neg_hi:[0,0,1]
    v_pk_fma_f32 v[62:63], v[46:47], v[104:105], v[106:107] op_sel_hi:[1,0,0] neg_lo:[0,0,1] neg_hi:[0,0,1]
    v_pk_fma_f32 v[64:65], v[48:49], v[104:105], v[106:107] op_sel_hi:[1,0,0] neg_lo:[0,0,1] neg_hi:[0,0,1]
    v_pk_fma_f32 v[66:67], v[50:51], v[104:105], v[106:107] op_sel_hi:[1,0,0] neg_lo:[0,0,1] neg_hi:[0,0,1]
    v_pk_fma_f32 v[68:69], v[52:53], v[104:105], v[106:107] op_sel_hi:[1,0,0] neg_lo:[0,0,1] neg_hi:[0,0,1]
    v_pk_fma_f32 v[70:71], v[54:55], v[104:105], v[106:107] op_sel_hi:[1,0,0] neg_lo:[0,0,1] neg_hi:[0,0,1]
    v_cvt_pk_bf16_f32 v80, v56, v57
    v_cvt_pk_bf16_f32 v81, v58, v59
    v_cvt_pk_bf16_f32 v82, v60, v61
    v_cvt_pk_bf16_f32 v83, v62, v63
    v_cvt_pk_bf16_f32 v84, v64, v65
    v_cvt_pk_bf16_f32 v85, v66, v67
    v_cvt_pk_bf16_f32 v86, v68, v69
    v_cvt_pk_bf16_f32 v87, v70, v71
    v_lshrrev_b32 v102, 16, v102
    v_cndmask_b32 v84, v84, v102, s[92:93]
    ds_write_b128 v109, v[80:83] offset:0
    ds_write_b128 v109, v[84:87] offset:512
    s_waitcnt lgkmcnt(0)
    s_barrier
    ds_read_b64_tr_b16 v[88:89], v110 offset:0
    ds_read_b64_tr_b16 v[90:91], v110 offset:4352
    ds_read_b64_tr_b16 v[92:93], v110 offset:512
    ds_read_b64_tr_b16 v[94:95], v110 offset:4864
    s_waitcnt lgkmcnt(2)
    buffer_store_dwordx4 v[88:91], v111, s[24:27], s63 offen sc1
    s_waitcnt lgkmcnt(0)
    buffer_store_dwordx4 v[92:95], v22, s[24:27], s64 offen sc1
    v_min_u32 v220, 111104, v220
    s_add_u32 s54, s54, 229376
    buffer_load_dword v108, v220, s[16:19], s54 offen
    s_waitcnt vmcnt(1)
    v_cmp_eq_u32 vcc, 0, v29
    s_nop 0
    s_cbranch_vccz L_ok12
    s_mov_b32 s59, 100000
L_spin11:
    buffer_load_dword v29, off, s[40:43], 0 sc1
    s_waitcnt vmcnt(0)
    v_cmp_eq_u32 vcc, 0, v29
    s_nop 0
    s_cbranch_vccz L_ok12
    s_sub_u32 s59, s59, 1
    s_cbranch_scc0 L_spin11
L_ok12:
    v_readfirstlane_b32 s47, v29
    s_barrier
    s_cmp_lg_u32 s44, 0
    s_cbranch_scc1 L_nopub13
    s_lshl_b32 s60, s2, 5
    s_add_u32 s60, s60, 12582912
    v_mov_b32 v30, s47
    s_mov_b64 exec, 1
    buffer_store_dword v30, off, s[24:27], s60 sc1
    s_mov_b64 exec, -1
L_nopub13:
    s_lshl_b32 s3, s45, 9
    v_min_u32 v223, 384, v217
    buffer_load_dword v108, v223, s[36:39], s3 offen
    s_and_b32 s56, s45, 6
    s_lshr_b32 s56, 0xc9, s56
    s_and_b32 s56, s56, 3
    s_add_u32 s54, s56, 1
    s_bfe_u32 s54, s54, 0x10001
    s_add_u32 s54, s54, 1
    v_min_u32 v221, s54, v210
    v_lshrrev_b32 v222, 2, v0
    v_min_u32 v222, 49, v222
    v_mul_u32_u24 v222, 21, v222
    v_add_lshl_u32 v221, v221, v222, 7
    s_mul_i32 s56, s56, 224
    s_andn2_b32 s56, s56, 127
    s_mul_i32 s54, s55, 134400
    s_add_u32 s54, s54, s56
    buffer_load_dword v108, v221, s[8:11], s54 offen offset:1792
    s_add_u32 s54, s54, 403200
    buffer_load_dword v108, v221, s[8:11], s54 offen offset:1792
    s_add_u32 s54, s54, 403200
    buffer_load_dword v108, v221, s[8:11], s54 offen offset:1792
    s_add_u32 s54, s54, 403200
    s_and_b32 s56, s45, 6
    s_lshr_b32 s56, 0xc9, s56
    s_and_b32 s56, s56, 3
    s_add_u32 s54, s56, 1
    s_bfe_u32 s54, s54, 0x10001
    s_add_u32 s54, s54, 1
    v_min_u32 v221, s54, v210
    v_lshrrev_b32 v222, 2, v0
    v_min_u32 v222, 49, v222
    v_mul_u32_u24 v222, 21, v222
    v_add_lshl_u32 v221, v221, v222, 7
    s_mul_i32 s56, s56, 224
    s_andn2_b32 s56, s56, 127
    s_mul_i32 s54, s55, 134400
    s_add_u32 s54, s54, s56
    buffer_load_dword v108, v221, s[8:11], s54 offen offset:0
    s_add_u32 s54, s54, 403200
    buffer_load_dword v108, v221, s[8:11], s54 offen offset:0
    s_add_u32 s54, s54, 403200
    buffer_load_dword v108, v221, s[8:11], s54 offen offset:0
    s_add_u32 s54, s54, 403200
    s_mul_i32 s54, s44, 28
    s_add_u32 s54, s54, s55
    s_add_u32 s54, s54, 0
    s_lshl_b32 s54, s54, 16
    s_lshl_b32 s56, s45, 9
    s_add_u32 s54, s54, s56
    buffer_load_dword v108, v218, s[20:23], s54 offen
    s_add_u32 s54, s54, 196608
    buffer_load_dword v108, v218, s[20:23], s54 offen
    s_add_u32 s54, s54, 196608
    buffer_load_dword v108, v218, s[20:23], s54 offen
    s_add_u32 s54, s54, 196608
    buffer_load_dword v108, v218, s[20:23], s54 offen
    s_add_u32 s54, s54, 196608
    s_waitcnt vmcnt(0) lgkmcnt(0)
    v_lshlrev_b32 v216, 6, v209
    v_lshl_add_u32 v216, v210, 3, v216
    v_lshl_add_u32 v216, v215, 5, v216
    s_add_u32 s53, s52, 49152
    v_lshl_add_u32 v2, v208, 10, v216
    v_add_u32 v2, s53, v2
    v_xor_b32 v3, 32, v2
    v_add_u32 v4, 65536, v2
    v_add_u32 v5, 65536, v3
    v_lshl_add_u32 v6, v208, 9, v216
    v_add_u32 v6, s53, v6
    v_xor_b32 v7, 32, v6
    v_add_u32 v8, 65536, v6
    v_add_u32 v9, 65536, v7
    s_lshr_b32 s53, s46, 2
    s_and_b32 s89, s46, 3
    s_bfe_u32 s54, s46, 0x20001
    s_and_b32 s55, s46, 1
    s_add_u32 s55, s55, 4
    s_cmp_lt_u32 s46, 16
    s_cselect_b32 s53, s53, s54
    s_cselect_b32 s89, s89, s55
    s_mul_i32 s49, s53, 2
    s_add_u32 s49, s49, s89
    s_sub_u32 s54, s49, 6
    s_min_u32 s49, s49, s54
    s_or_b32 s89, s89, 0
    s_lshl2_add_u32 s48, s45, s53
    s_mul_i32 s53, s44, 1835008
    s_lshl_b32 s74, s48, 7
    s_add_u32 s53, s53, s74
    s_lshl_b32 s56, s44, 5
    v_lshlrev_b32 v217, 5, v212
    v_xor_b32 v217, v217, v214
    v_xor_b32 v217, s56, v217
    s_add_u32 s74, s74, s56
    v_lshlrev_b32 v12, 12, v213
    v_add3_u32 v12, v12, v217, s53
    s_mul_i32 s53, s44, 28672
    s_lshl_b32 s54, s49, 7
    s_add_u32 s55, s53, s54
    v_mul_u32_u24 v13, 896, v213
    v_add3_u32 v13, v13, v214, s55
    v_xor_b32 v14, 32, v13
    s_mul_i32 s55, s44, 21504
    v_subrev_u32 v239, s55, v13
    s_and_b32 s55, s56, 32
    v_xor_b32 v239, s55, v239
    s_mul_i32 s73, s48, 57344
    s_add_u32 s71, s73, s54
    s_mul_i32 s55, s44, 14336
    s_add_u32 s71, s71, s55
    s_add_u32 s72, s71, 7168
    v_bfe_u32 v217, v1, 1, 2
    v_lshl_add_u32 v217, v212, 2, v217
    v_and_b32 v218, 24, v1
    v_add_u32 v217, v217, v218
    v_mul_u32_u24 v15, 896, v217
    v_and_b32 v217, 1, v1
    v_lshl_add_u32 v15, v217, 4, v15
    v_add_u32 v15, s53, v15
    s_lshl_b32 s54, s89, 5
    s_add_u32 s54, s54, 768
    s_add_u32 s68, s89, 24
    s_mul_i32 s68, s68, 58624
    s_mul_i32 s69, s44, 14336
    s_add_u32 s69, s69, 2097152
    s_add_u32 s68, s68, s69
    s_mul_i32 s55, s49, 234496
    s_add_u32 s69, s69, s55
    s_add_u32 s73, s73, s54
    s_mov_b32 s76, 0
    s_add_u32 s77, s76, 2048
    s_cmp_eq_u32 s77, 14336
    s_cselect_b32 s77, 0, s77
    s_add_u32 s78, s77, 2048
    s_cmp_eq_u32 s78, 14336
    s_cselect_b32 s78, 0, s78
    s_add_u32 s79, s78, 2048
    s_cmp_eq_u32 s79, 14336
    s_cselect_b32 s79, 0, s79
    s_add_u32 s80, s79, 2048
    s_cmp_eq_u32 s80, 14336
    s_cselect_b32 s80, 0, s80
    s_add_u32 s81, s80, 2048
    s_cmp_eq_u32 s81, 14336
    s_cselect_b32 s81, 0, s81
    s_add_u32 s82, s81, 2048
    s_cmp_eq_u32 s82, 14336
    s_cselect_b32 s82, 0, s82
    s_cmp_lt_u32 s89, 4
    s_cselect_b32 s75, s54, 2130706432
    s_cselect_b32 s68, s68, 2130706432
    s_cselect_b32 s73, s73, 2130706432
    v_lshlrev_b32 v16, 3, v1
    v_add_u32 v16, 81920, v16
    v_and_b32 v217, 7, v1
    v_min_u32 v218, 6, v217
    s_mul_i32 s54, s44, 7
    v_add_u32 v218, s54, v218
    v_mul_u32_u24 v219, 2, v218
    v_add_u32 v219, s89, v219
    v_mul_u32_u24 v220, 43, v219
    v_lshrrev_b32 v220, 8, v220
    v_mul_u32_u24 v220, 6, v220
    v_sub_u32 v219, v219, v220
    v_subrev_u32 v219, s49, v219
    v_bfe_u32 v220, v1, 3, 1
    v_mul_i32_i24 v219, v219, v220
    v_add_u32 v219, s49, v219
    v_lshl_add_u32 v218, v219, 5, v218
    v_lshlrev_b32 v20, 7, v218
    v_add_u32 v20, 12713984, v20
    s_lshr_b32 s53, s48, 1
    s_lshl_b32 s53, s53, 7
    s_add_u32 s53, s53, 12779520
    v_lshl_add_u32 v21, v210, 11, s53
    s_lshl_b32 s70, s48, 16
    s_lshl2_add_u32 s70, s52, s70
    s_add_u32 s70, s70, 4194304
    v_lshrrev_b32 v218, 3, v1
    v_mul_u32_u24 v22, 896, v218
    v_lshl_add_u32 v22, v217, 4, v22
    v_lshlrev_b32 v25, 1, v211
    s_add_u32 s53, s52, 65536
    v_mul_u32_u24 v244, 176, v218
    v_lshl_add_u32 v244, v217, 4, v244
    v_add_u32 v244, s53, v244
    v_mul_u32_u24 v238, 176, v211
    v_lshl_add_u32 v238, v208, 3, v238
    v_add_u32 v238, s53, v238
    v_lshrrev_b32 v218, 2, v0
    v_mul_u32_u24 v26, 896, v218
    v_lshl_add_u32 v26, v210, 3, v26
    v_lshrrev_b32 v218, 2, v1
    v_mul_u32_u24 v252, 176, v218
    v_lshl_add_u32 v252, v210, 3, v252
    v_add_u32 v252, s53, v252
    s_sub_u32 s53, 49152, s52
    v_add_u32 v246, s53, v2
    v_add_u32 v247, s53, v3
    v_mul_u32_u24 v218, 3072, v208
    v_add_u32 v248, v218, v246
    v_add_u32 v249, v218, v247
    v_add_u32 v232, s52, v23
    v_xor_b32 v233, 4096, v232
    v_xor_b32 v234, 8192, v232
    v_xor_b32 v235, 12288, v232
    buffer_load_dwordx4 v[216:219], v22, s[4:7], s71 offen
    buffer_load_dwordx4 v[220:223], v22, s[4:7], s72 offen
    buffer_load_dwordx2 v[224:225], v26, s[4:7], s73 offen
    buffer_load_ushort v228, v25, s[36:39], s74 offen
    s_waitcnt vmcnt(0)
    ds_write_b128 v244, v[216:219]
    ds_write_b128 v244, v[220:223] offset:1408
    ds_write_b64 v252, v[224:225] offset:128
    ds_read_b64 v[216:217], v238 offset:0
    ds_read_b64 v[218:219], v238 offset:32
    ds_read_b64 v[220:221], v238 offset:64
    ds_read_b64 v[222:223], v238 offset:96
    ds_read_b64 v[224:225], v238 offset:128
    s_add_u32 m0, s52, 81920
    s_lshl_b32 s57, s76, 7
    buffer_load_dwordx4 v12, s[20:23], s57 offen offset:0 lds
    s_add_u32 s57, s57, 31744
    buffer_load_dwordx4 v12, s[20:23], s57 offen offset:1024 lds
    s_add_u32 s57, s57, 31744
    buffer_load_dwordx4 v12, s[20:23], s57 offen offset:2048 lds
    s_add_u32 s57, s57, 31744
    buffer_load_dwordx4 v12, s[20:23], s57 offen offset:3072 lds
    s_add_u32 m0, s52, 98304
    s_lshl_b32 s57, s76, 7
    s_add_u32 s57, s57, 131072
    buffer_load_dwordx4 v12, s[20:23], s57 offen offset:0 lds
    s_add_u32 s57, s57, 31744
    buffer_load_dwordx4 v12, s[20:23], s57 offen offset:1024 lds
    s_add_u32 s57, s57, 31744
    buffer_load_dwordx4 v12, s[20:23], s57 offen offset:2048 lds
    s_add_u32 s57, s57, 31744
    buffer_load_dwordx4 v12, s[20:23], s57 offen offset:3072 lds
    s_add_u32 m0, s52, 114688
    s_lshl_b32 s57, s77, 7
    buffer_load_dwordx4 v12, s[20:23], s57 offen offset:0 lds
    s_add_u32 s57, s57, 31744
    buffer_load_dwordx4 v12, s[20:23], s57 offen offset:1024 lds
    s_add_u32 s57, s57, 31744
    buffer_load_dwordx4 v12, s[20:23], s57 offen offset:2048 lds
    s_add_u32 s57, s57, 31744
    buffer_load_dwordx4 v12, s[20:23], s57 offen offset:3072 lds
    s_add_u32 m0, s52, 131072
    s_lshl_b32 s57, s77, 7
    s_add_u32 s57, s57, 131072
    buffer_load_dwordx4 v12, s[20:23], s57 offen offset:0 lds
    s_add_u32 s57, s57, 31744
    buffer_load_dwordx4 v12, s[20:23], s57 offen offset:1024 lds
    s_waitcnt vmcnt(10)
    ds_read_b64_tr_b16 a[0:1], v6 offset:32768
    ds_read_b64_tr_b16 a[2:3], v6 offset:34816
    ds_read_b64_tr_b16 a[4:5], v7 offset:32768
    ds_read_b64_tr_b16 a[6:7], v7 offset:34816
    ds_read_b64_tr_b16 a[8:9], v6 offset:33024
    ds_read_b64_tr_b16 a[10:11], v6 offset:35072
    ds_read_b64_tr_b16 a[12:13], v7 offset:33024
    ds_read_b64_tr_b16 a[14:15], v7 offset:35072
    s_add_u32 s57, s57, 31744
    buffer_load_dwordx4 v12, s[20:23], s57 offen offset:2048 lds
    s_add_u32 s57, s57, 31744
    buffer_load_dwordx4 v12, s[20:23], s57 offen offset:3072 lds
    s_add_u32 m0, s52, 147456
    s_lshl_b32 s57, s78, 7
    buffer_load_dwordx4 v12, s[20:23], s57 offen offset:0 lds
    s_add_u32 s57, s57, 31744
    buffer_load_dwordx4 v12, s[20:23], s57 offen offset:1024 lds
    s_waitcnt vmcnt(10)
    ds_read_b64_tr_b16 a[16:17], v6 offset:49152
    ds_read_b64_tr_b16 a[18:19], v6 offset:51200
    ds_read_b64_tr_b16 a[20:21], v7 offset:49152
    ds_read_b64_tr_b16 a[22:23], v7 offset:51200
    ds_read_b64_tr_b16 a[24:25], v6 offset:49408
    ds_read_b64_tr_b16 a[26:27], v6 offset:51456
    ds_read_b64_tr_b16 a[28:29], v7 offset:49408
    ds_read_b64_tr_b16 a[30:31], v7 offset:51456
    s_add_u32 s57, s57, 31744
    buffer_load_dwordx4 v12, s[20:23], s57 offen offset:2048 lds
    s_add_u32 s57, s57, 31744
    buffer_load_dwordx4 v12, s[20:23], s57 offen offset:3072 lds
    s_add_u32 m0, s52, 49152
    s_lshl_b32 s57, s78, 7
    s_add_u32 s57, s57, 131072
    buffer_load_dwordx4 v12, s[20:23], s57 offen offset:0 lds
    s_add_u32 s57, s57, 31744
    buffer_load_dwordx4 v12, s[20:23], s57 offen offset:1024 lds
    s_waitcnt vmcnt(10)
    ds_read_b64_tr_b16 a[32:33], v8 offset:0
    ds_read_b64_tr_b16 a[34:35], v8 offset:2048
    ds_read_b64_tr_b16 a[36:37], v9 offset:0
    ds_read_b64_tr_b16 a[38:39], v9 offset:2048
    ds_read_b64_tr_b16 a[40:41], v8 offset:256
    ds_read_b64_tr_b16 a[42:43], v8 offset:2304
    ds_read_b64_tr_b16 a[44:45], v9 offset:256
    ds_read_b64_tr_b16 a[46:47], v9 offset:2304
    s_add_u32 s57, s57, 31744
    buffer_load_dwordx4 v12, s[20:23], s57 offen offset:2048 lds
    s_add_u32 s57, s57, 31744
    buffer_load_dwordx4 v12, s[20:23], s57 offen offset:3072 lds
    s_waitcnt lgkmcnt(15)
    s_add_u32 m0, s52, 65536
    s_lshl_b32 s57, s79, 7
    buffer_load_dwordx4 v12, s[20:23], s57 offen offset:0 lds
    s_add_u32 s57, s57, 31744
    buffer_load_dwordx4 v12, s[20:23], s57 offen offset:1024 lds
    s_waitcnt vmcnt(10)
    ds_read_b64_tr_b16 a[48:49], v8 offset:16384
    ds_read_b64_tr_b16 a[50:51], v8 offset:18432
    ds_read_b64_tr_b16 a[52:53], v9 offset:16384
    ds_read_b64_tr_b16 a[54:55], v9 offset:18432
    s_add_u32 s57, s57, 31744
    buffer_load_dwordx4 v12, s[20:23], s57 offen offset:2048 lds
    ds_read_b64_tr_b16 a[56:57], v8 offset:16640
    ds_read_b64_tr_b16 a[58:59], v8 offset:18688
    ds_read_b64_tr_b16 a[60:61], v9 offset:16640
    ds_read_b64_tr_b16 a[62:63], v9 offset:18688
    s_add_u32 s57, s57, 31744
    buffer_load_dwordx4 v12, s[20:23], s57 offen offset:3072 lds
    s_add_u32 m0, s52, 81920
    s_lshl_b32 s57, s79, 7
    s_add_u32 s57, s57, 131072
    buffer_load_dwordx4 v12, s[20:23], s57 offen offset:0 lds
    s_add_u32 s57, s57, 31744
    buffer_load_dwordx4 v12, s[20:23], s57 offen offset:1024 lds
    s_waitcnt vmcnt(10)
    ds_read_b64_tr_b16 a[64:65], v8 offset:32768
    ds_read_b64_tr_b16 a[66:67], v8 offset:34816
    ds_read_b64_tr_b16 a[68:69], v9 offset:32768
    ds_read_b64_tr_b16 a[70:71], v9 offset:34816
    s_add_u32 s57, s57, 31744
    buffer_load_dwordx4 v12, s[20:23], s57 offen offset:2048 lds
    ds_read_b64_tr_b16 a[72:73], v8 offset:33024
    ds_read_b64_tr_b16 a[74:75], v8 offset:35072
    ds_read_b64_tr_b16 a[76:77], v9 offset:33024
    ds_read_b64_tr_b16 a[78:79], v9 offset:35072
    s_add_u32 s57, s57, 31744
    buffer_load_dwordx4 v12, s[20:23], s57 offen offset:3072 lds
    s_waitcnt lgkmcnt(15)
    s_add_u32 m0, s52, 98304
    s_lshl_b32 s57, s80, 7
    buffer_load_dwordx4 v12, s[20:23], s57 offen offset:0 lds
    s_add_u32 s57, s57, 31744
    buffer_load_dwordx4 v12, s[20:23], s57 offen offset:1024 lds
    s_waitcnt vmcnt(10)
    ds_read_b64_tr_b16 a[80:81], v6 offset:0
    ds_read_b64_tr_b16 a[82:83], v6 offset:2048
    ds_read_b64_tr_b16 a[84:85], v7 offset:0
    ds_read_b64_tr_b16 a[86:87], v7 offset:2048
    s_add_u32 s57, s57, 31744
    buffer_load_dwordx4 v12, s[20:23], s57 offen offset:2048 lds
    ds_read_b64_tr_b16 a[88:89], v6 offset:256
    ds_read_b64_tr_b16 a[90:91], v6 offset:2304
    ds_read_b64_tr_b16 a[92:93], v7 offset:256
    ds_read_b64_tr_b16 a[94:95], v7 offset:2304
    s_waitcnt vmcnt(0) lgkmcnt(0)
    s_branch L_p3join
L_role_a:
    v_lshrrev_b32 v112, 4, v1
    v_bfe_u32 v113, v1, 2, 2
    v_and_b32 v114, 3, v1
    v_and_b32 v115, 15, v1
    v_lshrrev_b32 v116, 5, v1
    s_and_b32 s48, s45, 6
    s_lshr_b32 s48, 0xc9, s48
    s_and_b32 s48, s48, 3
    s_and_b32 s53, s45, 1
    s_lshl3_add_u32 s49, s53, s46
    s_sub_u32 s49, s49, 24
    s_lshl_b32 s90, s44, 11
    s_and_b32 s53, s44, 1
    s_lshl_b32 s53, s53, 1
    v_lshlrev_b32 v117, 2, v112
    v_sub_u32 v117, v115, v117
    v_and_b32 v117, 15, v117
    v_xor_b32 v117, s53, v117
    v_mul_u32_u24 v2, 2688, v112
    v_lshl_add_u32 v2, v117, 4, v2
    s_mul_i32 s53, s44, 21504
    s_mul_i32 s54, s48, 224
    s_andn2_b32 s54, s54, 63
    s_add_u32 s53, s53, s54
    v_add_u32 v2, s53, v2
    s_add_u32 m0, s90, 65536
    s_mov_b32 s57, 896
    buffer_load_dwordx4 v2, s[8:11], s57 offen offset:0 lds
    s_mov_b32 s57, 10624
    buffer_load_dwordx4 v2, s[8:11], s57 offen offset:1024 lds
    v_mul_u32_u24 v109, 1088, v25
    v_lshl_add_u32 v109, v26, 4, v109
    v_mul_u32_u24 v110, 1088, v113
    v_lshl_add_u32 v110, v112, 5, v110
    v_lshl_add_u32 v110, v114, 3, v110
    s_lshl_b32 s53, s44, 7
    v_add_u32 v110, s53, v110
    v_mul_u32_u24 v111, 66816, v112
    v_lshl_add_u32 v111, v115, 4, v111
    s_mul_i32 s63, s44, 267264
    s_lshl_b32 s53, s2, 8
    s_add_u32 s63, s63, s53
    s_add_u32 s64, s63, 1069056
    v_cmp_gt_u32 vcc, 208, v0
    v_mov_b32 v100, 2130706432
    v_cmp_le_u32 s[92:93], 24, v26
    v_cndmask_b32 v22, v100, v111, vcc
    s_mov_b32 s62, 0x3f803f80
    s_mov_b32 s61, 0xffff0000
    v_mov_b32 v96, 0
    v_mov_b32 v97, 0
    v_and_b32 v117, 1, v112
    v_lshlrev_b32 v117, 5, v117
    s_mul_i32 s53, s44, 56
    s_and_b32 s54, s48, 1
    s_lshl_b32 s54, s54, 5
    s_add_u32 s53, s53, s54
    v_lshlrev_b32 v118, 11, v112
    v_lshl_add_u32 v118, v113, 8, v118
    v_add_u32 v118, 65536, v118
    v_lshl_add_u32 v119, v114, 3, s53
    v_add_u32 v119, 0, v119
    v_xor_b32 v119, v119, v117
    v_lshl_add_u32 v119, v113, 6, v119
    v_and_b32 v119, 255, v119
    v_add_u32 v6, v118, v119
    v_add_u32 v10, 49152, v6
    v_subrev_u32 v120, 65536, v6
    v_lshl_add_u32 v119, v114, 3, s53
    v_add_u32 v119, 32, v119
    v_xor_b32 v119, v119, v117
    v_lshl_add_u32 v119, v113, 6, v119
    v_and_b32 v119, 255, v119
    v_add_u32 v7, v118, v119
    v_add_u32 v11, 49152, v7
    v_subrev_u32 v121, 65536, v7
    s_and_b32 s54, s44, 1
    s_lshl_b32 s54, s54, 3
    s_sub_u32 s53, s53, s54
    v_lshl_add_u32 v119, v114, 4, s53
    v_add_u32 v119, 0, v119
    v_xor_b32 v119, v119, v117
    v_lshl_add_u32 v119, v113, 6, v119
    v_and_b32 v119, 255, v119
    v_add_u32 v8, v118, v119
    v_add_u32 v12, 49152, v8
    v_subrev_u32 v122, 65536, v8
    v_lshl_add_u32 v119, v114, 4, s53
    v_add_u32 v119, 8, v119
    v_xor_b32 v119, v119, v117
    v_lshl_add_u32 v119, v113, 6, v119
    v_and_b32 v119, 255, v119
    v_add_u32 v9, v118, v119
    v_add_u32 v13, 49152, v9
    v_subrev_u32 v123, 65536, v9
    s_waitcnt vmcnt(4)
    v_dot2c_f32_bf16 v96, s62, v32
    v_dot2c_f32_bf16 v97, v32, v32
    v_lshlrev_b32 v40, 16, v32
    v_and_b32 v41, s61, v32
    v_dot2c_f32_bf16 v96, s62, v33
    v_dot2c_f32_bf16 v97, v33, v33
    v_lshlrev_b32 v42, 16, v33
    v_and_b32 v43, s61, v33
    v_dot2c_f32_bf16 v96, s62, v34
    v_dot2c_f32_bf16 v97, v34, v34
    v_lshlrev_b32 v44, 16, v34
    v_and_b32 v45, s61, v34
    v_dot2c_f32_bf16 v96, s62, v35
    v_dot2c_f32_bf16 v97, v35, v35
    v_lshlrev_b32 v46, 16, v35
    v_and_b32 v47, s61, v35
    s_waitcnt vmcnt(3)
    v_dot2c_f32_bf16 v96, s62, v36
    v_dot2c_f32_bf16 v97, v36, v36
    v_lshlrev_b32 v48, 16, v36
    v_and_b32 v49, s61, v36
    v_dot2c_f32_bf16 v96, s62, v37
    v_dot2c_f32_bf16 v97, v37, v37
    v_lshlrev_b32 v50, 16, v37
    v_and_b32 v51, s61, v37
    v_dot2c_f32_bf16 v96, s62, v38
    v_dot2c_f32_bf16 v97, v38, v38
    v_lshlrev_b32 v52, 16, v38
    v_and_b32 v53, s61, v38
    v_dot2c_f32_bf16 v96, s62, v39
    v_dot2c_f32_bf16 v97, v39, v39
    v_lshlrev_b32 v54, 16, v39
    v_and_b32 v55, s61, v39
    buffer_load_dword v29, off, s[40:43], 0 sc1
    v_add_f32_dpp v96, v96, v96 quad_perm:[1,0,3,2] row_mask:0xf bank_mask:0xf
    v_add_f32_dpp v97, v97, v97 quad_perm:[1,0,3,2] row_mask:0xf bank_mask:0xf
    s_nop 0
    v_add_f32_dpp v96, v96, v96 quad_perm:[2,3,0,1] row_mask:0xf bank_mask:0xf
    v_add_f32_dpp v97, v97, v97 quad_perm:[2,3,0,1] row_mask:0xf bank_mask:0xf
    s_nop 0
    v_add_f32_dpp v96, v96, v96 row_half_mirror row_mask:0xf bank_mask:0xf
    v_add_f32_dpp v97, v97, v97 row_half_mirror row_mask:0xf bank_mask:0xf
    s_nop 0
    v_add_f32_dpp v96, v96, v96 row_mirror row_mask:0xf bank_mask:0xf
    v_add_f32_dpp v97, v97, v97 row_mirror row_mask:0xf bank_mask:0xf
    v_mov_b32 v98, v96
    v_mov_b32 v99, v97
    s_nop 0
    v_permlane16_swap_b32 v96, v98
    v_permlane16_swap_b32 v97, v99
    v_add_f32 v96, v96, v98
    v_add_f32 v97, v97, v99
    v_mul_f32 v98, 0x3b124925, v96
    v_mul_f32 v99, 0x3b124925, v97
    v_fma_f32 v99, -v98, v98, v99
    v_max_f32 v99, 0, v99
    v_cvt_pk_bf16_f32 v100, 0, v99
    v_add_f32 v100, 0x3727c5ac, v100
    v_cvt_pk_bf16_f32 v100, 0, v100
    v_sqrt_f32 v100, v100
    s_nop 0
    v_cvt_pk_bf16_f32 v100, 0, v100
    v_rcp_f32 v100, v100
    s_nop 0
    v_mul_f32 v99, v99, v100
    v_mul_f32 v99, v99, v100
    v_cvt_pk_bf16_f32 v104, 0, v99
    v_add_f32 v104, 0x3727c5ac, v104
    v_cvt_pk_bf16_f32 v104, 0, v104
    v_sqrt_f32 v104, v104
    s_nop 0
    v_cvt_pk_bf16_f32 v102, 0, v104
    v_rcp_f32 v104, v102
    s_nop 0
    v_mul_f32 v104, v104, v100
    v_mul_f32 v106, v98, v104
    v_pk_fma_f32 v[56:57], v[40:41], v[104:105], v[106:107] op_sel_hi:[1,0,0] neg_lo:[0,0,1] neg_hi:[0,0,1]
    v_pk_fma_f32 v[58:59], v[42:43], v[104:105], v[106:107] op_sel_hi:[1,0,0] neg_lo:[0,0,1] neg_hi:[0,0,1]
    v_pk_fma_f32 v[60:61], v[44:45], v[104:105], v[106:107] op_sel_hi:[1,0,0] neg_lo:[0,0,1] neg_hi:[0,0,1]
    v_pk_fma_f32 v[62:63], v[46:47], v[104:105], v[106:107] op_sel_hi:[1,0,0] neg_lo:[0,0,1] neg_hi:[0,0,1]
    v_pk_fma_f32 v[64:65], v[48:49], v[104:105], v[106:107] op_sel_hi:[1,0,0] neg_lo:[0,0,1] neg_hi:[0,0,1]
    v_pk_fma_f32 v[66:67], v[50:51], v[104:105], v[106:107] op_sel_hi:[1,0,0] neg_lo:[0,0,1] neg_hi:[0,0,1]
    v_pk_fma_f32 v[68:69], v[52:53], v[104:105], v[106:107] op_sel_hi:[1,0,0] neg_lo:[0,0,1] neg_hi:[0,0,1]
    v_pk_fma_f32 v[70:71], v[54:55], v[104:105], v[106:107] op_sel_hi:[1,0,0] neg_lo:[0,0,1] neg_hi:[0,0,1]
    v_cvt_pk_bf16_f32 v80, v56, v57
    v_cvt_pk_bf16_f32 v81, v58, v59
    v_cvt_pk_bf16_f32 v82, v60, v61
    v_cvt_pk_bf16_f32 v83, v62, v63
    v_cvt_pk_bf16_f32 v84, v64, v65
    v_cvt_pk_bf16_f32 v85, v66, v67
    v_cvt_pk_bf16_f32 v86, v68, v69
    v_cvt_pk_bf16_f32 v87, v70, v71
    v_lshrrev_b32 v102, 16, v102
    v_cndmask_b32 v84, v84, v102, s[92:93]
    ds_write_b128 v109, v[80:83] offset:49152
    ds_write_b128 v109, v[84:87] offset:49664
    s_waitcnt lgkmcnt(0)
    s_barrier
    ds_read_b64_tr_b16 v[88:89], v110 offset:49152
    ds_read_b64_tr_b16 v[90:91], v110 offset:53504
    ds_read_b64_tr_b16 v[92:93], v110 offset:49664
    ds_read_b64_tr_b16 v[94:95], v110 offset:54016
    s_waitcnt lgkmcnt(2)
    buffer_store_dwordx4 v[88:91], v111, s[24:27], s63 offen sc1
    s_waitcnt lgkmcnt(0)
    buffer_store_dwordx4 v[92:95], v22, s[24:27], s64 offen sc1
    s_add_u32 m0, s90, 73728
    s_mov_b32 s57, 86912
    buffer_load_dwordx4 v2, s[8:11], s57 offen offset:0 lds
    s_movk_i32 s94, 224
    v_mul_u32_u24 v3, 66816, v116
    v_and_b32 v118, 1, v112
    v_lshlrev_b32 v119, 2, v118
    v_xor_b32 v119, v119, v115
    v_lshl_add_u32 v3, v118, 8, v3
    v_lshl_add_u32 v3, v119, 4, v3
    v_cmp_gt_u32 s[92:93], s94, v0
    v_mov_b32 v119, 2130706432
    s_mov_b32 s57, 96640
    buffer_load_dwordx4 v2, s[8:11], s57 offen offset:1024 lds
    v_lshlrev_b32 v4, 9, v116
    v_cndmask_b32 v24, v119, v3, s[92:93]
    v_lshl_add_u32 v4, v118, 7, v4
    v_lshl_add_u32 v4, v113, 4, v4
    v_lshrrev_b32 v118, 1, v114
    v_mul_u32_u24 v118, 320, v118
    v_add_u32 v4, v118, v4
    v_and_b32 v118, 1, v114
    v_lshl_add_u32 v4, v118, 3, v4
    v_xor_b32 v25, 64, v4
    s_lshl_b32 s53, s49, 4
    s_sub_u32 s53, s53, 2
    v_min_u32 v117, 17, v1
    v_add_u32 v117, s53, v117
    v_max_i32 v117, 0, v117
    v_lshlrev_b32 v19, 5, v117
    s_add_u32 m0, s90, 81920
    s_mov_b32 s57, 172928
    buffer_load_dwordx4 v2, s[8:11], s57 offen offset:0 lds
    v_add_u32 v19, 12582912, v19
    v_and_b32 v117, 1, v115
    v_cmp_eq_u32 s[76:77], 1, v117
    v_lshl_add_u32 v117, v112, 2, v117
    v_cmp_le_u32 s[78:79], v117, v115
    v_mul_u32_u24 v118, 304, v116
    v_lshl_add_u32 v93, v117, 1, v118
    v_add_u32 v117, 2, v117
    v_cmp_le_u32 s[80:81], v117, v115
    v_add_u32 v94, 4, v93
    v_mov_b32 v118, 14336
    v_mov_b32 v119, 30720
    v_cndmask_b32 v117, v118, v119, s[78:79]
    v_add_u32 v93, v117, v93
    v_cndmask_b32 v117, v118, v119, s[80:81]
    v_add_u32 v94, v117, v94
    s_mov_b32 s57, 182656
    buffer_load_dwordx4 v2, s[8:11], s57 offen offset:1024 lds
    v_lshrrev_b32 v117, 3, v115
    v_mul_u32_u24 v117, 304, v117
    v_lshl_add_u32 v92, v115, 1, v117
    v_add_u32 v92, v119, v92
    v_cmp_eq_u32 s[82:83], 3, v112
    v_mov_b32 v117, 0xffff
    v_mov_b32 v118, 0xffff0000
    v_cndmask_b32 v117, v117, v118, s[76:77]
    v_cndmask_b32 v14, v117, 0, s[78:79]
    v_cndmask_b32 v15, v117, 0, s[80:81]
    v_cndmask_b32 v16, 0, v117, s[78:79]
    v_cndmask_b32 v17, 0, v117, s[80:81]
    s_mov_b32 s91, 0x3e8b97f6
    v_mov_b32 v18, 0xf149f2ca
    s_lshl_b32 s53, s49, 3
    s_lshl_b32 s72, s53, 9
    s_add_u32 m0, s90, 90112
    s_mov_b32 s57, 258944
    buffer_load_dwordx4 v2, s[8:11], s57 offen offset:0 lds
    s_lshl_b32 s74, s53, 14
    s_lshl2_add_u32 s54, s48, s44
    s_mul_i32 s54, s54, 7
    s_lshr_b32 s54, s54, 1
    s_lshl_b32 s54, s54, 8
    s_add_u32 s74, s74, s54
    s_add_u32 s74, s74, 4194304
    s_mul_i32 s68, s44, 534528
    s_add_u32 s68, s68, 0
    s_mul_i32 s69, s44, 534528
    s_add_u32 s69, s69, 132608
    s_mul_i32 s70, s44, 534528
    s_add_u32 s70, s70, 265216
    s_mul_i32 s71, s44, 534528
    s_add_u32 s71, s71, 397824
    s_cmp_eq_u32 s44, 3
    s_cselect_b32 s71, 2130706432, s71
    s_cmp_eq_u32 s49, 0
    s_cselect_b64 s[84:85], -1, 0
    s_andn2_b64 s[86:87], s[84:85], s[80:81]
    s_andn2_b64 s[84:85], s[84:85], s[78:79]
    s_bitcmp1_b32 s44, 0
    s_cselect_b64 s[88:89], -1, 0
    s_cselect_b32 s53, 0, 3
    s_cselect_b32 s54, 8, 0
    v_cmp_eq_u32 vcc, s53, v112
    s_lshr_b32 s53, s44, 1
    s_lshl_b32 s55, s53, 11
    s_add_u32 s54, s54, s55
    s_add_u32 s54, s54, 147456
    v_lshl_add_u32 v118, v115, 4, s54
    v_add_u32 v117, 151552, v23
    v_cndmask_b32 v95, v117, v118, vcc
    v_mov_b32 v117, 2130706432
    v_cndmask_b32 v23, v23, v117, vcc
    s_lshl1_add_u32 s53, s48, s53
    s_mul_i32 s53, s53, 1792
    s_and_b32 s54, s44, 1
    s_lshl1_add_u32 s54, s49, s54
    s_lshl_b32 s54, s54, 16
    s_add_u32 s53, s53, s54
    s_add_u32 s95, s53, 4195072
    s_and_b32 s53, s46, 7
    s_mul_i32 s54, s44, 28
    s_add_u32 s54, s54, s53
    s_add_u32 s54, s54, 12
    s_lshl_b32 s73, s54, 16
    s_lshl_b32 s54, s45, 9
    s_add_u32 s73, s73, s54
    s_lshl3_add_u32 s75, s44, s53
    s_lshl_b32 s75, s75, 13
    v_lshrrev_b32 v5, 2, v1
    v_lshlrev_b32 v5, 12, v5
    v_lshl_add_u32 v5, v114, 7, v5
    v_lshlrev_b32 v20, 7, v1
    s_mov_b32 s57, 268672
    buffer_load_dwordx4 v2, s[8:11], s57 offen offset:1024 lds
    s_add_u32 m0, s90, 98304
    s_mov_b32 s57, 344960
    buffer_load_dwordx4 v2, s[8:11], s57 offen offset:0 lds
    s_mov_b32 s57, 354688
    buffer_load_dwordx4 v2, s[8:11], s57 offen offset:1024 lds
    s_mov_b32 s59, s44
    s_mov_b64 exec, 0
    s_branch L_wa_go
L_wa_ret:
    s_add_u32 s59, s59, 4
L_wa_go:
    s_cmp_eq_u32 s59, 0
    s_cbranch_scc1 L_wa_0
    s_cmp_eq_u32 s59, 1
    s_cbranch_scc1 L_wa_1
    s_cmp_eq_u32 s59, 2
    s_cbranch_scc1 L_wa_2
    s_cmp_eq_u32 s59, 3
    s_cbranch_scc1 L_wa_3
    s_cmp_eq_u32 s59, 4
    s_cbranch_scc1 L_wa_4
    s_mov_b64 exec, -1
    s_add_u32 m0, s90, 106496
L_wa_0:
    s_cbranch_execz L_wa_ret
    s_mov_b32 s57, 430976
    buffer_load_dwordx4 v2, s[8:11], s57 offen offset:0 lds
    s_mov_b32 s57, 440704
    buffer_load_dwordx4 v2, s[8:11], s57 offen offset:1024 lds
    s_add_u32 m0, s90, 114688
    s_mov_b32 s57, 516992
    buffer_load_dwordx4 v2, s[8:11], s57 offen offset:0 lds
    s_mov_b32 s57, 526720
    buffer_load_dwordx4 v2, s[8:11], s57 offen offset:1024 lds
    s_add_u32 m0, s90, 122880
    s_mov_b32 s57, 603008
    buffer_load_dwordx4 v2, s[8:11], s57 offen offset:0 lds
    s_mov_b32 s57, 612736
    buffer_load_dwordx4 v2, s[8:11], s57 offen offset:1024 lds
    s_add_u32 m0, s90, 131072
    s_mov_b32 s57, 689024
    buffer_load_dwordx4 v2, s[8:11], s57 offen offset:0 lds
    s_mov_b32 s57, 698752
    buffer_load_dwordx4 v2, s[8:11], s57 offen offset:1024 lds
    s_add_u32 m0, s90, 139264
    s_mov_b32 s57, 775040
    buffer_load_dwordx4 v2, s[8:11], s57 offen offset:0 lds
    s_mov_b32 s57, 784768
    buffer_load_dwordx4 v2, s[8:11], s57 offen offset:1024 lds
    s_add_u32 m0, s90, 147456
    s_mov_b32 s57, 861056
    buffer_load_dwordx4 v2, s[8:11], s57 offen offset:0 lds
    s_mov_b32 s57, 870784
    buffer_load_dwordx4 v2, s[8:11], s57 offen offset:1024 lds
    s_waitcnt vmcnt(20)
    v_cmp_eq_u32 vcc, 0, v29
    s_nop 0
    s_cbranch_vccz L_ok15
    s_mov_b32 s59, 100000
L_spin14:
    buffer_load_dword v29, off, s[40:43], 0 sc1
    s_waitcnt vmcnt(0)
    v_cmp_eq_u32 vcc, 0, v29
    s_nop 0
    s_cbranch_vccz L_ok15
    s_sub_u32 s59, s59, 1
    s_cbranch_scc0 L_spin14
L_ok15:
    v_readfirstlane_b32 s47, v29
    s_barrier
    s_cmp_lg_u32 s44, 0
    s_cbranch_scc1 L_nopub16
    s_lshl_b32 s60, s2, 5
    s_add_u32 s60, s60, 12582912
    v_mov_b32 v30, s47
    s_mov_b64 exec, 1
    buffer_store_dword v30, off, s[24:27], s60 sc1
    s_mov_b64 exec, -1
L_nopub16:
    s_waitcnt vmcnt(16)
    s_barrier
    s_add_u32 m0, s90, 155648
    s_mov_b32 s57, 947072
    buffer_load_dwordx4 v2, s[8:11], s57 offen offset:0 lds
    s_mov_b32 s57, 956800
    buffer_load_dwordx4 v2, s[8:11], s57 offen offset:1024 lds
    ds_read_b64_tr_b16 a[8:9], v6 offset:0
    ds_read_b64_tr_b16 a[10:11], v6 offset:1024
    ds_read_b64_tr_b16 a[12:13], v7 offset:0
    ds_read_b64_tr_b16 a[14:15], v7 offset:1024
    s_add_u32 m0, s90, 0
    s_mov_b32 s57, 1033088
    buffer_load_dwordx4 v2, s[8:11], s57 offen offset:0 lds
    s_mov_b32 s57, 1042816
    buffer_load_dwordx4 v2, s[8:11], s57 offen offset:1024 lds
    ds_read_b64_tr_b16 a[32:33], v6 offset:8192
    ds_read_b64_tr_b16 a[34:35], v6 offset:9216
    ds_read_b64_tr_b16 a[36:37], v7 offset:8192
    ds_read_b64_tr_b16 a[38:39], v7 offset:9216
    s_add_u32 m0, s90, 8192
    s_mov_b32 s57, 1119104
    buffer_load_dwordx4 v2, s[8:11], s57 offen offset:0 lds
    s_mov_b32 s57, 1128832
    buffer_load_dwordx4 v2, s[8:11], s57 offen offset:1024 lds
    ds_read_b64_tr_b16 a[56:57], v6 offset:16384
    ds_read_b64_tr_b16 a[58:59], v6 offset:17408
    ds_read_b64_tr_b16 a[60:61], v7 offset:16384
    ds_read_b64_tr_b16 a[62:63], v7 offset:17408
    s_waitcnt vmcnt(16)
    s_waitcnt lgkmcnt(0)
    s_barrier
    s_add_u32 m0, s90, 16384
    s_mov_b32 s57, 1792
    buffer_load_dwordx4 v2, s[8:11], s57 offen offset:0 lds
    s_mov_b32 s57, 11520
    buffer_load_dwordx4 v2, s[8:11], s57 offen offset:1024 lds
    ds_read_b64_tr_b16 a[80:81], v6 offset:24576
    ds_read_b64_tr_b16 a[82:83], v6 offset:25600
    ds_read_b64_tr_b16 a[84:85], v7 offset:24576
    ds_read_b64_tr_b16 a[86:87], v7 offset:25600
    s_add_u32 m0, s90, 24576
    s_mov_b32 s57, 87808
    buffer_load_dwordx4 v2, s[8:11], s57 offen offset:0 lds
    s_mov_b32 s57, 97536
    buffer_load_dwordx4 v2, s[8:11], s57 offen offset:1024 lds
    ds_read_b64_tr_b16 a[104:105], v6 offset:32768
    ds_read_b64_tr_b16 a[106:107], v6 offset:33792
    ds_read_b64_tr_b16 a[108:109], v7 offset:32768
    ds_read_b64_tr_b16 a[110:111], v7 offset:33792
    s_add_u32 m0, s90, 32768
    s_mov_b32 s57, 173824
    buffer_load_dwordx4 v2, s[8:11], s57 offen offset:0 lds
    s_mov_b32 s57, 183552
    buffer_load_dwordx4 v2, s[8:11], s57 offen offset:1024 lds
    ds_read_b64_tr_b16 a[128:129], v6 offset:40960
    ds_read_b64_tr_b16 a[130:131], v6 offset:41984
    ds_read_b64_tr_b16 a[132:133], v7 offset:40960
    ds_read_b64_tr_b16 a[134:135], v7 offset:41984
    s_waitcnt vmcnt(16)
    s_waitcnt lgkmcnt(0)
    s_barrier
    s_add_u32 m0, s90, 40960
    s_mov_b32 s57, 259840
    buffer_load_dwordx4 v2, s[8:11], s57 offen offset:0 lds
    s_mov_b32 s57, 269568
    buffer_load_dwordx4 v2, s[8:11], s57 offen offset:1024 lds
    ds_read_b64_tr_b16 a[152:153], v10 offset:0
    ds_read_b64_tr_b16 a[154:155], v10 offset:1024
    ds_read_b64_tr_b16 a[156:157], v11 offset:0
    ds_read_b64_tr_b16 a[158:159], v11 offset:1024
    s_add_u32 m0, s90, 65536
    s_mov_b32 s57, 345856
    buffer_load_dwordx4 v2, s[8:11], s57 offen offset:0 lds
    s_mov_b32 s57, 355584
    buffer_load_dwordx4 v2, s[8:11], s57 offen offset:1024 lds
    ds_read_b64_tr_b16 a[176:177], v10 offset:8192
    ds_read_b64_tr_b16 a[178:179], v10 offset:9216
    ds_read_b64_tr_b16 a[180:181], v11 offset:8192
    ds_read_b64_tr_b16 a[182:183], v11 offset:9216
    s_add_u32 m0, s90, 73728
    s_mov_b32 s57, 431872
    buffer_load_dwordx4 v2, s[8:11], s57 offen offset:0 lds
    s_mov_b32 s57, 441600
    buffer_load_dwordx4 v2, s[8:11], s57 offen offset:1024 lds
    ds_read_b64_tr_b16 a[200:201], v10 offset:16384
    ds_read_b64_tr_b16 a[202:203], v10 offset:17408
    ds_read_b64_tr_b16 a[204:205], v11 offset:16384
    ds_read_b64_tr_b16 a[206:207], v11 offset:17408
    s_waitcnt vmcnt(16)
    s_waitcnt lgkmcnt(0)
    s_barrier
    ds_read_b64_tr_b16 a[224:225], v10 offset:24576
    ds_read_b64_tr_b16 a[226:227], v10 offset:25600
    ds_read_b64_tr_b16 a[228:229], v11 offset:24576
    ds_read_b64_tr_b16 a[230:231], v11 offset:25600
    ds_read_b64_tr_b16 a[248:249], v10 offset:32768
    ds_read_b64_tr_b16 a[250:251], v10 offset:33792
    ds_read_b64_tr_b16 a[252:253], v11 offset:32768
    ds_read_b64_tr_b16 a[254:255], v11 offset:33792
    s_add_u32 m0, s90, 81920
    s_mov_b32 s57, 517888
    buffer_load_dwordx4 v2, s[8:11], s57 offen offset:0 lds
    ds_read_b64_tr_b16 v[192:193], v10 offset:40960
    ds_read_b64_tr_b16 v[194:195], v10 offset:41984
    ds_read_b64_tr_b16 v[196:197], v11 offset:40960
    ds_read_b64_tr_b16 v[198:199], v11 offset:41984
    s_mov_b32 s57, 527616
    buffer_load_dwordx4 v2, s[8:11], s57 offen offset:1024 lds
    s_waitcnt vmcnt(12)
    s_waitcnt lgkmcnt(0)
    s_barrier
    ds_read_b64_tr_b16 v[216:217], v120 offset:0
    ds_read_b64_tr_b16 v[218:219], v120 offset:1024
    ds_read_b64_tr_b16 v[220:221], v121 offset:0
    ds_read_b64_tr_b16 v[222:223], v121 offset:1024
    ds_read_b64_tr_b16 v[240:241], v120 offset:8192
    ds_read_b64_tr_b16 v[242:243], v120 offset:9216
    ds_read_b64_tr_b16 v[244:245], v121 offset:8192
    ds_read_b64_tr_b16 v[246:247], v121 offset:9216
    ds_read_b64_tr_b16 a[16:17], v122 offset:16384
    ds_read_b64_tr_b16 a[18:19], v122 offset:17408
    ds_read_b64_tr_b16 a[20:21], v123 offset:16384
    ds_read_b64_tr_b16 a[22:23], v123 offset:17408
    buffer_load_dword v21, v19, s[24:27], 0 offen sc1
    s_add_u32 m0, s90, 90112
    s_mov_b32 s57, 603904
    buffer_load_dwordx4 v2, s[8:11], s57 offen offset:0 lds
    s_mov_b32 s57, 613632
    buffer_load_dwordx4 v2, s[8:11], s57 offen offset:1024 lds
    s_add_u32 m0, s90, 98304
    s_mov_b32 s57, 689920
    buffer_load_dwordx4 v2, s[8:11], s57 offen offset:0 lds
    s_mov_b32 s57, 699648
    buffer_load_dwordx4 v2, s[8:11], s57 offen offset:1024 lds
    s_add_u32 m0, s90, 106496
    s_mov_b32 s57, 775936
    buffer_load_dwordx4 v2, s[8:11], s57 offen offset:0 lds
    s_waitcnt vmcnt(12)
    s_waitcnt lgkmcnt(0)
    s_barrier
    ds_read_b64_tr_b16 a[40:41], v122 offset:24576
    ds_read_b64_tr_b16 a[42:43], v122 offset:25600
    ds_read_b64_tr_b16 a[44:45], v123 offset:24576
    ds_read_b64_tr_b16 a[46:47], v123 offset:25600
    ds_read_b64_tr_b16 a[64:65], v122 offset:32768
    ds_read_b64_tr_b16 a[66:67], v122 offset:33792
    ds_read_b64_tr_b16 a[68:69], v123 offset:32768
    ds_read_b64_tr_b16 a[70:71], v123 offset:33792
    ds_read_b64_tr_b16 a[88:89], v122 offset:40960
    ds_read_b64_tr_b16 a[90:91], v122 offset:41984
    ds_read_b64_tr_b16 a[92:93], v123 offset:40960
    ds_read_b64_tr_b16 a[94:95], v123 offset:41984
    s_mov_b32 s57, 785664
    buffer_load_dwordx4 v2, s[8:11], s57 offen offset:1024 lds
    s_waitcnt vmcnt(7)
    s_waitcnt lgkmcnt(0)
    s_barrier
    ds_read_b64_tr_b16 a[112:113], v8 offset:0
    ds_read_b64_tr_b16 a[114:115], v8 offset:1024
    ds_read_b64_tr_b16 a[116:117], v9 offset:0
    ds_read_b64_tr_b16 a[118:119], v9 offset:1024
    ds_read_b64_tr_b16 a[136:137], v8 offset:8192
    ds_read_b64_tr_b16 a[138:139], v8 offset:9216
    ds_read_b64_tr_b16 a[140:141], v9 offset:8192
    ds_read_b64_tr_b16 a[142:143], v9 offset:9216
    ds_read_b64_tr_b16 a[160:161], v8 offset:16384
    ds_read_b64_tr_b16 a[162:163], v8 offset:17408
    ds_read_b64_tr_b16 a[164:165], v9 offset:16384
    ds_read_b64_tr_b16 a[166:167], v9 offset:17408
    s_waitcnt vmcnt(6)
    v_cmp_ne_u32 vcc, s47, v21
    s_nop 0
    s_cbranch_vccz L_ok18
    s_mov_b32 s59, 100000
L_spin17:
    buffer_load_dword v21, v19, s[24:27], 0 offen sc1
    s_waitcnt vmcnt(0)
    v_cmp_ne_u32 vcc, s47, v21
    s_nop 0
    s_cbranch_vccz L_ok18
    s_sub_u32 s59, s59, 1
    s_cbranch_scc0 L_spin17
L_ok18:
    s_add_u32 m0, s52, 0
    s_sub_u32 s58, s72, 512
    s_max_i32 s58, s58, 0
    s_add_u32 s57, s58, s68
    buffer_load_dwordx4 v3, s[24:27], s57 offen offset:0 sc1 lds
    s_add_u32 s57, s58, s69
    buffer_load_dwordx4 v3, s[24:27], s57 offen offset:1024 sc1 lds
    s_add_u32 s57, s58, s70
    buffer_load_dwordx4 v24, s[24:27], s57 offen offset:2048 sc1 lds
    s_add_u32 s57, s58, s71
    buffer_load_dwordx4 v3, s[24:27], s57 offen offset:3072 sc1 lds
    s_add_u32 m0, s52, 16384
    s_add_u32 s58, s72, 0
    s_add_u32 s57, s58, s68
    buffer_load_dwordx4 v3, s[24:27], s57 offen offset:0 sc1 lds
    s_add_u32 s57, s58, s69
    buffer_load_dwordx4 v3, s[24:27], s57 offen offset:1024 sc1 lds
    s_add_u32 s57, s58, s70
    buffer_load_dwordx4 v24, s[24:27], s57 offen offset:2048 sc1 lds
    s_add_u32 s57, s58, s71
    buffer_load_dwordx4 v3, s[24:27], s57 offen offset:3072 sc1 lds
    s_add_u32 m0, s90, 114688
    s_mov_b32 s57, 861952
    buffer_load_dwordx4 v2, s[8:11], s57 offen offset:0 lds
    s_mov_b32 s57, 871680
    buffer_load_dwordx4 v2, s[8:11], s57 offen offset:1024 lds
    s_add_u32 m0, s90, 122880
    s_mov_b32 s57, 947968
    buffer_load_dwordx4 v2, s[8:11], s57 offen offset:0 lds
    s_mov_b32 s57, 957696
    buffer_load_dwordx4 v2, s[8:11], s57 offen offset:1024 lds
    s_add_u32 m0, s90, 131072
    s_mov_b32 s57, 1033984
    buffer_load_dwordx4 v2, s[8:11], s57 offen offset:0 lds
    s_mov_b32 s57, 1043712
    buffer_load_dwordx4 v2, s[8:11], s57 offen offset:1024 lds
    s_add_u32 m0, s52, 32768
    s_add_u32 s58, s72, 512
    s_add_u32 s57, s58, s68
    buffer_load_dwordx4 v3, s[24:27], s57 offen offset:0 sc1 lds
    s_add_u32 s57, s58, s69
    buffer_load_dwordx4 v3, s[24:27], s57 offen offset:1024 sc1 lds
    s_waitcnt vmcnt(12)
    s_waitcnt lgkmcnt(0)
    s_barrier
    ds_read_b64_tr_b16 v[120:121], v4 offset:0
    ds_read_b64_tr_b16 v[122:123], v25 offset:0
    ds_read_b64_tr_b16 v[124:125], v4 offset:1024
    ds_read_b64_tr_b16 v[126:127], v25 offset:1024
    ds_read_b64_tr_b16 v[128:129], v4 offset:2048
    ds_read_b64_tr_b16 v[130:131], v25 offset:2048
    ds_read_b64_tr_b16 v[132:133], v4 offset:3072
    ds_read_b64_tr_b16 v[134:135], v25 offset:3072
    ds_read_b64_tr_b16 v[136:137], v4 offset:4096
    ds_read_b64_tr_b16 v[138:139], v25 offset:4096
    ds_read_b64_tr_b16 v[140:141], v4 offset:5120
    ds_read_b64_tr_b16 v[142:143], v25 offset:5120
    ds_read_b64_tr_b16 v[144:145], v4 offset:6144
    ds_read_b64_tr_b16 v[146:147], v25 offset:6144
    ds_read_b64_tr_b16 v[148:149], v4 offset:7168
    ds_read_b64_tr_b16 v[150:151], v25 offset:7168
    ds_read_b64_tr_b16 v[152:153], v4 offset:8192
    ds_read_b64_tr_b16 v[154:155], v25 offset:8192
    ds_read_b64_tr_b16 v[156:157], v4 offset:9216
    ds_read_b64_tr_b16 v[158:159], v25 offset:9216
    ds_read_b64_tr_b16 v[160:161], v4 offset:10240
    ds_read_b64_tr_b16 v[162:163], v25 offset:10240
    ds_read_b64_tr_b16 v[164:165], v4 offset:11264
    ds_read_b64_tr_b16 v[166:167], v25 offset:11264
    ds_read_b64_tr_b16 v[168:169], v4 offset:12288
    ds_read_b64_tr_b16 v[170:171], v25 offset:12288
    ds_read_b64_tr_b16 v[172:173], v4 offset:13312
    ds_read_b64_tr_b16 v[174:175], v25 offset:13312
    s_waitcnt lgkmcnt(15)
    v_mfma_f32_16x16x32_bf16 v[96:99], a[8:11], v[120:123], 0
    s_add_u32 s57, s58, s70
    ds_read_b64_tr_b16 a[184:185], v8 offset:24576
    v_mfma_f32_16x16x32_bf16 v[96:99], a[32:35], v[124:127], v[96:99]
    buffer_load_dwordx4 v24, s[24:27], s57 offen offset:2048 sc1 lds
    v_mfma_f32_16x16x32_bf16 v[96:99], a[56:59], v[128:131], v[96:99]
    ds_read_b64_tr_b16 a[186:187], v8 offset:25600
    ds_read_b64_tr_b16 a[188:189], v9 offset:24576
    v_mfma_f32_16x16x32_bf16 v[96:99], a[80:83], v[132:135], v[96:99]
    ds_read_b64_tr_b16 a[190:191], v9 offset:25600
    ds_read_b64_tr_b16 a[208:209], v8 offset:32768
    v_mfma_f32_16x16x32_bf16 v[96:99], a[104:107], v[136:139], v[96:99]
    s_add_u32 s57, s58, s71
    ds_read_b64_tr_b16 a[210:211], v8 offset:33792
    v_mfma_f32_16x16x32_bf16 v[96:99], a[128:131], v[140:143], v[96:99]
    buffer_load_dwordx4 v3, s[24:27], s57 offen offset:3072 sc1 lds
    s_waitcnt lgkmcnt(15)
    v_mfma_f32_16x16x32_bf16 v[96:99], a[152:155], v[144:147], v[96:99]
    ds_read_b64_tr_b16 a[212:213], v9 offset:32768
    ds_read_b64_tr_b16 a[214:215], v9 offset:33792
    v_mfma_f32_16x16x32_bf16 v[96:99], a[176:179], v[148:151], v[96:99]
    ds_read_b64_tr_b16 a[232:233], v8 offset:40960
    ds_read_b64_tr_b16 a[234:235], v8 offset:41984
    s_waitcnt lgkmcnt(15)
    v_mfma_f32_16x16x32_bf16 v[96:99], a[200:203], v[152:155], v[96:99]
    s_add_u32 m0, s90, 139264
    s_mov_b32 s57, 1120000
    ds_read_b64_tr_b16 a[236:237], v9 offset:40960
    v_mfma_f32_16x16x32_bf16 v[96:99], a[224:227], v[156:159], v[96:99]
    buffer_load_dwordx4 v2, s[8:11], s57 offen offset:0 lds
    s_waitcnt lgkmcnt(15)
    v_mfma_f32_16x16x32_bf16 v[96:99], a[248:251], v[160:163], v[96:99]
    ds_read_b64_tr_b16 a[238:239], v9 offset:41984
    v_mfma_f32_16x16x32_bf16 v[96:99], v[192:195], v[164:167], v[96:99]
    s_waitcnt lgkmcnt(12)
    v_mfma_f32_16x16x32_bf16 v[96:99], v[216:219], v[168:171], v[96:99]
    s_mov_b32 s57, 1129728
    v_mfma_f32_16x16x32_bf16 v[96:99], v[240:243], v[172:175], v[96:99]
    buffer_load_dwordx4 v2, s[8:11], s57 offen offset:1024 lds
    s_waitcnt vmcnt(12)
    s_barrier
    v_mfma_f32_16x16x32_bf16 v[100:103], a[12:15], v[120:123], 0
    ds_read_b64_tr_b16 v[120:121], v4 offset:16384
    ds_read_b64_tr_b16 v[122:123], v25 offset:16384
    v_mfma_f32_16x16x32_bf16 v[100:103], a[36:39], v[124:127], v[100:103]
    ds_read_b64_tr_b16 v[124:125], v4 offset:17408
    v_mfma_f32_16x16x32_bf16 v[100:103], a[60:63], v[128:131], v[100:103]
    ds_read_b64_tr_b16 v[126:127], v25 offset:17408
    ds_read_b64_tr_b16 v[128:129], v4 offset:18432
    s_add_u32 m0, s90, 147456
    s_mov_b32 s57, 0
    v_mfma_f32_16x16x32_bf16 v[100:103], a[84:87], v[132:135], v[100:103]
    buffer_load_dwordx4 v2, s[8:11], s57 offen offset:0 lds
    v_mfma_f32_16x16x32_bf16 v[100:103], a[108:111], v[136:139], v[100:103]
    ds_read_b64_tr_b16 v[130:131], v25 offset:18432
    ds_read_b64_tr_b16 v[132:133], v4 offset:19456
    v_mfma_f32_16x16x32_bf16 v[100:103], a[132:135], v[140:143], v[100:103]
    ds_read_b64_tr_b16 v[134:135], v25 offset:19456
    ds_read_b64_tr_b16 v[136:137], v4 offset:20480
    v_mfma_f32_16x16x32_bf16 v[100:103], a[156:159], v[144:147], v[100:103]
    ds_read_b64_tr_b16 v[138:139], v25 offset:20480
    s_mov_b32 s57, 9728
    v_mfma_f32_16x16x32_bf16 v[100:103], a[180:183], v[148:151], v[100:103]
    buffer_load_dwordx4 v2, s[8:11], s57 offen offset:1024 lds
    v_mfma_f32_16x16x32_bf16 v[100:103], a[204:207], v[152:155], v[100:103]
    ds_read_b64_tr_b16 v[140:141], v4 offset:21504
    ds_read_b64_tr_b16 v[142:143], v25 offset:21504
    v_mfma_f32_16x16x32_bf16 v[100:103], a[228:231], v[156:159], v[100:103]
    ds_read_b64_tr_b16 v[144:145], v4 offset:22528
    ds_read_b64_tr_b16 v[146:147], v25 offset:22528
    v_mfma_f32_16x16x32_bf16 v[100:103], a[252:255], v[160:163], v[100:103]
    ds_read_b64_tr_b16 v[148:149], v4 offset:23552
    ds_read_b64_tr_b16 v[150:151], v25 offset:23552
    s_add_u32 m0, s90, 155648
    s_mov_b32 s57, 86016
    v_mfma_f32_16x16x32_bf16 v[100:103], v[196:199], v[164:167], v[100:103]
    buffer_load_dwordx4 v2, s[8:11], s57 offen offset:0 lds
    v_mfma_f32_16x16x32_bf16 v[100:103], v[220:223], v[168:171], v[100:103]
    ds_read_b64_tr_b16 v[152:153], v4 offset:24576
    ds_read_b64_tr_b16 v[154:155], v25 offset:24576
    v_mfma_f32_16x16x32_bf16 v[100:103], v[244:247], v[172:175], v[100:103]
    ds_read_b64_tr_b16 v[156:157], v4 offset:25600
    ds_read_b64_tr_b16 v[158:159], v25 offset:25600
    s_waitcnt lgkmcnt(15)
    v_mfma_f32_16x16x32_bf16 v[104:107], a[8:11], v[120:123], 0
    ds_read_b64_tr_b16 v[160:161], v4 offset:26624
    s_mov_b32 s57, 95744
    v_mfma_f32_16x16x32_bf16 v[104:107], a[32:35], v[124:127], v[104:107]
    buffer_load_dwordx4 v2, s[8:11], s57 offen offset:1024 lds
    s_waitcnt lgkmcnt(13)
    v_mfma_f32_16x16x32_bf16 v[104:107], a[56:59], v[128:131], v[104:107]
    ds_read_b64_tr_b16 v[162:163], v25 offset:26624
    ds_read_b64_tr_b16 v[164:165], v4 offset:27648
    v_mfma_f32_16x16x32_bf16 v[104:107], a[80:83], v[132:135], v[104:107]
    ds_read_b64_tr_b16 v[166:167], v25 offset:27648
    ds_read_b64_tr_b16 v[168:169], v4 offset:28672
    s_waitcnt vmcnt(10)
    s_barrier
    s_waitcnt lgkmcnt(13)
    v_mfma_f32_16x16x32_bf16 v[104:107], a[104:107], v[136:139], v[104:107]
    ds_read_b64_tr_b16 v[170:171], v25 offset:28672
    ds_read_b64_tr_b16 v[172:173], v4 offset:29696
    s_add_u32 m0, s90, 65536
    s_mov_b32 s57, 172032
    v_mfma_f32_16x16x32_bf16 v[104:107], a[128:131], v[140:143], v[104:107]
    buffer_load_dwordx4 v2, s[8:11], s57 offen offset:0 lds
    s_waitcnt lgkmcnt(11)
    v_mfma_f32_16x16x32_bf16 v[104:107], a[152:155], v[144:147], v[104:107]
    ds_read_b64_tr_b16 v[174:175], v25 offset:29696
    v_cvt_pk_bf16_f32 v52, v96, v97
    v_mfma_f32_16x16x32_bf16 v[104:107], a[176:179], v[148:151], v[104:107]
    v_cvt_pk_bf16_f32 v53, v98, v99
    v_cvt_pk_bf16_f32 v54, v100, v101
    s_waitcnt lgkmcnt(8)
    v_mfma_f32_16x16x32_bf16 v[104:107], a[200:203], v[152:155], v[104:107]
    s_mov_b32 s57, 181760
    v_cvt_pk_bf16_f32 v55, v102, v103
    v_mfma_f32_16x16x32_bf16 v[104:107], a[224:227], v[156:159], v[104:107]
    buffer_load_dwordx4 v2, s[8:11], s57 offen offset:1024 lds
    s_waitcnt lgkmcnt(4)
    v_mfma_f32_16x16x32_bf16 v[104:107], a[248:251], v[160:163], v[104:107]
    v_cndmask_b32 v54, v54, 0, s[82:83]
    v_cndmask_b32 v55, v55, 0, s[82:83]
    v_mfma_f32_16x16x32_bf16 v[104:107], v[192:195], v[164:167], v[104:107]
    ds_read_b64_tr_b16 v[176:177], v12 offset:0
    ds_read_b64_tr_b16 v[178:179], v12 offset:1024
    s_waitcnt lgkmcnt(2)
    v_mfma_f32_16x16x32_bf16 v[104:107], v[216:219], v[168:171], v[104:107]
    s_add_u32 m0, s90, 73728
    s_mov_b32 s57, 258048
    ds_read_b64_tr_b16 v[180:181], v13 offset:0
    v_mfma_f32_16x16x32_bf16 v[104:107], v[240:243], v[172:175], v[104:107]
    buffer_load_dwordx4 v2, s[8:11], s57 offen offset:0 lds
    v_mfma_f32_16x16x32_bf16 v[108:111], a[12:15], v[120:123], 0
    ds_read_b64_tr_b16 v[182:183], v13 offset:1024
    ds_read_b64_tr_b16 v[200:201], v12 offset:8192
    v_mfma_f32_16x16x32_bf16 v[108:111], a[36:39], v[124:127], v[108:111]
    ds_read_b64_tr_b16 v[202:203], v12 offset:9216
    ds_read_b64_tr_b16 v[204:205], v13 offset:8192
    v_mfma_f32_16x16x32_bf16 v[108:111], a[60:63], v[128:131], v[108:111]
    s_mov_b32 s57, 267776
    ds_read_b64_tr_b16 v[206:207], v13 offset:9216
    v_mfma_f32_16x16x32_bf16 v[108:111], a[84:87], v[132:135], v[108:111]
    buffer_load_dwordx4 v2, s[8:11], s57 offen offset:1024 lds
    v_mfma_f32_16x16x32_bf16 v[108:111], a[108:111], v[136:139], v[108:111]
    ds_read_b64_tr_b16 v[224:225], v12 offset:16384
    ds_read_b64_tr_b16 v[226:227], v12 offset:17408
    v_mfma_f32_16x16x32_bf16 v[108:111], a[132:135], v[140:143], v[108:111]
    ds_read_b64_tr_b16 v[228:229], v13 offset:16384
    ds_read_b64_tr_b16 v[230:231], v13 offset:17408
    v_mfma_f32_16x16x32_bf16 v[108:111], a[156:159], v[144:147], v[108:111]
    s_add_u32 m0, s90, 81920
    s_mov_b32 s57, 344064
    v_cvt_pk_bf16_f32 v56, v104, v105
    v_mfma_f32_16x16x32_bf16 v[108:111], a[180:183], v[148:151], v[108:111]
    buffer_load_dwordx4 v2, s[8:11], s57 offen offset:0 lds
    v_mfma_f32_16x16x32_bf16 v[108:111], a[204:207], v[152:155], v[108:111]
    v_cvt_pk_bf16_f32 v57, v106, v107
    v_mfma_f32_16x16x32_bf16 v[108:111], a[228:231], v[156:159], v[108:111]
    v_mfma_f32_16x16x32_bf16 v[108:111], a[252:255], v[160:163], v[108:111]
    s_mov_b32 s57, 353792
    v_mfma_f32_16x16x32_bf16 v[108:111], v[196:199], v[164:167], v[108:111]
    buffer_load_dwordx4 v2, s[8:11], s57 offen offset:1024 lds
    v_mfma_f32_16x16x32_bf16 v[108:111], v[220:223], v[168:171], v[108:111]
    v_mfma_f32_16x16x32_bf16 v[108:111], v[244:247], v[172:175], v[108:111]
    v_mfma_f32_16x16x32_bf16 v[112:115], v[120:123], a[16:19], 0
    s_add_u32 m0, s90, 90112
    s_mov_b32 s57, 430080
    v_mfma_f32_16x16x32_bf16 v[112:115], v[124:127], a[40:43], v[112:115]
    buffer_load_dwordx4 v2, s[8:11], s57 offen offset:0 lds
    v_mfma_f32_16x16x32_bf16 v[112:115], v[128:131], a[64:67], v[112:115]
    v_mfma_f32_16x16x32_bf16 v[112:115], v[132:135], a[88:91], v[112:115]
    v_mfma_f32_16x16x32_bf16 v[112:115], v[136:139], a[112:115], v[112:115]
    s_mov_b32 s57, 439808
    v_mfma_f32_16x16x32_bf16 v[112:115], v[140:143], a[136:139], v[112:115]
    buffer_load_dwordx4 v2, s[8:11], s57 offen offset:1024 lds
    v_mfma_f32_16x16x32_bf16 v[112:115], v[144:147], a[160:163], v[112:115]
    v_cvt_pk_bf16_f32 v58, v108, v109
    v_cvt_pk_bf16_f32 v59, v110, v111
    v_mfma_f32_16x16x32_bf16 v[112:115], v[148:151], a[184:187], v[112:115]
    v_cndmask_b32 v58, v58, 0, s[82:83]
    v_cndmask_b32 v59, v59, 0, s[82:83]
    v_mfma_f32_16x16x32_bf16 v[112:115], v[152:155], a[208:211], v[112:115]
    s_add_u32 m0, s90, 98304
    s_mov_b32 s57, 516096
    buffer_load_dwordx4 v2, s[8:11], s57 offen offset:0 lds
    s_waitcnt vmcnt(9)
    s_waitcnt lgkmcnt(0)
    s_barrier
    ds_read_b64_tr_b16 v[248:249], v12 offset:24576
    ds_read_b64_tr_b16 v[250:251], v12 offset:25600
    ds_read_b64_tr_b16 v[252:253], v13 offset:24576
    ds_read_b64_tr_b16 v[254:255], v13 offset:25600
    v_mfma_f32_16x16x32_bf16 v[112:115], v[156:159], a[232:235], v[112:115]
    ds_read_b64_tr_b16 a[0:1], v10 offset:32768
    ds_read_b64_tr_b16 a[2:3], v10 offset:33792
    v_mfma_f32_16x16x32_bf16 v[112:115], v[160:163], v[176:179], v[112:115]
    ds_read_b64_tr_b16 a[4:5], v11 offset:32768
    ds_read_b64_tr_b16 a[6:7], v11 offset:33792
    v_mfma_f32_16x16x32_bf16 v[112:115], v[164:167], v[200:203], v[112:115]
    ds_read_b64_tr_b16 a[24:25], v10 offset:40960
    ds_read_b64_tr_b16 a[26:27], v10 offset:41984
    s_waitcnt lgkmcnt(6)
    v_mfma_f32_16x16x32_bf16 v[112:115], v[168:171], v[224:227], v[112:115]
    s_mov_b32 s57, 525824
    ds_read_b64_tr_b16 a[28:29], v11 offset:40960
    v_mfma_f32_16x16x32_bf16 v[112:115], v[172:175], v[248:251], v[112:115]
    buffer_load_dwordx4 v2, s[8:11], s57 offen offset:1024 lds
    v_mfma_f32_16x16x32_bf16 v[116:119], v[120:123], a[20:23], 0
    ds_read_b64_tr_b16 v[120:121], v4 offset:0
    ds_read_b64_tr_b16 v[122:123], v25 offset:0
    v_mfma_f32_16x16x32_bf16 v[116:119], v[124:127], a[44:47], v[116:119]
    ds_read_b64_tr_b16 v[124:125], v4 offset:1024
    ds_read_b64_tr_b16 a[30:31], v11 offset:41984
    v_mfma_f32_16x16x32_bf16 v[116:119], v[128:131], a[68:71], v[116:119]
    ds_read_b64_tr_b16 v[126:127], v25 offset:1024
    ds_read_b64_tr_b16 v[128:129], v4 offset:2048
    s_add_u32 m0, s90, 106496
    s_mov_b32 s57, 602112
    v_mfma_f32_16x16x32_bf16 v[116:119], v[132:135], a[92:95], v[116:119]
    buffer_load_dwordx4 v2, s[8:11], s57 offen offset:0 lds
    v_mfma_f32_16x16x32_bf16 v[116:119], v[136:139], a[116:119], v[116:119]
    ds_read_b64_tr_b16 v[130:131], v25 offset:2048
    ds_read_b64_tr_b16 v[132:133], v4 offset:3072
    v_mfma_f32_16x16x32_bf16 v[116:119], v[140:143], a[140:143], v[116:119]
    ds_read_b64_tr_b16 v[134:135], v25 offset:3072
    ds_read_b64_tr_b16 v[136:137], v4 offset:4096
    v_mfma_f32_16x16x32_bf16 v[116:119], v[144:147], a[164:167], v[116:119]
    ds_read_b64_tr_b16 v[138:139], v25 offset:4096
    s_mov_b32 s57, 611840
    v_mfma_f32_16x16x32_bf16 v[116:119], v[148:151], a[188:191], v[116:119]
    buffer_load_dwordx4 v2, s[8:11], s57 offen offset:1024 lds
    v_mfma_f32_16x16x32_bf16 v[116:119], v[152:155], a[212:215], v[116:119]
    ds_read_b64_tr_b16 v[140:141], v4 offset:5120
    ds_read_b64_tr_b16 v[142:143], v25 offset:5120
    v_mfma_f32_16x16x32_bf16 v[116:119], v[156:159], a[236:239], v[116:119]
    ds_read_b64_tr_b16 v[144:145], v4 offset:6144
    ds_read_b64_tr_b16 v[146:147], v25 offset:6144
    v_mfma_f32_16x16x32_bf16 v[116:119], v[160:163], v[180:183], v[116:119]
    ds_read_b64_tr_b16 v[148:149], v4 offset:7168
    ds_read_b64_tr_b16 v[150:151], v25 offset:7168
    s_add_u32 m0, s90, 114688
    s_mov_b32 s57, 688128
    v_mfma_f32_16x16x32_bf16 v[116:119], v[164:167], v[204:207], v[116:119]
    buffer_load_dwordx4 v2, s[8:11], s57 offen offset:0 lds
    v_mfma_f32_16x16x32_bf16 v[116:119], v[168:171], v[228:231], v[116:119]
    ds_read_b64_tr_b16 v[152:153], v4 offset:8192
    ds_read_b64_tr_b16 v[154:155], v25 offset:8192
    v_mfma_f32_16x16x32_bf16 v[116:119], v[172:175], v[252:255], v[116:119]
L_wa_1:
    s_cbranch_execz L_wa_ret
    ds_read_b64_tr_b16 v[156:157], v4 offset:9216
    ds_read_b64_tr_b16 v[158:159], v25 offset:9216
    s_waitcnt lgkmcnt(15)
    v_mfma_f32_16x16x32_bf16 v[96:99], v[120:123], a[16:19], 0
    ds_read_b64_tr_b16 v[160:161], v4 offset:10240
    s_mov_b32 s57, 697856
    v_mfma_f32_16x16x32_bf16 v[96:99], v[124:127], a[40:43], v[96:99]
    buffer_load_dwordx4 v2, s[8:11], s57 offen offset:1024 lds
    s_waitcnt lgkmcnt(13)
    v_mfma_f32_16x16x32_bf16 v[96:99], v[128:131], a[64:67], v[96:99]
    ds_read_b64_tr_b16 v[162:163], v25 offset:10240
    ds_read_b64_tr_b16 v[164:165], v4 offset:11264
    v_mfma_f32_16x16x32_bf16 v[96:99], v[132:135], a[88:91], v[96:99]
    ds_read_b64_tr_b16 v[166:167], v25 offset:11264
    ds_read_b64_tr_b16 v[168:169], v4 offset:12288
    s_waitcnt lgkmcnt(13)
    v_mfma_f32_16x16x32_bf16 v[96:99], v[136:139], a[112:115], v[96:99]
    ds_read_b64_tr_b16 v[170:171], v25 offset:12288
    ds_read_b64_tr_b16 v[172:173], v4 offset:13312
    s_add_u32 m0, s90, 122880
    s_mov_b32 s57, 774144
    v_mfma_f32_16x16x32_bf16 v[96:99], v[140:143], a[136:139], v[96:99]
    buffer_load_dwordx4 v2, s[8:11], s57 offen offset:0 lds
    s_waitcnt lgkmcnt(11)
    v_mfma_f32_16x16x32_bf16 v[96:99], v[144:147], a[160:163], v[96:99]
    ds_read_b64_tr_b16 v[174:175], v25 offset:13312
    v_cvt_pk_bf16_f32 v34, v112, v113
    v_mfma_f32_16x16x32_bf16 v[96:99], v[148:151], a[184:187], v[96:99]
    v_cvt_pk_bf16_f32 v35, v114, v115
    v_cvt_pk_bf16_f32 v44, v116, v117
    s_waitcnt lgkmcnt(8)
    v_mfma_f32_16x16x32_bf16 v[96:99], v[152:155], a[208:211], v[96:99]
    s_mov_b32 s57, 783872
    v_cvt_pk_bf16_f32 v45, v118, v119
    v_mfma_f32_16x16x32_bf16 v[96:99], v[156:159], a[232:235], v[96:99]
    buffer_load_dwordx4 v2, s[8:11], s57 offen offset:1024 lds
    s_waitcnt lgkmcnt(4)
    v_mfma_f32_16x16x32_bf16 v[96:99], v[160:163], v[176:179], v[96:99]
    v_mfma_f32_16x16x32_bf16 v[96:99], v[164:167], v[200:203], v[96:99]
    s_waitcnt vmcnt(10)
    s_barrier
    s_waitcnt lgkmcnt(0)
    v_mfma_f32_16x16x32_bf16 v[96:99], v[168:171], v[224:227], v[96:99]
    s_add_u32 m0, s90, 131072
    s_mov_b32 s57, 860160
    ds_read_b64_tr_b16 a[48:49], v6 offset:0
    v_mfma_f32_16x16x32_bf16 v[96:99], v[172:175], v[248:251], v[96:99]
    buffer_load_dwordx4 v2, s[8:11], s57 offen offset:0 lds
    v_mfma_f32_16x16x32_bf16 v[100:103], v[120:123], a[20:23], 0
    ds_read_b64_tr_b16 v[120:121], v4 offset:32768
    ds_read_b64_tr_b16 v[122:123], v25 offset:32768
    v_mfma_f32_16x16x32_bf16 v[100:103], v[124:127], a[44:47], v[100:103]
    ds_read_b64_tr_b16 v[124:125], v4 offset:33792
    ds_read_b64_tr_b16 a[50:51], v6 offset:1024
    v_mfma_f32_16x16x32_bf16 v[100:103], v[128:131], a[68:71], v[100:103]
    ds_read_b64_tr_b16 v[126:127], v25 offset:33792
    ds_read_b64_tr_b16 v[128:129], v4 offset:34816
    s_mov_b32 s57, 869888
    v_mfma_f32_16x16x32_bf16 v[100:103], v[132:135], a[92:95], v[100:103]
    buffer_load_dwordx4 v2, s[8:11], s57 offen offset:1024 lds
    v_mfma_f32_16x16x32_bf16 v[100:103], v[136:139], a[116:119], v[100:103]
    ds_read_b64_tr_b16 v[130:131], v25 offset:34816
    ds_read_b64_tr_b16 v[132:133], v4 offset:35840
    v_mfma_f32_16x16x32_bf16 v[100:103], v[140:143], a[140:143], v[100:103]
    ds_read_b64_tr_b16 v[134:135], v25 offset:35840
    ds_read_b64_tr_b16 v[136:137], v4 offset:36864
    v_mfma_f32_16x16x32_bf16 v[100:103], v[144:147], a[164:167], v[100:103]
    ds_read_b64_tr_b16 v[138:139], v25 offset:36864
    s_add_u32 m0, s90, 139264
    s_mov_b32 s57, 946176
    v_mfma_f32_16x16x32_bf16 v[100:103], v[148:151], a[188:191], v[100:103]
    buffer_load_dwordx4 v2, s[8:11], s57 offen offset:0 lds
    v_mfma_f32_16x16x32_bf16 v[100:103], v[152:155], a[212:215], v[100:103]
    ds_read_b64_tr_b16 v[140:141], v4 offset:37888
    ds_read_b64_tr_b16 v[142:143], v25 offset:37888
    v_mfma_f32_16x16x32_bf16 v[100:103], v[156:159], a[236:239], v[100:103]
    ds_read_b64_tr_b16 v[144:145], v4 offset:38912
    ds_read_b64_tr_b16 v[146:147], v25 offset:38912
    v_mfma_f32_16x16x32_bf16 v[100:103], v[160:163], v[180:183], v[100:103]
    ds_read_b64_tr_b16 v[148:149], v4 offset:39936
    ds_read_b64_tr_b16 v[150:151], v25 offset:39936
    s_mov_b32 s57, 955904
    v_mfma_f32_16x16x32_bf16 v[100:103], v[164:167], v[204:207], v[100:103]
    buffer_load_dwordx4 v2, s[8:11], s57 offen offset:1024 lds
    v_mfma_f32_16x16x32_bf16 v[100:103], v[168:171], v[228:231], v[100:103]
    ds_read_b64_tr_b16 v[152:153], v4 offset:40960
    ds_read_b64_tr_b16 v[154:155], v25 offset:40960
    v_mfma_f32_16x16x32_bf16 v[100:103], v[172:175], v[252:255], v[100:103]
    ds_read_b64_tr_b16 v[156:157], v4 offset:41984
    ds_read_b64_tr_b16 v[158:159], v25 offset:41984
    s_waitcnt lgkmcnt(15)
    v_mfma_f32_16x16x32_bf16 v[104:107], a[8:11], v[120:123], 0
    ds_read_b64_tr_b16 v[160:161], v4 offset:43008
    s_add_u32 m0, s90, 147456
    s_mov_b32 s57, 1032192
    v_mfma_f32_16x16x32_bf16 v[104:107], a[32:35], v[124:127], v[104:107]
    buffer_load_dwordx4 v2, s[8:11], s57 offen offset:0 lds
    s_waitcnt lgkmcnt(13)
    v_mfma_f32_16x16x32_bf16 v[104:107], a[56:59], v[128:131], v[104:107]
    ds_read_b64_tr_b16 v[162:163], v25 offset:43008
    ds_read_b64_tr_b16 v[164:165], v4 offset:44032
    v_mfma_f32_16x16x32_bf16 v[104:107], a[80:83], v[132:135], v[104:107]
    ds_read_b64_tr_b16 v[166:167], v25 offset:44032
    ds_read_b64_tr_b16 v[168:169], v4 offset:45056
    s_waitcnt lgkmcnt(13)
    v_mfma_f32_16x16x32_bf16 v[104:107], a[104:107], v[136:139], v[104:107]
    ds_read_b64_tr_b16 v[170:171], v25 offset:45056
    ds_read_b64_tr_b16 v[172:173], v4 offset:46080
    s_mov_b32 s57, 1041920
    v_mfma_f32_16x16x32_bf16 v[104:107], a[128:131], v[140:143], v[104:107]
    buffer_load_dwordx4 v2, s[8:11], s57 offen offset:1024 lds
    s_waitcnt lgkmcnt(11)
    v_mfma_f32_16x16x32_bf16 v[104:107], a[152:155], v[144:147], v[104:107]
    ds_read_b64_tr_b16 v[174:175], v25 offset:46080
    v_cvt_pk_bf16_f32 v32, v96, v97
    v_mfma_f32_16x16x32_bf16 v[104:107], a[176:179], v[148:151], v[104:107]
    v_cvt_pk_bf16_f32 v33, v98, v99
    v_cvt_pk_bf16_f32 v42, v100, v101
    s_waitcnt lgkmcnt(8)
    v_mfma_f32_16x16x32_bf16 v[104:107], a[200:203], v[152:155], v[104:107]
    s_add_u32 m0, s90, 155648
    s_mov_b32 s57, 1118208
    v_cvt_pk_bf16_f32 v43, v102, v103
    v_mfma_f32_16x16x32_bf16 v[104:107], a[224:227], v[156:159], v[104:107]
    buffer_load_dwordx4 v2, s[8:11], s57 offen offset:0 lds
    s_waitcnt lgkmcnt(4)
    v_mfma_f32_16x16x32_bf16 v[104:107], a[248:251], v[160:163], v[104:107]
    ds_read_b64_tr_b16 a[52:53], v7 offset:0
    ds_read_b64_tr_b16 a[54:55], v7 offset:1024
    v_mfma_f32_16x16x32_bf16 v[104:107], v[192:195], v[164:167], v[104:107]
    ds_read_b64_tr_b16 a[72:73], v6 offset:8192
    ds_read_b64_tr_b16 a[74:75], v6 offset:9216
    s_waitcnt lgkmcnt(4)
    v_mfma_f32_16x16x32_bf16 v[104:107], v[216:219], v[168:171], v[104:107]
    s_mov_b32 s57, 1127936
    ds_read_b64_tr_b16 a[76:77], v7 offset:8192
    v_mfma_f32_16x16x32_bf16 v[104:107], v[240:243], v[172:175], v[104:107]
    buffer_load_dwordx4 v2, s[8:11], s57 offen offset:1024 lds
    v_mfma_f32_16x16x32_bf16 v[108:111], a[12:15], v[120:123], 0
    ds_read_b64_tr_b16 a[78:79], v7 offset:9216
    ds_read_b64_tr_b16 a[96:97], v6 offset:16384
    v_mfma_f32_16x16x32_bf16 v[108:111], a[36:39], v[124:127], v[108:111]
    ds_read_b64_tr_b16 a[98:99], v6 offset:17408
    ds_read_b64_tr_b16 a[100:101], v7 offset:16384
    v_mfma_f32_16x16x32_bf16 v[108:111], a[60:63], v[128:131], v[108:111]
    s_add_u32 m0, s52, 49152
    s_add_u32 s58, s72, 1024
    s_add_u32 s57, s58, s68
    ds_read_b64_tr_b16 a[102:103], v7 offset:17408
    v_mfma_f32_16x16x32_bf16 v[108:111], a[84:87], v[132:135], v[108:111]
    buffer_load_dwordx4 v3, s[24:27], s57 offen offset:0 sc1 lds
    s_waitcnt vmcnt(13)
    s_waitcnt lgkmcnt(0)
    s_barrier
    v_mfma_f32_16x16x32_bf16 v[108:111], a[108:111], v[136:139], v[108:111]
    ds_read_b64_tr_b16 a[120:121], v6 offset:24576
    ds_read_b64_tr_b16 a[122:123], v6 offset:25600
    v_mfma_f32_16x16x32_bf16 v[108:111], a[132:135], v[140:143], v[108:111]
    ds_read_b64_tr_b16 a[124:125], v7 offset:24576
    ds_read_b64_tr_b16 a[126:127], v7 offset:25600
    v_mfma_f32_16x16x32_bf16 v[108:111], a[156:159], v[144:147], v[108:111]
    s_add_u32 s57, s58, s69
    v_cvt_pk_bf16_f32 v60, v104, v105
    v_mfma_f32_16x16x32_bf16 v[108:111], a[180:183], v[148:151], v[108:111]
    buffer_load_dwordx4 v3, s[24:27], s57 offen offset:1024 sc1 lds
    v_mfma_f32_16x16x32_bf16 v[108:111], a[204:207], v[152:155], v[108:111]
    v_cvt_pk_bf16_f32 v61, v106, v107
    ds_read_b64_tr_b16 a[144:145], v6 offset:32768
    v_mfma_f32_16x16x32_bf16 v[108:111], a[228:231], v[156:159], v[108:111]
    ds_read_b64_tr_b16 a[146:147], v6 offset:33792
    ds_read_b64_tr_b16 a[148:149], v7 offset:32768
    v_mfma_f32_16x16x32_bf16 v[108:111], a[252:255], v[160:163], v[108:111]
    s_add_u32 s57, s58, s70
    ds_read_b64_tr_b16 a[150:151], v7 offset:33792
    v_mfma_f32_16x16x32_bf16 v[108:111], v[196:199], v[164:167], v[108:111]
    buffer_load_dwordx4 v24, s[24:27], s57 offen offset:2048 sc1 lds
    v_mfma_f32_16x16x32_bf16 v[108:111], v[220:223], v[168:171], v[108:111]
    ds_read_b64_tr_b16 a[168:169], v6 offset:40960
    ds_read_b64_tr_b16 a[170:171], v6 offset:41984
    v_mfma_f32_16x16x32_bf16 v[108:111], v[244:247], v[172:175], v[108:111]
    ds_read_b64_tr_b16 a[172:173], v7 offset:40960
    ds_read_b64_tr_b16 a[174:175], v7 offset:41984
    v_mfma_f32_16x16x32_bf16 v[112:115], v[120:123], a[16:19], 0
    s_add_u32 s57, s58, s71
    v_mfma_f32_16x16x32_bf16 v[112:115], v[124:127], a[40:43], v[112:115]
    buffer_load_dwordx4 v3, s[24:27], s57 offen offset:3072 sc1 lds
    v_mfma_f32_16x16x32_bf16 v[112:115], v[128:131], a[64:67], v[112:115]
    v_mfma_f32_16x16x32_bf16 v[112:115], v[132:135], a[88:91], v[112:115]
    s_waitcnt vmcnt(10)
    s_waitcnt lgkmcnt(0)
    s_barrier
    v_mfma_f32_16x16x32_bf16 v[112:115], v[136:139], a[112:115], v[112:115]
    ds_read_b64_tr_b16 a[192:193], v10 offset:0
    ds_read_b64_tr_b16 a[194:195], v10 offset:1024
    v_mfma_f32_16x16x32_bf16 v[112:115], v[140:143], a[136:139], v[112:115]
    ds_read_b64_tr_b16 a[196:197], v11 offset:0
    ds_read_b64_tr_b16 a[198:199], v11 offset:1024
    v_mfma_f32_16x16x32_bf16 v[112:115], v[144:147], a[160:163], v[112:115]
    v_cvt_pk_bf16_f32 v62, v108, v109
    v_cvt_pk_bf16_f32 v63, v110, v111
    v_mfma_f32_16x16x32_bf16 v[112:115], v[148:151], a[184:187], v[112:115]
    v_cndmask_b32 v62, v62, 0, s[82:83]
    v_cndmask_b32 v63, v63, 0, s[82:83]
    v_mfma_f32_16x16x32_bf16 v[112:115], v[152:155], a[208:211], v[112:115]
    ds_read_b64_tr_b16 a[216:217], v10 offset:8192
    ds_read_b64_tr_b16 a[218:219], v10 offset:9216
    v_mfma_f32_16x16x32_bf16 v[112:115], v[156:159], a[232:235], v[112:115]
    ds_read_b64_tr_b16 a[220:221], v11 offset:8192
    ds_read_b64_tr_b16 a[222:223], v11 offset:9216
    v_mfma_f32_16x16x32_bf16 v[112:115], v[160:163], v[176:179], v[112:115]
    ds_read_b64_tr_b16 a[240:241], v10 offset:16384
    ds_read_b64_tr_b16 a[242:243], v10 offset:17408
    v_mfma_f32_16x16x32_bf16 v[112:115], v[164:167], v[200:203], v[112:115]
    ds_read_b64_tr_b16 a[244:245], v11 offset:16384
    ds_read_b64_tr_b16 a[246:247], v11 offset:17408
    v_mfma_f32_16x16x32_bf16 v[112:115], v[168:171], v[224:227], v[112:115]
    v_mfma_f32_16x16x32_bf16 v[112:115], v[172:175], v[248:251], v[112:115]
    v_mfma_f32_16x16x32_bf16 v[116:119], v[120:123], a[20:23], 0
    v_mfma_f32_16x16x32_bf16 v[116:119], v[124:127], a[44:47], v[116:119]
    v_mfma_f32_16x16x32_bf16 v[116:119], v[128:131], a[68:71], v[116:119]
    v_mfma_f32_16x16x32_bf16 v[116:119], v[132:135], a[92:95], v[116:119]
    v_mfma_f32_16x16x32_bf16 v[116:119], v[136:139], a[116:119], v[116:119]
    v_mfma_f32_16x16x32_bf16 v[116:119], v[140:143], a[140:143], v[116:119]
    v_mfma_f32_16x16x32_bf16 v[116:119], v[144:147], a[164:167], v[116:119]
    s_nop 0
    v_cvt_pk_bf16_f32 v36, v112, v113
    v_cvt_pk_bf16_f32 v37, v114, v115
    v_mfma_f32_16x16x32_bf16 v[116:119], v[148:151], a[188:191], v[116:119]
    v_mfma_f32_16x16x32_bf16 v[116:119], v[152:155], a[212:215], v[116:119]
    v_mfma_f32_16x16x32_bf16 v[116:119], v[156:159], a[236:239], v[116:119]
    v_mfma_f32_16x16x32_bf16 v[116:119], v[160:163], v[180:183], v[116:119]
    v_mfma_f32_16x16x32_bf16 v[116:119], v[164:167], v[204:207], v[116:119]
    v_mfma_f32_16x16x32_bf16 v[116:119], v[168:171], v[228:231], v[116:119]
    v_mfma_f32_16x16x32_bf16 v[116:119], v[172:175], v[252:255], v[116:119]
    s_waitcnt vmcnt(4)
    s_waitcnt lgkmcnt(0)
    s_barrier
    v_mfma_f32_16x16x32_bf16 v[96:99], a[0:3], v[120:123], 0
    ds_read_b64_tr_b16 v[184:185], v10 offset:24576
    ds_read_b64_tr_b16 v[186:187], v10 offset:25600
    v_mfma_f32_16x16x32_bf16 v[96:99], a[24:27], v[124:127], v[96:99]
    ds_read_b64_tr_b16 v[188:189], v11 offset:24576
    ds_read_b64_tr_b16 v[190:191], v11 offset:25600
    v_mfma_f32_16x16x32_bf16 v[96:99], a[48:51], v[128:131], v[96:99]
    ds_read_b64_tr_b16 v[208:209], v10 offset:32768
    ds_read_b64_tr_b16 v[210:211], v10 offset:33792
    v_mfma_f32_16x16x32_bf16 v[96:99], a[72:75], v[132:135], v[96:99]
    ds_read_b64_tr_b16 v[212:213], v11 offset:32768
    ds_read_b64_tr_b16 v[214:215], v11 offset:33792
    v_mfma_f32_16x16x32_bf16 v[96:99], a[96:99], v[136:139], v[96:99]
    ds_read_b64_tr_b16 v[232:233], v10 offset:40960
    ds_read_b64_tr_b16 v[234:235], v10 offset:41984
    v_mfma_f32_16x16x32_bf16 v[96:99], a[120:123], v[140:143], v[96:99]
    ds_read_b64_tr_b16 v[236:237], v11 offset:40960
    ds_read_b64_tr_b16 v[238:239], v11 offset:41984
    v_mfma_f32_16x16x32_bf16 v[96:99], a[144:147], v[144:147], v[96:99]
    v_cvt_pk_bf16_f32 v46, v116, v117
    v_cvt_pk_bf16_f32 v47, v118, v119
    v_mfma_f32_16x16x32_bf16 v[96:99], a[168:171], v[148:151], v[96:99]
    v_mfma_f32_16x16x32_bf16 v[96:99], a[192:195], v[152:155], v[96:99]
    v_mfma_f32_16x16x32_bf16 v[96:99], a[216:219], v[156:159], v[96:99]
    s_waitcnt lgkmcnt(8)
    v_mfma_f32_16x16x32_bf16 v[96:99], a[240:243], v[160:163], v[96:99]
    v_mfma_f32_16x16x32_bf16 v[96:99], v[184:187], v[164:167], v[96:99]
    s_waitcnt lgkmcnt(0)
    s_barrier
    v_mfma_f32_16x16x32_bf16 v[96:99], v[208:211], v[168:171], v[96:99]
    s_add_u32 m0, s52, 65536
    s_add_u32 s58, s72, 1536
    s_add_u32 s57, s58, s68
    v_mfma_f32_16x16x32_bf16 v[96:99], v[232:235], v[172:175], v[96:99]
    buffer_load_dwordx4 v3, s[24:27], s57 offen offset:0 sc1 lds
    v_mfma_f32_16x16x32_bf16 v[100:103], a[4:7], v[120:123], 0
    ds_read_b64_tr_b16 v[120:121], v4 offset:16384
    ds_read_b64_tr_b16 v[122:123], v25 offset:16384
    v_mfma_f32_16x16x32_bf16 v[100:103], a[28:31], v[124:127], v[100:103]
    ds_read_b64_tr_b16 v[124:125], v4 offset:17408
    v_mfma_f32_16x16x32_bf16 v[100:103], a[52:55], v[128:131], v[100:103]
    ds_read_b64_tr_b16 v[126:127], v25 offset:17408
    ds_read_b64_tr_b16 v[128:129], v4 offset:18432
    v_mfma_f32_16x16x32_bf16 v[100:103], a[76:79], v[132:135], v[100:103]
    ds_read_b64_tr_b16 v[130:131], v25 offset:18432
    v_mfma_f32_16x16x32_bf16 v[100:103], a[100:103], v[136:139], v[100:103]
    ds_read_b64_tr_b16 v[132:133], v4 offset:19456
    s_add_u32 s57, s58, s69
    v_mfma_f32_16x16x32_bf16 v[100:103], a[124:127], v[140:143], v[100:103]
    buffer_load_dwordx4 v3, s[24:27], s57 offen offset:1024 sc1 lds
    v_mfma_f32_16x16x32_bf16 v[100:103], a[148:151], v[144:147], v[100:103]
    ds_read_b64_tr_b16 v[134:135], v25 offset:19456
    ds_read_b64_tr_b16 v[136:137], v4 offset:20480
    v_mfma_f32_16x16x32_bf16 v[100:103], a[172:175], v[148:151], v[100:103]
    ds_read_b64_tr_b16 v[138:139], v25 offset:20480
    ds_read_b64_tr_b16 v[140:141], v4 offset:21504
    v_mfma_f32_16x16x32_bf16 v[100:103], a[196:199], v[152:155], v[100:103]
    ds_read_b64_tr_b16 v[142:143], v25 offset:21504
    ds_read_b64_tr_b16 v[144:145], v4 offset:22528
    v_mfma_f32_16x16x32_bf16 v[100:103], a[220:223], v[156:159], v[100:103]
    ds_read_b64_tr_b16 v[146:147], v25 offset:22528
    v_cvt_pk_bf16_f32 v64, v96, v97
    v_mfma_f32_16x16x32_bf16 v[100:103], a[244:247], v[160:163], v[100:103]
    ds_read_b64_tr_b16 v[148:149], v4 offset:23552
    ds_read_b64_tr_b16 v[150:151], v25 offset:23552
    s_add_u32 s57, s58, s70
    v_mfma_f32_16x16x32_bf16 v[100:103], v[188:191], v[164:167], v[100:103]
    buffer_load_dwordx4 v24, s[24:27], s57 offen offset:2048 sc1 lds
    v_mfma_f32_16x16x32_bf16 v[100:103], v[212:215], v[168:171], v[100:103]
    ds_read_b64_tr_b16 v[152:153], v4 offset:24576
    ds_read_b64_tr_b16 v[154:155], v25 offset:24576
    v_mfma_f32_16x16x32_bf16 v[100:103], v[236:239], v[172:175], v[100:103]
    ds_read_b64_tr_b16 v[156:157], v4 offset:25600
    ds_read_b64_tr_b16 v[158:159], v25 offset:25600
    s_waitcnt lgkmcnt(15)
    v_mfma_f32_16x16x32_bf16 v[104:107], a[0:3], v[120:123], 0
    ds_read_b64_tr_b16 v[160:161], v4 offset:26624
    v_cvt_pk_bf16_f32 v65, v98, v99
    v_mfma_f32_16x16x32_bf16 v[104:107], a[24:27], v[124:127], v[104:107]
    ds_read_b64_tr_b16 v[162:163], v25 offset:26624
    ds_read_b64_tr_b16 v[164:165], v4 offset:27648
    s_waitcnt lgkmcnt(15)
    v_mfma_f32_16x16x32_bf16 v[104:107], a[48:51], v[128:131], v[104:107]
    ds_read_b64_tr_b16 v[166:167], v25 offset:27648
    s_add_u32 s57, s58, s71
    v_mfma_f32_16x16x32_bf16 v[104:107], a[72:75], v[132:135], v[104:107]
    buffer_load_dwordx4 v3, s[24:27], s57 offen offset:3072 sc1 lds
    s_waitcnt lgkmcnt(12)
    v_mfma_f32_16x16x32_bf16 v[104:107], a[96:99], v[136:139], v[104:107]
    ds_read_b64_tr_b16 v[168:169], v4 offset:28672
    ds_read_b64_tr_b16 v[170:171], v25 offset:28672
    v_mfma_f32_16x16x32_bf16 v[104:107], a[120:123], v[140:143], v[104:107]
    ds_read_b64_tr_b16 v[172:173], v4 offset:29696
    ds_read_b64_tr_b16 v[174:175], v25 offset:29696
    s_waitcnt lgkmcnt(12)
    v_mfma_f32_16x16x32_bf16 v[104:107], a[144:147], v[144:147], v[104:107]
    v_cvt_pk_bf16_f32 v66, v100, v101
    v_cvt_pk_bf16_f32 v67, v102, v103
    v_mfma_f32_16x16x32_bf16 v[104:107], a[168:171], v[148:151], v[104:107]
    v_cndmask_b32 v66, v66, 0, s[82:83]
    v_cndmask_b32 v67, v67, 0, s[82:83]
    s_waitcnt lgkmcnt(8)
    v_mfma_f32_16x16x32_bf16 v[104:107], a[192:195], v[152:155], v[104:107]
    s_add_u32 m0, s52, 81920
    s_add_u32 s58, s72, 2048
    s_add_u32 s57, s58, s68
    v_mfma_f32_16x16x32_bf16 v[104:107], a[216:219], v[156:159], v[104:107]
    buffer_load_dwordx4 v3, s[24:27], s57 offen offset:0 sc1 lds
    s_waitcnt lgkmcnt(4)
    v_mfma_f32_16x16x32_bf16 v[104:107], a[240:243], v[160:163], v[104:107]
    v_mfma_f32_16x16x32_bf16 v[104:107], v[184:187], v[164:167], v[104:107]
    s_waitcnt lgkmcnt(0)
    v_mfma_f32_16x16x32_bf16 v[104:107], v[208:211], v[168:171], v[104:107]
    v_mfma_f32_16x16x32_bf16 v[104:107], v[232:235], v[172:175], v[104:107]
    s_waitcnt vmcnt(5)
    s_barrier
    v_mfma_f32_16x16x32_bf16 v[108:111], a[4:7], v[120:123], 0
    ds_read_b64_tr_b16 v[120:121], v4 offset:49152
    ds_read_b64_tr_b16 v[122:123], v25 offset:49152
    s_add_u32 s57, s58, s69
    v_mfma_f32_16x16x32_bf16 v[108:111], a[28:31], v[124:127], v[108:111]
    buffer_load_dwordx4 v3, s[24:27], s57 offen offset:1024 sc1 lds
    v_mfma_f32_16x16x32_bf16 v[108:111], a[52:55], v[128:131], v[108:111]
    ds_read_b64_tr_b16 v[124:125], v4 offset:50176
    ds_read_b64_tr_b16 v[126:127], v25 offset:50176
    v_mfma_f32_16x16x32_bf16 v[108:111], a[76:79], v[132:135], v[108:111]
    ds_read_b64_tr_b16 v[128:129], v4 offset:51200
    ds_read_b64_tr_b16 v[130:131], v25 offset:51200
    v_mfma_f32_16x16x32_bf16 v[108:111], a[100:103], v[136:139], v[108:111]
    ds_read_b64_tr_b16 v[132:133], v4 offset:52224
    v_mfma_f32_16x16x32_bf16 v[108:111], a[124:127], v[140:143], v[108:111]
    ds_read_b64_tr_b16 v[134:135], v25 offset:52224
    ds_read_b64_tr_b16 v[136:137], v4 offset:53248
    v_mfma_f32_16x16x32_bf16 v[108:111], a[148:151], v[144:147], v[108:111]
    ds_read_b64_tr_b16 v[138:139], v25 offset:53248
    s_add_u32 s57, s58, s70
    v_mfma_f32_16x16x32_bf16 v[108:111], a[172:175], v[148:151], v[108:111]
    buffer_load_dwordx4 v24, s[24:27], s57 offen offset:2048 sc1 lds
    v_mfma_f32_16x16x32_bf16 v[108:111], a[196:199], v[152:155], v[108:111]
    ds_read_b64_tr_b16 v[140:141], v4 offset:54272
    ds_read_b64_tr_b16 v[142:143], v25 offset:54272
    v_mfma_f32_16x16x32_bf16 v[108:111], a[220:223], v[156:159], v[108:111]
    ds_read_b64_tr_b16 v[144:145], v4 offset:55296
    ds_read_b64_tr_b16 v[146:147], v25 offset:55296
    v_mfma_f32_16x16x32_bf16 v[108:111], a[244:247], v[160:163], v[108:111]
    ds_read_b64_tr_b16 v[148:149], v4 offset:56320
    ds_read_b64_tr_b16 v[150:151], v25 offset:56320
    v_mfma_f32_16x16x32_bf16 v[108:111], v[188:191], v[164:167], v[108:111]
    ds_read_b64_tr_b16 v[152:153], v4 offset:57344
    v_cvt_pk_bf16_f32 v68, v104, v105
    v_mfma_f32_16x16x32_bf16 v[108:111], v[212:215], v[168:171], v[108:111]
    ds_read_b64_tr_b16 v[154:155], v25 offset:57344
    ds_read_b64_tr_b16 v[156:157], v4 offset:58368
    s_add_u32 s57, s58, s71
    v_mfma_f32_16x16x32_bf16 v[108:111], v[236:239], v[172:175], v[108:111]
    buffer_load_dwordx4 v3, s[24:27], s57 offen offset:3072 sc1 lds
    s_waitcnt lgkmcnt(15)
    v_mfma_f32_16x16x32_bf16 v[112:115], a[8:11], v[120:123], 0
    ds_read_b64_tr_b16 v[158:159], v25 offset:58368
    ds_read_b64_tr_b16 v[160:161], v4 offset:59392
    v_mfma_f32_16x16x32_bf16 v[112:115], a[32:35], v[124:127], v[112:115]
    ds_read_b64_tr_b16 v[162:163], v25 offset:59392
    ds_read_b64_tr_b16 v[164:165], v4 offset:60416
    s_waitcnt lgkmcnt(15)
    v_mfma_f32_16x16x32_bf16 v[112:115], a[56:59], v[128:131], v[112:115]
    ds_read_b64_tr_b16 v[166:167], v25 offset:60416
    v_cvt_pk_bf16_f32 v69, v106, v107
    v_mfma_f32_16x16x32_bf16 v[112:115], a[80:83], v[132:135], v[112:115]
    ds_read_b64_tr_b16 v[168:169], v4 offset:61440
    s_waitcnt lgkmcnt(13)
    v_mfma_f32_16x16x32_bf16 v[112:115], a[104:107], v[136:139], v[112:115]
    ds_read_b64_tr_b16 v[170:171], v25 offset:61440
    ds_read_b64_tr_b16 v[172:173], v4 offset:62464
    s_add_u32 m0, s52, 98304
    s_add_u32 s58, s72, 2560
    s_add_u32 s57, s58, s68
    v_mfma_f32_16x16x32_bf16 v[112:115], a[128:131], v[140:143], v[112:115]
    buffer_load_dwordx4 v3, s[24:27], s57 offen offset:0 sc1 lds
    s_waitcnt lgkmcnt(11)
    v_mfma_f32_16x16x32_bf16 v[112:115], a[152:155], v[144:147], v[112:115]
    ds_read_b64_tr_b16 v[174:175], v25 offset:62464
    v_cvt_pk_bf16_f32 v70, v108, v109
    v_mfma_f32_16x16x32_bf16 v[112:115], a[176:179], v[148:151], v[112:115]
    v_cvt_pk_bf16_f32 v71, v110, v111
    v_cndmask_b32 v70, v70, 0, s[82:83]
    s_waitcnt lgkmcnt(8)
    v_mfma_f32_16x16x32_bf16 v[112:115], a[200:203], v[152:155], v[112:115]
    v_cndmask_b32 v71, v71, 0, s[82:83]
    v_mov_b32 v8, 0
    v_mfma_f32_16x16x32_bf16 v[112:115], a[224:227], v[156:159], v[112:115]
    v_mov_b32 v9, 0
    v_mov_b32 v10, 0
    s_waitcnt lgkmcnt(4)
    v_mfma_f32_16x16x32_bf16 v[112:115], a[248:251], v[160:163], v[112:115]
    s_add_u32 s57, s58, s69
    v_mfma_f32_16x16x32_bf16 v[72:75], v[52:55], v[68:71], 0
    v_mfma_f32_16x16x32_bf16 v[112:115], v[192:195], v[164:167], v[112:115]
    buffer_load_dwordx4 v3, s[24:27], s57 offen offset:1024 sc1 lds
    s_waitcnt lgkmcnt(0)
    v_mfma_f32_16x16x32_bf16 v[112:115], v[216:219], v[168:171], v[112:115]
    v_mfma_f32_16x16x32_bf16 v[76:79], v[56:59], v[68:71], 0
    v_mfma_f32_16x16x32_bf16 v[112:115], v[240:243], v[172:175], v[112:115]
    ds_read_u16_d16_hi v8, v93 offset:0
    ds_read_u16_d16_hi v9, v94 offset:0
    v_mfma_f32_16x16x32_bf16 v[116:119], a[12:15], v[120:123], 0
    ds_read_u16_d16_hi v10, v92 offset:0
    v_mfma_f32_16x16x32_bf16 v[116:119], a[36:39], v[124:127], v[116:119]
    v_mfma_f32_16x16x32_bf16 v[116:119], a[60:63], v[128:131], v[116:119]
    s_add_u32 s57, s58, s70
    v_mfma_f32_16x16x32_bf16 v[116:119], a[84:87], v[132:135], v[116:119]
    buffer_load_dwordx4 v24, s[24:27], s57 offen offset:2048 sc1 lds
    v_mfma_f32_16x16x32_bf16 v[116:119], a[108:111], v[136:139], v[116:119]
    v_cndmask_b32 v26, v72, v73, s[76:77]
    v_cndmask_b32 v27, v74, v75, s[76:77]
    v_mfma_f32_16x16x32_bf16 v[116:119], a[132:135], v[140:143], v[116:119]
    v_cndmask_b32 v28, v76, v77, s[76:77]
    v_cndmask_b32 v29, v78, v79, s[76:77]
    v_mfma_f32_16x16x32_bf16 v[116:119], a[156:159], v[144:147], v[116:119]
    v_cvt_pk_bf16_f32 v52, v112, v113
    v_cvt_pk_bf16_f32 v53, v114, v115
    v_mfma_f32_16x16x32_bf16 v[116:119], a[180:183], v[148:151], v[116:119]
    v_cndmask_b32 v26, v26, v28, s[78:79]
    v_cndmask_b32 v27, v27, v29, s[80:81]
    v_mfma_f32_16x16x32_bf16 v[116:119], a[204:207], v[152:155], v[116:119]
    s_add_u32 s57, s58, s71
    s_waitcnt lgkmcnt(0)
    v_mfma_f32_16x16x32_bf16 v[116:119], a[228:231], v[156:159], v[116:119]
    buffer_load_dwordx4 v3, s[24:27], s57 offen offset:3072 sc1 lds
    v_mfma_f32_16x16x32_bf16 v[116:119], a[252:255], v[160:163], v[116:119]
    v_mul_f32 v26, v26, v8
    v_mul_f32 v27, v27, v9
    v_mfma_f32_16x16x32_bf16 v[116:119], v[196:199], v[164:167], v[116:119]
    v_mul_f32 v11, s91, v10
    v_cndmask_b32 v26, v26, v18, s[84:85]
    v_mfma_f32_16x16x32_bf16 v[116:119], v[220:223], v[168:171], v[116:119]
    v_cndmask_b32 v27, v27, v18, s[86:87]
    v_max_f32 v28, v26, v27
    v_mfma_f32_16x16x32_bf16 v[116:119], v[244:247], v[172:175], v[116:119]
    v_mov_b32 v29, v28
    v_mfma_f32_16x16x32_bf16 v[96:99], v[120:123], a[16:19], 0
    s_add_u32 m0, s52, 114688
    s_add_u32 s58, s72, 3072
    s_add_u32 s57, s58, s68
    v_mfma_f32_16x16x32_bf16 v[96:99], v[124:127], a[40:43], v[96:99]
    buffer_load_dwordx4 v3, s[24:27], s57 offen offset:0 sc1 lds
    v_mfma_f32_16x16x32_bf16 v[96:99], v[128:131], a[64:67], v[96:99]
    v_permlane16_swap_b32 v28, v29
    v_max_f32 v28, v28, v29
    v_mfma_f32_16x16x32_bf16 v[96:99], v[132:135], a[88:91], v[96:99]
    v_mov_b32 v29, v28
    v_mfma_f32_16x16x32_bf16 v[96:99], v[136:139], a[112:115], v[96:99]
    v_mfma_f32_16x16x32_bf16 v[96:99], v[140:143], a[136:139], v[96:99]
    v_permlane32_swap_b32 v28, v29
    v_max_f32 v28, v28, v29
    v_mfma_f32_16x16x32_bf16 v[96:99], v[144:147], a[160:163], v[96:99]
    s_add_u32 s57, s58, s69
    v_cvt_pk_bf16_f32 v54, v116, v117
    v_mfma_f32_16x16x32_bf16 v[96:99], v[148:151], a[184:187], v[96:99]
    buffer_load_dwordx4 v3, s[24:27], s57 offen offset:1024 sc1 lds
    v_mfma_f32_16x16x32_bf16 v[96:99], v[152:155], a[208:211], v[96:99]
    v_cvt_pk_bf16_f32 v55, v118, v119
    v_cndmask_b32 v54, v54, 0, s[82:83]
    v_mfma_f32_16x16x32_bf16 v[96:99], v[156:159], a[232:235], v[96:99]
    v_cndmask_b32 v55, v55, 0, s[82:83]
    v_sub_f32 v26, v26, v28
    v_mfma_f32_16x16x32_bf16 v[96:99], v[160:163], v[176:179], v[96:99]
    v_sub_f32 v27, v27, v28
    v_mul_f32 v26, v11, v26
    v_mfma_f32_16x16x32_bf16 v[96:99], v[164:167], v[200:203], v[96:99]
    v_mul_f32 v27, v11, v27
    v_exp_f32 v26, v26
    v_mfma_f32_16x16x32_bf16 v[96:99], v[168:171], v[224:227], v[96:99]
    s_add_u32 s57, s58, s70
    v_exp_f32 v27, v27
    v_mfma_f32_16x16x32_bf16 v[96:99], v[172:175], v[248:251], v[96:99]
    buffer_load_dwordx4 v24, s[24:27], s57 offen offset:2048 sc1 lds
    v_mfma_f32_16x16x32_bf16 v[100:103], v[120:123], a[20:23], 0
    v_add_f32 v28, v26, v27
    v_mov_b32 v29, v28
    v_mfma_f32_16x16x32_bf16 v[100:103], v[124:127], a[44:47], v[100:103]
    v_mfma_f32_16x16x32_bf16 v[100:103], v[128:131], a[68:71], v[100:103]
    v_permlane16_swap_b32 v28, v29
    v_add_f32 v28, v28, v29
    v_mfma_f32_16x16x32_bf16 v[100:103], v[132:135], a[92:95], v[100:103]
    v_mov_b32 v29, v28
    v_mfma_f32_16x16x32_bf16 v[100:103], v[136:139], a[116:119], v[100:103]
    s_add_u32 s57, s58, s71
    v_mfma_f32_16x16x32_bf16 v[100:103], v[140:143], a[140:143], v[100:103]
    buffer_load_dwordx4 v3, s[24:27], s57 offen offset:3072 sc1 lds
    v_mfma_f32_16x16x32_bf16 v[100:103], v[144:147], a[164:167], v[100:103]
    v_cvt_pk_bf16_f32 v38, v96, v97
    v_cvt_pk_bf16_f32 v39, v98, v99
    v_mfma_f32_16x16x32_bf16 v[100:103], v[148:151], a[188:191], v[100:103]
    v_permlane32_swap_b32 v28, v29
    v_add_f32 v28, v28, v29
    v_mfma_f32_16x16x32_bf16 v[100:103], v[152:155], a[212:215], v[100:103]
    v_rcp_f32 v28, v28
    v_mfma_f32_16x16x32_bf16 v[100:103], v[156:159], a[236:239], v[100:103]
    v_mul_f32 v26, v26, v8
    v_mul_f32 v27, v27, v9
    v_mfma_f32_16x16x32_bf16 v[100:103], v[160:163], v[180:183], v[100:103]
    s_add_u32 m0, s52, 131072
    s_add_u32 s58, s72, 3584
    s_add_u32 s57, s58, s68
    v_mul_f32 v26, v26, v28
    v_mfma_f32_16x16x32_bf16 v[100:103], v[164:167], v[204:207], v[100:103]
    buffer_load_dwordx4 v3, s[24:27], s57 offen offset:0 sc1 lds
    v_mfma_f32_16x16x32_bf16 v[100:103], v[168:171], v[228:231], v[100:103]
    v_mul_f32 v27, v27, v28
    v_cvt_pk_bf16_f32 v26, v26, v26
    v_mfma_f32_16x16x32_bf16 v[100:103], v[172:175], v[252:255], v[100:103]
    v_cvt_pk_bf16_f32 v27, v27, v27
    v_and_b32 v80, v26, v14
    v_mfma_f32_16x16x32_bf16 v[104:107], a[0:3], v[120:123], 0
    v_and_b32 v81, v27, v15
    v_and_b32 v82, v26, v16
    v_mfma_f32_16x16x32_bf16 v[104:107], a[24:27], v[124:127], v[104:107]
    v_and_b32 v83, v27, v17
    v_mfma_f32_16x16x32_bf16 v[104:107], a[48:51], v[128:131], v[104:107]
    s_add_u32 s57, s58, s69
    v_mfma_f32_16x16x32_bf16 v[104:107], a[72:75], v[132:135], v[104:107]
    buffer_load_dwordx4 v3, s[24:27], s57 offen offset:1024 sc1 lds
    v_mfma_f32_16x16x32_bf16 v[104:107], a[96:99], v[136:139], v[104:107]
    v_mfma_f32_16x16x32_bf16 v[72:75], v[32:35], v[80:83], 0
    v_mfma_f32_16x16x32_bf16 v[104:107], a[120:123], v[140:143], v[104:107]
    v_mfma_f32_16x16x32_bf16 v[76:79], v[42:45], v[80:83], 0
L_wa_2:
    s_cbranch_execz L_wa_ret
    v_mfma_f32_16x16x32_bf16 v[104:107], a[144:147], v[144:147], v[104:107]
    v_cvt_pk_bf16_f32 v48, v100, v101
    v_cvt_pk_bf16_f32 v49, v102, v103
    v_mfma_f32_16x16x32_bf16 v[104:107], a[168:171], v[148:151], v[104:107]
    s_add_u32 s53, s74, 0
    v_mfma_f32_16x16x32_bf16 v[104:107], a[192:195], v[152:155], v[104:107]
    s_add_u32 s57, s58, s70
    v_mfma_f32_16x16x32_bf16 v[104:107], a[216:219], v[156:159], v[104:107]
    buffer_load_dwordx4 v24, s[24:27], s57 offen offset:2048 sc1 lds
    v_mfma_f32_16x16x32_bf16 v[104:107], a[240:243], v[160:163], v[104:107]
    v_mfma_f32_16x16x32_bf16 v[104:107], v[184:187], v[164:167], v[104:107]
    v_mfma_f32_16x16x32_bf16 v[104:107], v[208:211], v[168:171], v[104:107]
    v_cvt_pk_bf16_f32 v84, v72, v73
    v_cvt_pk_bf16_f32 v85, v74, v75
    v_mfma_f32_16x16x32_bf16 v[104:107], v[232:235], v[172:175], v[104:107]
    v_cvt_pk_bf16_f32 v86, v76, v77
    v_cvt_pk_bf16_f32 v87, v78, v79
    s_waitcnt vmcnt(7)
    s_barrier
    v_mfma_f32_16x16x32_bf16 v[108:111], a[4:7], v[120:123], 0
    v_add_u32 v4, 65536, v4
    v_add_u32 v25, 65536, v25
    ds_read_b64_tr_b16 v[120:121], v4 offset:0
    ds_read_b64_tr_b16 v[122:123], v25 offset:0
    s_add_u32 s57, s58, s71
    v_mfma_f32_16x16x32_bf16 v[108:111], a[28:31], v[124:127], v[108:111]
    buffer_load_dwordx4 v3, s[24:27], s57 offen offset:3072 sc1 lds
    v_mfma_f32_16x16x32_bf16 v[108:111], a[52:55], v[128:131], v[108:111]
    ds_read_b64_tr_b16 v[124:125], v4 offset:1024
    ds_read_b64_tr_b16 v[126:127], v25 offset:1024
    v_mfma_f32_16x16x32_bf16 v[108:111], a[76:79], v[132:135], v[108:111]
    ds_read_b64_tr_b16 v[128:129], v4 offset:2048
    ds_read_b64_tr_b16 v[130:131], v25 offset:2048
    v_mfma_f32_16x16x32_bf16 v[108:111], a[100:103], v[136:139], v[108:111]
    ds_read_b64_tr_b16 v[132:133], v4 offset:3072
    v_lshlrev_b32 v13, 4, v1
    v_mfma_f32_16x16x32_bf16 v[108:111], a[124:127], v[140:143], v[108:111]
    ds_read_b64_tr_b16 v[134:135], v25 offset:3072
    ds_read_b64_tr_b16 v[136:137], v4 offset:4096
    v_mfma_f32_16x16x32_bf16 v[108:111], a[148:151], v[144:147], v[108:111]
    ds_read_b64_tr_b16 v[138:139], v25 offset:4096
    s_add_u32 s57, s73, 0
    v_mfma_f32_16x16x32_bf16 v[108:111], a[172:175], v[148:151], v[108:111]
    buffer_load_dword v22, v5, s[20:23], s57 offen
    v_mfma_f32_16x16x32_bf16 v[108:111], a[196:199], v[152:155], v[108:111]
    ds_read_b64_tr_b16 v[140:141], v4 offset:5120
    ds_read_b64_tr_b16 v[142:143], v25 offset:5120
    v_mfma_f32_16x16x32_bf16 v[108:111], a[220:223], v[156:159], v[108:111]
    ds_read_b64_tr_b16 v[144:145], v4 offset:6144
    ds_read_b64_tr_b16 v[146:147], v25 offset:6144
    v_mfma_f32_16x16x32_bf16 v[108:111], a[244:247], v[160:163], v[108:111]
    ds_read_b64_tr_b16 v[148:149], v4 offset:7168
    ds_read_b64_tr_b16 v[150:151], v25 offset:7168
    v_mfma_f32_16x16x32_bf16 v[108:111], v[188:191], v[164:167], v[108:111]
    ds_read_b64_tr_b16 v[152:153], v4 offset:8192
    v_cvt_pk_bf16_f32 v68, v104, v105
    v_mfma_f32_16x16x32_bf16 v[108:111], v[212:215], v[168:171], v[108:111]
    ds_read_b64_tr_b16 v[154:155], v25 offset:8192
    ds_read_b64_tr_b16 v[156:157], v4 offset:9216
    s_add_u32 s57, s73, 524288
    v_mfma_f32_16x16x32_bf16 v[108:111], v[236:239], v[172:175], v[108:111]
    buffer_load_dword v22, v5, s[20:23], s57 offen
    s_waitcnt lgkmcnt(15)
    v_mfma_f32_16x16x32_bf16 v[112:115], a[8:11], v[120:123], 0
    ds_read_b64_tr_b16 v[158:159], v25 offset:9216
    ds_read_b64_tr_b16 v[160:161], v4 offset:10240
    v_mfma_f32_16x16x32_bf16 v[112:115], a[32:35], v[124:127], v[112:115]
    ds_read_b64_tr_b16 v[162:163], v25 offset:10240
    ds_read_b64_tr_b16 v[164:165], v4 offset:11264
    s_waitcnt lgkmcnt(15)
    v_mfma_f32_16x16x32_bf16 v[112:115], a[56:59], v[128:131], v[112:115]
    ds_read_b64_tr_b16 v[166:167], v25 offset:11264
    v_cvt_pk_bf16_f32 v69, v106, v107
    v_mfma_f32_16x16x32_bf16 v[112:115], a[80:83], v[132:135], v[112:115]
    ds_read_b64_tr_b16 v[168:169], v4 offset:12288
    v_add_u32 v12, s90, v13
    s_waitcnt lgkmcnt(13)
    v_mfma_f32_16x16x32_bf16 v[112:115], a[104:107], v[136:139], v[112:115]
    ds_read_b64_tr_b16 v[170:171], v25 offset:12288
    ds_read_b64_tr_b16 v[172:173], v4 offset:13312
    s_add_u32 s57, s75, 0
    v_mfma_f32_16x16x32_bf16 v[112:115], a[128:131], v[140:143], v[112:115]
    buffer_load_dword v22, v20, s[12:15], s57 offen
    s_waitcnt lgkmcnt(11)
    v_mfma_f32_16x16x32_bf16 v[112:115], a[152:155], v[144:147], v[112:115]
    ds_read_b64_tr_b16 v[174:175], v25 offset:13312
    v_cvt_pk_bf16_f32 v70, v108, v109
    v_mfma_f32_16x16x32_bf16 v[112:115], a[176:179], v[148:151], v[112:115]
    v_cvt_pk_bf16_f32 v71, v110, v111
    v_cndmask_b32 v70, v70, 0, s[82:83]
    s_waitcnt lgkmcnt(8)
    v_mfma_f32_16x16x32_bf16 v[112:115], a[200:203], v[152:155], v[112:115]
    v_cndmask_b32 v71, v71, 0, s[82:83]
    v_add_u32 v12, 155648, v12
    v_mfma_f32_16x16x32_bf16 v[112:115], a[224:227], v[156:159], v[112:115]
    v_add_u32 v13, s52, v13
    ds_write_b128 v12, v[84:87] offset:0
    s_waitcnt lgkmcnt(5)
    v_mfma_f32_16x16x32_bf16 v[112:115], a[248:251], v[160:163], v[112:115]
    s_add_u32 s57, s75, 262144
    v_cndmask_b32 v80, v84, v86, s[88:89]
    v_mfma_f32_16x16x32_bf16 v[112:115], v[192:195], v[164:167], v[112:115]
    buffer_load_dword v22, v20, s[12:15], s57 offen
    s_waitcnt lgkmcnt(1)
    v_mfma_f32_16x16x32_bf16 v[112:115], v[216:219], v[168:171], v[112:115]
    v_cndmask_b32 v81, v85, v87, s[88:89]
    ds_write_b64 v95, v[80:81] offset:0
    v_mfma_f32_16x16x32_bf16 v[112:115], v[240:243], v[172:175], v[112:115]
    v_mfma_f32_16x16x32_bf16 v[116:119], a[12:15], v[120:123], 0
    v_mfma_f32_16x16x32_bf16 v[72:75], v[56:59], v[64:67], 0
    v_mfma_f32_16x16x32_bf16 v[116:119], a[36:39], v[124:127], v[116:119]
    v_mfma_f32_16x16x32_bf16 v[76:79], v[60:63], v[64:67], 0
    v_mfma_f32_16x16x32_bf16 v[116:119], a[60:63], v[128:131], v[116:119]
    ds_read_u16_d16_hi v8, v93 offset:16384
    ds_read_u16_d16_hi v9, v94 offset:16384
    v_mfma_f32_16x16x32_bf16 v[116:119], a[84:87], v[132:135], v[116:119]
    ds_read_u16_d16_hi v10, v92 offset:16384
    v_mfma_f32_16x16x32_bf16 v[116:119], a[108:111], v[136:139], v[116:119]
    v_mfma_f32_16x16x32_bf16 v[116:119], a[132:135], v[140:143], v[116:119]
    v_mfma_f32_16x16x32_bf16 v[116:119], a[156:159], v[144:147], v[116:119]
    v_cvt_pk_bf16_f32 v56, v112, v113
    v_cvt_pk_bf16_f32 v57, v114, v115
    v_mfma_f32_16x16x32_bf16 v[116:119], a[180:183], v[148:151], v[116:119]
    v_cndmask_b32 v26, v72, v73, s[76:77]
    v_cndmask_b32 v27, v74, v75, s[76:77]
    v_mfma_f32_16x16x32_bf16 v[116:119], a[204:207], v[152:155], v[116:119]
    v_cndmask_b32 v28, v76, v77, s[76:77]
    v_cndmask_b32 v29, v78, v79, s[76:77]
    v_mfma_f32_16x16x32_bf16 v[116:119], a[228:231], v[156:159], v[116:119]
    v_cndmask_b32 v26, v26, v28, s[78:79]
    v_cndmask_b32 v27, v27, v29, s[80:81]
    v_mfma_f32_16x16x32_bf16 v[116:119], a[252:255], v[160:163], v[116:119]
    s_waitcnt lgkmcnt(0)
    v_mul_f32 v26, v26, v8
    v_mfma_f32_16x16x32_bf16 v[116:119], v[196:199], v[164:167], v[116:119]
    v_mul_f32 v27, v27, v9
    v_mul_f32 v11, s91, v10
    v_mfma_f32_16x16x32_bf16 v[116:119], v[220:223], v[168:171], v[116:119]
    v_max_f32 v28, v26, v27
    v_mov_b32 v29, v28
    v_mfma_f32_16x16x32_bf16 v[116:119], v[244:247], v[172:175], v[116:119]
    v_mfma_f32_16x16x32_bf16 v[96:99], v[120:123], a[16:19], 0
    v_permlane16_swap_b32 v28, v29
    v_max_f32 v28, v28, v29
    v_mfma_f32_16x16x32_bf16 v[96:99], v[124:127], a[40:43], v[96:99]
    v_mov_b32 v29, v28
    v_mfma_f32_16x16x32_bf16 v[96:99], v[128:131], a[64:67], v[96:99]
    v_mfma_f32_16x16x32_bf16 v[96:99], v[132:135], a[88:91], v[96:99]
    v_permlane32_swap_b32 v28, v29
    v_max_f32 v28, v28, v29
    v_mfma_f32_16x16x32_bf16 v[96:99], v[136:139], a[112:115], v[96:99]
    v_sub_f32 v26, v26, v28
    v_sub_f32 v27, v27, v28
    v_mfma_f32_16x16x32_bf16 v[96:99], v[140:143], a[136:139], v[96:99]
    v_mul_f32 v26, v11, v26
    v_mul_f32 v27, v11, v27
    v_mfma_f32_16x16x32_bf16 v[96:99], v[144:147], a[160:163], v[96:99]
    v_cvt_pk_bf16_f32 v58, v116, v117
    v_cvt_pk_bf16_f32 v59, v118, v119
    v_mfma_f32_16x16x32_bf16 v[96:99], v[148:151], a[184:187], v[96:99]
    v_cndmask_b32 v58, v58, 0, s[82:83]
    v_cndmask_b32 v59, v59, 0, s[82:83]
    v_mfma_f32_16x16x32_bf16 v[96:99], v[152:155], a[208:211], v[96:99]
    v_exp_f32 v26, v26
    v_mfma_f32_16x16x32_bf16 v[96:99], v[156:159], a[232:235], v[96:99]
    v_exp_f32 v27, v27
    v_mfma_f32_16x16x32_bf16 v[96:99], v[160:163], v[176:179], v[96:99]
    v_add_f32 v28, v26, v27
    v_mov_b32 v29, v28
    v_mfma_f32_16x16x32_bf16 v[96:99], v[164:167], v[200:203], v[96:99]
    v_mfma_f32_16x16x32_bf16 v[96:99], v[168:171], v[224:227], v[96:99]
    v_permlane16_swap_b32 v28, v29
    v_add_f32 v28, v28, v29
    v_mfma_f32_16x16x32_bf16 v[96:99], v[172:175], v[248:251], v[96:99]
    v_mov_b32 v29, v28
    v_mfma_f32_16x16x32_bf16 v[100:103], v[120:123], a[20:23], 0
    v_mfma_f32_16x16x32_bf16 v[100:103], v[124:127], a[44:47], v[100:103]
    v_permlane32_swap_b32 v28, v29
    v_add_f32 v28, v28, v29
    v_mfma_f32_16x16x32_bf16 v[100:103], v[128:131], a[68:71], v[100:103]
    v_rcp_f32 v28, v28
    v_mfma_f32_16x16x32_bf16 v[100:103], v[132:135], a[92:95], v[100:103]
    v_mul_f32 v26, v26, v8
    v_mul_f32 v27, v27, v9
    v_mfma_f32_16x16x32_bf16 v[100:103], v[136:139], a[116:119], v[100:103]
    v_mul_f32 v26, v26, v28
    v_mul_f32 v27, v27, v28
    v_mfma_f32_16x16x32_bf16 v[100:103], v[140:143], a[140:143], v[100:103]
    v_cvt_pk_bf16_f32 v26, v26, v26
    v_cvt_pk_bf16_f32 v27, v27, v27
    v_mfma_f32_16x16x32_bf16 v[100:103], v[144:147], a[164:167], v[100:103]
    v_cvt_pk_bf16_f32 v40, v96, v97
    v_cvt_pk_bf16_f32 v41, v98, v99
    v_mfma_f32_16x16x32_bf16 v[100:103], v[148:151], a[188:191], v[100:103]
    v_cvt_pk_bf16_f32 v32, v96, v97
    v_cvt_pk_bf16_f32 v33, v98, v99
    v_mfma_f32_16x16x32_bf16 v[100:103], v[152:155], a[212:215], v[100:103]
    v_and_b32 v80, v26, v14
    v_and_b32 v81, v27, v15
    v_mfma_f32_16x16x32_bf16 v[100:103], v[156:159], a[236:239], v[100:103]
    v_and_b32 v82, v26, v16
    v_and_b32 v83, v27, v17
    v_mfma_f32_16x16x32_bf16 v[100:103], v[160:163], v[180:183], v[100:103]
    v_mfma_f32_16x16x32_bf16 v[100:103], v[164:167], v[204:207], v[100:103]
    v_mfma_f32_16x16x32_bf16 v[72:75], v[34:37], v[80:83], 0
    v_mfma_f32_16x16x32_bf16 v[100:103], v[168:171], v[228:231], v[100:103]
    v_mfma_f32_16x16x32_bf16 v[76:79], v[44:47], v[80:83], 0
    v_mfma_f32_16x16x32_bf16 v[100:103], v[172:175], v[252:255], v[100:103]
    s_add_u32 s53, s74, 16384
    v_mfma_f32_16x16x32_bf16 v[104:107], a[0:3], v[120:123], 0
    v_mfma_f32_16x16x32_bf16 v[104:107], a[24:27], v[124:127], v[104:107]
    v_mfma_f32_16x16x32_bf16 v[104:107], a[48:51], v[128:131], v[104:107]
    v_mfma_f32_16x16x32_bf16 v[104:107], a[72:75], v[132:135], v[104:107]
    v_mfma_f32_16x16x32_bf16 v[104:107], a[96:99], v[136:139], v[104:107]
    v_cvt_pk_bf16_f32 v84, v72, v73
    v_cvt_pk_bf16_f32 v85, v74, v75
    v_mfma_f32_16x16x32_bf16 v[104:107], a[120:123], v[140:143], v[104:107]
    v_cvt_pk_bf16_f32 v86, v76, v77
    v_cvt_pk_bf16_f32 v87, v78, v79
    v_mfma_f32_16x16x32_bf16 v[104:107], a[144:147], v[144:147], v[104:107]
    v_cvt_pk_bf16_f32 v50, v100, v101
    v_cvt_pk_bf16_f32 v51, v102, v103
    v_mfma_f32_16x16x32_bf16 v[104:107], a[168:171], v[148:151], v[104:107]
    v_cvt_pk_bf16_f32 v42, v100, v101
    v_cvt_pk_bf16_f32 v43, v102, v103
    v_mfma_f32_16x16x32_bf16 v[104:107], a[192:195], v[152:155], v[104:107]
    ds_write_b128 v12, v[84:87] offset:1024
    v_cndmask_b32 v80, v84, v86, s[88:89]
    v_mfma_f32_16x16x32_bf16 v[104:107], a[216:219], v[156:159], v[104:107]
    v_cndmask_b32 v81, v85, v87, s[88:89]
    ds_write_b64 v95, v[80:81] offset:256
    v_mfma_f32_16x16x32_bf16 v[104:107], a[240:243], v[160:163], v[104:107]
    v_mfma_f32_16x16x32_bf16 v[104:107], v[184:187], v[164:167], v[104:107]
    v_mfma_f32_16x16x32_bf16 v[72:75], v[60:63], v[68:71], 0
    v_mfma_f32_16x16x32_bf16 v[104:107], v[208:211], v[168:171], v[104:107]
    v_mfma_f32_16x16x32_bf16 v[76:79], v[52:55], v[68:71], 0
    v_mfma_f32_16x16x32_bf16 v[104:107], v[232:235], v[172:175], v[104:107]
    ds_read_u16_d16_hi v8, v93 offset:32768
    ds_read_u16_d16_hi v9, v94 offset:32768
    v_mfma_f32_16x16x32_bf16 v[108:111], a[4:7], v[120:123], 0
    ds_read_b64_tr_b16 v[120:121], v4 offset:16384
    ds_read_b64_tr_b16 v[122:123], v25 offset:16384
    v_mfma_f32_16x16x32_bf16 v[108:111], a[28:31], v[124:127], v[108:111]
    ds_read_b64_tr_b16 v[124:125], v4 offset:17408
    ds_read_u16_d16_hi v10, v92 offset:32768
    v_mfma_f32_16x16x32_bf16 v[108:111], a[52:55], v[128:131], v[108:111]
    ds_read_b64_tr_b16 v[126:127], v25 offset:17408
    ds_read_b64_tr_b16 v[128:129], v4 offset:18432
    v_mfma_f32_16x16x32_bf16 v[108:111], a[76:79], v[132:135], v[108:111]
    ds_read_b64_tr_b16 v[130:131], v25 offset:18432
    v_mfma_f32_16x16x32_bf16 v[108:111], a[100:103], v[136:139], v[108:111]
    ds_read_b64_tr_b16 v[132:133], v4 offset:19456
    v_mfma_f32_16x16x32_bf16 v[108:111], a[124:127], v[140:143], v[108:111]
    ds_read_b64_tr_b16 v[134:135], v25 offset:19456
    ds_read_b64_tr_b16 v[136:137], v4 offset:20480
    v_mfma_f32_16x16x32_bf16 v[108:111], a[148:151], v[144:147], v[108:111]
    ds_read_b64_tr_b16 v[138:139], v25 offset:20480
    v_cvt_pk_bf16_f32 v64, v104, v105
    v_mfma_f32_16x16x32_bf16 v[108:111], a[172:175], v[148:151], v[108:111]
    ds_read_b64_tr_b16 v[140:141], v4 offset:21504
    ds_read_b64_tr_b16 v[142:143], v25 offset:21504
    v_mfma_f32_16x16x32_bf16 v[108:111], a[196:199], v[152:155], v[108:111]
    ds_read_b64_tr_b16 v[144:145], v4 offset:22528
    v_cvt_pk_bf16_f32 v65, v106, v107
    v_mfma_f32_16x16x32_bf16 v[108:111], a[220:223], v[156:159], v[108:111]
    ds_read_b64_tr_b16 v[146:147], v25 offset:22528
    v_cndmask_b32 v26, v72, v73, s[76:77]
    v_mfma_f32_16x16x32_bf16 v[108:111], a[244:247], v[160:163], v[108:111]
    ds_read_b64_tr_b16 v[148:149], v4 offset:23552
    ds_read_b64_tr_b16 v[150:151], v25 offset:23552
    v_mfma_f32_16x16x32_bf16 v[108:111], v[188:191], v[164:167], v[108:111]
    ds_read_b64_tr_b16 v[152:153], v4 offset:24576
    v_cndmask_b32 v27, v74, v75, s[76:77]
    v_mfma_f32_16x16x32_bf16 v[108:111], v[212:215], v[168:171], v[108:111]
    ds_read_b64_tr_b16 v[154:155], v25 offset:24576
    ds_read_b64_tr_b16 v[156:157], v4 offset:25600
    v_mfma_f32_16x16x32_bf16 v[108:111], v[236:239], v[172:175], v[108:111]
    ds_read_b64_tr_b16 v[158:159], v25 offset:25600
    v_cndmask_b32 v28, v76, v77, s[76:77]
    s_waitcnt lgkmcnt(15)
    v_mfma_f32_16x16x32_bf16 v[112:115], a[8:11], v[120:123], 0
    ds_read_b64_tr_b16 v[160:161], v4 offset:26624
    v_cndmask_b32 v29, v78, v79, s[76:77]
    v_mfma_f32_16x16x32_bf16 v[112:115], a[32:35], v[124:127], v[112:115]
    ds_read_b64_tr_b16 v[162:163], v25 offset:26624
    ds_read_b64_tr_b16 v[164:165], v4 offset:27648
    s_waitcnt lgkmcnt(15)
    v_mfma_f32_16x16x32_bf16 v[112:115], a[56:59], v[128:131], v[112:115]
    ds_read_b64_tr_b16 v[166:167], v25 offset:27648
    v_cndmask_b32 v26, v26, v28, s[78:79]
    v_mfma_f32_16x16x32_bf16 v[112:115], a[80:83], v[132:135], v[112:115]
    ds_read_b64_tr_b16 v[168:169], v4 offset:28672
    v_cndmask_b32 v27, v27, v29, s[80:81]
    s_waitcnt lgkmcnt(13)
    v_mfma_f32_16x16x32_bf16 v[112:115], a[104:107], v[136:139], v[112:115]
    ds_read_b64_tr_b16 v[170:171], v25 offset:28672
    ds_read_b64_tr_b16 v[172:173], v4 offset:29696
    v_mfma_f32_16x16x32_bf16 v[112:115], a[128:131], v[140:143], v[112:115]
    ds_read_b64_tr_b16 v[174:175], v25 offset:29696
    s_waitcnt lgkmcnt(12)
    v_mfma_f32_16x16x32_bf16 v[112:115], a[152:155], v[144:147], v[112:115]
    v_cvt_pk_bf16_f32 v66, v108, v109
    v_cvt_pk_bf16_f32 v67, v110, v111
    v_mfma_f32_16x16x32_bf16 v[112:115], a[176:179], v[148:151], v[112:115]
    v_cndmask_b32 v66, v66, 0, s[82:83]
    v_cndmask_b32 v67, v67, 0, s[82:83]
    s_waitcnt lgkmcnt(8)
    v_mfma_f32_16x16x32_bf16 v[112:115], a[200:203], v[152:155], v[112:115]
    v_mul_f32 v26, v26, v8
    v_mul_f32 v27, v27, v9
    v_mfma_f32_16x16x32_bf16 v[112:115], a[224:227], v[156:159], v[112:115]
    v_mul_f32 v11, s91, v10
    v_max_f32 v28, v26, v27
    s_waitcnt lgkmcnt(4)
    v_mfma_f32_16x16x32_bf16 v[112:115], a[248:251], v[160:163], v[112:115]
    v_mov_b32 v29, v28
    v_mfma_f32_16x16x32_bf16 v[112:115], v[192:195], v[164:167], v[112:115]
    s_waitcnt lgkmcnt(0)
    v_mfma_f32_16x16x32_bf16 v[112:115], v[216:219], v[168:171], v[112:115]
    v_permlane16_swap_b32 v28, v29
    v_max_f32 v28, v28, v29
    v_mfma_f32_16x16x32_bf16 v[112:115], v[240:243], v[172:175], v[112:115]
    v_mov_b32 v29, v28
    v_mfma_f32_16x16x32_bf16 v[116:119], a[12:15], v[120:123], 0
    v_mfma_f32_16x16x32_bf16 v[116:119], a[36:39], v[124:127], v[116:119]
    v_permlane32_swap_b32 v28, v29
    v_max_f32 v28, v28, v29
    v_mfma_f32_16x16x32_bf16 v[116:119], a[60:63], v[128:131], v[116:119]
    v_sub_f32 v26, v26, v28
    v_sub_f32 v27, v27, v28
    v_mfma_f32_16x16x32_bf16 v[116:119], a[84:87], v[132:135], v[116:119]
    v_mul_f32 v26, v11, v26
    v_mul_f32 v27, v11, v27
    v_mfma_f32_16x16x32_bf16 v[116:119], a[108:111], v[136:139], v[116:119]
    v_exp_f32 v26, v26
    v_mfma_f32_16x16x32_bf16 v[116:119], a[132:135], v[140:143], v[116:119]
    v_exp_f32 v27, v27
    v_mfma_f32_16x16x32_bf16 v[116:119], a[156:159], v[144:147], v[116:119]
    v_cvt_pk_bf16_f32 v60, v112, v113
    v_cvt_pk_bf16_f32 v61, v114, v115
    v_mfma_f32_16x16x32_bf16 v[116:119], a[180:183], v[148:151], v[116:119]
    v_add_f32 v28, v26, v27
    v_mov_b32 v29, v28
    v_mfma_f32_16x16x32_bf16 v[116:119], a[204:207], v[152:155], v[116:119]
    v_mfma_f32_16x16x32_bf16 v[116:119], a[228:231], v[156:159], v[116:119]
    v_permlane16_swap_b32 v28, v29
    v_add_f32 v28, v28, v29
    v_mfma_f32_16x16x32_bf16 v[116:119], a[252:255], v[160:163], v[116:119]
    v_mov_b32 v29, v28
    v_mfma_f32_16x16x32_bf16 v[116:119], v[196:199], v[164:167], v[116:119]
    v_mfma_f32_16x16x32_bf16 v[116:119], v[220:223], v[168:171], v[116:119]
    v_permlane32_swap_b32 v28, v29
    v_add_f32 v28, v28, v29
    v_mfma_f32_16x16x32_bf16 v[116:119], v[244:247], v[172:175], v[116:119]
    v_rcp_f32 v28, v28
    v_mfma_f32_16x16x32_bf16 v[96:99], v[120:123], a[16:19], 0
    v_mul_f32 v26, v26, v8
    v_mul_f32 v27, v27, v9
    v_mfma_f32_16x16x32_bf16 v[96:99], v[124:127], a[40:43], v[96:99]
    v_mul_f32 v26, v26, v28
    v_mul_f32 v27, v27, v28
    v_mfma_f32_16x16x32_bf16 v[96:99], v[128:131], a[64:67], v[96:99]
    v_cvt_pk_bf16_f32 v26, v26, v26
    v_cvt_pk_bf16_f32 v27, v27, v27
    v_mfma_f32_16x16x32_bf16 v[96:99], v[132:135], a[88:91], v[96:99]
    v_and_b32 v80, v26, v14
    v_and_b32 v81, v27, v15
    v_mfma_f32_16x16x32_bf16 v[96:99], v[136:139], a[112:115], v[96:99]
    v_and_b32 v82, v26, v16
    v_and_b32 v83, v27, v17
    v_mfma_f32_16x16x32_bf16 v[96:99], v[140:143], a[136:139], v[96:99]
    v_mfma_f32_16x16x32_bf16 v[96:99], v[144:147], a[160:163], v[96:99]
    v_cvt_pk_bf16_f32 v62, v116, v117
    v_cvt_pk_bf16_f32 v63, v118, v119
    v_mfma_f32_16x16x32_bf16 v[96:99], v[148:151], a[184:187], v[96:99]
    v_cndmask_b32 v62, v62, 0, s[82:83]
    v_cndmask_b32 v63, v63, 0, s[82:83]
    v_mfma_f32_16x16x32_bf16 v[96:99], v[152:155], a[208:211], v[96:99]
    v_mfma_f32_16x16x32_bf16 v[72:75], v[36:39], v[80:83], 0
    v_mfma_f32_16x16x32_bf16 v[96:99], v[156:159], a[232:235], v[96:99]
    v_mfma_f32_16x16x32_bf16 v[76:79], v[46:49], v[80:83], 0
    v_mfma_f32_16x16x32_bf16 v[96:99], v[160:163], v[176:179], v[96:99]
    s_add_u32 s53, s74, 32768
    v_mfma_f32_16x16x32_bf16 v[96:99], v[164:167], v[200:203], v[96:99]
    v_mfma_f32_16x16x32_bf16 v[96:99], v[168:171], v[224:227], v[96:99]
    v_mfma_f32_16x16x32_bf16 v[96:99], v[172:175], v[248:251], v[96:99]
    v_mfma_f32_16x16x32_bf16 v[100:103], v[120:123], a[20:23], 0
    v_mfma_f32_16x16x32_bf16 v[100:103], v[124:127], a[44:47], v[100:103]
    v_cvt_pk_bf16_f32 v84, v72, v73
    v_cvt_pk_bf16_f32 v85, v74, v75
    v_mfma_f32_16x16x32_bf16 v[100:103], v[128:131], a[68:71], v[100:103]
    v_cvt_pk_bf16_f32 v86, v76, v77
    v_cvt_pk_bf16_f32 v87, v78, v79
    v_mfma_f32_16x16x32_bf16 v[100:103], v[132:135], a[92:95], v[100:103]
    ds_write_b128 v13, v[84:87] offset:0
    v_mfma_f32_16x16x32_bf16 v[100:103], v[136:139], a[116:119], v[100:103]
    v_cndmask_b32 v80, v84, v86, s[88:89]
    v_cndmask_b32 v81, v85, v87, s[88:89]
    v_mfma_f32_16x16x32_bf16 v[100:103], v[140:143], a[140:143], v[100:103]
    ds_write_b64 v95, v[80:81] offset:512
    v_mfma_f32_16x16x32_bf16 v[100:103], v[144:147], a[164:167], v[100:103]
    v_cvt_pk_bf16_f32 v34, v96, v97
    v_cvt_pk_bf16_f32 v35, v98, v99
    v_mfma_f32_16x16x32_bf16 v[100:103], v[148:151], a[188:191], v[100:103]
    v_mfma_f32_16x16x32_bf16 v[72:75], v[52:55], v[64:67], 0
    v_mfma_f32_16x16x32_bf16 v[100:103], v[152:155], a[212:215], v[100:103]
    v_mfma_f32_16x16x32_bf16 v[76:79], v[56:59], v[64:67], 0
    v_mfma_f32_16x16x32_bf16 v[100:103], v[156:159], a[236:239], v[100:103]
    ds_read_u16_d16_hi v8, v93 offset:49152
    ds_read_u16_d16_hi v9, v94 offset:49152
    v_mfma_f32_16x16x32_bf16 v[100:103], v[160:163], v[180:183], v[100:103]
    ds_read_u16_d16_hi v10, v92 offset:49152
    v_mfma_f32_16x16x32_bf16 v[100:103], v[164:167], v[204:207], v[100:103]
    v_mfma_f32_16x16x32_bf16 v[100:103], v[168:171], v[228:231], v[100:103]
    v_mfma_f32_16x16x32_bf16 v[100:103], v[172:175], v[252:255], v[100:103]
    v_mfma_f32_16x16x32_bf16 v[104:107], a[0:3], v[120:123], 0
    v_cndmask_b32 v26, v72, v73, s[76:77]
    v_cndmask_b32 v27, v74, v75, s[76:77]
    v_mfma_f32_16x16x32_bf16 v[104:107], a[24:27], v[124:127], v[104:107]
    v_cndmask_b32 v28, v76, v77, s[76:77]
    v_cndmask_b32 v29, v78, v79, s[76:77]
    v_mfma_f32_16x16x32_bf16 v[104:107], a[48:51], v[128:131], v[104:107]
    v_cndmask_b32 v26, v26, v28, s[78:79]
    v_cndmask_b32 v27, v27, v29, s[80:81]
    v_mfma_f32_16x16x32_bf16 v[104:107], a[72:75], v[132:135], v[104:107]
    s_waitcnt lgkmcnt(0)
    v_mul_f32 v26, v26, v8
    v_mfma_f32_16x16x32_bf16 v[104:107], a[96:99], v[136:139], v[104:107]
    v_mul_f32 v27, v27, v9
    v_mul_f32 v11, s91, v10
    v_mfma_f32_16x16x32_bf16 v[104:107], a[120:123], v[140:143], v[104:107]
    v_max_f32 v28, v26, v27
    v_mov_b32 v29, v28
    v_mfma_f32_16x16x32_bf16 v[104:107], a[144:147], v[144:147], v[104:107]
    v_cvt_pk_bf16_f32 v44, v100, v101
    v_cvt_pk_bf16_f32 v45, v102, v103
    v_mfma_f32_16x16x32_bf16 v[104:107], a[168:171], v[148:151], v[104:107]
    v_permlane16_swap_b32 v28, v29
    v_max_f32 v28, v28, v29
    v_mfma_f32_16x16x32_bf16 v[104:107], a[192:195], v[152:155], v[104:107]
    v_mov_b32 v29, v28
    v_mfma_f32_16x16x32_bf16 v[104:107], a[216:219], v[156:159], v[104:107]
    v_mfma_f32_16x16x32_bf16 v[104:107], a[240:243], v[160:163], v[104:107]
    v_permlane32_swap_b32 v28, v29
    v_max_f32 v28, v28, v29
    v_mfma_f32_16x16x32_bf16 v[104:107], v[184:187], v[164:167], v[104:107]
    v_sub_f32 v26, v26, v28
    v_sub_f32 v27, v27, v28
    v_mfma_f32_16x16x32_bf16 v[104:107], v[208:211], v[168:171], v[104:107]
    v_mul_f32 v26, v11, v26
    v_mul_f32 v27, v11, v27
    v_mfma_f32_16x16x32_bf16 v[104:107], v[232:235], v[172:175], v[104:107]
    v_exp_f32 v26, v26
    v_mfma_f32_16x16x32_bf16 v[108:111], a[4:7], v[120:123], 0
    ds_read_b64_tr_b16 v[120:121], v4 offset:32768
    ds_read_b64_tr_b16 v[122:123], v25 offset:32768
    v_mfma_f32_16x16x32_bf16 v[108:111], a[28:31], v[124:127], v[108:111]
    ds_read_b64_tr_b16 v[124:125], v4 offset:33792
    v_exp_f32 v27, v27
    v_mfma_f32_16x16x32_bf16 v[108:111], a[52:55], v[128:131], v[108:111]
    ds_read_b64_tr_b16 v[126:127], v25 offset:33792
    ds_read_b64_tr_b16 v[128:129], v4 offset:34816
    v_mfma_f32_16x16x32_bf16 v[108:111], a[76:79], v[132:135], v[108:111]
    ds_read_b64_tr_b16 v[130:131], v25 offset:34816
    v_add_f32 v28, v26, v27
    v_mfma_f32_16x16x32_bf16 v[108:111], a[100:103], v[136:139], v[108:111]
    ds_read_b64_tr_b16 v[132:133], v4 offset:35840
    v_mov_b32 v29, v28
    v_mfma_f32_16x16x32_bf16 v[108:111], a[124:127], v[140:143], v[108:111]
    ds_read_b64_tr_b16 v[134:135], v25 offset:35840
    ds_read_b64_tr_b16 v[136:137], v4 offset:36864
    v_mfma_f32_16x16x32_bf16 v[108:111], a[148:151], v[144:147], v[108:111]
    ds_read_b64_tr_b16 v[138:139], v25 offset:36864
    v_cvt_pk_bf16_f32 v68, v104, v105
    v_mfma_f32_16x16x32_bf16 v[108:111], a[172:175], v[148:151], v[108:111]
    ds_read_b64_tr_b16 v[140:141], v4 offset:37888
    ds_read_b64_tr_b16 v[142:143], v25 offset:37888
    v_mfma_f32_16x16x32_bf16 v[108:111], a[196:199], v[152:155], v[108:111]
    ds_read_b64_tr_b16 v[144:145], v4 offset:38912
    v_cvt_pk_bf16_f32 v69, v106, v107
    v_mfma_f32_16x16x32_bf16 v[108:111], a[220:223], v[156:159], v[108:111]
    ds_read_b64_tr_b16 v[146:147], v25 offset:38912
    v_permlane16_swap_b32 v28, v29
    v_mfma_f32_16x16x32_bf16 v[108:111], a[244:247], v[160:163], v[108:111]
    ds_read_b64_tr_b16 v[148:149], v4 offset:39936
    ds_read_b64_tr_b16 v[150:151], v25 offset:39936
    v_mfma_f32_16x16x32_bf16 v[108:111], v[188:191], v[164:167], v[108:111]
    ds_read_b64_tr_b16 v[152:153], v4 offset:40960
    v_add_f32 v28, v28, v29
    v_mfma_f32_16x16x32_bf16 v[108:111], v[212:215], v[168:171], v[108:111]
    ds_read_b64_tr_b16 v[154:155], v25 offset:40960
    ds_read_b64_tr_b16 v[156:157], v4 offset:41984
    v_mfma_f32_16x16x32_bf16 v[108:111], v[236:239], v[172:175], v[108:111]
    ds_read_b64_tr_b16 v[158:159], v25 offset:41984
    v_mov_b32 v29, v28
    s_waitcnt lgkmcnt(15)
    v_mfma_f32_16x16x32_bf16 v[112:115], a[8:11], v[120:123], 0
    ds_read_b64_tr_b16 v[160:161], v4 offset:43008
    v_mfma_f32_16x16x32_bf16 v[112:115], a[32:35], v[124:127], v[112:115]
    ds_read_b64_tr_b16 v[162:163], v25 offset:43008
    ds_read_b64_tr_b16 v[164:165], v4 offset:44032
    s_waitcnt lgkmcnt(15)
    v_mfma_f32_16x16x32_bf16 v[112:115], a[56:59], v[128:131], v[112:115]
    ds_read_b64_tr_b16 v[166:167], v25 offset:44032
    v_permlane32_swap_b32 v28, v29
    v_mfma_f32_16x16x32_bf16 v[112:115], a[80:83], v[132:135], v[112:115]
    ds_read_b64_tr_b16 v[168:169], v4 offset:45056
    v_add_f32 v28, v28, v29
    s_waitcnt lgkmcnt(13)
    v_mfma_f32_16x16x32_bf16 v[112:115], a[104:107], v[136:139], v[112:115]
    ds_read_b64_tr_b16 v[170:171], v25 offset:45056
    ds_read_b64_tr_b16 v[172:173], v4 offset:46080
    v_mfma_f32_16x16x32_bf16 v[112:115], a[128:131], v[140:143], v[112:115]
    ds_read_b64_tr_b16 v[174:175], v25 offset:46080
    v_rcp_f32 v28, v28
    s_waitcnt lgkmcnt(12)
    v_mfma_f32_16x16x32_bf16 v[112:115], a[152:155], v[144:147], v[112:115]
    v_cvt_pk_bf16_f32 v70, v108, v109
    v_cvt_pk_bf16_f32 v71, v110, v111
    v_mfma_f32_16x16x32_bf16 v[112:115], a[176:179], v[148:151], v[112:115]
    v_cndmask_b32 v70, v70, 0, s[82:83]
    v_cndmask_b32 v71, v71, 0, s[82:83]
    s_waitcnt lgkmcnt(8)
    v_mfma_f32_16x16x32_bf16 v[112:115], a[200:203], v[152:155], v[112:115]
    v_mul_f32 v26, v26, v8
    v_mul_f32 v27, v27, v9
    v_mfma_f32_16x16x32_bf16 v[112:115], a[224:227], v[156:159], v[112:115]
    v_mul_f32 v26, v26, v28
    v_mul_f32 v27, v27, v28
    s_waitcnt lgkmcnt(4)
    v_mfma_f32_16x16x32_bf16 v[112:115], a[248:251], v[160:163], v[112:115]
    v_cvt_pk_bf16_f32 v26, v26, v26
    v_cvt_pk_bf16_f32 v27, v27, v27
    v_mfma_f32_16x16x32_bf16 v[112:115], v[192:195], v[164:167], v[112:115]
    v_and_b32 v80, v26, v14
    v_and_b32 v81, v27, v15
    s_waitcnt lgkmcnt(0)
    v_mfma_f32_16x16x32_bf16 v[112:115], v[216:219], v[168:171], v[112:115]
    v_and_b32 v82, v26, v16
    v_and_b32 v83, v27, v17
    v_mfma_f32_16x16x32_bf16 v[112:115], v[240:243], v[172:175], v[112:115]
    v_mfma_f32_16x16x32_bf16 v[116:119], a[12:15], v[120:123], 0
    v_mfma_f32_16x16x32_bf16 v[72:75], v[38:41], v[80:83], 0
    v_mfma_f32_16x16x32_bf16 v[116:119], a[36:39], v[124:127], v[116:119]
    v_mfma_f32_16x16x32_bf16 v[76:79], v[48:51], v[80:83], 0
    v_mfma_f32_16x16x32_bf16 v[116:119], a[60:63], v[128:131], v[116:119]
    s_add_u32 s53, s74, 49152
    v_mfma_f32_16x16x32_bf16 v[116:119], a[84:87], v[132:135], v[116:119]
    v_mfma_f32_16x16x32_bf16 v[116:119], a[108:111], v[136:139], v[116:119]
    v_mfma_f32_16x16x32_bf16 v[116:119], a[132:135], v[140:143], v[116:119]
    v_mfma_f32_16x16x32_bf16 v[116:119], a[156:159], v[144:147], v[116:119]
    v_cvt_pk_bf16_f32 v52, v112, v113
    v_cvt_pk_bf16_f32 v53, v114, v115
    v_mfma_f32_16x16x32_bf16 v[116:119], a[180:183], v[148:151], v[116:119]
    v_cvt_pk_bf16_f32 v84, v72, v73
    v_cvt_pk_bf16_f32 v85, v74, v75
    v_mfma_f32_16x16x32_bf16 v[116:119], a[204:207], v[152:155], v[116:119]
    v_cvt_pk_bf16_f32 v86, v76, v77
    v_cvt_pk_bf16_f32 v87, v78, v79
    v_mfma_f32_16x16x32_bf16 v[116:119], a[228:231], v[156:159], v[116:119]
    buffer_store_dwordx4 v[84:87], v23, s[24:27], s53 offen sc1
    v_mfma_f32_16x16x32_bf16 v[116:119], a[252:255], v[160:163], v[116:119]
    v_cndmask_b32 v80, v84, v86, s[88:89]
    v_cndmask_b32 v81, v85, v87, s[88:89]
    v_mfma_f32_16x16x32_bf16 v[116:119], v[196:199], v[164:167], v[116:119]
    ds_write_b64 v95, v[80:81] offset:768
    ds_read_b128 v[72:75], v12 offset:0
    v_mfma_f32_16x16x32_bf16 v[116:119], v[220:223], v[168:171], v[116:119]
    s_add_u32 s53, s74, 0
    v_mfma_f32_16x16x32_bf16 v[116:119], v[244:247], v[172:175], v[116:119]
    v_mfma_f32_16x16x32_bf16 v[96:99], v[120:123], a[16:19], 0
    v_mfma_f32_16x16x32_bf16 v[96:99], v[124:127], a[40:43], v[96:99]
    v_mfma_f32_16x16x32_bf16 v[96:99], v[128:131], a[64:67], v[96:99]
    s_waitcnt lgkmcnt(0)
    buffer_store_dwordx4 v[72:75], v23, s[24:27], s53 offen sc1
    v_mfma_f32_16x16x32_bf16 v[96:99], v[132:135], a[88:91], v[96:99]
    v_add_u32 v92, 65536, v92
L_wa_3:
    s_cbranch_execz L_wa_ret
    v_add_u32 v93, 65536, v93
    v_mfma_f32_16x16x32_bf16 v[96:99], v[136:139], a[112:115], v[96:99]
    v_add_u32 v94, 65536, v94
    v_mfma_f32_16x16x32_bf16 v[96:99], v[140:143], a[136:139], v[96:99]
    v_mfma_f32_16x16x32_bf16 v[72:75], v[56:59], v[68:71], 0
    v_mfma_f32_16x16x32_bf16 v[96:99], v[144:147], a[160:163], v[96:99]
    v_cvt_pk_bf16_f32 v54, v116, v117
    v_cvt_pk_bf16_f32 v55, v118, v119
    v_mfma_f32_16x16x32_bf16 v[96:99], v[148:151], a[184:187], v[96:99]
    v_cndmask_b32 v54, v54, 0, s[82:83]
    v_cndmask_b32 v55, v55, 0, s[82:83]
    v_mfma_f32_16x16x32_bf16 v[96:99], v[152:155], a[208:211], v[96:99]
    v_mfma_f32_16x16x32_bf16 v[76:79], v[60:63], v[68:71], 0
    v_mfma_f32_16x16x32_bf16 v[96:99], v[156:159], a[232:235], v[96:99]
    ds_read_u16_d16_hi v8, v93 offset:0
    ds_read_u16_d16_hi v9, v94 offset:0
    v_mfma_f32_16x16x32_bf16 v[96:99], v[160:163], v[176:179], v[96:99]
    ds_read_u16_d16_hi v10, v92 offset:0
    v_mfma_f32_16x16x32_bf16 v[96:99], v[164:167], v[200:203], v[96:99]
    v_mfma_f32_16x16x32_bf16 v[96:99], v[168:171], v[224:227], v[96:99]
    v_mfma_f32_16x16x32_bf16 v[96:99], v[172:175], v[248:251], v[96:99]
    v_mfma_f32_16x16x32_bf16 v[100:103], v[120:123], a[20:23], 0
    v_cndmask_b32 v26, v72, v73, s[76:77]
    v_cndmask_b32 v27, v74, v75, s[76:77]
    v_mfma_f32_16x16x32_bf16 v[100:103], v[124:127], a[44:47], v[100:103]
    v_cndmask_b32 v28, v76, v77, s[76:77]
    v_cndmask_b32 v29, v78, v79, s[76:77]
    v_mfma_f32_16x16x32_bf16 v[100:103], v[128:131], a[68:71], v[100:103]
    v_cndmask_b32 v26, v26, v28, s[78:79]
    v_cndmask_b32 v27, v27, v29, s[80:81]
    v_mfma_f32_16x16x32_bf16 v[100:103], v[132:135], a[92:95], v[100:103]
    s_waitcnt lgkmcnt(0)
    v_mul_f32 v26, v26, v8
    v_mfma_f32_16x16x32_bf16 v[100:103], v[136:139], a[116:119], v[100:103]
    v_mul_f32 v27, v27, v9
    v_mul_f32 v11, s91, v10
    v_mfma_f32_16x16x32_bf16 v[100:103], v[140:143], a[140:143], v[100:103]
    v_max_f32 v28, v26, v27
    v_mov_b32 v29, v28
    v_mfma_f32_16x16x32_bf16 v[100:103], v[144:147], a[164:167], v[100:103]
    v_cvt_pk_bf16_f32 v36, v96, v97
    v_cvt_pk_bf16_f32 v37, v98, v99
    v_mfma_f32_16x16x32_bf16 v[100:103], v[148:151], a[188:191], v[100:103]
    v_permlane16_swap_b32 v28, v29
    v_max_f32 v28, v28, v29
    v_mfma_f32_16x16x32_bf16 v[100:103], v[152:155], a[212:215], v[100:103]
    v_mov_b32 v29, v28
    v_mfma_f32_16x16x32_bf16 v[100:103], v[156:159], a[236:239], v[100:103]
    v_mfma_f32_16x16x32_bf16 v[100:103], v[160:163], v[180:183], v[100:103]
    v_permlane32_swap_b32 v28, v29
    v_max_f32 v28, v28, v29
    v_mfma_f32_16x16x32_bf16 v[100:103], v[164:167], v[204:207], v[100:103]
    v_sub_f32 v26, v26, v28
    v_sub_f32 v27, v27, v28
    v_mfma_f32_16x16x32_bf16 v[100:103], v[168:171], v[228:231], v[100:103]
    v_mul_f32 v26, v11, v26
    v_mul_f32 v27, v11, v27
    v_mfma_f32_16x16x32_bf16 v[100:103], v[172:175], v[252:255], v[100:103]
    v_exp_f32 v26, v26
    v_mfma_f32_16x16x32_bf16 v[104:107], a[0:3], v[120:123], 0
    v_exp_f32 v27, v27
    v_mfma_f32_16x16x32_bf16 v[104:107], a[24:27], v[124:127], v[104:107]
    v_add_f32 v28, v26, v27
    v_mov_b32 v29, v28
    v_mfma_f32_16x16x32_bf16 v[104:107], a[48:51], v[128:131], v[104:107]
    v_mfma_f32_16x16x32_bf16 v[104:107], a[72:75], v[132:135], v[104:107]
    v_permlane16_swap_b32 v28, v29
    v_add_f32 v28, v28, v29
    v_mfma_f32_16x16x32_bf16 v[104:107], a[96:99], v[136:139], v[104:107]
    v_mov_b32 v29, v28
    v_mfma_f32_16x16x32_bf16 v[104:107], a[120:123], v[140:143], v[104:107]
    v_mfma_f32_16x16x32_bf16 v[104:107], a[144:147], v[144:147], v[104:107]
    v_cvt_pk_bf16_f32 v46, v100, v101
    v_cvt_pk_bf16_f32 v47, v102, v103
    v_mfma_f32_16x16x32_bf16 v[104:107], a[168:171], v[148:151], v[104:107]
    v_permlane32_swap_b32 v28, v29
    v_add_f32 v28, v28, v29
    v_mfma_f32_16x16x32_bf16 v[104:107], a[192:195], v[152:155], v[104:107]
    v_rcp_f32 v28, v28
    v_mfma_f32_16x16x32_bf16 v[104:107], a[216:219], v[156:159], v[104:107]
    v_mul_f32 v26, v26, v8
    v_mul_f32 v27, v27, v9
    v_mfma_f32_16x16x32_bf16 v[104:107], a[240:243], v[160:163], v[104:107]
    v_mul_f32 v26, v26, v28
    v_mul_f32 v27, v27, v28
    v_mfma_f32_16x16x32_bf16 v[104:107], v[184:187], v[164:167], v[104:107]
    v_cvt_pk_bf16_f32 v26, v26, v26
    v_cvt_pk_bf16_f32 v27, v27, v27
    v_mfma_f32_16x16x32_bf16 v[104:107], v[208:211], v[168:171], v[104:107]
    v_and_b32 v80, v26, v14
    v_and_b32 v81, v27, v15
    v_mfma_f32_16x16x32_bf16 v[104:107], v[232:235], v[172:175], v[104:107]
    v_and_b32 v82, v26, v16
    v_and_b32 v83, v27, v17
    s_waitcnt vmcnt(6)
    s_barrier
    v_mfma_f32_16x16x32_bf16 v[108:111], a[4:7], v[120:123], 0
    ds_read_b64_tr_b16 v[120:121], v4 offset:49152
    ds_read_b64_tr_b16 v[122:123], v25 offset:49152
    v_mfma_f32_16x16x32_bf16 v[108:111], a[28:31], v[124:127], v[108:111]
    ds_read_b64_tr_b16 v[124:125], v4 offset:50176
    v_mfma_f32_16x16x32_bf16 v[72:75], v[32:35], v[80:83], 0
    v_mfma_f32_16x16x32_bf16 v[108:111], a[52:55], v[128:131], v[108:111]
    ds_read_b64_tr_b16 v[126:127], v25 offset:50176
    ds_read_b64_tr_b16 v[128:129], v4 offset:51200
    v_mfma_f32_16x16x32_bf16 v[108:111], a[76:79], v[132:135], v[108:111]
    ds_read_b64_tr_b16 v[130:131], v25 offset:51200
    v_mfma_f32_16x16x32_bf16 v[76:79], v[42:45], v[80:83], 0
    v_mfma_f32_16x16x32_bf16 v[108:111], a[100:103], v[136:139], v[108:111]
    ds_read_b64_tr_b16 v[132:133], v4 offset:52224
    s_add_u32 s53, s74, 65536
    v_mfma_f32_16x16x32_bf16 v[108:111], a[124:127], v[140:143], v[108:111]
    ds_read_b64_tr_b16 v[134:135], v25 offset:52224
    ds_read_b64_tr_b16 v[136:137], v4 offset:53248
    v_mfma_f32_16x16x32_bf16 v[108:111], a[148:151], v[144:147], v[108:111]
    ds_read_b64_tr_b16 v[138:139], v25 offset:53248
    v_cvt_pk_bf16_f32 v64, v104, v105
    v_mfma_f32_16x16x32_bf16 v[108:111], a[172:175], v[148:151], v[108:111]
    ds_read_b64_tr_b16 v[140:141], v4 offset:54272
    ds_read_b64_tr_b16 v[142:143], v25 offset:54272
    v_mfma_f32_16x16x32_bf16 v[108:111], a[196:199], v[152:155], v[108:111]
    ds_read_b64_tr_b16 v[144:145], v4 offset:55296
    v_cvt_pk_bf16_f32 v65, v106, v107
    v_mfma_f32_16x16x32_bf16 v[108:111], a[220:223], v[156:159], v[108:111]
    ds_read_b64_tr_b16 v[146:147], v25 offset:55296
    v_cvt_pk_bf16_f32 v84, v72, v73
    v_mfma_f32_16x16x32_bf16 v[108:111], a[244:247], v[160:163], v[108:111]
    ds_read_b64_tr_b16 v[148:149], v4 offset:56320
    ds_read_b64_tr_b16 v[150:151], v25 offset:56320
    v_mfma_f32_16x16x32_bf16 v[108:111], v[188:191], v[164:167], v[108:111]
    ds_read_b64_tr_b16 v[152:153], v4 offset:57344
    v_cvt_pk_bf16_f32 v85, v74, v75
    v_mfma_f32_16x16x32_bf16 v[108:111], v[212:215], v[168:171], v[108:111]
    ds_read_b64_tr_b16 v[154:155], v25 offset:57344
    ds_read_b64_tr_b16 v[156:157], v4 offset:58368
    v_mfma_f32_16x16x32_bf16 v[108:111], v[236:239], v[172:175], v[108:111]
    ds_read_b64_tr_b16 v[158:159], v25 offset:58368
    v_cvt_pk_bf16_f32 v86, v76, v77
    s_waitcnt lgkmcnt(15)
    v_mfma_f32_16x16x32_bf16 v[112:115], a[8:11], v[120:123], 0
    ds_read_b64_tr_b16 v[160:161], v4 offset:59392
    v_cvt_pk_bf16_f32 v87, v78, v79
    v_mfma_f32_16x16x32_bf16 v[112:115], a[32:35], v[124:127], v[112:115]
    ds_read_b64_tr_b16 v[162:163], v25 offset:59392
    ds_read_b64_tr_b16 v[164:165], v4 offset:60416
    s_waitcnt lgkmcnt(15)
    v_mfma_f32_16x16x32_bf16 v[112:115], a[56:59], v[128:131], v[112:115]
    ds_read_b64_tr_b16 v[166:167], v25 offset:60416
    buffer_store_dwordx4 v[84:87], v23, s[24:27], s53 offen sc1
    v_mfma_f32_16x16x32_bf16 v[112:115], a[80:83], v[132:135], v[112:115]
    ds_read_b64_tr_b16 v[168:169], v4 offset:61440
    v_cndmask_b32 v80, v84, v86, s[88:89]
    s_waitcnt lgkmcnt(13)
    v_mfma_f32_16x16x32_bf16 v[112:115], a[104:107], v[136:139], v[112:115]
    ds_read_b64_tr_b16 v[170:171], v25 offset:61440
    ds_read_b64_tr_b16 v[172:173], v4 offset:62464
    v_mfma_f32_16x16x32_bf16 v[112:115], a[128:131], v[140:143], v[112:115]
    ds_read_b64_tr_b16 v[174:175], v25 offset:62464
    v_cndmask_b32 v81, v85, v87, s[88:89]
    s_waitcnt lgkmcnt(12)
    v_mfma_f32_16x16x32_bf16 v[112:115], a[152:155], v[144:147], v[112:115]
    v_cvt_pk_bf16_f32 v66, v108, v109
    v_cvt_pk_bf16_f32 v67, v110, v111
    v_mfma_f32_16x16x32_bf16 v[112:115], a[176:179], v[148:151], v[112:115]
    v_cndmask_b32 v66, v66, 0, s[82:83]
    v_cndmask_b32 v67, v67, 0, s[82:83]
    s_waitcnt lgkmcnt(8)
    v_mfma_f32_16x16x32_bf16 v[112:115], a[200:203], v[152:155], v[112:115]
    ds_write_b64 v95, v[80:81] offset:1024
    ds_read_b128 v[72:75], v12 offset:1024
    v_mfma_f32_16x16x32_bf16 v[112:115], a[224:227], v[156:159], v[112:115]
    s_add_u32 s53, s74, 16384
    s_waitcnt lgkmcnt(6)
    v_mfma_f32_16x16x32_bf16 v[112:115], a[248:251], v[160:163], v[112:115]
    v_mfma_f32_16x16x32_bf16 v[112:115], v[192:195], v[164:167], v[112:115]
    s_waitcnt lgkmcnt(2)
    v_mfma_f32_16x16x32_bf16 v[112:115], v[216:219], v[168:171], v[112:115]
    v_mfma_f32_16x16x32_bf16 v[112:115], v[240:243], v[172:175], v[112:115]
    s_waitcnt lgkmcnt(0)
    buffer_store_dwordx4 v[72:75], v23, s[24:27], s53 offen sc1
    v_mfma_f32_16x16x32_bf16 v[116:119], a[12:15], v[120:123], 0
    v_mfma_f32_16x16x32_bf16 v[116:119], a[36:39], v[124:127], v[116:119]
    v_mfma_f32_16x16x32_bf16 v[72:75], v[60:63], v[64:67], 0
    v_mfma_f32_16x16x32_bf16 v[116:119], a[60:63], v[128:131], v[116:119]
    v_mfma_f32_16x16x32_bf16 v[76:79], v[52:55], v[64:67], 0
    v_mfma_f32_16x16x32_bf16 v[116:119], a[84:87], v[132:135], v[116:119]
    ds_read_u16_d16_hi v8, v93 offset:16384
    ds_read_u16_d16_hi v9, v94 offset:16384
    v_mfma_f32_16x16x32_bf16 v[116:119], a[108:111], v[136:139], v[116:119]
    ds_read_u16_d16_hi v10, v92 offset:16384
    v_mfma_f32_16x16x32_bf16 v[116:119], a[132:135], v[140:143], v[116:119]
    v_mfma_f32_16x16x32_bf16 v[116:119], a[156:159], v[144:147], v[116:119]
    v_cvt_pk_bf16_f32 v56, v112, v113
    v_cvt_pk_bf16_f32 v57, v114, v115
    v_mfma_f32_16x16x32_bf16 v[116:119], a[180:183], v[148:151], v[116:119]
    v_mfma_f32_16x16x32_bf16 v[116:119], a[204:207], v[152:155], v[116:119]
    v_cndmask_b32 v26, v72, v73, s[76:77]
    v_cndmask_b32 v27, v74, v75, s[76:77]
    v_mfma_f32_16x16x32_bf16 v[116:119], a[228:231], v[156:159], v[116:119]
    v_cndmask_b32 v28, v76, v77, s[76:77]
    v_cndmask_b32 v29, v78, v79, s[76:77]
    v_mfma_f32_16x16x32_bf16 v[116:119], a[252:255], v[160:163], v[116:119]
    v_cndmask_b32 v26, v26, v28, s[78:79]
    v_cndmask_b32 v27, v27, v29, s[80:81]
    v_mfma_f32_16x16x32_bf16 v[116:119], v[196:199], v[164:167], v[116:119]
    s_waitcnt lgkmcnt(0)
    v_mul_f32 v26, v26, v8
    v_mfma_f32_16x16x32_bf16 v[116:119], v[220:223], v[168:171], v[116:119]
    v_mul_f32 v27, v27, v9
    v_mul_f32 v11, s91, v10
    v_mfma_f32_16x16x32_bf16 v[116:119], v[244:247], v[172:175], v[116:119]
    v_max_f32 v28, v26, v27
    v_mov_b32 v29, v28
    v_mfma_f32_16x16x32_bf16 v[96:99], v[120:123], a[16:19], 0
    v_mfma_f32_16x16x32_bf16 v[96:99], v[124:127], a[40:43], v[96:99]
    v_permlane16_swap_b32 v28, v29
    v_max_f32 v28, v28, v29
    v_mfma_f32_16x16x32_bf16 v[96:99], v[128:131], a[64:67], v[96:99]
    v_mov_b32 v29, v28
    v_mfma_f32_16x16x32_bf16 v[96:99], v[132:135], a[88:91], v[96:99]
    v_mfma_f32_16x16x32_bf16 v[96:99], v[136:139], a[112:115], v[96:99]
    v_permlane32_swap_b32 v28, v29
    v_max_f32 v28, v28, v29
    v_mfma_f32_16x16x32_bf16 v[96:99], v[140:143], a[136:139], v[96:99]
    v_sub_f32 v26, v26, v28
    v_sub_f32 v27, v27, v28
    v_mfma_f32_16x16x32_bf16 v[96:99], v[144:147], a[160:163], v[96:99]
    v_cvt_pk_bf16_f32 v58, v116, v117
    v_cvt_pk_bf16_f32 v59, v118, v119
    v_mfma_f32_16x16x32_bf16 v[96:99], v[148:151], a[184:187], v[96:99]
    v_cndmask_b32 v58, v58, 0, s[82:83]
    v_cndmask_b32 v59, v59, 0, s[82:83]
    v_mfma_f32_16x16x32_bf16 v[96:99], v[152:155], a[208:211], v[96:99]
    v_mul_f32 v26, v11, v26
    v_mul_f32 v27, v11, v27
    v_mfma_f32_16x16x32_bf16 v[96:99], v[156:159], a[232:235], v[96:99]
    v_exp_f32 v26, v26
    v_mfma_f32_16x16x32_bf16 v[96:99], v[160:163], v[176:179], v[96:99]
    v_exp_f32 v27, v27
    v_mfma_f32_16x16x32_bf16 v[96:99], v[164:167], v[200:203], v[96:99]
    v_add_f32 v28, v26, v27
    v_mov_b32 v29, v28
    v_mfma_f32_16x16x32_bf16 v[96:99], v[168:171], v[224:227], v[96:99]
    v_mfma_f32_16x16x32_bf16 v[96:99], v[172:175], v[248:251], v[96:99]
    v_permlane16_swap_b32 v28, v29
    v_add_f32 v28, v28, v29
    v_mfma_f32_16x16x32_bf16 v[100:103], v[120:123], a[20:23], 0
    v_mov_b32 v29, v28
    v_mfma_f32_16x16x32_bf16 v[100:103], v[124:127], a[44:47], v[100:103]
    v_mfma_f32_16x16x32_bf16 v[100:103], v[128:131], a[68:71], v[100:103]
    v_permlane32_swap_b32 v28, v29
    v_add_f32 v28, v28, v29
    v_mfma_f32_16x16x32_bf16 v[100:103], v[132:135], a[92:95], v[100:103]
    v_rcp_f32 v28, v28
    v_mfma_f32_16x16x32_bf16 v[100:103], v[136:139], a[116:119], v[100:103]
    v_mul_f32 v26, v26, v8
    v_mul_f32 v27, v27, v9
    v_mfma_f32_16x16x32_bf16 v[100:103], v[140:143], a[140:143], v[100:103]
    v_mul_f32 v26, v26, v28
    v_mul_f32 v27, v27, v28
    v_mfma_f32_16x16x32_bf16 v[100:103], v[144:147], a[164:167], v[100:103]
    v_cvt_pk_bf16_f32 v38, v96, v97
    v_cvt_pk_bf16_f32 v39, v98, v99
    v_mfma_f32_16x16x32_bf16 v[100:103], v[148:151], a[188:191], v[100:103]
    v_cvt_pk_bf16_f32 v26, v26, v26
    v_cvt_pk_bf16_f32 v27, v27, v27
    v_mfma_f32_16x16x32_bf16 v[100:103], v[152:155], a[212:215], v[100:103]
    v_and_b32 v80, v26, v14
    v_and_b32 v81, v27, v15
    v_mfma_f32_16x16x32_bf16 v[100:103], v[156:159], a[236:239], v[100:103]
    v_and_b32 v82, v26, v16
    v_and_b32 v83, v27, v17
    v_mfma_f32_16x16x32_bf16 v[100:103], v[160:163], v[180:183], v[100:103]
    v_mfma_f32_16x16x32_bf16 v[100:103], v[164:167], v[204:207], v[100:103]
    v_mfma_f32_16x16x32_bf16 v[72:75], v[34:37], v[80:83], 0
    v_mfma_f32_16x16x32_bf16 v[100:103], v[168:171], v[228:231], v[100:103]
    v_mfma_f32_16x16x32_bf16 v[76:79], v[44:47], v[80:83], 0
    v_mfma_f32_16x16x32_bf16 v[100:103], v[172:175], v[252:255], v[100:103]
    s_add_u32 s53, s74, 81920
    v_mfma_f32_16x16x32_bf16 v[104:107], a[0:3], v[120:123], 0
    v_mfma_f32_16x16x32_bf16 v[104:107], a[24:27], v[124:127], v[104:107]
    v_mfma_f32_16x16x32_bf16 v[104:107], a[48:51], v[128:131], v[104:107]
    v_mfma_f32_16x16x32_bf16 v[104:107], a[72:75], v[132:135], v[104:107]
    v_mfma_f32_16x16x32_bf16 v[104:107], a[96:99], v[136:139], v[104:107]
    v_cvt_pk_bf16_f32 v84, v72, v73
    v_cvt_pk_bf16_f32 v85, v74, v75
    v_mfma_f32_16x16x32_bf16 v[104:107], a[120:123], v[140:143], v[104:107]
    v_cvt_pk_bf16_f32 v86, v76, v77
    v_cvt_pk_bf16_f32 v87, v78, v79
    v_mfma_f32_16x16x32_bf16 v[104:107], a[144:147], v[144:147], v[104:107]
    v_cvt_pk_bf16_f32 v48, v100, v101
    v_cvt_pk_bf16_f32 v49, v102, v103
    v_mfma_f32_16x16x32_bf16 v[104:107], a[168:171], v[148:151], v[104:107]
    buffer_store_dwordx4 v[84:87], v23, s[24:27], s53 offen sc1
    v_mfma_f32_16x16x32_bf16 v[104:107], a[192:195], v[152:155], v[104:107]
    v_cndmask_b32 v80, v84, v86, s[88:89]
    v_cndmask_b32 v81, v85, v87, s[88:89]
    v_mfma_f32_16x16x32_bf16 v[104:107], a[216:219], v[156:159], v[104:107]
    ds_write_b64 v95, v[80:81] offset:1280
    ds_read_b128 v[72:75], v13 offset:0
    v_mfma_f32_16x16x32_bf16 v[104:107], a[240:243], v[160:163], v[104:107]
    s_add_u32 s53, s74, 32768
    v_mfma_f32_16x16x32_bf16 v[104:107], v[184:187], v[164:167], v[104:107]
    v_mfma_f32_16x16x32_bf16 v[104:107], v[208:211], v[168:171], v[104:107]
    v_mfma_f32_16x16x32_bf16 v[104:107], v[232:235], v[172:175], v[104:107]
    v_mfma_f32_16x16x32_bf16 v[108:111], a[4:7], v[120:123], 0
    v_add_u32 v4, 65536, v4
    v_add_u32 v25, 65536, v25
    ds_read_b64_tr_b16 v[120:121], v4 offset:0
    ds_read_b64_tr_b16 v[122:123], v25 offset:0
    v_mfma_f32_16x16x32_bf16 v[108:111], a[28:31], v[124:127], v[108:111]
    ds_read_b64_tr_b16 v[124:125], v4 offset:1024
    s_waitcnt lgkmcnt(3)
    v_mfma_f32_16x16x32_bf16 v[108:111], a[52:55], v[128:131], v[108:111]
    ds_read_b64_tr_b16 v[126:127], v25 offset:1024
    ds_read_b64_tr_b16 v[128:129], v4 offset:2048
    v_mfma_f32_16x16x32_bf16 v[108:111], a[76:79], v[132:135], v[108:111]
    ds_read_b64_tr_b16 v[130:131], v25 offset:2048
    buffer_store_dwordx4 v[72:75], v23, s[24:27], s53 offen sc1
    v_mfma_f32_16x16x32_bf16 v[108:111], a[100:103], v[136:139], v[108:111]
    ds_read_b64_tr_b16 v[132:133], v4 offset:3072
    v_mfma_f32_16x16x32_bf16 v[108:111], a[124:127], v[140:143], v[108:111]
    ds_read_b64_tr_b16 v[134:135], v25 offset:3072
    ds_read_b64_tr_b16 v[136:137], v4 offset:4096
    v_mfma_f32_16x16x32_bf16 v[108:111], a[148:151], v[144:147], v[108:111]
    ds_read_b64_tr_b16 v[138:139], v25 offset:4096
    v_cvt_pk_bf16_f32 v68, v104, v105
    v_mfma_f32_16x16x32_bf16 v[108:111], a[172:175], v[148:151], v[108:111]
    ds_read_b64_tr_b16 v[140:141], v4 offset:5120
    ds_read_b64_tr_b16 v[142:143], v25 offset:5120
    v_mfma_f32_16x16x32_bf16 v[108:111], a[196:199], v[152:155], v[108:111]
    ds_read_b64_tr_b16 v[144:145], v4 offset:6144
    v_cvt_pk_bf16_f32 v69, v106, v107
    v_mfma_f32_16x16x32_bf16 v[108:111], a[220:223], v[156:159], v[108:111]
    ds_read_b64_tr_b16 v[146:147], v25 offset:6144
    v_mfma_f32_16x16x32_bf16 v[108:111], a[244:247], v[160:163], v[108:111]
    ds_read_b64_tr_b16 v[148:149], v4 offset:7168
    ds_read_b64_tr_b16 v[150:151], v25 offset:7168
    v_mfma_f32_16x16x32_bf16 v[108:111], v[188:191], v[164:167], v[108:111]
    ds_read_b64_tr_b16 v[152:153], v4 offset:8192
    v_mfma_f32_16x16x32_bf16 v[108:111], v[212:215], v[168:171], v[108:111]
    ds_read_b64_tr_b16 v[154:155], v25 offset:8192
    ds_read_b64_tr_b16 v[156:157], v4 offset:9216
    v_mfma_f32_16x16x32_bf16 v[108:111], v[236:239], v[172:175], v[108:111]
    ds_read_b64_tr_b16 v[158:159], v25 offset:9216
    s_waitcnt lgkmcnt(15)
    v_mfma_f32_16x16x32_bf16 v[112:115], a[0:3], v[120:123], 0
    ds_read_b64_tr_b16 v[160:161], v4 offset:10240
    v_mfma_f32_16x16x32_bf16 v[112:115], a[24:27], v[124:127], v[112:115]
    ds_read_b64_tr_b16 v[162:163], v25 offset:10240
    ds_read_b64_tr_b16 v[164:165], v4 offset:11264
    s_waitcnt lgkmcnt(15)
    v_mfma_f32_16x16x32_bf16 v[112:115], a[48:51], v[128:131], v[112:115]
    ds_read_b64_tr_b16 v[166:167], v25 offset:11264
    v_mfma_f32_16x16x32_bf16 v[112:115], a[72:75], v[132:135], v[112:115]
    ds_read_b64_tr_b16 v[168:169], v4 offset:12288
    s_waitcnt lgkmcnt(13)
    v_mfma_f32_16x16x32_bf16 v[112:115], a[96:99], v[136:139], v[112:115]
    ds_read_b64_tr_b16 v[170:171], v25 offset:12288
    ds_read_b64_tr_b16 v[172:173], v4 offset:13312
    v_mfma_f32_16x16x32_bf16 v[112:115], a[120:123], v[140:143], v[112:115]
    ds_read_b64_tr_b16 v[174:175], v25 offset:13312
    s_waitcnt lgkmcnt(12)
    v_mfma_f32_16x16x32_bf16 v[112:115], a[144:147], v[144:147], v[112:115]
    v_cvt_pk_bf16_f32 v70, v108, v109
    v_cvt_pk_bf16_f32 v71, v110, v111
    v_mfma_f32_16x16x32_bf16 v[112:115], a[168:171], v[148:151], v[112:115]
    v_cndmask_b32 v70, v70, 0, s[82:83]
    v_cndmask_b32 v71, v71, 0, s[82:83]
    s_waitcnt lgkmcnt(8)
    v_mfma_f32_16x16x32_bf16 v[112:115], a[192:195], v[152:155], v[112:115]
    v_mfma_f32_16x16x32_bf16 v[112:115], a[216:219], v[156:159], v[112:115]
    v_mfma_f32_16x16x32_bf16 v[72:75], v[52:55], v[68:71], 0
    s_waitcnt lgkmcnt(4)
    v_mfma_f32_16x16x32_bf16 v[112:115], a[240:243], v[160:163], v[112:115]
    v_mfma_f32_16x16x32_bf16 v[76:79], v[56:59], v[68:71], 0
    v_mfma_f32_16x16x32_bf16 v[112:115], v[184:187], v[164:167], v[112:115]
    ds_read_u16_d16_hi v8, v93 offset:32768
    ds_read_u16_d16_hi v9, v94 offset:32768
    s_waitcnt lgkmcnt(2)
    v_mfma_f32_16x16x32_bf16 v[112:115], v[208:211], v[168:171], v[112:115]
    ds_read_u16_d16_hi v10, v92 offset:32768
    v_mfma_f32_16x16x32_bf16 v[112:115], v[232:235], v[172:175], v[112:115]
    v_mfma_f32_16x16x32_bf16 v[116:119], a[4:7], v[120:123], 0
    v_mfma_f32_16x16x32_bf16 v[116:119], a[28:31], v[124:127], v[116:119]
    v_mfma_f32_16x16x32_bf16 v[116:119], a[52:55], v[128:131], v[116:119]
    v_cndmask_b32 v26, v72, v73, s[76:77]
    v_cndmask_b32 v27, v74, v75, s[76:77]
    v_mfma_f32_16x16x32_bf16 v[116:119], a[76:79], v[132:135], v[116:119]
    v_cndmask_b32 v28, v76, v77, s[76:77]
    v_cndmask_b32 v29, v78, v79, s[76:77]
    v_mfma_f32_16x16x32_bf16 v[116:119], a[100:103], v[136:139], v[116:119]
    v_cndmask_b32 v26, v26, v28, s[78:79]
    v_cndmask_b32 v27, v27, v29, s[80:81]
    v_mfma_f32_16x16x32_bf16 v[116:119], a[124:127], v[140:143], v[116:119]
    s_waitcnt lgkmcnt(0)
    v_mul_f32 v26, v26, v8
    v_mfma_f32_16x16x32_bf16 v[116:119], a[148:151], v[144:147], v[116:119]
    v_cvt_pk_bf16_f32 v64, v112, v113
    v_cvt_pk_bf16_f32 v65, v114, v115
    v_mfma_f32_16x16x32_bf16 v[116:119], a[172:175], v[148:151], v[116:119]
    v_mul_f32 v27, v27, v9
    v_mul_f32 v11, s91, v10
    v_mfma_f32_16x16x32_bf16 v[116:119], a[196:199], v[152:155], v[116:119]
    v_max_f32 v28, v26, v27
    v_mov_b32 v29, v28
    v_mfma_f32_16x16x32_bf16 v[116:119], a[220:223], v[156:159], v[116:119]
    v_mfma_f32_16x16x32_bf16 v[116:119], a[244:247], v[160:163], v[116:119]
    v_permlane16_swap_b32 v28, v29
    v_max_f32 v28, v28, v29
    v_mfma_f32_16x16x32_bf16 v[116:119], v[188:191], v[164:167], v[116:119]
    v_mov_b32 v29, v28
    v_mfma_f32_16x16x32_bf16 v[116:119], v[212:215], v[168:171], v[116:119]
    v_mfma_f32_16x16x32_bf16 v[116:119], v[236:239], v[172:175], v[116:119]
    v_permlane32_swap_b32 v28, v29
    v_max_f32 v28, v28, v29
    v_mfma_f32_16x16x32_bf16 v[96:99], a[8:11], v[120:123], 0
    v_sub_f32 v26, v26, v28
    v_sub_f32 v27, v27, v28
    v_mfma_f32_16x16x32_bf16 v[96:99], a[32:35], v[124:127], v[96:99]
    v_mul_f32 v26, v11, v26
    v_mul_f32 v27, v11, v27
    v_mfma_f32_16x16x32_bf16 v[96:99], a[56:59], v[128:131], v[96:99]
    v_exp_f32 v26, v26
    v_mfma_f32_16x16x32_bf16 v[96:99], a[80:83], v[132:135], v[96:99]
    v_exp_f32 v27, v27
    v_mfma_f32_16x16x32_bf16 v[96:99], a[104:107], v[136:139], v[96:99]
    v_add_f32 v28, v26, v27
    v_mov_b32 v29, v28
    v_mfma_f32_16x16x32_bf16 v[96:99], a[128:131], v[140:143], v[96:99]
    v_mfma_f32_16x16x32_bf16 v[96:99], a[152:155], v[144:147], v[96:99]
    v_cvt_pk_bf16_f32 v66, v116, v117
    v_cvt_pk_bf16_f32 v67, v118, v119
    v_mfma_f32_16x16x32_bf16 v[96:99], a[176:179], v[148:151], v[96:99]
    v_cndmask_b32 v66, v66, 0, s[82:83]
    v_cndmask_b32 v67, v67, 0, s[82:83]
    v_mfma_f32_16x16x32_bf16 v[96:99], a[200:203], v[152:155], v[96:99]
    v_permlane16_swap_b32 v28, v29
    v_add_f32 v28, v28, v29
    v_mfma_f32_16x16x32_bf16 v[96:99], a[224:227], v[156:159], v[96:99]
    v_mov_b32 v29, v28
    v_mfma_f32_16x16x32_bf16 v[96:99], a[248:251], v[160:163], v[96:99]
    v_mfma_f32_16x16x32_bf16 v[96:99], v[192:195], v[164:167], v[96:99]
    v_permlane32_swap_b32 v28, v29
    v_add_f32 v28, v28, v29
    v_mfma_f32_16x16x32_bf16 v[96:99], v[216:219], v[168:171], v[96:99]
    v_rcp_f32 v28, v28
    v_mfma_f32_16x16x32_bf16 v[96:99], v[240:243], v[172:175], v[96:99]
    v_mul_f32 v26, v26, v8
    v_mul_f32 v27, v27, v9
    v_mfma_f32_16x16x32_bf16 v[100:103], a[12:15], v[120:123], 0
    v_mul_f32 v26, v26, v28
    v_mul_f32 v27, v27, v28
    v_mfma_f32_16x16x32_bf16 v[100:103], a[36:39], v[124:127], v[100:103]
    v_cvt_pk_bf16_f32 v26, v26, v26
    v_cvt_pk_bf16_f32 v27, v27, v27
    v_mfma_f32_16x16x32_bf16 v[100:103], a[60:63], v[128:131], v[100:103]
    v_and_b32 v80, v26, v14
    v_and_b32 v81, v27, v15
    v_mfma_f32_16x16x32_bf16 v[100:103], a[84:87], v[132:135], v[100:103]
    v_and_b32 v82, v26, v16
    v_and_b32 v83, v27, v17
    v_mfma_f32_16x16x32_bf16 v[100:103], a[108:111], v[136:139], v[100:103]
    v_mfma_f32_16x16x32_bf16 v[100:103], a[132:135], v[140:143], v[100:103]
    v_mfma_f32_16x16x32_bf16 v[72:75], v[36:39], v[80:83], 0
    v_mfma_f32_16x16x32_bf16 v[100:103], a[156:159], v[144:147], v[100:103]
    v_cvt_pk_bf16_f32 v60, v96, v97
    v_cvt_pk_bf16_f32 v61, v98, v99
    v_mfma_f32_16x16x32_bf16 v[100:103], a[180:183], v[148:151], v[100:103]
    v_mfma_f32_16x16x32_bf16 v[76:79], v[46:49], v[80:83], 0
    v_mfma_f32_16x16x32_bf16 v[100:103], a[204:207], v[152:155], v[100:103]
    s_add_u32 s53, s74, 98304
    v_mfma_f32_16x16x32_bf16 v[100:103], a[228:231], v[156:159], v[100:103]
    v_mfma_f32_16x16x32_bf16 v[100:103], a[252:255], v[160:163], v[100:103]
    v_mfma_f32_16x16x32_bf16 v[100:103], v[196:199], v[164:167], v[100:103]
    v_mfma_f32_16x16x32_bf16 v[100:103], v[220:223], v[168:171], v[100:103]
    v_mfma_f32_16x16x32_bf16 v[100:103], v[244:247], v[172:175], v[100:103]
    v_cvt_pk_bf16_f32 v84, v72, v73
    v_cvt_pk_bf16_f32 v85, v74, v75
    v_mfma_f32_16x16x32_bf16 v[104:107], v[120:123], a[16:19], 0
    v_cvt_pk_bf16_f32 v86, v76, v77
    v_cvt_pk_bf16_f32 v87, v78, v79
    v_mfma_f32_16x16x32_bf16 v[104:107], v[124:127], a[40:43], v[104:107]
    buffer_store_dwordx4 v[84:87], v23, s[24:27], s53 offen sc1
    v_mfma_f32_16x16x32_bf16 v[104:107], v[128:131], a[64:67], v[104:107]
    v_cndmask_b32 v80, v84, v86, s[88:89]
    v_cndmask_b32 v81, v85, v87, s[88:89]
    v_mfma_f32_16x16x32_bf16 v[104:107], v[132:135], a[88:91], v[104:107]
    ds_write_b64 v95, v[80:81] offset:1536
    v_mfma_f32_16x16x32_bf16 v[104:107], v[136:139], a[112:115], v[104:107]
    v_mfma_f32_16x16x32_bf16 v[104:107], v[140:143], a[136:139], v[104:107]
    v_mfma_f32_16x16x32_bf16 v[104:107], v[144:147], a[160:163], v[104:107]
    v_cvt_pk_bf16_f32 v62, v100, v101
    v_cvt_pk_bf16_f32 v63, v102, v103
    v_mfma_f32_16x16x32_bf16 v[104:107], v[148:151], a[184:187], v[104:107]
    v_cndmask_b32 v62, v62, 0, s[82:83]
    v_cndmask_b32 v63, v63, 0, s[82:83]
    v_mfma_f32_16x16x32_bf16 v[104:107], v[152:155], a[208:211], v[104:107]
    v_mfma_f32_16x16x32_bf16 v[104:107], v[156:159], a[232:235], v[104:107]
    v_mfma_f32_16x16x32_bf16 v[72:75], v[56:59], v[64:67], 0
    v_mfma_f32_16x16x32_bf16 v[104:107], v[160:163], v[176:179], v[104:107]
    v_mfma_f32_16x16x32_bf16 v[76:79], v[60:63], v[64:67], 0
    v_mfma_f32_16x16x32_bf16 v[104:107], v[164:167], v[200:203], v[104:107]
    ds_read_u16_d16_hi v8, v93 offset:49152
    ds_read_u16_d16_hi v9, v94 offset:49152
    v_mfma_f32_16x16x32_bf16 v[104:107], v[168:171], v[224:227], v[104:107]
    ds_read_u16_d16_hi v10, v92 offset:49152
    v_mfma_f32_16x16x32_bf16 v[104:107], v[172:175], v[248:251], v[104:107]
    v_mfma_f32_16x16x32_bf16 v[108:111], v[120:123], a[20:23], 0
    v_mfma_f32_16x16x32_bf16 v[108:111], v[124:127], a[44:47], v[108:111]
    v_mfma_f32_16x16x32_bf16 v[108:111], v[128:131], a[68:71], v[108:111]
    v_cndmask_b32 v26, v72, v73, s[76:77]
    v_cndmask_b32 v27, v74, v75, s[76:77]
    v_mfma_f32_16x16x32_bf16 v[108:111], v[132:135], a[92:95], v[108:111]
    v_cndmask_b32 v28, v76, v77, s[76:77]
    v_cndmask_b32 v29, v78, v79, s[76:77]
    v_mfma_f32_16x16x32_bf16 v[108:111], v[136:139], a[116:119], v[108:111]
    v_cndmask_b32 v26, v26, v28, s[78:79]
    v_cndmask_b32 v27, v27, v29, s[80:81]
    v_mfma_f32_16x16x32_bf16 v[108:111], v[140:143], a[140:143], v[108:111]
    s_waitcnt lgkmcnt(0)
    v_mul_f32 v26, v26, v8
    v_mfma_f32_16x16x32_bf16 v[108:111], v[144:147], a[164:167], v[108:111]
    v_cvt_pk_bf16_f32 v40, v104, v105
    v_cvt_pk_bf16_f32 v41, v106, v107
    v_mfma_f32_16x16x32_bf16 v[108:111], v[148:151], a[188:191], v[108:111]
    v_mul_f32 v27, v27, v9
    v_mul_f32 v11, s91, v10
    v_mfma_f32_16x16x32_bf16 v[108:111], v[152:155], a[212:215], v[108:111]
    v_max_f32 v28, v26, v27
    v_mov_b32 v29, v28
    v_mfma_f32_16x16x32_bf16 v[108:111], v[156:159], a[236:239], v[108:111]
    v_mfma_f32_16x16x32_bf16 v[108:111], v[160:163], v[180:183], v[108:111]
    v_permlane16_swap_b32 v28, v29
    v_max_f32 v28, v28, v29
    v_mfma_f32_16x16x32_bf16 v[108:111], v[164:167], v[204:207], v[108:111]
    v_mov_b32 v29, v28
    v_mfma_f32_16x16x32_bf16 v[108:111], v[168:171], v[228:231], v[108:111]
    v_mfma_f32_16x16x32_bf16 v[108:111], v[172:175], v[252:255], v[108:111]
    v_permlane32_swap_b32 v28, v29
    v_max_f32 v28, v28, v29
    s_nop 5
    v_cvt_pk_bf16_f32 v50, v108, v109
    v_cvt_pk_bf16_f32 v51, v110, v111
    v_sub_f32 v26, v26, v28
    v_sub_f32 v27, v27, v28
    v_mul_f32 v26, v11, v26
    v_mul_f32 v27, v11, v27
    v_exp_f32 v26, v26
    v_exp_f32 v27, v27
    s_nop 0
    v_add_f32 v28, v26, v27
    v_mov_b32 v29, v28
    s_nop 1
    v_permlane16_swap_b32 v28, v29
    v_add_f32 v28, v28, v29
    v_mov_b32 v29, v28
    s_nop 1
    v_permlane32_swap_b32 v28, v29
    v_add_f32 v28, v28, v29
    v_rcp_f32 v28, v28
    v_mul_f32 v26, v26, v8
    v_mul_f32 v27, v27, v9
    v_mul_f32 v26, v26, v28
    v_mul_f32 v27, v27, v28
    v_cvt_pk_bf16_f32 v26, v26, v26
    v_cvt_pk_bf16_f32 v27, v27, v27
    v_and_b32 v80, v26, v14
    v_and_b32 v81, v27, v15
    v_and_b32 v82, v26, v16
    v_and_b32 v83, v27, v17
    s_nop 1
    v_mfma_f32_16x16x32_bf16 v[72:75], v[38:41], v[80:83], 0
    v_mfma_f32_16x16x32_bf16 v[76:79], v[48:51], v[80:83], 0
    s_add_u32 s53, s74, 114688
    s_nop 5
    v_cvt_pk_bf16_f32 v84, v72, v73
    v_cvt_pk_bf16_f32 v85, v74, v75
    v_cvt_pk_bf16_f32 v86, v76, v77
    v_cvt_pk_bf16_f32 v87, v78, v79
    buffer_store_dwordx4 v[84:87], v23, s[24:27], s53 offen sc1
    v_cndmask_b32 v80, v84, v86, s[88:89]
    v_cndmask_b32 v81, v85, v87, s[88:89]
    ds_write_b64 v95, v[80:81] offset:1792
    v_lshlrev_b32 v6, 4, v0
    v_add_u32 v6, 147456, v6
    v_lshrrev_b32 v7, 4, v1
    v_and_b32 v12, 15, v1
    v_lshlrev_b32 v7, 14, v7
    v_lshl_add_u32 v7, v12, 4, v7
    s_waitcnt lgkmcnt(0)
    s_barrier
L_wa_4:
    s_cbranch_execz L_wa_ret
    ds_read_b128 v[72:75], v6
    s_waitcnt lgkmcnt(0)
    buffer_store_dwordx4 v[72:75], v7, s[24:27], s95 offen sc1
    s_waitcnt vmcnt(0) lgkmcnt(0)
    s_barrier
    s_cmp_lg_u32 s44, 0
    s_cbranch_scc1 L_nopub19
    s_lshl_b32 s60, s48, 4
    s_add_u32 s60, s60, s49
    s_lshl_b32 s60, s60, 7
    s_add_u32 s60, s60, 12779520
    v_mov_b32 v30, s47
    s_mov_b64 exec, 1
    buffer_store_dword v30, off, s[24:27], s60 sc1
    s_mov_b64 exec, -1
L_nopub19:
    s_endpgm
L_codeend:
.section .rodata,"a"
.p2align 6
.amdhsa_kernel parallel_sum__sliding_local_dilated__mixer_token_mlp__prompt_kernel
  .amdhsa_next_free_vgpr 512
  .amdhsa_next_free_sgpr 102
  .amdhsa_accum_offset 256
  .amdhsa_group_segment_fixed_size 0
  .amdhsa_kernarg_size 88
  .amdhsa_user_sgpr_count 2
  .amdhsa_user_sgpr_kernarg_segment_ptr 1
  .amdhsa_system_sgpr_workgroup_id_x 1
  .amdhsa_float_denorm_mode_32 3
.end_amdhsa_kernel
```
